```python
import torch

def _softmax(x, axis=-1):
    return torch.softmax(x, dim=axis)
def _gelu(x):
    return torch.nn.functional.gelu(x, approximate="tanh")
def _silu(x):
    return torch.nn.functional.silu(x)
def _sigmoid(x):
    return torch.sigmoid(x)
def _layernorm(x, axis=-1, eps=1e-5):
    m = x.mean(dim=axis, keepdim=True)
    v = x.var(dim=axis, keepdim=True, unbiased=False)
    return (x - m) / torch.sqrt(v + eps)
def _scatter_add(tgt, idx, src, axis=0):
    return tgt.clone().index_add_(axis, idx, src)
def _segment_sum(src, seg, n):
    out = torch.zeros((n,) + src.shape[1:], dtype=src.dtype)
    return out.index_add_(0, seg, src)
def _pad(x, pw):
    flat = tuple(v for pair in reversed(pw) for v in pair)
    return torch.nn.functional.pad(x, flat)

kernel_name = 'concat_heads__compressed_kv_cla__gqa_block_cached__decode'

def setup_inputs():

    _w = (lambda a: (lambda t: t.to(torch.bfloat16) if t.is_floating_point() else t)(torch.as_tensor(a)))
    def _A_setup():
        B, H, Sq, Sk, D, M = 2, 32, 1, 4096, 128, 512
        Dc = 4 * D
        return {
            "x": _w((lambda *s: torch.randn(*s, dtype=torch.bfloat16) * 3.2)(B, Sq, M)),
            "c_kv": _w((lambda *s: torch.randn(*s, dtype=torch.bfloat16) * 0.1)(B, Sk, Dc)),
            "w_q": _w((lambda *s: torch.randn(*s, dtype=torch.bfloat16) * 6.4)(M, H, D) * (M ** -0.5)),
            "w_uk": _w((lambda *s: torch.randn(*s, dtype=torch.bfloat16) * 6.4)(Dc, H, D) * (Dc ** -0.5)),
            "w_uv": _w((lambda *s: torch.randn(*s, dtype=torch.bfloat16) * 0.1)(Dc, H, D) * (Dc ** -0.5)),
            "w_o": _w((lambda *s: torch.randn(*s, dtype=torch.bfloat16) * 0.1)(H, D, M) * ((H * D) ** -0.5)),
        }
    _A_in = _A_setup()

    def _B_setup():
        B, Sq, D = 2, 1, 512
        Hq, Hkv, Sk, Dh = 32, 32, 4096, 128
        assert Hq % Hkv == 0, (Hq, Hkv)
        return {
            "x": _w((lambda *s: torch.randn(*s, dtype=torch.bfloat16) * 1.6)(B, Sq, D)),
            "k_cache": _w((lambda *s: torch.randn(*s, dtype=torch.bfloat16) * 1.6)(B, Hkv, Sk, Dh)),
            "v_cache": _w((lambda *s: torch.randn(*s, dtype=torch.bfloat16) * 0.05)(B, Hkv, Sk, Dh)),
            "wq": _w((lambda *s: torch.randn(*s, dtype=torch.bfloat16) * 1.6)(D, Hq * Dh) * (D ** -0.5)),
            "wo": _w((lambda *s: torch.randn(*s, dtype=torch.bfloat16) * 0.05)(Hq * Dh, D) * ((Hq * Dh) ** -0.5)),
        }
    _B_in = _B_setup()

    return {
        "A_x": _A_in["x"],
        "A_c_kv": _A_in["c_kv"],
        "A_w_q": _A_in["w_q"],
        "A_w_uk": _A_in["w_uk"],
        "A_w_uv": _A_in["w_uv"],
        "A_w_o": _A_in["w_o"],
        "B_x": _B_in["x"],
        "B_k_cache": _B_in["k_cache"],
        "B_v_cache": _B_in["v_cache"],
        "B_wq": _B_in["wq"],
        "B_wo": _B_in["wo"],
    }

def reference(A_x, A_c_kv, A_w_q, A_w_uk, A_w_uv, A_w_o, B_x, B_k_cache, B_v_cache, B_wq, B_wo):
    def _A_ref(x, c_kv, w_q, w_uk, w_uv, w_o):
        B, Sq, M = x.shape[0], x.shape[1], x.shape[2]
        Sk = c_kv.shape[1]
        H, D = w_q.shape[1], w_q.shape[2]
        q = torch.einsum("bqm,mhd->bhqd", x, w_q)
        k = torch.einsum("bkc,chd->bhkd", c_kv, w_uk)
        v = torch.einsum("bkc,chd->bhkd", c_kv, w_uv)
        scores = torch.einsum("bhqd,bhkd->bhqk", q, k) * (D ** -0.5)
        off = Sk - Sq
        qi = torch.arange(Sq)[:, None]
        kj = torch.arange(Sk)[None, :]
        cmask = kj <= (qi + off)
        scores = torch.where(cmask[None, None], scores, -1e9)
        p = _softmax(scores, axis=-1)
        ctx = torch.einsum("bhqk,bhkd->bhqd", p, v)
        return torch.einsum("bhqd,hdm->bqm", ctx, w_o)

    def _B_ref(x, k_cache, v_cache, wq, wo):
        B, Sq, D = x.shape
        Hq, Dh = 32, 128
        Hkv = k_cache.shape[1]
        rep = Hq // Hkv
        q = (lambda x, *d: x.permute(*d))((x @ wq).reshape(B, Sq, Hq, Dh), 0, 2, 1, 3)
        k = (lambda x, n, axis: torch.repeat_interleave(x, n, dim=axis))(k_cache, rep, axis=1)
        v = (lambda x, n, axis: torch.repeat_interleave(x, n, dim=axis))(v_cache, rep, axis=1)
        scores = torch.einsum("bhqd,bhkd->bhqk", q, k) * (Dh ** -0.5)
        p = _softmax(scores, axis=-1)
        o = torch.einsum("bhqk,bhkd->bhqd", p, v)
        return (lambda x, *d: x.permute(*d))(o, 0, 2, 1, 3).reshape(B, Sq, Hq * Dh) @ wo

    a = _A_ref(A_x, A_c_kv, A_w_q, A_w_uk, A_w_uv, A_w_o)
    b = _B_ref(B_x, B_k_cache, B_v_cache, B_wq, B_wo)
    return torch.concatenate([a, b], axis=-1)
```

```asm
; @launch grid=(256,1,1) block=(512,1,1) lds=163840
.amdgcn_target "amdgcn-amd-amdhsa--gfx950"
.text
.globl concat_heads__compressed_kv_cla__gqa_block_cached__decode_kernel
.p2align 8
.type concat_heads__compressed_kv_cla__gqa_block_cached__decode_kernel,@function
concat_heads__compressed_kv_cla__gqa_block_cached__decode_kernel:
    s_cmp_ge_u32 s2, 256
    s_cbranch_scc1 L_end
    s_cmp_ge_u32 s2, 8
    s_cbranch_scc1 Lpf_1
    s_getpc_b64 s[4:5]
    s_and_b32 s4, s4, 0xffffff00
    v_lshlrev_b32 v2, 4, v0
    v_min_u32 v3, L_end-concat_heads__compressed_kv_cla__gqa_block_cached__decode_kernel-16, v2
    global_load_dwordx4 v[252:255], v3, s[4:5]
    v_add_u32 v2, 0x2000, v2
    v_min_u32 v3, L_end-concat_heads__compressed_kv_cla__gqa_block_cached__decode_kernel-16, v2
    global_load_dwordx4 v[252:255], v3, s[4:5]
    v_add_u32 v2, 0x2000, v2
    v_min_u32 v3, L_end-concat_heads__compressed_kv_cla__gqa_block_cached__decode_kernel-16, v2
    global_load_dwordx4 v[252:255], v3, s[4:5]
    v_add_u32 v2, 0x2000, v2
    v_min_u32 v3, L_end-concat_heads__compressed_kv_cla__gqa_block_cached__decode_kernel-16, v2
    global_load_dwordx4 v[252:255], v3, s[4:5]
Lpf_1:
    s_load_dwordx16 s[4:19], s[0:1], 0
    s_load_dwordx8 s[20:27], s[0:1], 64
    s_load_dwordx4 s[28:31], s[0:1], 96
    v_lshrrev_b32 v1, 6, v0
    s_lshr_b32 s57, s2, 3
    v_readfirstlane_b32 s56, v1
    s_and_b32 s58, s2, 7
    s_mov_b32 s34, 268435456
    s_mov_b32 s35, 0x00020000
    s_mov_b32 s54, 256
    s_mov_b32 s55, 0x00020000
    s_nop 0
    s_and_b32 s59, s57, 3
    s_lshl_b32 s60, s58, 2
    s_add_u32 s59, s59, s60
    s_bfe_u32 s60, s57, 0x10002
    s_bfe_u32 s62, s57, 0x10003
    s_lshr_b32 s78, s57, 4
    s_lshl_b32 s3, s78, 5
    s_add_u32 s3, s3, s59
    s_lshl_b32 s3, s3, 2
    s_add_u32 s3, s3, s62
    s_lshl_b32 s3, s3, 1
    s_add_u32 s3, s3, s60
    s_lshl_b32 s3, s3, 8
    s_add_u32 s3, s3, 1310720
    s_and_b32 s91, s59, 0xfc
    v_and_b32 v228, 63, v0
    v_lshrrev_b32 v229, 3, v228
    v_and_b32 v230, 7, v228
    v_lshlrev_b32 v231, 3, v229
    v_lshlrev_b32 v232, 15, v229
    v_lshl_add_u32 v232, v230, 4, v232
    s_lshl_b32 s76, s56, 6
    s_lshl_b32 s62, s62, 9
    s_add_u32 s76, s76, s62
    s_lshl_b32 s77, s76, 12
    s_lshl_b32 s59, s59, 8
    s_lshl_b32 s60, s60, 7
    s_add_u32 s77, s77, s59
    s_add_u32 s77, s77, s60
    s_mov_b32 s38, 4194304
    s_mov_b32 s39, 0x00020000
    s_mov_b32 s42, 2048
    s_mov_b32 s43, 0x00020000
    s_mov_b32 s68, 0x05040100
    s_mov_b32 s69, 0x07060302
    s_cmp_lt_u32 s57, 8
    s_cbranch_scc1 L_roleA
    s_waitcnt lgkmcnt(0)
    s_mov_b32 s32, s30
    s_and_b32 s33, s31, 0xffff
    s_mov_b32 s52, s28
    s_and_b32 s53, s29, 0xffff
    s_cmp_eq_u32 s78, 0
    s_cselect_b32 s36, s8, s22
    s_cselect_b32 s37, s9, s23
    s_cselect_b32 s40, s4, s16
    s_cselect_b32 s41, s5, s17
    s_and_b32 s37, s37, 0xffff
    s_and_b32 s41, s41, 0xffff
    buffer_load_dwordx4 v[192:195], v232, s[36:39], s77 offen nt
    s_add_u32 s77, s77, 8192
    buffer_load_dwordx4 v[196:199], v232, s[36:39], s77 offen nt
    s_add_u32 s77, s77, 8192
    buffer_load_dwordx4 v[200:203], v232, s[36:39], s77 offen nt
    s_add_u32 s77, s77, 8192
    buffer_load_dwordx4 v[204:207], v232, s[36:39], s77 offen nt
    buffer_load_dwordx2 v[208:209], v231, s[40:43], s76 offen offset:0
    buffer_load_dwordx2 v[210:211], v231, s[40:43], s76 offen offset:1024
    s_sub_u32 s57, s57, 8
    s_mul_i32 s59, s57, 43
    s_lshr_b32 s59, s59, 8
    s_mul_i32 s60, s59, 6
    s_sub_u32 s60, s57, s60
    s_mul_i32 s66, s60, 86
    s_lshr_b32 s66, s66, 8
    s_mul_i32 s61, s66, 3
    s_sub_u32 s67, s60, s61
    s_mov_b32 s64, s60
    s_mul_i32 s65, s67, 3
    s_add_u32 s65, s65, s58
    s_and_b32 s65, s65, 7
    s_lshl_b32 s65, s65, 2
    s_add_u32 s65, s65, s59
    v_and_b32 v1, 63, v0
    v_lshrrev_b32 v2, 4, v1
    v_and_b32 v3, 15, v1
    s_lshl_b32 s59, s66, 5
    s_add_u32 s59, s59, s65
    s_lshl_b32 s61, s59, 20
    s_lshl_b32 s63, s59, 8
    s_add_u32 s63, s63, 1507328
    v_lshlrev_b32 v4, 4, v1
    s_mov_b32 s70, 1040356334
    v_mov_b32 v60, 0
    s_mul_i32 s71, s67, 7
    s_add_u32 s71, s71, s56
    s_mov_b32 s46, 1048576
    s_mov_b32 s47, 0x00020000
    s_mov_b32 s50, 1048576
    s_mov_b32 s51, 0x00020000
    s_add_u32 s44, s18, s61
    s_addc_u32 s45, s19, 0
    s_and_b32 s45, s45, 0xffff
    s_add_u32 s48, s20, s61
    s_addc_u32 s49, s21, 0
    s_and_b32 s49, s49, 0xffff
    s_barrier
    s_mov_b32 s74, 256
    s_add_u32 s72, s71, 21
    s_cmp_eq_u32 s56, 7
    s_cbranch_scc1 Lpoller_2
    s_add_u32 s88, s71, 0
    s_lshl_b32 s100, s88, 12
    buffer_load_dwordx4 v[64:67], v4, s[44:47], s100 offen offset:0 nt
    buffer_load_dwordx4 v[68:71], v4, s[44:47], s100 offen offset:1024 nt
    buffer_load_dwordx4 v[72:75], v4, s[44:47], s100 offen offset:2048 nt
    buffer_load_dwordx4 v[76:79], v4, s[44:47], s100 offen offset:3072 nt
    s_waitcnt vmcnt(4)
    v_perm_b32 v232, v196, v192, s68
    v_perm_b32 v233, v196, v192, s69
    v_perm_b32 v234, v197, v193, s68
    v_perm_b32 v235, v197, v193, s69
    v_perm_b32 v236, v198, v194, s68
    v_perm_b32 v237, v198, v194, s69
    v_perm_b32 v238, v199, v195, s68
    v_perm_b32 v239, v199, v195, s69
    v_dot2_f32_bf16 v212, v232, v208, 0
    v_dot2_f32_bf16 v213, v233, v208, 0
    v_dot2_f32_bf16 v214, v234, v208, 0
    v_dot2_f32_bf16 v215, v235, v208, 0
    v_dot2_f32_bf16 v216, v236, v208, 0
    v_dot2_f32_bf16 v217, v237, v208, 0
    v_dot2_f32_bf16 v218, v238, v208, 0
    v_dot2_f32_bf16 v219, v239, v208, 0
    v_dot2_f32_bf16 v220, v232, v210, 0
    v_dot2_f32_bf16 v221, v233, v210, 0
    v_dot2_f32_bf16 v222, v234, v210, 0
    v_dot2_f32_bf16 v223, v235, v210, 0
    v_dot2_f32_bf16 v224, v236, v210, 0
    v_dot2_f32_bf16 v225, v237, v210, 0
    v_dot2_f32_bf16 v226, v238, v210, 0
    v_dot2_f32_bf16 v227, v239, v210, 0
    v_perm_b32 v232, v204, v200, s68
    v_perm_b32 v233, v204, v200, s69
    v_perm_b32 v234, v205, v201, s68
    v_perm_b32 v235, v205, v201, s69
    v_perm_b32 v236, v206, v202, s68
    v_perm_b32 v237, v206, v202, s69
    v_perm_b32 v238, v207, v203, s68
    v_perm_b32 v239, v207, v203, s69
    v_dot2_f32_bf16 v212, v232, v209, v212
    v_dot2_f32_bf16 v213, v233, v209, v213
    v_dot2_f32_bf16 v214, v234, v209, v214
    v_dot2_f32_bf16 v215, v235, v209, v215
    v_dot2_f32_bf16 v216, v236, v209, v216
    v_dot2_f32_bf16 v217, v237, v209, v217
    v_dot2_f32_bf16 v218, v238, v209, v218
    v_dot2_f32_bf16 v219, v239, v209, v219
    v_dot2_f32_bf16 v220, v232, v211, v220
    v_dot2_f32_bf16 v221, v233, v211, v221
    v_dot2_f32_bf16 v222, v234, v211, v222
    v_dot2_f32_bf16 v223, v235, v211, v223
    v_dot2_f32_bf16 v224, v236, v211, v224
    v_dot2_f32_bf16 v225, v237, v211, v225
    v_dot2_f32_bf16 v226, v238, v211, v226
    v_dot2_f32_bf16 v227, v239, v211, v227
    s_nop 2
    v_permlane32_swap_b32 v212, v220
    v_permlane32_swap_b32 v213, v221
    v_permlane32_swap_b32 v214, v222
    v_permlane32_swap_b32 v215, v223
    v_permlane32_swap_b32 v216, v224
    v_permlane32_swap_b32 v217, v225
    v_permlane32_swap_b32 v218, v226
    v_permlane32_swap_b32 v219, v227
    s_nop 1
    v_add_f32 v212, v212, v220
    v_add_f32 v213, v213, v221
    v_add_f32 v214, v214, v222
    v_add_f32 v215, v215, v223
    v_add_f32 v216, v216, v224
    v_add_f32 v217, v217, v225
    v_add_f32 v218, v218, v226
    v_add_f32 v219, v219, v227
    s_nop 1
    v_permlane16_swap_b32 v212, v216
    v_permlane16_swap_b32 v213, v217
    v_permlane16_swap_b32 v214, v218
    v_permlane16_swap_b32 v215, v219
    s_nop 1
    v_add_f32 v212, v212, v216
    v_add_f32 v213, v213, v217
    v_add_f32 v214, v214, v218
    v_add_f32 v215, v215, v219
    s_nop 1
    v_add_f32_dpp v212, v212, v212 row_ror:8 row_mask:0xf bank_mask:0xf
    v_add_f32_dpp v213, v213, v213 row_ror:8 row_mask:0xf bank_mask:0xf
    v_add_f32_dpp v214, v214, v214 row_ror:8 row_mask:0xf bank_mask:0xf
    v_add_f32_dpp v215, v215, v215 row_ror:8 row_mask:0xf bank_mask:0xf
    v_lshrrev_b32 v232, 5, v228
    v_lshlrev_b32 v232, 8, v232
    v_bfe_u32 v233, v228, 4, 1
    v_lshl_add_u32 v232, v233, 4, v232
    v_lshl_add_u32 v232, v230, 5, v232
    s_lshl_b32 s61, s56, 9
    s_add_u32 s61, s61, 12288
    v_add_u32 v232, s61, v232
    ds_write_b128 v232, v[212:215]
    s_waitcnt lgkmcnt(0)
    s_barrier
    s_waitcnt vmcnt(3)
    buffer_load_dwordx4 v[80:83], v4, s[48:51], s100 offen offset:0 nt
    s_waitcnt vmcnt(3)
    buffer_load_dwordx4 v[84:87], v4, s[48:51], s100 offen offset:1024 nt
    s_waitcnt vmcnt(3)
    buffer_load_dwordx4 v[88:91], v4, s[48:51], s100 offen offset:2048 nt
    s_waitcnt vmcnt(3)
    buffer_load_dwordx4 v[92:95], v4, s[48:51], s100 offen offset:3072 nt
    s_add_u32 s88, s71, 21
    s_lshl_b32 s100, s88, 12
    s_waitcnt vmcnt(3)
    buffer_load_dwordx4 v[96:99], v4, s[44:47], s100 offen offset:0 nt
    s_waitcnt vmcnt(3)
    buffer_load_dwordx4 v[100:103], v4, s[44:47], s100 offen offset:1024 nt
    s_waitcnt vmcnt(3)
    buffer_load_dwordx4 v[104:107], v4, s[44:47], s100 offen offset:2048 nt
    s_waitcnt vmcnt(3)
    buffer_load_dwordx4 v[108:111], v4, s[44:47], s100 offen offset:3072 nt
    s_waitcnt vmcnt(3)
    buffer_load_dwordx4 v[112:115], v4, s[48:51], s100 offen offset:0 nt
    s_waitcnt vmcnt(3)
    buffer_load_dwordx4 v[116:119], v4, s[48:51], s100 offen offset:1024 nt
    s_waitcnt vmcnt(3)
    buffer_load_dwordx4 v[120:123], v4, s[48:51], s100 offen offset:2048 nt
    s_waitcnt vmcnt(3)
    buffer_load_dwordx4 v[124:127], v4, s[48:51], s100 offen offset:3072 nt
    s_add_u32 s88, s71, 42
    s_lshl_b32 s100, s88, 12
    s_waitcnt vmcnt(3)
    buffer_load_dwordx4 v[128:131], v4, s[44:47], s100 offen offset:0 nt
    s_waitcnt vmcnt(3)
    buffer_load_dwordx4 v[132:135], v4, s[44:47], s100 offen offset:1024 nt
    s_waitcnt vmcnt(3)
    buffer_load_dwordx4 v[136:139], v4, s[44:47], s100 offen offset:2048 nt
    s_waitcnt vmcnt(3)
    buffer_load_dwordx4 v[140:143], v4, s[44:47], s100 offen offset:3072 nt
    s_waitcnt vmcnt(3)
    buffer_load_dwordx4 v[144:147], v4, s[48:51], s100 offen offset:0 nt
    s_waitcnt vmcnt(3)
    buffer_load_dwordx4 v[148:151], v4, s[48:51], s100 offen offset:1024 nt
    s_waitcnt vmcnt(3)
    buffer_load_dwordx4 v[152:155], v4, s[48:51], s100 offen offset:2048 nt
    s_waitcnt vmcnt(3)
    buffer_load_dwordx4 v[156:159], v4, s[48:51], s100 offen offset:3072 nt
    s_add_u32 s88, s71, 63
    s_lshl_b32 s100, s88, 12
    s_waitcnt vmcnt(3)
    buffer_load_dwordx4 v[160:163], v4, s[44:47], s100 offen offset:0 nt
    s_waitcnt vmcnt(3)
    buffer_load_dwordx4 v[164:167], v4, s[44:47], s100 offen offset:1024 nt
    s_waitcnt vmcnt(3)
    buffer_load_dwordx4 v[168:171], v4, s[44:47], s100 offen offset:2048 nt
    s_waitcnt vmcnt(3)
    buffer_load_dwordx4 v[172:175], v4, s[44:47], s100 offen offset:3072 nt
    s_waitcnt vmcnt(3)
    buffer_load_dwordx4 v[176:179], v4, s[48:51], s100 offen offset:0 nt
    s_waitcnt vmcnt(3)
    buffer_load_dwordx4 v[180:183], v4, s[48:51], s100 offen offset:1024 nt
    s_waitcnt vmcnt(3)
    buffer_load_dwordx4 v[184:187], v4, s[48:51], s100 offen offset:2048 nt
    s_waitcnt vmcnt(3)
    buffer_load_dwordx4 v[188:191], v4, s[48:51], s100 offen offset:3072 nt
    s_branch Ljoin_3
Lpoller_2:
    s_setprio 3
    s_waitcnt vmcnt(0)
    v_perm_b32 v232, v196, v192, s68
    v_perm_b32 v233, v196, v192, s69
    v_perm_b32 v234, v197, v193, s68
    v_perm_b32 v235, v197, v193, s69
    v_perm_b32 v236, v198, v194, s68
    v_perm_b32 v237, v198, v194, s69
    v_perm_b32 v238, v199, v195, s68
    v_perm_b32 v239, v199, v195, s69
    v_dot2_f32_bf16 v212, v232, v208, 0
    v_dot2_f32_bf16 v213, v233, v208, 0
    v_dot2_f32_bf16 v214, v234, v208, 0
    v_dot2_f32_bf16 v215, v235, v208, 0
    v_dot2_f32_bf16 v216, v236, v208, 0
    v_dot2_f32_bf16 v217, v237, v208, 0
    v_dot2_f32_bf16 v218, v238, v208, 0
    v_dot2_f32_bf16 v219, v239, v208, 0
    v_dot2_f32_bf16 v220, v232, v210, 0
    v_dot2_f32_bf16 v221, v233, v210, 0
    v_dot2_f32_bf16 v222, v234, v210, 0
    v_dot2_f32_bf16 v223, v235, v210, 0
    v_dot2_f32_bf16 v224, v236, v210, 0
    v_dot2_f32_bf16 v225, v237, v210, 0
    v_dot2_f32_bf16 v226, v238, v210, 0
    v_dot2_f32_bf16 v227, v239, v210, 0
    v_perm_b32 v232, v204, v200, s68
    v_perm_b32 v233, v204, v200, s69
    v_perm_b32 v234, v205, v201, s68
    v_perm_b32 v235, v205, v201, s69
    v_perm_b32 v236, v206, v202, s68
    v_perm_b32 v237, v206, v202, s69
    v_perm_b32 v238, v207, v203, s68
    v_perm_b32 v239, v207, v203, s69
    v_dot2_f32_bf16 v212, v232, v209, v212
    v_dot2_f32_bf16 v213, v233, v209, v213
    v_dot2_f32_bf16 v214, v234, v209, v214
    v_dot2_f32_bf16 v215, v235, v209, v215
    v_dot2_f32_bf16 v216, v236, v209, v216
    v_dot2_f32_bf16 v217, v237, v209, v217
    v_dot2_f32_bf16 v218, v238, v209, v218
    v_dot2_f32_bf16 v219, v239, v209, v219
    v_dot2_f32_bf16 v220, v232, v211, v220
    v_dot2_f32_bf16 v221, v233, v211, v221
    v_dot2_f32_bf16 v222, v234, v211, v222
    v_dot2_f32_bf16 v223, v235, v211, v223
    v_dot2_f32_bf16 v224, v236, v211, v224
    v_dot2_f32_bf16 v225, v237, v211, v225
    v_dot2_f32_bf16 v226, v238, v211, v226
    v_dot2_f32_bf16 v227, v239, v211, v227
    s_nop 2
    v_permlane32_swap_b32 v212, v220
    v_permlane32_swap_b32 v213, v221
    v_permlane32_swap_b32 v214, v222
    v_permlane32_swap_b32 v215, v223
    v_permlane32_swap_b32 v216, v224
    v_permlane32_swap_b32 v217, v225
    v_permlane32_swap_b32 v218, v226
    v_permlane32_swap_b32 v219, v227
    s_nop 1
    v_add_f32 v212, v212, v220
    v_add_f32 v213, v213, v221
    v_add_f32 v214, v214, v222
    v_add_f32 v215, v215, v223
    v_add_f32 v216, v216, v224
    v_add_f32 v217, v217, v225
    v_add_f32 v218, v218, v226
    v_add_f32 v219, v219, v227
    s_nop 1
    v_permlane16_swap_b32 v212, v216
    v_permlane16_swap_b32 v213, v217
    v_permlane16_swap_b32 v214, v218
    v_permlane16_swap_b32 v215, v219
    s_nop 1
    v_add_f32 v212, v212, v216
    v_add_f32 v213, v213, v217
    v_add_f32 v214, v214, v218
    v_add_f32 v215, v215, v219
    s_nop 1
    v_add_f32_dpp v212, v212, v212 row_ror:8 row_mask:0xf bank_mask:0xf
    v_add_f32_dpp v213, v213, v213 row_ror:8 row_mask:0xf bank_mask:0xf
    v_add_f32_dpp v214, v214, v214 row_ror:8 row_mask:0xf bank_mask:0xf
    v_add_f32_dpp v215, v215, v215 row_ror:8 row_mask:0xf bank_mask:0xf
    v_lshrrev_b32 v232, 5, v228
    v_lshlrev_b32 v232, 8, v232
    v_bfe_u32 v233, v228, 4, 1
    v_lshl_add_u32 v232, v233, 4, v232
    v_lshl_add_u32 v232, v230, 5, v232
    s_lshl_b32 s61, s56, 9
    s_add_u32 s61, s61, 12288
    v_add_u32 v232, s61, v232
    ds_write_b128 v232, v[212:215]
    s_waitcnt lgkmcnt(0)
    s_barrier
    v_mov_b32 v234, 0
    buffer_load_dword v235, v234, s[52:55], s91 offen offset:0 sc0 sc1
    v_and_b32 v232, 31, v228
    v_lshlrev_b32 v233, 4, v232
    v_add_u32 v233, 12288, v233
    ds_read_b128 v[192:195], v233 offset:0
    ds_read_b128 v[196:199], v233 offset:512
    ds_read_b128 v[200:203], v233 offset:1024
    ds_read_b128 v[204:207], v233 offset:1536
    ds_read_b128 v[208:211], v233 offset:2048
    ds_read_b128 v[212:215], v233 offset:2560
    ds_read_b128 v[216:219], v233 offset:3072
    ds_read_b128 v[220:223], v233 offset:3584
    s_waitcnt lgkmcnt(6)
    v_add_f32 v192, v192, v196
    v_add_f32 v193, v193, v197
    v_add_f32 v194, v194, v198
    v_add_f32 v195, v195, v199
    s_waitcnt lgkmcnt(5)
    v_add_f32 v192, v192, v200
    v_add_f32 v193, v193, v201
    v_add_f32 v194, v194, v202
    v_add_f32 v195, v195, v203
    s_waitcnt lgkmcnt(4)
    v_add_f32 v192, v192, v204
    v_add_f32 v193, v193, v205
    v_add_f32 v194, v194, v206
    v_add_f32 v195, v195, v207
    s_waitcnt lgkmcnt(3)
    v_add_f32 v192, v192, v208
    v_add_f32 v193, v193, v209
    v_add_f32 v194, v194, v210
    v_add_f32 v195, v195, v211
    s_waitcnt lgkmcnt(2)
    v_add_f32 v192, v192, v212
    v_add_f32 v193, v193, v213
    v_add_f32 v194, v194, v214
    v_add_f32 v195, v195, v215
    s_waitcnt lgkmcnt(1)
    v_add_f32 v192, v192, v216
    v_add_f32 v193, v193, v217
    v_add_f32 v194, v194, v218
    v_add_f32 v195, v195, v219
    s_waitcnt lgkmcnt(0)
    v_add_f32 v192, v192, v220
    v_add_f32 v193, v193, v221
    v_add_f32 v194, v194, v222
    v_add_f32 v195, v195, v223
    v_lshrrev_b32 v233, 4, v232
    v_lshlrev_b32 v233, 10, v233
    v_and_b32 v232, 15, v232
    v_lshl_add_u32 v233, v232, 4, v233
    s_waitcnt vmcnt(0)
    s_mov_b32 s92, 0
Lcf_4:
    v_readfirstlane_b32 s57, v235
    s_nop 3
    s_cmp_lg_u32 s57, 0
    s_cbranch_scc1 Lcfd_5
    s_sleep 2
    buffer_load_dword v235, v234, s[52:55], s91 offen offset:0 sc0 sc1
    s_waitcnt vmcnt(0)
    s_add_u32 s92, s92, 1
    s_cmp_lt_u32 s92, 400000
    s_cbranch_scc1 Lcf_4
Lcfd_5:
    s_mov_b64 exec, 0xffffffff
    buffer_store_dwordx4 v[192:195], v233, s[32:35], s3 offen sc0 sc1
    s_mov_b64 exec, -1
    s_and_b32 s91, s65, 0xfc
    v_mov_b32 v44, 0
    v_mov_b32 v45, 0
    s_mov_b32 s92, 0
Lcf_6:
    v_readfirstlane_b32 s57, v45
    s_nop 3
    s_cmp_lg_u32 s57, 0
    s_cbranch_scc1 Lcfd_7
    s_sleep 2
    buffer_load_dword v45, v44, s[52:55], s91 offen offset:0 sc0 sc1
    s_waitcnt vmcnt(0)
    s_add_u32 s92, s92, 1
    s_cmp_lt_u32 s92, 400000
    s_cbranch_scc1 Lcf_6
Lcfd_7:
    v_lshlrev_b32 v40, 4, v1
    s_lshl_b32 s61, s65, 11
    s_lshl_b32 s62, s66, 10
    s_add_u32 s61, s61, s62
    s_add_u32 s61, s61, 1376256
    s_mov_b32 s92, 0
Lpoll_8:
    buffer_load_dwordx4 v[48:51], v40, s[32:35], s61 offen sc0 sc1
    s_waitcnt vmcnt(0)
    v_mov_b32 v41, v48
    v_max3_u32 v41, v41, v49, v50
    v_max_u32 v41, v41, v51
    v_cmpx_eq_u32 vcc, -1, v41
    s_cbranch_execz Lpolld_9
    s_sleep 4
    s_add_u32 s92, s92, 1
    s_cmp_lt_u32 s92, 400000
    s_cbranch_scc1 Lpoll_8
Lpolld_9:
    s_mov_b64 exec, -1
    v_mov_b32 v52, v48
    v_mov_b32 v53, v49
    v_mov_b32 v54, v50
    v_mov_b32 v55, v51
    s_nop 1
    v_permlane32_swap_b32 v48, v52
    v_permlane32_swap_b32 v49, v53
    v_permlane32_swap_b32 v50, v54
    v_permlane32_swap_b32 v51, v55
    s_nop 1
    v_add_f32 v48, v48, v52
    v_add_f32 v49, v49, v53
    v_add_f32 v50, v50, v54
    v_add_f32 v51, v51, v55
    v_cvt_pk_bf16_f32 v48, v48, v49
    v_cvt_pk_bf16_f32 v49, v50, v51
    v_mov_b32 v44, 0
    s_mov_b32 s92, 0
Lcf_10:
    buffer_load_dword v45, v44, s[52:55], 0 offen offset:128 sc0 sc1
    s_waitcnt vmcnt(0)
    v_readfirstlane_b32 s57, v45
    s_nop 3
    s_cmp_ge_u32 s57, 64
    s_cbranch_scc1 Lcfd_11
    s_sleep 16
    s_add_u32 s92, s92, 1
    s_cmp_lt_u32 s92, 400000
    s_cbranch_scc1 Lcf_10
Lcfd_11:
    v_and_b32 v42, 31, v1
    v_lshlrev_b32 v42, 3, v42
    ds_write_b64 v42, v[48:49] offset:0
    s_waitcnt lgkmcnt(0)
    v_mov_b32 v40, 0xff7fffff
    v_mov_b32 v41, 0
    v_mov_b32 v42, 56
    ds_write_b64 v42, v[40:41] offset:8192
    v_mov_b32 v40, 0
    v_lshlrev_b32 v42, 3, v1
    ds_write_b64 v42, v[40:41] offset:7680
    v_mov_b32 v42, 256
    ds_write_b32 v42, v40
    s_waitcnt lgkmcnt(0)
    s_barrier
    s_barrier
    s_branch L_end
Ljoin_3:
    s_barrier
    v_lshlrev_b32 v40, 4, v3
    ds_read_b128 v[24:27], v40 offset:0
    s_mul_i32 s62, s67, 7
    s_add_u32 s62, s62, s56
    s_add_u32 s73, s62, 84
    s_add_u32 s61, s62, 65515
    v_mov_b32 v61, s61
    v_mov_b32 v36, 0xff7fffff
    v_mov_b32 v37, 0
    v_mov_b32 v16, 0
    v_mov_b32 v17, 0
    v_mov_b32 v18, 0
    v_mov_b32 v19, 0
    v_mov_b32 v20, 0
    v_mov_b32 v21, 0
    v_mov_b32 v22, 0
    v_mov_b32 v23, 0
    v_lshlrev_b32 v6, 5, v3
    v_lshl_add_u32 v6, v2, 3, v6
    s_lshl_b32 s61, s56, 9
    v_add_u32 v7, s61, v6
    s_waitcnt lgkmcnt(0)
    s_lshl_b32 s100, s73, 12
    s_mov_b32 s71, s73
    s_mov_b64 s[94:95], exec
    s_mov_b64 exec, 1
    v_mov_b32 v59, 1
    buffer_atomic_add v59, v60, s[32:35], s63 offen sc0 sc1
    s_mov_b64 exec, s[94:95]
    v_dot2_f32_bf16 v28, v64, v24, 0
    v_dot2_f32_bf16 v28, v65, v25, v28
    v_dot2_f32_bf16 v28, v66, v26, v28
    v_dot2_f32_bf16 v28, v67, v27, v28
    s_waitcnt vmcnt(3)
    buffer_load_dwordx4 v[64:67], v4, s[44:47], s100 offen offset:0 nt
    v_dot2_f32_bf16 v29, v68, v24, 0
    v_dot2_f32_bf16 v29, v69, v25, v29
    v_dot2_f32_bf16 v29, v70, v26, v29
    v_dot2_f32_bf16 v29, v71, v27, v29
    s_waitcnt vmcnt(3)
    buffer_load_dwordx4 v[68:71], v4, s[44:47], s100 offen offset:1024 nt
    v_dot2_f32_bf16 v30, v72, v24, 0
    v_dot2_f32_bf16 v30, v73, v25, v30
    v_dot2_f32_bf16 v30, v74, v26, v30
    v_dot2_f32_bf16 v30, v75, v27, v30
    s_waitcnt vmcnt(3)
    buffer_load_dwordx4 v[72:75], v4, s[44:47], s100 offen offset:2048 nt
    v_dot2_f32_bf16 v31, v76, v24, 0
    v_dot2_f32_bf16 v31, v77, v25, v31
    v_dot2_f32_bf16 v31, v78, v26, v31
    v_dot2_f32_bf16 v31, v79, v27, v31
    s_waitcnt vmcnt(3)
    buffer_load_dwordx4 v[76:79], v4, s[44:47], s100 offen offset:3072 nt
    s_nop 2
    v_add_f32_dpp v28, v28, v28 row_ror:8 row_mask:0xf bank_mask:0xf
    v_add_f32_dpp v29, v29, v29 row_ror:8 row_mask:0xf bank_mask:0xf
    v_add_f32_dpp v30, v30, v30 row_ror:8 row_mask:0xf bank_mask:0xf
    v_add_f32_dpp v31, v31, v31 row_ror:8 row_mask:0xf bank_mask:0xf
    v_add_f32_dpp v28, v28, v28 row_ror:4 row_mask:0xf bank_mask:0xf
    v_add_f32_dpp v29, v29, v29 row_ror:4 row_mask:0xf bank_mask:0xf
    v_add_f32_dpp v30, v30, v30 row_ror:4 row_mask:0xf bank_mask:0xf
    v_add_f32_dpp v31, v31, v31 row_ror:4 row_mask:0xf bank_mask:0xf
    v_add_f32_dpp v28, v28, v28 row_ror:2 row_mask:0xf bank_mask:0xf
    v_add_f32_dpp v29, v29, v29 row_ror:2 row_mask:0xf bank_mask:0xf
    v_add_f32_dpp v30, v30, v30 row_ror:2 row_mask:0xf bank_mask:0xf
    v_add_f32_dpp v31, v31, v31 row_ror:2 row_mask:0xf bank_mask:0xf
    v_add_f32_dpp v28, v28, v28 row_ror:1 row_mask:0xf bank_mask:0xf
    v_add_f32_dpp v29, v29, v29 row_ror:1 row_mask:0xf bank_mask:0xf
    v_add_f32_dpp v30, v30, v30 row_ror:1 row_mask:0xf bank_mask:0xf
    v_add_f32_dpp v31, v31, v31 row_ror:1 row_mask:0xf bank_mask:0xf
    v_max3_f32 v38, v36, v28, v29
    v_max3_f32 v38, v38, v30, v31
    v_sub_f32 v39, v36, v38
    v_mul_f32 v39, s70, v39
    v_exp_f32 v39, v39
    v_mul_f32 v56, s70, v38
    v_mov_b32 v36, v38
    v_fma_f32 v48, v28, s70, -v56
    v_fma_f32 v49, v29, s70, -v56
    v_fma_f32 v50, v30, s70, -v56
    v_fma_f32 v51, v31, s70, -v56
    v_exp_f32 v48, v48
    v_exp_f32 v49, v49
    v_exp_f32 v50, v50
    v_exp_f32 v51, v51
    v_mul_f32 v37, v37, v39
    v_mul_f32 v16, v16, v39
    v_mul_f32 v17, v17, v39
    v_mul_f32 v18, v18, v39
    v_mul_f32 v19, v19, v39
    v_mul_f32 v20, v20, v39
    v_mul_f32 v21, v21, v39
    v_mul_f32 v22, v22, v39
    v_mul_f32 v23, v23, v39
    v_add_f32 v37, v37, v48
    v_add_f32 v37, v37, v49
    v_add_f32 v37, v37, v50
    v_add_f32 v37, v37, v51
    v_lshlrev_b32 v40, 16, v80
    v_and_b32 v41, 0xffff0000, v80
    v_lshlrev_b32 v42, 16, v81
    v_and_b32 v43, 0xffff0000, v81
    v_lshlrev_b32 v44, 16, v82
    v_and_b32 v45, 0xffff0000, v82
    v_lshlrev_b32 v46, 16, v83
    v_and_b32 v47, 0xffff0000, v83
    s_waitcnt vmcnt(3)
    buffer_load_dwordx4 v[80:83], v4, s[48:51], s100 offen offset:0 nt
    v_fmac_f32 v16, v40, v48
    v_fmac_f32 v17, v41, v48
    v_fmac_f32 v18, v42, v48
    v_fmac_f32 v19, v43, v48
    v_fmac_f32 v20, v44, v48
    v_fmac_f32 v21, v45, v48
    v_fmac_f32 v22, v46, v48
    v_fmac_f32 v23, v47, v48
    v_lshlrev_b32 v40, 16, v84
    v_and_b32 v41, 0xffff0000, v84
    v_lshlrev_b32 v42, 16, v85
    v_and_b32 v43, 0xffff0000, v85
    v_lshlrev_b32 v44, 16, v86
    v_and_b32 v45, 0xffff0000, v86
    v_lshlrev_b32 v46, 16, v87
    v_and_b32 v47, 0xffff0000, v87
    s_waitcnt vmcnt(3)
    buffer_load_dwordx4 v[84:87], v4, s[48:51], s100 offen offset:1024 nt
    v_fmac_f32 v16, v40, v49
    v_fmac_f32 v17, v41, v49
    v_fmac_f32 v18, v42, v49
    v_fmac_f32 v19, v43, v49
    v_fmac_f32 v20, v44, v49
    v_fmac_f32 v21, v45, v49
    v_fmac_f32 v22, v46, v49
    v_fmac_f32 v23, v47, v49
    v_lshlrev_b32 v40, 16, v88
    v_and_b32 v41, 0xffff0000, v88
    v_lshlrev_b32 v42, 16, v89
    v_and_b32 v43, 0xffff0000, v89
    v_lshlrev_b32 v44, 16, v90
    v_and_b32 v45, 0xffff0000, v90
    v_lshlrev_b32 v46, 16, v91
    v_and_b32 v47, 0xffff0000, v91
    s_waitcnt vmcnt(3)
    buffer_load_dwordx4 v[88:91], v4, s[48:51], s100 offen offset:2048 nt
    v_fmac_f32 v16, v40, v50
    v_fmac_f32 v17, v41, v50
    v_fmac_f32 v18, v42, v50
    v_fmac_f32 v19, v43, v50
    v_fmac_f32 v20, v44, v50
    v_fmac_f32 v21, v45, v50
    v_fmac_f32 v22, v46, v50
    v_fmac_f32 v23, v47, v50
    v_lshlrev_b32 v40, 16, v92
    v_and_b32 v41, 0xffff0000, v92
    v_lshlrev_b32 v42, 16, v93
    v_and_b32 v43, 0xffff0000, v93
    v_lshlrev_b32 v44, 16, v94
    v_and_b32 v45, 0xffff0000, v94
    v_lshlrev_b32 v46, 16, v95
    v_and_b32 v47, 0xffff0000, v95
    s_waitcnt vmcnt(3)
    buffer_load_dwordx4 v[92:95], v4, s[48:51], s100 offen offset:3072 nt
    v_fmac_f32 v16, v40, v51
    v_fmac_f32 v17, v41, v51
    v_fmac_f32 v18, v42, v51
    v_fmac_f32 v19, v43, v51
    v_fmac_f32 v20, v44, v51
    v_fmac_f32 v21, v45, v51
    v_fmac_f32 v22, v46, v51
    v_fmac_f32 v23, v47, v51
    v_readfirstlane_b32 s73, v61
    s_nop 3
    s_cmp_ge_u32 s73, 65536
    s_cbranch_scc1 Lgr_16
    s_waitcnt vmcnt(0)
    v_readfirstlane_b32 s73, v61
    s_nop 3
Lgr_16:
    s_add_u32 s73, s73, 4294901886
    v_dot2_f32_bf16 v28, v128, v24, 0
    v_dot2_f32_bf16 v28, v129, v25, v28
    v_dot2_f32_bf16 v28, v130, v26, v28
    v_dot2_f32_bf16 v28, v131, v27, v28
    v_dot2_f32_bf16 v29, v132, v24, 0
    v_dot2_f32_bf16 v29, v133, v25, v29
    v_dot2_f32_bf16 v29, v134, v26, v29
    v_dot2_f32_bf16 v29, v135, v27, v29
    v_dot2_f32_bf16 v30, v136, v24, 0
    v_dot2_f32_bf16 v30, v137, v25, v30
    v_dot2_f32_bf16 v30, v138, v26, v30
    v_dot2_f32_bf16 v30, v139, v27, v30
    v_dot2_f32_bf16 v31, v140, v24, 0
    v_dot2_f32_bf16 v31, v141, v25, v31
    v_dot2_f32_bf16 v31, v142, v26, v31
    v_dot2_f32_bf16 v31, v143, v27, v31
    s_nop 2
    v_add_f32_dpp v28, v28, v28 row_ror:8 row_mask:0xf bank_mask:0xf
    v_add_f32_dpp v29, v29, v29 row_ror:8 row_mask:0xf bank_mask:0xf
    v_add_f32_dpp v30, v30, v30 row_ror:8 row_mask:0xf bank_mask:0xf
    v_add_f32_dpp v31, v31, v31 row_ror:8 row_mask:0xf bank_mask:0xf
    v_add_f32_dpp v28, v28, v28 row_ror:4 row_mask:0xf bank_mask:0xf
    v_add_f32_dpp v29, v29, v29 row_ror:4 row_mask:0xf bank_mask:0xf
    v_add_f32_dpp v30, v30, v30 row_ror:4 row_mask:0xf bank_mask:0xf
    v_add_f32_dpp v31, v31, v31 row_ror:4 row_mask:0xf bank_mask:0xf
    v_add_f32_dpp v28, v28, v28 row_ror:2 row_mask:0xf bank_mask:0xf
    v_add_f32_dpp v29, v29, v29 row_ror:2 row_mask:0xf bank_mask:0xf
    v_add_f32_dpp v30, v30, v30 row_ror:2 row_mask:0xf bank_mask:0xf
    v_add_f32_dpp v31, v31, v31 row_ror:2 row_mask:0xf bank_mask:0xf
    v_add_f32_dpp v28, v28, v28 row_ror:1 row_mask:0xf bank_mask:0xf
    v_add_f32_dpp v29, v29, v29 row_ror:1 row_mask:0xf bank_mask:0xf
    v_add_f32_dpp v30, v30, v30 row_ror:1 row_mask:0xf bank_mask:0xf
    v_add_f32_dpp v31, v31, v31 row_ror:1 row_mask:0xf bank_mask:0xf
    v_max3_f32 v38, v36, v28, v29
    v_max3_f32 v38, v38, v30, v31
    v_sub_f32 v39, v36, v38
    v_mul_f32 v39, s70, v39
    v_exp_f32 v39, v39
    v_mul_f32 v56, s70, v38
    v_mov_b32 v36, v38
    v_fma_f32 v48, v28, s70, -v56
    v_fma_f32 v49, v29, s70, -v56
    v_fma_f32 v50, v30, s70, -v56
    v_fma_f32 v51, v31, s70, -v56
    v_exp_f32 v48, v48
    v_exp_f32 v49, v49
    v_exp_f32 v50, v50
    v_exp_f32 v51, v51
    v_mul_f32 v37, v37, v39
    v_mul_f32 v16, v16, v39
    v_mul_f32 v17, v17, v39
    v_mul_f32 v18, v18, v39
    v_mul_f32 v19, v19, v39
    v_mul_f32 v20, v20, v39
    v_mul_f32 v21, v21, v39
    v_mul_f32 v22, v22, v39
    v_mul_f32 v23, v23, v39
    v_add_f32 v37, v37, v48
    v_add_f32 v37, v37, v49
    v_add_f32 v37, v37, v50
    v_add_f32 v37, v37, v51
    v_lshlrev_b32 v40, 16, v144
    v_and_b32 v41, 0xffff0000, v144
    v_lshlrev_b32 v42, 16, v145
    v_and_b32 v43, 0xffff0000, v145
    v_lshlrev_b32 v44, 16, v146
    v_and_b32 v45, 0xffff0000, v146
    v_lshlrev_b32 v46, 16, v147
    v_and_b32 v47, 0xffff0000, v147
    v_fmac_f32 v16, v40, v48
    v_fmac_f32 v17, v41, v48
    v_fmac_f32 v18, v42, v48
    v_fmac_f32 v19, v43, v48
    v_fmac_f32 v20, v44, v48
    v_fmac_f32 v21, v45, v48
    v_fmac_f32 v22, v46, v48
    v_fmac_f32 v23, v47, v48
    v_lshlrev_b32 v40, 16, v148
    v_and_b32 v41, 0xffff0000, v148
    v_lshlrev_b32 v42, 16, v149
    v_and_b32 v43, 0xffff0000, v149
    v_lshlrev_b32 v44, 16, v150
    v_and_b32 v45, 0xffff0000, v150
    v_lshlrev_b32 v46, 16, v151
    v_and_b32 v47, 0xffff0000, v151
    v_fmac_f32 v16, v40, v49
    v_fmac_f32 v17, v41, v49
    v_fmac_f32 v18, v42, v49
    v_fmac_f32 v19, v43, v49
    v_fmac_f32 v20, v44, v49
    v_fmac_f32 v21, v45, v49
    v_fmac_f32 v22, v46, v49
    v_fmac_f32 v23, v47, v49
    v_lshlrev_b32 v40, 16, v152
    v_and_b32 v41, 0xffff0000, v152
    v_lshlrev_b32 v42, 16, v153
    v_and_b32 v43, 0xffff0000, v153
    v_lshlrev_b32 v44, 16, v154
    v_and_b32 v45, 0xffff0000, v154
    v_lshlrev_b32 v46, 16, v155
    v_and_b32 v47, 0xffff0000, v155
    v_fmac_f32 v16, v40, v50
    v_fmac_f32 v17, v41, v50
    v_fmac_f32 v18, v42, v50
    v_fmac_f32 v19, v43, v50
    v_fmac_f32 v20, v44, v50
    v_fmac_f32 v21, v45, v50
    v_fmac_f32 v22, v46, v50
    v_fmac_f32 v23, v47, v50
    v_lshlrev_b32 v40, 16, v156
    v_and_b32 v41, 0xffff0000, v156
    v_lshlrev_b32 v42, 16, v157
    v_and_b32 v43, 0xffff0000, v157
    v_lshlrev_b32 v44, 16, v158
    v_and_b32 v45, 0xffff0000, v158
    v_lshlrev_b32 v46, 16, v159
    v_and_b32 v47, 0xffff0000, v159
    v_fmac_f32 v16, v40, v51
    v_fmac_f32 v17, v41, v51
    v_fmac_f32 v18, v42, v51
    v_fmac_f32 v19, v43, v51
    v_fmac_f32 v20, v44, v51
    v_fmac_f32 v21, v45, v51
    v_fmac_f32 v22, v46, v51
    v_fmac_f32 v23, v47, v51
    s_lshl_b32 s100, s73, 12
    s_mov_b32 s72, s73
    s_mov_b64 s[94:95], exec
    s_mov_b64 exec, 1
    v_mov_b32 v61, 1
    buffer_atomic_add v61, v60, s[32:35], s63 offen sc0 sc1
    s_mov_b64 exec, s[94:95]
    v_dot2_f32_bf16 v28, v96, v24, 0
    v_dot2_f32_bf16 v28, v97, v25, v28
    v_dot2_f32_bf16 v28, v98, v26, v28
    v_dot2_f32_bf16 v28, v99, v27, v28
    s_waitcnt vmcnt(3)
    buffer_load_dwordx4 v[96:99], v4, s[44:47], s100 offen offset:0 nt
    v_dot2_f32_bf16 v29, v100, v24, 0
    v_dot2_f32_bf16 v29, v101, v25, v29
    v_dot2_f32_bf16 v29, v102, v26, v29
    v_dot2_f32_bf16 v29, v103, v27, v29
    s_waitcnt vmcnt(3)
    buffer_load_dwordx4 v[100:103], v4, s[44:47], s100 offen offset:1024 nt
    v_dot2_f32_bf16 v30, v104, v24, 0
    v_dot2_f32_bf16 v30, v105, v25, v30
    v_dot2_f32_bf16 v30, v106, v26, v30
    v_dot2_f32_bf16 v30, v107, v27, v30
    s_waitcnt vmcnt(3)
    buffer_load_dwordx4 v[104:107], v4, s[44:47], s100 offen offset:2048 nt
    v_dot2_f32_bf16 v31, v108, v24, 0
    v_dot2_f32_bf16 v31, v109, v25, v31
    v_dot2_f32_bf16 v31, v110, v26, v31
    v_dot2_f32_bf16 v31, v111, v27, v31
    s_waitcnt vmcnt(3)
    buffer_load_dwordx4 v[108:111], v4, s[44:47], s100 offen offset:3072 nt
    s_nop 2
    v_add_f32_dpp v28, v28, v28 row_ror:8 row_mask:0xf bank_mask:0xf
    v_add_f32_dpp v29, v29, v29 row_ror:8 row_mask:0xf bank_mask:0xf
    v_add_f32_dpp v30, v30, v30 row_ror:8 row_mask:0xf bank_mask:0xf
    v_add_f32_dpp v31, v31, v31 row_ror:8 row_mask:0xf bank_mask:0xf
    v_add_f32_dpp v28, v28, v28 row_ror:4 row_mask:0xf bank_mask:0xf
    v_add_f32_dpp v29, v29, v29 row_ror:4 row_mask:0xf bank_mask:0xf
    v_add_f32_dpp v30, v30, v30 row_ror:4 row_mask:0xf bank_mask:0xf
    v_add_f32_dpp v31, v31, v31 row_ror:4 row_mask:0xf bank_mask:0xf
    v_add_f32_dpp v28, v28, v28 row_ror:2 row_mask:0xf bank_mask:0xf
    v_add_f32_dpp v29, v29, v29 row_ror:2 row_mask:0xf bank_mask:0xf
    v_add_f32_dpp v30, v30, v30 row_ror:2 row_mask:0xf bank_mask:0xf
    v_add_f32_dpp v31, v31, v31 row_ror:2 row_mask:0xf bank_mask:0xf
    v_add_f32_dpp v28, v28, v28 row_ror:1 row_mask:0xf bank_mask:0xf
    v_add_f32_dpp v29, v29, v29 row_ror:1 row_mask:0xf bank_mask:0xf
    v_add_f32_dpp v30, v30, v30 row_ror:1 row_mask:0xf bank_mask:0xf
    v_add_f32_dpp v31, v31, v31 row_ror:1 row_mask:0xf bank_mask:0xf
    v_max3_f32 v38, v36, v28, v29
    v_max3_f32 v38, v38, v30, v31
    v_sub_f32 v39, v36, v38
    v_mul_f32 v39, s70, v39
    v_exp_f32 v39, v39
    v_mul_f32 v56, s70, v38
    v_mov_b32 v36, v38
    v_fma_f32 v48, v28, s70, -v56
    v_fma_f32 v49, v29, s70, -v56
    v_fma_f32 v50, v30, s70, -v56
    v_fma_f32 v51, v31, s70, -v56
    v_exp_f32 v48, v48
    v_exp_f32 v49, v49
    v_exp_f32 v50, v50
    v_exp_f32 v51, v51
    v_mul_f32 v37, v37, v39
    v_mul_f32 v16, v16, v39
    v_mul_f32 v17, v17, v39
    v_mul_f32 v18, v18, v39
    v_mul_f32 v19, v19, v39
    v_mul_f32 v20, v20, v39
    v_mul_f32 v21, v21, v39
    v_mul_f32 v22, v22, v39
    v_mul_f32 v23, v23, v39
    v_add_f32 v37, v37, v48
    v_add_f32 v37, v37, v49
    v_add_f32 v37, v37, v50
    v_add_f32 v37, v37, v51
    v_lshlrev_b32 v40, 16, v112
    v_and_b32 v41, 0xffff0000, v112
    v_lshlrev_b32 v42, 16, v113
    v_and_b32 v43, 0xffff0000, v113
    v_lshlrev_b32 v44, 16, v114
    v_and_b32 v45, 0xffff0000, v114
    v_lshlrev_b32 v46, 16, v115
    v_and_b32 v47, 0xffff0000, v115
    s_waitcnt vmcnt(3)
    buffer_load_dwordx4 v[112:115], v4, s[48:51], s100 offen offset:0 nt
    v_fmac_f32 v16, v40, v48
    v_fmac_f32 v17, v41, v48
    v_fmac_f32 v18, v42, v48
    v_fmac_f32 v19, v43, v48
    v_fmac_f32 v20, v44, v48
    v_fmac_f32 v21, v45, v48
    v_fmac_f32 v22, v46, v48
    v_fmac_f32 v23, v47, v48
    v_lshlrev_b32 v40, 16, v116
    v_and_b32 v41, 0xffff0000, v116
    v_lshlrev_b32 v42, 16, v117
    v_and_b32 v43, 0xffff0000, v117
    v_lshlrev_b32 v44, 16, v118
    v_and_b32 v45, 0xffff0000, v118
    v_lshlrev_b32 v46, 16, v119
    v_and_b32 v47, 0xffff0000, v119
    s_waitcnt vmcnt(3)
    buffer_load_dwordx4 v[116:119], v4, s[48:51], s100 offen offset:1024 nt
    v_fmac_f32 v16, v40, v49
    v_fmac_f32 v17, v41, v49
    v_fmac_f32 v18, v42, v49
    v_fmac_f32 v19, v43, v49
    v_fmac_f32 v20, v44, v49
    v_fmac_f32 v21, v45, v49
    v_fmac_f32 v22, v46, v49
    v_fmac_f32 v23, v47, v49
    v_lshlrev_b32 v40, 16, v120
    v_and_b32 v41, 0xffff0000, v120
    v_lshlrev_b32 v42, 16, v121
    v_and_b32 v43, 0xffff0000, v121
    v_lshlrev_b32 v44, 16, v122
    v_and_b32 v45, 0xffff0000, v122
    v_lshlrev_b32 v46, 16, v123
    v_and_b32 v47, 0xffff0000, v123
    s_waitcnt vmcnt(3)
    buffer_load_dwordx4 v[120:123], v4, s[48:51], s100 offen offset:2048 nt
    v_fmac_f32 v16, v40, v50
    v_fmac_f32 v17, v41, v50
    v_fmac_f32 v18, v42, v50
    v_fmac_f32 v19, v43, v50
    v_fmac_f32 v20, v44, v50
    v_fmac_f32 v21, v45, v50
    v_fmac_f32 v22, v46, v50
    v_fmac_f32 v23, v47, v50
    v_lshlrev_b32 v40, 16, v124
    v_and_b32 v41, 0xffff0000, v124
    v_lshlrev_b32 v42, 16, v125
    v_and_b32 v43, 0xffff0000, v125
    v_lshlrev_b32 v44, 16, v126
    v_and_b32 v45, 0xffff0000, v126
    v_lshlrev_b32 v46, 16, v127
    v_and_b32 v47, 0xffff0000, v127
    s_waitcnt vmcnt(3)
    buffer_load_dwordx4 v[124:127], v4, s[48:51], s100 offen offset:3072 nt
    v_fmac_f32 v16, v40, v51
    v_fmac_f32 v17, v41, v51
    v_fmac_f32 v18, v42, v51
    v_fmac_f32 v19, v43, v51
    v_fmac_f32 v20, v44, v51
    v_fmac_f32 v21, v45, v51
    v_fmac_f32 v22, v46, v51
    v_fmac_f32 v23, v47, v51
    v_readfirstlane_b32 s73, v59
    s_nop 3
    s_cmp_ge_u32 s73, 65536
    s_cbranch_scc1 Lgr_17
    s_waitcnt vmcnt(0)
    v_readfirstlane_b32 s73, v59
    s_nop 3
Lgr_17:
    s_add_u32 s73, s73, 4294901886
    s_waitcnt vmcnt(4)
    v_dot2_f32_bf16 v28, v160, v24, 0
    v_dot2_f32_bf16 v28, v161, v25, v28
    v_dot2_f32_bf16 v28, v162, v26, v28
    v_dot2_f32_bf16 v28, v163, v27, v28
    v_dot2_f32_bf16 v29, v164, v24, 0
    v_dot2_f32_bf16 v29, v165, v25, v29
    v_dot2_f32_bf16 v29, v166, v26, v29
    v_dot2_f32_bf16 v29, v167, v27, v29
    v_dot2_f32_bf16 v30, v168, v24, 0
    v_dot2_f32_bf16 v30, v169, v25, v30
    v_dot2_f32_bf16 v30, v170, v26, v30
    v_dot2_f32_bf16 v30, v171, v27, v30
    v_dot2_f32_bf16 v31, v172, v24, 0
    v_dot2_f32_bf16 v31, v173, v25, v31
    v_dot2_f32_bf16 v31, v174, v26, v31
    v_dot2_f32_bf16 v31, v175, v27, v31
    s_nop 2
    v_add_f32_dpp v28, v28, v28 row_ror:8 row_mask:0xf bank_mask:0xf
    v_add_f32_dpp v29, v29, v29 row_ror:8 row_mask:0xf bank_mask:0xf
    v_add_f32_dpp v30, v30, v30 row_ror:8 row_mask:0xf bank_mask:0xf
    v_add_f32_dpp v31, v31, v31 row_ror:8 row_mask:0xf bank_mask:0xf
    v_add_f32_dpp v28, v28, v28 row_ror:4 row_mask:0xf bank_mask:0xf
    v_add_f32_dpp v29, v29, v29 row_ror:4 row_mask:0xf bank_mask:0xf
    v_add_f32_dpp v30, v30, v30 row_ror:4 row_mask:0xf bank_mask:0xf
    v_add_f32_dpp v31, v31, v31 row_ror:4 row_mask:0xf bank_mask:0xf
    v_add_f32_dpp v28, v28, v28 row_ror:2 row_mask:0xf bank_mask:0xf
    v_add_f32_dpp v29, v29, v29 row_ror:2 row_mask:0xf bank_mask:0xf
    v_add_f32_dpp v30, v30, v30 row_ror:2 row_mask:0xf bank_mask:0xf
    v_add_f32_dpp v31, v31, v31 row_ror:2 row_mask:0xf bank_mask:0xf
    v_add_f32_dpp v28, v28, v28 row_ror:1 row_mask:0xf bank_mask:0xf
    v_add_f32_dpp v29, v29, v29 row_ror:1 row_mask:0xf bank_mask:0xf
    v_add_f32_dpp v30, v30, v30 row_ror:1 row_mask:0xf bank_mask:0xf
    v_add_f32_dpp v31, v31, v31 row_ror:1 row_mask:0xf bank_mask:0xf
    v_max3_f32 v38, v36, v28, v29
    v_max3_f32 v38, v38, v30, v31
    v_sub_f32 v39, v36, v38
    v_mul_f32 v39, s70, v39
    v_exp_f32 v39, v39
    v_mul_f32 v56, s70, v38
    v_mov_b32 v36, v38
    v_fma_f32 v48, v28, s70, -v56
    v_fma_f32 v49, v29, s70, -v56
    v_fma_f32 v50, v30, s70, -v56
    v_fma_f32 v51, v31, s70, -v56
    v_exp_f32 v48, v48
    v_exp_f32 v49, v49
    v_exp_f32 v50, v50
    v_exp_f32 v51, v51
    v_mul_f32 v37, v37, v39
    v_mul_f32 v16, v16, v39
    v_mul_f32 v17, v17, v39
    v_mul_f32 v18, v18, v39
    v_mul_f32 v19, v19, v39
    v_mul_f32 v20, v20, v39
    v_mul_f32 v21, v21, v39
    v_mul_f32 v22, v22, v39
    v_mul_f32 v23, v23, v39
    v_add_f32 v37, v37, v48
    v_add_f32 v37, v37, v49
    v_add_f32 v37, v37, v50
    v_add_f32 v37, v37, v51
    v_lshlrev_b32 v40, 16, v176
    v_and_b32 v41, 0xffff0000, v176
    v_lshlrev_b32 v42, 16, v177
    v_and_b32 v43, 0xffff0000, v177
    v_lshlrev_b32 v44, 16, v178
    v_and_b32 v45, 0xffff0000, v178
    v_lshlrev_b32 v46, 16, v179
    v_and_b32 v47, 0xffff0000, v179
    v_fmac_f32 v16, v40, v48
    v_fmac_f32 v17, v41, v48
    v_fmac_f32 v18, v42, v48
    v_fmac_f32 v19, v43, v48
    v_fmac_f32 v20, v44, v48
    v_fmac_f32 v21, v45, v48
    v_fmac_f32 v22, v46, v48
    v_fmac_f32 v23, v47, v48
    v_lshlrev_b32 v40, 16, v180
    v_and_b32 v41, 0xffff0000, v180
    v_lshlrev_b32 v42, 16, v181
    v_and_b32 v43, 0xffff0000, v181
    v_lshlrev_b32 v44, 16, v182
    v_and_b32 v45, 0xffff0000, v182
    v_lshlrev_b32 v46, 16, v183
    v_and_b32 v47, 0xffff0000, v183
    v_fmac_f32 v16, v40, v49
    v_fmac_f32 v17, v41, v49
    v_fmac_f32 v18, v42, v49
    v_fmac_f32 v19, v43, v49
    v_fmac_f32 v20, v44, v49
    v_fmac_f32 v21, v45, v49
    v_fmac_f32 v22, v46, v49
    v_fmac_f32 v23, v47, v49
    v_lshlrev_b32 v40, 16, v184
    v_and_b32 v41, 0xffff0000, v184
    v_lshlrev_b32 v42, 16, v185
    v_and_b32 v43, 0xffff0000, v185
    v_lshlrev_b32 v44, 16, v186
    v_and_b32 v45, 0xffff0000, v186
    v_lshlrev_b32 v46, 16, v187
    v_and_b32 v47, 0xffff0000, v187
    v_fmac_f32 v16, v40, v50
    v_fmac_f32 v17, v41, v50
    v_fmac_f32 v18, v42, v50
    v_fmac_f32 v19, v43, v50
    v_fmac_f32 v20, v44, v50
    v_fmac_f32 v21, v45, v50
    v_fmac_f32 v22, v46, v50
    v_fmac_f32 v23, v47, v50
    v_lshlrev_b32 v40, 16, v188
    v_and_b32 v41, 0xffff0000, v188
    v_lshlrev_b32 v42, 16, v189
    v_and_b32 v43, 0xffff0000, v189
    v_lshlrev_b32 v44, 16, v190
    v_and_b32 v45, 0xffff0000, v190
    v_lshlrev_b32 v46, 16, v191
    v_and_b32 v47, 0xffff0000, v191
    v_fmac_f32 v16, v40, v51
    v_fmac_f32 v17, v41, v51
    v_fmac_f32 v18, v42, v51
    v_fmac_f32 v19, v43, v51
    v_fmac_f32 v20, v44, v51
    v_fmac_f32 v21, v45, v51
    v_fmac_f32 v22, v46, v51
    v_fmac_f32 v23, v47, v51
LBloop_12:
    s_cmp_ge_u32 s73, 114
    s_cbranch_scc1 LBloop2_14
    s_lshl_b32 s100, s73, 12
    s_mov_b32 s71, s73
    s_mov_b64 s[94:95], exec
    s_mov_b64 exec, 1
    v_mov_b32 v59, 1
    buffer_atomic_add v59, v60, s[32:35], s63 offen sc0 sc1
    s_mov_b64 exec, s[94:95]
    v_dot2_f32_bf16 v28, v64, v24, 0
    v_dot2_f32_bf16 v28, v65, v25, v28
    v_dot2_f32_bf16 v28, v66, v26, v28
    v_dot2_f32_bf16 v28, v67, v27, v28
    s_waitcnt vmcnt(3)
    buffer_load_dwordx4 v[64:67], v4, s[44:47], s100 offen offset:0 nt
    v_dot2_f32_bf16 v29, v68, v24, 0
    v_dot2_f32_bf16 v29, v69, v25, v29
    v_dot2_f32_bf16 v29, v70, v26, v29
    v_dot2_f32_bf16 v29, v71, v27, v29
    s_waitcnt vmcnt(3)
    buffer_load_dwordx4 v[68:71], v4, s[44:47], s100 offen offset:1024 nt
    v_dot2_f32_bf16 v30, v72, v24, 0
    v_dot2_f32_bf16 v30, v73, v25, v30
    v_dot2_f32_bf16 v30, v74, v26, v30
    v_dot2_f32_bf16 v30, v75, v27, v30
    s_waitcnt vmcnt(3)
    buffer_load_dwordx4 v[72:75], v4, s[44:47], s100 offen offset:2048 nt
    v_dot2_f32_bf16 v31, v76, v24, 0
    v_dot2_f32_bf16 v31, v77, v25, v31
    v_dot2_f32_bf16 v31, v78, v26, v31
    v_dot2_f32_bf16 v31, v79, v27, v31
    s_waitcnt vmcnt(3)
    buffer_load_dwordx4 v[76:79], v4, s[44:47], s100 offen offset:3072 nt
    s_nop 2
    v_add_f32_dpp v28, v28, v28 row_ror:8 row_mask:0xf bank_mask:0xf
    v_add_f32_dpp v29, v29, v29 row_ror:8 row_mask:0xf bank_mask:0xf
    v_add_f32_dpp v30, v30, v30 row_ror:8 row_mask:0xf bank_mask:0xf
    v_add_f32_dpp v31, v31, v31 row_ror:8 row_mask:0xf bank_mask:0xf
    v_add_f32_dpp v28, v28, v28 row_ror:4 row_mask:0xf bank_mask:0xf
    v_add_f32_dpp v29, v29, v29 row_ror:4 row_mask:0xf bank_mask:0xf
    v_add_f32_dpp v30, v30, v30 row_ror:4 row_mask:0xf bank_mask:0xf
    v_add_f32_dpp v31, v31, v31 row_ror:4 row_mask:0xf bank_mask:0xf
    v_add_f32_dpp v28, v28, v28 row_ror:2 row_mask:0xf bank_mask:0xf
    v_add_f32_dpp v29, v29, v29 row_ror:2 row_mask:0xf bank_mask:0xf
    v_add_f32_dpp v30, v30, v30 row_ror:2 row_mask:0xf bank_mask:0xf
    v_add_f32_dpp v31, v31, v31 row_ror:2 row_mask:0xf bank_mask:0xf
    v_add_f32_dpp v28, v28, v28 row_ror:1 row_mask:0xf bank_mask:0xf
    v_add_f32_dpp v29, v29, v29 row_ror:1 row_mask:0xf bank_mask:0xf
    v_add_f32_dpp v30, v30, v30 row_ror:1 row_mask:0xf bank_mask:0xf
    v_add_f32_dpp v31, v31, v31 row_ror:1 row_mask:0xf bank_mask:0xf
    v_max3_f32 v38, v36, v28, v29
    v_max3_f32 v38, v38, v30, v31
    v_sub_f32 v39, v36, v38
    v_mul_f32 v39, s70, v39
    v_exp_f32 v39, v39
    v_mul_f32 v56, s70, v38
    v_mov_b32 v36, v38
    v_fma_f32 v48, v28, s70, -v56
    v_fma_f32 v49, v29, s70, -v56
    v_fma_f32 v50, v30, s70, -v56
    v_fma_f32 v51, v31, s70, -v56
    v_exp_f32 v48, v48
    v_exp_f32 v49, v49
    v_exp_f32 v50, v50
    v_exp_f32 v51, v51
    v_mul_f32 v37, v37, v39
    v_mul_f32 v16, v16, v39
    v_mul_f32 v17, v17, v39
    v_mul_f32 v18, v18, v39
    v_mul_f32 v19, v19, v39
    v_mul_f32 v20, v20, v39
    v_mul_f32 v21, v21, v39
    v_mul_f32 v22, v22, v39
    v_mul_f32 v23, v23, v39
    v_add_f32 v37, v37, v48
    v_add_f32 v37, v37, v49
    v_add_f32 v37, v37, v50
    v_add_f32 v37, v37, v51
    v_lshlrev_b32 v40, 16, v80
    v_and_b32 v41, 0xffff0000, v80
    v_lshlrev_b32 v42, 16, v81
    v_and_b32 v43, 0xffff0000, v81
    v_lshlrev_b32 v44, 16, v82
    v_and_b32 v45, 0xffff0000, v82
    v_lshlrev_b32 v46, 16, v83
    v_and_b32 v47, 0xffff0000, v83
    s_waitcnt vmcnt(3)
    buffer_load_dwordx4 v[80:83], v4, s[48:51], s100 offen offset:0 nt
    v_fmac_f32 v16, v40, v48
    v_fmac_f32 v17, v41, v48
    v_fmac_f32 v18, v42, v48
    v_fmac_f32 v19, v43, v48
    v_fmac_f32 v20, v44, v48
    v_fmac_f32 v21, v45, v48
    v_fmac_f32 v22, v46, v48
    v_fmac_f32 v23, v47, v48
    v_lshlrev_b32 v40, 16, v84
    v_and_b32 v41, 0xffff0000, v84
    v_lshlrev_b32 v42, 16, v85
    v_and_b32 v43, 0xffff0000, v85
    v_lshlrev_b32 v44, 16, v86
    v_and_b32 v45, 0xffff0000, v86
    v_lshlrev_b32 v46, 16, v87
    v_and_b32 v47, 0xffff0000, v87
    s_waitcnt vmcnt(3)
    buffer_load_dwordx4 v[84:87], v4, s[48:51], s100 offen offset:1024 nt
    v_fmac_f32 v16, v40, v49
    v_fmac_f32 v17, v41, v49
    v_fmac_f32 v18, v42, v49
    v_fmac_f32 v19, v43, v49
    v_fmac_f32 v20, v44, v49
    v_fmac_f32 v21, v45, v49
    v_fmac_f32 v22, v46, v49
    v_fmac_f32 v23, v47, v49
    v_lshlrev_b32 v40, 16, v88
    v_and_b32 v41, 0xffff0000, v88
    v_lshlrev_b32 v42, 16, v89
    v_and_b32 v43, 0xffff0000, v89
    v_lshlrev_b32 v44, 16, v90
    v_and_b32 v45, 0xffff0000, v90
    v_lshlrev_b32 v46, 16, v91
    v_and_b32 v47, 0xffff0000, v91
    s_waitcnt vmcnt(3)
    buffer_load_dwordx4 v[88:91], v4, s[48:51], s100 offen offset:2048 nt
    v_fmac_f32 v16, v40, v50
    v_fmac_f32 v17, v41, v50
    v_fmac_f32 v18, v42, v50
    v_fmac_f32 v19, v43, v50
    v_fmac_f32 v20, v44, v50
    v_fmac_f32 v21, v45, v50
    v_fmac_f32 v22, v46, v50
    v_fmac_f32 v23, v47, v50
    v_lshlrev_b32 v40, 16, v92
    v_and_b32 v41, 0xffff0000, v92
    v_lshlrev_b32 v42, 16, v93
    v_and_b32 v43, 0xffff0000, v93
    v_lshlrev_b32 v44, 16, v94
    v_and_b32 v45, 0xffff0000, v94
    v_lshlrev_b32 v46, 16, v95
    v_and_b32 v47, 0xffff0000, v95
    s_waitcnt vmcnt(3)
    buffer_load_dwordx4 v[92:95], v4, s[48:51], s100 offen offset:3072 nt
    v_fmac_f32 v16, v40, v51
    v_fmac_f32 v17, v41, v51
    v_fmac_f32 v18, v42, v51
    v_fmac_f32 v19, v43, v51
    v_fmac_f32 v20, v44, v51
    v_fmac_f32 v21, v45, v51
    v_fmac_f32 v22, v46, v51
    v_fmac_f32 v23, v47, v51
    v_readfirstlane_b32 s73, v61
    s_nop 3
    s_cmp_ge_u32 s73, 65536
    s_cbranch_scc1 Lgr_18
    s_waitcnt vmcnt(0)
    v_readfirstlane_b32 s73, v61
    s_nop 3
Lgr_18:
    s_add_u32 s73, s73, 4294901886
    s_cmp_ge_u32 s73, 114
    s_cbranch_scc1 LBloop2b_15
    s_lshl_b32 s100, s73, 12
    s_mov_b32 s72, s73
    s_mov_b64 s[94:95], exec
    s_mov_b64 exec, 1
    v_mov_b32 v61, 1
    buffer_atomic_add v61, v60, s[32:35], s63 offen sc0 sc1
    s_mov_b64 exec, s[94:95]
    v_dot2_f32_bf16 v28, v96, v24, 0
    v_dot2_f32_bf16 v28, v97, v25, v28
    v_dot2_f32_bf16 v28, v98, v26, v28
    v_dot2_f32_bf16 v28, v99, v27, v28
    s_waitcnt vmcnt(3)
    buffer_load_dwordx4 v[96:99], v4, s[44:47], s100 offen offset:0 nt
    v_dot2_f32_bf16 v29, v100, v24, 0
    v_dot2_f32_bf16 v29, v101, v25, v29
    v_dot2_f32_bf16 v29, v102, v26, v29
    v_dot2_f32_bf16 v29, v103, v27, v29
    s_waitcnt vmcnt(3)
    buffer_load_dwordx4 v[100:103], v4, s[44:47], s100 offen offset:1024 nt
    v_dot2_f32_bf16 v30, v104, v24, 0
    v_dot2_f32_bf16 v30, v105, v25, v30
    v_dot2_f32_bf16 v30, v106, v26, v30
    v_dot2_f32_bf16 v30, v107, v27, v30
    s_waitcnt vmcnt(3)
    buffer_load_dwordx4 v[104:107], v4, s[44:47], s100 offen offset:2048 nt
    v_dot2_f32_bf16 v31, v108, v24, 0
    v_dot2_f32_bf16 v31, v109, v25, v31
    v_dot2_f32_bf16 v31, v110, v26, v31
    v_dot2_f32_bf16 v31, v111, v27, v31
    s_waitcnt vmcnt(3)
    buffer_load_dwordx4 v[108:111], v4, s[44:47], s100 offen offset:3072 nt
    s_nop 2
    v_add_f32_dpp v28, v28, v28 row_ror:8 row_mask:0xf bank_mask:0xf
    v_add_f32_dpp v29, v29, v29 row_ror:8 row_mask:0xf bank_mask:0xf
    v_add_f32_dpp v30, v30, v30 row_ror:8 row_mask:0xf bank_mask:0xf
    v_add_f32_dpp v31, v31, v31 row_ror:8 row_mask:0xf bank_mask:0xf
    v_add_f32_dpp v28, v28, v28 row_ror:4 row_mask:0xf bank_mask:0xf
    v_add_f32_dpp v29, v29, v29 row_ror:4 row_mask:0xf bank_mask:0xf
    v_add_f32_dpp v30, v30, v30 row_ror:4 row_mask:0xf bank_mask:0xf
    v_add_f32_dpp v31, v31, v31 row_ror:4 row_mask:0xf bank_mask:0xf
    v_add_f32_dpp v28, v28, v28 row_ror:2 row_mask:0xf bank_mask:0xf
    v_add_f32_dpp v29, v29, v29 row_ror:2 row_mask:0xf bank_mask:0xf
    v_add_f32_dpp v30, v30, v30 row_ror:2 row_mask:0xf bank_mask:0xf
    v_add_f32_dpp v31, v31, v31 row_ror:2 row_mask:0xf bank_mask:0xf
    v_add_f32_dpp v28, v28, v28 row_ror:1 row_mask:0xf bank_mask:0xf
    v_add_f32_dpp v29, v29, v29 row_ror:1 row_mask:0xf bank_mask:0xf
    v_add_f32_dpp v30, v30, v30 row_ror:1 row_mask:0xf bank_mask:0xf
    v_add_f32_dpp v31, v31, v31 row_ror:1 row_mask:0xf bank_mask:0xf
    v_max3_f32 v38, v36, v28, v29
    v_max3_f32 v38, v38, v30, v31
    v_sub_f32 v39, v36, v38
    v_mul_f32 v39, s70, v39
    v_exp_f32 v39, v39
    v_mul_f32 v56, s70, v38
    v_mov_b32 v36, v38
    v_fma_f32 v48, v28, s70, -v56
    v_fma_f32 v49, v29, s70, -v56
    v_fma_f32 v50, v30, s70, -v56
    v_fma_f32 v51, v31, s70, -v56
    v_exp_f32 v48, v48
    v_exp_f32 v49, v49
    v_exp_f32 v50, v50
    v_exp_f32 v51, v51
    v_mul_f32 v37, v37, v39
    v_mul_f32 v16, v16, v39
    v_mul_f32 v17, v17, v39
    v_mul_f32 v18, v18, v39
    v_mul_f32 v19, v19, v39
    v_mul_f32 v20, v20, v39
    v_mul_f32 v21, v21, v39
    v_mul_f32 v22, v22, v39
    v_mul_f32 v23, v23, v39
    v_add_f32 v37, v37, v48
    v_add_f32 v37, v37, v49
    v_add_f32 v37, v37, v50
    v_add_f32 v37, v37, v51
    v_lshlrev_b32 v40, 16, v112
    v_and_b32 v41, 0xffff0000, v112
    v_lshlrev_b32 v42, 16, v113
    v_and_b32 v43, 0xffff0000, v113
    v_lshlrev_b32 v44, 16, v114
    v_and_b32 v45, 0xffff0000, v114
    v_lshlrev_b32 v46, 16, v115
    v_and_b32 v47, 0xffff0000, v115
    s_waitcnt vmcnt(3)
    buffer_load_dwordx4 v[112:115], v4, s[48:51], s100 offen offset:0 nt
    v_fmac_f32 v16, v40, v48
    v_fmac_f32 v17, v41, v48
    v_fmac_f32 v18, v42, v48
    v_fmac_f32 v19, v43, v48
    v_fmac_f32 v20, v44, v48
    v_fmac_f32 v21, v45, v48
    v_fmac_f32 v22, v46, v48
    v_fmac_f32 v23, v47, v48
    v_lshlrev_b32 v40, 16, v116
    v_and_b32 v41, 0xffff0000, v116
    v_lshlrev_b32 v42, 16, v117
    v_and_b32 v43, 0xffff0000, v117
    v_lshlrev_b32 v44, 16, v118
    v_and_b32 v45, 0xffff0000, v118
    v_lshlrev_b32 v46, 16, v119
    v_and_b32 v47, 0xffff0000, v119
    s_waitcnt vmcnt(3)
    buffer_load_dwordx4 v[116:119], v4, s[48:51], s100 offen offset:1024 nt
    v_fmac_f32 v16, v40, v49
    v_fmac_f32 v17, v41, v49
    v_fmac_f32 v18, v42, v49
    v_fmac_f32 v19, v43, v49
    v_fmac_f32 v20, v44, v49
    v_fmac_f32 v21, v45, v49
    v_fmac_f32 v22, v46, v49
    v_fmac_f32 v23, v47, v49
    v_lshlrev_b32 v40, 16, v120
    v_and_b32 v41, 0xffff0000, v120
    v_lshlrev_b32 v42, 16, v121
    v_and_b32 v43, 0xffff0000, v121
    v_lshlrev_b32 v44, 16, v122
    v_and_b32 v45, 0xffff0000, v122
    v_lshlrev_b32 v46, 16, v123
    v_and_b32 v47, 0xffff0000, v123
    s_waitcnt vmcnt(3)
    buffer_load_dwordx4 v[120:123], v4, s[48:51], s100 offen offset:2048 nt
    v_fmac_f32 v16, v40, v50
    v_fmac_f32 v17, v41, v50
    v_fmac_f32 v18, v42, v50
    v_fmac_f32 v19, v43, v50
    v_fmac_f32 v20, v44, v50
    v_fmac_f32 v21, v45, v50
    v_fmac_f32 v22, v46, v50
    v_fmac_f32 v23, v47, v50
    v_lshlrev_b32 v40, 16, v124
    v_and_b32 v41, 0xffff0000, v124
    v_lshlrev_b32 v42, 16, v125
    v_and_b32 v43, 0xffff0000, v125
    v_lshlrev_b32 v44, 16, v126
    v_and_b32 v45, 0xffff0000, v126
    v_lshlrev_b32 v46, 16, v127
    v_and_b32 v47, 0xffff0000, v127
    s_waitcnt vmcnt(3)
    buffer_load_dwordx4 v[124:127], v4, s[48:51], s100 offen offset:3072 nt
    v_fmac_f32 v16, v40, v51
    v_fmac_f32 v17, v41, v51
    v_fmac_f32 v18, v42, v51
    v_fmac_f32 v19, v43, v51
    v_fmac_f32 v20, v44, v51
    v_fmac_f32 v21, v45, v51
    v_fmac_f32 v22, v46, v51
    v_fmac_f32 v23, v47, v51
    v_readfirstlane_b32 s73, v59
    s_nop 3
    s_cmp_ge_u32 s73, 65536
    s_cbranch_scc1 Lgr_19
    s_waitcnt vmcnt(0)
    v_readfirstlane_b32 s73, v59
    s_nop 3
Lgr_19:
    s_add_u32 s73, s73, 4294901886
    s_branch LBloop_12
LBloop2_14:
    s_cmp_ge_u32 s73, s74
    s_cbranch_scc1 LBtail0_20
    s_lshl_b32 s100, s73, 12
    s_mov_b32 s71, s73
    s_mov_b64 s[94:95], exec
    s_mov_b64 exec, 1
    v_mov_b32 v59, 1
    buffer_atomic_add v59, v60, s[32:35], s63 offen sc0 sc1
    s_mov_b64 exec, s[94:95]
    v_dot2_f32_bf16 v28, v64, v24, 0
    v_dot2_f32_bf16 v28, v65, v25, v28
    v_dot2_f32_bf16 v28, v66, v26, v28
    v_dot2_f32_bf16 v28, v67, v27, v28
    s_waitcnt vmcnt(13)
    buffer_load_dwordx4 v[64:67], v4, s[44:47], s100 offen offset:0 nt
    v_dot2_f32_bf16 v29, v68, v24, 0
    v_dot2_f32_bf16 v29, v69, v25, v29
    v_dot2_f32_bf16 v29, v70, v26, v29
    v_dot2_f32_bf16 v29, v71, v27, v29
    s_waitcnt vmcnt(13)
    buffer_load_dwordx4 v[68:71], v4, s[44:47], s100 offen offset:1024 nt
    v_dot2_f32_bf16 v30, v72, v24, 0
    v_dot2_f32_bf16 v30, v73, v25, v30
    v_dot2_f32_bf16 v30, v74, v26, v30
    v_dot2_f32_bf16 v30, v75, v27, v30
    s_waitcnt vmcnt(13)
    buffer_load_dwordx4 v[72:75], v4, s[44:47], s100 offen offset:2048 nt
    v_dot2_f32_bf16 v31, v76, v24, 0
    v_dot2_f32_bf16 v31, v77, v25, v31
    v_dot2_f32_bf16 v31, v78, v26, v31
    v_dot2_f32_bf16 v31, v79, v27, v31
    s_waitcnt vmcnt(13)
    buffer_load_dwordx4 v[76:79], v4, s[44:47], s100 offen offset:3072 nt
    s_nop 2
    v_add_f32_dpp v28, v28, v28 row_ror:8 row_mask:0xf bank_mask:0xf
    v_add_f32_dpp v29, v29, v29 row_ror:8 row_mask:0xf bank_mask:0xf
    v_add_f32_dpp v30, v30, v30 row_ror:8 row_mask:0xf bank_mask:0xf
    v_add_f32_dpp v31, v31, v31 row_ror:8 row_mask:0xf bank_mask:0xf
    v_add_f32_dpp v28, v28, v28 row_ror:4 row_mask:0xf bank_mask:0xf
    v_add_f32_dpp v29, v29, v29 row_ror:4 row_mask:0xf bank_mask:0xf
    v_add_f32_dpp v30, v30, v30 row_ror:4 row_mask:0xf bank_mask:0xf
    v_add_f32_dpp v31, v31, v31 row_ror:4 row_mask:0xf bank_mask:0xf
    v_add_f32_dpp v28, v28, v28 row_ror:2 row_mask:0xf bank_mask:0xf
    v_add_f32_dpp v29, v29, v29 row_ror:2 row_mask:0xf bank_mask:0xf
    v_add_f32_dpp v30, v30, v30 row_ror:2 row_mask:0xf bank_mask:0xf
    v_add_f32_dpp v31, v31, v31 row_ror:2 row_mask:0xf bank_mask:0xf
    v_add_f32_dpp v28, v28, v28 row_ror:1 row_mask:0xf bank_mask:0xf
    v_add_f32_dpp v29, v29, v29 row_ror:1 row_mask:0xf bank_mask:0xf
    v_add_f32_dpp v30, v30, v30 row_ror:1 row_mask:0xf bank_mask:0xf
    v_add_f32_dpp v31, v31, v31 row_ror:1 row_mask:0xf bank_mask:0xf
    v_max3_f32 v38, v36, v28, v29
    v_max3_f32 v38, v38, v30, v31
    v_sub_f32 v39, v36, v38
    v_mul_f32 v39, s70, v39
    v_exp_f32 v39, v39
    v_mul_f32 v56, s70, v38
    v_mov_b32 v36, v38
    v_fma_f32 v48, v28, s70, -v56
    v_fma_f32 v49, v29, s70, -v56
    v_fma_f32 v50, v30, s70, -v56
    v_fma_f32 v51, v31, s70, -v56
    v_exp_f32 v48, v48
    v_exp_f32 v49, v49
    v_exp_f32 v50, v50
    v_exp_f32 v51, v51
    v_mul_f32 v37, v37, v39
    v_mul_f32 v16, v16, v39
    v_mul_f32 v17, v17, v39
    v_mul_f32 v18, v18, v39
    v_mul_f32 v19, v19, v39
    v_mul_f32 v20, v20, v39
    v_mul_f32 v21, v21, v39
    v_mul_f32 v22, v22, v39
    v_mul_f32 v23, v23, v39
    v_add_f32 v37, v37, v48
    v_add_f32 v37, v37, v49
    v_add_f32 v37, v37, v50
    v_add_f32 v37, v37, v51
    v_lshlrev_b32 v40, 16, v80
    v_and_b32 v41, 0xffff0000, v80
    v_lshlrev_b32 v42, 16, v81
    v_and_b32 v43, 0xffff0000, v81
    v_lshlrev_b32 v44, 16, v82
    v_and_b32 v45, 0xffff0000, v82
    v_lshlrev_b32 v46, 16, v83
    v_and_b32 v47, 0xffff0000, v83
    s_waitcnt vmcnt(13)
    buffer_load_dwordx4 v[80:83], v4, s[48:51], s100 offen offset:0 nt
    v_fmac_f32 v16, v40, v48
    v_fmac_f32 v17, v41, v48
    v_fmac_f32 v18, v42, v48
    v_fmac_f32 v19, v43, v48
    v_fmac_f32 v20, v44, v48
    v_fmac_f32 v21, v45, v48
    v_fmac_f32 v22, v46, v48
    v_fmac_f32 v23, v47, v48
    v_lshlrev_b32 v40, 16, v84
    v_and_b32 v41, 0xffff0000, v84
    v_lshlrev_b32 v42, 16, v85
    v_and_b32 v43, 0xffff0000, v85
    v_lshlrev_b32 v44, 16, v86
    v_and_b32 v45, 0xffff0000, v86
    v_lshlrev_b32 v46, 16, v87
    v_and_b32 v47, 0xffff0000, v87
    s_waitcnt vmcnt(13)
    buffer_load_dwordx4 v[84:87], v4, s[48:51], s100 offen offset:1024 nt
    v_fmac_f32 v16, v40, v49
    v_fmac_f32 v17, v41, v49
    v_fmac_f32 v18, v42, v49
    v_fmac_f32 v19, v43, v49
    v_fmac_f32 v20, v44, v49
    v_fmac_f32 v21, v45, v49
    v_fmac_f32 v22, v46, v49
    v_fmac_f32 v23, v47, v49
    v_lshlrev_b32 v40, 16, v88
    v_and_b32 v41, 0xffff0000, v88
    v_lshlrev_b32 v42, 16, v89
    v_and_b32 v43, 0xffff0000, v89
    v_lshlrev_b32 v44, 16, v90
    v_and_b32 v45, 0xffff0000, v90
    v_lshlrev_b32 v46, 16, v91
    v_and_b32 v47, 0xffff0000, v91
    s_waitcnt vmcnt(13)
    buffer_load_dwordx4 v[88:91], v4, s[48:51], s100 offen offset:2048 nt
    v_fmac_f32 v16, v40, v50
    v_fmac_f32 v17, v41, v50
    v_fmac_f32 v18, v42, v50
    v_fmac_f32 v19, v43, v50
    v_fmac_f32 v20, v44, v50
    v_fmac_f32 v21, v45, v50
    v_fmac_f32 v22, v46, v50
    v_fmac_f32 v23, v47, v50
    v_lshlrev_b32 v40, 16, v92
    v_and_b32 v41, 0xffff0000, v92
    v_lshlrev_b32 v42, 16, v93
    v_and_b32 v43, 0xffff0000, v93
    v_lshlrev_b32 v44, 16, v94
    v_and_b32 v45, 0xffff0000, v94
    v_lshlrev_b32 v46, 16, v95
    v_and_b32 v47, 0xffff0000, v95
    s_waitcnt vmcnt(13)
    buffer_load_dwordx4 v[92:95], v4, s[48:51], s100 offen offset:3072 nt
    v_fmac_f32 v16, v40, v51
    v_fmac_f32 v17, v41, v51
    v_fmac_f32 v18, v42, v51
    v_fmac_f32 v19, v43, v51
    v_fmac_f32 v20, v44, v51
    v_fmac_f32 v21, v45, v51
    v_fmac_f32 v22, v46, v51
    v_fmac_f32 v23, v47, v51
    v_readfirstlane_b32 s73, v61
    s_nop 3
    s_cmp_ge_u32 s73, 65536
    s_cbranch_scc1 Lgr_22
    s_waitcnt vmcnt(0)
    v_readfirstlane_b32 s73, v61
    s_nop 3
Lgr_22:
    s_add_u32 s73, s73, 4294901886
LBloop2b_15:
    s_cmp_ge_u32 s73, s74
    s_cbranch_scc1 LBtail1_21
    s_lshl_b32 s100, s73, 12
    s_mov_b32 s72, s73
    s_mov_b64 s[94:95], exec
    s_mov_b64 exec, 1
    v_mov_b32 v61, 1
    buffer_atomic_add v61, v60, s[32:35], s63 offen sc0 sc1
    s_mov_b64 exec, s[94:95]
    v_dot2_f32_bf16 v28, v96, v24, 0
    v_dot2_f32_bf16 v28, v97, v25, v28
    v_dot2_f32_bf16 v28, v98, v26, v28
    v_dot2_f32_bf16 v28, v99, v27, v28
    s_waitcnt vmcnt(13)
    buffer_load_dwordx4 v[96:99], v4, s[44:47], s100 offen offset:0 nt
    v_dot2_f32_bf16 v29, v100, v24, 0
    v_dot2_f32_bf16 v29, v101, v25, v29
    v_dot2_f32_bf16 v29, v102, v26, v29
    v_dot2_f32_bf16 v29, v103, v27, v29
    s_waitcnt vmcnt(13)
    buffer_load_dwordx4 v[100:103], v4, s[44:47], s100 offen offset:1024 nt
    v_dot2_f32_bf16 v30, v104, v24, 0
    v_dot2_f32_bf16 v30, v105, v25, v30
    v_dot2_f32_bf16 v30, v106, v26, v30
    v_dot2_f32_bf16 v30, v107, v27, v30
    s_waitcnt vmcnt(13)
    buffer_load_dwordx4 v[104:107], v4, s[44:47], s100 offen offset:2048 nt
    v_dot2_f32_bf16 v31, v108, v24, 0
    v_dot2_f32_bf16 v31, v109, v25, v31
    v_dot2_f32_bf16 v31, v110, v26, v31
    v_dot2_f32_bf16 v31, v111, v27, v31
    s_waitcnt vmcnt(13)
    buffer_load_dwordx4 v[108:111], v4, s[44:47], s100 offen offset:3072 nt
    s_nop 2
    v_add_f32_dpp v28, v28, v28 row_ror:8 row_mask:0xf bank_mask:0xf
    v_add_f32_dpp v29, v29, v29 row_ror:8 row_mask:0xf bank_mask:0xf
    v_add_f32_dpp v30, v30, v30 row_ror:8 row_mask:0xf bank_mask:0xf
    v_add_f32_dpp v31, v31, v31 row_ror:8 row_mask:0xf bank_mask:0xf
    v_add_f32_dpp v28, v28, v28 row_ror:4 row_mask:0xf bank_mask:0xf
    v_add_f32_dpp v29, v29, v29 row_ror:4 row_mask:0xf bank_mask:0xf
    v_add_f32_dpp v30, v30, v30 row_ror:4 row_mask:0xf bank_mask:0xf
    v_add_f32_dpp v31, v31, v31 row_ror:4 row_mask:0xf bank_mask:0xf
    v_add_f32_dpp v28, v28, v28 row_ror:2 row_mask:0xf bank_mask:0xf
    v_add_f32_dpp v29, v29, v29 row_ror:2 row_mask:0xf bank_mask:0xf
    v_add_f32_dpp v30, v30, v30 row_ror:2 row_mask:0xf bank_mask:0xf
    v_add_f32_dpp v31, v31, v31 row_ror:2 row_mask:0xf bank_mask:0xf
    v_add_f32_dpp v28, v28, v28 row_ror:1 row_mask:0xf bank_mask:0xf
    v_add_f32_dpp v29, v29, v29 row_ror:1 row_mask:0xf bank_mask:0xf
    v_add_f32_dpp v30, v30, v30 row_ror:1 row_mask:0xf bank_mask:0xf
    v_add_f32_dpp v31, v31, v31 row_ror:1 row_mask:0xf bank_mask:0xf
    v_max3_f32 v38, v36, v28, v29
    v_max3_f32 v38, v38, v30, v31
    v_sub_f32 v39, v36, v38
    v_mul_f32 v39, s70, v39
    v_exp_f32 v39, v39
    v_mul_f32 v56, s70, v38
    v_mov_b32 v36, v38
    v_fma_f32 v48, v28, s70, -v56
    v_fma_f32 v49, v29, s70, -v56
    v_fma_f32 v50, v30, s70, -v56
    v_fma_f32 v51, v31, s70, -v56
    v_exp_f32 v48, v48
    v_exp_f32 v49, v49
    v_exp_f32 v50, v50
    v_exp_f32 v51, v51
    v_mul_f32 v37, v37, v39
    v_mul_f32 v16, v16, v39
    v_mul_f32 v17, v17, v39
    v_mul_f32 v18, v18, v39
    v_mul_f32 v19, v19, v39
    v_mul_f32 v20, v20, v39
    v_mul_f32 v21, v21, v39
    v_mul_f32 v22, v22, v39
    v_mul_f32 v23, v23, v39
    v_add_f32 v37, v37, v48
    v_add_f32 v37, v37, v49
    v_add_f32 v37, v37, v50
    v_add_f32 v37, v37, v51
    v_lshlrev_b32 v40, 16, v112
    v_and_b32 v41, 0xffff0000, v112
    v_lshlrev_b32 v42, 16, v113
    v_and_b32 v43, 0xffff0000, v113
    v_lshlrev_b32 v44, 16, v114
    v_and_b32 v45, 0xffff0000, v114
    v_lshlrev_b32 v46, 16, v115
    v_and_b32 v47, 0xffff0000, v115
    s_waitcnt vmcnt(13)
    buffer_load_dwordx4 v[112:115], v4, s[48:51], s100 offen offset:0 nt
    v_fmac_f32 v16, v40, v48
    v_fmac_f32 v17, v41, v48
    v_fmac_f32 v18, v42, v48
    v_fmac_f32 v19, v43, v48
    v_fmac_f32 v20, v44, v48
    v_fmac_f32 v21, v45, v48
    v_fmac_f32 v22, v46, v48
    v_fmac_f32 v23, v47, v48
    v_lshlrev_b32 v40, 16, v116
    v_and_b32 v41, 0xffff0000, v116
    v_lshlrev_b32 v42, 16, v117
    v_and_b32 v43, 0xffff0000, v117
    v_lshlrev_b32 v44, 16, v118
    v_and_b32 v45, 0xffff0000, v118
    v_lshlrev_b32 v46, 16, v119
    v_and_b32 v47, 0xffff0000, v119
    s_waitcnt vmcnt(13)
    buffer_load_dwordx4 v[116:119], v4, s[48:51], s100 offen offset:1024 nt
    v_fmac_f32 v16, v40, v49
    v_fmac_f32 v17, v41, v49
    v_fmac_f32 v18, v42, v49
    v_fmac_f32 v19, v43, v49
    v_fmac_f32 v20, v44, v49
    v_fmac_f32 v21, v45, v49
    v_fmac_f32 v22, v46, v49
    v_fmac_f32 v23, v47, v49
    v_lshlrev_b32 v40, 16, v120
    v_and_b32 v41, 0xffff0000, v120
    v_lshlrev_b32 v42, 16, v121
    v_and_b32 v43, 0xffff0000, v121
    v_lshlrev_b32 v44, 16, v122
    v_and_b32 v45, 0xffff0000, v122
    v_lshlrev_b32 v46, 16, v123
    v_and_b32 v47, 0xffff0000, v123
    s_waitcnt vmcnt(13)
    buffer_load_dwordx4 v[120:123], v4, s[48:51], s100 offen offset:2048 nt
    v_fmac_f32 v16, v40, v50
    v_fmac_f32 v17, v41, v50
    v_fmac_f32 v18, v42, v50
    v_fmac_f32 v19, v43, v50
    v_fmac_f32 v20, v44, v50
    v_fmac_f32 v21, v45, v50
    v_fmac_f32 v22, v46, v50
    v_fmac_f32 v23, v47, v50
    v_lshlrev_b32 v40, 16, v124
    v_and_b32 v41, 0xffff0000, v124
    v_lshlrev_b32 v42, 16, v125
    v_and_b32 v43, 0xffff0000, v125
    v_lshlrev_b32 v44, 16, v126
    v_and_b32 v45, 0xffff0000, v126
    v_lshlrev_b32 v46, 16, v127
    v_and_b32 v47, 0xffff0000, v127
    s_waitcnt vmcnt(13)
    buffer_load_dwordx4 v[124:127], v4, s[48:51], s100 offen offset:3072 nt
    v_fmac_f32 v16, v40, v51
    v_fmac_f32 v17, v41, v51
    v_fmac_f32 v18, v42, v51
    v_fmac_f32 v19, v43, v51
    v_fmac_f32 v20, v44, v51
    v_fmac_f32 v21, v45, v51
    v_fmac_f32 v22, v46, v51
    v_fmac_f32 v23, v47, v51
    v_readfirstlane_b32 s73, v59
    s_nop 3
    s_cmp_ge_u32 s73, 65536
    s_cbranch_scc1 Lgr_23
    s_waitcnt vmcnt(0)
    v_readfirstlane_b32 s73, v59
    s_nop 3
Lgr_23:
    s_add_u32 s73, s73, 4294901886
    s_branch LBloop2_14
LBtail0_20:
    s_waitcnt vmcnt(15)
    v_dot2_f32_bf16 v28, v64, v24, 0
    v_dot2_f32_bf16 v28, v65, v25, v28
    v_dot2_f32_bf16 v28, v66, v26, v28
    v_dot2_f32_bf16 v28, v67, v27, v28
    s_waitcnt vmcnt(14)
    v_dot2_f32_bf16 v29, v68, v24, 0
    v_dot2_f32_bf16 v29, v69, v25, v29
    v_dot2_f32_bf16 v29, v70, v26, v29
    v_dot2_f32_bf16 v29, v71, v27, v29
    s_waitcnt vmcnt(13)
    v_dot2_f32_bf16 v30, v72, v24, 0
    v_dot2_f32_bf16 v30, v73, v25, v30
    v_dot2_f32_bf16 v30, v74, v26, v30
    v_dot2_f32_bf16 v30, v75, v27, v30
    s_waitcnt vmcnt(12)
    v_dot2_f32_bf16 v31, v76, v24, 0
    v_dot2_f32_bf16 v31, v77, v25, v31
    v_dot2_f32_bf16 v31, v78, v26, v31
    v_dot2_f32_bf16 v31, v79, v27, v31
    s_nop 2
    v_add_f32_dpp v28, v28, v28 row_ror:8 row_mask:0xf bank_mask:0xf
    v_add_f32_dpp v29, v29, v29 row_ror:8 row_mask:0xf bank_mask:0xf
    v_add_f32_dpp v30, v30, v30 row_ror:8 row_mask:0xf bank_mask:0xf
    v_add_f32_dpp v31, v31, v31 row_ror:8 row_mask:0xf bank_mask:0xf
    v_add_f32_dpp v28, v28, v28 row_ror:4 row_mask:0xf bank_mask:0xf
    v_add_f32_dpp v29, v29, v29 row_ror:4 row_mask:0xf bank_mask:0xf
    v_add_f32_dpp v30, v30, v30 row_ror:4 row_mask:0xf bank_mask:0xf
    v_add_f32_dpp v31, v31, v31 row_ror:4 row_mask:0xf bank_mask:0xf
    v_add_f32_dpp v28, v28, v28 row_ror:2 row_mask:0xf bank_mask:0xf
    v_add_f32_dpp v29, v29, v29 row_ror:2 row_mask:0xf bank_mask:0xf
    v_add_f32_dpp v30, v30, v30 row_ror:2 row_mask:0xf bank_mask:0xf
    v_add_f32_dpp v31, v31, v31 row_ror:2 row_mask:0xf bank_mask:0xf
    v_add_f32_dpp v28, v28, v28 row_ror:1 row_mask:0xf bank_mask:0xf
    v_add_f32_dpp v29, v29, v29 row_ror:1 row_mask:0xf bank_mask:0xf
    v_add_f32_dpp v30, v30, v30 row_ror:1 row_mask:0xf bank_mask:0xf
    v_add_f32_dpp v31, v31, v31 row_ror:1 row_mask:0xf bank_mask:0xf
    v_max3_f32 v38, v36, v28, v29
    v_max3_f32 v38, v38, v30, v31
    v_sub_f32 v39, v36, v38
    v_mul_f32 v39, s70, v39
    v_exp_f32 v39, v39
    v_mul_f32 v56, s70, v38
    v_mov_b32 v36, v38
    v_fma_f32 v48, v28, s70, -v56
    v_fma_f32 v49, v29, s70, -v56
    v_fma_f32 v50, v30, s70, -v56
    v_fma_f32 v51, v31, s70, -v56
    v_exp_f32 v48, v48
    v_exp_f32 v49, v49
    v_exp_f32 v50, v50
    v_exp_f32 v51, v51
    v_mul_f32 v37, v37, v39
    v_mul_f32 v16, v16, v39
    v_mul_f32 v17, v17, v39
    v_mul_f32 v18, v18, v39
    v_mul_f32 v19, v19, v39
    v_mul_f32 v20, v20, v39
    v_mul_f32 v21, v21, v39
    v_mul_f32 v22, v22, v39
    v_mul_f32 v23, v23, v39
    v_add_f32 v37, v37, v48
    v_add_f32 v37, v37, v49
    v_add_f32 v37, v37, v50
    v_add_f32 v37, v37, v51
    s_waitcnt vmcnt(11)
    v_lshlrev_b32 v40, 16, v80
    v_and_b32 v41, 0xffff0000, v80
    v_lshlrev_b32 v42, 16, v81
    v_and_b32 v43, 0xffff0000, v81
    v_lshlrev_b32 v44, 16, v82
    v_and_b32 v45, 0xffff0000, v82
    v_lshlrev_b32 v46, 16, v83
    v_and_b32 v47, 0xffff0000, v83
    v_fmac_f32 v16, v40, v48
    v_fmac_f32 v17, v41, v48
    v_fmac_f32 v18, v42, v48
    v_fmac_f32 v19, v43, v48
    v_fmac_f32 v20, v44, v48
    v_fmac_f32 v21, v45, v48
    v_fmac_f32 v22, v46, v48
    v_fmac_f32 v23, v47, v48
    s_waitcnt vmcnt(10)
    v_lshlrev_b32 v40, 16, v84
    v_and_b32 v41, 0xffff0000, v84
    v_lshlrev_b32 v42, 16, v85
    v_and_b32 v43, 0xffff0000, v85
    v_lshlrev_b32 v44, 16, v86
    v_and_b32 v45, 0xffff0000, v86
    v_lshlrev_b32 v46, 16, v87
    v_and_b32 v47, 0xffff0000, v87
    v_fmac_f32 v16, v40, v49
    v_fmac_f32 v17, v41, v49
    v_fmac_f32 v18, v42, v49
    v_fmac_f32 v19, v43, v49
    v_fmac_f32 v20, v44, v49
    v_fmac_f32 v21, v45, v49
    v_fmac_f32 v22, v46, v49
    v_fmac_f32 v23, v47, v49
    s_waitcnt vmcnt(9)
    v_lshlrev_b32 v40, 16, v88
    v_and_b32 v41, 0xffff0000, v88
    v_lshlrev_b32 v42, 16, v89
    v_and_b32 v43, 0xffff0000, v89
    v_lshlrev_b32 v44, 16, v90
    v_and_b32 v45, 0xffff0000, v90
    v_lshlrev_b32 v46, 16, v91
    v_and_b32 v47, 0xffff0000, v91
    v_fmac_f32 v16, v40, v50
    v_fmac_f32 v17, v41, v50
    v_fmac_f32 v18, v42, v50
    v_fmac_f32 v19, v43, v50
    v_fmac_f32 v20, v44, v50
    v_fmac_f32 v21, v45, v50
    v_fmac_f32 v22, v46, v50
    v_fmac_f32 v23, v47, v50
    s_waitcnt vmcnt(8)
    v_lshlrev_b32 v40, 16, v92
    v_and_b32 v41, 0xffff0000, v92
    v_lshlrev_b32 v42, 16, v93
    v_and_b32 v43, 0xffff0000, v93
    v_lshlrev_b32 v44, 16, v94
    v_and_b32 v45, 0xffff0000, v94
    v_lshlrev_b32 v46, 16, v95
    v_and_b32 v47, 0xffff0000, v95
    v_fmac_f32 v16, v40, v51
    v_fmac_f32 v17, v41, v51
    v_fmac_f32 v18, v42, v51
    v_fmac_f32 v19, v43, v51
    v_fmac_f32 v20, v44, v51
    v_fmac_f32 v21, v45, v51
    v_fmac_f32 v22, v46, v51
    v_fmac_f32 v23, v47, v51
    s_waitcnt vmcnt(7)
    v_dot2_f32_bf16 v28, v96, v24, 0
    v_dot2_f32_bf16 v28, v97, v25, v28
    v_dot2_f32_bf16 v28, v98, v26, v28
    v_dot2_f32_bf16 v28, v99, v27, v28
    s_waitcnt vmcnt(6)
    v_dot2_f32_bf16 v29, v100, v24, 0
    v_dot2_f32_bf16 v29, v101, v25, v29
    v_dot2_f32_bf16 v29, v102, v26, v29
    v_dot2_f32_bf16 v29, v103, v27, v29
    s_waitcnt vmcnt(5)
    v_dot2_f32_bf16 v30, v104, v24, 0
    v_dot2_f32_bf16 v30, v105, v25, v30
    v_dot2_f32_bf16 v30, v106, v26, v30
    v_dot2_f32_bf16 v30, v107, v27, v30
    s_waitcnt vmcnt(4)
    v_dot2_f32_bf16 v31, v108, v24, 0
    v_dot2_f32_bf16 v31, v109, v25, v31
    v_dot2_f32_bf16 v31, v110, v26, v31
    v_dot2_f32_bf16 v31, v111, v27, v31
    s_nop 2
    v_add_f32_dpp v28, v28, v28 row_ror:8 row_mask:0xf bank_mask:0xf
    v_add_f32_dpp v29, v29, v29 row_ror:8 row_mask:0xf bank_mask:0xf
    v_add_f32_dpp v30, v30, v30 row_ror:8 row_mask:0xf bank_mask:0xf
    v_add_f32_dpp v31, v31, v31 row_ror:8 row_mask:0xf bank_mask:0xf
    v_add_f32_dpp v28, v28, v28 row_ror:4 row_mask:0xf bank_mask:0xf
    v_add_f32_dpp v29, v29, v29 row_ror:4 row_mask:0xf bank_mask:0xf
    v_add_f32_dpp v30, v30, v30 row_ror:4 row_mask:0xf bank_mask:0xf
    v_add_f32_dpp v31, v31, v31 row_ror:4 row_mask:0xf bank_mask:0xf
    v_add_f32_dpp v28, v28, v28 row_ror:2 row_mask:0xf bank_mask:0xf
    v_add_f32_dpp v29, v29, v29 row_ror:2 row_mask:0xf bank_mask:0xf
    v_add_f32_dpp v30, v30, v30 row_ror:2 row_mask:0xf bank_mask:0xf
    v_add_f32_dpp v31, v31, v31 row_ror:2 row_mask:0xf bank_mask:0xf
    v_add_f32_dpp v28, v28, v28 row_ror:1 row_mask:0xf bank_mask:0xf
    v_add_f32_dpp v29, v29, v29 row_ror:1 row_mask:0xf bank_mask:0xf
    v_add_f32_dpp v30, v30, v30 row_ror:1 row_mask:0xf bank_mask:0xf
    v_add_f32_dpp v31, v31, v31 row_ror:1 row_mask:0xf bank_mask:0xf
    v_max3_f32 v38, v36, v28, v29
    v_max3_f32 v38, v38, v30, v31
    v_sub_f32 v39, v36, v38
    v_mul_f32 v39, s70, v39
    v_exp_f32 v39, v39
    v_mul_f32 v56, s70, v38
    v_mov_b32 v36, v38
    v_fma_f32 v48, v28, s70, -v56
    v_fma_f32 v49, v29, s70, -v56
    v_fma_f32 v50, v30, s70, -v56
    v_fma_f32 v51, v31, s70, -v56
    v_exp_f32 v48, v48
    v_exp_f32 v49, v49
    v_exp_f32 v50, v50
    v_exp_f32 v51, v51
    v_mul_f32 v37, v37, v39
    v_mul_f32 v16, v16, v39
    v_mul_f32 v17, v17, v39
    v_mul_f32 v18, v18, v39
    v_mul_f32 v19, v19, v39
    v_mul_f32 v20, v20, v39
    v_mul_f32 v21, v21, v39
    v_mul_f32 v22, v22, v39
    v_mul_f32 v23, v23, v39
    v_add_f32 v37, v37, v48
    v_add_f32 v37, v37, v49
    v_add_f32 v37, v37, v50
    v_add_f32 v37, v37, v51
    s_waitcnt vmcnt(3)
    v_lshlrev_b32 v40, 16, v112
    v_and_b32 v41, 0xffff0000, v112
    v_lshlrev_b32 v42, 16, v113
    v_and_b32 v43, 0xffff0000, v113
    v_lshlrev_b32 v44, 16, v114
    v_and_b32 v45, 0xffff0000, v114
    v_lshlrev_b32 v46, 16, v115
    v_and_b32 v47, 0xffff0000, v115
    v_fmac_f32 v16, v40, v48
    v_fmac_f32 v17, v41, v48
    v_fmac_f32 v18, v42, v48
    v_fmac_f32 v19, v43, v48
    v_fmac_f32 v20, v44, v48
    v_fmac_f32 v21, v45, v48
    v_fmac_f32 v22, v46, v48
    v_fmac_f32 v23, v47, v48
    s_waitcnt vmcnt(2)
    v_lshlrev_b32 v40, 16, v116
    v_and_b32 v41, 0xffff0000, v116
    v_lshlrev_b32 v42, 16, v117
    v_and_b32 v43, 0xffff0000, v117
    v_lshlrev_b32 v44, 16, v118
    v_and_b32 v45, 0xffff0000, v118
    v_lshlrev_b32 v46, 16, v119
    v_and_b32 v47, 0xffff0000, v119
    v_fmac_f32 v16, v40, v49
    v_fmac_f32 v17, v41, v49
    v_fmac_f32 v18, v42, v49
    v_fmac_f32 v19, v43, v49
    v_fmac_f32 v20, v44, v49
    v_fmac_f32 v21, v45, v49
    v_fmac_f32 v22, v46, v49
    v_fmac_f32 v23, v47, v49
    s_waitcnt vmcnt(1)
    v_lshlrev_b32 v40, 16, v120
    v_and_b32 v41, 0xffff0000, v120
    v_lshlrev_b32 v42, 16, v121
    v_and_b32 v43, 0xffff0000, v121
    v_lshlrev_b32 v44, 16, v122
    v_and_b32 v45, 0xffff0000, v122
    v_lshlrev_b32 v46, 16, v123
    v_and_b32 v47, 0xffff0000, v123
    v_fmac_f32 v16, v40, v50
    v_fmac_f32 v17, v41, v50
    v_fmac_f32 v18, v42, v50
    v_fmac_f32 v19, v43, v50
    v_fmac_f32 v20, v44, v50
    v_fmac_f32 v21, v45, v50
    v_fmac_f32 v22, v46, v50
    v_fmac_f32 v23, v47, v50
    s_waitcnt vmcnt(0)
    v_lshlrev_b32 v40, 16, v124
    v_and_b32 v41, 0xffff0000, v124
    v_lshlrev_b32 v42, 16, v125
    v_and_b32 v43, 0xffff0000, v125
    v_lshlrev_b32 v44, 16, v126
    v_and_b32 v45, 0xffff0000, v126
    v_lshlrev_b32 v46, 16, v127
    v_and_b32 v47, 0xffff0000, v127
    v_fmac_f32 v16, v40, v51
    v_fmac_f32 v17, v41, v51
    v_fmac_f32 v18, v42, v51
    v_fmac_f32 v19, v43, v51
    v_fmac_f32 v20, v44, v51
    v_fmac_f32 v21, v45, v51
    v_fmac_f32 v22, v46, v51
    v_fmac_f32 v23, v47, v51
    s_branch LBdone_13
LBtail1_21:
    s_waitcnt vmcnt(15)
    v_dot2_f32_bf16 v28, v96, v24, 0
    v_dot2_f32_bf16 v28, v97, v25, v28
    v_dot2_f32_bf16 v28, v98, v26, v28
    v_dot2_f32_bf16 v28, v99, v27, v28
    s_waitcnt vmcnt(14)
    v_dot2_f32_bf16 v29, v100, v24, 0
    v_dot2_f32_bf16 v29, v101, v25, v29
    v_dot2_f32_bf16 v29, v102, v26, v29
    v_dot2_f32_bf16 v29, v103, v27, v29
    s_waitcnt vmcnt(13)
    v_dot2_f32_bf16 v30, v104, v24, 0
    v_dot2_f32_bf16 v30, v105, v25, v30
    v_dot2_f32_bf16 v30, v106, v26, v30
    v_dot2_f32_bf16 v30, v107, v27, v30
    s_waitcnt vmcnt(12)
    v_dot2_f32_bf16 v31, v108, v24, 0
    v_dot2_f32_bf16 v31, v109, v25, v31
    v_dot2_f32_bf16 v31, v110, v26, v31
    v_dot2_f32_bf16 v31, v111, v27, v31
    s_nop 2
    v_add_f32_dpp v28, v28, v28 row_ror:8 row_mask:0xf bank_mask:0xf
    v_add_f32_dpp v29, v29, v29 row_ror:8 row_mask:0xf bank_mask:0xf
    v_add_f32_dpp v30, v30, v30 row_ror:8 row_mask:0xf bank_mask:0xf
    v_add_f32_dpp v31, v31, v31 row_ror:8 row_mask:0xf bank_mask:0xf
    v_add_f32_dpp v28, v28, v28 row_ror:4 row_mask:0xf bank_mask:0xf
    v_add_f32_dpp v29, v29, v29 row_ror:4 row_mask:0xf bank_mask:0xf
    v_add_f32_dpp v30, v30, v30 row_ror:4 row_mask:0xf bank_mask:0xf
    v_add_f32_dpp v31, v31, v31 row_ror:4 row_mask:0xf bank_mask:0xf
    v_add_f32_dpp v28, v28, v28 row_ror:2 row_mask:0xf bank_mask:0xf
    v_add_f32_dpp v29, v29, v29 row_ror:2 row_mask:0xf bank_mask:0xf
    v_add_f32_dpp v30, v30, v30 row_ror:2 row_mask:0xf bank_mask:0xf
    v_add_f32_dpp v31, v31, v31 row_ror:2 row_mask:0xf bank_mask:0xf
    v_add_f32_dpp v28, v28, v28 row_ror:1 row_mask:0xf bank_mask:0xf
    v_add_f32_dpp v29, v29, v29 row_ror:1 row_mask:0xf bank_mask:0xf
    v_add_f32_dpp v30, v30, v30 row_ror:1 row_mask:0xf bank_mask:0xf
    v_add_f32_dpp v31, v31, v31 row_ror:1 row_mask:0xf bank_mask:0xf
    v_max3_f32 v38, v36, v28, v29
    v_max3_f32 v38, v38, v30, v31
    v_sub_f32 v39, v36, v38
    v_mul_f32 v39, s70, v39
    v_exp_f32 v39, v39
    v_mul_f32 v56, s70, v38
    v_mov_b32 v36, v38
    v_fma_f32 v48, v28, s70, -v56
    v_fma_f32 v49, v29, s70, -v56
    v_fma_f32 v50, v30, s70, -v56
    v_fma_f32 v51, v31, s70, -v56
    v_exp_f32 v48, v48
    v_exp_f32 v49, v49
    v_exp_f32 v50, v50
    v_exp_f32 v51, v51
    v_mul_f32 v37, v37, v39
    v_mul_f32 v16, v16, v39
    v_mul_f32 v17, v17, v39
    v_mul_f32 v18, v18, v39
    v_mul_f32 v19, v19, v39
    v_mul_f32 v20, v20, v39
    v_mul_f32 v21, v21, v39
    v_mul_f32 v22, v22, v39
    v_mul_f32 v23, v23, v39
    v_add_f32 v37, v37, v48
    v_add_f32 v37, v37, v49
    v_add_f32 v37, v37, v50
    v_add_f32 v37, v37, v51
    s_waitcnt vmcnt(11)
    v_lshlrev_b32 v40, 16, v112
    v_and_b32 v41, 0xffff0000, v112
    v_lshlrev_b32 v42, 16, v113
    v_and_b32 v43, 0xffff0000, v113
    v_lshlrev_b32 v44, 16, v114
    v_and_b32 v45, 0xffff0000, v114
    v_lshlrev_b32 v46, 16, v115
    v_and_b32 v47, 0xffff0000, v115
    v_fmac_f32 v16, v40, v48
    v_fmac_f32 v17, v41, v48
    v_fmac_f32 v18, v42, v48
    v_fmac_f32 v19, v43, v48
    v_fmac_f32 v20, v44, v48
    v_fmac_f32 v21, v45, v48
    v_fmac_f32 v22, v46, v48
    v_fmac_f32 v23, v47, v48
    s_waitcnt vmcnt(10)
    v_lshlrev_b32 v40, 16, v116
    v_and_b32 v41, 0xffff0000, v116
    v_lshlrev_b32 v42, 16, v117
    v_and_b32 v43, 0xffff0000, v117
    v_lshlrev_b32 v44, 16, v118
    v_and_b32 v45, 0xffff0000, v118
    v_lshlrev_b32 v46, 16, v119
    v_and_b32 v47, 0xffff0000, v119
    v_fmac_f32 v16, v40, v49
    v_fmac_f32 v17, v41, v49
    v_fmac_f32 v18, v42, v49
    v_fmac_f32 v19, v43, v49
    v_fmac_f32 v20, v44, v49
    v_fmac_f32 v21, v45, v49
    v_fmac_f32 v22, v46, v49
    v_fmac_f32 v23, v47, v49
    s_waitcnt vmcnt(9)
    v_lshlrev_b32 v40, 16, v120
    v_and_b32 v41, 0xffff0000, v120
    v_lshlrev_b32 v42, 16, v121
    v_and_b32 v43, 0xffff0000, v121
    v_lshlrev_b32 v44, 16, v122
    v_and_b32 v45, 0xffff0000, v122
    v_lshlrev_b32 v46, 16, v123
    v_and_b32 v47, 0xffff0000, v123
    v_fmac_f32 v16, v40, v50
    v_fmac_f32 v17, v41, v50
    v_fmac_f32 v18, v42, v50
    v_fmac_f32 v19, v43, v50
    v_fmac_f32 v20, v44, v50
    v_fmac_f32 v21, v45, v50
    v_fmac_f32 v22, v46, v50
    v_fmac_f32 v23, v47, v50
    s_waitcnt vmcnt(8)
    v_lshlrev_b32 v40, 16, v124
    v_and_b32 v41, 0xffff0000, v124
    v_lshlrev_b32 v42, 16, v125
    v_and_b32 v43, 0xffff0000, v125
    v_lshlrev_b32 v44, 16, v126
    v_and_b32 v45, 0xffff0000, v126
    v_lshlrev_b32 v46, 16, v127
    v_and_b32 v47, 0xffff0000, v127
    v_fmac_f32 v16, v40, v51
    v_fmac_f32 v17, v41, v51
    v_fmac_f32 v18, v42, v51
    v_fmac_f32 v19, v43, v51
    v_fmac_f32 v20, v44, v51
    v_fmac_f32 v21, v45, v51
    v_fmac_f32 v22, v46, v51
    v_fmac_f32 v23, v47, v51
    s_waitcnt vmcnt(7)
    v_dot2_f32_bf16 v28, v64, v24, 0
    v_dot2_f32_bf16 v28, v65, v25, v28
    v_dot2_f32_bf16 v28, v66, v26, v28
    v_dot2_f32_bf16 v28, v67, v27, v28
    s_waitcnt vmcnt(6)
    v_dot2_f32_bf16 v29, v68, v24, 0
    v_dot2_f32_bf16 v29, v69, v25, v29
    v_dot2_f32_bf16 v29, v70, v26, v29
    v_dot2_f32_bf16 v29, v71, v27, v29
    s_waitcnt vmcnt(5)
    v_dot2_f32_bf16 v30, v72, v24, 0
    v_dot2_f32_bf16 v30, v73, v25, v30
    v_dot2_f32_bf16 v30, v74, v26, v30
    v_dot2_f32_bf16 v30, v75, v27, v30
    s_waitcnt vmcnt(4)
    v_dot2_f32_bf16 v31, v76, v24, 0
    v_dot2_f32_bf16 v31, v77, v25, v31
    v_dot2_f32_bf16 v31, v78, v26, v31
    v_dot2_f32_bf16 v31, v79, v27, v31
    s_nop 2
    v_add_f32_dpp v28, v28, v28 row_ror:8 row_mask:0xf bank_mask:0xf
    v_add_f32_dpp v29, v29, v29 row_ror:8 row_mask:0xf bank_mask:0xf
    v_add_f32_dpp v30, v30, v30 row_ror:8 row_mask:0xf bank_mask:0xf
    v_add_f32_dpp v31, v31, v31 row_ror:8 row_mask:0xf bank_mask:0xf
    v_add_f32_dpp v28, v28, v28 row_ror:4 row_mask:0xf bank_mask:0xf
    v_add_f32_dpp v29, v29, v29 row_ror:4 row_mask:0xf bank_mask:0xf
    v_add_f32_dpp v30, v30, v30 row_ror:4 row_mask:0xf bank_mask:0xf
    v_add_f32_dpp v31, v31, v31 row_ror:4 row_mask:0xf bank_mask:0xf
    v_add_f32_dpp v28, v28, v28 row_ror:2 row_mask:0xf bank_mask:0xf
    v_add_f32_dpp v29, v29, v29 row_ror:2 row_mask:0xf bank_mask:0xf
    v_add_f32_dpp v30, v30, v30 row_ror:2 row_mask:0xf bank_mask:0xf
    v_add_f32_dpp v31, v31, v31 row_ror:2 row_mask:0xf bank_mask:0xf
    v_add_f32_dpp v28, v28, v28 row_ror:1 row_mask:0xf bank_mask:0xf
    v_add_f32_dpp v29, v29, v29 row_ror:1 row_mask:0xf bank_mask:0xf
    v_add_f32_dpp v30, v30, v30 row_ror:1 row_mask:0xf bank_mask:0xf
    v_add_f32_dpp v31, v31, v31 row_ror:1 row_mask:0xf bank_mask:0xf
    v_max3_f32 v38, v36, v28, v29
    v_max3_f32 v38, v38, v30, v31
    v_sub_f32 v39, v36, v38
    v_mul_f32 v39, s70, v39
    v_exp_f32 v39, v39
    v_mul_f32 v56, s70, v38
    v_mov_b32 v36, v38
    v_fma_f32 v48, v28, s70, -v56
    v_fma_f32 v49, v29, s70, -v56
    v_fma_f32 v50, v30, s70, -v56
    v_fma_f32 v51, v31, s70, -v56
    v_exp_f32 v48, v48
    v_exp_f32 v49, v49
    v_exp_f32 v50, v50
    v_exp_f32 v51, v51
    v_mul_f32 v37, v37, v39
    v_mul_f32 v16, v16, v39
    v_mul_f32 v17, v17, v39
    v_mul_f32 v18, v18, v39
    v_mul_f32 v19, v19, v39
    v_mul_f32 v20, v20, v39
    v_mul_f32 v21, v21, v39
    v_mul_f32 v22, v22, v39
    v_mul_f32 v23, v23, v39
    v_add_f32 v37, v37, v48
    v_add_f32 v37, v37, v49
    v_add_f32 v37, v37, v50
    v_add_f32 v37, v37, v51
    s_waitcnt vmcnt(3)
    v_lshlrev_b32 v40, 16, v80
    v_and_b32 v41, 0xffff0000, v80
    v_lshlrev_b32 v42, 16, v81
    v_and_b32 v43, 0xffff0000, v81
    v_lshlrev_b32 v44, 16, v82
    v_and_b32 v45, 0xffff0000, v82
    v_lshlrev_b32 v46, 16, v83
    v_and_b32 v47, 0xffff0000, v83
    v_fmac_f32 v16, v40, v48
    v_fmac_f32 v17, v41, v48
    v_fmac_f32 v18, v42, v48
    v_fmac_f32 v19, v43, v48
    v_fmac_f32 v20, v44, v48
    v_fmac_f32 v21, v45, v48
    v_fmac_f32 v22, v46, v48
    v_fmac_f32 v23, v47, v48
    s_waitcnt vmcnt(2)
    v_lshlrev_b32 v40, 16, v84
    v_and_b32 v41, 0xffff0000, v84
    v_lshlrev_b32 v42, 16, v85
    v_and_b32 v43, 0xffff0000, v85
    v_lshlrev_b32 v44, 16, v86
    v_and_b32 v45, 0xffff0000, v86
    v_lshlrev_b32 v46, 16, v87
    v_and_b32 v47, 0xffff0000, v87
    v_fmac_f32 v16, v40, v49
    v_fmac_f32 v17, v41, v49
    v_fmac_f32 v18, v42, v49
    v_fmac_f32 v19, v43, v49
    v_fmac_f32 v20, v44, v49
    v_fmac_f32 v21, v45, v49
    v_fmac_f32 v22, v46, v49
    v_fmac_f32 v23, v47, v49
    s_waitcnt vmcnt(1)
    v_lshlrev_b32 v40, 16, v88
    v_and_b32 v41, 0xffff0000, v88
    v_lshlrev_b32 v42, 16, v89
    v_and_b32 v43, 0xffff0000, v89
    v_lshlrev_b32 v44, 16, v90
    v_and_b32 v45, 0xffff0000, v90
    v_lshlrev_b32 v46, 16, v91
    v_and_b32 v47, 0xffff0000, v91
    v_fmac_f32 v16, v40, v50
    v_fmac_f32 v17, v41, v50
    v_fmac_f32 v18, v42, v50
    v_fmac_f32 v19, v43, v50
    v_fmac_f32 v20, v44, v50
    v_fmac_f32 v21, v45, v50
    v_fmac_f32 v22, v46, v50
    v_fmac_f32 v23, v47, v50
    s_waitcnt vmcnt(0)
    v_lshlrev_b32 v40, 16, v92
    v_and_b32 v41, 0xffff0000, v92
    v_lshlrev_b32 v42, 16, v93
    v_and_b32 v43, 0xffff0000, v93
    v_lshlrev_b32 v44, 16, v94
    v_and_b32 v45, 0xffff0000, v94
    v_lshlrev_b32 v46, 16, v95
    v_and_b32 v47, 0xffff0000, v95
    v_fmac_f32 v16, v40, v51
    v_fmac_f32 v17, v41, v51
    v_fmac_f32 v18, v42, v51
    v_fmac_f32 v19, v43, v51
    v_fmac_f32 v20, v44, v51
    v_fmac_f32 v21, v45, v51
    v_fmac_f32 v22, v46, v51
    v_fmac_f32 v23, v47, v51
LBdone_13:
    v_mov_b32 v38, v36
    v_mov_b32 v40, v38
    s_nop 1
    v_permlane32_swap_b32 v38, v40
    s_nop 1
    v_max_f32 v38, v38, v40
    v_mov_b32 v40, v38
    s_nop 1
    v_permlane16_swap_b32 v38, v40
    s_nop 1
    v_max_f32 v38, v38, v40
    v_sub_f32 v39, v36, v38
    v_mul_f32 v39, s70, v39
    v_exp_f32 v39, v39
    s_nop 0
    v_mul_f32 v37, v37, v39
    v_mul_f32 v16, v16, v39
    v_mul_f32 v17, v17, v39
    v_mul_f32 v18, v18, v39
    v_mul_f32 v19, v19, v39
    v_mul_f32 v20, v20, v39
    v_mul_f32 v21, v21, v39
    v_mul_f32 v22, v22, v39
    v_mul_f32 v23, v23, v39
    v_mov_b32 v40, v37
    s_nop 1
    v_permlane32_swap_b32 v37, v40
    s_nop 1
    v_add_f32 v37, v37, v40
    v_mov_b32 v40, v37
    s_nop 1
    v_permlane16_swap_b32 v37, v40
    s_nop 1
    v_add_f32 v37, v37, v40
    s_nop 2
    v_permlane32_swap_b32 v16, v20
    v_permlane32_swap_b32 v17, v21
    v_permlane32_swap_b32 v18, v22
    v_permlane32_swap_b32 v19, v23
    s_nop 1
    v_add_f32 v16, v16, v20
    v_add_f32 v17, v17, v21
    v_add_f32 v18, v18, v22
    v_add_f32 v19, v19, v23
    s_nop 1
    v_permlane16_swap_b32 v16, v18
    v_permlane16_swap_b32 v17, v19
    s_nop 1
    v_add_f32 v16, v16, v18
    v_add_f32 v17, v17, v19
    ds_write_b64 v7, v[16:17] offset:4096
    v_mov_b32 v40, v38
    v_mov_b32 v41, v37
    s_lshl_b32 s61, s56, 3
    v_mov_b32 v42, s61
    ds_write_b64 v42, v[40:41] offset:8192
    s_waitcnt lgkmcnt(0)
    s_barrier
    s_cmp_lg_u32 s56, 0
    s_cbranch_scc1 L_end
    v_mov_b32 v42, 0
    ds_read_b128 v[28:31], v42 offset:8192
    ds_read_b128 v[32:35], v42 offset:8208
    ds_read_b128 v[48:51], v42 offset:8224
    ds_read_b128 v[52:55], v42 offset:8240
    v_and_b32 v43, 31, v1
    v_lshlrev_b32 v43, 4, v43
    ds_read_b128 v[64:67], v43 offset:4096
    ds_read_b128 v[68:71], v43 offset:4608
    ds_read_b128 v[72:75], v43 offset:5120
    ds_read_b128 v[76:79], v43 offset:5632
    ds_read_b128 v[80:83], v43 offset:6144
    ds_read_b128 v[84:87], v43 offset:6656
    ds_read_b128 v[88:91], v43 offset:7168
    ds_read_b128 v[92:95], v43 offset:7680
    s_waitcnt lgkmcnt(8)
    v_max3_f32 v38, v28, v30, v32
    v_max3_f32 v38, v38, v34, v48
    v_max3_f32 v38, v38, v50, v52
    v_max_f32 v38, v38, v54
    v_mul_f32 v56, s70, v38
    v_fma_f32 v28, v28, s70, -v56
    v_fma_f32 v30, v30, s70, -v56
    v_fma_f32 v32, v32, s70, -v56
    v_fma_f32 v34, v34, s70, -v56
    v_fma_f32 v48, v48, s70, -v56
    v_fma_f32 v50, v50, s70, -v56
    v_fma_f32 v52, v52, s70, -v56
    v_fma_f32 v54, v54, s70, -v56
    v_exp_f32 v28, v28
    v_exp_f32 v30, v30
    v_exp_f32 v32, v32
    v_exp_f32 v34, v34
    v_exp_f32 v48, v48
    v_exp_f32 v50, v50
    v_exp_f32 v52, v52
    v_exp_f32 v54, v54
    s_nop 0
    v_mul_f32 v37, v28, v29
    v_fmac_f32 v37, v30, v31
    v_fmac_f32 v37, v32, v33
    v_fmac_f32 v37, v34, v35
    v_fmac_f32 v37, v48, v49
    v_fmac_f32 v37, v50, v51
    v_fmac_f32 v37, v52, v53
    v_fmac_f32 v37, v54, v55
    s_waitcnt lgkmcnt(0)
    v_mul_f32 v40, v64, v28
    v_mul_f32 v41, v65, v28
    v_mul_f32 v42, v66, v28
    v_mul_f32 v43, v67, v28
    v_fmac_f32 v40, v68, v30
    v_fmac_f32 v41, v69, v30
    v_fmac_f32 v42, v70, v30
    v_fmac_f32 v43, v71, v30
    v_fmac_f32 v40, v72, v32
    v_fmac_f32 v41, v73, v32
    v_fmac_f32 v42, v74, v32
    v_fmac_f32 v43, v75, v32
    v_fmac_f32 v40, v76, v34
    v_fmac_f32 v41, v77, v34
    v_fmac_f32 v42, v78, v34
    v_fmac_f32 v43, v79, v34
    v_fmac_f32 v40, v80, v48
    v_fmac_f32 v41, v81, v48
    v_fmac_f32 v42, v82, v48
    v_fmac_f32 v43, v83, v48
    v_fmac_f32 v40, v84, v50
    v_fmac_f32 v41, v85, v50
    v_fmac_f32 v42, v86, v50
    v_fmac_f32 v43, v87, v50
    v_fmac_f32 v40, v88, v52
    v_fmac_f32 v41, v89, v52
    v_fmac_f32 v42, v90, v52
    v_fmac_f32 v43, v91, v52
    v_fmac_f32 v40, v92, v54
    v_fmac_f32 v41, v93, v54
    v_fmac_f32 v42, v94, v54
    v_fmac_f32 v43, v95, v54
    v_cmp_eq_u32 vcc, 32, v1
    v_mov_b32 v45, 0
    s_nop 0
    v_cndmask_b32 v40, v40, v38, vcc
    v_cndmask_b32 v41, v41, v37, vcc
    v_cndmask_b32 v42, v42, v45, vcc
    v_cndmask_b32 v43, v43, v45, vcc
    v_lshlrev_b32 v44, 4, v1
    s_lshl_b32 s61, s64, 9
    s_add_u32 s61, s61, 256
    v_add_u32 v44, s61, v44
    s_lshl_b32 s61, s64, 4
    s_add_u32 s61, s61, 128
    v_mov_b32 v46, s61
    v_cndmask_b32 v44, v44, v46, vcc
    s_add_u32 s61, s65, 32
    s_mul_i32 s61, s61, 16384
    s_mov_b32 exec_lo, -1
    s_mov_b32 exec_hi, 1
    buffer_store_dwordx4 v[40:43], v44, s[32:35], s61 offen sc0 sc1
    s_mov_b64 exec, -1
    s_branch L_end
L_roleA:
    s_and_b32 s60, s57, 3
    s_lshr_b32 s59, s57, 2
    s_lshl_b32 s59, s59, 5
    s_lshl_b32 s75, s58, 2
    s_add_u32 s75, s75, s60
    s_add_u32 s75, s75, s59
    s_waitcnt lgkmcnt(0)
    s_mov_b32 s32, s30
    s_and_b32 s33, s31, 0xffff
    s_mov_b32 s52, s28
    s_and_b32 s53, s29, 0xffff
    v_and_b32 v1, 63, v0
    v_lshrrev_b32 v2, 4, v1
    v_and_b32 v3, 15, v1
    v_lshlrev_b32 v5, 4, v1
    v_lshlrev_b32 v4, 17, v2
    v_lshl_add_u32 v4, v3, 4, v4
    s_mov_b32 s68, 0x05040100
    s_mov_b32 s69, 0x07060302
    s_mul_i32 s93, s75, 16384
    v_mov_b32 v40, -1
    v_mov_b32 v41, -1
    v_mov_b32 v42, -1
    v_mov_b32 v43, -1
    s_cmp_lg_u32 s57, 0
    s_cbranch_scc1 Lcq_24
    v_lshlrev_b32 v45, 4, v0
    s_lshl_b32 s61, s75, 11
    s_add_u32 s61, s61, 1310720
    buffer_store_dwordx4 v[40:43], v45, s[32:35], s61 offen sc0 sc1
    s_add_u32 s61, s61, 65536
    buffer_store_dwordx4 v[40:43], v45, s[32:35], s61 offen sc0 sc1
    s_waitcnt vmcnt(0)
    s_barrier
    s_cmp_lg_u32 s56, 7
    s_cbranch_scc1 Lcq_24
    v_mov_b32 v45, 1
    v_mov_b32 v46, 0
    s_mov_b64 s[94:95], exec
    s_mov_b64 exec, 1
    buffer_atomic_add v45, v46, s[52:55], s75 offen offset:0 sc1
    s_mov_b64 exec, s[94:95]
Lcq_24:
    v_lshlrev_b32 v44, 4, v0
    v_cmp_gt_u32 vcc, 7424, v44
    s_and_saveexec_b64 s[94:95], vcc
    s_cbranch_execz Lci_25
    buffer_store_dwordx4 v[40:43], v44, s[32:35], s93 offen sc0 sc1
Lci_25:
    s_mov_b64 exec, s[94:95]
    s_cmp_lg_u32 s56, 5
    s_cbranch_scc1 Lcq_26
    v_mov_b32 v46, 0
    v_mov_b32 v47, 65536
    s_lshl_b32 s61, s75, 8
    s_add_u32 s61, s61, 1507328
    s_mov_b64 s[94:95], exec
    s_mov_b64 exec, 1
    buffer_store_dword v47, v46, s[32:35], s61 offen sc0 sc1
    s_mov_b64 exec, s[94:95]
Lcq_26:
    s_cmp_lg_u32 s56, 6
    s_cbranch_scc1 Lcq_27
    s_lshl_b32 s61, s75, 10
    s_add_u32 s61, s61, 1146880
    buffer_store_dwordx4 v[40:43], v5, s[32:35], s61 offen sc0 sc1
Lcq_27:
    s_cmp_eq_u32 s78, 0
    s_cselect_b32 s36, s8, s22
    s_cselect_b32 s37, s9, s23
    s_cselect_b32 s40, s4, s16
    s_cselect_b32 s41, s5, s17
    s_and_b32 s37, s37, 0xffff
    s_and_b32 s41, s41, 0xffff
    buffer_load_dwordx4 v[192:195], v232, s[36:39], s77 offen nt
    s_add_u32 s77, s77, 8192
    buffer_load_dwordx4 v[196:199], v232, s[36:39], s77 offen nt
    s_add_u32 s77, s77, 8192
    buffer_load_dwordx4 v[200:203], v232, s[36:39], s77 offen nt
    s_add_u32 s77, s77, 8192
    buffer_load_dwordx4 v[204:207], v232, s[36:39], s77 offen nt
    buffer_load_dwordx2 v[208:209], v231, s[40:43], s76 offen offset:0
    buffer_load_dwordx2 v[210:211], v231, s[40:43], s76 offen offset:1024
    s_cmp_lt_u32 s75, 32
    s_cbranch_scc1 L_roleT1
    s_sub_u32 s65, s75, 32
    s_waitcnt vmcnt(0)
    s_barrier
    s_cmp_lg_u32 s56, 1
    s_cbranch_scc1 Lsc_28
    v_mov_b32 v40, 1
    v_mov_b32 v41, 0
    s_mov_b64 s[94:95], exec
    s_mov_b64 exec, 1
    buffer_atomic_add v40, v41, s[52:55], 0 offen offset:128 sc1
    s_mov_b64 exec, s[94:95]
Lsc_28:
    s_lshl_b32 s61, s65, 18
    s_add_u32 s44, s6, s61
    s_addc_u32 s45, s7, 0
    s_and_b32 s45, s45, 0xffff
    s_mov_b32 s46, 262144
    s_mov_b32 s47, 0x00020000
    s_waitcnt vmcnt(0)
    v_perm_b32 v232, v196, v192, s68
    v_perm_b32 v233, v196, v192, s69
    v_perm_b32 v234, v197, v193, s68
    v_perm_b32 v235, v197, v193, s69
    v_perm_b32 v236, v198, v194, s68
    v_perm_b32 v237, v198, v194, s69
    v_perm_b32 v238, v199, v195, s68
    v_perm_b32 v239, v199, v195, s69
    v_dot2_f32_bf16 v212, v232, v208, 0
    v_dot2_f32_bf16 v213, v233, v208, 0
    v_dot2_f32_bf16 v214, v234, v208, 0
    v_dot2_f32_bf16 v215, v235, v208, 0
    v_dot2_f32_bf16 v216, v236, v208, 0
    v_dot2_f32_bf16 v217, v237, v208, 0
    v_dot2_f32_bf16 v218, v238, v208, 0
    v_dot2_f32_bf16 v219, v239, v208, 0
    v_dot2_f32_bf16 v220, v232, v210, 0
    v_dot2_f32_bf16 v221, v233, v210, 0
    v_dot2_f32_bf16 v222, v234, v210, 0
    v_dot2_f32_bf16 v223, v235, v210, 0
    v_dot2_f32_bf16 v224, v236, v210, 0
    v_dot2_f32_bf16 v225, v237, v210, 0
    v_dot2_f32_bf16 v226, v238, v210, 0
    v_dot2_f32_bf16 v227, v239, v210, 0
    v_perm_b32 v232, v204, v200, s68
    v_perm_b32 v233, v204, v200, s69
    v_perm_b32 v234, v205, v201, s68
    v_perm_b32 v235, v205, v201, s69
    v_perm_b32 v236, v206, v202, s68
    v_perm_b32 v237, v206, v202, s69
    v_perm_b32 v238, v207, v203, s68
    v_perm_b32 v239, v207, v203, s69
    v_dot2_f32_bf16 v212, v232, v209, v212
    v_dot2_f32_bf16 v213, v233, v209, v213
    v_dot2_f32_bf16 v214, v234, v209, v214
    v_dot2_f32_bf16 v215, v235, v209, v215
    v_dot2_f32_bf16 v216, v236, v209, v216
    v_dot2_f32_bf16 v217, v237, v209, v217
    v_dot2_f32_bf16 v218, v238, v209, v218
    v_dot2_f32_bf16 v219, v239, v209, v219
    v_dot2_f32_bf16 v220, v232, v211, v220
    v_dot2_f32_bf16 v221, v233, v211, v221
    v_dot2_f32_bf16 v222, v234, v211, v222
    v_dot2_f32_bf16 v223, v235, v211, v223
    v_dot2_f32_bf16 v224, v236, v211, v224
    v_dot2_f32_bf16 v225, v237, v211, v225
    v_dot2_f32_bf16 v226, v238, v211, v226
    v_dot2_f32_bf16 v227, v239, v211, v227
    s_nop 2
    v_permlane32_swap_b32 v212, v220
    v_permlane32_swap_b32 v213, v221
    v_permlane32_swap_b32 v214, v222
    v_permlane32_swap_b32 v215, v223
    v_permlane32_swap_b32 v216, v224
    v_permlane32_swap_b32 v217, v225
    v_permlane32_swap_b32 v218, v226
    v_permlane32_swap_b32 v219, v227
    s_nop 1
    v_add_f32 v212, v212, v220
    v_add_f32 v213, v213, v221
    v_add_f32 v214, v214, v222
    v_add_f32 v215, v215, v223
    v_add_f32 v216, v216, v224
    v_add_f32 v217, v217, v225
    v_add_f32 v218, v218, v226
    v_add_f32 v219, v219, v227
    s_nop 1
    v_permlane16_swap_b32 v212, v216
    v_permlane16_swap_b32 v213, v217
    v_permlane16_swap_b32 v214, v218
    v_permlane16_swap_b32 v215, v219
    s_nop 1
    v_add_f32 v212, v212, v216
    v_add_f32 v213, v213, v217
    v_add_f32 v214, v214, v218
    v_add_f32 v215, v215, v219
    s_nop 1
    v_add_f32_dpp v212, v212, v212 row_ror:8 row_mask:0xf bank_mask:0xf
    v_add_f32_dpp v213, v213, v213 row_ror:8 row_mask:0xf bank_mask:0xf
    v_add_f32_dpp v214, v214, v214 row_ror:8 row_mask:0xf bank_mask:0xf
    v_add_f32_dpp v215, v215, v215 row_ror:8 row_mask:0xf bank_mask:0xf
    v_lshrrev_b32 v232, 5, v228
    v_lshlrev_b32 v232, 8, v232
    v_bfe_u32 v233, v228, 4, 1
    v_lshl_add_u32 v232, v233, 4, v232
    v_lshl_add_u32 v232, v230, 5, v232
    s_lshl_b32 s61, s56, 9
    s_add_u32 s61, s61, 147456
    v_add_u32 v232, s61, v232
    ds_write_b128 v232, v[212:215]
    s_waitcnt lgkmcnt(0)
    s_barrier
    s_cmp_lg_u32 s56, 0
    s_cbranch_scc1 Ls1p_29
    v_mov_b32 v234, 0
    buffer_load_dword v235, v234, s[52:55], s91 offen offset:0 sc0 sc1
    v_and_b32 v232, 31, v228
    v_lshlrev_b32 v233, 4, v232
    v_add_u32 v233, 147456, v233
    ds_read_b128 v[192:195], v233 offset:0
    ds_read_b128 v[196:199], v233 offset:512
    ds_read_b128 v[200:203], v233 offset:1024
    ds_read_b128 v[204:207], v233 offset:1536
    ds_read_b128 v[208:211], v233 offset:2048
    ds_read_b128 v[212:215], v233 offset:2560
    ds_read_b128 v[216:219], v233 offset:3072
    ds_read_b128 v[220:223], v233 offset:3584
    s_waitcnt lgkmcnt(6)
    v_add_f32 v192, v192, v196
    v_add_f32 v193, v193, v197
    v_add_f32 v194, v194, v198
    v_add_f32 v195, v195, v199
    s_waitcnt lgkmcnt(5)
    v_add_f32 v192, v192, v200
    v_add_f32 v193, v193, v201
    v_add_f32 v194, v194, v202
    v_add_f32 v195, v195, v203
    s_waitcnt lgkmcnt(4)
    v_add_f32 v192, v192, v204
    v_add_f32 v193, v193, v205
    v_add_f32 v194, v194, v206
    v_add_f32 v195, v195, v207
    s_waitcnt lgkmcnt(3)
    v_add_f32 v192, v192, v208
    v_add_f32 v193, v193, v209
    v_add_f32 v194, v194, v210
    v_add_f32 v195, v195, v211
    s_waitcnt lgkmcnt(2)
    v_add_f32 v192, v192, v212
    v_add_f32 v193, v193, v213
    v_add_f32 v194, v194, v214
    v_add_f32 v195, v195, v215
    s_waitcnt lgkmcnt(1)
    v_add_f32 v192, v192, v216
    v_add_f32 v193, v193, v217
    v_add_f32 v194, v194, v218
    v_add_f32 v195, v195, v219
    s_waitcnt lgkmcnt(0)
    v_add_f32 v192, v192, v220
    v_add_f32 v193, v193, v221
    v_add_f32 v194, v194, v222
    v_add_f32 v195, v195, v223
    v_lshrrev_b32 v233, 4, v232
    v_lshlrev_b32 v233, 10, v233
    v_and_b32 v232, 15, v232
    v_lshl_add_u32 v233, v232, 4, v233
    s_waitcnt vmcnt(0)
    s_mov_b32 s92, 0
Lcf_30:
    v_readfirstlane_b32 s57, v235
    s_nop 3
    s_cmp_lg_u32 s57, 0
    s_cbranch_scc1 Lcfd_31
    s_sleep 2
    buffer_load_dword v235, v234, s[52:55], s91 offen offset:0 sc0 sc1
    s_waitcnt vmcnt(0)
    s_add_u32 s92, s92, 1
    s_cmp_lt_u32 s92, 400000
    s_cbranch_scc1 Lcf_30
Lcfd_31:
    s_mov_b64 exec, 0xffffffff
    buffer_store_dwordx4 v[192:195], v233, s[32:35], s3 offen sc0 sc1
    s_mov_b64 exec, -1
Ls1p_29:
    s_lshl_b32 s61, s56, 14
    s_add_u32 m0, s61, 0
    v_xor_b32 v52, 0, v5
    s_add_u32 s62, s61, 0
    buffer_load_dwordx4 v52, s[44:47], s62 offen nt lds
    s_add_u32 m0, s61, 1024
    v_xor_b32 v53, 64, v5
    s_add_u32 s62, s61, 1024
    buffer_load_dwordx4 v53, s[44:47], s62 offen nt lds
    s_add_u32 m0, s61, 2048
    v_xor_b32 v52, 128, v5
    s_add_u32 s62, s61, 2048
    buffer_load_dwordx4 v52, s[44:47], s62 offen nt lds
    s_add_u32 m0, s61, 3072
    v_xor_b32 v53, 192, v5
    s_add_u32 s62, s61, 3072
    buffer_load_dwordx4 v53, s[44:47], s62 offen nt lds
    s_add_u32 m0, s61, 4096
    v_xor_b32 v52, 0, v5
    s_add_u32 s62, s61, 4096
    buffer_load_dwordx4 v52, s[44:47], s62 offen nt lds
    s_add_u32 m0, s61, 5120
    v_xor_b32 v53, 64, v5
    s_add_u32 s62, s61, 5120
    buffer_load_dwordx4 v53, s[44:47], s62 offen nt lds
    s_add_u32 m0, s61, 6144
    v_xor_b32 v52, 128, v5
    s_add_u32 s62, s61, 6144
    buffer_load_dwordx4 v52, s[44:47], s62 offen nt lds
    s_add_u32 m0, s61, 7168
    v_xor_b32 v53, 192, v5
    s_add_u32 s62, s61, 7168
    buffer_load_dwordx4 v53, s[44:47], s62 offen nt lds
    s_add_u32 m0, s61, 8192
    v_xor_b32 v52, 32, v5
    s_add_u32 s62, s61, 8192
    buffer_load_dwordx4 v52, s[44:47], s62 offen nt lds
    s_add_u32 m0, s61, 9216
    v_xor_b32 v53, 96, v5
    s_add_u32 s62, s61, 9216
    buffer_load_dwordx4 v53, s[44:47], s62 offen nt lds
    s_add_u32 m0, s61, 10240
    v_xor_b32 v52, 160, v5
    s_add_u32 s62, s61, 10240
    buffer_load_dwordx4 v52, s[44:47], s62 offen nt lds
    s_add_u32 m0, s61, 11264
    v_xor_b32 v53, 224, v5
    s_add_u32 s62, s61, 11264
    buffer_load_dwordx4 v53, s[44:47], s62 offen nt lds
    s_add_u32 m0, s61, 12288
    v_xor_b32 v52, 32, v5
    s_add_u32 s62, s61, 12288
    buffer_load_dwordx4 v52, s[44:47], s62 offen nt lds
    s_add_u32 m0, s61, 13312
    v_xor_b32 v53, 96, v5
    s_add_u32 s62, s61, 13312
    buffer_load_dwordx4 v53, s[44:47], s62 offen nt lds
    s_add_u32 m0, s61, 14336
    v_xor_b32 v52, 160, v5
    s_add_u32 s62, s61, 14336
    buffer_load_dwordx4 v52, s[44:47], s62 offen nt lds
    s_add_u32 m0, s61, 15360
    v_xor_b32 v53, 224, v5
    s_add_u32 s62, s61, 15360
    buffer_load_dwordx4 v53, s[44:47], s62 offen nt lds
    s_barrier
    s_lshr_b32 s66, s65, 4
    s_and_b32 s67, s65, 15
    s_and_b32 s63, s56, 3
    s_lshr_b32 s64, s56, 2
    v_and_b32 v40, 3, v3
    v_lshlrev_b32 v40, 2, v40
    v_lshrrev_b32 v41, 3, v3
    v_lshl_or_b32 v40, v41, 1, v40
    s_lshl_b32 s61, s63, 15
    v_lshlrev_b32 v41, 10, v3
    v_add_u32 v41, s61, v41
    v_add_u32 v42, 0, v2
    v_xor_b32 v42, v42, v40
    v_lshl_add_u32 v8, v42, 4, v41
    v_add_u32 v42, 4, v2
    v_xor_b32 v42, v42, v40
    v_lshl_add_u32 v9, v42, 4, v41
    v_add_u32 v42, 8, v2
    v_xor_b32 v42, v42, v40
    v_lshl_add_u32 v10, v42, 4, v41
    v_add_u32 v42, 12, v2
    v_xor_b32 v42, v42, v40
    v_lshl_add_u32 v11, v42, 4, v41
    s_lshl_b32 s61, s64, 14
    s_add_u32 s61, s61, 131072
    s_lshl_b32 s62, s63, 15
    s_sub_u32 s61, s61, s62
    v_lshrrev_b32 v43, 1, v2
    v_and_b32 v44, 1, v2
    v_lshrrev_b32 v45, 2, v3
    v_lshl_add_u32 v46, v43, 3, v45
    v_lshlrev_b32 v47, 2, v45
    v_lshl_or_b32 v47, v43, 1, v47
    v_bfe_u32 v48, v3, 1, 1
    v_lshl_add_u32 v48, v44, 1, v48
    s_lshl_b32 s62, s56, 3
    s_add_u32 s62, s62, 0
    v_add_u32 v48, s62, v48
    v_xor_b32 v48, v48, v47
    v_lshlrev_b32 v48, 4, v48
    v_lshl_add_u32 v48, v46, 10, v48
    v_and_b32 v49, 1, v3
    v_lshl_add_u32 v12, v49, 3, v48
    v_bfe_u32 v48, v3, 1, 1
    v_lshl_add_u32 v48, v44, 1, v48
    s_lshl_b32 s62, s56, 3
    s_add_u32 s62, s62, 4
    v_add_u32 v48, s62, v48
    v_xor_b32 v48, v48, v47
    v_lshlrev_b32 v48, 4, v48
    v_lshl_add_u32 v48, v46, 10, v48
    v_and_b32 v49, 1, v3
    v_lshl_add_u32 v13, v49, 3, v48
    v_lshl_add_u32 v46, v43, 3, v45
    v_add_u32 v46, 4, v46
    v_lshlrev_b32 v47, 2, v45
    v_lshl_or_b32 v47, v43, 1, v47
    v_bfe_u32 v48, v3, 1, 1
    v_lshl_add_u32 v48, v44, 1, v48
    s_lshl_b32 s62, s56, 3
    s_add_u32 s62, s62, 0
    v_add_u32 v48, s62, v48
    v_xor_b32 v48, v48, v47
    v_lshlrev_b32 v48, 4, v48
    v_lshl_add_u32 v48, v46, 10, v48
    v_and_b32 v49, 1, v3
    v_lshl_add_u32 v14, v49, 3, v48
    v_bfe_u32 v48, v3, 1, 1
    v_lshl_add_u32 v48, v44, 1, v48
    s_lshl_b32 s62, s56, 3
    s_add_u32 s62, s62, 4
    v_add_u32 v48, s62, v48
    v_xor_b32 v48, v48, v47
    v_lshlrev_b32 v48, 4, v48
    v_lshl_add_u32 v48, v46, 10, v48
    v_and_b32 v49, 1, v3
    v_lshl_add_u32 v15, v49, 3, v48
    v_and_b32 v43, 31, v1
    v_lshrrev_b32 v44, 5, v1
    v_mul_u32_u24 v16, 272, v43
    v_lshl_add_u32 v16, v44, 4, v16
    v_add_u32 v16, 131072, v16
    v_lshlrev_b32 v23, 4, v43
    v_add_u32 v23, 139776, v23
    s_lshl_b32 s62, s64, 4
    v_add_u32 v43, s62, v3
    v_mul_u32_u24 v17, 272, v43
    v_lshl_add_u32 v17, v2, 3, v17
    s_lshl_b32 s62, s63, 6
    s_add_u32 s62, s62, 131072
    v_add_u32 v17, s62, v17
    v_lshlrev_b32 v22, 4, v43
    v_add_u32 v22, 139776, v22
    s_lshl_b32 s62, s63, 2
    v_add_u32 v21, s62, v22
    v_add_u32 v33, s61, v8
    v_mov_b32 v18, 0xff7fffff
    v_mov_b32 v20, 0xff7fffff
    v_mov_b32 v19, 0
    s_mov_b32 s100, s61
    s_cmp_lt_u32 s56, 4
    s_cbranch_scc1 Lqa0_32
    s_waitcnt vmcnt(0)
    s_lshl_b32 s61, s56, 14
    s_add_u32 s61, s61, 131072
    buffer_load_dwordx4 v[128:131], v5, s[44:47], s61 offen offset:0 nt
    buffer_load_dwordx4 v[132:135], v5, s[44:47], s61 offen offset:1024 nt
    buffer_load_dwordx4 v[136:139], v5, s[44:47], s61 offen offset:2048 nt
    buffer_load_dwordx4 v[140:143], v5, s[44:47], s61 offen offset:3072 nt
    s_add_u32 s61, s61, 4096
    buffer_load_dwordx4 v[144:147], v5, s[44:47], s61 offen offset:0 nt
    buffer_load_dwordx4 v[148:151], v5, s[44:47], s61 offen offset:1024 nt
    buffer_load_dwordx4 v[152:155], v5, s[44:47], s61 offen offset:2048 nt
    buffer_load_dwordx4 v[156:159], v5, s[44:47], s61 offen offset:3072 nt
    s_add_u32 s61, s61, 4096
    buffer_load_dwordx4 v[160:163], v5, s[44:47], s61 offen offset:0 nt
    buffer_load_dwordx4 v[164:167], v5, s[44:47], s61 offen offset:1024 nt
    buffer_load_dwordx4 v[168:171], v5, s[44:47], s61 offen offset:2048 nt
    buffer_load_dwordx4 v[172:175], v5, s[44:47], s61 offen offset:3072 nt
    s_add_u32 s61, s61, 4096
    buffer_load_dwordx4 v[176:179], v5, s[44:47], s61 offen offset:0 nt
    buffer_load_dwordx4 v[180:183], v5, s[44:47], s61 offen offset:1024 nt
    buffer_load_dwordx4 v[184:187], v5, s[44:47], s61 offen offset:2048 nt
    buffer_load_dwordx4 v[188:191], v5, s[44:47], s61 offen offset:3072 nt
    s_branch Lqaj_33
Lqa0_32:
    v_mov_b32 v40, 0
    s_mov_b32 s92, 0
Lcf_34:
    buffer_load_dword v41, v40, s[52:55], 0 offen offset:128 sc0 sc1
    s_waitcnt vmcnt(0)
    v_readfirstlane_b32 s57, v41
    s_nop 3
    s_cmp_ge_u32 s57, 64
    s_cbranch_scc1 Lcfd_35
    s_sleep 16
    s_add_u32 s92, s92, 1
    s_cmp_lt_u32 s92, 400000
    s_cbranch_scc1 Lcf_34
Lcfd_35:
    s_lshl_b32 s61, s66, 15
    s_lshl_b32 s62, s56, 13
    s_add_u32 s61, s61, s62
    s_add_u32 s61, s61, 1146880
    s_add_u32 s62, s61, 4096
    s_mov_b32 s92, 0
Lpoll_36:
    buffer_load_dwordx4 v[64:67], v5, s[32:35], s61 offen offset:0 sc0 sc1
    buffer_load_dwordx4 v[68:71], v5, s[32:35], s61 offen offset:1024 sc0 sc1
    buffer_load_dwordx4 v[72:75], v5, s[32:35], s61 offen offset:2048 sc0 sc1
    buffer_load_dwordx4 v[76:79], v5, s[32:35], s61 offen offset:3072 sc0 sc1
    buffer_load_dwordx4 v[80:83], v5, s[32:35], s62 offen offset:0 sc0 sc1
    buffer_load_dwordx4 v[84:87], v5, s[32:35], s62 offen offset:1024 sc0 sc1
    buffer_load_dwordx4 v[88:91], v5, s[32:35], s62 offen offset:2048 sc0 sc1
    buffer_load_dwordx4 v[92:95], v5, s[32:35], s62 offen offset:3072 sc0 sc1
    s_waitcnt vmcnt(0)
    v_mov_b32 v40, v64
    v_max3_u32 v40, v40, v65, v66
    v_max3_u32 v40, v40, v67, v68
    v_max3_u32 v40, v40, v69, v70
    v_max3_u32 v40, v40, v71, v72
    v_max3_u32 v40, v40, v73, v74
    v_max3_u32 v40, v40, v75, v76
    v_max3_u32 v40, v40, v77, v78
    v_max3_u32 v40, v40, v79, v80
    v_max3_u32 v40, v40, v81, v82
    v_max3_u32 v40, v40, v83, v84
    v_max3_u32 v40, v40, v85, v86
    v_max3_u32 v40, v40, v87, v88
    v_max3_u32 v40, v40, v89, v90
    v_max3_u32 v40, v40, v91, v92
    v_max3_u32 v40, v40, v93, v94
    v_max_u32 v40, v40, v95
    v_cmpx_eq_u32 vcc, -1, v40
    s_cbranch_execz Lpolld_37
    s_sleep 4
    s_add_u32 s92, s92, 1
    s_cmp_lt_u32 s92, 400000
    s_cbranch_scc1 Lpoll_36
Lpolld_37:
    s_mov_b64 exec, -1
    s_and_b32 s62, s56, 1
    s_lshl_b32 s62, s62, 5
    s_lshl_b32 s61, s56, 13
    s_add_u32 s61, s61, 131072
    s_add_u32 s57, s62, 0
    v_xor_b32 v40, s57, v5
    v_add_u32 v40, s61, v40
    ds_write_b128 v40, v[64:67] offset:0
    s_add_u32 s57, s62, 64
    v_xor_b32 v41, s57, v5
    v_add_u32 v41, s61, v41
    ds_write_b128 v41, v[68:71] offset:1024
    s_add_u32 s57, s62, 128
    v_xor_b32 v42, s57, v5
    v_add_u32 v42, s61, v42
    ds_write_b128 v42, v[72:75] offset:2048
    s_add_u32 s57, s62, 192
    v_xor_b32 v43, s57, v5
    v_add_u32 v43, s61, v43
    ds_write_b128 v43, v[76:79] offset:3072
    s_add_u32 s57, s62, 0
    v_xor_b32 v40, s57, v5
    v_add_u32 v40, s61, v40
    ds_write_b128 v40, v[80:83] offset:4096
    s_add_u32 s57, s62, 64
    v_xor_b32 v41, s57, v5
    v_add_u32 v41, s61, v41
    ds_write_b128 v41, v[84:87] offset:5120
    s_add_u32 s57, s62, 128
    v_xor_b32 v42, s57, v5
    v_add_u32 v42, s61, v42
    ds_write_b128 v42, v[88:91] offset:6144
    s_add_u32 s57, s62, 192
    v_xor_b32 v43, s57, v5
    v_add_u32 v43, s61, v43
    ds_write_b128 v43, v[92:95] offset:7168
    s_waitcnt lgkmcnt(0)
    s_lshl_b32 s61, s56, 14
    s_add_u32 s61, s61, 131072
    buffer_load_dwordx4 v[128:131], v5, s[44:47], s61 offen offset:0 nt
    buffer_load_dwordx4 v[132:135], v5, s[44:47], s61 offen offset:1024 nt
    buffer_load_dwordx4 v[136:139], v5, s[44:47], s61 offen offset:2048 nt
    buffer_load_dwordx4 v[140:143], v5, s[44:47], s61 offen offset:3072 nt
    s_add_u32 s61, s61, 4096
    buffer_load_dwordx4 v[144:147], v5, s[44:47], s61 offen offset:0 nt
    buffer_load_dwordx4 v[148:151], v5, s[44:47], s61 offen offset:1024 nt
    buffer_load_dwordx4 v[152:155], v5, s[44:47], s61 offen offset:2048 nt
    buffer_load_dwordx4 v[156:159], v5, s[44:47], s61 offen offset:3072 nt
    s_add_u32 s61, s61, 4096
    buffer_load_dwordx4 v[160:163], v5, s[44:47], s61 offen offset:0 nt
    buffer_load_dwordx4 v[164:167], v5, s[44:47], s61 offen offset:1024 nt
    buffer_load_dwordx4 v[168:171], v5, s[44:47], s61 offen offset:2048 nt
    buffer_load_dwordx4 v[172:175], v5, s[44:47], s61 offen offset:3072 nt
    s_add_u32 s61, s61, 4096
    buffer_load_dwordx4 v[176:179], v5, s[44:47], s61 offen offset:0 nt
    buffer_load_dwordx4 v[180:183], v5, s[44:47], s61 offen offset:1024 nt
    buffer_load_dwordx4 v[184:187], v5, s[44:47], s61 offen offset:2048 nt
    buffer_load_dwordx4 v[188:191], v5, s[44:47], s61 offen offset:3072 nt
Lqaj_33:
    s_barrier
    v_add_u32 v40, s100, v8
    v_add_u32 v41, s100, v9
    v_add_u32 v42, s100, v10
    v_add_u32 v43, s100, v11
    ds_read_b128 v[192:195], v40 offset:0
    ds_read_b128 v[196:199], v41 offset:0
    ds_read_b128 v[200:203], v42 offset:0
    ds_read_b128 v[204:207], v43 offset:0
    ds_read_b128 v[208:211], v40 offset:256
    ds_read_b128 v[212:215], v41 offset:256
    ds_read_b128 v[216:219], v42 offset:256
    ds_read_b128 v[220:223], v43 offset:256
    ds_read_b128 v[224:227], v40 offset:512
    ds_read_b128 v[228:231], v41 offset:512
    ds_read_b128 v[232:235], v42 offset:512
    ds_read_b128 v[236:239], v43 offset:512
    ds_read_b128 v[240:243], v40 offset:768
    ds_read_b128 v[244:247], v41 offset:768
    ds_read_b128 v[248:251], v42 offset:768
    ds_read_b128 v[252:255], v43 offset:768
    s_waitcnt lgkmcnt(0)
    s_barrier
    ds_read_b128 v[96:99], v8 offset:0
    ds_read_b128 v[100:103], v8 offset:16384
    ds_read_b128 v[104:107], v9 offset:0
    ds_read_b128 v[108:111], v9 offset:16384
    ds_read_b128 v[112:115], v10 offset:0
    ds_read_b128 v[116:119], v10 offset:16384
    ds_read_b128 v[120:123], v11 offset:0
    ds_read_b128 v[124:127], v11 offset:16384
    s_waitcnt lgkmcnt(7)
    v_mfma_f32_16x16x32_bf16 v[24:27], v[96:99], v[192:195], 0
    ds_read_b128 v[96:99], v8 offset:256
    s_waitcnt lgkmcnt(7)
    v_mfma_f32_16x16x32_bf16 v[28:31], v[100:103], v[192:195], 0
    ds_read_b128 v[100:103], v8 offset:16640
    s_waitcnt lgkmcnt(7)
    v_mfma_f32_16x16x32_bf16 v[24:27], v[104:107], v[196:199], v[24:27]
    ds_read_b128 v[104:107], v9 offset:256
    s_waitcnt lgkmcnt(7)
    v_mfma_f32_16x16x32_bf16 v[28:31], v[108:111], v[196:199], v[28:31]
    ds_read_b128 v[108:111], v9 offset:16640
    s_waitcnt lgkmcnt(7)
    v_mfma_f32_16x16x32_bf16 v[24:27], v[112:115], v[200:203], v[24:27]
    ds_read_b128 v[112:115], v10 offset:256
    s_waitcnt lgkmcnt(7)
    v_mfma_f32_16x16x32_bf16 v[28:31], v[116:119], v[200:203], v[28:31]
    ds_read_b128 v[116:119], v10 offset:16640
    s_waitcnt lgkmcnt(7)
    v_mfma_f32_16x16x32_bf16 v[24:27], v[120:123], v[204:207], v[24:27]
    ds_read_b128 v[120:123], v11 offset:256
    s_waitcnt lgkmcnt(7)
    v_mfma_f32_16x16x32_bf16 v[28:31], v[124:127], v[204:207], v[28:31]
    ds_read_b128 v[124:127], v11 offset:16640
    s_waitcnt lgkmcnt(7)
    v_mfma_f32_16x16x32_bf16 v[24:27], v[96:99], v[208:211], v[24:27]
    ds_read_b128 v[96:99], v8 offset:512
    s_waitcnt lgkmcnt(7)
    v_mfma_f32_16x16x32_bf16 v[28:31], v[100:103], v[208:211], v[28:31]
    ds_read_b128 v[100:103], v8 offset:16896
    s_waitcnt lgkmcnt(7)
    v_mfma_f32_16x16x32_bf16 v[24:27], v[104:107], v[212:215], v[24:27]
    ds_read_b128 v[104:107], v9 offset:512
    s_waitcnt lgkmcnt(7)
    v_mfma_f32_16x16x32_bf16 v[28:31], v[108:111], v[212:215], v[28:31]
    ds_read_b128 v[108:111], v9 offset:16896
    s_waitcnt lgkmcnt(7)
    v_mfma_f32_16x16x32_bf16 v[24:27], v[112:115], v[216:219], v[24:27]
    ds_read_b128 v[112:115], v10 offset:512
    s_waitcnt lgkmcnt(7)
    v_mfma_f32_16x16x32_bf16 v[28:31], v[116:119], v[216:219], v[28:31]
    ds_read_b128 v[116:119], v10 offset:16896
    s_waitcnt lgkmcnt(7)
    v_mfma_f32_16x16x32_bf16 v[24:27], v[120:123], v[220:223], v[24:27]
    ds_read_b128 v[120:123], v11 offset:512
    s_waitcnt lgkmcnt(7)
    v_mfma_f32_16x16x32_bf16 v[28:31], v[124:127], v[220:223], v[28:31]
    ds_read_b128 v[124:127], v11 offset:16896
    s_waitcnt lgkmcnt(7)
    v_mfma_f32_16x16x32_bf16 v[24:27], v[96:99], v[224:227], v[24:27]
    ds_read_b128 v[96:99], v8 offset:768
    s_waitcnt lgkmcnt(7)
    v_mfma_f32_16x16x32_bf16 v[28:31], v[100:103], v[224:227], v[28:31]
    ds_read_b128 v[100:103], v8 offset:17152
    s_waitcnt lgkmcnt(7)
    v_mfma_f32_16x16x32_bf16 v[24:27], v[104:107], v[228:231], v[24:27]
    ds_read_b128 v[104:107], v9 offset:768
    s_waitcnt lgkmcnt(7)
    v_mfma_f32_16x16x32_bf16 v[28:31], v[108:111], v[228:231], v[28:31]
    ds_read_b128 v[108:111], v9 offset:17152
    s_waitcnt lgkmcnt(7)
    v_mfma_f32_16x16x32_bf16 v[24:27], v[112:115], v[232:235], v[24:27]
    ds_read_b128 v[112:115], v10 offset:768
    s_waitcnt lgkmcnt(7)
    v_mfma_f32_16x16x32_bf16 v[28:31], v[116:119], v[232:235], v[28:31]
    ds_read_b128 v[116:119], v10 offset:17152
    s_waitcnt lgkmcnt(7)
    v_mfma_f32_16x16x32_bf16 v[24:27], v[120:123], v[236:239], v[24:27]
    ds_read_b128 v[120:123], v11 offset:768
    s_waitcnt lgkmcnt(7)
    v_mfma_f32_16x16x32_bf16 v[28:31], v[124:127], v[236:239], v[28:31]
    ds_read_b128 v[124:127], v11 offset:17152
    s_waitcnt lgkmcnt(7)
    v_mfma_f32_16x16x32_bf16 v[24:27], v[96:99], v[240:243], v[24:27]
    s_waitcnt lgkmcnt(6)
    v_mfma_f32_16x16x32_bf16 v[28:31], v[100:103], v[240:243], v[28:31]
    s_waitcnt lgkmcnt(5)
    v_mfma_f32_16x16x32_bf16 v[24:27], v[104:107], v[244:247], v[24:27]
    s_waitcnt lgkmcnt(4)
    v_mfma_f32_16x16x32_bf16 v[28:31], v[108:111], v[244:247], v[28:31]
    s_waitcnt lgkmcnt(3)
    v_mfma_f32_16x16x32_bf16 v[24:27], v[112:115], v[248:251], v[24:27]
    s_waitcnt lgkmcnt(2)
    v_mfma_f32_16x16x32_bf16 v[28:31], v[116:119], v[248:251], v[28:31]
    s_waitcnt lgkmcnt(1)
    v_mfma_f32_16x16x32_bf16 v[24:27], v[120:123], v[252:255], v[24:27]
    s_waitcnt lgkmcnt(0)
    v_mfma_f32_16x16x32_bf16 v[28:31], v[124:127], v[252:255], v[28:31]
    s_nop 7
    s_nop 1
    v_max3_f32 v40, v24, v25, v26
    v_max3_f32 v40, v40, v27, v28
    v_max3_f32 v40, v40, v29, v30
    v_max_f32 v40, v40, v31
    v_mov_b32 v41, v40
    s_nop 1
    v_permlane32_swap_b32 v40, v41
    s_nop 1
    v_max_f32 v40, v40, v41
    v_mov_b32 v41, v40
    s_nop 1
    v_permlane16_swap_b32 v40, v41
    s_nop 1
    v_max_f32 v40, v40, v41
    ds_write_b32 v21, v40
    s_waitcnt lgkmcnt(0)
    s_barrier
    ds_read_b128 v[40:43], v22
    ds_read_b128 v[44:47], v23
    s_waitcnt lgkmcnt(1)
    v_max3_f32 v40, v40, v41, v42
    v_max3_f32 v20, v40, v43, v20
    v_sub_f32 v24, v24, v20
    v_sub_f32 v25, v25, v20
    v_sub_f32 v26, v26, v20
    v_sub_f32 v27, v27, v20
    v_sub_f32 v28, v28, v20
    v_sub_f32 v29, v29, v20
    v_sub_f32 v30, v30, v20
    v_sub_f32 v31, v31, v20
    v_exp_f32 v24, v24
    v_exp_f32 v25, v25
    v_exp_f32 v26, v26
    v_exp_f32 v27, v27
    v_exp_f32 v28, v28
    v_exp_f32 v29, v29
    v_exp_f32 v30, v30
    v_exp_f32 v31, v31
    s_waitcnt lgkmcnt(0)
    v_max3_f32 v44, v44, v45, v46
    v_max3_f32 v44, v44, v47, v18
    v_sub_f32 v32, v18, v44
    v_exp_f32 v32, v32
    v_mov_b32 v18, v44
    v_add_f32 v40, v24, v25
    v_add_f32 v40, v40, v26
    v_add_f32 v40, v40, v27
    v_add_f32 v40, v40, v28
    v_add_f32 v40, v40, v29
    v_add_f32 v40, v40, v30
    v_add_f32 v40, v40, v31
    v_cvt_pk_bf16_f32 v48, v24, v25
    v_cvt_pk_bf16_f32 v49, v26, v27
    v_cvt_pk_bf16_f32 v50, v28, v29
    v_cvt_pk_bf16_f32 v51, v30, v31
    ds_write_b64 v17, v[48:49] offset:0
    ds_write_b64 v17, v[50:51] offset:32
    v_mov_b32 v41, v40
    s_nop 1
    v_permlane32_swap_b32 v40, v41
    s_nop 1
    v_add_f32 v40, v40, v41
    v_mov_b32 v41, v40
    s_nop 1
    v_permlane16_swap_b32 v40, v41
    s_nop 1
    v_add_f32 v40, v40, v41
    ds_write_b32 v21, v40 offset:512
    s_waitcnt lgkmcnt(0)
    s_barrier
    ds_read_b128 v[40:43], v23 offset:512
    ds_read_b128 v[96:99], v16 offset:0
    ds_read_b64_tr_b16 v[100:101], v12 offset:0
    ds_read_b64_tr_b16 v[102:103], v14 offset:0
    ds_read_b64_tr_b16 v[104:105], v13 offset:0
    ds_read_b64_tr_b16 v[106:107], v15 offset:0
    ds_read_b128 v[108:111], v16 offset:32
    ds_read_b64_tr_b16 v[112:113], v12 offset:16384
    ds_read_b64_tr_b16 v[114:115], v14 offset:16384
    ds_read_b64_tr_b16 v[116:117], v13 offset:16384
    ds_read_b64_tr_b16 v[118:119], v15 offset:16384
    s_waitcnt lgkmcnt(5)
    v_mfma_f32_32x32x16_bf16 v[64:79], v[100:103], v[96:99], 0
    v_mfma_f32_32x32x16_bf16 v[80:95], v[104:107], v[96:99], 0
    ds_read_b128 v[96:99], v16 offset:64
    ds_read_b64_tr_b16 v[100:101], v12 offset:32768
    ds_read_b64_tr_b16 v[102:103], v14 offset:32768
    ds_read_b64_tr_b16 v[104:105], v13 offset:32768
    ds_read_b64_tr_b16 v[106:107], v15 offset:32768
    s_waitcnt lgkmcnt(5)
    v_mfma_f32_32x32x16_bf16 v[64:79], v[112:115], v[108:111], v[64:79]
    v_mfma_f32_32x32x16_bf16 v[80:95], v[116:119], v[108:111], v[80:95]
    ds_read_b128 v[108:111], v16 offset:96
    ds_read_b64_tr_b16 v[112:113], v12 offset:49152
    ds_read_b64_tr_b16 v[114:115], v14 offset:49152
    ds_read_b64_tr_b16 v[116:117], v13 offset:49152
    ds_read_b64_tr_b16 v[118:119], v15 offset:49152
    s_waitcnt lgkmcnt(5)
    v_mfma_f32_32x32x16_bf16 v[64:79], v[100:103], v[96:99], v[64:79]
    v_mfma_f32_32x32x16_bf16 v[80:95], v[104:107], v[96:99], v[80:95]
    v_add_u32 v12, 0x10000, v12
    v_add_u32 v13, 0x10000, v13
    v_add_u32 v14, 0x10000, v14
    v_add_u32 v15, 0x10000, v15
    ds_read_b128 v[96:99], v16 offset:128
    ds_read_b64_tr_b16 v[100:101], v12 offset:0
    ds_read_b64_tr_b16 v[102:103], v14 offset:0
    ds_read_b64_tr_b16 v[104:105], v13 offset:0
    ds_read_b64_tr_b16 v[106:107], v15 offset:0
    s_waitcnt lgkmcnt(5)
    v_mfma_f32_32x32x16_bf16 v[64:79], v[112:115], v[108:111], v[64:79]
    v_mfma_f32_32x32x16_bf16 v[80:95], v[116:119], v[108:111], v[80:95]
    ds_read_b128 v[108:111], v16 offset:160
    ds_read_b64_tr_b16 v[112:113], v12 offset:16384
    ds_read_b64_tr_b16 v[114:115], v14 offset:16384
    ds_read_b64_tr_b16 v[116:117], v13 offset:16384
    ds_read_b64_tr_b16 v[118:119], v15 offset:16384
    s_waitcnt lgkmcnt(5)
    v_mfma_f32_32x32x16_bf16 v[64:79], v[100:103], v[96:99], v[64:79]
    v_mfma_f32_32x32x16_bf16 v[80:95], v[104:107], v[96:99], v[80:95]
    ds_read_b128 v[96:99], v16 offset:192
    ds_read_b64_tr_b16 v[100:101], v12 offset:32768
    ds_read_b64_tr_b16 v[102:103], v14 offset:32768
    ds_read_b64_tr_b16 v[104:105], v13 offset:32768
    ds_read_b64_tr_b16 v[106:107], v15 offset:32768
    s_waitcnt lgkmcnt(5)
    v_mfma_f32_32x32x16_bf16 v[64:79], v[112:115], v[108:111], v[64:79]
    v_mfma_f32_32x32x16_bf16 v[80:95], v[116:119], v[108:111], v[80:95]
    ds_read_b128 v[108:111], v16 offset:224
    ds_read_b64_tr_b16 v[112:113], v12 offset:49152
    ds_read_b64_tr_b16 v[114:115], v14 offset:49152
    ds_read_b64_tr_b16 v[116:117], v13 offset:49152
    ds_read_b64_tr_b16 v[118:119], v15 offset:49152
    s_waitcnt lgkmcnt(5)
    v_mfma_f32_32x32x16_bf16 v[64:79], v[100:103], v[96:99], v[64:79]
    v_mfma_f32_32x32x16_bf16 v[80:95], v[104:107], v[96:99], v[80:95]
    s_waitcnt lgkmcnt(0)
    v_mfma_f32_32x32x16_bf16 v[64:79], v[112:115], v[108:111], v[64:79]
    v_mfma_f32_32x32x16_bf16 v[80:95], v[116:119], v[108:111], v[80:95]
    v_subrev_u32 v12, 0x10000, v12
    v_subrev_u32 v13, 0x10000, v13
    v_subrev_u32 v14, 0x10000, v14
    v_subrev_u32 v15, 0x10000, v15
    v_add_f32 v40, v40, v41
    v_add_f32 v42, v42, v43
    v_add_f32 v40, v40, v42
    v_fma_f32 v19, v19, v32, v40
    s_barrier
    s_waitcnt vmcnt(0)
    s_lshl_b32 s61, s56, 14
    v_xor_b32 v40, 0, v5
    v_add_u32 v40, s61, v40
    ds_write_b128 v40, v[128:131] offset:0
    v_xor_b32 v41, 64, v5
    v_add_u32 v41, s61, v41
    ds_write_b128 v41, v[132:135] offset:1024
    v_xor_b32 v42, 128, v5
    v_add_u32 v42, s61, v42
    ds_write_b128 v42, v[136:139] offset:2048
    v_xor_b32 v43, 192, v5
    v_add_u32 v43, s61, v43
    ds_write_b128 v43, v[140:143] offset:3072
    v_xor_b32 v40, 0, v5
    v_add_u32 v40, s61, v40
    ds_write_b128 v40, v[144:147] offset:4096
    v_xor_b32 v41, 64, v5
    v_add_u32 v41, s61, v41
    ds_write_b128 v41, v[148:151] offset:5120
    v_xor_b32 v42, 128, v5
    v_add_u32 v42, s61, v42
    ds_write_b128 v42, v[152:155] offset:6144
    v_xor_b32 v43, 192, v5
    v_add_u32 v43, s61, v43
    ds_write_b128 v43, v[156:159] offset:7168
    v_xor_b32 v40, 32, v5
    v_add_u32 v40, s61, v40
    ds_write_b128 v40, v[160:163] offset:8192
    v_xor_b32 v41, 96, v5
    v_add_u32 v41, s61, v41
    ds_write_b128 v41, v[164:167] offset:9216
    v_xor_b32 v42, 160, v5
    v_add_u32 v42, s61, v42
    ds_write_b128 v42, v[168:171] offset:10240
    v_xor_b32 v43, 224, v5
    v_add_u32 v43, s61, v43
    ds_write_b128 v43, v[172:175] offset:11264
    v_xor_b32 v40, 32, v5
    v_add_u32 v40, s61, v40
    ds_write_b128 v40, v[176:179] offset:12288
    v_xor_b32 v41, 96, v5
    v_add_u32 v41, s61, v41
    ds_write_b128 v41, v[180:183] offset:13312
    v_xor_b32 v42, 160, v5
    v_add_u32 v42, s61, v42
    ds_write_b128 v42, v[184:187] offset:14336
    v_xor_b32 v43, 224, v5
    v_add_u32 v43, s61, v43
    ds_write_b128 v43, v[188:191] offset:15360
    s_waitcnt lgkmcnt(0)
    s_barrier
    ds_read_b128 v[96:99], v8 offset:0
    ds_read_b128 v[100:103], v8 offset:16384
    ds_read_b128 v[104:107], v9 offset:0
    ds_read_b128 v[108:111], v9 offset:16384
    ds_read_b128 v[112:115], v10 offset:0
    ds_read_b128 v[116:119], v10 offset:16384
    ds_read_b128 v[120:123], v11 offset:0
    ds_read_b128 v[124:127], v11 offset:16384
    s_waitcnt lgkmcnt(7)
    v_mfma_f32_16x16x32_bf16 v[24:27], v[96:99], v[192:195], 0
    ds_read_b128 v[96:99], v8 offset:256
    s_waitcnt lgkmcnt(7)
    v_mfma_f32_16x16x32_bf16 v[28:31], v[100:103], v[192:195], 0
    ds_read_b128 v[100:103], v8 offset:16640
    s_waitcnt lgkmcnt(7)
    v_mfma_f32_16x16x32_bf16 v[24:27], v[104:107], v[196:199], v[24:27]
    ds_read_b128 v[104:107], v9 offset:256
    s_waitcnt lgkmcnt(7)
    v_mfma_f32_16x16x32_bf16 v[28:31], v[108:111], v[196:199], v[28:31]
    ds_read_b128 v[108:111], v9 offset:16640
    s_waitcnt lgkmcnt(7)
    v_mfma_f32_16x16x32_bf16 v[24:27], v[112:115], v[200:203], v[24:27]
    ds_read_b128 v[112:115], v10 offset:256
    s_waitcnt lgkmcnt(7)
    v_mfma_f32_16x16x32_bf16 v[28:31], v[116:119], v[200:203], v[28:31]
    ds_read_b128 v[116:119], v10 offset:16640
    s_waitcnt lgkmcnt(7)
    v_mfma_f32_16x16x32_bf16 v[24:27], v[120:123], v[204:207], v[24:27]
    ds_read_b128 v[120:123], v11 offset:256
    s_waitcnt lgkmcnt(7)
    v_mfma_f32_16x16x32_bf16 v[28:31], v[124:127], v[204:207], v[28:31]
    ds_read_b128 v[124:127], v11 offset:16640
    s_waitcnt lgkmcnt(7)
    v_mfma_f32_16x16x32_bf16 v[24:27], v[96:99], v[208:211], v[24:27]
    ds_read_b128 v[96:99], v8 offset:512
    s_waitcnt lgkmcnt(7)
    v_mfma_f32_16x16x32_bf16 v[28:31], v[100:103], v[208:211], v[28:31]
    ds_read_b128 v[100:103], v8 offset:16896
    s_waitcnt lgkmcnt(7)
    v_mfma_f32_16x16x32_bf16 v[24:27], v[104:107], v[212:215], v[24:27]
    ds_read_b128 v[104:107], v9 offset:512
    s_waitcnt lgkmcnt(7)
    v_mfma_f32_16x16x32_bf16 v[28:31], v[108:111], v[212:215], v[28:31]
    ds_read_b128 v[108:111], v9 offset:16896
    s_waitcnt lgkmcnt(7)
    v_mfma_f32_16x16x32_bf16 v[24:27], v[112:115], v[216:219], v[24:27]
    ds_read_b128 v[112:115], v10 offset:512
    s_waitcnt lgkmcnt(7)
    v_mfma_f32_16x16x32_bf16 v[28:31], v[116:119], v[216:219], v[28:31]
    ds_read_b128 v[116:119], v10 offset:16896
    s_waitcnt lgkmcnt(7)
    v_mfma_f32_16x16x32_bf16 v[24:27], v[120:123], v[220:223], v[24:27]
    ds_read_b128 v[120:123], v11 offset:512
    s_waitcnt lgkmcnt(7)
    v_mfma_f32_16x16x32_bf16 v[28:31], v[124:127], v[220:223], v[28:31]
    ds_read_b128 v[124:127], v11 offset:16896
    s_waitcnt lgkmcnt(7)
    v_mfma_f32_16x16x32_bf16 v[24:27], v[96:99], v[224:227], v[24:27]
    ds_read_b128 v[96:99], v8 offset:768
    s_waitcnt lgkmcnt(7)
    v_mfma_f32_16x16x32_bf16 v[28:31], v[100:103], v[224:227], v[28:31]
    ds_read_b128 v[100:103], v8 offset:17152
    s_waitcnt lgkmcnt(7)
    v_mfma_f32_16x16x32_bf16 v[24:27], v[104:107], v[228:231], v[24:27]
    ds_read_b128 v[104:107], v9 offset:768
    s_waitcnt lgkmcnt(7)
    v_mfma_f32_16x16x32_bf16 v[28:31], v[108:111], v[228:231], v[28:31]
    ds_read_b128 v[108:111], v9 offset:17152
    s_waitcnt lgkmcnt(7)
    v_mfma_f32_16x16x32_bf16 v[24:27], v[112:115], v[232:235], v[24:27]
    ds_read_b128 v[112:115], v10 offset:768
    s_waitcnt lgkmcnt(7)
    v_mfma_f32_16x16x32_bf16 v[28:31], v[116:119], v[232:235], v[28:31]
    ds_read_b128 v[116:119], v10 offset:17152
    s_waitcnt lgkmcnt(7)
    v_mfma_f32_16x16x32_bf16 v[24:27], v[120:123], v[236:239], v[24:27]
    ds_read_b128 v[120:123], v11 offset:768
    s_waitcnt lgkmcnt(7)
    v_mfma_f32_16x16x32_bf16 v[28:31], v[124:127], v[236:239], v[28:31]
    ds_read_b128 v[124:127], v11 offset:17152
    s_waitcnt lgkmcnt(7)
    v_mfma_f32_16x16x32_bf16 v[24:27], v[96:99], v[240:243], v[24:27]
    s_waitcnt lgkmcnt(6)
    v_mfma_f32_16x16x32_bf16 v[28:31], v[100:103], v[240:243], v[28:31]
    s_waitcnt lgkmcnt(5)
    v_mfma_f32_16x16x32_bf16 v[24:27], v[104:107], v[244:247], v[24:27]
    s_waitcnt lgkmcnt(4)
    v_mfma_f32_16x16x32_bf16 v[28:31], v[108:111], v[244:247], v[28:31]
    s_waitcnt lgkmcnt(3)
    v_mfma_f32_16x16x32_bf16 v[24:27], v[112:115], v[248:251], v[24:27]
    s_waitcnt lgkmcnt(2)
    v_mfma_f32_16x16x32_bf16 v[28:31], v[116:119], v[248:251], v[28:31]
    s_waitcnt lgkmcnt(1)
    v_mfma_f32_16x16x32_bf16 v[24:27], v[120:123], v[252:255], v[24:27]
    s_waitcnt lgkmcnt(0)
    v_mfma_f32_16x16x32_bf16 v[28:31], v[124:127], v[252:255], v[28:31]
    s_nop 7
    s_nop 1
    v_max3_f32 v40, v24, v25, v26
    v_max3_f32 v40, v40, v27, v28
    v_max3_f32 v40, v40, v29, v30
    v_max_f32 v40, v40, v31
    v_mov_b32 v41, v40
    s_nop 1
    v_permlane32_swap_b32 v40, v41
    s_nop 1
    v_max_f32 v40, v40, v41
    v_mov_b32 v41, v40
    s_nop 1
    v_permlane16_swap_b32 v40, v41
    s_nop 1
    v_max_f32 v40, v40, v41
    ds_write_b32 v21, v40
    s_waitcnt lgkmcnt(0)
    s_barrier
    ds_read_b128 v[40:43], v22
    ds_read_b128 v[44:47], v23
    s_waitcnt lgkmcnt(1)
    v_max3_f32 v40, v40, v41, v42
    v_max3_f32 v20, v40, v43, v20
    v_sub_f32 v24, v24, v20
    v_sub_f32 v25, v25, v20
    v_sub_f32 v26, v26, v20
    v_sub_f32 v27, v27, v20
    v_sub_f32 v28, v28, v20
    v_sub_f32 v29, v29, v20
    v_sub_f32 v30, v30, v20
    v_sub_f32 v31, v31, v20
    v_exp_f32 v24, v24
    v_exp_f32 v25, v25
    v_exp_f32 v26, v26
    v_exp_f32 v27, v27
    v_exp_f32 v28, v28
    v_exp_f32 v29, v29
    v_exp_f32 v30, v30
    v_exp_f32 v31, v31
    s_waitcnt lgkmcnt(0)
    v_max3_f32 v44, v44, v45, v46
    v_max3_f32 v44, v44, v47, v18
    v_sub_f32 v32, v18, v44
    v_exp_f32 v32, v32
    v_mov_b32 v18, v44
    v_add_f32 v40, v24, v25
    v_add_f32 v40, v40, v26
    v_add_f32 v40, v40, v27
    v_add_f32 v40, v40, v28
    v_add_f32 v40, v40, v29
    v_add_f32 v40, v40, v30
    v_add_f32 v40, v40, v31
    v_cvt_pk_bf16_f32 v48, v24, v25
    v_cvt_pk_bf16_f32 v49, v26, v27
    v_cvt_pk_bf16_f32 v50, v28, v29
    v_cvt_pk_bf16_f32 v51, v30, v31
    ds_write_b64 v17, v[48:49] offset:0
    ds_write_b64 v17, v[50:51] offset:32
    v_mov_b32 v41, v40
    s_nop 1
    v_permlane32_swap_b32 v40, v41
    s_nop 1
    v_add_f32 v40, v40, v41
    v_mov_b32 v41, v40
    s_nop 1
    v_permlane16_swap_b32 v40, v41
    s_nop 1
    v_add_f32 v40, v40, v41
    ds_write_b32 v21, v40 offset:512
    s_waitcnt lgkmcnt(0)
    s_barrier
    ds_read_b128 v[40:43], v23 offset:512
    v_mul_f32 v64, v64, v32
    v_mul_f32 v65, v65, v32
    v_mul_f32 v66, v66, v32
    v_mul_f32 v67, v67, v32
    v_mul_f32 v68, v68, v32
    v_mul_f32 v69, v69, v32
    v_mul_f32 v70, v70, v32
    v_mul_f32 v71, v71, v32
    v_mul_f32 v72, v72, v32
    v_mul_f32 v73, v73, v32
    v_mul_f32 v74, v74, v32
    v_mul_f32 v75, v75, v32
    v_mul_f32 v76, v76, v32
    v_mul_f32 v77, v77, v32
    v_mul_f32 v78, v78, v32
    v_mul_f32 v79, v79, v32
    v_mul_f32 v80, v80, v32
    v_mul_f32 v81, v81, v32
    v_mul_f32 v82, v82, v32
    v_mul_f32 v83, v83, v32
    v_mul_f32 v84, v84, v32
    v_mul_f32 v85, v85, v32
    v_mul_f32 v86, v86, v32
    v_mul_f32 v87, v87, v32
    v_mul_f32 v88, v88, v32
    v_mul_f32 v89, v89, v32
    v_mul_f32 v90, v90, v32
    v_mul_f32 v91, v91, v32
    v_mul_f32 v92, v92, v32
    v_mul_f32 v93, v93, v32
    v_mul_f32 v94, v94, v32
    v_mul_f32 v95, v95, v32
    ds_read_b128 v[96:99], v16 offset:0
    ds_read_b64_tr_b16 v[100:101], v12 offset:0
    ds_read_b64_tr_b16 v[102:103], v14 offset:0
    ds_read_b64_tr_b16 v[104:105], v13 offset:0
    ds_read_b64_tr_b16 v[106:107], v15 offset:0
    ds_read_b128 v[108:111], v16 offset:32
    ds_read_b64_tr_b16 v[112:113], v12 offset:16384
    ds_read_b64_tr_b16 v[114:115], v14 offset:16384
    ds_read_b64_tr_b16 v[116:117], v13 offset:16384
    ds_read_b64_tr_b16 v[118:119], v15 offset:16384
    s_waitcnt lgkmcnt(5)
    v_mfma_f32_32x32x16_bf16 v[64:79], v[100:103], v[96:99], v[64:79]
    v_mfma_f32_32x32x16_bf16 v[80:95], v[104:107], v[96:99], v[80:95]
    ds_read_b128 v[96:99], v16 offset:64
    ds_read_b64_tr_b16 v[100:101], v12 offset:32768
    ds_read_b64_tr_b16 v[102:103], v14 offset:32768
    ds_read_b64_tr_b16 v[104:105], v13 offset:32768
    ds_read_b64_tr_b16 v[106:107], v15 offset:32768
    s_waitcnt lgkmcnt(5)
    v_mfma_f32_32x32x16_bf16 v[64:79], v[112:115], v[108:111], v[64:79]
    v_mfma_f32_32x32x16_bf16 v[80:95], v[116:119], v[108:111], v[80:95]
    ds_read_b128 v[108:111], v16 offset:96
    ds_read_b64_tr_b16 v[112:113], v12 offset:49152
    ds_read_b64_tr_b16 v[114:115], v14 offset:49152
    ds_read_b64_tr_b16 v[116:117], v13 offset:49152
    ds_read_b64_tr_b16 v[118:119], v15 offset:49152
    s_waitcnt lgkmcnt(5)
    v_mfma_f32_32x32x16_bf16 v[64:79], v[100:103], v[96:99], v[64:79]
    v_mfma_f32_32x32x16_bf16 v[80:95], v[104:107], v[96:99], v[80:95]
    v_add_u32 v12, 0x10000, v12
    v_add_u32 v13, 0x10000, v13
    v_add_u32 v14, 0x10000, v14
    v_add_u32 v15, 0x10000, v15
    ds_read_b128 v[96:99], v16 offset:128
    ds_read_b64_tr_b16 v[100:101], v12 offset:0
    ds_read_b64_tr_b16 v[102:103], v14 offset:0
    ds_read_b64_tr_b16 v[104:105], v13 offset:0
    ds_read_b64_tr_b16 v[106:107], v15 offset:0
    s_waitcnt lgkmcnt(5)
    v_mfma_f32_32x32x16_bf16 v[64:79], v[112:115], v[108:111], v[64:79]
    v_mfma_f32_32x32x16_bf16 v[80:95], v[116:119], v[108:111], v[80:95]
    ds_read_b128 v[108:111], v16 offset:160
    ds_read_b64_tr_b16 v[112:113], v12 offset:16384
    ds_read_b64_tr_b16 v[114:115], v14 offset:16384
    ds_read_b64_tr_b16 v[116:117], v13 offset:16384
    ds_read_b64_tr_b16 v[118:119], v15 offset:16384
    s_waitcnt lgkmcnt(5)
    v_mfma_f32_32x32x16_bf16 v[64:79], v[100:103], v[96:99], v[64:79]
    v_mfma_f32_32x32x16_bf16 v[80:95], v[104:107], v[96:99], v[80:95]
    ds_read_b128 v[96:99], v16 offset:192
    ds_read_b64_tr_b16 v[100:101], v12 offset:32768
    ds_read_b64_tr_b16 v[102:103], v14 offset:32768
    ds_read_b64_tr_b16 v[104:105], v13 offset:32768
    ds_read_b64_tr_b16 v[106:107], v15 offset:32768
    s_waitcnt lgkmcnt(5)
    v_mfma_f32_32x32x16_bf16 v[64:79], v[112:115], v[108:111], v[64:79]
    v_mfma_f32_32x32x16_bf16 v[80:95], v[116:119], v[108:111], v[80:95]
    ds_read_b128 v[108:111], v16 offset:224
    ds_read_b64_tr_b16 v[112:113], v12 offset:49152
    ds_read_b64_tr_b16 v[114:115], v14 offset:49152
    ds_read_b64_tr_b16 v[116:117], v13 offset:49152
    ds_read_b64_tr_b16 v[118:119], v15 offset:49152
    s_waitcnt lgkmcnt(5)
    v_mfma_f32_32x32x16_bf16 v[64:79], v[100:103], v[96:99], v[64:79]
    v_mfma_f32_32x32x16_bf16 v[80:95], v[104:107], v[96:99], v[80:95]
    s_waitcnt lgkmcnt(0)
    v_mfma_f32_32x32x16_bf16 v[64:79], v[112:115], v[108:111], v[64:79]
    v_mfma_f32_32x32x16_bf16 v[80:95], v[116:119], v[108:111], v[80:95]
    v_subrev_u32 v12, 0x10000, v12
    v_subrev_u32 v13, 0x10000, v13
    v_subrev_u32 v14, 0x10000, v14
    v_subrev_u32 v15, 0x10000, v15
    v_add_f32 v40, v40, v41
    v_add_f32 v42, v42, v43
    v_add_f32 v40, v40, v42
    v_fma_f32 v19, v19, v32, v40
    s_barrier
    s_nop 7
    s_nop 3
    v_and_b32 v43, 31, v1
    v_lshrrev_b32 v44, 5, v1
    v_mul_u32_u24 v40, 1040, v43
    v_lshl_add_u32 v40, v44, 3, v40
    s_lshl_b32 s61, s56, 7
    v_add_u32 v40, s61, v40
    v_cvt_pk_bf16_f32 v64, v64, v65
    v_cvt_pk_bf16_f32 v65, v66, v67
    ds_write_b64 v40, v[64:65] offset:0
    v_cvt_pk_bf16_f32 v68, v68, v69
    v_cvt_pk_bf16_f32 v69, v70, v71
    ds_write_b64 v40, v[68:69] offset:16
    v_cvt_pk_bf16_f32 v72, v72, v73
    v_cvt_pk_bf16_f32 v73, v74, v75
    ds_write_b64 v40, v[72:73] offset:32
    v_cvt_pk_bf16_f32 v76, v76, v77
    v_cvt_pk_bf16_f32 v77, v78, v79
    ds_write_b64 v40, v[76:77] offset:48
    v_cvt_pk_bf16_f32 v80, v80, v81
    v_cvt_pk_bf16_f32 v81, v82, v83
    ds_write_b64 v40, v[80:81] offset:64
    v_cvt_pk_bf16_f32 v84, v84, v85
    v_cvt_pk_bf16_f32 v85, v86, v87
    ds_write_b64 v40, v[84:85] offset:80
    v_cvt_pk_bf16_f32 v88, v88, v89
    v_cvt_pk_bf16_f32 v89, v90, v91
    ds_write_b64 v40, v[88:89] offset:96
    v_cvt_pk_bf16_f32 v92, v92, v93
    v_cvt_pk_bf16_f32 v93, v94, v95
    ds_write_b64 v40, v[92:93] offset:112
    v_mov_b32 v46, v18
    v_mov_b32 v47, v19
    v_lshlrev_b32 v45, 8, v43
    s_lshl_b32 s62, s65, 3
    s_add_u32 s62, s62, 1245184
    s_cmp_lg_u32 s56, 0
    s_cbranch_scc1 Lml_38
    s_mov_b64 exec, 0xffffffff
    buffer_store_dwordx2 v[46:47], v45, s[32:35], s62 offen sc0 sc1
    s_mov_b64 exec, -1
Lml_38:
    s_waitcnt lgkmcnt(0)
    s_barrier
    s_mul_i32 s61, s56, 4160
    v_add_u32 v40, s61, v5
    ds_read_b128 v[96:99], v40 offset:0
    ds_read_b128 v[100:103], v40 offset:1040
    ds_read_b128 v[104:107], v40 offset:2080
    ds_read_b128 v[108:111], v40 offset:3120
    s_lshl_b32 s61, s65, 15
    s_lshl_b32 s62, s56, 12
    s_add_u32 s61, s61, s62
    s_add_u32 s61, s61, 2097152
    s_waitcnt lgkmcnt(3)
    buffer_store_dwordx4 v[96:99], v5, s[32:35], s61 offen offset:0 sc0 sc1
    s_waitcnt lgkmcnt(2)
    buffer_store_dwordx4 v[100:103], v5, s[32:35], s61 offen offset:1024 sc0 sc1
    s_waitcnt lgkmcnt(1)
    buffer_store_dwordx4 v[104:107], v5, s[32:35], s61 offen offset:2048 sc0 sc1
    s_waitcnt lgkmcnt(0)
    buffer_store_dwordx4 v[108:111], v5, s[32:35], s61 offen offset:3072 sc0 sc1
    s_waitcnt vmcnt(0)
    s_barrier
    s_cmp_lg_u32 s56, 0
    s_cbranch_scc1 Lpf_39
    v_lshlrev_b32 v40, 14, v1
    v_mov_b32 v41, 0
    s_lshl_b32 s61, s65, 2
    s_add_u32 s61, s61, 0
    s_mov_b64 exec, 0xffffffff
    buffer_store_dword v41, v40, s[32:35], s61 offen sc0 sc1
    s_mov_b64 exec, -1
Lpf_39:
    s_mov_b32 s36, s24
    s_mov_b32 s37, s25
    s_and_b32 s37, s37, 0xffff
    s_mov_b32 s38, 4194304
    s_mov_b32 s39, 0x00020000
    s_lshl_b32 s61, s56, 14
    s_lshl_b32 s62, s65, 17
    s_add_u32 s62, s62, s61
    s_add_u32 m0, s61, 0
    v_xor_b32 v52, 0, v5
    buffer_load_dwordx4 v52, s[36:39], s62 offen nt lds
    s_add_u32 s62, s62, 1024
    s_add_u32 m0, s61, 1024
    v_xor_b32 v53, 64, v5
    buffer_load_dwordx4 v53, s[36:39], s62 offen nt lds
    s_add_u32 s62, s62, 1024
    s_add_u32 m0, s61, 2048
    v_xor_b32 v52, 128, v5
    buffer_load_dwordx4 v52, s[36:39], s62 offen nt lds
    s_add_u32 s62, s62, 1024
    s_add_u32 m0, s61, 3072
    v_xor_b32 v53, 192, v5
    buffer_load_dwordx4 v53, s[36:39], s62 offen nt lds
    s_add_u32 s62, s62, 1024
    s_add_u32 m0, s61, 4096
    v_xor_b32 v52, 0, v5
    buffer_load_dwordx4 v52, s[36:39], s62 offen nt lds
    s_add_u32 s62, s62, 1024
    s_add_u32 m0, s61, 5120
    v_xor_b32 v53, 64, v5
    buffer_load_dwordx4 v53, s[36:39], s62 offen nt lds
    s_add_u32 s62, s62, 1024
    s_add_u32 m0, s61, 6144
    v_xor_b32 v52, 128, v5
    buffer_load_dwordx4 v52, s[36:39], s62 offen nt lds
    s_add_u32 s62, s62, 1024
    s_add_u32 m0, s61, 7168
    v_xor_b32 v53, 192, v5
    buffer_load_dwordx4 v53, s[36:39], s62 offen nt lds
    s_add_u32 s62, s62, 1024
    s_add_u32 m0, s61, 8192
    v_xor_b32 v52, 32, v5
    buffer_load_dwordx4 v52, s[36:39], s62 offen nt lds
    s_add_u32 s62, s62, 1024
    s_add_u32 m0, s61, 9216
    v_xor_b32 v53, 96, v5
    buffer_load_dwordx4 v53, s[36:39], s62 offen nt lds
    s_add_u32 s62, s62, 1024
    s_add_u32 m0, s61, 10240
    v_xor_b32 v52, 160, v5
    buffer_load_dwordx4 v52, s[36:39], s62 offen nt lds
    s_add_u32 s62, s62, 1024
    s_add_u32 m0, s61, 11264
    v_xor_b32 v53, 224, v5
    buffer_load_dwordx4 v53, s[36:39], s62 offen nt lds
    s_add_u32 s62, s62, 1024
    s_add_u32 m0, s61, 12288
    v_xor_b32 v52, 32, v5
    buffer_load_dwordx4 v52, s[36:39], s62 offen nt lds
    s_add_u32 s62, s62, 1024
    s_add_u32 m0, s61, 13312
    v_xor_b32 v53, 96, v5
    buffer_load_dwordx4 v53, s[36:39], s62 offen nt lds
    s_add_u32 s62, s62, 1024
    s_add_u32 m0, s61, 14336
    v_xor_b32 v52, 160, v5
    buffer_load_dwordx4 v52, s[36:39], s62 offen nt lds
    s_add_u32 s62, s62, 1024
    s_add_u32 m0, s61, 15360
    v_xor_b32 v53, 224, v5
    buffer_load_dwordx4 v53, s[36:39], s62 offen nt lds
    s_waitcnt vmcnt(0)
    s_barrier
    v_lshrrev_b32 v40, 2, v3
    v_and_b32 v41, 1, v2
    v_lshlrev_b32 v42, 2, v40
    v_lshl_or_b32 v42, v41, 1, v42
    v_lshl_add_u32 v43, v2, 3, v40
    v_lshlrev_b32 v43, 10, v43
    v_and_b32 v44, 1, v3
    v_lshl_add_u32 v43, v44, 3, v43
    v_bfe_u32 v44, v3, 1, 1
    s_lshl_b32 s61, s56, 3
    s_add_u32 s62, s61, 0
    v_add_u32 v45, s62, v44
    v_xor_b32 v45, v45, v42
    v_lshl_add_u32 v48, v45, 4, v43
    s_add_u32 s62, s61, 2
    v_add_u32 v45, s62, v44
    v_xor_b32 v45, v45, v42
    v_lshl_add_u32 v49, v45, 4, v43
    s_add_u32 s62, s61, 4
    v_add_u32 v45, s62, v44
    v_xor_b32 v45, v45, v42
    v_lshl_add_u32 v50, v45, 4, v43
    s_add_u32 s62, s61, 6
    v_add_u32 v45, s62, v44
    v_xor_b32 v45, v45, v42
    v_lshl_add_u32 v51, v45, 4, v43
    ds_read_b64_tr_b16 v[128:129], v48 offset:0
    ds_read_b64_tr_b16 v[130:131], v48 offset:4096
    ds_read_b64_tr_b16 v[144:145], v49 offset:0
    ds_read_b64_tr_b16 v[146:147], v49 offset:4096
    ds_read_b64_tr_b16 v[160:161], v50 offset:0
    ds_read_b64_tr_b16 v[162:163], v50 offset:4096
    ds_read_b64_tr_b16 v[176:177], v51 offset:0
    ds_read_b64_tr_b16 v[178:179], v51 offset:4096
    s_waitcnt lgkmcnt(0)
    ds_read_b64_tr_b16 v[132:133], v48 offset:32768
    ds_read_b64_tr_b16 v[134:135], v48 offset:36864
    ds_read_b64_tr_b16 v[148:149], v49 offset:32768
    ds_read_b64_tr_b16 v[150:151], v49 offset:36864
    ds_read_b64_tr_b16 v[164:165], v50 offset:32768
    ds_read_b64_tr_b16 v[166:167], v50 offset:36864
    ds_read_b64_tr_b16 v[180:181], v51 offset:32768
    ds_read_b64_tr_b16 v[182:183], v51 offset:36864
    s_waitcnt lgkmcnt(0)
    v_add_u32 v48, 0x10000, v48
    v_add_u32 v49, 0x10000, v49
    v_add_u32 v50, 0x10000, v50
    v_add_u32 v51, 0x10000, v51
    ds_read_b64_tr_b16 v[136:137], v48 offset:0
    ds_read_b64_tr_b16 v[138:139], v48 offset:4096
    ds_read_b64_tr_b16 v[152:153], v49 offset:0
    ds_read_b64_tr_b16 v[154:155], v49 offset:4096
    ds_read_b64_tr_b16 v[168:169], v50 offset:0
    ds_read_b64_tr_b16 v[170:171], v50 offset:4096
    ds_read_b64_tr_b16 v[184:185], v51 offset:0
    ds_read_b64_tr_b16 v[186:187], v51 offset:4096
    s_waitcnt lgkmcnt(0)
    ds_read_b64_tr_b16 v[140:141], v48 offset:32768
    ds_read_b64_tr_b16 v[142:143], v48 offset:36864
    ds_read_b64_tr_b16 v[156:157], v49 offset:32768
    ds_read_b64_tr_b16 v[158:159], v49 offset:36864
    ds_read_b64_tr_b16 v[172:173], v50 offset:32768
    ds_read_b64_tr_b16 v[174:175], v50 offset:36864
    ds_read_b64_tr_b16 v[188:189], v51 offset:32768
    ds_read_b64_tr_b16 v[190:191], v51 offset:36864
    s_waitcnt lgkmcnt(0)
    v_lshrrev_b32 v40, 5, v1
    v_mul_u32_u24 v41, 1536, v40
    v_and_b32 v42, 31, v1
    v_lshl_add_u32 v41, v42, 4, v41
    v_mul_u32_u24 v43, 48, v40
    s_lshl_b32 s61, s56, 9
    s_add_u32 s61, s61, 131072
    v_lshlrev_b32 v46, 3, v1
    v_add_u32 v46, s61, v46
    v_and_b32 v47, 1, v3
    v_lshlrev_b32 v47, 8, v47
    v_lshl_add_u32 v47, v2, 4, v47
    v_add_u32 v47, s61, v47
    s_mov_b32 s70, 1040356334
    s_mov_b32 s92, 0
Lpoll_41:
    buffer_load_dwordx4 v[192:195], v41, s[32:35], s93 offen offset:256 sc0 sc1
    buffer_load_dwordx2 v[204:205], v43, s[32:35], s93 offen offset:128 sc0 sc1
    buffer_load_dwordx4 v[196:199], v41, s[32:35], s93 offen offset:768 sc0 sc1
    buffer_load_dwordx2 v[206:207], v43, s[32:35], s93 offen offset:144 sc0 sc1
    buffer_load_dwordx4 v[200:203], v41, s[32:35], s93 offen offset:1280 sc0 sc1
    buffer_load_dwordx2 v[208:209], v43, s[32:35], s93 offen offset:160 sc0 sc1
    s_waitcnt vmcnt(0)
    v_mov_b32 v45, v192
    v_max3_u32 v45, v45, v193, v194
    v_max3_u32 v45, v45, v195, v196
    v_max3_u32 v45, v45, v197, v198
    v_max3_u32 v45, v45, v199, v200
    v_max3_u32 v45, v45, v201, v202
    v_max3_u32 v45, v45, v203, v204
    v_max3_u32 v45, v45, v205, v206
    v_max3_u32 v45, v45, v207, v208
    v_max_u32 v45, v45, v209
    v_cmpx_eq_u32 vcc, -1, v45
    s_cbranch_execz Lpolld_42
    s_sleep 2
    s_add_u32 s92, s92, 1
    s_cmp_lt_u32 s92, 400000
    s_cbranch_scc1 Lpoll_41
Lpolld_42:
    s_mov_b64 exec, -1
    v_max3_f32 v45, v204, v206, v208
    v_mul_f32 v44, s70, v45
    v_fma_f32 v204, v204, s70, -v44
    v_fma_f32 v206, v206, s70, -v44
    v_fma_f32 v208, v208, s70, -v44
    v_exp_f32 v204, v204
    v_exp_f32 v206, v206
    v_exp_f32 v208, v208
    s_nop 0
    v_mul_f32 v45, v204, v205
    v_fmac_f32 v45, v206, v207
    v_fmac_f32 v45, v208, v209
    v_rcp_f32 v45, v45
    v_mul_f32 v192, v192, v204
    v_mul_f32 v193, v193, v204
    v_mul_f32 v194, v194, v204
    v_mul_f32 v195, v195, v204
    v_fmac_f32 v192, v196, v206
    v_fmac_f32 v193, v197, v206
    v_fmac_f32 v194, v198, v206
    v_fmac_f32 v195, v199, v206
    v_fmac_f32 v192, v200, v208
    v_fmac_f32 v193, v201, v208
    v_fmac_f32 v194, v202, v208
    v_fmac_f32 v195, v203, v208
    v_mul_f32 v192, v192, v45
    v_mul_f32 v193, v193, v45
    v_mul_f32 v194, v194, v45
    v_mul_f32 v195, v195, v45
    v_cvt_pk_bf16_f32 v192, v192, v193
    v_cvt_pk_bf16_f32 v193, v194, v195
    ds_write_b64 v46, v[192:193]
    s_waitcnt lgkmcnt(0)
    ds_read_b128 v[24:27], v47 offset:0
    ds_read_b128 v[28:31], v47 offset:64
    ds_read_b128 v[32:35], v47 offset:128
    ds_read_b128 v[36:39], v47 offset:192
    s_waitcnt lgkmcnt(3)
    v_mfma_f32_16x16x32_bf16 v[8:11], v[24:27], v[128:131], 0
    v_mfma_f32_16x16x32_bf16 v[12:15], v[24:27], v[144:147], 0
    v_mfma_f32_16x16x32_bf16 v[16:19], v[24:27], v[160:163], 0
    v_mfma_f32_16x16x32_bf16 v[20:23], v[24:27], v[176:179], 0
    s_waitcnt lgkmcnt(2)
    v_mfma_f32_16x16x32_bf16 v[8:11], v[28:31], v[132:135], v[8:11]
    v_mfma_f32_16x16x32_bf16 v[12:15], v[28:31], v[148:151], v[12:15]
    v_mfma_f32_16x16x32_bf16 v[16:19], v[28:31], v[164:167], v[16:19]
    v_mfma_f32_16x16x32_bf16 v[20:23], v[28:31], v[180:183], v[20:23]
    s_waitcnt lgkmcnt(1)
    v_mfma_f32_16x16x32_bf16 v[8:11], v[32:35], v[136:139], v[8:11]
    v_mfma_f32_16x16x32_bf16 v[12:15], v[32:35], v[152:155], v[12:15]
    v_mfma_f32_16x16x32_bf16 v[16:19], v[32:35], v[168:171], v[16:19]
    v_mfma_f32_16x16x32_bf16 v[20:23], v[32:35], v[184:187], v[20:23]
    s_waitcnt lgkmcnt(0)
    v_mfma_f32_16x16x32_bf16 v[8:11], v[36:39], v[140:143], v[8:11]
    v_mfma_f32_16x16x32_bf16 v[12:15], v[36:39], v[156:159], v[12:15]
    v_mfma_f32_16x16x32_bf16 v[16:19], v[36:39], v[172:175], v[16:19]
    v_mfma_f32_16x16x32_bf16 v[20:23], v[36:39], v[188:191], v[20:23]
    v_lshlrev_b32 v40, 2, v3
    s_lshl_b32 s61, s56, 16
    s_lshl_b32 s62, s65, 6
    s_add_u32 s61, s61, s62
    s_add_u32 s61, s61, 3328
    s_nop 4
    s_mov_b64 exec, 0xffff
    s_add_u32 s62, s61, 0
    buffer_store_dword v8, v40, s[32:35], s62 offen sc0 sc1
    s_add_u32 s62, s61, 524288
    buffer_store_dword v9, v40, s[32:35], s62 offen sc0 sc1
    s_add_u32 s62, s61, 16384
    buffer_store_dword v12, v40, s[32:35], s62 offen sc0 sc1
    s_add_u32 s62, s61, 540672
    buffer_store_dword v13, v40, s[32:35], s62 offen sc0 sc1
    s_add_u32 s62, s61, 32768
    buffer_store_dword v16, v40, s[32:35], s62 offen sc0 sc1
    s_add_u32 s62, s61, 557056
    buffer_store_dword v17, v40, s[32:35], s62 offen sc0 sc1
    s_add_u32 s62, s61, 49152
    buffer_store_dword v20, v40, s[32:35], s62 offen sc0 sc1
    s_add_u32 s62, s61, 573440
    buffer_store_dword v21, v40, s[32:35], s62 offen sc0 sc1
    s_mov_b64 exec, -1
    s_branch L_final
L_roleT1:
    s_mov_b32 s65, s75
    s_waitcnt vmcnt(0)
    s_barrier
    s_cmp_lg_u32 s56, 1
    s_cbranch_scc1 Lsc_43
    v_mov_b32 v40, 1
    v_mov_b32 v41, 0
    s_mov_b64 s[94:95], exec
    s_mov_b64 exec, 1
    buffer_atomic_add v40, v41, s[52:55], 0 offen offset:128 sc1
    s_mov_b64 exec, s[94:95]
Lsc_43:
    s_waitcnt vmcnt(0)
    v_perm_b32 v232, v196, v192, s68
    v_perm_b32 v233, v196, v192, s69
    v_perm_b32 v234, v197, v193, s68
    v_perm_b32 v235, v197, v193, s69
    v_perm_b32 v236, v198, v194, s68
    v_perm_b32 v237, v198, v194, s69
    v_perm_b32 v238, v199, v195, s68
    v_perm_b32 v239, v199, v195, s69
    v_dot2_f32_bf16 v212, v232, v208, 0
    v_dot2_f32_bf16 v213, v233, v208, 0
    v_dot2_f32_bf16 v214, v234, v208, 0
    v_dot2_f32_bf16 v215, v235, v208, 0
    v_dot2_f32_bf16 v216, v236, v208, 0
    v_dot2_f32_bf16 v217, v237, v208, 0
    v_dot2_f32_bf16 v218, v238, v208, 0
    v_dot2_f32_bf16 v219, v239, v208, 0
    v_dot2_f32_bf16 v220, v232, v210, 0
    v_dot2_f32_bf16 v221, v233, v210, 0
    v_dot2_f32_bf16 v222, v234, v210, 0
    v_dot2_f32_bf16 v223, v235, v210, 0
    v_dot2_f32_bf16 v224, v236, v210, 0
    v_dot2_f32_bf16 v225, v237, v210, 0
    v_dot2_f32_bf16 v226, v238, v210, 0
    v_dot2_f32_bf16 v227, v239, v210, 0
    v_perm_b32 v232, v204, v200, s68
    v_perm_b32 v233, v204, v200, s69
    v_perm_b32 v234, v205, v201, s68
    v_perm_b32 v235, v205, v201, s69
    v_perm_b32 v236, v206, v202, s68
    v_perm_b32 v237, v206, v202, s69
    v_perm_b32 v238, v207, v203, s68
    v_perm_b32 v239, v207, v203, s69
    v_dot2_f32_bf16 v212, v232, v209, v212
    v_dot2_f32_bf16 v213, v233, v209, v213
    v_dot2_f32_bf16 v214, v234, v209, v214
    v_dot2_f32_bf16 v215, v235, v209, v215
    v_dot2_f32_bf16 v216, v236, v209, v216
    v_dot2_f32_bf16 v217, v237, v209, v217
    v_dot2_f32_bf16 v218, v238, v209, v218
    v_dot2_f32_bf16 v219, v239, v209, v219
    v_dot2_f32_bf16 v220, v232, v211, v220
    v_dot2_f32_bf16 v221, v233, v211, v221
    v_dot2_f32_bf16 v222, v234, v211, v222
    v_dot2_f32_bf16 v223, v235, v211, v223
    v_dot2_f32_bf16 v224, v236, v211, v224
    v_dot2_f32_bf16 v225, v237, v211, v225
    v_dot2_f32_bf16 v226, v238, v211, v226
    v_dot2_f32_bf16 v227, v239, v211, v227
    s_nop 2
    v_permlane32_swap_b32 v212, v220
    v_permlane32_swap_b32 v213, v221
    v_permlane32_swap_b32 v214, v222
    v_permlane32_swap_b32 v215, v223
    v_permlane32_swap_b32 v216, v224
    v_permlane32_swap_b32 v217, v225
    v_permlane32_swap_b32 v218, v226
    v_permlane32_swap_b32 v219, v227
    s_nop 1
    v_add_f32 v212, v212, v220
    v_add_f32 v213, v213, v221
    v_add_f32 v214, v214, v222
    v_add_f32 v215, v215, v223
    v_add_f32 v216, v216, v224
    v_add_f32 v217, v217, v225
    v_add_f32 v218, v218, v226
    v_add_f32 v219, v219, v227
    s_nop 1
    v_permlane16_swap_b32 v212, v216
    v_permlane16_swap_b32 v213, v217
    v_permlane16_swap_b32 v214, v218
    v_permlane16_swap_b32 v215, v219
    s_nop 1
    v_add_f32 v212, v212, v216
    v_add_f32 v213, v213, v217
    v_add_f32 v214, v214, v218
    v_add_f32 v215, v215, v219
    s_nop 1
    v_add_f32_dpp v212, v212, v212 row_ror:8 row_mask:0xf bank_mask:0xf
    v_add_f32_dpp v213, v213, v213 row_ror:8 row_mask:0xf bank_mask:0xf
    v_add_f32_dpp v214, v214, v214 row_ror:8 row_mask:0xf bank_mask:0xf
    v_add_f32_dpp v215, v215, v215 row_ror:8 row_mask:0xf bank_mask:0xf
    v_lshrrev_b32 v232, 5, v228
    v_lshlrev_b32 v232, 8, v232
    v_bfe_u32 v233, v228, 4, 1
    v_lshl_add_u32 v232, v233, 4, v232
    v_lshl_add_u32 v232, v230, 5, v232
    s_lshl_b32 s61, s56, 9
    s_add_u32 s61, s61, 131072
    v_add_u32 v232, s61, v232
    ds_write_b128 v232, v[212:215]
    s_waitcnt lgkmcnt(0)
    s_barrier
    s_cmp_eq_u32 s56, 0
    s_cbranch_scc1 Ls1p0_45
    s_mov_b32 s44, s10
    s_mov_b32 s45, s11
    s_and_b32 s45, s45, 0xffff
    s_mov_b32 s46, 4194304
    s_mov_b32 s47, 0x00020000
    s_lshl_b32 s61, s56, 19
    s_lshl_b32 s62, s65, 8
    s_add_u32 s61, s61, s62
    buffer_load_dwordx4 v[128:131], v4, s[44:47], s61 offen nt
    s_add_u32 s61, s61, 8192
    buffer_load_dwordx4 v[132:135], v4, s[44:47], s61 offen nt
    s_add_u32 s61, s61, 8192
    buffer_load_dwordx4 v[136:139], v4, s[44:47], s61 offen nt
    s_add_u32 s61, s61, 8192
    buffer_load_dwordx4 v[140:143], v4, s[44:47], s61 offen nt
    s_add_u32 s61, s61, 8192
    buffer_load_dwordx4 v[144:147], v4, s[44:47], s61 offen nt
    s_add_u32 s61, s61, 8192
    buffer_load_dwordx4 v[148:151], v4, s[44:47], s61 offen nt
    s_add_u32 s61, s61, 8192
    buffer_load_dwordx4 v[152:155], v4, s[44:47], s61 offen nt
    s_add_u32 s61, s61, 8192
    buffer_load_dwordx4 v[156:159], v4, s[44:47], s61 offen nt
    s_add_u32 s61, s61, 8192
    buffer_load_dwordx4 v[160:163], v4, s[44:47], s61 offen nt
    s_add_u32 s61, s61, 8192
    buffer_load_dwordx4 v[164:167], v4, s[44:47], s61 offen nt
    s_add_u32 s61, s61, 8192
    buffer_load_dwordx4 v[168:171], v4, s[44:47], s61 offen nt
    s_add_u32 s61, s61, 8192
    buffer_load_dwordx4 v[172:175], v4, s[44:47], s61 offen nt
    s_add_u32 s61, s61, 8192
    buffer_load_dwordx4 v[176:179], v4, s[44:47], s61 offen nt
    s_add_u32 s61, s61, 8192
    buffer_load_dwordx4 v[180:183], v4, s[44:47], s61 offen nt
    s_add_u32 s61, s61, 8192
    buffer_load_dwordx4 v[184:187], v4, s[44:47], s61 offen nt
    s_add_u32 s61, s61, 8192
    buffer_load_dwordx4 v[188:191], v4, s[44:47], s61 offen nt
    s_branch Ls1p_44
Ls1p0_45:
    v_mov_b32 v234, 0
    buffer_load_dword v235, v234, s[52:55], s91 offen offset:0 sc0 sc1
    v_and_b32 v232, 31, v228
    v_lshlrev_b32 v233, 4, v232
    v_add_u32 v233, 131072, v233
    ds_read_b128 v[192:195], v233 offset:0
    ds_read_b128 v[196:199], v233 offset:512
    ds_read_b128 v[200:203], v233 offset:1024
    ds_read_b128 v[204:207], v233 offset:1536
    ds_read_b128 v[208:211], v233 offset:2048
    ds_read_b128 v[212:215], v233 offset:2560
    ds_read_b128 v[216:219], v233 offset:3072
    ds_read_b128 v[220:223], v233 offset:3584
    s_waitcnt lgkmcnt(6)
    v_add_f32 v192, v192, v196
    v_add_f32 v193, v193, v197
    v_add_f32 v194, v194, v198
    v_add_f32 v195, v195, v199
    s_waitcnt lgkmcnt(5)
    v_add_f32 v192, v192, v200
    v_add_f32 v193, v193, v201
    v_add_f32 v194, v194, v202
    v_add_f32 v195, v195, v203
    s_waitcnt lgkmcnt(4)
    v_add_f32 v192, v192, v204
    v_add_f32 v193, v193, v205
    v_add_f32 v194, v194, v206
    v_add_f32 v195, v195, v207
    s_waitcnt lgkmcnt(3)
    v_add_f32 v192, v192, v208
    v_add_f32 v193, v193, v209
    v_add_f32 v194, v194, v210
    v_add_f32 v195, v195, v211
    s_waitcnt lgkmcnt(2)
    v_add_f32 v192, v192, v212
    v_add_f32 v193, v193, v213
    v_add_f32 v194, v194, v214
    v_add_f32 v195, v195, v215
    s_waitcnt lgkmcnt(1)
    v_add_f32 v192, v192, v216
    v_add_f32 v193, v193, v217
    v_add_f32 v194, v194, v218
    v_add_f32 v195, v195, v219
    s_waitcnt lgkmcnt(0)
    v_add_f32 v192, v192, v220
    v_add_f32 v193, v193, v221
    v_add_f32 v194, v194, v222
    v_add_f32 v195, v195, v223
    v_lshrrev_b32 v233, 4, v232
    v_lshlrev_b32 v233, 10, v233
    v_and_b32 v232, 15, v232
    v_lshl_add_u32 v233, v232, 4, v233
    s_waitcnt vmcnt(0)
    s_mov_b32 s92, 0
Lcf_46:
    v_readfirstlane_b32 s57, v235
    s_nop 3
    s_cmp_lg_u32 s57, 0
    s_cbranch_scc1 Lcfd_47
    s_sleep 2
    buffer_load_dword v235, v234, s[52:55], s91 offen offset:0 sc0 sc1
    s_waitcnt vmcnt(0)
    s_add_u32 s92, s92, 1
    s_cmp_lt_u32 s92, 400000
    s_cbranch_scc1 Lcf_46
Lcfd_47:
    s_mov_b64 exec, 0xffffffff
    buffer_store_dwordx4 v[192:195], v233, s[32:35], s3 offen sc0 sc1
    s_mov_b64 exec, -1
    s_mov_b32 s44, s10
    s_mov_b32 s45, s11
    s_and_b32 s45, s45, 0xffff
    s_mov_b32 s46, 4194304
    s_mov_b32 s47, 0x00020000
    s_lshl_b32 s61, s56, 19
    s_lshl_b32 s62, s65, 8
    s_add_u32 s61, s61, s62
    buffer_load_dwordx4 v[128:131], v4, s[44:47], s61 offen nt
    s_add_u32 s61, s61, 8192
    buffer_load_dwordx4 v[132:135], v4, s[44:47], s61 offen nt
    s_add_u32 s61, s61, 8192
    buffer_load_dwordx4 v[136:139], v4, s[44:47], s61 offen nt
    s_add_u32 s61, s61, 8192
    buffer_load_dwordx4 v[140:143], v4, s[44:47], s61 offen nt
    s_add_u32 s61, s61, 8192
    buffer_load_dwordx4 v[144:147], v4, s[44:47], s61 offen nt
    s_add_u32 s61, s61, 8192
    buffer_load_dwordx4 v[148:151], v4, s[44:47], s61 offen nt
    s_add_u32 s61, s61, 8192
    buffer_load_dwordx4 v[152:155], v4, s[44:47], s61 offen nt
    s_add_u32 s61, s61, 8192
    buffer_load_dwordx4 v[156:159], v4, s[44:47], s61 offen nt
    s_add_u32 s61, s61, 8192
    buffer_load_dwordx4 v[160:163], v4, s[44:47], s61 offen nt
    s_add_u32 s61, s61, 8192
    buffer_load_dwordx4 v[164:167], v4, s[44:47], s61 offen nt
    s_add_u32 s61, s61, 8192
    buffer_load_dwordx4 v[168:171], v4, s[44:47], s61 offen nt
    s_add_u32 s61, s61, 8192
    buffer_load_dwordx4 v[172:175], v4, s[44:47], s61 offen nt
    s_add_u32 s61, s61, 8192
    buffer_load_dwordx4 v[176:179], v4, s[44:47], s61 offen nt
    s_add_u32 s61, s61, 8192
    buffer_load_dwordx4 v[180:183], v4, s[44:47], s61 offen nt
    s_add_u32 s61, s61, 8192
    buffer_load_dwordx4 v[184:187], v4, s[44:47], s61 offen nt
    s_add_u32 s61, s61, 8192
    buffer_load_dwordx4 v[188:191], v4, s[44:47], s61 offen nt
    v_lshlrev_b32 v40, 4, v1
    s_lshl_b32 s61, s65, 11
    s_add_u32 s61, s61, 1310720
    s_mov_b32 s92, 0
Lpoll_48:
    buffer_load_dwordx4 v[24:27], v40, s[32:35], s61 offen offset:0 sc0 sc1
    buffer_load_dwordx4 v[32:35], v40, s[32:35], s61 offen offset:1024 sc0 sc1
    s_waitcnt vmcnt(0)
    v_mov_b32 v41, v24
    v_max3_u32 v41, v41, v25, v26
    v_max3_u32 v41, v41, v27, v32
    v_max3_u32 v41, v41, v33, v34
    v_max_u32 v41, v41, v35
    v_cmpx_eq_u32 vcc, -1, v41
    s_cbranch_execz Lpolld_49
    s_sleep 4
    s_add_u32 s92, s92, 1
    s_cmp_lt_u32 s92, 400000
    s_cbranch_scc1 Lpoll_48
Lpolld_49:
    s_mov_b64 exec, -1
    v_mov_b32 v28, v24
    v_mov_b32 v29, v25
    v_mov_b32 v30, v26
    v_mov_b32 v31, v27
    v_mov_b32 v36, v32
    v_mov_b32 v37, v33
    v_mov_b32 v38, v34
    v_mov_b32 v39, v35
    s_nop 1
    v_permlane32_swap_b32 v24, v28
    v_permlane32_swap_b32 v25, v29
    v_permlane32_swap_b32 v26, v30
    v_permlane32_swap_b32 v27, v31
    v_permlane32_swap_b32 v32, v36
    v_permlane32_swap_b32 v33, v37
    v_permlane32_swap_b32 v34, v38
    v_permlane32_swap_b32 v35, v39
    s_nop 1
    v_add_f32 v24, v24, v28
    v_add_f32 v25, v25, v29
    v_add_f32 v26, v26, v30
    v_add_f32 v27, v27, v31
    v_cvt_pk_bf16_f32 v24, v24, v25
    v_cvt_pk_bf16_f32 v25, v26, v27
    v_add_f32 v32, v32, v36
    v_add_f32 v33, v33, v37
    v_add_f32 v34, v34, v38
    v_add_f32 v35, v35, v39
    v_cvt_pk_bf16_f32 v32, v32, v33
    v_cvt_pk_bf16_f32 v33, v34, v35
    v_mov_b32 v46, 0
    s_mov_b32 s92, 0
Lcf_50:
    buffer_load_dword v47, v46, s[52:55], 0 offen offset:128 sc0 sc1
    s_waitcnt vmcnt(0)
    v_readfirstlane_b32 s57, v47
    s_nop 3
    s_cmp_ge_u32 s57, 64
    s_cbranch_scc1 Lcfd_51
    s_sleep 16
    s_add_u32 s92, s92, 1
    s_cmp_lt_u32 s92, 400000
    s_cbranch_scc1 Lcf_50
Lcfd_51:
    v_and_b32 v42, 31, v1
    v_lshlrev_b32 v42, 3, v42
    v_add_u32 v42, 135168, v42
    ds_write_b64 v42, v[24:25] offset:0
    ds_write_b64 v42, v[32:33] offset:256
    s_waitcnt lgkmcnt(0)
Ls1p_44:
    s_barrier
    v_lshlrev_b32 v40, 4, v3
    v_add_u32 v40, 135168, v40
    ds_read_b128 v[56:59], v40
    ds_read_b128 v[60:63], v40 offset:256
    s_waitcnt lgkmcnt(0)
    s_waitcnt vmcnt(15)
    v_dot2_f32_bf16 v192, v128, v56, 0
    v_dot2_f32_bf16 v192, v129, v57, v192
    v_dot2_f32_bf16 v192, v130, v58, v192
    v_dot2_f32_bf16 v192, v131, v59, v192
    v_dot2_f32_bf16 v208, v128, v60, 0
    v_dot2_f32_bf16 v208, v129, v61, v208
    v_dot2_f32_bf16 v208, v130, v62, v208
    v_dot2_f32_bf16 v208, v131, v63, v208
    s_waitcnt vmcnt(14)
    v_dot2_f32_bf16 v193, v132, v56, 0
    v_dot2_f32_bf16 v193, v133, v57, v193
    v_dot2_f32_bf16 v193, v134, v58, v193
    v_dot2_f32_bf16 v193, v135, v59, v193
    v_dot2_f32_bf16 v209, v132, v60, 0
    v_dot2_f32_bf16 v209, v133, v61, v209
    v_dot2_f32_bf16 v209, v134, v62, v209
    v_dot2_f32_bf16 v209, v135, v63, v209
    s_waitcnt vmcnt(13)
    v_dot2_f32_bf16 v194, v136, v56, 0
    v_dot2_f32_bf16 v194, v137, v57, v194
    v_dot2_f32_bf16 v194, v138, v58, v194
    v_dot2_f32_bf16 v194, v139, v59, v194
    v_dot2_f32_bf16 v210, v136, v60, 0
    v_dot2_f32_bf16 v210, v137, v61, v210
    v_dot2_f32_bf16 v210, v138, v62, v210
    v_dot2_f32_bf16 v210, v139, v63, v210
    s_waitcnt vmcnt(12)
    v_dot2_f32_bf16 v195, v140, v56, 0
    v_dot2_f32_bf16 v195, v141, v57, v195
    v_dot2_f32_bf16 v195, v142, v58, v195
    v_dot2_f32_bf16 v195, v143, v59, v195
    v_dot2_f32_bf16 v211, v140, v60, 0
    v_dot2_f32_bf16 v211, v141, v61, v211
    v_dot2_f32_bf16 v211, v142, v62, v211
    v_dot2_f32_bf16 v211, v143, v63, v211
    s_waitcnt vmcnt(11)
    v_dot2_f32_bf16 v196, v144, v56, 0
    v_dot2_f32_bf16 v196, v145, v57, v196
    v_dot2_f32_bf16 v196, v146, v58, v196
    v_dot2_f32_bf16 v196, v147, v59, v196
    v_dot2_f32_bf16 v212, v144, v60, 0
    v_dot2_f32_bf16 v212, v145, v61, v212
    v_dot2_f32_bf16 v212, v146, v62, v212
    v_dot2_f32_bf16 v212, v147, v63, v212
    s_waitcnt vmcnt(10)
    v_dot2_f32_bf16 v197, v148, v56, 0
    v_dot2_f32_bf16 v197, v149, v57, v197
    v_dot2_f32_bf16 v197, v150, v58, v197
    v_dot2_f32_bf16 v197, v151, v59, v197
    v_dot2_f32_bf16 v213, v148, v60, 0
    v_dot2_f32_bf16 v213, v149, v61, v213
    v_dot2_f32_bf16 v213, v150, v62, v213
    v_dot2_f32_bf16 v213, v151, v63, v213
    s_waitcnt vmcnt(9)
    v_dot2_f32_bf16 v198, v152, v56, 0
    v_dot2_f32_bf16 v198, v153, v57, v198
    v_dot2_f32_bf16 v198, v154, v58, v198
    v_dot2_f32_bf16 v198, v155, v59, v198
    v_dot2_f32_bf16 v214, v152, v60, 0
    v_dot2_f32_bf16 v214, v153, v61, v214
    v_dot2_f32_bf16 v214, v154, v62, v214
    v_dot2_f32_bf16 v214, v155, v63, v214
    s_waitcnt vmcnt(8)
    v_dot2_f32_bf16 v199, v156, v56, 0
    v_dot2_f32_bf16 v199, v157, v57, v199
    v_dot2_f32_bf16 v199, v158, v58, v199
    v_dot2_f32_bf16 v199, v159, v59, v199
    v_dot2_f32_bf16 v215, v156, v60, 0
    v_dot2_f32_bf16 v215, v157, v61, v215
    v_dot2_f32_bf16 v215, v158, v62, v215
    v_dot2_f32_bf16 v215, v159, v63, v215
    s_waitcnt vmcnt(7)
    v_dot2_f32_bf16 v200, v160, v56, 0
    v_dot2_f32_bf16 v200, v161, v57, v200
    v_dot2_f32_bf16 v200, v162, v58, v200
    v_dot2_f32_bf16 v200, v163, v59, v200
    v_dot2_f32_bf16 v216, v160, v60, 0
    v_dot2_f32_bf16 v216, v161, v61, v216
    v_dot2_f32_bf16 v216, v162, v62, v216
    v_dot2_f32_bf16 v216, v163, v63, v216
    s_waitcnt vmcnt(6)
    v_dot2_f32_bf16 v201, v164, v56, 0
    v_dot2_f32_bf16 v201, v165, v57, v201
    v_dot2_f32_bf16 v201, v166, v58, v201
    v_dot2_f32_bf16 v201, v167, v59, v201
    v_dot2_f32_bf16 v217, v164, v60, 0
    v_dot2_f32_bf16 v217, v165, v61, v217
    v_dot2_f32_bf16 v217, v166, v62, v217
    v_dot2_f32_bf16 v217, v167, v63, v217
    s_waitcnt vmcnt(5)
    v_dot2_f32_bf16 v202, v168, v56, 0
    v_dot2_f32_bf16 v202, v169, v57, v202
    v_dot2_f32_bf16 v202, v170, v58, v202
    v_dot2_f32_bf16 v202, v171, v59, v202
    v_dot2_f32_bf16 v218, v168, v60, 0
    v_dot2_f32_bf16 v218, v169, v61, v218
    v_dot2_f32_bf16 v218, v170, v62, v218
    v_dot2_f32_bf16 v218, v171, v63, v218
    s_waitcnt vmcnt(4)
    v_dot2_f32_bf16 v203, v172, v56, 0
    v_dot2_f32_bf16 v203, v173, v57, v203
    v_dot2_f32_bf16 v203, v174, v58, v203
    v_dot2_f32_bf16 v203, v175, v59, v203
    v_dot2_f32_bf16 v219, v172, v60, 0
    v_dot2_f32_bf16 v219, v173, v61, v219
    v_dot2_f32_bf16 v219, v174, v62, v219
    v_dot2_f32_bf16 v219, v175, v63, v219
    s_waitcnt vmcnt(3)
    v_dot2_f32_bf16 v204, v176, v56, 0
    v_dot2_f32_bf16 v204, v177, v57, v204
    v_dot2_f32_bf16 v204, v178, v58, v204
    v_dot2_f32_bf16 v204, v179, v59, v204
    v_dot2_f32_bf16 v220, v176, v60, 0
    v_dot2_f32_bf16 v220, v177, v61, v220
    v_dot2_f32_bf16 v220, v178, v62, v220
    v_dot2_f32_bf16 v220, v179, v63, v220
    s_waitcnt vmcnt(2)
    v_dot2_f32_bf16 v205, v180, v56, 0
    v_dot2_f32_bf16 v205, v181, v57, v205
    v_dot2_f32_bf16 v205, v182, v58, v205
    v_dot2_f32_bf16 v205, v183, v59, v205
    v_dot2_f32_bf16 v221, v180, v60, 0
    v_dot2_f32_bf16 v221, v181, v61, v221
    v_dot2_f32_bf16 v221, v182, v62, v221
    v_dot2_f32_bf16 v221, v183, v63, v221
    s_waitcnt vmcnt(1)
    v_dot2_f32_bf16 v206, v184, v56, 0
    v_dot2_f32_bf16 v206, v185, v57, v206
    v_dot2_f32_bf16 v206, v186, v58, v206
    v_dot2_f32_bf16 v206, v187, v59, v206
    v_dot2_f32_bf16 v222, v184, v60, 0
    v_dot2_f32_bf16 v222, v185, v61, v222
    v_dot2_f32_bf16 v222, v186, v62, v222
    v_dot2_f32_bf16 v222, v187, v63, v222
    s_waitcnt vmcnt(0)
    v_dot2_f32_bf16 v207, v188, v56, 0
    v_dot2_f32_bf16 v207, v189, v57, v207
    v_dot2_f32_bf16 v207, v190, v58, v207
    v_dot2_f32_bf16 v207, v191, v59, v207
    v_dot2_f32_bf16 v223, v188, v60, 0
    v_dot2_f32_bf16 v223, v189, v61, v223
    v_dot2_f32_bf16 v223, v190, v62, v223
    v_dot2_f32_bf16 v223, v191, v63, v223
    s_nop 2
    v_add_f32_dpp v192, v192, v192 row_ror:8 row_mask:0xf bank_mask:0xf
    v_add_f32_dpp v193, v193, v193 row_ror:8 row_mask:0xf bank_mask:0xf
    v_add_f32_dpp v194, v194, v194 row_ror:8 row_mask:0xf bank_mask:0xf
    v_add_f32_dpp v195, v195, v195 row_ror:8 row_mask:0xf bank_mask:0xf
    v_add_f32_dpp v196, v196, v196 row_ror:8 row_mask:0xf bank_mask:0xf
    v_add_f32_dpp v197, v197, v197 row_ror:8 row_mask:0xf bank_mask:0xf
    v_add_f32_dpp v198, v198, v198 row_ror:8 row_mask:0xf bank_mask:0xf
    v_add_f32_dpp v199, v199, v199 row_ror:8 row_mask:0xf bank_mask:0xf
    v_add_f32_dpp v200, v200, v200 row_ror:8 row_mask:0xf bank_mask:0xf
    v_add_f32_dpp v201, v201, v201 row_ror:8 row_mask:0xf bank_mask:0xf
    v_add_f32_dpp v202, v202, v202 row_ror:8 row_mask:0xf bank_mask:0xf
    v_add_f32_dpp v203, v203, v203 row_ror:8 row_mask:0xf bank_mask:0xf
    v_add_f32_dpp v204, v204, v204 row_ror:8 row_mask:0xf bank_mask:0xf
    v_add_f32_dpp v205, v205, v205 row_ror:8 row_mask:0xf bank_mask:0xf
    v_add_f32_dpp v206, v206, v206 row_ror:8 row_mask:0xf bank_mask:0xf
    v_add_f32_dpp v207, v207, v207 row_ror:8 row_mask:0xf bank_mask:0xf
    v_add_f32_dpp v208, v208, v208 row_ror:8 row_mask:0xf bank_mask:0xf
    v_add_f32_dpp v209, v209, v209 row_ror:8 row_mask:0xf bank_mask:0xf
    v_add_f32_dpp v210, v210, v210 row_ror:8 row_mask:0xf bank_mask:0xf
    v_add_f32_dpp v211, v211, v211 row_ror:8 row_mask:0xf bank_mask:0xf
    v_add_f32_dpp v212, v212, v212 row_ror:8 row_mask:0xf bank_mask:0xf
    v_add_f32_dpp v213, v213, v213 row_ror:8 row_mask:0xf bank_mask:0xf
    v_add_f32_dpp v214, v214, v214 row_ror:8 row_mask:0xf bank_mask:0xf
    v_add_f32_dpp v215, v215, v215 row_ror:8 row_mask:0xf bank_mask:0xf
    v_add_f32_dpp v216, v216, v216 row_ror:8 row_mask:0xf bank_mask:0xf
    v_add_f32_dpp v217, v217, v217 row_ror:8 row_mask:0xf bank_mask:0xf
    v_add_f32_dpp v218, v218, v218 row_ror:8 row_mask:0xf bank_mask:0xf
    v_add_f32_dpp v219, v219, v219 row_ror:8 row_mask:0xf bank_mask:0xf
    v_add_f32_dpp v220, v220, v220 row_ror:8 row_mask:0xf bank_mask:0xf
    v_add_f32_dpp v221, v221, v221 row_ror:8 row_mask:0xf bank_mask:0xf
    v_add_f32_dpp v222, v222, v222 row_ror:8 row_mask:0xf bank_mask:0xf
    v_add_f32_dpp v223, v223, v223 row_ror:8 row_mask:0xf bank_mask:0xf
    v_add_f32_dpp v192, v192, v192 row_ror:4 row_mask:0xf bank_mask:0xf
    v_add_f32_dpp v193, v193, v193 row_ror:4 row_mask:0xf bank_mask:0xf
    v_add_f32_dpp v194, v194, v194 row_ror:4 row_mask:0xf bank_mask:0xf
    v_add_f32_dpp v195, v195, v195 row_ror:4 row_mask:0xf bank_mask:0xf
    v_add_f32_dpp v196, v196, v196 row_ror:4 row_mask:0xf bank_mask:0xf
    v_add_f32_dpp v197, v197, v197 row_ror:4 row_mask:0xf bank_mask:0xf
    v_add_f32_dpp v198, v198, v198 row_ror:4 row_mask:0xf bank_mask:0xf
    v_add_f32_dpp v199, v199, v199 row_ror:4 row_mask:0xf bank_mask:0xf
    v_add_f32_dpp v200, v200, v200 row_ror:4 row_mask:0xf bank_mask:0xf
    v_add_f32_dpp v201, v201, v201 row_ror:4 row_mask:0xf bank_mask:0xf
    v_add_f32_dpp v202, v202, v202 row_ror:4 row_mask:0xf bank_mask:0xf
    v_add_f32_dpp v203, v203, v203 row_ror:4 row_mask:0xf bank_mask:0xf
    v_add_f32_dpp v204, v204, v204 row_ror:4 row_mask:0xf bank_mask:0xf
    v_add_f32_dpp v205, v205, v205 row_ror:4 row_mask:0xf bank_mask:0xf
    v_add_f32_dpp v206, v206, v206 row_ror:4 row_mask:0xf bank_mask:0xf
    v_add_f32_dpp v207, v207, v207 row_ror:4 row_mask:0xf bank_mask:0xf
    v_add_f32_dpp v208, v208, v208 row_ror:4 row_mask:0xf bank_mask:0xf
    v_add_f32_dpp v209, v209, v209 row_ror:4 row_mask:0xf bank_mask:0xf
    v_add_f32_dpp v210, v210, v210 row_ror:4 row_mask:0xf bank_mask:0xf
    v_add_f32_dpp v211, v211, v211 row_ror:4 row_mask:0xf bank_mask:0xf
    v_add_f32_dpp v212, v212, v212 row_ror:4 row_mask:0xf bank_mask:0xf
    v_add_f32_dpp v213, v213, v213 row_ror:4 row_mask:0xf bank_mask:0xf
    v_add_f32_dpp v214, v214, v214 row_ror:4 row_mask:0xf bank_mask:0xf
    v_add_f32_dpp v215, v215, v215 row_ror:4 row_mask:0xf bank_mask:0xf
    v_add_f32_dpp v216, v216, v216 row_ror:4 row_mask:0xf bank_mask:0xf
    v_add_f32_dpp v217, v217, v217 row_ror:4 row_mask:0xf bank_mask:0xf
    v_add_f32_dpp v218, v218, v218 row_ror:4 row_mask:0xf bank_mask:0xf
    v_add_f32_dpp v219, v219, v219 row_ror:4 row_mask:0xf bank_mask:0xf
    v_add_f32_dpp v220, v220, v220 row_ror:4 row_mask:0xf bank_mask:0xf
    v_add_f32_dpp v221, v221, v221 row_ror:4 row_mask:0xf bank_mask:0xf
    v_add_f32_dpp v222, v222, v222 row_ror:4 row_mask:0xf bank_mask:0xf
    v_add_f32_dpp v223, v223, v223 row_ror:4 row_mask:0xf bank_mask:0xf
    v_add_f32_dpp v192, v192, v192 row_ror:2 row_mask:0xf bank_mask:0xf
    v_add_f32_dpp v193, v193, v193 row_ror:2 row_mask:0xf bank_mask:0xf
    v_add_f32_dpp v194, v194, v194 row_ror:2 row_mask:0xf bank_mask:0xf
    v_add_f32_dpp v195, v195, v195 row_ror:2 row_mask:0xf bank_mask:0xf
    v_add_f32_dpp v196, v196, v196 row_ror:2 row_mask:0xf bank_mask:0xf
    v_add_f32_dpp v197, v197, v197 row_ror:2 row_mask:0xf bank_mask:0xf
    v_add_f32_dpp v198, v198, v198 row_ror:2 row_mask:0xf bank_mask:0xf
    v_add_f32_dpp v199, v199, v199 row_ror:2 row_mask:0xf bank_mask:0xf
    v_add_f32_dpp v200, v200, v200 row_ror:2 row_mask:0xf bank_mask:0xf
    v_add_f32_dpp v201, v201, v201 row_ror:2 row_mask:0xf bank_mask:0xf
    v_add_f32_dpp v202, v202, v202 row_ror:2 row_mask:0xf bank_mask:0xf
    v_add_f32_dpp v203, v203, v203 row_ror:2 row_mask:0xf bank_mask:0xf
    v_add_f32_dpp v204, v204, v204 row_ror:2 row_mask:0xf bank_mask:0xf
    v_add_f32_dpp v205, v205, v205 row_ror:2 row_mask:0xf bank_mask:0xf
    v_add_f32_dpp v206, v206, v206 row_ror:2 row_mask:0xf bank_mask:0xf
    v_add_f32_dpp v207, v207, v207 row_ror:2 row_mask:0xf bank_mask:0xf
    v_add_f32_dpp v208, v208, v208 row_ror:2 row_mask:0xf bank_mask:0xf
    v_add_f32_dpp v209, v209, v209 row_ror:2 row_mask:0xf bank_mask:0xf
    v_add_f32_dpp v210, v210, v210 row_ror:2 row_mask:0xf bank_mask:0xf
    v_add_f32_dpp v211, v211, v211 row_ror:2 row_mask:0xf bank_mask:0xf
    v_add_f32_dpp v212, v212, v212 row_ror:2 row_mask:0xf bank_mask:0xf
    v_add_f32_dpp v213, v213, v213 row_ror:2 row_mask:0xf bank_mask:0xf
    v_add_f32_dpp v214, v214, v214 row_ror:2 row_mask:0xf bank_mask:0xf
    v_add_f32_dpp v215, v215, v215 row_ror:2 row_mask:0xf bank_mask:0xf
    v_add_f32_dpp v216, v216, v216 row_ror:2 row_mask:0xf bank_mask:0xf
    v_add_f32_dpp v217, v217, v217 row_ror:2 row_mask:0xf bank_mask:0xf
    v_add_f32_dpp v218, v218, v218 row_ror:2 row_mask:0xf bank_mask:0xf
    v_add_f32_dpp v219, v219, v219 row_ror:2 row_mask:0xf bank_mask:0xf
    v_add_f32_dpp v220, v220, v220 row_ror:2 row_mask:0xf bank_mask:0xf
    v_add_f32_dpp v221, v221, v221 row_ror:2 row_mask:0xf bank_mask:0xf
    v_add_f32_dpp v222, v222, v222 row_ror:2 row_mask:0xf bank_mask:0xf
    v_add_f32_dpp v223, v223, v223 row_ror:2 row_mask:0xf bank_mask:0xf
    v_add_f32_dpp v192, v192, v192 row_ror:1 row_mask:0xf bank_mask:0xf
    v_add_f32_dpp v193, v193, v193 row_ror:1 row_mask:0xf bank_mask:0xf
    v_add_f32_dpp v194, v194, v194 row_ror:1 row_mask:0xf bank_mask:0xf
    v_add_f32_dpp v195, v195, v195 row_ror:1 row_mask:0xf bank_mask:0xf
    v_add_f32_dpp v196, v196, v196 row_ror:1 row_mask:0xf bank_mask:0xf
    v_add_f32_dpp v197, v197, v197 row_ror:1 row_mask:0xf bank_mask:0xf
    v_add_f32_dpp v198, v198, v198 row_ror:1 row_mask:0xf bank_mask:0xf
    v_add_f32_dpp v199, v199, v199 row_ror:1 row_mask:0xf bank_mask:0xf
    v_add_f32_dpp v200, v200, v200 row_ror:1 row_mask:0xf bank_mask:0xf
    v_add_f32_dpp v201, v201, v201 row_ror:1 row_mask:0xf bank_mask:0xf
    v_add_f32_dpp v202, v202, v202 row_ror:1 row_mask:0xf bank_mask:0xf
    v_add_f32_dpp v203, v203, v203 row_ror:1 row_mask:0xf bank_mask:0xf
    v_add_f32_dpp v204, v204, v204 row_ror:1 row_mask:0xf bank_mask:0xf
    v_add_f32_dpp v205, v205, v205 row_ror:1 row_mask:0xf bank_mask:0xf
    v_add_f32_dpp v206, v206, v206 row_ror:1 row_mask:0xf bank_mask:0xf
    v_add_f32_dpp v207, v207, v207 row_ror:1 row_mask:0xf bank_mask:0xf
    v_add_f32_dpp v208, v208, v208 row_ror:1 row_mask:0xf bank_mask:0xf
    v_add_f32_dpp v209, v209, v209 row_ror:1 row_mask:0xf bank_mask:0xf
    v_add_f32_dpp v210, v210, v210 row_ror:1 row_mask:0xf bank_mask:0xf
    v_add_f32_dpp v211, v211, v211 row_ror:1 row_mask:0xf bank_mask:0xf
    v_add_f32_dpp v212, v212, v212 row_ror:1 row_mask:0xf bank_mask:0xf
    v_add_f32_dpp v213, v213, v213 row_ror:1 row_mask:0xf bank_mask:0xf
    v_add_f32_dpp v214, v214, v214 row_ror:1 row_mask:0xf bank_mask:0xf
    v_add_f32_dpp v215, v215, v215 row_ror:1 row_mask:0xf bank_mask:0xf
    v_add_f32_dpp v216, v216, v216 row_ror:1 row_mask:0xf bank_mask:0xf
    v_add_f32_dpp v217, v217, v217 row_ror:1 row_mask:0xf bank_mask:0xf
    v_add_f32_dpp v218, v218, v218 row_ror:1 row_mask:0xf bank_mask:0xf
    v_add_f32_dpp v219, v219, v219 row_ror:1 row_mask:0xf bank_mask:0xf
    v_add_f32_dpp v220, v220, v220 row_ror:1 row_mask:0xf bank_mask:0xf
    v_add_f32_dpp v221, v221, v221 row_ror:1 row_mask:0xf bank_mask:0xf
    v_add_f32_dpp v222, v222, v222 row_ror:1 row_mask:0xf bank_mask:0xf
    v_add_f32_dpp v223, v223, v223 row_ror:1 row_mask:0xf bank_mask:0xf
    s_mov_b32 s70, 1040356334
    v_mul_f32 v192, s70, v192
    v_mul_f32 v193, s70, v193
    v_mul_f32 v194, s70, v194
    v_mul_f32 v195, s70, v195
    v_mul_f32 v196, s70, v196
    v_mul_f32 v197, s70, v197
    v_mul_f32 v198, s70, v198
    v_mul_f32 v199, s70, v199
    v_mul_f32 v200, s70, v200
    v_mul_f32 v201, s70, v201
    v_mul_f32 v202, s70, v202
    v_mul_f32 v203, s70, v203
    v_mul_f32 v204, s70, v204
    v_mul_f32 v205, s70, v205
    v_mul_f32 v206, s70, v206
    v_mul_f32 v207, s70, v207
    v_mul_f32 v208, s70, v208
    v_mul_f32 v209, s70, v209
    v_mul_f32 v210, s70, v210
    v_mul_f32 v211, s70, v211
    v_mul_f32 v212, s70, v212
    v_mul_f32 v213, s70, v213
    v_mul_f32 v214, s70, v214
    v_mul_f32 v215, s70, v215
    v_mul_f32 v216, s70, v216
    v_mul_f32 v217, s70, v217
    v_mul_f32 v218, s70, v218
    v_mul_f32 v219, s70, v219
    v_mul_f32 v220, s70, v220
    v_mul_f32 v221, s70, v221
    v_mul_f32 v222, s70, v222
    v_mul_f32 v223, s70, v223
    s_lshl_b32 s61, s56, 8
    s_add_u32 s61, s61, 139264
    v_lshlrev_b32 v40, 6, v2
    v_add_u32 v40, s61, v40
    s_mov_b64 s[94:95], exec
    s_mov_b32 exec_lo, 0x00010001
    s_mov_b32 exec_hi, 0x00010001
    ds_write_b128 v40, v[192:195] offset:0
    ds_write_b128 v40, v[196:199] offset:16
    ds_write_b128 v40, v[200:203] offset:32
    ds_write_b128 v40, v[204:207] offset:48
    ds_write_b128 v40, v[208:211] offset:2048
    ds_write_b128 v40, v[212:215] offset:2064
    ds_write_b128 v40, v[216:219] offset:2080
    ds_write_b128 v40, v[220:223] offset:2096
    s_mov_b64 exec, s[94:95]
    s_waitcnt lgkmcnt(0)
    s_barrier
    s_cmp_eq_u32 s56, 0
    s_cbranch_scc1 Lqa0_52
    s_mov_b32 s44, s12
    s_mov_b32 s45, s13
    s_and_b32 s45, s45, 0xffff
    s_mov_b32 s46, 4194304
    s_mov_b32 s47, 0x00020000
    s_lshl_b32 s61, s56, 19
    s_lshl_b32 s62, s65, 8
    s_add_u32 s61, s61, s62
    buffer_load_dwordx4 v[64:67], v4, s[44:47], s61 offen nt
    s_add_u32 s61, s61, 8192
    buffer_load_dwordx4 v[68:71], v4, s[44:47], s61 offen nt
    s_add_u32 s61, s61, 8192
    buffer_load_dwordx4 v[72:75], v4, s[44:47], s61 offen nt
    s_add_u32 s61, s61, 8192
    buffer_load_dwordx4 v[76:79], v4, s[44:47], s61 offen nt
    s_add_u32 s61, s61, 8192
    buffer_load_dwordx4 v[80:83], v4, s[44:47], s61 offen nt
    s_add_u32 s61, s61, 8192
    buffer_load_dwordx4 v[84:87], v4, s[44:47], s61 offen nt
    s_add_u32 s61, s61, 8192
    buffer_load_dwordx4 v[88:91], v4, s[44:47], s61 offen nt
    s_add_u32 s61, s61, 8192
    buffer_load_dwordx4 v[92:95], v4, s[44:47], s61 offen nt
    s_add_u32 s61, s61, 8192
    buffer_load_dwordx4 v[96:99], v4, s[44:47], s61 offen nt
    s_add_u32 s61, s61, 8192
    buffer_load_dwordx4 v[100:103], v4, s[44:47], s61 offen nt
    s_add_u32 s61, s61, 8192
    buffer_load_dwordx4 v[104:107], v4, s[44:47], s61 offen nt
    s_add_u32 s61, s61, 8192
    buffer_load_dwordx4 v[108:111], v4, s[44:47], s61 offen nt
    s_add_u32 s61, s61, 8192
    buffer_load_dwordx4 v[112:115], v4, s[44:47], s61 offen nt
    s_add_u32 s61, s61, 8192
    buffer_load_dwordx4 v[116:119], v4, s[44:47], s61 offen nt
    s_add_u32 s61, s61, 8192
    buffer_load_dwordx4 v[120:123], v4, s[44:47], s61 offen nt
    s_add_u32 s61, s61, 8192
    buffer_load_dwordx4 v[124:127], v4, s[44:47], s61 offen nt
    s_mov_b32 s36, s14
    s_mov_b32 s37, s15
    s_and_b32 s37, s37, 0xffff
    s_mov_b32 s38, 4194304
    s_mov_b32 s39, 0x00020000
    s_lshl_b32 s61, s56, 14
    s_lshl_b32 s62, s65, 17
    s_add_u32 s62, s62, s61
    s_add_u32 m0, s61, 0
    v_xor_b32 v52, 0, v5
    buffer_load_dwordx4 v52, s[36:39], s62 offen nt lds
    s_add_u32 s62, s62, 1024
    s_add_u32 m0, s61, 1024
    v_xor_b32 v53, 64, v5
    buffer_load_dwordx4 v53, s[36:39], s62 offen nt lds
    s_add_u32 s62, s62, 1024
    s_add_u32 m0, s61, 2048
    v_xor_b32 v52, 128, v5
    buffer_load_dwordx4 v52, s[36:39], s62 offen nt lds
    s_add_u32 s62, s62, 1024
    s_add_u32 m0, s61, 3072
    v_xor_b32 v53, 192, v5
    buffer_load_dwordx4 v53, s[36:39], s62 offen nt lds
    s_add_u32 s62, s62, 1024
    s_add_u32 m0, s61, 4096
    v_xor_b32 v52, 0, v5
    buffer_load_dwordx4 v52, s[36:39], s62 offen nt lds
    s_add_u32 s62, s62, 1024
    s_add_u32 m0, s61, 5120
    v_xor_b32 v53, 64, v5
    buffer_load_dwordx4 v53, s[36:39], s62 offen nt lds
    s_add_u32 s62, s62, 1024
    s_add_u32 m0, s61, 6144
    v_xor_b32 v52, 128, v5
    buffer_load_dwordx4 v52, s[36:39], s62 offen nt lds
    s_add_u32 s62, s62, 1024
    s_add_u32 m0, s61, 7168
    v_xor_b32 v53, 192, v5
    buffer_load_dwordx4 v53, s[36:39], s62 offen nt lds
    s_add_u32 s62, s62, 1024
    s_add_u32 m0, s61, 8192
    v_xor_b32 v52, 32, v5
    buffer_load_dwordx4 v52, s[36:39], s62 offen nt lds
    s_add_u32 s62, s62, 1024
    s_add_u32 m0, s61, 9216
    v_xor_b32 v53, 96, v5
    buffer_load_dwordx4 v53, s[36:39], s62 offen nt lds
    s_add_u32 s62, s62, 1024
    s_add_u32 m0, s61, 10240
    v_xor_b32 v52, 160, v5
    buffer_load_dwordx4 v52, s[36:39], s62 offen nt lds
    s_add_u32 s62, s62, 1024
    s_add_u32 m0, s61, 11264
    v_xor_b32 v53, 224, v5
    buffer_load_dwordx4 v53, s[36:39], s62 offen nt lds
    s_add_u32 s62, s62, 1024
    s_add_u32 m0, s61, 12288
    v_xor_b32 v52, 32, v5
    buffer_load_dwordx4 v52, s[36:39], s62 offen nt lds
    s_add_u32 s62, s62, 1024
    s_add_u32 m0, s61, 13312
    v_xor_b32 v53, 96, v5
    buffer_load_dwordx4 v53, s[36:39], s62 offen nt lds
    s_add_u32 s62, s62, 1024
    s_add_u32 m0, s61, 14336
    v_xor_b32 v52, 160, v5
    buffer_load_dwordx4 v52, s[36:39], s62 offen nt lds
    s_add_u32 s62, s62, 1024
    s_add_u32 m0, s61, 15360
    v_xor_b32 v53, 224, v5
    buffer_load_dwordx4 v53, s[36:39], s62 offen nt lds
    s_branch Lqaj_53
Lqa0_52:
    v_lshlrev_b32 v40, 5, v1
    v_add_u32 v40, 139264, v40
    ds_read_b128 v[192:195], v40 offset:0
    ds_read_b128 v[196:199], v40 offset:16
    ds_read_b128 v[200:203], v40 offset:2048
    ds_read_b128 v[204:207], v40 offset:2064
    s_waitcnt lgkmcnt(0)
    s_lshl_b32 s61, s65, 10
    s_add_u32 s61, s61, 1146880
    v_cvt_pk_bf16_f32 v208, v192, v193
    v_cvt_pk_bf16_f32 v209, v194, v195
    v_cvt_pk_bf16_f32 v210, v196, v197
    v_cvt_pk_bf16_f32 v211, v198, v199
    buffer_store_dwordx4 v[208:211], v5, s[32:35], s61 offen sc0 sc1
    s_add_u32 s61, s61, 32768
    v_cvt_pk_bf16_f32 v212, v200, v201
    v_cvt_pk_bf16_f32 v213, v202, v203
    v_cvt_pk_bf16_f32 v214, v204, v205
    v_cvt_pk_bf16_f32 v215, v206, v207
    buffer_store_dwordx4 v[212:215], v5, s[32:35], s61 offen sc0 sc1
    s_mov_b32 s44, s12
    s_mov_b32 s45, s13
    s_and_b32 s45, s45, 0xffff
    s_mov_b32 s46, 4194304
    s_mov_b32 s47, 0x00020000
    s_lshl_b32 s61, s56, 19
    s_lshl_b32 s62, s65, 8
    s_add_u32 s61, s61, s62
    buffer_load_dwordx4 v[64:67], v4, s[44:47], s61 offen nt
    s_add_u32 s61, s61, 8192
    buffer_load_dwordx4 v[68:71], v4, s[44:47], s61 offen nt
    s_add_u32 s61, s61, 8192
    buffer_load_dwordx4 v[72:75], v4, s[44:47], s61 offen nt
    s_add_u32 s61, s61, 8192
    buffer_load_dwordx4 v[76:79], v4, s[44:47], s61 offen nt
    s_add_u32 s61, s61, 8192
    buffer_load_dwordx4 v[80:83], v4, s[44:47], s61 offen nt
    s_add_u32 s61, s61, 8192
    buffer_load_dwordx4 v[84:87], v4, s[44:47], s61 offen nt
    s_add_u32 s61, s61, 8192
    buffer_load_dwordx4 v[88:91], v4, s[44:47], s61 offen nt
    s_add_u32 s61, s61, 8192
    buffer_load_dwordx4 v[92:95], v4, s[44:47], s61 offen nt
    s_add_u32 s61, s61, 8192
    buffer_load_dwordx4 v[96:99], v4, s[44:47], s61 offen nt
    s_add_u32 s61, s61, 8192
    buffer_load_dwordx4 v[100:103], v4, s[44:47], s61 offen nt
    s_add_u32 s61, s61, 8192
    buffer_load_dwordx4 v[104:107], v4, s[44:47], s61 offen nt
    s_add_u32 s61, s61, 8192
    buffer_load_dwordx4 v[108:111], v4, s[44:47], s61 offen nt
    s_add_u32 s61, s61, 8192
    buffer_load_dwordx4 v[112:115], v4, s[44:47], s61 offen nt
    s_add_u32 s61, s61, 8192
    buffer_load_dwordx4 v[116:119], v4, s[44:47], s61 offen nt
    s_add_u32 s61, s61, 8192
    buffer_load_dwordx4 v[120:123], v4, s[44:47], s61 offen nt
    s_add_u32 s61, s61, 8192
    buffer_load_dwordx4 v[124:127], v4, s[44:47], s61 offen nt
    s_mov_b32 s36, s14
    s_mov_b32 s37, s15
    s_and_b32 s37, s37, 0xffff
    s_mov_b32 s38, 4194304
    s_mov_b32 s39, 0x00020000
    s_lshl_b32 s61, s56, 14
    s_lshl_b32 s62, s65, 17
    s_add_u32 s62, s62, s61
    s_add_u32 m0, s61, 0
    v_xor_b32 v52, 0, v5
    buffer_load_dwordx4 v52, s[36:39], s62 offen nt lds
    s_add_u32 s62, s62, 1024
    s_add_u32 m0, s61, 1024
    v_xor_b32 v53, 64, v5
    buffer_load_dwordx4 v53, s[36:39], s62 offen nt lds
    s_add_u32 s62, s62, 1024
    s_add_u32 m0, s61, 2048
    v_xor_b32 v52, 128, v5
    buffer_load_dwordx4 v52, s[36:39], s62 offen nt lds
    s_add_u32 s62, s62, 1024
    s_add_u32 m0, s61, 3072
    v_xor_b32 v53, 192, v5
    buffer_load_dwordx4 v53, s[36:39], s62 offen nt lds
    s_add_u32 s62, s62, 1024
    s_add_u32 m0, s61, 4096
    v_xor_b32 v52, 0, v5
    buffer_load_dwordx4 v52, s[36:39], s62 offen nt lds
    s_add_u32 s62, s62, 1024
    s_add_u32 m0, s61, 5120
    v_xor_b32 v53, 64, v5
    buffer_load_dwordx4 v53, s[36:39], s62 offen nt lds
    s_add_u32 s62, s62, 1024
    s_add_u32 m0, s61, 6144
    v_xor_b32 v52, 128, v5
    buffer_load_dwordx4 v52, s[36:39], s62 offen nt lds
    s_add_u32 s62, s62, 1024
    s_add_u32 m0, s61, 7168
    v_xor_b32 v53, 192, v5
    buffer_load_dwordx4 v53, s[36:39], s62 offen nt lds
    s_add_u32 s62, s62, 1024
    s_add_u32 m0, s61, 8192
    v_xor_b32 v52, 32, v5
    buffer_load_dwordx4 v52, s[36:39], s62 offen nt lds
    s_add_u32 s62, s62, 1024
    s_add_u32 m0, s61, 9216
    v_xor_b32 v53, 96, v5
    buffer_load_dwordx4 v53, s[36:39], s62 offen nt lds
    s_add_u32 s62, s62, 1024
    s_add_u32 m0, s61, 10240
    v_xor_b32 v52, 160, v5
    buffer_load_dwordx4 v52, s[36:39], s62 offen nt lds
    s_add_u32 s62, s62, 1024
    s_add_u32 m0, s61, 11264
    v_xor_b32 v53, 224, v5
    buffer_load_dwordx4 v53, s[36:39], s62 offen nt lds
    s_add_u32 s62, s62, 1024
    s_add_u32 m0, s61, 12288
    v_xor_b32 v52, 32, v5
    buffer_load_dwordx4 v52, s[36:39], s62 offen nt lds
    s_add_u32 s62, s62, 1024
    s_add_u32 m0, s61, 13312
    v_xor_b32 v53, 96, v5
    buffer_load_dwordx4 v53, s[36:39], s62 offen nt lds
    s_add_u32 s62, s62, 1024
    s_add_u32 m0, s61, 14336
    v_xor_b32 v52, 160, v5
    buffer_load_dwordx4 v52, s[36:39], s62 offen nt lds
    s_add_u32 s62, s62, 1024
    s_add_u32 m0, s61, 15360
    v_xor_b32 v53, 224, v5
    buffer_load_dwordx4 v53, s[36:39], s62 offen nt lds
Lqaj_53:
    s_waitcnt vmcnt(0)
    s_barrier
    v_lshrrev_b32 v40, 2, v3
    v_and_b32 v41, 1, v2
    v_lshlrev_b32 v42, 2, v40
    v_lshl_or_b32 v42, v41, 1, v42
    v_lshl_add_u32 v43, v2, 3, v40
    v_lshlrev_b32 v43, 10, v43
    v_and_b32 v44, 1, v3
    v_lshl_add_u32 v43, v44, 3, v43
    v_bfe_u32 v44, v3, 1, 1
    s_lshl_b32 s61, s56, 3
    s_add_u32 s62, s61, 0
    v_add_u32 v45, s62, v44
    v_xor_b32 v45, v45, v42
    v_lshl_add_u32 v48, v45, 4, v43
    s_add_u32 s62, s61, 2
    v_add_u32 v45, s62, v44
    v_xor_b32 v45, v45, v42
    v_lshl_add_u32 v49, v45, 4, v43
    s_add_u32 s62, s61, 4
    v_add_u32 v45, s62, v44
    v_xor_b32 v45, v45, v42
    v_lshl_add_u32 v50, v45, 4, v43
    s_add_u32 s62, s61, 6
    v_add_u32 v45, s62, v44
    v_xor_b32 v45, v45, v42
    v_lshl_add_u32 v51, v45, 4, v43
    ds_read_b64_tr_b16 v[128:129], v48 offset:0
    ds_read_b64_tr_b16 v[130:131], v48 offset:4096
    ds_read_b64_tr_b16 v[144:145], v49 offset:0
    ds_read_b64_tr_b16 v[146:147], v49 offset:4096
    ds_read_b64_tr_b16 v[160:161], v50 offset:0
    ds_read_b64_tr_b16 v[162:163], v50 offset:4096
    ds_read_b64_tr_b16 v[176:177], v51 offset:0
    ds_read_b64_tr_b16 v[178:179], v51 offset:4096
    s_waitcnt lgkmcnt(0)
    ds_read_b64_tr_b16 v[132:133], v48 offset:32768
    ds_read_b64_tr_b16 v[134:135], v48 offset:36864
    ds_read_b64_tr_b16 v[148:149], v49 offset:32768
    ds_read_b64_tr_b16 v[150:151], v49 offset:36864
    ds_read_b64_tr_b16 v[164:165], v50 offset:32768
    ds_read_b64_tr_b16 v[166:167], v50 offset:36864
    ds_read_b64_tr_b16 v[180:181], v51 offset:32768
    ds_read_b64_tr_b16 v[182:183], v51 offset:36864
    s_waitcnt lgkmcnt(0)
    v_add_u32 v48, 0x10000, v48
    v_add_u32 v49, 0x10000, v49
    v_add_u32 v50, 0x10000, v50
    v_add_u32 v51, 0x10000, v51
    ds_read_b64_tr_b16 v[136:137], v48 offset:0
    ds_read_b64_tr_b16 v[138:139], v48 offset:4096
    ds_read_b64_tr_b16 v[152:153], v49 offset:0
    ds_read_b64_tr_b16 v[154:155], v49 offset:4096
    ds_read_b64_tr_b16 v[168:169], v50 offset:0
    ds_read_b64_tr_b16 v[170:171], v50 offset:4096
    ds_read_b64_tr_b16 v[184:185], v51 offset:0
    ds_read_b64_tr_b16 v[186:187], v51 offset:4096
    s_waitcnt lgkmcnt(0)
    ds_read_b64_tr_b16 v[140:141], v48 offset:32768
    ds_read_b64_tr_b16 v[142:143], v48 offset:36864
    ds_read_b64_tr_b16 v[156:157], v49 offset:32768
    ds_read_b64_tr_b16 v[158:159], v49 offset:36864
    ds_read_b64_tr_b16 v[172:173], v50 offset:32768
    ds_read_b64_tr_b16 v[174:175], v50 offset:36864
    ds_read_b64_tr_b16 v[188:189], v51 offset:32768
    ds_read_b64_tr_b16 v[190:191], v51 offset:36864
    s_waitcnt lgkmcnt(0)
    s_barrier
    s_cmp_lg_u32 s56, 0
    s_cbranch_scc1 Lwf_54
    v_lshlrev_b32 v40, 2, v1
    s_mov_b64 exec, 0xffffffff
    s_mov_b32 s92, 0
Lpoll_55:
    buffer_load_dword v41, v40, s[32:35], s93 offen offset:0 sc0 sc1
    s_waitcnt vmcnt(0)
    v_mov_b32 v42, v41
    v_cmpx_eq_u32 vcc, -1, v42
    s_cbranch_execz Lpolld_56
    s_sleep 8
    s_add_u32 s92, s92, 1
    s_cmp_lt_u32 s92, 400000
    s_cbranch_scc1 Lpoll_55
Lpolld_56:
    s_mov_b64 exec, -1
Lwf_54:
    s_barrier
    s_lshr_b32 s66, s56, 2
    s_and_b32 s63, s56, 3
    s_lshl_b32 s61, s56, 17
    s_lshl_b32 s62, s65, 10
    s_add_u32 s61, s61, s62
    s_add_u32 s61, s61, 2097152
    v_lshlrev_b32 v40, 3, v3
    s_lshl_b32 s62, s65, 8
    s_lshl_b32 s64, s66, 7
    s_add_u32 s62, s62, s64
    s_add_u32 s62, s62, 1245184
    buffer_load_dwordx2 v[42:43], v40, s[32:35], s62 offen sc0 sc1
    buffer_load_dwordx4 v[192:195], v5, s[32:35], s61 offen sc0 sc1
    s_add_u32 s61, s61, 32768
    buffer_load_dwordx4 v[196:199], v5, s[32:35], s61 offen sc0 sc1
    s_add_u32 s61, s61, 32768
    buffer_load_dwordx4 v[200:203], v5, s[32:35], s61 offen sc0 sc1
    s_add_u32 s61, s61, 32768
    buffer_load_dwordx4 v[204:207], v5, s[32:35], s61 offen sc0 sc1
    s_waitcnt vmcnt(4)
    v_mov_b32 v44, v42
    s_nop 1
    v_max_f32_dpp v44, v44, v44 row_ror:8 row_mask:0xf bank_mask:0xf
    s_nop 1
    v_max_f32_dpp v44, v44, v44 row_ror:4 row_mask:0xf bank_mask:0xf
    s_nop 1
    v_max_f32_dpp v44, v44, v44 row_ror:2 row_mask:0xf bank_mask:0xf
    s_nop 1
    v_max_f32_dpp v44, v44, v44 row_ror:1 row_mask:0xf bank_mask:0xf
    v_sub_f32 v42, v42, v44
    v_exp_f32 v42, v42
    s_nop 0
    v_mul_f32 v43, v43, v42
    s_nop 1
    v_add_f32_dpp v43, v43, v43 row_ror:8 row_mask:0xf bank_mask:0xf
    s_nop 1
    v_add_f32_dpp v43, v43, v43 row_ror:4 row_mask:0xf bank_mask:0xf
    s_nop 1
    v_add_f32_dpp v43, v43, v43 row_ror:2 row_mask:0xf bank_mask:0xf
    s_nop 1
    v_add_f32_dpp v43, v43, v43 row_ror:1 row_mask:0xf bank_mask:0xf
    v_rcp_f32 v43, v43
    s_nop 0
    v_mul_f32 v42, v42, v43
    s_lshl_b32 s63, s63, 2
    s_nop 1
    s_add_u32 s64, s63, 0
    v_readlane_b32 s76, v42, s64
    s_add_u32 s64, s63, 1
    v_readlane_b32 s77, v42, s64
    s_add_u32 s64, s63, 2
    v_readlane_b32 s78, v42, s64
    s_add_u32 s64, s63, 3
    v_readlane_b32 s79, v42, s64
    s_nop 1
    s_waitcnt vmcnt(3)
    v_lshlrev_b32 v48, 16, v192
    v_and_b32 v49, 0xffff0000, v192
    v_lshlrev_b32 v50, 16, v193
    v_and_b32 v51, 0xffff0000, v193
    v_lshlrev_b32 v52, 16, v194
    v_and_b32 v53, 0xffff0000, v194
    v_lshlrev_b32 v54, 16, v195
    v_and_b32 v55, 0xffff0000, v195
    v_mul_f32 v24, s76, v48
    v_mul_f32 v25, s76, v49
    v_mul_f32 v26, s76, v50
    v_mul_f32 v27, s76, v51
    v_mul_f32 v28, s76, v52
    v_mul_f32 v29, s76, v53
    v_mul_f32 v30, s76, v54
    v_mul_f32 v31, s76, v55
    s_waitcnt vmcnt(2)
    v_lshlrev_b32 v48, 16, v196
    v_and_b32 v49, 0xffff0000, v196
    v_lshlrev_b32 v50, 16, v197
    v_and_b32 v51, 0xffff0000, v197
    v_lshlrev_b32 v52, 16, v198
    v_and_b32 v53, 0xffff0000, v198
    v_lshlrev_b32 v54, 16, v199
    v_and_b32 v55, 0xffff0000, v199
    v_fmac_f32 v24, s77, v48
    v_fmac_f32 v25, s77, v49
    v_fmac_f32 v26, s77, v50
    v_fmac_f32 v27, s77, v51
    v_fmac_f32 v28, s77, v52
    v_fmac_f32 v29, s77, v53
    v_fmac_f32 v30, s77, v54
    v_fmac_f32 v31, s77, v55
    s_waitcnt vmcnt(1)
    v_lshlrev_b32 v48, 16, v200
    v_and_b32 v49, 0xffff0000, v200
    v_lshlrev_b32 v50, 16, v201
    v_and_b32 v51, 0xffff0000, v201
    v_lshlrev_b32 v52, 16, v202
    v_and_b32 v53, 0xffff0000, v202
    v_lshlrev_b32 v54, 16, v203
    v_and_b32 v55, 0xffff0000, v203
    v_fmac_f32 v24, s78, v48
    v_fmac_f32 v25, s78, v49
    v_fmac_f32 v26, s78, v50
    v_fmac_f32 v27, s78, v51
    v_fmac_f32 v28, s78, v52
    v_fmac_f32 v29, s78, v53
    v_fmac_f32 v30, s78, v54
    v_fmac_f32 v31, s78, v55
    s_waitcnt vmcnt(0)
    v_lshlrev_b32 v48, 16, v204
    v_and_b32 v49, 0xffff0000, v204
    v_lshlrev_b32 v50, 16, v205
    v_and_b32 v51, 0xffff0000, v205
    v_lshlrev_b32 v52, 16, v206
    v_and_b32 v53, 0xffff0000, v206
    v_lshlrev_b32 v54, 16, v207
    v_and_b32 v55, 0xffff0000, v207
    v_fmac_f32 v24, s79, v48
    v_fmac_f32 v25, s79, v49
    v_fmac_f32 v26, s79, v50
    v_fmac_f32 v27, s79, v51
    v_fmac_f32 v28, s79, v52
    v_fmac_f32 v29, s79, v53
    v_fmac_f32 v30, s79, v54
    v_fmac_f32 v31, s79, v55
    s_lshl_b32 s61, s56, 11
    v_lshlrev_b32 v40, 5, v1
    v_add_u32 v40, s61, v40
    ds_write_b128 v40, v[24:27] offset:16384
    ds_write_b128 v40, v[28:31] offset:16400
    s_waitcnt lgkmcnt(0)
    s_barrier
    v_and_b32 v40, 255, v0
    v_lshlrev_b32 v40, 3, v40
    s_lshl_b32 s61, s66, 13
    v_add_u32 v40, s61, v40
    ds_read_b64 v[24:25], v40 offset:16384
    ds_read_b64 v[26:27], v40 offset:18432
    ds_read_b64 v[28:29], v40 offset:20480
    ds_read_b64 v[30:31], v40 offset:22528
    s_waitcnt lgkmcnt(0)
    v_add_f32 v24, v24, v26
    v_add_f32 v25, v25, v27
    v_add_f32 v24, v24, v28
    v_add_f32 v25, v25, v29
    v_add_f32 v24, v24, v30
    v_add_f32 v25, v25, v31
    v_cvt_pk_bf16_f32 v24, v24, v25
    v_lshlrev_b32 v40, 2, v0
    ds_write_b32 v40, v24 offset:32768
    s_waitcnt lgkmcnt(0)
    s_barrier
    s_lshl_b32 s61, s56, 7
    v_lshlrev_b32 v40, 5, v2
    v_add_u32 v40, s61, v40
    ds_read_b128 v[8:11], v40 offset:32768
    ds_read_b128 v[12:15], v40 offset:32784
    ds_read_b128 v[16:19], v40 offset:33792
    ds_read_b128 v[20:23], v40 offset:33808
    s_waitcnt lgkmcnt(0)
    v_mov_b32 v24, 0
    v_mov_b32 v25, 0
    v_mov_b32 v26, 0
    v_mov_b32 v27, 0
    v_mov_b32 v28, 0
    v_mov_b32 v29, 0
    v_mov_b32 v30, 0
    v_mov_b32 v31, 0
    v_mov_b32 v32, 0
    v_mov_b32 v33, 0
    v_mov_b32 v34, 0
    v_mov_b32 v35, 0
    v_mov_b32 v36, 0
    v_mov_b32 v37, 0
    v_mov_b32 v38, 0
    v_mov_b32 v39, 0
    v_perm_b32 v40, v68, v64, s68
    v_perm_b32 v41, v68, v64, s69
    v_perm_b32 v42, v69, v65, s68
    v_perm_b32 v43, v69, v65, s69
    v_perm_b32 v44, v70, v66, s68
    v_perm_b32 v45, v70, v66, s69
    v_perm_b32 v46, v71, v67, s68
    v_perm_b32 v47, v71, v67, s69
    v_dot2_f32_bf16 v24, v40, v8, v24
    v_dot2_f32_bf16 v25, v41, v8, v25
    v_dot2_f32_bf16 v26, v42, v8, v26
    v_dot2_f32_bf16 v27, v43, v8, v27
    v_dot2_f32_bf16 v28, v44, v8, v28
    v_dot2_f32_bf16 v29, v45, v8, v29
    v_dot2_f32_bf16 v30, v46, v8, v30
    v_dot2_f32_bf16 v31, v47, v8, v31
    v_dot2_f32_bf16 v32, v40, v16, v32
    v_dot2_f32_bf16 v33, v41, v16, v33
    v_dot2_f32_bf16 v34, v42, v16, v34
    v_dot2_f32_bf16 v35, v43, v16, v35
    v_dot2_f32_bf16 v36, v44, v16, v36
    v_dot2_f32_bf16 v37, v45, v16, v37
    v_dot2_f32_bf16 v38, v46, v16, v38
    v_dot2_f32_bf16 v39, v47, v16, v39
    v_perm_b32 v40, v76, v72, s68
    v_perm_b32 v41, v76, v72, s69
    v_perm_b32 v42, v77, v73, s68
    v_perm_b32 v43, v77, v73, s69
    v_perm_b32 v44, v78, v74, s68
    v_perm_b32 v45, v78, v74, s69
    v_perm_b32 v46, v79, v75, s68
    v_perm_b32 v47, v79, v75, s69
    v_dot2_f32_bf16 v24, v40, v9, v24
    v_dot2_f32_bf16 v25, v41, v9, v25
    v_dot2_f32_bf16 v26, v42, v9, v26
    v_dot2_f32_bf16 v27, v43, v9, v27
    v_dot2_f32_bf16 v28, v44, v9, v28
    v_dot2_f32_bf16 v29, v45, v9, v29
    v_dot2_f32_bf16 v30, v46, v9, v30
    v_dot2_f32_bf16 v31, v47, v9, v31
    v_dot2_f32_bf16 v32, v40, v17, v32
    v_dot2_f32_bf16 v33, v41, v17, v33
    v_dot2_f32_bf16 v34, v42, v17, v34
    v_dot2_f32_bf16 v35, v43, v17, v35
    v_dot2_f32_bf16 v36, v44, v17, v36
    v_dot2_f32_bf16 v37, v45, v17, v37
    v_dot2_f32_bf16 v38, v46, v17, v38
    v_dot2_f32_bf16 v39, v47, v17, v39
    v_perm_b32 v40, v84, v80, s68
    v_perm_b32 v41, v84, v80, s69
    v_perm_b32 v42, v85, v81, s68
    v_perm_b32 v43, v85, v81, s69
    v_perm_b32 v44, v86, v82, s68
    v_perm_b32 v45, v86, v82, s69
    v_perm_b32 v46, v87, v83, s68
    v_perm_b32 v47, v87, v83, s69
    v_dot2_f32_bf16 v24, v40, v10, v24
    v_dot2_f32_bf16 v25, v41, v10, v25
    v_dot2_f32_bf16 v26, v42, v10, v26
    v_dot2_f32_bf16 v27, v43, v10, v27
    v_dot2_f32_bf16 v28, v44, v10, v28
    v_dot2_f32_bf16 v29, v45, v10, v29
    v_dot2_f32_bf16 v30, v46, v10, v30
    v_dot2_f32_bf16 v31, v47, v10, v31
    v_dot2_f32_bf16 v32, v40, v18, v32
    v_dot2_f32_bf16 v33, v41, v18, v33
    v_dot2_f32_bf16 v34, v42, v18, v34
    v_dot2_f32_bf16 v35, v43, v18, v35
    v_dot2_f32_bf16 v36, v44, v18, v36
    v_dot2_f32_bf16 v37, v45, v18, v37
    v_dot2_f32_bf16 v38, v46, v18, v38
    v_dot2_f32_bf16 v39, v47, v18, v39
    v_perm_b32 v40, v92, v88, s68
    v_perm_b32 v41, v92, v88, s69
    v_perm_b32 v42, v93, v89, s68
    v_perm_b32 v43, v93, v89, s69
    v_perm_b32 v44, v94, v90, s68
    v_perm_b32 v45, v94, v90, s69
    v_perm_b32 v46, v95, v91, s68
    v_perm_b32 v47, v95, v91, s69
    v_dot2_f32_bf16 v24, v40, v11, v24
    v_dot2_f32_bf16 v25, v41, v11, v25
    v_dot2_f32_bf16 v26, v42, v11, v26
    v_dot2_f32_bf16 v27, v43, v11, v27
    v_dot2_f32_bf16 v28, v44, v11, v28
    v_dot2_f32_bf16 v29, v45, v11, v29
    v_dot2_f32_bf16 v30, v46, v11, v30
    v_dot2_f32_bf16 v31, v47, v11, v31
    v_dot2_f32_bf16 v32, v40, v19, v32
    v_dot2_f32_bf16 v33, v41, v19, v33
    v_dot2_f32_bf16 v34, v42, v19, v34
    v_dot2_f32_bf16 v35, v43, v19, v35
    v_dot2_f32_bf16 v36, v44, v19, v36
    v_dot2_f32_bf16 v37, v45, v19, v37
    v_dot2_f32_bf16 v38, v46, v19, v38
    v_dot2_f32_bf16 v39, v47, v19, v39
    v_perm_b32 v40, v100, v96, s68
    v_perm_b32 v41, v100, v96, s69
    v_perm_b32 v42, v101, v97, s68
    v_perm_b32 v43, v101, v97, s69
    v_perm_b32 v44, v102, v98, s68
    v_perm_b32 v45, v102, v98, s69
    v_perm_b32 v46, v103, v99, s68
    v_perm_b32 v47, v103, v99, s69
    v_dot2_f32_bf16 v24, v40, v12, v24
    v_dot2_f32_bf16 v25, v41, v12, v25
    v_dot2_f32_bf16 v26, v42, v12, v26
    v_dot2_f32_bf16 v27, v43, v12, v27
    v_dot2_f32_bf16 v28, v44, v12, v28
    v_dot2_f32_bf16 v29, v45, v12, v29
    v_dot2_f32_bf16 v30, v46, v12, v30
    v_dot2_f32_bf16 v31, v47, v12, v31
    v_dot2_f32_bf16 v32, v40, v20, v32
    v_dot2_f32_bf16 v33, v41, v20, v33
    v_dot2_f32_bf16 v34, v42, v20, v34
    v_dot2_f32_bf16 v35, v43, v20, v35
    v_dot2_f32_bf16 v36, v44, v20, v36
    v_dot2_f32_bf16 v37, v45, v20, v37
    v_dot2_f32_bf16 v38, v46, v20, v38
    v_dot2_f32_bf16 v39, v47, v20, v39
    v_perm_b32 v40, v108, v104, s68
    v_perm_b32 v41, v108, v104, s69
    v_perm_b32 v42, v109, v105, s68
    v_perm_b32 v43, v109, v105, s69
    v_perm_b32 v44, v110, v106, s68
    v_perm_b32 v45, v110, v106, s69
    v_perm_b32 v46, v111, v107, s68
    v_perm_b32 v47, v111, v107, s69
    v_dot2_f32_bf16 v24, v40, v13, v24
    v_dot2_f32_bf16 v25, v41, v13, v25
    v_dot2_f32_bf16 v26, v42, v13, v26
    v_dot2_f32_bf16 v27, v43, v13, v27
    v_dot2_f32_bf16 v28, v44, v13, v28
    v_dot2_f32_bf16 v29, v45, v13, v29
    v_dot2_f32_bf16 v30, v46, v13, v30
    v_dot2_f32_bf16 v31, v47, v13, v31
    v_dot2_f32_bf16 v32, v40, v21, v32
    v_dot2_f32_bf16 v33, v41, v21, v33
    v_dot2_f32_bf16 v34, v42, v21, v34
    v_dot2_f32_bf16 v35, v43, v21, v35
    v_dot2_f32_bf16 v36, v44, v21, v36
    v_dot2_f32_bf16 v37, v45, v21, v37
    v_dot2_f32_bf16 v38, v46, v21, v38
    v_dot2_f32_bf16 v39, v47, v21, v39
    v_perm_b32 v40, v116, v112, s68
    v_perm_b32 v41, v116, v112, s69
    v_perm_b32 v42, v117, v113, s68
    v_perm_b32 v43, v117, v113, s69
    v_perm_b32 v44, v118, v114, s68
    v_perm_b32 v45, v118, v114, s69
    v_perm_b32 v46, v119, v115, s68
    v_perm_b32 v47, v119, v115, s69
    v_dot2_f32_bf16 v24, v40, v14, v24
    v_dot2_f32_bf16 v25, v41, v14, v25
    v_dot2_f32_bf16 v26, v42, v14, v26
    v_dot2_f32_bf16 v27, v43, v14, v27
    v_dot2_f32_bf16 v28, v44, v14, v28
    v_dot2_f32_bf16 v29, v45, v14, v29
    v_dot2_f32_bf16 v30, v46, v14, v30
    v_dot2_f32_bf16 v31, v47, v14, v31
    v_dot2_f32_bf16 v32, v40, v22, v32
    v_dot2_f32_bf16 v33, v41, v22, v33
    v_dot2_f32_bf16 v34, v42, v22, v34
    v_dot2_f32_bf16 v35, v43, v22, v35
    v_dot2_f32_bf16 v36, v44, v22, v36
    v_dot2_f32_bf16 v37, v45, v22, v37
    v_dot2_f32_bf16 v38, v46, v22, v38
    v_dot2_f32_bf16 v39, v47, v22, v39
    v_perm_b32 v40, v124, v120, s68
    v_perm_b32 v41, v124, v120, s69
    v_perm_b32 v42, v125, v121, s68
    v_perm_b32 v43, v125, v121, s69
    v_perm_b32 v44, v126, v122, s68
    v_perm_b32 v45, v126, v122, s69
    v_perm_b32 v46, v127, v123, s68
    v_perm_b32 v47, v127, v123, s69
    v_dot2_f32_bf16 v24, v40, v15, v24
    v_dot2_f32_bf16 v25, v41, v15, v25
    v_dot2_f32_bf16 v26, v42, v15, v26
    v_dot2_f32_bf16 v27, v43, v15, v27
    v_dot2_f32_bf16 v28, v44, v15, v28
    v_dot2_f32_bf16 v29, v45, v15, v29
    v_dot2_f32_bf16 v30, v46, v15, v30
    v_dot2_f32_bf16 v31, v47, v15, v31
    v_dot2_f32_bf16 v32, v40, v23, v32
    v_dot2_f32_bf16 v33, v41, v23, v33
    v_dot2_f32_bf16 v34, v42, v23, v34
    v_dot2_f32_bf16 v35, v43, v23, v35
    v_dot2_f32_bf16 v36, v44, v23, v36
    v_dot2_f32_bf16 v37, v45, v23, v37
    v_dot2_f32_bf16 v38, v46, v23, v38
    v_dot2_f32_bf16 v39, v47, v23, v39
    s_nop 2
    v_permlane32_swap_b32 v24, v28
    v_permlane32_swap_b32 v25, v29
    v_permlane32_swap_b32 v26, v30
    v_permlane32_swap_b32 v27, v31
    v_permlane32_swap_b32 v32, v36
    v_permlane32_swap_b32 v33, v37
    v_permlane32_swap_b32 v34, v38
    v_permlane32_swap_b32 v35, v39
    s_nop 1
    v_add_f32 v24, v24, v28
    v_add_f32 v25, v25, v29
    v_add_f32 v26, v26, v30
    v_add_f32 v27, v27, v31
    v_add_f32 v32, v32, v36
    v_add_f32 v33, v33, v37
    v_add_f32 v34, v34, v38
    v_add_f32 v35, v35, v39
    s_nop 1
    v_permlane16_swap_b32 v24, v26
    v_permlane16_swap_b32 v25, v27
    v_permlane16_swap_b32 v32, v34
    v_permlane16_swap_b32 v33, v35
    s_nop 1
    v_add_f32 v24, v24, v26
    v_add_f32 v25, v25, v27
    v_add_f32 v32, v32, v34
    v_add_f32 v33, v33, v35
    v_lshlrev_b32 v48, 5, v3
    v_lshl_add_u32 v48, v2, 3, v48
    s_lshl_b32 s61, s56, 9
    v_add_u32 v49, s61, v48
    ds_write_b64 v49, v[24:25] offset:0
    ds_write_b64 v49, v[32:33] offset:4096
    s_waitcnt lgkmcnt(0)
    s_barrier
    v_lshrrev_b32 v40, 5, v1
    v_lshlrev_b32 v40, 12, v40
    v_and_b32 v41, 31, v1
    v_lshl_add_u32 v40, v41, 4, v40
    ds_read_b128 v[192:195], v40 offset:0
    ds_read_b128 v[196:199], v40 offset:512
    ds_read_b128 v[200:203], v40 offset:1024
    ds_read_b128 v[204:207], v40 offset:1536
    ds_read_b128 v[208:211], v40 offset:2048
    ds_read_b128 v[212:215], v40 offset:2560
    ds_read_b128 v[216:219], v40 offset:3072
    ds_read_b128 v[220:223], v40 offset:3584
    s_lshl_b32 s61, s56, 9
    s_add_u32 s61, s61, 131072
    v_lshlrev_b32 v46, 3, v1
    v_add_u32 v46, s61, v46
    v_and_b32 v47, 1, v3
    v_lshlrev_b32 v47, 8, v47
    v_lshl_add_u32 v47, v2, 4, v47
    v_add_u32 v47, s61, v47
    s_waitcnt lgkmcnt(6)
    v_add_f32 v192, v192, v196
    v_add_f32 v193, v193, v197
    v_add_f32 v194, v194, v198
    v_add_f32 v195, v195, v199
    s_waitcnt lgkmcnt(5)
    v_add_f32 v192, v192, v200
    v_add_f32 v193, v193, v201
    v_add_f32 v194, v194, v202
    v_add_f32 v195, v195, v203
    s_waitcnt lgkmcnt(4)
    v_add_f32 v192, v192, v204
    v_add_f32 v193, v193, v205
    v_add_f32 v194, v194, v206
    v_add_f32 v195, v195, v207
    s_waitcnt lgkmcnt(3)
    v_add_f32 v192, v192, v208
    v_add_f32 v193, v193, v209
    v_add_f32 v194, v194, v210
    v_add_f32 v195, v195, v211
    s_waitcnt lgkmcnt(2)
    v_add_f32 v192, v192, v212
    v_add_f32 v193, v193, v213
    v_add_f32 v194, v194, v214
    v_add_f32 v195, v195, v215
    s_waitcnt lgkmcnt(1)
    v_add_f32 v192, v192, v216
    v_add_f32 v193, v193, v217
    v_add_f32 v194, v194, v218
    v_add_f32 v195, v195, v219
    s_waitcnt lgkmcnt(0)
    v_add_f32 v192, v192, v220
    v_add_f32 v193, v193, v221
    v_add_f32 v194, v194, v222
    v_add_f32 v195, v195, v223
    v_cvt_pk_bf16_f32 v192, v192, v193
    v_cvt_pk_bf16_f32 v193, v194, v195
    ds_write_b64 v46, v[192:193]
    s_waitcnt lgkmcnt(0)
    ds_read_b128 v[24:27], v47 offset:0
    ds_read_b128 v[28:31], v47 offset:64
    ds_read_b128 v[32:35], v47 offset:128
    ds_read_b128 v[36:39], v47 offset:192
    s_waitcnt lgkmcnt(3)
    v_mfma_f32_16x16x32_bf16 v[8:11], v[24:27], v[128:131], 0
    v_mfma_f32_16x16x32_bf16 v[12:15], v[24:27], v[144:147], 0
    v_mfma_f32_16x16x32_bf16 v[16:19], v[24:27], v[160:163], 0
    v_mfma_f32_16x16x32_bf16 v[20:23], v[24:27], v[176:179], 0
    s_waitcnt lgkmcnt(2)
    v_mfma_f32_16x16x32_bf16 v[8:11], v[28:31], v[132:135], v[8:11]
    v_mfma_f32_16x16x32_bf16 v[12:15], v[28:31], v[148:151], v[12:15]
    v_mfma_f32_16x16x32_bf16 v[16:19], v[28:31], v[164:167], v[16:19]
    v_mfma_f32_16x16x32_bf16 v[20:23], v[28:31], v[180:183], v[20:23]
    s_waitcnt lgkmcnt(1)
    v_mfma_f32_16x16x32_bf16 v[8:11], v[32:35], v[136:139], v[8:11]
    v_mfma_f32_16x16x32_bf16 v[12:15], v[32:35], v[152:155], v[12:15]
    v_mfma_f32_16x16x32_bf16 v[16:19], v[32:35], v[168:171], v[16:19]
    v_mfma_f32_16x16x32_bf16 v[20:23], v[32:35], v[184:187], v[20:23]
    s_waitcnt lgkmcnt(0)
    v_mfma_f32_16x16x32_bf16 v[8:11], v[36:39], v[140:143], v[8:11]
    v_mfma_f32_16x16x32_bf16 v[12:15], v[36:39], v[156:159], v[12:15]
    v_mfma_f32_16x16x32_bf16 v[16:19], v[36:39], v[172:175], v[16:19]
    v_mfma_f32_16x16x32_bf16 v[20:23], v[36:39], v[188:191], v[20:23]
    v_lshlrev_b32 v40, 2, v3
    s_lshl_b32 s61, s56, 16
    s_lshl_b32 s62, s65, 6
    s_add_u32 s61, s61, s62
    s_add_u32 s61, s61, 5376
    s_nop 4
    s_mov_b64 exec, 0xffff
    s_add_u32 s62, s61, 0
    buffer_store_dword v8, v40, s[32:35], s62 offen sc0 sc1
    s_add_u32 s62, s61, 524288
    buffer_store_dword v9, v40, s[32:35], s62 offen sc0 sc1
    s_add_u32 s62, s61, 16384
    buffer_store_dword v12, v40, s[32:35], s62 offen sc0 sc1
    s_add_u32 s62, s61, 540672
    buffer_store_dword v13, v40, s[32:35], s62 offen sc0 sc1
    s_add_u32 s62, s61, 32768
    buffer_store_dword v16, v40, s[32:35], s62 offen sc0 sc1
    s_add_u32 s62, s61, 557056
    buffer_store_dword v17, v40, s[32:35], s62 offen sc0 sc1
    s_add_u32 s62, s61, 49152
    buffer_store_dword v20, v40, s[32:35], s62 offen sc0 sc1
    s_add_u32 s62, s61, 573440
    buffer_store_dword v21, v40, s[32:35], s62 offen sc0 sc1
    s_mov_b64 exec, -1
    s_branch L_final
L_final:
    s_cmp_ge_u32 s56, 2
    s_cbranch_scc1 L_end
    s_lshr_b32 s66, s75, 5
    s_and_b32 s64, s75, 31
    v_lshlrev_b32 v8, 5, v1
    s_lshl_b32 s61, s56, 11
    s_add_u32 s61, s61, 3328
    s_add_u32 s61, s61, s93
    s_mov_b32 s92, 0
Lpoll_59:
    buffer_load_dwordx4 v[12:15], v8, s[32:35], s61 offen sc0 sc1
    buffer_load_dwordx4 v[16:19], v8, s[32:35], s61 offen offset:16 sc0 sc1
    s_waitcnt vmcnt(0)
    v_mov_b32 v22, v12
    v_max3_u32 v22, v22, v13, v14
    v_max3_u32 v22, v22, v15, v16
    v_max3_u32 v22, v22, v17, v18
    v_max_u32 v22, v22, v19
    v_cmpx_eq_u32 vcc, -1, v22
    s_cbranch_execz Lpolld_60
    s_sleep 2
    s_add_u32 s92, s92, 1
    s_cmp_lt_u32 s92, 400000
    s_cbranch_scc1 Lpoll_59
Lpolld_60:
    s_mov_b64 exec, -1
Lfsk_57:
    s_nop 1
    v_permlane32_swap_b32 v12, v16
    v_permlane32_swap_b32 v13, v17
    v_permlane32_swap_b32 v14, v18
    v_permlane32_swap_b32 v15, v19
    s_nop 1
    v_add_f32 v12, v12, v16
    v_add_f32 v13, v13, v17
    v_add_f32 v14, v14, v18
    v_add_f32 v15, v15, v19
    s_nop 1
    v_permlane16_swap_b32 v12, v14
    v_permlane16_swap_b32 v13, v15
    s_nop 1
    v_add_f32 v12, v12, v14
    v_add_f32 v13, v13, v15
    s_nop 0
    v_add_f32_dpp v12, v12, v12 row_ror:8 row_mask:0xf bank_mask:0xf
    v_add_f32_dpp v13, v13, v13 row_ror:8 row_mask:0xf bank_mask:0xf
    s_nop 0
    v_add_f32_dpp v12, v12, v12 row_ror:4 row_mask:0xf bank_mask:0xf
    v_add_f32_dpp v13, v13, v13 row_ror:4 row_mask:0xf bank_mask:0xf
    s_nop 0
    v_add_f32_dpp v12, v12, v12 quad_perm:[2,3,0,1] row_mask:0xf bank_mask:0xf
    v_add_f32_dpp v13, v13, v13 quad_perm:[2,3,0,1] row_mask:0xf bank_mask:0xf
    v_cvt_pk_bf16_f32 v12, v12, v13
    v_and_b32 v6, 1, v1
    v_lshlrev_b32 v6, 4, v6
    v_lshl_add_u32 v6, v2, 2, v6
    s_lshl_b32 s57, s66, 11
    s_lshl_b32 s58, s64, 5
    s_add_u32 s57, s57, s58
    s_xor_b32 s58, s56, 1
    s_lshl_b32 s58, s58, 10
    s_add_u32 s57, s57, s58
    s_mov_b32 s36, s26
    s_mov_b32 s37, s27
    s_and_b32 s37, s37, 0xffff
    s_mov_b32 s38, 4096
    s_mov_b32 s39, 0x00020000
    s_mov_b32 exec_lo, 0x00030003
    s_mov_b32 exec_hi, 0x00030003
    buffer_store_dword v12, v6, s[36:39], s57 offen
    s_mov_b64 exec, -1
    s_branch L_end
L_end:
    s_endpgm
.section .rodata,"a"
.p2align 6
.amdhsa_kernel concat_heads__compressed_kv_cla__gqa_block_cached__decode_kernel
  .amdhsa_next_free_vgpr 256
  .amdhsa_next_free_sgpr 102
  .amdhsa_accum_offset 256
  .amdhsa_group_segment_fixed_size 0
  .amdhsa_kernarg_size 112
  .amdhsa_user_sgpr_count 2
  .amdhsa_user_sgpr_kernarg_segment_ptr 1
  .amdhsa_system_sgpr_workgroup_id_x 1
.end_amdhsa_kernel
```

```asm
; @launch grid=(256,1,1) block=(512,1,1) lds=163840
.amdgcn_target "amdgcn-amd-amdhsa--gfx950"
.text
.globl concat_heads__compressed_kv_cla__gqa_block_cached__decode_kernel
.p2align 8
.type concat_heads__compressed_kv_cla__gqa_block_cached__decode_kernel,@function
concat_heads__compressed_kv_cla__gqa_block_cached__decode_kernel:
    s_cmp_ge_u32 s2, 256
    s_cbranch_scc1 L_end
    s_cmp_ge_u32 s2, 8
    s_cbranch_scc1 Lpf_1
    s_getpc_b64 s[4:5]
    s_and_b32 s4, s4, 0xffffff00
    v_lshlrev_b32 v2, 4, v0
    v_min_u32 v3, L_end-concat_heads__compressed_kv_cla__gqa_block_cached__decode_kernel-16, v2
    global_load_dwordx4 v[252:255], v3, s[4:5]
    v_add_u32 v2, 0x2000, v2
    v_min_u32 v3, L_end-concat_heads__compressed_kv_cla__gqa_block_cached__decode_kernel-16, v2
    global_load_dwordx4 v[252:255], v3, s[4:5]
    v_add_u32 v2, 0x2000, v2
    v_min_u32 v3, L_end-concat_heads__compressed_kv_cla__gqa_block_cached__decode_kernel-16, v2
    global_load_dwordx4 v[252:255], v3, s[4:5]
    v_add_u32 v2, 0x2000, v2
    v_min_u32 v3, L_end-concat_heads__compressed_kv_cla__gqa_block_cached__decode_kernel-16, v2
    global_load_dwordx4 v[252:255], v3, s[4:5]
Lpf_1:
    s_load_dwordx16 s[4:19], s[0:1], 0
    s_load_dwordx8 s[20:27], s[0:1], 64
    s_load_dwordx4 s[28:31], s[0:1], 96
    v_lshrrev_b32 v1, 6, v0
    s_lshr_b32 s57, s2, 3
    v_readfirstlane_b32 s56, v1
    s_and_b32 s58, s2, 7
    s_mov_b32 s34, 268435456
    s_mov_b32 s35, 0x00020000
    s_mov_b32 s54, 256
    s_mov_b32 s55, 0x00020000
    s_nop 0
    s_and_b32 s59, s57, 3
    s_lshl_b32 s60, s58, 2
    s_add_u32 s59, s59, s60
    s_bfe_u32 s60, s57, 0x10002
    s_bfe_u32 s62, s57, 0x10003
    s_lshr_b32 s78, s57, 4
    s_lshl_b32 s3, s78, 5
    s_add_u32 s3, s3, s59
    s_lshl_b32 s3, s3, 2
    s_add_u32 s3, s3, s62
    s_lshl_b32 s3, s3, 1
    s_add_u32 s3, s3, s60
    s_lshl_b32 s3, s3, 8
    s_add_u32 s3, s3, 1310720
    s_and_b32 s91, s59, 0xfc
    v_and_b32 v228, 63, v0
    v_lshrrev_b32 v229, 3, v228
    v_and_b32 v230, 7, v228
    v_lshlrev_b32 v231, 3, v229
    v_lshlrev_b32 v232, 15, v229
    v_lshl_add_u32 v232, v230, 4, v232
    s_lshl_b32 s76, s56, 6
    s_lshl_b32 s62, s62, 9
    s_add_u32 s76, s76, s62
    s_lshl_b32 s77, s76, 12
    s_lshl_b32 s59, s59, 8
    s_lshl_b32 s60, s60, 7
    s_add_u32 s77, s77, s59
    s_add_u32 s77, s77, s60
    s_mov_b32 s38, 4194304
    s_mov_b32 s39, 0x00020000
    s_mov_b32 s42, 2048
    s_mov_b32 s43, 0x00020000
    s_mov_b32 s68, 0x05040100
    s_mov_b32 s69, 0x07060302
    s_cmp_lt_u32 s57, 8
    s_cbranch_scc1 L_roleA
    s_waitcnt lgkmcnt(0)
    s_mov_b32 s32, s30
    s_and_b32 s33, s31, 0xffff
    s_mov_b32 s52, s28
    s_and_b32 s53, s29, 0xffff
    s_cmp_eq_u32 s78, 0
    s_cselect_b32 s36, s8, s22
    s_cselect_b32 s37, s9, s23
    s_cselect_b32 s40, s4, s16
    s_cselect_b32 s41, s5, s17
    s_and_b32 s37, s37, 0xffff
    s_and_b32 s41, s41, 0xffff
    buffer_load_dwordx4 v[192:195], v232, s[36:39], s77 offen nt
    s_add_u32 s77, s77, 8192
    buffer_load_dwordx4 v[196:199], v232, s[36:39], s77 offen nt
    s_add_u32 s77, s77, 8192
    buffer_load_dwordx4 v[200:203], v232, s[36:39], s77 offen nt
    s_add_u32 s77, s77, 8192
    buffer_load_dwordx4 v[204:207], v232, s[36:39], s77 offen nt
    buffer_load_dwordx2 v[208:209], v231, s[40:43], s76 offen offset:0
    buffer_load_dwordx2 v[210:211], v231, s[40:43], s76 offen offset:1024
    s_sub_u32 s57, s57, 8
    s_mul_i32 s59, s57, 43
    s_lshr_b32 s59, s59, 8
    s_mul_i32 s60, s59, 6
    s_sub_u32 s60, s57, s60
    s_mul_i32 s66, s60, 86
    s_lshr_b32 s66, s66, 8
    s_mul_i32 s61, s66, 3
    s_sub_u32 s67, s60, s61
    s_mov_b32 s64, s60
    s_mul_i32 s65, s67, 3
    s_add_u32 s65, s65, s58
    s_and_b32 s65, s65, 7
    s_lshl_b32 s65, s65, 2
    s_add_u32 s65, s65, s59
    v_and_b32 v1, 63, v0
    v_lshrrev_b32 v2, 4, v1
    v_and_b32 v3, 15, v1
    s_lshl_b32 s59, s66, 5
    s_add_u32 s59, s59, s65
    s_lshl_b32 s61, s59, 20
    s_lshl_b32 s63, s59, 8
    s_add_u32 s63, s63, 1507328
    v_lshlrev_b32 v4, 4, v1
    s_mov_b32 s70, 1040356334
    v_mov_b32 v60, 0
    s_mul_i32 s71, s67, 7
    s_add_u32 s71, s71, s56
    s_mov_b32 s46, 1048576
    s_mov_b32 s47, 0x00020000
    s_mov_b32 s50, 1048576
    s_mov_b32 s51, 0x00020000
    s_add_u32 s44, s18, s61
    s_addc_u32 s45, s19, 0
    s_and_b32 s45, s45, 0xffff
    s_add_u32 s48, s20, s61
    s_addc_u32 s49, s21, 0
    s_and_b32 s49, s49, 0xffff
    s_barrier
    s_mov_b32 s74, 256
    s_add_u32 s72, s71, 21
    s_cmp_eq_u32 s56, 7
    s_cbranch_scc1 Lpoller_2
    s_add_u32 s88, s71, 0
    s_lshl_b32 s100, s88, 12
    buffer_load_dwordx4 v[64:67], v4, s[44:47], s100 offen offset:0 nt
    buffer_load_dwordx4 v[68:71], v4, s[44:47], s100 offen offset:1024 nt
    buffer_load_dwordx4 v[72:75], v4, s[44:47], s100 offen offset:2048 nt
    buffer_load_dwordx4 v[76:79], v4, s[44:47], s100 offen offset:3072 nt
    s_waitcnt vmcnt(4)
    v_perm_b32 v232, v196, v192, s68
    v_perm_b32 v233, v196, v192, s69
    v_perm_b32 v234, v197, v193, s68
    v_perm_b32 v235, v197, v193, s69
    v_perm_b32 v236, v198, v194, s68
    v_perm_b32 v237, v198, v194, s69
    v_perm_b32 v238, v199, v195, s68
    v_perm_b32 v239, v199, v195, s69
    v_dot2_f32_bf16 v212, v232, v208, 0
    v_dot2_f32_bf16 v213, v233, v208, 0
    v_dot2_f32_bf16 v214, v234, v208, 0
    v_dot2_f32_bf16 v215, v235, v208, 0
    v_dot2_f32_bf16 v216, v236, v208, 0
    v_dot2_f32_bf16 v217, v237, v208, 0
    v_dot2_f32_bf16 v218, v238, v208, 0
    v_dot2_f32_bf16 v219, v239, v208, 0
    v_dot2_f32_bf16 v220, v232, v210, 0
    v_dot2_f32_bf16 v221, v233, v210, 0
    v_dot2_f32_bf16 v222, v234, v210, 0
    v_dot2_f32_bf16 v223, v235, v210, 0
    v_dot2_f32_bf16 v224, v236, v210, 0
    v_dot2_f32_bf16 v225, v237, v210, 0
    v_dot2_f32_bf16 v226, v238, v210, 0
    v_dot2_f32_bf16 v227, v239, v210, 0
    v_perm_b32 v232, v204, v200, s68
    v_perm_b32 v233, v204, v200, s69
    v_perm_b32 v234, v205, v201, s68
    v_perm_b32 v235, v205, v201, s69
    v_perm_b32 v236, v206, v202, s68
    v_perm_b32 v237, v206, v202, s69
    v_perm_b32 v238, v207, v203, s68
    v_perm_b32 v239, v207, v203, s69
    v_dot2_f32_bf16 v212, v232, v209, v212
    v_dot2_f32_bf16 v213, v233, v209, v213
    v_dot2_f32_bf16 v214, v234, v209, v214
    v_dot2_f32_bf16 v215, v235, v209, v215
    v_dot2_f32_bf16 v216, v236, v209, v216
    v_dot2_f32_bf16 v217, v237, v209, v217
    v_dot2_f32_bf16 v218, v238, v209, v218
    v_dot2_f32_bf16 v219, v239, v209, v219
    v_dot2_f32_bf16 v220, v232, v211, v220
    v_dot2_f32_bf16 v221, v233, v211, v221
    v_dot2_f32_bf16 v222, v234, v211, v222
    v_dot2_f32_bf16 v223, v235, v211, v223
    v_dot2_f32_bf16 v224, v236, v211, v224
    v_dot2_f32_bf16 v225, v237, v211, v225
    v_dot2_f32_bf16 v226, v238, v211, v226
    v_dot2_f32_bf16 v227, v239, v211, v227
    s_nop 2
    v_permlane32_swap_b32 v212, v220
    v_permlane32_swap_b32 v213, v221
    v_permlane32_swap_b32 v214, v222
    v_permlane32_swap_b32 v215, v223
    v_permlane32_swap_b32 v216, v224
    v_permlane32_swap_b32 v217, v225
    v_permlane32_swap_b32 v218, v226
    v_permlane32_swap_b32 v219, v227
    s_nop 1
    v_add_f32 v212, v212, v220
    v_add_f32 v213, v213, v221
    v_add_f32 v214, v214, v222
    v_add_f32 v215, v215, v223
    v_add_f32 v216, v216, v224
    v_add_f32 v217, v217, v225
    v_add_f32 v218, v218, v226
    v_add_f32 v219, v219, v227
    s_nop 1
    v_permlane16_swap_b32 v212, v216
    v_permlane16_swap_b32 v213, v217
    v_permlane16_swap_b32 v214, v218
    v_permlane16_swap_b32 v215, v219
    s_nop 1
    v_add_f32 v212, v212, v216
    v_add_f32 v213, v213, v217
    v_add_f32 v214, v214, v218
    v_add_f32 v215, v215, v219
    s_nop 1
    v_add_f32_dpp v212, v212, v212 row_ror:8 row_mask:0xf bank_mask:0xf
    v_add_f32_dpp v213, v213, v213 row_ror:8 row_mask:0xf bank_mask:0xf
    v_add_f32_dpp v214, v214, v214 row_ror:8 row_mask:0xf bank_mask:0xf
    v_add_f32_dpp v215, v215, v215 row_ror:8 row_mask:0xf bank_mask:0xf
    v_lshrrev_b32 v232, 5, v228
    v_lshlrev_b32 v232, 8, v232
    v_bfe_u32 v233, v228, 4, 1
    v_lshl_add_u32 v232, v233, 4, v232
    v_lshl_add_u32 v232, v230, 5, v232
    s_lshl_b32 s61, s56, 9
    s_add_u32 s61, s61, 12288
    v_add_u32 v232, s61, v232
    ds_write_b128 v232, v[212:215]
    s_waitcnt lgkmcnt(0)
    s_barrier
    s_waitcnt vmcnt(3)
    buffer_load_dwordx4 v[80:83], v4, s[48:51], s100 offen offset:0 nt
    s_waitcnt vmcnt(3)
    buffer_load_dwordx4 v[84:87], v4, s[48:51], s100 offen offset:1024 nt
    s_waitcnt vmcnt(3)
    buffer_load_dwordx4 v[88:91], v4, s[48:51], s100 offen offset:2048 nt
    s_waitcnt vmcnt(3)
    buffer_load_dwordx4 v[92:95], v4, s[48:51], s100 offen offset:3072 nt
    s_add_u32 s88, s71, 21
    s_lshl_b32 s100, s88, 12
    s_waitcnt vmcnt(3)
    buffer_load_dwordx4 v[96:99], v4, s[44:47], s100 offen offset:0 nt
    s_waitcnt vmcnt(3)
    buffer_load_dwordx4 v[100:103], v4, s[44:47], s100 offen offset:1024 nt
    s_waitcnt vmcnt(3)
    buffer_load_dwordx4 v[104:107], v4, s[44:47], s100 offen offset:2048 nt
    s_waitcnt vmcnt(3)
    buffer_load_dwordx4 v[108:111], v4, s[44:47], s100 offen offset:3072 nt
    s_waitcnt vmcnt(3)
    buffer_load_dwordx4 v[112:115], v4, s[48:51], s100 offen offset:0 nt
    s_waitcnt vmcnt(3)
    buffer_load_dwordx4 v[116:119], v4, s[48:51], s100 offen offset:1024 nt
    s_waitcnt vmcnt(3)
    buffer_load_dwordx4 v[120:123], v4, s[48:51], s100 offen offset:2048 nt
    s_waitcnt vmcnt(3)
    buffer_load_dwordx4 v[124:127], v4, s[48:51], s100 offen offset:3072 nt
    s_add_u32 s88, s71, 42
    s_lshl_b32 s100, s88, 12
    s_waitcnt vmcnt(3)
    buffer_load_dwordx4 v[128:131], v4, s[44:47], s100 offen offset:0 nt
    s_waitcnt vmcnt(3)
    buffer_load_dwordx4 v[132:135], v4, s[44:47], s100 offen offset:1024 nt
    s_waitcnt vmcnt(3)
    buffer_load_dwordx4 v[136:139], v4, s[44:47], s100 offen offset:2048 nt
    s_waitcnt vmcnt(3)
    buffer_load_dwordx4 v[140:143], v4, s[44:47], s100 offen offset:3072 nt
    s_waitcnt vmcnt(3)
    buffer_load_dwordx4 v[144:147], v4, s[48:51], s100 offen offset:0 nt
    s_waitcnt vmcnt(3)
    buffer_load_dwordx4 v[148:151], v4, s[48:51], s100 offen offset:1024 nt
    s_waitcnt vmcnt(3)
    buffer_load_dwordx4 v[152:155], v4, s[48:51], s100 offen offset:2048 nt
    s_waitcnt vmcnt(3)
    buffer_load_dwordx4 v[156:159], v4, s[48:51], s100 offen offset:3072 nt
    s_add_u32 s88, s71, 63
    s_lshl_b32 s100, s88, 12
    s_waitcnt vmcnt(3)
    buffer_load_dwordx4 v[160:163], v4, s[44:47], s100 offen offset:0 nt
    s_waitcnt vmcnt(3)
    buffer_load_dwordx4 v[164:167], v4, s[44:47], s100 offen offset:1024 nt
    s_waitcnt vmcnt(3)
    buffer_load_dwordx4 v[168:171], v4, s[44:47], s100 offen offset:2048 nt
    s_waitcnt vmcnt(3)
    buffer_load_dwordx4 v[172:175], v4, s[44:47], s100 offen offset:3072 nt
    s_waitcnt vmcnt(3)
    buffer_load_dwordx4 v[176:179], v4, s[48:51], s100 offen offset:0 nt
    s_waitcnt vmcnt(3)
    buffer_load_dwordx4 v[180:183], v4, s[48:51], s100 offen offset:1024 nt
    s_waitcnt vmcnt(3)
    buffer_load_dwordx4 v[184:187], v4, s[48:51], s100 offen offset:2048 nt
    s_waitcnt vmcnt(3)
    buffer_load_dwordx4 v[188:191], v4, s[48:51], s100 offen offset:3072 nt
    s_branch Ljoin_3
Lpoller_2:
    s_setprio 3
    s_waitcnt vmcnt(0)
    v_perm_b32 v232, v196, v192, s68
    v_perm_b32 v233, v196, v192, s69
    v_perm_b32 v234, v197, v193, s68
    v_perm_b32 v235, v197, v193, s69
    v_perm_b32 v236, v198, v194, s68
    v_perm_b32 v237, v198, v194, s69
    v_perm_b32 v238, v199, v195, s68
    v_perm_b32 v239, v199, v195, s69
    v_dot2_f32_bf16 v212, v232, v208, 0
    v_dot2_f32_bf16 v213, v233, v208, 0
    v_dot2_f32_bf16 v214, v234, v208, 0
    v_dot2_f32_bf16 v215, v235, v208, 0
    v_dot2_f32_bf16 v216, v236, v208, 0
    v_dot2_f32_bf16 v217, v237, v208, 0
    v_dot2_f32_bf16 v218, v238, v208, 0
    v_dot2_f32_bf16 v219, v239, v208, 0
    v_dot2_f32_bf16 v220, v232, v210, 0
    v_dot2_f32_bf16 v221, v233, v210, 0
    v_dot2_f32_bf16 v222, v234, v210, 0
    v_dot2_f32_bf16 v223, v235, v210, 0
    v_dot2_f32_bf16 v224, v236, v210, 0
    v_dot2_f32_bf16 v225, v237, v210, 0
    v_dot2_f32_bf16 v226, v238, v210, 0
    v_dot2_f32_bf16 v227, v239, v210, 0
    v_perm_b32 v232, v204, v200, s68
    v_perm_b32 v233, v204, v200, s69
    v_perm_b32 v234, v205, v201, s68
    v_perm_b32 v235, v205, v201, s69
    v_perm_b32 v236, v206, v202, s68
    v_perm_b32 v237, v206, v202, s69
    v_perm_b32 v238, v207, v203, s68
    v_perm_b32 v239, v207, v203, s69
    v_dot2_f32_bf16 v212, v232, v209, v212
    v_dot2_f32_bf16 v213, v233, v209, v213
    v_dot2_f32_bf16 v214, v234, v209, v214
    v_dot2_f32_bf16 v215, v235, v209, v215
    v_dot2_f32_bf16 v216, v236, v209, v216
    v_dot2_f32_bf16 v217, v237, v209, v217
    v_dot2_f32_bf16 v218, v238, v209, v218
    v_dot2_f32_bf16 v219, v239, v209, v219
    v_dot2_f32_bf16 v220, v232, v211, v220
    v_dot2_f32_bf16 v221, v233, v211, v221
    v_dot2_f32_bf16 v222, v234, v211, v222
    v_dot2_f32_bf16 v223, v235, v211, v223
    v_dot2_f32_bf16 v224, v236, v211, v224
    v_dot2_f32_bf16 v225, v237, v211, v225
    v_dot2_f32_bf16 v226, v238, v211, v226
    v_dot2_f32_bf16 v227, v239, v211, v227
    s_nop 2
    v_permlane32_swap_b32 v212, v220
    v_permlane32_swap_b32 v213, v221
    v_permlane32_swap_b32 v214, v222
    v_permlane32_swap_b32 v215, v223
    v_permlane32_swap_b32 v216, v224
    v_permlane32_swap_b32 v217, v225
    v_permlane32_swap_b32 v218, v226
    v_permlane32_swap_b32 v219, v227
    s_nop 1
    v_add_f32 v212, v212, v220
    v_add_f32 v213, v213, v221
    v_add_f32 v214, v214, v222
    v_add_f32 v215, v215, v223
    v_add_f32 v216, v216, v224
    v_add_f32 v217, v217, v225
    v_add_f32 v218, v218, v226
    v_add_f32 v219, v219, v227
    s_nop 1
    v_permlane16_swap_b32 v212, v216
    v_permlane16_swap_b32 v213, v217
    v_permlane16_swap_b32 v214, v218
    v_permlane16_swap_b32 v215, v219
    s_nop 1
    v_add_f32 v212, v212, v216
    v_add_f32 v213, v213, v217
    v_add_f32 v214, v214, v218
    v_add_f32 v215, v215, v219
    s_nop 1
    v_add_f32_dpp v212, v212, v212 row_ror:8 row_mask:0xf bank_mask:0xf
    v_add_f32_dpp v213, v213, v213 row_ror:8 row_mask:0xf bank_mask:0xf
    v_add_f32_dpp v214, v214, v214 row_ror:8 row_mask:0xf bank_mask:0xf
    v_add_f32_dpp v215, v215, v215 row_ror:8 row_mask:0xf bank_mask:0xf
    v_lshrrev_b32 v232, 5, v228
    v_lshlrev_b32 v232, 8, v232
    v_bfe_u32 v233, v228, 4, 1
    v_lshl_add_u32 v232, v233, 4, v232
    v_lshl_add_u32 v232, v230, 5, v232
    s_lshl_b32 s61, s56, 9
    s_add_u32 s61, s61, 12288
    v_add_u32 v232, s61, v232
    ds_write_b128 v232, v[212:215]
    s_waitcnt lgkmcnt(0)
    s_barrier
    v_mov_b32 v234, 0
    buffer_load_dword v235, v234, s[52:55], s91 offen offset:0 sc0 sc1
    v_and_b32 v232, 31, v228
    v_lshlrev_b32 v233, 4, v232
    v_add_u32 v233, 12288, v233
    ds_read_b128 v[192:195], v233 offset:0
    ds_read_b128 v[196:199], v233 offset:512
    ds_read_b128 v[200:203], v233 offset:1024
    ds_read_b128 v[204:207], v233 offset:1536
    ds_read_b128 v[208:211], v233 offset:2048
    ds_read_b128 v[212:215], v233 offset:2560
    ds_read_b128 v[216:219], v233 offset:3072
    ds_read_b128 v[220:223], v233 offset:3584
    s_waitcnt lgkmcnt(6)
    v_add_f32 v192, v192, v196
    v_add_f32 v193, v193, v197
    v_add_f32 v194, v194, v198
    v_add_f32 v195, v195, v199
    s_waitcnt lgkmcnt(5)
    v_add_f32 v192, v192, v200
    v_add_f32 v193, v193, v201
    v_add_f32 v194, v194, v202
    v_add_f32 v195, v195, v203
    s_waitcnt lgkmcnt(4)
    v_add_f32 v192, v192, v204
    v_add_f32 v193, v193, v205
    v_add_f32 v194, v194, v206
    v_add_f32 v195, v195, v207
    s_waitcnt lgkmcnt(3)
    v_add_f32 v192, v192, v208
    v_add_f32 v193, v193, v209
    v_add_f32 v194, v194, v210
    v_add_f32 v195, v195, v211
    s_waitcnt lgkmcnt(2)
    v_add_f32 v192, v192, v212
    v_add_f32 v193, v193, v213
    v_add_f32 v194, v194, v214
    v_add_f32 v195, v195, v215
    s_waitcnt lgkmcnt(1)
    v_add_f32 v192, v192, v216
    v_add_f32 v193, v193, v217
    v_add_f32 v194, v194, v218
    v_add_f32 v195, v195, v219
    s_waitcnt lgkmcnt(0)
    v_add_f32 v192, v192, v220
    v_add_f32 v193, v193, v221
    v_add_f32 v194, v194, v222
    v_add_f32 v195, v195, v223
    v_lshrrev_b32 v233, 4, v232
    v_lshlrev_b32 v233, 10, v233
    v_and_b32 v232, 15, v232
    v_lshl_add_u32 v233, v232, 4, v233
    s_waitcnt vmcnt(0)
    s_mov_b32 s92, 0
Lcf_4:
    v_readfirstlane_b32 s57, v235
    s_nop 3
    s_cmp_lg_u32 s57, 0
    s_cbranch_scc1 Lcfd_5
    s_sleep 2
    buffer_load_dword v235, v234, s[52:55], s91 offen offset:0 sc0 sc1
    s_waitcnt vmcnt(0)
    s_add_u32 s92, s92, 1
    s_cmp_lt_u32 s92, 400000
    s_cbranch_scc1 Lcf_4
Lcfd_5:
    s_mov_b64 exec, 0xffffffff
    buffer_store_dwordx4 v[192:195], v233, s[32:35], s3 offen sc0 sc1
    s_mov_b64 exec, -1
    s_and_b32 s91, s65, 0xfc
    v_mov_b32 v44, 0
    v_mov_b32 v45, 0
    s_mov_b32 s92, 0
Lcf_6:
    v_readfirstlane_b32 s57, v45
    s_nop 3
    s_cmp_lg_u32 s57, 0
    s_cbranch_scc1 Lcfd_7
    s_sleep 2
    buffer_load_dword v45, v44, s[52:55], s91 offen offset:0 sc0 sc1
    s_waitcnt vmcnt(0)
    s_add_u32 s92, s92, 1
    s_cmp_lt_u32 s92, 400000
    s_cbranch_scc1 Lcf_6
Lcfd_7:
    v_lshlrev_b32 v40, 4, v1
    s_lshl_b32 s61, s65, 11
    s_lshl_b32 s62, s66, 10
    s_add_u32 s61, s61, s62
    s_add_u32 s61, s61, 1376256
    s_mov_b32 s92, 0
Lpoll_8:
    buffer_load_dwordx4 v[48:51], v40, s[32:35], s61 offen sc0 sc1
    s_waitcnt vmcnt(0)
    v_mov_b32 v41, v48
    v_max3_u32 v41, v41, v49, v50
    v_max_u32 v41, v41, v51
    v_cmpx_eq_u32 vcc, -1, v41
    s_cbranch_execz Lpolld_9
    s_sleep 4
    s_add_u32 s92, s92, 1
    s_cmp_lt_u32 s92, 400000
    s_cbranch_scc1 Lpoll_8
Lpolld_9:
    s_mov_b64 exec, -1
    v_mov_b32 v52, v48
    v_mov_b32 v53, v49
    v_mov_b32 v54, v50
    v_mov_b32 v55, v51
    s_nop 1
    v_permlane32_swap_b32 v48, v52
    v_permlane32_swap_b32 v49, v53
    v_permlane32_swap_b32 v50, v54
    v_permlane32_swap_b32 v51, v55
    s_nop 1
    v_add_f32 v48, v48, v52
    v_add_f32 v49, v49, v53
    v_add_f32 v50, v50, v54
    v_add_f32 v51, v51, v55
    v_cvt_pk_bf16_f32 v48, v48, v49
    v_cvt_pk_bf16_f32 v49, v50, v51
    v_mov_b32 v44, 0
    s_mov_b32 s92, 0
Lcf_10:
    buffer_load_dword v45, v44, s[52:55], 0 offen offset:128 sc0 sc1
    s_waitcnt vmcnt(0)
    v_readfirstlane_b32 s57, v45
    s_nop 3
    s_cmp_ge_u32 s57, 64
    s_cbranch_scc1 Lcfd_11
    s_sleep 16
    s_add_u32 s92, s92, 1
    s_cmp_lt_u32 s92, 400000
    s_cbranch_scc1 Lcf_10
Lcfd_11:
    v_and_b32 v42, 31, v1
    v_lshlrev_b32 v42, 3, v42
    ds_write_b64 v42, v[48:49] offset:0
    s_waitcnt lgkmcnt(0)
    v_mov_b32 v40, 0xff7fffff
    v_mov_b32 v41, 0
    v_mov_b32 v42, 56
    ds_write_b64 v42, v[40:41] offset:8192
    v_mov_b32 v40, 0
    v_lshlrev_b32 v42, 3, v1
    ds_write_b64 v42, v[40:41] offset:7680
    v_mov_b32 v42, 256
    ds_write_b32 v42, v40
    s_mul_i32 s61, s67, 12
    s_add_u32 s61, s61, 84
    v_add_u32 v40, s61, v1
    v_cmp_gt_u32 vcc, 12, v1
    v_mov_b32 v41, -1
    v_lshlrev_b32 v43, 2, v1
    v_cndmask_b32 v40, v41, v40, vcc
    ds_write_b32 v43, v40 offset:1024
    ds_write_b32 v43, v41 offset:1280
    ds_write_b32 v43, v41 offset:1536
    ds_write_b32 v43, v41 offset:1792
    ds_write_b32 v43, v41 offset:2048
    v_mov_b32 v40, 7
    ds_write_b32 v42, v40
    s_waitcnt lgkmcnt(0)
    s_barrier
    s_mov_b32 s84, 12
    s_mov_b32 s86, 10
    v_mov_b32 v42, 256
    s_mov_b32 s92, 0
Lprod_12:
    s_add_u32 s92, s92, 1
    s_cmp_gt_u32 s92, 400000
    s_cbranch_scc1 Lprods_14
    ds_read_b32 v40, v42
    s_waitcnt lgkmcnt(0)
    v_readfirstlane_b32 s85, v40
    s_nop 3
    s_add_u32 s85, s85, 10
    s_sub_i32 s85, s85, s84
    s_cmp_gt_i32 s85, 0
    s_cbranch_scc1 Lprodg_15
    s_sleep 1
    s_branch Lprod_12
Lprodg_15:
    s_min_u32 s85, s85, 8
    s_bfm_b64 exec, s85, 0
    v_mov_b32 v44, 1
    buffer_atomic_add v44, v60, s[32:35], s63 offen sc0 sc1
    s_waitcnt vmcnt(0)
    v_add_u32 v44, 4294901880, v44
    v_cmp_gt_u32 vcc, 256, v44
    s_mov_b64 s[94:95], exec
    s_nop 1
    v_mbcnt_lo_u32_b32 v45, vcc_lo, 0
    s_bcnt1_i32_b64 s85, vcc
    v_add_u32 v45, s84, v45
    v_lshlrev_b32 v45, 2, v45
    s_mov_b64 exec, vcc
    s_cbranch_execz Lprodn_16
    ds_write_b32 v45, v44 offset:1024
Lprodn_16:
    s_add_u32 s84, s84, s85
    s_cmp_eq_u64 vcc, s[94:95]
    s_mov_b64 exec, -1
    s_cbranch_scc1 Lprod_12
Lprods_14:
    s_mov_b64 exec, -1
    v_add_u32 v45, s84, v1
    v_lshlrev_b32 v45, 2, v45
    v_mov_b32 v44, 0x1000
    s_mov_b64 exec, 0xff
    ds_write_b32 v45, v44 offset:1024
    s_mov_b64 exec, -1
    s_waitcnt lgkmcnt(0)
    s_barrier
    s_branch L_end
Ljoin_3:
    s_barrier
    v_lshlrev_b32 v40, 4, v3
    ds_read_b128 v[24:27], v40 offset:0
    s_mul_i32 s62, s67, 7
    s_add_u32 s62, s62, s56
    s_add_u32 s73, s62, 84
    s_mul_i32 s61, s67, 12
    s_add_u32 s61, s61, 84
    s_add_u32 s73, s61, s56
    s_mov_b32 s83, 114
    v_mov_b32 v61, 256
    v_mov_b32 v5, 1
    v_mov_b32 v36, 0xff7fffff
    v_mov_b32 v37, 0
    v_mov_b32 v16, 0
    v_mov_b32 v17, 0
    v_mov_b32 v18, 0
    v_mov_b32 v19, 0
    v_mov_b32 v20, 0
    v_mov_b32 v21, 0
    v_mov_b32 v22, 0
    v_mov_b32 v23, 0
    v_lshlrev_b32 v6, 5, v3
    v_lshl_add_u32 v6, v2, 3, v6
    s_lshl_b32 s61, s56, 9
    v_add_u32 v7, s61, v6
    s_waitcnt lgkmcnt(0)
    s_lshl_b32 s100, s73, 12
    s_mov_b32 s71, s73
    v_dot2_f32_bf16 v28, v64, v24, 0
    v_dot2_f32_bf16 v28, v65, v25, v28
    v_dot2_f32_bf16 v28, v66, v26, v28
    v_dot2_f32_bf16 v28, v67, v27, v28
    s_waitcnt vmcnt(3)
    buffer_load_dwordx4 v[64:67], v4, s[44:47], s100 offen offset:0 nt
    v_dot2_f32_bf16 v29, v68, v24, 0
    v_dot2_f32_bf16 v29, v69, v25, v29
    v_dot2_f32_bf16 v29, v70, v26, v29
    v_dot2_f32_bf16 v29, v71, v27, v29
    s_waitcnt vmcnt(3)
    buffer_load_dwordx4 v[68:71], v4, s[44:47], s100 offen offset:1024 nt
    v_dot2_f32_bf16 v30, v72, v24, 0
    v_dot2_f32_bf16 v30, v73, v25, v30
    v_dot2_f32_bf16 v30, v74, v26, v30
    v_dot2_f32_bf16 v30, v75, v27, v30
    s_waitcnt vmcnt(3)
    buffer_load_dwordx4 v[72:75], v4, s[44:47], s100 offen offset:2048 nt
    v_dot2_f32_bf16 v31, v76, v24, 0
    v_dot2_f32_bf16 v31, v77, v25, v31
    v_dot2_f32_bf16 v31, v78, v26, v31
    v_dot2_f32_bf16 v31, v79, v27, v31
    s_waitcnt vmcnt(3)
    buffer_load_dwordx4 v[76:79], v4, s[44:47], s100 offen offset:3072 nt
    s_nop 2
    v_add_f32_dpp v28, v28, v28 row_ror:8 row_mask:0xf bank_mask:0xf
    v_add_f32_dpp v29, v29, v29 row_ror:8 row_mask:0xf bank_mask:0xf
    v_add_f32_dpp v30, v30, v30 row_ror:8 row_mask:0xf bank_mask:0xf
    v_add_f32_dpp v31, v31, v31 row_ror:8 row_mask:0xf bank_mask:0xf
    v_add_f32_dpp v28, v28, v28 row_ror:4 row_mask:0xf bank_mask:0xf
    v_add_f32_dpp v29, v29, v29 row_ror:4 row_mask:0xf bank_mask:0xf
    v_add_f32_dpp v30, v30, v30 row_ror:4 row_mask:0xf bank_mask:0xf
    v_add_f32_dpp v31, v31, v31 row_ror:4 row_mask:0xf bank_mask:0xf
    v_add_f32_dpp v28, v28, v28 row_ror:2 row_mask:0xf bank_mask:0xf
    v_add_f32_dpp v29, v29, v29 row_ror:2 row_mask:0xf bank_mask:0xf
    v_add_f32_dpp v30, v30, v30 row_ror:2 row_mask:0xf bank_mask:0xf
    v_add_f32_dpp v31, v31, v31 row_ror:2 row_mask:0xf bank_mask:0xf
    v_add_f32_dpp v28, v28, v28 row_ror:1 row_mask:0xf bank_mask:0xf
    v_add_f32_dpp v29, v29, v29 row_ror:1 row_mask:0xf bank_mask:0xf
    v_add_f32_dpp v30, v30, v30 row_ror:1 row_mask:0xf bank_mask:0xf
    v_add_f32_dpp v31, v31, v31 row_ror:1 row_mask:0xf bank_mask:0xf
    v_max3_f32 v38, v36, v28, v29
    v_max3_f32 v38, v38, v30, v31
    v_sub_f32 v39, v36, v38
    v_mul_f32 v39, s70, v39
    v_exp_f32 v39, v39
    v_mul_f32 v56, s70, v38
    v_mov_b32 v36, v38
    v_fma_f32 v48, v28, s70, -v56
    v_fma_f32 v49, v29, s70, -v56
    v_fma_f32 v50, v30, s70, -v56
    v_fma_f32 v51, v31, s70, -v56
    v_exp_f32 v48, v48
    v_exp_f32 v49, v49
    v_exp_f32 v50, v50
    v_exp_f32 v51, v51
    v_mul_f32 v37, v37, v39
    v_mul_f32 v16, v16, v39
    v_mul_f32 v17, v17, v39
    v_mul_f32 v18, v18, v39
    v_mul_f32 v19, v19, v39
    v_mul_f32 v20, v20, v39
    v_mul_f32 v21, v21, v39
    v_mul_f32 v22, v22, v39
    v_mul_f32 v23, v23, v39
    v_add_f32 v37, v37, v48
    v_add_f32 v37, v37, v49
    v_add_f32 v37, v37, v50
    v_add_f32 v37, v37, v51
    v_lshlrev_b32 v40, 16, v80
    v_and_b32 v41, 0xffff0000, v80
    v_lshlrev_b32 v42, 16, v81
    v_and_b32 v43, 0xffff0000, v81
    v_lshlrev_b32 v44, 16, v82
    v_and_b32 v45, 0xffff0000, v82
    v_lshlrev_b32 v46, 16, v83
    v_and_b32 v47, 0xffff0000, v83
    s_waitcnt vmcnt(3)
    buffer_load_dwordx4 v[80:83], v4, s[48:51], s100 offen offset:0 nt
    v_fmac_f32 v16, v40, v48
    v_fmac_f32 v17, v41, v48
    v_fmac_f32 v18, v42, v48
    v_fmac_f32 v19, v43, v48
    v_fmac_f32 v20, v44, v48
    v_fmac_f32 v21, v45, v48
    v_fmac_f32 v22, v46, v48
    v_fmac_f32 v23, v47, v48
    v_lshlrev_b32 v40, 16, v84
    v_and_b32 v41, 0xffff0000, v84
    v_lshlrev_b32 v42, 16, v85
    v_and_b32 v43, 0xffff0000, v85
    v_lshlrev_b32 v44, 16, v86
    v_and_b32 v45, 0xffff0000, v86
    v_lshlrev_b32 v46, 16, v87
    v_and_b32 v47, 0xffff0000, v87
    s_waitcnt vmcnt(3)
    buffer_load_dwordx4 v[84:87], v4, s[48:51], s100 offen offset:1024 nt
    v_fmac_f32 v16, v40, v49
    v_fmac_f32 v17, v41, v49
    v_fmac_f32 v18, v42, v49
    v_fmac_f32 v19, v43, v49
    v_fmac_f32 v20, v44, v49
    v_fmac_f32 v21, v45, v49
    v_fmac_f32 v22, v46, v49
    v_fmac_f32 v23, v47, v49
    v_lshlrev_b32 v40, 16, v88
    v_and_b32 v41, 0xffff0000, v88
    v_lshlrev_b32 v42, 16, v89
    v_and_b32 v43, 0xffff0000, v89
    v_lshlrev_b32 v44, 16, v90
    v_and_b32 v45, 0xffff0000, v90
    v_lshlrev_b32 v46, 16, v91
    v_and_b32 v47, 0xffff0000, v91
    s_waitcnt vmcnt(3)
    buffer_load_dwordx4 v[88:91], v4, s[48:51], s100 offen offset:2048 nt
    v_fmac_f32 v16, v40, v50
    v_fmac_f32 v17, v41, v50
    v_fmac_f32 v18, v42, v50
    v_fmac_f32 v19, v43, v50
    v_fmac_f32 v20, v44, v50
    v_fmac_f32 v21, v45, v50
    v_fmac_f32 v22, v46, v50
    v_fmac_f32 v23, v47, v50
    v_lshlrev_b32 v40, 16, v92
    v_and_b32 v41, 0xffff0000, v92
    v_lshlrev_b32 v42, 16, v93
    v_and_b32 v43, 0xffff0000, v93
    v_lshlrev_b32 v44, 16, v94
    v_and_b32 v45, 0xffff0000, v94
    v_lshlrev_b32 v46, 16, v95
    v_and_b32 v47, 0xffff0000, v95
    s_waitcnt vmcnt(3)
    buffer_load_dwordx4 v[92:95], v4, s[48:51], s100 offen offset:3072 nt
    v_fmac_f32 v16, v40, v51
    v_fmac_f32 v17, v41, v51
    v_fmac_f32 v18, v42, v51
    v_fmac_f32 v19, v43, v51
    v_fmac_f32 v20, v44, v51
    v_fmac_f32 v21, v45, v51
    v_fmac_f32 v22, v46, v51
    v_fmac_f32 v23, v47, v51
    s_waitcnt vmcnt(8)
    s_mov_b64 s[94:95], exec
    s_mov_b64 exec, 1
    ds_add_rtn_u32 v59, v61, v5
    s_mov_b64 exec, s[94:95]
    s_waitcnt lgkmcnt(0)
    s_mov_b64 exec, 1
    v_lshlrev_b32 v59, 2, v59
    s_mov_b32 s92, 0
Lpop_21:
    ds_read_b32 v62, v59 offset:1024
    s_waitcnt lgkmcnt(0)
    v_readfirstlane_b32 s73, v62
    s_nop 3
    s_cmp_lg_u32 s73, -1
    s_cbranch_scc1 Lpopd_22
    s_sleep 1
    s_add_u32 s92, s92, 1
    s_cmp_lt_u32 s92, 400000
    s_cbranch_scc1 Lpop_21
Lpopd_22:
    s_mov_b64 exec, -1
    v_dot2_f32_bf16 v28, v128, v24, 0
    v_dot2_f32_bf16 v28, v129, v25, v28
    v_dot2_f32_bf16 v28, v130, v26, v28
    v_dot2_f32_bf16 v28, v131, v27, v28
    v_dot2_f32_bf16 v29, v132, v24, 0
    v_dot2_f32_bf16 v29, v133, v25, v29
    v_dot2_f32_bf16 v29, v134, v26, v29
    v_dot2_f32_bf16 v29, v135, v27, v29
    v_dot2_f32_bf16 v30, v136, v24, 0
    v_dot2_f32_bf16 v30, v137, v25, v30
    v_dot2_f32_bf16 v30, v138, v26, v30
    v_dot2_f32_bf16 v30, v139, v27, v30
    v_dot2_f32_bf16 v31, v140, v24, 0
    v_dot2_f32_bf16 v31, v141, v25, v31
    v_dot2_f32_bf16 v31, v142, v26, v31
    v_dot2_f32_bf16 v31, v143, v27, v31
    s_nop 2
    v_add_f32_dpp v28, v28, v28 row_ror:8 row_mask:0xf bank_mask:0xf
    v_add_f32_dpp v29, v29, v29 row_ror:8 row_mask:0xf bank_mask:0xf
    v_add_f32_dpp v30, v30, v30 row_ror:8 row_mask:0xf bank_mask:0xf
    v_add_f32_dpp v31, v31, v31 row_ror:8 row_mask:0xf bank_mask:0xf
    v_add_f32_dpp v28, v28, v28 row_ror:4 row_mask:0xf bank_mask:0xf
    v_add_f32_dpp v29, v29, v29 row_ror:4 row_mask:0xf bank_mask:0xf
    v_add_f32_dpp v30, v30, v30 row_ror:4 row_mask:0xf bank_mask:0xf
    v_add_f32_dpp v31, v31, v31 row_ror:4 row_mask:0xf bank_mask:0xf
    v_add_f32_dpp v28, v28, v28 row_ror:2 row_mask:0xf bank_mask:0xf
    v_add_f32_dpp v29, v29, v29 row_ror:2 row_mask:0xf bank_mask:0xf
    v_add_f32_dpp v30, v30, v30 row_ror:2 row_mask:0xf bank_mask:0xf
    v_add_f32_dpp v31, v31, v31 row_ror:2 row_mask:0xf bank_mask:0xf
    v_add_f32_dpp v28, v28, v28 row_ror:1 row_mask:0xf bank_mask:0xf
    v_add_f32_dpp v29, v29, v29 row_ror:1 row_mask:0xf bank_mask:0xf
    v_add_f32_dpp v30, v30, v30 row_ror:1 row_mask:0xf bank_mask:0xf
    v_add_f32_dpp v31, v31, v31 row_ror:1 row_mask:0xf bank_mask:0xf
    v_max3_f32 v38, v36, v28, v29
    v_max3_f32 v38, v38, v30, v31
    v_sub_f32 v39, v36, v38
    v_mul_f32 v39, s70, v39
    v_exp_f32 v39, v39
    v_mul_f32 v56, s70, v38
    v_mov_b32 v36, v38
    v_fma_f32 v48, v28, s70, -v56
    v_fma_f32 v49, v29, s70, -v56
    v_fma_f32 v50, v30, s70, -v56
    v_fma_f32 v51, v31, s70, -v56
    v_exp_f32 v48, v48
    v_exp_f32 v49, v49
    v_exp_f32 v50, v50
    v_exp_f32 v51, v51
    v_mul_f32 v37, v37, v39
    v_mul_f32 v16, v16, v39
    v_mul_f32 v17, v17, v39
    v_mul_f32 v18, v18, v39
    v_mul_f32 v19, v19, v39
    v_mul_f32 v20, v20, v39
    v_mul_f32 v21, v21, v39
    v_mul_f32 v22, v22, v39
    v_mul_f32 v23, v23, v39
    v_add_f32 v37, v37, v48
    v_add_f32 v37, v37, v49
    v_add_f32 v37, v37, v50
    v_add_f32 v37, v37, v51
    v_lshlrev_b32 v40, 16, v144
    v_and_b32 v41, 0xffff0000, v144
    v_lshlrev_b32 v42, 16, v145
    v_and_b32 v43, 0xffff0000, v145
    v_lshlrev_b32 v44, 16, v146
    v_and_b32 v45, 0xffff0000, v146
    v_lshlrev_b32 v46, 16, v147
    v_and_b32 v47, 0xffff0000, v147
    v_fmac_f32 v16, v40, v48
    v_fmac_f32 v17, v41, v48
    v_fmac_f32 v18, v42, v48
    v_fmac_f32 v19, v43, v48
    v_fmac_f32 v20, v44, v48
    v_fmac_f32 v21, v45, v48
    v_fmac_f32 v22, v46, v48
    v_fmac_f32 v23, v47, v48
    v_lshlrev_b32 v40, 16, v148
    v_and_b32 v41, 0xffff0000, v148
    v_lshlrev_b32 v42, 16, v149
    v_and_b32 v43, 0xffff0000, v149
    v_lshlrev_b32 v44, 16, v150
    v_and_b32 v45, 0xffff0000, v150
    v_lshlrev_b32 v46, 16, v151
    v_and_b32 v47, 0xffff0000, v151
    v_fmac_f32 v16, v40, v49
    v_fmac_f32 v17, v41, v49
    v_fmac_f32 v18, v42, v49
    v_fmac_f32 v19, v43, v49
    v_fmac_f32 v20, v44, v49
    v_fmac_f32 v21, v45, v49
    v_fmac_f32 v22, v46, v49
    v_fmac_f32 v23, v47, v49
    v_lshlrev_b32 v40, 16, v152
    v_and_b32 v41, 0xffff0000, v152
    v_lshlrev_b32 v42, 16, v153
    v_and_b32 v43, 0xffff0000, v153
    v_lshlrev_b32 v44, 16, v154
    v_and_b32 v45, 0xffff0000, v154
    v_lshlrev_b32 v46, 16, v155
    v_and_b32 v47, 0xffff0000, v155
    v_fmac_f32 v16, v40, v50
    v_fmac_f32 v17, v41, v50
    v_fmac_f32 v18, v42, v50
    v_fmac_f32 v19, v43, v50
    v_fmac_f32 v20, v44, v50
    v_fmac_f32 v21, v45, v50
    v_fmac_f32 v22, v46, v50
    v_fmac_f32 v23, v47, v50
    v_lshlrev_b32 v40, 16, v156
    v_and_b32 v41, 0xffff0000, v156
    v_lshlrev_b32 v42, 16, v157
    v_and_b32 v43, 0xffff0000, v157
    v_lshlrev_b32 v44, 16, v158
    v_and_b32 v45, 0xffff0000, v158
    v_lshlrev_b32 v46, 16, v159
    v_and_b32 v47, 0xffff0000, v159
    v_fmac_f32 v16, v40, v51
    v_fmac_f32 v17, v41, v51
    v_fmac_f32 v18, v42, v51
    v_fmac_f32 v19, v43, v51
    v_fmac_f32 v20, v44, v51
    v_fmac_f32 v21, v45, v51
    v_fmac_f32 v22, v46, v51
    v_fmac_f32 v23, v47, v51
    s_lshl_b32 s100, s73, 12
    s_mov_b32 s72, s73
    v_dot2_f32_bf16 v28, v96, v24, 0
    v_dot2_f32_bf16 v28, v97, v25, v28
    v_dot2_f32_bf16 v28, v98, v26, v28
    v_dot2_f32_bf16 v28, v99, v27, v28
    s_waitcnt vmcnt(3)
    buffer_load_dwordx4 v[96:99], v4, s[44:47], s100 offen offset:0 nt
    v_dot2_f32_bf16 v29, v100, v24, 0
    v_dot2_f32_bf16 v29, v101, v25, v29
    v_dot2_f32_bf16 v29, v102, v26, v29
    v_dot2_f32_bf16 v29, v103, v27, v29
    s_waitcnt vmcnt(3)
    buffer_load_dwordx4 v[100:103], v4, s[44:47], s100 offen offset:1024 nt
    v_dot2_f32_bf16 v30, v104, v24, 0
    v_dot2_f32_bf16 v30, v105, v25, v30
    v_dot2_f32_bf16 v30, v106, v26, v30
    v_dot2_f32_bf16 v30, v107, v27, v30
    s_waitcnt vmcnt(3)
    buffer_load_dwordx4 v[104:107], v4, s[44:47], s100 offen offset:2048 nt
    v_dot2_f32_bf16 v31, v108, v24, 0
    v_dot2_f32_bf16 v31, v109, v25, v31
    v_dot2_f32_bf16 v31, v110, v26, v31
    v_dot2_f32_bf16 v31, v111, v27, v31
    s_waitcnt vmcnt(3)
    buffer_load_dwordx4 v[108:111], v4, s[44:47], s100 offen offset:3072 nt
    s_nop 2
    v_add_f32_dpp v28, v28, v28 row_ror:8 row_mask:0xf bank_mask:0xf
    v_add_f32_dpp v29, v29, v29 row_ror:8 row_mask:0xf bank_mask:0xf
    v_add_f32_dpp v30, v30, v30 row_ror:8 row_mask:0xf bank_mask:0xf
    v_add_f32_dpp v31, v31, v31 row_ror:8 row_mask:0xf bank_mask:0xf
    v_add_f32_dpp v28, v28, v28 row_ror:4 row_mask:0xf bank_mask:0xf
    v_add_f32_dpp v29, v29, v29 row_ror:4 row_mask:0xf bank_mask:0xf
    v_add_f32_dpp v30, v30, v30 row_ror:4 row_mask:0xf bank_mask:0xf
    v_add_f32_dpp v31, v31, v31 row_ror:4 row_mask:0xf bank_mask:0xf
    v_add_f32_dpp v28, v28, v28 row_ror:2 row_mask:0xf bank_mask:0xf
    v_add_f32_dpp v29, v29, v29 row_ror:2 row_mask:0xf bank_mask:0xf
    v_add_f32_dpp v30, v30, v30 row_ror:2 row_mask:0xf bank_mask:0xf
    v_add_f32_dpp v31, v31, v31 row_ror:2 row_mask:0xf bank_mask:0xf
    v_add_f32_dpp v28, v28, v28 row_ror:1 row_mask:0xf bank_mask:0xf
    v_add_f32_dpp v29, v29, v29 row_ror:1 row_mask:0xf bank_mask:0xf
    v_add_f32_dpp v30, v30, v30 row_ror:1 row_mask:0xf bank_mask:0xf
    v_add_f32_dpp v31, v31, v31 row_ror:1 row_mask:0xf bank_mask:0xf
    v_max3_f32 v38, v36, v28, v29
    v_max3_f32 v38, v38, v30, v31
    v_sub_f32 v39, v36, v38
    v_mul_f32 v39, s70, v39
    v_exp_f32 v39, v39
    v_mul_f32 v56, s70, v38
    v_mov_b32 v36, v38
    v_fma_f32 v48, v28, s70, -v56
    v_fma_f32 v49, v29, s70, -v56
    v_fma_f32 v50, v30, s70, -v56
    v_fma_f32 v51, v31, s70, -v56
    v_exp_f32 v48, v48
    v_exp_f32 v49, v49
    v_exp_f32 v50, v50
    v_exp_f32 v51, v51
    v_mul_f32 v37, v37, v39
    v_mul_f32 v16, v16, v39
    v_mul_f32 v17, v17, v39
    v_mul_f32 v18, v18, v39
    v_mul_f32 v19, v19, v39
    v_mul_f32 v20, v20, v39
    v_mul_f32 v21, v21, v39
    v_mul_f32 v22, v22, v39
    v_mul_f32 v23, v23, v39
    v_add_f32 v37, v37, v48
    v_add_f32 v37, v37, v49
    v_add_f32 v37, v37, v50
    v_add_f32 v37, v37, v51
    v_lshlrev_b32 v40, 16, v112
    v_and_b32 v41, 0xffff0000, v112
    v_lshlrev_b32 v42, 16, v113
    v_and_b32 v43, 0xffff0000, v113
    v_lshlrev_b32 v44, 16, v114
    v_and_b32 v45, 0xffff0000, v114
    v_lshlrev_b32 v46, 16, v115
    v_and_b32 v47, 0xffff0000, v115
    s_waitcnt vmcnt(3)
    buffer_load_dwordx4 v[112:115], v4, s[48:51], s100 offen offset:0 nt
    v_fmac_f32 v16, v40, v48
    v_fmac_f32 v17, v41, v48
    v_fmac_f32 v18, v42, v48
    v_fmac_f32 v19, v43, v48
    v_fmac_f32 v20, v44, v48
    v_fmac_f32 v21, v45, v48
    v_fmac_f32 v22, v46, v48
    v_fmac_f32 v23, v47, v48
    v_lshlrev_b32 v40, 16, v116
    v_and_b32 v41, 0xffff0000, v116
    v_lshlrev_b32 v42, 16, v117
    v_and_b32 v43, 0xffff0000, v117
    v_lshlrev_b32 v44, 16, v118
    v_and_b32 v45, 0xffff0000, v118
    v_lshlrev_b32 v46, 16, v119
    v_and_b32 v47, 0xffff0000, v119
    s_waitcnt vmcnt(3)
    buffer_load_dwordx4 v[116:119], v4, s[48:51], s100 offen offset:1024 nt
    v_fmac_f32 v16, v40, v49
    v_fmac_f32 v17, v41, v49
    v_fmac_f32 v18, v42, v49
    v_fmac_f32 v19, v43, v49
    v_fmac_f32 v20, v44, v49
    v_fmac_f32 v21, v45, v49
    v_fmac_f32 v22, v46, v49
    v_fmac_f32 v23, v47, v49
    v_lshlrev_b32 v40, 16, v120
    v_and_b32 v41, 0xffff0000, v120
    v_lshlrev_b32 v42, 16, v121
    v_and_b32 v43, 0xffff0000, v121
    v_lshlrev_b32 v44, 16, v122
    v_and_b32 v45, 0xffff0000, v122
    v_lshlrev_b32 v46, 16, v123
    v_and_b32 v47, 0xffff0000, v123
    s_waitcnt vmcnt(3)
    buffer_load_dwordx4 v[120:123], v4, s[48:51], s100 offen offset:2048 nt
    v_fmac_f32 v16, v40, v50
    v_fmac_f32 v17, v41, v50
    v_fmac_f32 v18, v42, v50
    v_fmac_f32 v19, v43, v50
    v_fmac_f32 v20, v44, v50
    v_fmac_f32 v21, v45, v50
    v_fmac_f32 v22, v46, v50
    v_fmac_f32 v23, v47, v50
    v_lshlrev_b32 v40, 16, v124
    v_and_b32 v41, 0xffff0000, v124
    v_lshlrev_b32 v42, 16, v125
    v_and_b32 v43, 0xffff0000, v125
    v_lshlrev_b32 v44, 16, v126
    v_and_b32 v45, 0xffff0000, v126
    v_lshlrev_b32 v46, 16, v127
    v_and_b32 v47, 0xffff0000, v127
    s_waitcnt vmcnt(3)
    buffer_load_dwordx4 v[124:127], v4, s[48:51], s100 offen offset:3072 nt
    v_fmac_f32 v16, v40, v51
    v_fmac_f32 v17, v41, v51
    v_fmac_f32 v18, v42, v51
    v_fmac_f32 v19, v43, v51
    v_fmac_f32 v20, v44, v51
    v_fmac_f32 v21, v45, v51
    v_fmac_f32 v22, v46, v51
    v_fmac_f32 v23, v47, v51
    s_waitcnt vmcnt(8)
    s_mov_b64 s[94:95], exec
    s_mov_b64 exec, 1
    ds_add_rtn_u32 v59, v61, v5
    s_mov_b64 exec, s[94:95]
    s_waitcnt lgkmcnt(0)
    s_mov_b64 exec, 1
    v_lshlrev_b32 v59, 2, v59
    s_mov_b32 s92, 0
Lpop_23:
    ds_read_b32 v62, v59 offset:1024
    s_waitcnt lgkmcnt(0)
    v_readfirstlane_b32 s73, v62
    s_nop 3
    s_cmp_lg_u32 s73, -1
    s_cbranch_scc1 Lpopd_24
    s_sleep 1
    s_add_u32 s92, s92, 1
    s_cmp_lt_u32 s92, 400000
    s_cbranch_scc1 Lpop_23
Lpopd_24:
    s_mov_b64 exec, -1
    s_waitcnt vmcnt(4)
    v_dot2_f32_bf16 v28, v160, v24, 0
    v_dot2_f32_bf16 v28, v161, v25, v28
    v_dot2_f32_bf16 v28, v162, v26, v28
    v_dot2_f32_bf16 v28, v163, v27, v28
    v_dot2_f32_bf16 v29, v164, v24, 0
    v_dot2_f32_bf16 v29, v165, v25, v29
    v_dot2_f32_bf16 v29, v166, v26, v29
    v_dot2_f32_bf16 v29, v167, v27, v29
    v_dot2_f32_bf16 v30, v168, v24, 0
    v_dot2_f32_bf16 v30, v169, v25, v30
    v_dot2_f32_bf16 v30, v170, v26, v30
    v_dot2_f32_bf16 v30, v171, v27, v30
    v_dot2_f32_bf16 v31, v172, v24, 0
    v_dot2_f32_bf16 v31, v173, v25, v31
    v_dot2_f32_bf16 v31, v174, v26, v31
    v_dot2_f32_bf16 v31, v175, v27, v31
    s_nop 2
    v_add_f32_dpp v28, v28, v28 row_ror:8 row_mask:0xf bank_mask:0xf
    v_add_f32_dpp v29, v29, v29 row_ror:8 row_mask:0xf bank_mask:0xf
    v_add_f32_dpp v30, v30, v30 row_ror:8 row_mask:0xf bank_mask:0xf
    v_add_f32_dpp v31, v31, v31 row_ror:8 row_mask:0xf bank_mask:0xf
    v_add_f32_dpp v28, v28, v28 row_ror:4 row_mask:0xf bank_mask:0xf
    v_add_f32_dpp v29, v29, v29 row_ror:4 row_mask:0xf bank_mask:0xf
    v_add_f32_dpp v30, v30, v30 row_ror:4 row_mask:0xf bank_mask:0xf
    v_add_f32_dpp v31, v31, v31 row_ror:4 row_mask:0xf bank_mask:0xf
    v_add_f32_dpp v28, v28, v28 row_ror:2 row_mask:0xf bank_mask:0xf
    v_add_f32_dpp v29, v29, v29 row_ror:2 row_mask:0xf bank_mask:0xf
    v_add_f32_dpp v30, v30, v30 row_ror:2 row_mask:0xf bank_mask:0xf
    v_add_f32_dpp v31, v31, v31 row_ror:2 row_mask:0xf bank_mask:0xf
    v_add_f32_dpp v28, v28, v28 row_ror:1 row_mask:0xf bank_mask:0xf
    v_add_f32_dpp v29, v29, v29 row_ror:1 row_mask:0xf bank_mask:0xf
    v_add_f32_dpp v30, v30, v30 row_ror:1 row_mask:0xf bank_mask:0xf
    v_add_f32_dpp v31, v31, v31 row_ror:1 row_mask:0xf bank_mask:0xf
    v_max3_f32 v38, v36, v28, v29
    v_max3_f32 v38, v38, v30, v31
    v_sub_f32 v39, v36, v38
    v_mul_f32 v39, s70, v39
    v_exp_f32 v39, v39
    v_mul_f32 v56, s70, v38
    v_mov_b32 v36, v38
    v_fma_f32 v48, v28, s70, -v56
    v_fma_f32 v49, v29, s70, -v56
    v_fma_f32 v50, v30, s70, -v56
    v_fma_f32 v51, v31, s70, -v56
    v_exp_f32 v48, v48
    v_exp_f32 v49, v49
    v_exp_f32 v50, v50
    v_exp_f32 v51, v51
    v_mul_f32 v37, v37, v39
    v_mul_f32 v16, v16, v39
    v_mul_f32 v17, v17, v39
    v_mul_f32 v18, v18, v39
    v_mul_f32 v19, v19, v39
    v_mul_f32 v20, v20, v39
    v_mul_f32 v21, v21, v39
    v_mul_f32 v22, v22, v39
    v_mul_f32 v23, v23, v39
    v_add_f32 v37, v37, v48
    v_add_f32 v37, v37, v49
    v_add_f32 v37, v37, v50
    v_add_f32 v37, v37, v51
    v_lshlrev_b32 v40, 16, v176
    v_and_b32 v41, 0xffff0000, v176
    v_lshlrev_b32 v42, 16, v177
    v_and_b32 v43, 0xffff0000, v177
    v_lshlrev_b32 v44, 16, v178
    v_and_b32 v45, 0xffff0000, v178
    v_lshlrev_b32 v46, 16, v179
    v_and_b32 v47, 0xffff0000, v179
    v_fmac_f32 v16, v40, v48
    v_fmac_f32 v17, v41, v48
    v_fmac_f32 v18, v42, v48
    v_fmac_f32 v19, v43, v48
    v_fmac_f32 v20, v44, v48
    v_fmac_f32 v21, v45, v48
    v_fmac_f32 v22, v46, v48
    v_fmac_f32 v23, v47, v48
    v_lshlrev_b32 v40, 16, v180
    v_and_b32 v41, 0xffff0000, v180
    v_lshlrev_b32 v42, 16, v181
    v_and_b32 v43, 0xffff0000, v181
    v_lshlrev_b32 v44, 16, v182
    v_and_b32 v45, 0xffff0000, v182
    v_lshlrev_b32 v46, 16, v183
    v_and_b32 v47, 0xffff0000, v183
    v_fmac_f32 v16, v40, v49
    v_fmac_f32 v17, v41, v49
    v_fmac_f32 v18, v42, v49
    v_fmac_f32 v19, v43, v49
    v_fmac_f32 v20, v44, v49
    v_fmac_f32 v21, v45, v49
    v_fmac_f32 v22, v46, v49
    v_fmac_f32 v23, v47, v49
    v_lshlrev_b32 v40, 16, v184
    v_and_b32 v41, 0xffff0000, v184
    v_lshlrev_b32 v42, 16, v185
    v_and_b32 v43, 0xffff0000, v185
    v_lshlrev_b32 v44, 16, v186
    v_and_b32 v45, 0xffff0000, v186
    v_lshlrev_b32 v46, 16, v187
    v_and_b32 v47, 0xffff0000, v187
    v_fmac_f32 v16, v40, v50
    v_fmac_f32 v17, v41, v50
    v_fmac_f32 v18, v42, v50
    v_fmac_f32 v19, v43, v50
    v_fmac_f32 v20, v44, v50
    v_fmac_f32 v21, v45, v50
    v_fmac_f32 v22, v46, v50
    v_fmac_f32 v23, v47, v50
    v_lshlrev_b32 v40, 16, v188
    v_and_b32 v41, 0xffff0000, v188
    v_lshlrev_b32 v42, 16, v189
    v_and_b32 v43, 0xffff0000, v189
    v_lshlrev_b32 v44, 16, v190
    v_and_b32 v45, 0xffff0000, v190
    v_lshlrev_b32 v46, 16, v191
    v_and_b32 v47, 0xffff0000, v191
    v_fmac_f32 v16, v40, v51
    v_fmac_f32 v17, v41, v51
    v_fmac_f32 v18, v42, v51
    v_fmac_f32 v19, v43, v51
    v_fmac_f32 v20, v44, v51
    v_fmac_f32 v21, v45, v51
    v_fmac_f32 v22, v46, v51
    v_fmac_f32 v23, v47, v51
LBloop_17:
    s_cmp_ge_u32 s73, s83
    s_cbranch_scc1 LBloop2_19
    s_lshl_b32 s100, s73, 12
    s_mov_b32 s71, s73
    v_dot2_f32_bf16 v28, v64, v24, 0
    v_dot2_f32_bf16 v28, v65, v25, v28
    v_dot2_f32_bf16 v28, v66, v26, v28
    v_dot2_f32_bf16 v28, v67, v27, v28
    s_waitcnt vmcnt(3)
    buffer_load_dwordx4 v[64:67], v4, s[44:47], s100 offen offset:0 nt
    v_dot2_f32_bf16 v29, v68, v24, 0
    v_dot2_f32_bf16 v29, v69, v25, v29
    v_dot2_f32_bf16 v29, v70, v26, v29
    v_dot2_f32_bf16 v29, v71, v27, v29
    s_waitcnt vmcnt(3)
    buffer_load_dwordx4 v[68:71], v4, s[44:47], s100 offen offset:1024 nt
    v_dot2_f32_bf16 v30, v72, v24, 0
    v_dot2_f32_bf16 v30, v73, v25, v30
    v_dot2_f32_bf16 v30, v74, v26, v30
    v_dot2_f32_bf16 v30, v75, v27, v30
    s_waitcnt vmcnt(3)
    buffer_load_dwordx4 v[72:75], v4, s[44:47], s100 offen offset:2048 nt
    v_dot2_f32_bf16 v31, v76, v24, 0
    v_dot2_f32_bf16 v31, v77, v25, v31
    v_dot2_f32_bf16 v31, v78, v26, v31
    v_dot2_f32_bf16 v31, v79, v27, v31
    s_waitcnt vmcnt(3)
    buffer_load_dwordx4 v[76:79], v4, s[44:47], s100 offen offset:3072 nt
    s_nop 2
    v_add_f32_dpp v28, v28, v28 row_ror:8 row_mask:0xf bank_mask:0xf
    v_add_f32_dpp v29, v29, v29 row_ror:8 row_mask:0xf bank_mask:0xf
    v_add_f32_dpp v30, v30, v30 row_ror:8 row_mask:0xf bank_mask:0xf
    v_add_f32_dpp v31, v31, v31 row_ror:8 row_mask:0xf bank_mask:0xf
    v_add_f32_dpp v28, v28, v28 row_ror:4 row_mask:0xf bank_mask:0xf
    v_add_f32_dpp v29, v29, v29 row_ror:4 row_mask:0xf bank_mask:0xf
    v_add_f32_dpp v30, v30, v30 row_ror:4 row_mask:0xf bank_mask:0xf
    v_add_f32_dpp v31, v31, v31 row_ror:4 row_mask:0xf bank_mask:0xf
    v_add_f32_dpp v28, v28, v28 row_ror:2 row_mask:0xf bank_mask:0xf
    v_add_f32_dpp v29, v29, v29 row_ror:2 row_mask:0xf bank_mask:0xf
    v_add_f32_dpp v30, v30, v30 row_ror:2 row_mask:0xf bank_mask:0xf
    v_add_f32_dpp v31, v31, v31 row_ror:2 row_mask:0xf bank_mask:0xf
    v_add_f32_dpp v28, v28, v28 row_ror:1 row_mask:0xf bank_mask:0xf
    v_add_f32_dpp v29, v29, v29 row_ror:1 row_mask:0xf bank_mask:0xf
    v_add_f32_dpp v30, v30, v30 row_ror:1 row_mask:0xf bank_mask:0xf
    v_add_f32_dpp v31, v31, v31 row_ror:1 row_mask:0xf bank_mask:0xf
    v_max3_f32 v38, v36, v28, v29
    v_max3_f32 v38, v38, v30, v31
    v_sub_f32 v39, v36, v38
    v_mul_f32 v39, s70, v39
    v_exp_f32 v39, v39
    v_mul_f32 v56, s70, v38
    v_mov_b32 v36, v38
    v_fma_f32 v48, v28, s70, -v56
    v_fma_f32 v49, v29, s70, -v56
    v_fma_f32 v50, v30, s70, -v56
    v_fma_f32 v51, v31, s70, -v56
    v_exp_f32 v48, v48
    v_exp_f32 v49, v49
    v_exp_f32 v50, v50
    v_exp_f32 v51, v51
    v_mul_f32 v37, v37, v39
    v_mul_f32 v16, v16, v39
    v_mul_f32 v17, v17, v39
    v_mul_f32 v18, v18, v39
    v_mul_f32 v19, v19, v39
    v_mul_f32 v20, v20, v39
    v_mul_f32 v21, v21, v39
    v_mul_f32 v22, v22, v39
    v_mul_f32 v23, v23, v39
    v_add_f32 v37, v37, v48
    v_add_f32 v37, v37, v49
    v_add_f32 v37, v37, v50
    v_add_f32 v37, v37, v51
    v_lshlrev_b32 v40, 16, v80
    v_and_b32 v41, 0xffff0000, v80
    v_lshlrev_b32 v42, 16, v81
    v_and_b32 v43, 0xffff0000, v81
    v_lshlrev_b32 v44, 16, v82
    v_and_b32 v45, 0xffff0000, v82
    v_lshlrev_b32 v46, 16, v83
    v_and_b32 v47, 0xffff0000, v83
    s_waitcnt vmcnt(3)
    buffer_load_dwordx4 v[80:83], v4, s[48:51], s100 offen offset:0 nt
    v_fmac_f32 v16, v40, v48
    v_fmac_f32 v17, v41, v48
    v_fmac_f32 v18, v42, v48
    v_fmac_f32 v19, v43, v48
    v_fmac_f32 v20, v44, v48
    v_fmac_f32 v21, v45, v48
    v_fmac_f32 v22, v46, v48
    v_fmac_f32 v23, v47, v48
    v_lshlrev_b32 v40, 16, v84
    v_and_b32 v41, 0xffff0000, v84
    v_lshlrev_b32 v42, 16, v85
    v_and_b32 v43, 0xffff0000, v85
    v_lshlrev_b32 v44, 16, v86
    v_and_b32 v45, 0xffff0000, v86
    v_lshlrev_b32 v46, 16, v87
    v_and_b32 v47, 0xffff0000, v87
    s_waitcnt vmcnt(3)
    buffer_load_dwordx4 v[84:87], v4, s[48:51], s100 offen offset:1024 nt
    v_fmac_f32 v16, v40, v49
    v_fmac_f32 v17, v41, v49
    v_fmac_f32 v18, v42, v49
    v_fmac_f32 v19, v43, v49
    v_fmac_f32 v20, v44, v49
    v_fmac_f32 v21, v45, v49
    v_fmac_f32 v22, v46, v49
    v_fmac_f32 v23, v47, v49
    v_lshlrev_b32 v40, 16, v88
    v_and_b32 v41, 0xffff0000, v88
    v_lshlrev_b32 v42, 16, v89
    v_and_b32 v43, 0xffff0000, v89
    v_lshlrev_b32 v44, 16, v90
    v_and_b32 v45, 0xffff0000, v90
    v_lshlrev_b32 v46, 16, v91
    v_and_b32 v47, 0xffff0000, v91
    s_waitcnt vmcnt(3)
    buffer_load_dwordx4 v[88:91], v4, s[48:51], s100 offen offset:2048 nt
    v_fmac_f32 v16, v40, v50
    v_fmac_f32 v17, v41, v50
    v_fmac_f32 v18, v42, v50
    v_fmac_f32 v19, v43, v50
    v_fmac_f32 v20, v44, v50
    v_fmac_f32 v21, v45, v50
    v_fmac_f32 v22, v46, v50
    v_fmac_f32 v23, v47, v50
    v_lshlrev_b32 v40, 16, v92
    v_and_b32 v41, 0xffff0000, v92
    v_lshlrev_b32 v42, 16, v93
    v_and_b32 v43, 0xffff0000, v93
    v_lshlrev_b32 v44, 16, v94
    v_and_b32 v45, 0xffff0000, v94
    v_lshlrev_b32 v46, 16, v95
    v_and_b32 v47, 0xffff0000, v95
    s_waitcnt vmcnt(3)
    buffer_load_dwordx4 v[92:95], v4, s[48:51], s100 offen offset:3072 nt
    v_fmac_f32 v16, v40, v51
    v_fmac_f32 v17, v41, v51
    v_fmac_f32 v18, v42, v51
    v_fmac_f32 v19, v43, v51
    v_fmac_f32 v20, v44, v51
    v_fmac_f32 v21, v45, v51
    v_fmac_f32 v22, v46, v51
    v_fmac_f32 v23, v47, v51
    s_waitcnt vmcnt(8)
    s_mov_b64 s[94:95], exec
    s_mov_b64 exec, 1
    ds_add_rtn_u32 v59, v61, v5
    s_mov_b64 exec, s[94:95]
    s_waitcnt lgkmcnt(0)
    s_mov_b64 exec, 1
    v_lshlrev_b32 v59, 2, v59
    s_mov_b32 s92, 0
Lpop_25:
    ds_read_b32 v62, v59 offset:1024
    s_waitcnt lgkmcnt(0)
    v_readfirstlane_b32 s73, v62
    s_nop 3
    s_cmp_lg_u32 s73, -1
    s_cbranch_scc1 Lpopd_26
    s_sleep 1
    s_add_u32 s92, s92, 1
    s_cmp_lt_u32 s92, 400000
    s_cbranch_scc1 Lpop_25
Lpopd_26:
    s_mov_b64 exec, -1
    s_cmp_ge_u32 s73, s83
    s_cbranch_scc1 LBloop2b_20
    s_lshl_b32 s100, s73, 12
    s_mov_b32 s72, s73
    v_dot2_f32_bf16 v28, v96, v24, 0
    v_dot2_f32_bf16 v28, v97, v25, v28
    v_dot2_f32_bf16 v28, v98, v26, v28
    v_dot2_f32_bf16 v28, v99, v27, v28
    s_waitcnt vmcnt(3)
    buffer_load_dwordx4 v[96:99], v4, s[44:47], s100 offen offset:0 nt
    v_dot2_f32_bf16 v29, v100, v24, 0
    v_dot2_f32_bf16 v29, v101, v25, v29
    v_dot2_f32_bf16 v29, v102, v26, v29
    v_dot2_f32_bf16 v29, v103, v27, v29
    s_waitcnt vmcnt(3)
    buffer_load_dwordx4 v[100:103], v4, s[44:47], s100 offen offset:1024 nt
    v_dot2_f32_bf16 v30, v104, v24, 0
    v_dot2_f32_bf16 v30, v105, v25, v30
    v_dot2_f32_bf16 v30, v106, v26, v30
    v_dot2_f32_bf16 v30, v107, v27, v30
    s_waitcnt vmcnt(3)
    buffer_load_dwordx4 v[104:107], v4, s[44:47], s100 offen offset:2048 nt
    v_dot2_f32_bf16 v31, v108, v24, 0
    v_dot2_f32_bf16 v31, v109, v25, v31
    v_dot2_f32_bf16 v31, v110, v26, v31
    v_dot2_f32_bf16 v31, v111, v27, v31
    s_waitcnt vmcnt(3)
    buffer_load_dwordx4 v[108:111], v4, s[44:47], s100 offen offset:3072 nt
    s_nop 2
    v_add_f32_dpp v28, v28, v28 row_ror:8 row_mask:0xf bank_mask:0xf
    v_add_f32_dpp v29, v29, v29 row_ror:8 row_mask:0xf bank_mask:0xf
    v_add_f32_dpp v30, v30, v30 row_ror:8 row_mask:0xf bank_mask:0xf
    v_add_f32_dpp v31, v31, v31 row_ror:8 row_mask:0xf bank_mask:0xf
    v_add_f32_dpp v28, v28, v28 row_ror:4 row_mask:0xf bank_mask:0xf
    v_add_f32_dpp v29, v29, v29 row_ror:4 row_mask:0xf bank_mask:0xf
    v_add_f32_dpp v30, v30, v30 row_ror:4 row_mask:0xf bank_mask:0xf
    v_add_f32_dpp v31, v31, v31 row_ror:4 row_mask:0xf bank_mask:0xf
    v_add_f32_dpp v28, v28, v28 row_ror:2 row_mask:0xf bank_mask:0xf
    v_add_f32_dpp v29, v29, v29 row_ror:2 row_mask:0xf bank_mask:0xf
    v_add_f32_dpp v30, v30, v30 row_ror:2 row_mask:0xf bank_mask:0xf
    v_add_f32_dpp v31, v31, v31 row_ror:2 row_mask:0xf bank_mask:0xf
    v_add_f32_dpp v28, v28, v28 row_ror:1 row_mask:0xf bank_mask:0xf
    v_add_f32_dpp v29, v29, v29 row_ror:1 row_mask:0xf bank_mask:0xf
    v_add_f32_dpp v30, v30, v30 row_ror:1 row_mask:0xf bank_mask:0xf
    v_add_f32_dpp v31, v31, v31 row_ror:1 row_mask:0xf bank_mask:0xf
    v_max3_f32 v38, v36, v28, v29
    v_max3_f32 v38, v38, v30, v31
    v_sub_f32 v39, v36, v38
    v_mul_f32 v39, s70, v39
    v_exp_f32 v39, v39
    v_mul_f32 v56, s70, v38
    v_mov_b32 v36, v38
    v_fma_f32 v48, v28, s70, -v56
    v_fma_f32 v49, v29, s70, -v56
    v_fma_f32 v50, v30, s70, -v56
    v_fma_f32 v51, v31, s70, -v56
    v_exp_f32 v48, v48
    v_exp_f32 v49, v49
    v_exp_f32 v50, v50
    v_exp_f32 v51, v51
    v_mul_f32 v37, v37, v39
    v_mul_f32 v16, v16, v39
    v_mul_f32 v17, v17, v39
    v_mul_f32 v18, v18, v39
    v_mul_f32 v19, v19, v39
    v_mul_f32 v20, v20, v39
    v_mul_f32 v21, v21, v39
    v_mul_f32 v22, v22, v39
    v_mul_f32 v23, v23, v39
    v_add_f32 v37, v37, v48
    v_add_f32 v37, v37, v49
    v_add_f32 v37, v37, v50
    v_add_f32 v37, v37, v51
    v_lshlrev_b32 v40, 16, v112
    v_and_b32 v41, 0xffff0000, v112
    v_lshlrev_b32 v42, 16, v113
    v_and_b32 v43, 0xffff0000, v113
    v_lshlrev_b32 v44, 16, v114
    v_and_b32 v45, 0xffff0000, v114
    v_lshlrev_b32 v46, 16, v115
    v_and_b32 v47, 0xffff0000, v115
    s_waitcnt vmcnt(3)
    buffer_load_dwordx4 v[112:115], v4, s[48:51], s100 offen offset:0 nt
    v_fmac_f32 v16, v40, v48
    v_fmac_f32 v17, v41, v48
    v_fmac_f32 v18, v42, v48
    v_fmac_f32 v19, v43, v48
    v_fmac_f32 v20, v44, v48
    v_fmac_f32 v21, v45, v48
    v_fmac_f32 v22, v46, v48
    v_fmac_f32 v23, v47, v48
    v_lshlrev_b32 v40, 16, v116
    v_and_b32 v41, 0xffff0000, v116
    v_lshlrev_b32 v42, 16, v117
    v_and_b32 v43, 0xffff0000, v117
    v_lshlrev_b32 v44, 16, v118
    v_and_b32 v45, 0xffff0000, v118
    v_lshlrev_b32 v46, 16, v119
    v_and_b32 v47, 0xffff0000, v119
    s_waitcnt vmcnt(3)
    buffer_load_dwordx4 v[116:119], v4, s[48:51], s100 offen offset:1024 nt
    v_fmac_f32 v16, v40, v49
    v_fmac_f32 v17, v41, v49
    v_fmac_f32 v18, v42, v49
    v_fmac_f32 v19, v43, v49
    v_fmac_f32 v20, v44, v49
    v_fmac_f32 v21, v45, v49
    v_fmac_f32 v22, v46, v49
    v_fmac_f32 v23, v47, v49
    v_lshlrev_b32 v40, 16, v120
    v_and_b32 v41, 0xffff0000, v120
    v_lshlrev_b32 v42, 16, v121
    v_and_b32 v43, 0xffff0000, v121
    v_lshlrev_b32 v44, 16, v122
    v_and_b32 v45, 0xffff0000, v122
    v_lshlrev_b32 v46, 16, v123
    v_and_b32 v47, 0xffff0000, v123
    s_waitcnt vmcnt(3)
    buffer_load_dwordx4 v[120:123], v4, s[48:51], s100 offen offset:2048 nt
    v_fmac_f32 v16, v40, v50
    v_fmac_f32 v17, v41, v50
    v_fmac_f32 v18, v42, v50
    v_fmac_f32 v19, v43, v50
    v_fmac_f32 v20, v44, v50
    v_fmac_f32 v21, v45, v50
    v_fmac_f32 v22, v46, v50
    v_fmac_f32 v23, v47, v50
    v_lshlrev_b32 v40, 16, v124
    v_and_b32 v41, 0xffff0000, v124
    v_lshlrev_b32 v42, 16, v125
    v_and_b32 v43, 0xffff0000, v125
    v_lshlrev_b32 v44, 16, v126
    v_and_b32 v45, 0xffff0000, v126
    v_lshlrev_b32 v46, 16, v127
    v_and_b32 v47, 0xffff0000, v127
    s_waitcnt vmcnt(3)
    buffer_load_dwordx4 v[124:127], v4, s[48:51], s100 offen offset:3072 nt
    v_fmac_f32 v16, v40, v51
    v_fmac_f32 v17, v41, v51
    v_fmac_f32 v18, v42, v51
    v_fmac_f32 v19, v43, v51
    v_fmac_f32 v20, v44, v51
    v_fmac_f32 v21, v45, v51
    v_fmac_f32 v22, v46, v51
    v_fmac_f32 v23, v47, v51
    s_waitcnt vmcnt(8)
    s_mov_b64 s[94:95], exec
    s_mov_b64 exec, 1
    ds_add_rtn_u32 v59, v61, v5
    s_mov_b64 exec, s[94:95]
    s_waitcnt lgkmcnt(0)
    s_mov_b64 exec, 1
    v_lshlrev_b32 v59, 2, v59
    s_mov_b32 s92, 0
Lpop_27:
    ds_read_b32 v62, v59 offset:1024
    s_waitcnt lgkmcnt(0)
    v_readfirstlane_b32 s73, v62
    s_nop 3
    s_cmp_lg_u32 s73, -1
    s_cbranch_scc1 Lpopd_28
    s_sleep 1
    s_add_u32 s92, s92, 1
    s_cmp_lt_u32 s92, 400000
    s_cbranch_scc1 Lpop_27
Lpopd_28:
    s_mov_b64 exec, -1
    s_branch LBloop_17
LBloop2_19:
    s_cmp_ge_u32 s73, s74
    s_cbranch_scc1 LBtail0_29
    s_lshl_b32 s100, s73, 12
    s_mov_b32 s71, s73
    v_dot2_f32_bf16 v28, v64, v24, 0
    v_dot2_f32_bf16 v28, v65, v25, v28
    v_dot2_f32_bf16 v28, v66, v26, v28
    v_dot2_f32_bf16 v28, v67, v27, v28
    s_waitcnt vmcnt(13)
    buffer_load_dwordx4 v[64:67], v4, s[44:47], s100 offen offset:0 nt
    v_dot2_f32_bf16 v29, v68, v24, 0
    v_dot2_f32_bf16 v29, v69, v25, v29
    v_dot2_f32_bf16 v29, v70, v26, v29
    v_dot2_f32_bf16 v29, v71, v27, v29
    s_waitcnt vmcnt(13)
    buffer_load_dwordx4 v[68:71], v4, s[44:47], s100 offen offset:1024 nt
    v_dot2_f32_bf16 v30, v72, v24, 0
    v_dot2_f32_bf16 v30, v73, v25, v30
    v_dot2_f32_bf16 v30, v74, v26, v30
    v_dot2_f32_bf16 v30, v75, v27, v30
    s_waitcnt vmcnt(13)
    buffer_load_dwordx4 v[72:75], v4, s[44:47], s100 offen offset:2048 nt
    v_dot2_f32_bf16 v31, v76, v24, 0
    v_dot2_f32_bf16 v31, v77, v25, v31
    v_dot2_f32_bf16 v31, v78, v26, v31
    v_dot2_f32_bf16 v31, v79, v27, v31
    s_waitcnt vmcnt(13)
    buffer_load_dwordx4 v[76:79], v4, s[44:47], s100 offen offset:3072 nt
    s_nop 2
    v_add_f32_dpp v28, v28, v28 row_ror:8 row_mask:0xf bank_mask:0xf
    v_add_f32_dpp v29, v29, v29 row_ror:8 row_mask:0xf bank_mask:0xf
    v_add_f32_dpp v30, v30, v30 row_ror:8 row_mask:0xf bank_mask:0xf
    v_add_f32_dpp v31, v31, v31 row_ror:8 row_mask:0xf bank_mask:0xf
    v_add_f32_dpp v28, v28, v28 row_ror:4 row_mask:0xf bank_mask:0xf
    v_add_f32_dpp v29, v29, v29 row_ror:4 row_mask:0xf bank_mask:0xf
    v_add_f32_dpp v30, v30, v30 row_ror:4 row_mask:0xf bank_mask:0xf
    v_add_f32_dpp v31, v31, v31 row_ror:4 row_mask:0xf bank_mask:0xf
    v_add_f32_dpp v28, v28, v28 row_ror:2 row_mask:0xf bank_mask:0xf
    v_add_f32_dpp v29, v29, v29 row_ror:2 row_mask:0xf bank_mask:0xf
    v_add_f32_dpp v30, v30, v30 row_ror:2 row_mask:0xf bank_mask:0xf
    v_add_f32_dpp v31, v31, v31 row_ror:2 row_mask:0xf bank_mask:0xf
    v_add_f32_dpp v28, v28, v28 row_ror:1 row_mask:0xf bank_mask:0xf
    v_add_f32_dpp v29, v29, v29 row_ror:1 row_mask:0xf bank_mask:0xf
    v_add_f32_dpp v30, v30, v30 row_ror:1 row_mask:0xf bank_mask:0xf
    v_add_f32_dpp v31, v31, v31 row_ror:1 row_mask:0xf bank_mask:0xf
    v_max3_f32 v38, v36, v28, v29
    v_max3_f32 v38, v38, v30, v31
    v_sub_f32 v39, v36, v38
    v_mul_f32 v39, s70, v39
    v_exp_f32 v39, v39
    v_mul_f32 v56, s70, v38
    v_mov_b32 v36, v38
    v_fma_f32 v48, v28, s70, -v56
    v_fma_f32 v49, v29, s70, -v56
    v_fma_f32 v50, v30, s70, -v56
    v_fma_f32 v51, v31, s70, -v56
    v_exp_f32 v48, v48
    v_exp_f32 v49, v49
    v_exp_f32 v50, v50
    v_exp_f32 v51, v51
    v_mul_f32 v37, v37, v39
    v_mul_f32 v16, v16, v39
    v_mul_f32 v17, v17, v39
    v_mul_f32 v18, v18, v39
    v_mul_f32 v19, v19, v39
    v_mul_f32 v20, v20, v39
    v_mul_f32 v21, v21, v39
    v_mul_f32 v22, v22, v39
    v_mul_f32 v23, v23, v39
    v_add_f32 v37, v37, v48
    v_add_f32 v37, v37, v49
    v_add_f32 v37, v37, v50
    v_add_f32 v37, v37, v51
    v_lshlrev_b32 v40, 16, v80
    v_and_b32 v41, 0xffff0000, v80
    v_lshlrev_b32 v42, 16, v81
    v_and_b32 v43, 0xffff0000, v81
    v_lshlrev_b32 v44, 16, v82
    v_and_b32 v45, 0xffff0000, v82
    v_lshlrev_b32 v46, 16, v83
    v_and_b32 v47, 0xffff0000, v83
    s_waitcnt vmcnt(13)
    buffer_load_dwordx4 v[80:83], v4, s[48:51], s100 offen offset:0 nt
    v_fmac_f32 v16, v40, v48
    v_fmac_f32 v17, v41, v48
    v_fmac_f32 v18, v42, v48
    v_fmac_f32 v19, v43, v48
    v_fmac_f32 v20, v44, v48
    v_fmac_f32 v21, v45, v48
    v_fmac_f32 v22, v46, v48
    v_fmac_f32 v23, v47, v48
    v_lshlrev_b32 v40, 16, v84
    v_and_b32 v41, 0xffff0000, v84
    v_lshlrev_b32 v42, 16, v85
    v_and_b32 v43, 0xffff0000, v85
    v_lshlrev_b32 v44, 16, v86
    v_and_b32 v45, 0xffff0000, v86
    v_lshlrev_b32 v46, 16, v87
    v_and_b32 v47, 0xffff0000, v87
    s_waitcnt vmcnt(13)
    buffer_load_dwordx4 v[84:87], v4, s[48:51], s100 offen offset:1024 nt
    v_fmac_f32 v16, v40, v49
    v_fmac_f32 v17, v41, v49
    v_fmac_f32 v18, v42, v49
    v_fmac_f32 v19, v43, v49
    v_fmac_f32 v20, v44, v49
    v_fmac_f32 v21, v45, v49
    v_fmac_f32 v22, v46, v49
    v_fmac_f32 v23, v47, v49
    v_lshlrev_b32 v40, 16, v88
    v_and_b32 v41, 0xffff0000, v88
    v_lshlrev_b32 v42, 16, v89
    v_and_b32 v43, 0xffff0000, v89
    v_lshlrev_b32 v44, 16, v90
    v_and_b32 v45, 0xffff0000, v90
    v_lshlrev_b32 v46, 16, v91
    v_and_b32 v47, 0xffff0000, v91
    s_waitcnt vmcnt(13)
    buffer_load_dwordx4 v[88:91], v4, s[48:51], s100 offen offset:2048 nt
    v_fmac_f32 v16, v40, v50
    v_fmac_f32 v17, v41, v50
    v_fmac_f32 v18, v42, v50
    v_fmac_f32 v19, v43, v50
    v_fmac_f32 v20, v44, v50
    v_fmac_f32 v21, v45, v50
    v_fmac_f32 v22, v46, v50
    v_fmac_f32 v23, v47, v50
    v_lshlrev_b32 v40, 16, v92
    v_and_b32 v41, 0xffff0000, v92
    v_lshlrev_b32 v42, 16, v93
    v_and_b32 v43, 0xffff0000, v93
    v_lshlrev_b32 v44, 16, v94
    v_and_b32 v45, 0xffff0000, v94
    v_lshlrev_b32 v46, 16, v95
    v_and_b32 v47, 0xffff0000, v95
    s_waitcnt vmcnt(13)
    buffer_load_dwordx4 v[92:95], v4, s[48:51], s100 offen offset:3072 nt
    v_fmac_f32 v16, v40, v51
    v_fmac_f32 v17, v41, v51
    v_fmac_f32 v18, v42, v51
    v_fmac_f32 v19, v43, v51
    v_fmac_f32 v20, v44, v51
    v_fmac_f32 v21, v45, v51
    v_fmac_f32 v22, v46, v51
    v_fmac_f32 v23, v47, v51
    s_waitcnt vmcnt(8)
    s_mov_b64 s[94:95], exec
    s_mov_b64 exec, 1
    ds_add_rtn_u32 v59, v61, v5
    s_mov_b64 exec, s[94:95]
    s_waitcnt lgkmcnt(0)
    s_mov_b64 exec, 1
    v_lshlrev_b32 v59, 2, v59
    s_mov_b32 s92, 0
Lpop_31:
    ds_read_b32 v62, v59 offset:1024
    s_waitcnt lgkmcnt(0)
    v_readfirstlane_b32 s73, v62
    s_nop 3
    s_cmp_lg_u32 s73, -1
    s_cbranch_scc1 Lpopd_32
    s_sleep 1
    s_add_u32 s92, s92, 1
    s_cmp_lt_u32 s92, 400000
    s_cbranch_scc1 Lpop_31
Lpopd_32:
    s_mov_b64 exec, -1
LBloop2b_20:
    s_cmp_ge_u32 s73, s74
    s_cbranch_scc1 LBtail1_30
    s_lshl_b32 s100, s73, 12
    s_mov_b32 s72, s73
    v_dot2_f32_bf16 v28, v96, v24, 0
    v_dot2_f32_bf16 v28, v97, v25, v28
    v_dot2_f32_bf16 v28, v98, v26, v28
    v_dot2_f32_bf16 v28, v99, v27, v28
    s_waitcnt vmcnt(13)
    buffer_load_dwordx4 v[96:99], v4, s[44:47], s100 offen offset:0 nt
    v_dot2_f32_bf16 v29, v100, v24, 0
    v_dot2_f32_bf16 v29, v101, v25, v29
    v_dot2_f32_bf16 v29, v102, v26, v29
    v_dot2_f32_bf16 v29, v103, v27, v29
    s_waitcnt vmcnt(13)
    buffer_load_dwordx4 v[100:103], v4, s[44:47], s100 offen offset:1024 nt
    v_dot2_f32_bf16 v30, v104, v24, 0
    v_dot2_f32_bf16 v30, v105, v25, v30
    v_dot2_f32_bf16 v30, v106, v26, v30
    v_dot2_f32_bf16 v30, v107, v27, v30
    s_waitcnt vmcnt(13)
    buffer_load_dwordx4 v[104:107], v4, s[44:47], s100 offen offset:2048 nt
    v_dot2_f32_bf16 v31, v108, v24, 0
    v_dot2_f32_bf16 v31, v109, v25, v31
    v_dot2_f32_bf16 v31, v110, v26, v31
    v_dot2_f32_bf16 v31, v111, v27, v31
    s_waitcnt vmcnt(13)
    buffer_load_dwordx4 v[108:111], v4, s[44:47], s100 offen offset:3072 nt
    s_nop 2
    v_add_f32_dpp v28, v28, v28 row_ror:8 row_mask:0xf bank_mask:0xf
    v_add_f32_dpp v29, v29, v29 row_ror:8 row_mask:0xf bank_mask:0xf
    v_add_f32_dpp v30, v30, v30 row_ror:8 row_mask:0xf bank_mask:0xf
    v_add_f32_dpp v31, v31, v31 row_ror:8 row_mask:0xf bank_mask:0xf
    v_add_f32_dpp v28, v28, v28 row_ror:4 row_mask:0xf bank_mask:0xf
    v_add_f32_dpp v29, v29, v29 row_ror:4 row_mask:0xf bank_mask:0xf
    v_add_f32_dpp v30, v30, v30 row_ror:4 row_mask:0xf bank_mask:0xf
    v_add_f32_dpp v31, v31, v31 row_ror:4 row_mask:0xf bank_mask:0xf
    v_add_f32_dpp v28, v28, v28 row_ror:2 row_mask:0xf bank_mask:0xf
    v_add_f32_dpp v29, v29, v29 row_ror:2 row_mask:0xf bank_mask:0xf
    v_add_f32_dpp v30, v30, v30 row_ror:2 row_mask:0xf bank_mask:0xf
    v_add_f32_dpp v31, v31, v31 row_ror:2 row_mask:0xf bank_mask:0xf
    v_add_f32_dpp v28, v28, v28 row_ror:1 row_mask:0xf bank_mask:0xf
    v_add_f32_dpp v29, v29, v29 row_ror:1 row_mask:0xf bank_mask:0xf
    v_add_f32_dpp v30, v30, v30 row_ror:1 row_mask:0xf bank_mask:0xf
    v_add_f32_dpp v31, v31, v31 row_ror:1 row_mask:0xf bank_mask:0xf
    v_max3_f32 v38, v36, v28, v29
    v_max3_f32 v38, v38, v30, v31
    v_sub_f32 v39, v36, v38
    v_mul_f32 v39, s70, v39
    v_exp_f32 v39, v39
    v_mul_f32 v56, s70, v38
    v_mov_b32 v36, v38
    v_fma_f32 v48, v28, s70, -v56
    v_fma_f32 v49, v29, s70, -v56
    v_fma_f32 v50, v30, s70, -v56
    v_fma_f32 v51, v31, s70, -v56
    v_exp_f32 v48, v48
    v_exp_f32 v49, v49
    v_exp_f32 v50, v50
    v_exp_f32 v51, v51
    v_mul_f32 v37, v37, v39
    v_mul_f32 v16, v16, v39
    v_mul_f32 v17, v17, v39
    v_mul_f32 v18, v18, v39
    v_mul_f32 v19, v19, v39
    v_mul_f32 v20, v20, v39
    v_mul_f32 v21, v21, v39
    v_mul_f32 v22, v22, v39
    v_mul_f32 v23, v23, v39
    v_add_f32 v37, v37, v48
    v_add_f32 v37, v37, v49
    v_add_f32 v37, v37, v50
    v_add_f32 v37, v37, v51
    v_lshlrev_b32 v40, 16, v112
    v_and_b32 v41, 0xffff0000, v112
    v_lshlrev_b32 v42, 16, v113
    v_and_b32 v43, 0xffff0000, v113
    v_lshlrev_b32 v44, 16, v114
    v_and_b32 v45, 0xffff0000, v114
    v_lshlrev_b32 v46, 16, v115
    v_and_b32 v47, 0xffff0000, v115
    s_waitcnt vmcnt(13)
    buffer_load_dwordx4 v[112:115], v4, s[48:51], s100 offen offset:0 nt
    v_fmac_f32 v16, v40, v48
    v_fmac_f32 v17, v41, v48
    v_fmac_f32 v18, v42, v48
    v_fmac_f32 v19, v43, v48
    v_fmac_f32 v20, v44, v48
    v_fmac_f32 v21, v45, v48
    v_fmac_f32 v22, v46, v48
    v_fmac_f32 v23, v47, v48
    v_lshlrev_b32 v40, 16, v116
    v_and_b32 v41, 0xffff0000, v116
    v_lshlrev_b32 v42, 16, v117
    v_and_b32 v43, 0xffff0000, v117
    v_lshlrev_b32 v44, 16, v118
    v_and_b32 v45, 0xffff0000, v118
    v_lshlrev_b32 v46, 16, v119
    v_and_b32 v47, 0xffff0000, v119
    s_waitcnt vmcnt(13)
    buffer_load_dwordx4 v[116:119], v4, s[48:51], s100 offen offset:1024 nt
    v_fmac_f32 v16, v40, v49
    v_fmac_f32 v17, v41, v49
    v_fmac_f32 v18, v42, v49
    v_fmac_f32 v19, v43, v49
    v_fmac_f32 v20, v44, v49
    v_fmac_f32 v21, v45, v49
    v_fmac_f32 v22, v46, v49
    v_fmac_f32 v23, v47, v49
    v_lshlrev_b32 v40, 16, v120
    v_and_b32 v41, 0xffff0000, v120
    v_lshlrev_b32 v42, 16, v121
    v_and_b32 v43, 0xffff0000, v121
    v_lshlrev_b32 v44, 16, v122
    v_and_b32 v45, 0xffff0000, v122
    v_lshlrev_b32 v46, 16, v123
    v_and_b32 v47, 0xffff0000, v123
    s_waitcnt vmcnt(13)
    buffer_load_dwordx4 v[120:123], v4, s[48:51], s100 offen offset:2048 nt
    v_fmac_f32 v16, v40, v50
    v_fmac_f32 v17, v41, v50
    v_fmac_f32 v18, v42, v50
    v_fmac_f32 v19, v43, v50
    v_fmac_f32 v20, v44, v50
    v_fmac_f32 v21, v45, v50
    v_fmac_f32 v22, v46, v50
    v_fmac_f32 v23, v47, v50
    v_lshlrev_b32 v40, 16, v124
    v_and_b32 v41, 0xffff0000, v124
    v_lshlrev_b32 v42, 16, v125
    v_and_b32 v43, 0xffff0000, v125
    v_lshlrev_b32 v44, 16, v126
    v_and_b32 v45, 0xffff0000, v126
    v_lshlrev_b32 v46, 16, v127
    v_and_b32 v47, 0xffff0000, v127
    s_waitcnt vmcnt(13)
    buffer_load_dwordx4 v[124:127], v4, s[48:51], s100 offen offset:3072 nt
    v_fmac_f32 v16, v40, v51
    v_fmac_f32 v17, v41, v51
    v_fmac_f32 v18, v42, v51
    v_fmac_f32 v19, v43, v51
    v_fmac_f32 v20, v44, v51
    v_fmac_f32 v21, v45, v51
    v_fmac_f32 v22, v46, v51
    v_fmac_f32 v23, v47, v51
    s_waitcnt vmcnt(8)
    s_mov_b64 s[94:95], exec
    s_mov_b64 exec, 1
    ds_add_rtn_u32 v59, v61, v5
    s_mov_b64 exec, s[94:95]
    s_waitcnt lgkmcnt(0)
    s_mov_b64 exec, 1
    v_lshlrev_b32 v59, 2, v59
    s_mov_b32 s92, 0
Lpop_33:
    ds_read_b32 v62, v59 offset:1024
    s_waitcnt lgkmcnt(0)
    v_readfirstlane_b32 s73, v62
    s_nop 3
    s_cmp_lg_u32 s73, -1
    s_cbranch_scc1 Lpopd_34
    s_sleep 1
    s_add_u32 s92, s92, 1
    s_cmp_lt_u32 s92, 400000
    s_cbranch_scc1 Lpop_33
Lpopd_34:
    s_mov_b64 exec, -1
    s_branch LBloop2_19
LBtail0_29:
    s_waitcnt vmcnt(15)
    v_dot2_f32_bf16 v28, v64, v24, 0
    v_dot2_f32_bf16 v28, v65, v25, v28
    v_dot2_f32_bf16 v28, v66, v26, v28
    v_dot2_f32_bf16 v28, v67, v27, v28
    s_waitcnt vmcnt(14)
    v_dot2_f32_bf16 v29, v68, v24, 0
    v_dot2_f32_bf16 v29, v69, v25, v29
    v_dot2_f32_bf16 v29, v70, v26, v29
    v_dot2_f32_bf16 v29, v71, v27, v29
    s_waitcnt vmcnt(13)
    v_dot2_f32_bf16 v30, v72, v24, 0
    v_dot2_f32_bf16 v30, v73, v25, v30
    v_dot2_f32_bf16 v30, v74, v26, v30
    v_dot2_f32_bf16 v30, v75, v27, v30
    s_waitcnt vmcnt(12)
    v_dot2_f32_bf16 v31, v76, v24, 0
    v_dot2_f32_bf16 v31, v77, v25, v31
    v_dot2_f32_bf16 v31, v78, v26, v31
    v_dot2_f32_bf16 v31, v79, v27, v31
    s_nop 2
    v_add_f32_dpp v28, v28, v28 row_ror:8 row_mask:0xf bank_mask:0xf
    v_add_f32_dpp v29, v29, v29 row_ror:8 row_mask:0xf bank_mask:0xf
    v_add_f32_dpp v30, v30, v30 row_ror:8 row_mask:0xf bank_mask:0xf
    v_add_f32_dpp v31, v31, v31 row_ror:8 row_mask:0xf bank_mask:0xf
    v_add_f32_dpp v28, v28, v28 row_ror:4 row_mask:0xf bank_mask:0xf
    v_add_f32_dpp v29, v29, v29 row_ror:4 row_mask:0xf bank_mask:0xf
    v_add_f32_dpp v30, v30, v30 row_ror:4 row_mask:0xf bank_mask:0xf
    v_add_f32_dpp v31, v31, v31 row_ror:4 row_mask:0xf bank_mask:0xf
    v_add_f32_dpp v28, v28, v28 row_ror:2 row_mask:0xf bank_mask:0xf
    v_add_f32_dpp v29, v29, v29 row_ror:2 row_mask:0xf bank_mask:0xf
    v_add_f32_dpp v30, v30, v30 row_ror:2 row_mask:0xf bank_mask:0xf
    v_add_f32_dpp v31, v31, v31 row_ror:2 row_mask:0xf bank_mask:0xf
    v_add_f32_dpp v28, v28, v28 row_ror:1 row_mask:0xf bank_mask:0xf
    v_add_f32_dpp v29, v29, v29 row_ror:1 row_mask:0xf bank_mask:0xf
    v_add_f32_dpp v30, v30, v30 row_ror:1 row_mask:0xf bank_mask:0xf
    v_add_f32_dpp v31, v31, v31 row_ror:1 row_mask:0xf bank_mask:0xf
    v_max3_f32 v38, v36, v28, v29
    v_max3_f32 v38, v38, v30, v31
    v_sub_f32 v39, v36, v38
    v_mul_f32 v39, s70, v39
    v_exp_f32 v39, v39
    v_mul_f32 v56, s70, v38
    v_mov_b32 v36, v38
    v_fma_f32 v48, v28, s70, -v56
    v_fma_f32 v49, v29, s70, -v56
    v_fma_f32 v50, v30, s70, -v56
    v_fma_f32 v51, v31, s70, -v56
    v_exp_f32 v48, v48
    v_exp_f32 v49, v49
    v_exp_f32 v50, v50
    v_exp_f32 v51, v51
    v_mul_f32 v37, v37, v39
    v_mul_f32 v16, v16, v39
    v_mul_f32 v17, v17, v39
    v_mul_f32 v18, v18, v39
    v_mul_f32 v19, v19, v39
    v_mul_f32 v20, v20, v39
    v_mul_f32 v21, v21, v39
    v_mul_f32 v22, v22, v39
    v_mul_f32 v23, v23, v39
    v_add_f32 v37, v37, v48
    v_add_f32 v37, v37, v49
    v_add_f32 v37, v37, v50
    v_add_f32 v37, v37, v51
    s_waitcnt vmcnt(11)
    v_lshlrev_b32 v40, 16, v80
    v_and_b32 v41, 0xffff0000, v80
    v_lshlrev_b32 v42, 16, v81
    v_and_b32 v43, 0xffff0000, v81
    v_lshlrev_b32 v44, 16, v82
    v_and_b32 v45, 0xffff0000, v82
    v_lshlrev_b32 v46, 16, v83
    v_and_b32 v47, 0xffff0000, v83
    v_fmac_f32 v16, v40, v48
    v_fmac_f32 v17, v41, v48
    v_fmac_f32 v18, v42, v48
    v_fmac_f32 v19, v43, v48
    v_fmac_f32 v20, v44, v48
    v_fmac_f32 v21, v45, v48
    v_fmac_f32 v22, v46, v48
    v_fmac_f32 v23, v47, v48
    s_waitcnt vmcnt(10)
    v_lshlrev_b32 v40, 16, v84
    v_and_b32 v41, 0xffff0000, v84
    v_lshlrev_b32 v42, 16, v85
    v_and_b32 v43, 0xffff0000, v85
    v_lshlrev_b32 v44, 16, v86
    v_and_b32 v45, 0xffff0000, v86
    v_lshlrev_b32 v46, 16, v87
    v_and_b32 v47, 0xffff0000, v87
    v_fmac_f32 v16, v40, v49
    v_fmac_f32 v17, v41, v49
    v_fmac_f32 v18, v42, v49
    v_fmac_f32 v19, v43, v49
    v_fmac_f32 v20, v44, v49
    v_fmac_f32 v21, v45, v49
    v_fmac_f32 v22, v46, v49
    v_fmac_f32 v23, v47, v49
    s_waitcnt vmcnt(9)
    v_lshlrev_b32 v40, 16, v88
    v_and_b32 v41, 0xffff0000, v88
    v_lshlrev_b32 v42, 16, v89
    v_and_b32 v43, 0xffff0000, v89
    v_lshlrev_b32 v44, 16, v90
    v_and_b32 v45, 0xffff0000, v90
    v_lshlrev_b32 v46, 16, v91
    v_and_b32 v47, 0xffff0000, v91
    v_fmac_f32 v16, v40, v50
    v_fmac_f32 v17, v41, v50
    v_fmac_f32 v18, v42, v50
    v_fmac_f32 v19, v43, v50
    v_fmac_f32 v20, v44, v50
    v_fmac_f32 v21, v45, v50
    v_fmac_f32 v22, v46, v50
    v_fmac_f32 v23, v47, v50
    s_waitcnt vmcnt(8)
    v_lshlrev_b32 v40, 16, v92
    v_and_b32 v41, 0xffff0000, v92
    v_lshlrev_b32 v42, 16, v93
    v_and_b32 v43, 0xffff0000, v93
    v_lshlrev_b32 v44, 16, v94
    v_and_b32 v45, 0xffff0000, v94
    v_lshlrev_b32 v46, 16, v95
    v_and_b32 v47, 0xffff0000, v95
    v_fmac_f32 v16, v40, v51
    v_fmac_f32 v17, v41, v51
    v_fmac_f32 v18, v42, v51
    v_fmac_f32 v19, v43, v51
    v_fmac_f32 v20, v44, v51
    v_fmac_f32 v21, v45, v51
    v_fmac_f32 v22, v46, v51
    v_fmac_f32 v23, v47, v51
    s_waitcnt vmcnt(7)
    v_dot2_f32_bf16 v28, v96, v24, 0
    v_dot2_f32_bf16 v28, v97, v25, v28
    v_dot2_f32_bf16 v28, v98, v26, v28
    v_dot2_f32_bf16 v28, v99, v27, v28
    s_waitcnt vmcnt(6)
    v_dot2_f32_bf16 v29, v100, v24, 0
    v_dot2_f32_bf16 v29, v101, v25, v29
    v_dot2_f32_bf16 v29, v102, v26, v29
    v_dot2_f32_bf16 v29, v103, v27, v29
    s_waitcnt vmcnt(5)
    v_dot2_f32_bf16 v30, v104, v24, 0
    v_dot2_f32_bf16 v30, v105, v25, v30
    v_dot2_f32_bf16 v30, v106, v26, v30
    v_dot2_f32_bf16 v30, v107, v27, v30
    s_waitcnt vmcnt(4)
    v_dot2_f32_bf16 v31, v108, v24, 0
    v_dot2_f32_bf16 v31, v109, v25, v31
    v_dot2_f32_bf16 v31, v110, v26, v31
    v_dot2_f32_bf16 v31, v111, v27, v31
    s_nop 2
    v_add_f32_dpp v28, v28, v28 row_ror:8 row_mask:0xf bank_mask:0xf
    v_add_f32_dpp v29, v29, v29 row_ror:8 row_mask:0xf bank_mask:0xf
    v_add_f32_dpp v30, v30, v30 row_ror:8 row_mask:0xf bank_mask:0xf
    v_add_f32_dpp v31, v31, v31 row_ror:8 row_mask:0xf bank_mask:0xf
    v_add_f32_dpp v28, v28, v28 row_ror:4 row_mask:0xf bank_mask:0xf
    v_add_f32_dpp v29, v29, v29 row_ror:4 row_mask:0xf bank_mask:0xf
    v_add_f32_dpp v30, v30, v30 row_ror:4 row_mask:0xf bank_mask:0xf
    v_add_f32_dpp v31, v31, v31 row_ror:4 row_mask:0xf bank_mask:0xf
    v_add_f32_dpp v28, v28, v28 row_ror:2 row_mask:0xf bank_mask:0xf
    v_add_f32_dpp v29, v29, v29 row_ror:2 row_mask:0xf bank_mask:0xf
    v_add_f32_dpp v30, v30, v30 row_ror:2 row_mask:0xf bank_mask:0xf
    v_add_f32_dpp v31, v31, v31 row_ror:2 row_mask:0xf bank_mask:0xf
    v_add_f32_dpp v28, v28, v28 row_ror:1 row_mask:0xf bank_mask:0xf
    v_add_f32_dpp v29, v29, v29 row_ror:1 row_mask:0xf bank_mask:0xf
    v_add_f32_dpp v30, v30, v30 row_ror:1 row_mask:0xf bank_mask:0xf
    v_add_f32_dpp v31, v31, v31 row_ror:1 row_mask:0xf bank_mask:0xf
    v_max3_f32 v38, v36, v28, v29
    v_max3_f32 v38, v38, v30, v31
    v_sub_f32 v39, v36, v38
    v_mul_f32 v39, s70, v39
    v_exp_f32 v39, v39
    v_mul_f32 v56, s70, v38
    v_mov_b32 v36, v38
    v_fma_f32 v48, v28, s70, -v56
    v_fma_f32 v49, v29, s70, -v56
    v_fma_f32 v50, v30, s70, -v56
    v_fma_f32 v51, v31, s70, -v56
    v_exp_f32 v48, v48
    v_exp_f32 v49, v49
    v_exp_f32 v50, v50
    v_exp_f32 v51, v51
    v_mul_f32 v37, v37, v39
    v_mul_f32 v16, v16, v39
    v_mul_f32 v17, v17, v39
    v_mul_f32 v18, v18, v39
    v_mul_f32 v19, v19, v39
    v_mul_f32 v20, v20, v39
    v_mul_f32 v21, v21, v39
    v_mul_f32 v22, v22, v39
    v_mul_f32 v23, v23, v39
    v_add_f32 v37, v37, v48
    v_add_f32 v37, v37, v49
    v_add_f32 v37, v37, v50
    v_add_f32 v37, v37, v51
    s_waitcnt vmcnt(3)
    v_lshlrev_b32 v40, 16, v112
    v_and_b32 v41, 0xffff0000, v112
    v_lshlrev_b32 v42, 16, v113
    v_and_b32 v43, 0xffff0000, v113
    v_lshlrev_b32 v44, 16, v114
    v_and_b32 v45, 0xffff0000, v114
    v_lshlrev_b32 v46, 16, v115
    v_and_b32 v47, 0xffff0000, v115
    v_fmac_f32 v16, v40, v48
    v_fmac_f32 v17, v41, v48
    v_fmac_f32 v18, v42, v48
    v_fmac_f32 v19, v43, v48
    v_fmac_f32 v20, v44, v48
    v_fmac_f32 v21, v45, v48
    v_fmac_f32 v22, v46, v48
    v_fmac_f32 v23, v47, v48
    s_waitcnt vmcnt(2)
    v_lshlrev_b32 v40, 16, v116
    v_and_b32 v41, 0xffff0000, v116
    v_lshlrev_b32 v42, 16, v117
    v_and_b32 v43, 0xffff0000, v117
    v_lshlrev_b32 v44, 16, v118
    v_and_b32 v45, 0xffff0000, v118
    v_lshlrev_b32 v46, 16, v119
    v_and_b32 v47, 0xffff0000, v119
    v_fmac_f32 v16, v40, v49
    v_fmac_f32 v17, v41, v49
    v_fmac_f32 v18, v42, v49
    v_fmac_f32 v19, v43, v49
    v_fmac_f32 v20, v44, v49
    v_fmac_f32 v21, v45, v49
    v_fmac_f32 v22, v46, v49
    v_fmac_f32 v23, v47, v49
    s_waitcnt vmcnt(1)
    v_lshlrev_b32 v40, 16, v120
    v_and_b32 v41, 0xffff0000, v120
    v_lshlrev_b32 v42, 16, v121
    v_and_b32 v43, 0xffff0000, v121
    v_lshlrev_b32 v44, 16, v122
    v_and_b32 v45, 0xffff0000, v122
    v_lshlrev_b32 v46, 16, v123
    v_and_b32 v47, 0xffff0000, v123
    v_fmac_f32 v16, v40, v50
    v_fmac_f32 v17, v41, v50
    v_fmac_f32 v18, v42, v50
    v_fmac_f32 v19, v43, v50
    v_fmac_f32 v20, v44, v50
    v_fmac_f32 v21, v45, v50
    v_fmac_f32 v22, v46, v50
    v_fmac_f32 v23, v47, v50
    s_waitcnt vmcnt(0)
    v_lshlrev_b32 v40, 16, v124
    v_and_b32 v41, 0xffff0000, v124
    v_lshlrev_b32 v42, 16, v125
    v_and_b32 v43, 0xffff0000, v125
    v_lshlrev_b32 v44, 16, v126
    v_and_b32 v45, 0xffff0000, v126
    v_lshlrev_b32 v46, 16, v127
    v_and_b32 v47, 0xffff0000, v127
    v_fmac_f32 v16, v40, v51
    v_fmac_f32 v17, v41, v51
    v_fmac_f32 v18, v42, v51
    v_fmac_f32 v19, v43, v51
    v_fmac_f32 v20, v44, v51
    v_fmac_f32 v21, v45, v51
    v_fmac_f32 v22, v46, v51
    v_fmac_f32 v23, v47, v51
    s_branch LBdone_18
LBtail1_30:
    s_waitcnt vmcnt(15)
    v_dot2_f32_bf16 v28, v96, v24, 0
    v_dot2_f32_bf16 v28, v97, v25, v28
    v_dot2_f32_bf16 v28, v98, v26, v28
    v_dot2_f32_bf16 v28, v99, v27, v28
    s_waitcnt vmcnt(14)
    v_dot2_f32_bf16 v29, v100, v24, 0
    v_dot2_f32_bf16 v29, v101, v25, v29
    v_dot2_f32_bf16 v29, v102, v26, v29
    v_dot2_f32_bf16 v29, v103, v27, v29
    s_waitcnt vmcnt(13)
    v_dot2_f32_bf16 v30, v104, v24, 0
    v_dot2_f32_bf16 v30, v105, v25, v30
    v_dot2_f32_bf16 v30, v106, v26, v30
    v_dot2_f32_bf16 v30, v107, v27, v30
    s_waitcnt vmcnt(12)
    v_dot2_f32_bf16 v31, v108, v24, 0
    v_dot2_f32_bf16 v31, v109, v25, v31
    v_dot2_f32_bf16 v31, v110, v26, v31
    v_dot2_f32_bf16 v31, v111, v27, v31
    s_nop 2
    v_add_f32_dpp v28, v28, v28 row_ror:8 row_mask:0xf bank_mask:0xf
    v_add_f32_dpp v29, v29, v29 row_ror:8 row_mask:0xf bank_mask:0xf
    v_add_f32_dpp v30, v30, v30 row_ror:8 row_mask:0xf bank_mask:0xf
    v_add_f32_dpp v31, v31, v31 row_ror:8 row_mask:0xf bank_mask:0xf
    v_add_f32_dpp v28, v28, v28 row_ror:4 row_mask:0xf bank_mask:0xf
    v_add_f32_dpp v29, v29, v29 row_ror:4 row_mask:0xf bank_mask:0xf
    v_add_f32_dpp v30, v30, v30 row_ror:4 row_mask:0xf bank_mask:0xf
    v_add_f32_dpp v31, v31, v31 row_ror:4 row_mask:0xf bank_mask:0xf
    v_add_f32_dpp v28, v28, v28 row_ror:2 row_mask:0xf bank_mask:0xf
    v_add_f32_dpp v29, v29, v29 row_ror:2 row_mask:0xf bank_mask:0xf
    v_add_f32_dpp v30, v30, v30 row_ror:2 row_mask:0xf bank_mask:0xf
    v_add_f32_dpp v31, v31, v31 row_ror:2 row_mask:0xf bank_mask:0xf
    v_add_f32_dpp v28, v28, v28 row_ror:1 row_mask:0xf bank_mask:0xf
    v_add_f32_dpp v29, v29, v29 row_ror:1 row_mask:0xf bank_mask:0xf
    v_add_f32_dpp v30, v30, v30 row_ror:1 row_mask:0xf bank_mask:0xf
    v_add_f32_dpp v31, v31, v31 row_ror:1 row_mask:0xf bank_mask:0xf
    v_max3_f32 v38, v36, v28, v29
    v_max3_f32 v38, v38, v30, v31
    v_sub_f32 v39, v36, v38
    v_mul_f32 v39, s70, v39
    v_exp_f32 v39, v39
    v_mul_f32 v56, s70, v38
    v_mov_b32 v36, v38
    v_fma_f32 v48, v28, s70, -v56
    v_fma_f32 v49, v29, s70, -v56
    v_fma_f32 v50, v30, s70, -v56
    v_fma_f32 v51, v31, s70, -v56
    v_exp_f32 v48, v48
    v_exp_f32 v49, v49
    v_exp_f32 v50, v50
    v_exp_f32 v51, v51
    v_mul_f32 v37, v37, v39
    v_mul_f32 v16, v16, v39
    v_mul_f32 v17, v17, v39
    v_mul_f32 v18, v18, v39
    v_mul_f32 v19, v19, v39
    v_mul_f32 v20, v20, v39
    v_mul_f32 v21, v21, v39
    v_mul_f32 v22, v22, v39
    v_mul_f32 v23, v23, v39
    v_add_f32 v37, v37, v48
    v_add_f32 v37, v37, v49
    v_add_f32 v37, v37, v50
    v_add_f32 v37, v37, v51
    s_waitcnt vmcnt(11)
    v_lshlrev_b32 v40, 16, v112
    v_and_b32 v41, 0xffff0000, v112
    v_lshlrev_b32 v42, 16, v113
    v_and_b32 v43, 0xffff0000, v113
    v_lshlrev_b32 v44, 16, v114
    v_and_b32 v45, 0xffff0000, v114
    v_lshlrev_b32 v46, 16, v115
    v_and_b32 v47, 0xffff0000, v115
    v_fmac_f32 v16, v40, v48
    v_fmac_f32 v17, v41, v48
    v_fmac_f32 v18, v42, v48
    v_fmac_f32 v19, v43, v48
    v_fmac_f32 v20, v44, v48
    v_fmac_f32 v21, v45, v48
    v_fmac_f32 v22, v46, v48
    v_fmac_f32 v23, v47, v48
    s_waitcnt vmcnt(10)
    v_lshlrev_b32 v40, 16, v116
    v_and_b32 v41, 0xffff0000, v116
    v_lshlrev_b32 v42, 16, v117
    v_and_b32 v43, 0xffff0000, v117
    v_lshlrev_b32 v44, 16, v118
    v_and_b32 v45, 0xffff0000, v118
    v_lshlrev_b32 v46, 16, v119
    v_and_b32 v47, 0xffff0000, v119
    v_fmac_f32 v16, v40, v49
    v_fmac_f32 v17, v41, v49
    v_fmac_f32 v18, v42, v49
    v_fmac_f32 v19, v43, v49
    v_fmac_f32 v20, v44, v49
    v_fmac_f32 v21, v45, v49
    v_fmac_f32 v22, v46, v49
    v_fmac_f32 v23, v47, v49
    s_waitcnt vmcnt(9)
    v_lshlrev_b32 v40, 16, v120
    v_and_b32 v41, 0xffff0000, v120
    v_lshlrev_b32 v42, 16, v121
    v_and_b32 v43, 0xffff0000, v121
    v_lshlrev_b32 v44, 16, v122
    v_and_b32 v45, 0xffff0000, v122
    v_lshlrev_b32 v46, 16, v123
    v_and_b32 v47, 0xffff0000, v123
    v_fmac_f32 v16, v40, v50
    v_fmac_f32 v17, v41, v50
    v_fmac_f32 v18, v42, v50
    v_fmac_f32 v19, v43, v50
    v_fmac_f32 v20, v44, v50
    v_fmac_f32 v21, v45, v50
    v_fmac_f32 v22, v46, v50
    v_fmac_f32 v23, v47, v50
    s_waitcnt vmcnt(8)
    v_lshlrev_b32 v40, 16, v124
    v_and_b32 v41, 0xffff0000, v124
    v_lshlrev_b32 v42, 16, v125
    v_and_b32 v43, 0xffff0000, v125
    v_lshlrev_b32 v44, 16, v126
    v_and_b32 v45, 0xffff0000, v126
    v_lshlrev_b32 v46, 16, v127
    v_and_b32 v47, 0xffff0000, v127
    v_fmac_f32 v16, v40, v51
    v_fmac_f32 v17, v41, v51
    v_fmac_f32 v18, v42, v51
    v_fmac_f32 v19, v43, v51
    v_fmac_f32 v20, v44, v51
    v_fmac_f32 v21, v45, v51
    v_fmac_f32 v22, v46, v51
    v_fmac_f32 v23, v47, v51
    s_waitcnt vmcnt(7)
    v_dot2_f32_bf16 v28, v64, v24, 0
    v_dot2_f32_bf16 v28, v65, v25, v28
    v_dot2_f32_bf16 v28, v66, v26, v28
    v_dot2_f32_bf16 v28, v67, v27, v28
    s_waitcnt vmcnt(6)
    v_dot2_f32_bf16 v29, v68, v24, 0
    v_dot2_f32_bf16 v29, v69, v25, v29
    v_dot2_f32_bf16 v29, v70, v26, v29
    v_dot2_f32_bf16 v29, v71, v27, v29
    s_waitcnt vmcnt(5)
    v_dot2_f32_bf16 v30, v72, v24, 0
    v_dot2_f32_bf16 v30, v73, v25, v30
    v_dot2_f32_bf16 v30, v74, v26, v30
    v_dot2_f32_bf16 v30, v75, v27, v30
    s_waitcnt vmcnt(4)
    v_dot2_f32_bf16 v31, v76, v24, 0
    v_dot2_f32_bf16 v31, v77, v25, v31
    v_dot2_f32_bf16 v31, v78, v26, v31
    v_dot2_f32_bf16 v31, v79, v27, v31
    s_nop 2
    v_add_f32_dpp v28, v28, v28 row_ror:8 row_mask:0xf bank_mask:0xf
    v_add_f32_dpp v29, v29, v29 row_ror:8 row_mask:0xf bank_mask:0xf
    v_add_f32_dpp v30, v30, v30 row_ror:8 row_mask:0xf bank_mask:0xf
    v_add_f32_dpp v31, v31, v31 row_ror:8 row_mask:0xf bank_mask:0xf
    v_add_f32_dpp v28, v28, v28 row_ror:4 row_mask:0xf bank_mask:0xf
    v_add_f32_dpp v29, v29, v29 row_ror:4 row_mask:0xf bank_mask:0xf
    v_add_f32_dpp v30, v30, v30 row_ror:4 row_mask:0xf bank_mask:0xf
    v_add_f32_dpp v31, v31, v31 row_ror:4 row_mask:0xf bank_mask:0xf
    v_add_f32_dpp v28, v28, v28 row_ror:2 row_mask:0xf bank_mask:0xf
    v_add_f32_dpp v29, v29, v29 row_ror:2 row_mask:0xf bank_mask:0xf
    v_add_f32_dpp v30, v30, v30 row_ror:2 row_mask:0xf bank_mask:0xf
    v_add_f32_dpp v31, v31, v31 row_ror:2 row_mask:0xf bank_mask:0xf
    v_add_f32_dpp v28, v28, v28 row_ror:1 row_mask:0xf bank_mask:0xf
    v_add_f32_dpp v29, v29, v29 row_ror:1 row_mask:0xf bank_mask:0xf
    v_add_f32_dpp v30, v30, v30 row_ror:1 row_mask:0xf bank_mask:0xf
    v_add_f32_dpp v31, v31, v31 row_ror:1 row_mask:0xf bank_mask:0xf
    v_max3_f32 v38, v36, v28, v29
    v_max3_f32 v38, v38, v30, v31
    v_sub_f32 v39, v36, v38
    v_mul_f32 v39, s70, v39
    v_exp_f32 v39, v39
    v_mul_f32 v56, s70, v38
    v_mov_b32 v36, v38
    v_fma_f32 v48, v28, s70, -v56
    v_fma_f32 v49, v29, s70, -v56
    v_fma_f32 v50, v30, s70, -v56
    v_fma_f32 v51, v31, s70, -v56
    v_exp_f32 v48, v48
    v_exp_f32 v49, v49
    v_exp_f32 v50, v50
    v_exp_f32 v51, v51
    v_mul_f32 v37, v37, v39
    v_mul_f32 v16, v16, v39
    v_mul_f32 v17, v17, v39
    v_mul_f32 v18, v18, v39
    v_mul_f32 v19, v19, v39
    v_mul_f32 v20, v20, v39
    v_mul_f32 v21, v21, v39
    v_mul_f32 v22, v22, v39
    v_mul_f32 v23, v23, v39
    v_add_f32 v37, v37, v48
    v_add_f32 v37, v37, v49
    v_add_f32 v37, v37, v50
    v_add_f32 v37, v37, v51
    s_waitcnt vmcnt(3)
    v_lshlrev_b32 v40, 16, v80
    v_and_b32 v41, 0xffff0000, v80
    v_lshlrev_b32 v42, 16, v81
    v_and_b32 v43, 0xffff0000, v81
    v_lshlrev_b32 v44, 16, v82
    v_and_b32 v45, 0xffff0000, v82
    v_lshlrev_b32 v46, 16, v83
    v_and_b32 v47, 0xffff0000, v83
    v_fmac_f32 v16, v40, v48
    v_fmac_f32 v17, v41, v48
    v_fmac_f32 v18, v42, v48
    v_fmac_f32 v19, v43, v48
    v_fmac_f32 v20, v44, v48
    v_fmac_f32 v21, v45, v48
    v_fmac_f32 v22, v46, v48
    v_fmac_f32 v23, v47, v48
    s_waitcnt vmcnt(2)
    v_lshlrev_b32 v40, 16, v84
    v_and_b32 v41, 0xffff0000, v84
    v_lshlrev_b32 v42, 16, v85
    v_and_b32 v43, 0xffff0000, v85
    v_lshlrev_b32 v44, 16, v86
    v_and_b32 v45, 0xffff0000, v86
    v_lshlrev_b32 v46, 16, v87
    v_and_b32 v47, 0xffff0000, v87
    v_fmac_f32 v16, v40, v49
    v_fmac_f32 v17, v41, v49
    v_fmac_f32 v18, v42, v49
    v_fmac_f32 v19, v43, v49
    v_fmac_f32 v20, v44, v49
    v_fmac_f32 v21, v45, v49
    v_fmac_f32 v22, v46, v49
    v_fmac_f32 v23, v47, v49
    s_waitcnt vmcnt(1)
    v_lshlrev_b32 v40, 16, v88
    v_and_b32 v41, 0xffff0000, v88
    v_lshlrev_b32 v42, 16, v89
    v_and_b32 v43, 0xffff0000, v89
    v_lshlrev_b32 v44, 16, v90
    v_and_b32 v45, 0xffff0000, v90
    v_lshlrev_b32 v46, 16, v91
    v_and_b32 v47, 0xffff0000, v91
    v_fmac_f32 v16, v40, v50
    v_fmac_f32 v17, v41, v50
    v_fmac_f32 v18, v42, v50
    v_fmac_f32 v19, v43, v50
    v_fmac_f32 v20, v44, v50
    v_fmac_f32 v21, v45, v50
    v_fmac_f32 v22, v46, v50
    v_fmac_f32 v23, v47, v50
    s_waitcnt vmcnt(0)
    v_lshlrev_b32 v40, 16, v92
    v_and_b32 v41, 0xffff0000, v92
    v_lshlrev_b32 v42, 16, v93
    v_and_b32 v43, 0xffff0000, v93
    v_lshlrev_b32 v44, 16, v94
    v_and_b32 v45, 0xffff0000, v94
    v_lshlrev_b32 v46, 16, v95
    v_and_b32 v47, 0xffff0000, v95
    v_fmac_f32 v16, v40, v51
    v_fmac_f32 v17, v41, v51
    v_fmac_f32 v18, v42, v51
    v_fmac_f32 v19, v43, v51
    v_fmac_f32 v20, v44, v51
    v_fmac_f32 v21, v45, v51
    v_fmac_f32 v22, v46, v51
    v_fmac_f32 v23, v47, v51
LBdone_18:
    v_mov_b32 v38, v36
    v_mov_b32 v40, v38
    s_nop 1
    v_permlane32_swap_b32 v38, v40
    s_nop 1
    v_max_f32 v38, v38, v40
    v_mov_b32 v40, v38
    s_nop 1
    v_permlane16_swap_b32 v38, v40
    s_nop 1
    v_max_f32 v38, v38, v40
    v_sub_f32 v39, v36, v38
    v_mul_f32 v39, s70, v39
    v_exp_f32 v39, v39
    s_nop 0
    v_mul_f32 v37, v37, v39
    v_mul_f32 v16, v16, v39
    v_mul_f32 v17, v17, v39
    v_mul_f32 v18, v18, v39
    v_mul_f32 v19, v19, v39
    v_mul_f32 v20, v20, v39
    v_mul_f32 v21, v21, v39
    v_mul_f32 v22, v22, v39
    v_mul_f32 v23, v23, v39
    v_mov_b32 v40, v37
    s_nop 1
    v_permlane32_swap_b32 v37, v40
    s_nop 1
    v_add_f32 v37, v37, v40
    v_mov_b32 v40, v37
    s_nop 1
    v_permlane16_swap_b32 v37, v40
    s_nop 1
    v_add_f32 v37, v37, v40
    s_nop 2
    v_permlane32_swap_b32 v16, v20
    v_permlane32_swap_b32 v17, v21
    v_permlane32_swap_b32 v18, v22
    v_permlane32_swap_b32 v19, v23
    s_nop 1
    v_add_f32 v16, v16, v20
    v_add_f32 v17, v17, v21
    v_add_f32 v18, v18, v22
    v_add_f32 v19, v19, v23
    s_nop 1
    v_permlane16_swap_b32 v16, v18
    v_permlane16_swap_b32 v17, v19
    s_nop 1
    v_add_f32 v16, v16, v18
    v_add_f32 v17, v17, v19
    ds_write_b64 v7, v[16:17] offset:4096
    v_mov_b32 v40, v38
    v_mov_b32 v41, v37
    s_lshl_b32 s61, s56, 3
    v_mov_b32 v42, s61
    ds_write_b64 v42, v[40:41] offset:8192
    s_waitcnt lgkmcnt(0)
    s_barrier
    s_cmp_lg_u32 s56, 0
    s_cbranch_scc1 L_end
    v_mov_b32 v42, 0
    ds_read_b128 v[28:31], v42 offset:8192
    ds_read_b128 v[32:35], v42 offset:8208
    ds_read_b128 v[48:51], v42 offset:8224
    ds_read_b128 v[52:55], v42 offset:8240
    v_and_b32 v43, 31, v1
    v_lshlrev_b32 v43, 4, v43
    ds_read_b128 v[64:67], v43 offset:4096
    ds_read_b128 v[68:71], v43 offset:4608
    ds_read_b128 v[72:75], v43 offset:5120
    ds_read_b128 v[76:79], v43 offset:5632
    ds_read_b128 v[80:83], v43 offset:6144
    ds_read_b128 v[84:87], v43 offset:6656
    ds_read_b128 v[88:91], v43 offset:7168
    ds_read_b128 v[92:95], v43 offset:7680
    s_waitcnt lgkmcnt(8)
    v_max3_f32 v38, v28, v30, v32
    v_max3_f32 v38, v38, v34, v48
    v_max3_f32 v38, v38, v50, v52
    v_max_f32 v38, v38, v54
    v_mul_f32 v56, s70, v38
    v_fma_f32 v28, v28, s70, -v56
    v_fma_f32 v30, v30, s70, -v56
    v_fma_f32 v32, v32, s70, -v56
    v_fma_f32 v34, v34, s70, -v56
    v_fma_f32 v48, v48, s70, -v56
    v_fma_f32 v50, v50, s70, -v56
    v_fma_f32 v52, v52, s70, -v56
    v_fma_f32 v54, v54, s70, -v56
    v_exp_f32 v28, v28
    v_exp_f32 v30, v30
    v_exp_f32 v32, v32
    v_exp_f32 v34, v34
    v_exp_f32 v48, v48
    v_exp_f32 v50, v50
    v_exp_f32 v52, v52
    v_exp_f32 v54, v54
    s_nop 0
    v_mul_f32 v37, v28, v29
    v_fmac_f32 v37, v30, v31
    v_fmac_f32 v37, v32, v33
    v_fmac_f32 v37, v34, v35
    v_fmac_f32 v37, v48, v49
    v_fmac_f32 v37, v50, v51
    v_fmac_f32 v37, v52, v53
    v_fmac_f32 v37, v54, v55
    s_waitcnt lgkmcnt(0)
    v_mul_f32 v40, v64, v28
    v_mul_f32 v41, v65, v28
    v_mul_f32 v42, v66, v28
    v_mul_f32 v43, v67, v28
    v_fmac_f32 v40, v68, v30
    v_fmac_f32 v41, v69, v30
    v_fmac_f32 v42, v70, v30
    v_fmac_f32 v43, v71, v30
    v_fmac_f32 v40, v72, v32
    v_fmac_f32 v41, v73, v32
    v_fmac_f32 v42, v74, v32
    v_fmac_f32 v43, v75, v32
    v_fmac_f32 v40, v76, v34
    v_fmac_f32 v41, v77, v34
    v_fmac_f32 v42, v78, v34
    v_fmac_f32 v43, v79, v34
    v_fmac_f32 v40, v80, v48
    v_fmac_f32 v41, v81, v48
    v_fmac_f32 v42, v82, v48
    v_fmac_f32 v43, v83, v48
    v_fmac_f32 v40, v84, v50
    v_fmac_f32 v41, v85, v50
    v_fmac_f32 v42, v86, v50
    v_fmac_f32 v43, v87, v50
    v_fmac_f32 v40, v88, v52
    v_fmac_f32 v41, v89, v52
    v_fmac_f32 v42, v90, v52
    v_fmac_f32 v43, v91, v52
    v_fmac_f32 v40, v92, v54
    v_fmac_f32 v41, v93, v54
    v_fmac_f32 v42, v94, v54
    v_fmac_f32 v43, v95, v54
    v_cmp_eq_u32 vcc, 32, v1
    v_mov_b32 v45, 0
    s_nop 0
    v_cndmask_b32 v40, v40, v38, vcc
    v_cndmask_b32 v41, v41, v37, vcc
    v_cndmask_b32 v42, v42, v45, vcc
    v_cndmask_b32 v43, v43, v45, vcc
    v_lshlrev_b32 v44, 4, v1
    s_lshl_b32 s61, s64, 9
    s_add_u32 s61, s61, 256
    v_add_u32 v44, s61, v44
    s_lshl_b32 s61, s64, 4
    s_add_u32 s61, s61, 128
    v_mov_b32 v46, s61
    v_cndmask_b32 v44, v44, v46, vcc
    s_add_u32 s61, s65, 32
    s_mul_i32 s61, s61, 16384
    s_mov_b32 exec_lo, -1
    s_mov_b32 exec_hi, 1
    buffer_store_dwordx4 v[40:43], v44, s[32:35], s61 offen sc0 sc1
    s_mov_b64 exec, -1
    s_branch L_end
L_roleA:
    s_and_b32 s60, s57, 3
    s_lshr_b32 s59, s57, 2
    s_lshl_b32 s59, s59, 5
    s_lshl_b32 s75, s58, 2
    s_add_u32 s75, s75, s60
    s_add_u32 s75, s75, s59
    s_waitcnt lgkmcnt(0)
    s_mov_b32 s32, s30
    s_and_b32 s33, s31, 0xffff
    s_mov_b32 s52, s28
    s_and_b32 s53, s29, 0xffff
    v_and_b32 v1, 63, v0
    v_lshrrev_b32 v2, 4, v1
    v_and_b32 v3, 15, v1
    v_lshlrev_b32 v5, 4, v1
    v_lshlrev_b32 v4, 17, v2
    v_lshl_add_u32 v4, v3, 4, v4
    s_mov_b32 s68, 0x05040100
    s_mov_b32 s69, 0x07060302
    s_mul_i32 s93, s75, 16384
    v_mov_b32 v40, -1
    v_mov_b32 v41, -1
    v_mov_b32 v42, -1
    v_mov_b32 v43, -1
    s_cmp_lg_u32 s57, 0
    s_cbranch_scc1 Lcq_35
    v_lshlrev_b32 v45, 4, v0
    s_lshl_b32 s61, s75, 11
    s_add_u32 s61, s61, 1310720
    buffer_store_dwordx4 v[40:43], v45, s[32:35], s61 offen sc0 sc1
    s_add_u32 s61, s61, 65536
    buffer_store_dwordx4 v[40:43], v45, s[32:35], s61 offen sc0 sc1
    s_waitcnt vmcnt(0)
    s_barrier
    s_cmp_lg_u32 s56, 7
    s_cbranch_scc1 Lcq_35
    v_mov_b32 v45, 1
    v_mov_b32 v46, 0
    s_mov_b64 s[94:95], exec
    s_mov_b64 exec, 1
    buffer_atomic_add v45, v46, s[52:55], s75 offen offset:0 sc1
    s_mov_b64 exec, s[94:95]
Lcq_35:
    v_lshlrev_b32 v44, 4, v0
    v_cmp_gt_u32 vcc, 7424, v44
    s_and_saveexec_b64 s[94:95], vcc
    s_cbranch_execz Lci_36
    buffer_store_dwordx4 v[40:43], v44, s[32:35], s93 offen sc0 sc1
Lci_36:
    s_mov_b64 exec, s[94:95]
    s_cmp_lg_u32 s56, 5
    s_cbranch_scc1 Lcq_37
    v_mov_b32 v46, 0
    v_mov_b32 v47, 65536
    s_lshl_b32 s61, s75, 8
    s_add_u32 s61, s61, 1507328
    s_mov_b64 s[94:95], exec
    s_mov_b64 exec, 1
    buffer_store_dword v47, v46, s[32:35], s61 offen sc0 sc1
    s_mov_b64 exec, s[94:95]
Lcq_37:
    s_cmp_lg_u32 s56, 6
    s_cbranch_scc1 Lcq_38
    s_lshl_b32 s61, s75, 10
    s_add_u32 s61, s61, 1146880
    buffer_store_dwordx4 v[40:43], v5, s[32:35], s61 offen sc0 sc1
Lcq_38:
    s_cmp_eq_u32 s78, 0
    s_cselect_b32 s36, s8, s22
    s_cselect_b32 s37, s9, s23
    s_cselect_b32 s40, s4, s16
    s_cselect_b32 s41, s5, s17
    s_and_b32 s37, s37, 0xffff
    s_and_b32 s41, s41, 0xffff
    buffer_load_dwordx4 v[192:195], v232, s[36:39], s77 offen nt
    s_add_u32 s77, s77, 8192
    buffer_load_dwordx4 v[196:199], v232, s[36:39], s77 offen nt
    s_add_u32 s77, s77, 8192
    buffer_load_dwordx4 v[200:203], v232, s[36:39], s77 offen nt
    s_add_u32 s77, s77, 8192
    buffer_load_dwordx4 v[204:207], v232, s[36:39], s77 offen nt
    buffer_load_dwordx2 v[208:209], v231, s[40:43], s76 offen offset:0
    buffer_load_dwordx2 v[210:211], v231, s[40:43], s76 offen offset:1024
    s_cmp_lt_u32 s75, 32
    s_cbranch_scc1 L_roleT1
    s_sub_u32 s65, s75, 32
    s_waitcnt vmcnt(0)
    s_barrier
    s_cmp_lg_u32 s56, 1
    s_cbranch_scc1 Lsc_39
    v_mov_b32 v40, 1
    v_mov_b32 v41, 0
    s_mov_b64 s[94:95], exec
    s_mov_b64 exec, 1
    buffer_atomic_add v40, v41, s[52:55], 0 offen offset:128 sc1
    s_mov_b64 exec, s[94:95]
Lsc_39:
    s_lshl_b32 s61, s65, 18
    s_add_u32 s44, s6, s61
    s_addc_u32 s45, s7, 0
    s_and_b32 s45, s45, 0xffff
    s_mov_b32 s46, 262144
    s_mov_b32 s47, 0x00020000
    s_waitcnt vmcnt(0)
    v_perm_b32 v232, v196, v192, s68
    v_perm_b32 v233, v196, v192, s69
    v_perm_b32 v234, v197, v193, s68
    v_perm_b32 v235, v197, v193, s69
    v_perm_b32 v236, v198, v194, s68
    v_perm_b32 v237, v198, v194, s69
    v_perm_b32 v238, v199, v195, s68
    v_perm_b32 v239, v199, v195, s69
    v_dot2_f32_bf16 v212, v232, v208, 0
    v_dot2_f32_bf16 v213, v233, v208, 0
    v_dot2_f32_bf16 v214, v234, v208, 0
    v_dot2_f32_bf16 v215, v235, v208, 0
    v_dot2_f32_bf16 v216, v236, v208, 0
    v_dot2_f32_bf16 v217, v237, v208, 0
    v_dot2_f32_bf16 v218, v238, v208, 0
    v_dot2_f32_bf16 v219, v239, v208, 0
    v_dot2_f32_bf16 v220, v232, v210, 0
    v_dot2_f32_bf16 v221, v233, v210, 0
    v_dot2_f32_bf16 v222, v234, v210, 0
    v_dot2_f32_bf16 v223, v235, v210, 0
    v_dot2_f32_bf16 v224, v236, v210, 0
    v_dot2_f32_bf16 v225, v237, v210, 0
    v_dot2_f32_bf16 v226, v238, v210, 0
    v_dot2_f32_bf16 v227, v239, v210, 0
    v_perm_b32 v232, v204, v200, s68
    v_perm_b32 v233, v204, v200, s69
    v_perm_b32 v234, v205, v201, s68
    v_perm_b32 v235, v205, v201, s69
    v_perm_b32 v236, v206, v202, s68
    v_perm_b32 v237, v206, v202, s69
    v_perm_b32 v238, v207, v203, s68
    v_perm_b32 v239, v207, v203, s69
    v_dot2_f32_bf16 v212, v232, v209, v212
    v_dot2_f32_bf16 v213, v233, v209, v213
    v_dot2_f32_bf16 v214, v234, v209, v214
    v_dot2_f32_bf16 v215, v235, v209, v215
    v_dot2_f32_bf16 v216, v236, v209, v216
    v_dot2_f32_bf16 v217, v237, v209, v217
    v_dot2_f32_bf16 v218, v238, v209, v218
    v_dot2_f32_bf16 v219, v239, v209, v219
    v_dot2_f32_bf16 v220, v232, v211, v220
    v_dot2_f32_bf16 v221, v233, v211, v221
    v_dot2_f32_bf16 v222, v234, v211, v222
    v_dot2_f32_bf16 v223, v235, v211, v223
    v_dot2_f32_bf16 v224, v236, v211, v224
    v_dot2_f32_bf16 v225, v237, v211, v225
    v_dot2_f32_bf16 v226, v238, v211, v226
    v_dot2_f32_bf16 v227, v239, v211, v227
    s_nop 2
    v_permlane32_swap_b32 v212, v220
    v_permlane32_swap_b32 v213, v221
    v_permlane32_swap_b32 v214, v222
    v_permlane32_swap_b32 v215, v223
    v_permlane32_swap_b32 v216, v224
    v_permlane32_swap_b32 v217, v225
    v_permlane32_swap_b32 v218, v226
    v_permlane32_swap_b32 v219, v227
    s_nop 1
    v_add_f32 v212, v212, v220
    v_add_f32 v213, v213, v221
    v_add_f32 v214, v214, v222
    v_add_f32 v215, v215, v223
    v_add_f32 v216, v216, v224
    v_add_f32 v217, v217, v225
    v_add_f32 v218, v218, v226
    v_add_f32 v219, v219, v227
    s_nop 1
    v_permlane16_swap_b32 v212, v216
    v_permlane16_swap_b32 v213, v217
    v_permlane16_swap_b32 v214, v218
    v_permlane16_swap_b32 v215, v219
    s_nop 1
    v_add_f32 v212, v212, v216
    v_add_f32 v213, v213, v217
    v_add_f32 v214, v214, v218
    v_add_f32 v215, v215, v219
    s_nop 1
    v_add_f32_dpp v212, v212, v212 row_ror:8 row_mask:0xf bank_mask:0xf
    v_add_f32_dpp v213, v213, v213 row_ror:8 row_mask:0xf bank_mask:0xf
    v_add_f32_dpp v214, v214, v214 row_ror:8 row_mask:0xf bank_mask:0xf
    v_add_f32_dpp v215, v215, v215 row_ror:8 row_mask:0xf bank_mask:0xf
    v_lshrrev_b32 v232, 5, v228
    v_lshlrev_b32 v232, 8, v232
    v_bfe_u32 v233, v228, 4, 1
    v_lshl_add_u32 v232, v233, 4, v232
    v_lshl_add_u32 v232, v230, 5, v232
    s_lshl_b32 s61, s56, 9
    s_add_u32 s61, s61, 147456
    v_add_u32 v232, s61, v232
    ds_write_b128 v232, v[212:215]
    s_waitcnt lgkmcnt(0)
    s_barrier
    s_cmp_lg_u32 s56, 0
    s_cbranch_scc1 Ls1p_40
    v_mov_b32 v234, 0
    buffer_load_dword v235, v234, s[52:55], s91 offen offset:0 sc0 sc1
    v_and_b32 v232, 31, v228
    v_lshlrev_b32 v233, 4, v232
    v_add_u32 v233, 147456, v233
    ds_read_b128 v[192:195], v233 offset:0
    ds_read_b128 v[196:199], v233 offset:512
    ds_read_b128 v[200:203], v233 offset:1024
    ds_read_b128 v[204:207], v233 offset:1536
    ds_read_b128 v[208:211], v233 offset:2048
    ds_read_b128 v[212:215], v233 offset:2560
    ds_read_b128 v[216:219], v233 offset:3072
    ds_read_b128 v[220:223], v233 offset:3584
    s_waitcnt lgkmcnt(6)
    v_add_f32 v192, v192, v196
    v_add_f32 v193, v193, v197
    v_add_f32 v194, v194, v198
    v_add_f32 v195, v195, v199
    s_waitcnt lgkmcnt(5)
    v_add_f32 v192, v192, v200
    v_add_f32 v193, v193, v201
    v_add_f32 v194, v194, v202
    v_add_f32 v195, v195, v203
    s_waitcnt lgkmcnt(4)
    v_add_f32 v192, v192, v204
    v_add_f32 v193, v193, v205
    v_add_f32 v194, v194, v206
    v_add_f32 v195, v195, v207
    s_waitcnt lgkmcnt(3)
    v_add_f32 v192, v192, v208
    v_add_f32 v193, v193, v209
    v_add_f32 v194, v194, v210
    v_add_f32 v195, v195, v211
    s_waitcnt lgkmcnt(2)
    v_add_f32 v192, v192, v212
    v_add_f32 v193, v193, v213
    v_add_f32 v194, v194, v214
    v_add_f32 v195, v195, v215
    s_waitcnt lgkmcnt(1)
    v_add_f32 v192, v192, v216
    v_add_f32 v193, v193, v217
    v_add_f32 v194, v194, v218
    v_add_f32 v195, v195, v219
    s_waitcnt lgkmcnt(0)
    v_add_f32 v192, v192, v220
    v_add_f32 v193, v193, v221
    v_add_f32 v194, v194, v222
    v_add_f32 v195, v195, v223
    v_lshrrev_b32 v233, 4, v232
    v_lshlrev_b32 v233, 10, v233
    v_and_b32 v232, 15, v232
    v_lshl_add_u32 v233, v232, 4, v233
    s_waitcnt vmcnt(0)
    s_mov_b32 s92, 0
Lcf_41:
    v_readfirstlane_b32 s57, v235
    s_nop 3
    s_cmp_lg_u32 s57, 0
    s_cbranch_scc1 Lcfd_42
    s_sleep 2
    buffer_load_dword v235, v234, s[52:55], s91 offen offset:0 sc0 sc1
    s_waitcnt vmcnt(0)
    s_add_u32 s92, s92, 1
    s_cmp_lt_u32 s92, 400000
    s_cbranch_scc1 Lcf_41
Lcfd_42:
    s_mov_b64 exec, 0xffffffff
    buffer_store_dwordx4 v[192:195], v233, s[32:35], s3 offen sc0 sc1
    s_mov_b64 exec, -1
Ls1p_40:
    s_lshl_b32 s61, s56, 14
    s_add_u32 m0, s61, 0
    v_xor_b32 v52, 0, v5
    s_add_u32 s62, s61, 0
    buffer_load_dwordx4 v52, s[44:47], s62 offen nt lds
    s_add_u32 m0, s61, 1024
    v_xor_b32 v53, 64, v5
    s_add_u32 s62, s61, 1024
    buffer_load_dwordx4 v53, s[44:47], s62 offen nt lds
    s_add_u32 m0, s61, 2048
    v_xor_b32 v52, 128, v5
    s_add_u32 s62, s61, 2048
    buffer_load_dwordx4 v52, s[44:47], s62 offen nt lds
    s_add_u32 m0, s61, 3072
    v_xor_b32 v53, 192, v5
    s_add_u32 s62, s61, 3072
    buffer_load_dwordx4 v53, s[44:47], s62 offen nt lds
    s_add_u32 m0, s61, 4096
    v_xor_b32 v52, 0, v5
    s_add_u32 s62, s61, 4096
    buffer_load_dwordx4 v52, s[44:47], s62 offen nt lds
    s_add_u32 m0, s61, 5120
    v_xor_b32 v53, 64, v5
    s_add_u32 s62, s61, 5120
    buffer_load_dwordx4 v53, s[44:47], s62 offen nt lds
    s_add_u32 m0, s61, 6144
    v_xor_b32 v52, 128, v5
    s_add_u32 s62, s61, 6144
    buffer_load_dwordx4 v52, s[44:47], s62 offen nt lds
    s_add_u32 m0, s61, 7168
    v_xor_b32 v53, 192, v5
    s_add_u32 s62, s61, 7168
    buffer_load_dwordx4 v53, s[44:47], s62 offen nt lds
    s_add_u32 m0, s61, 8192
    v_xor_b32 v52, 32, v5
    s_add_u32 s62, s61, 8192
    buffer_load_dwordx4 v52, s[44:47], s62 offen nt lds
    s_add_u32 m0, s61, 9216
    v_xor_b32 v53, 96, v5
    s_add_u32 s62, s61, 9216
    buffer_load_dwordx4 v53, s[44:47], s62 offen nt lds
    s_add_u32 m0, s61, 10240
    v_xor_b32 v52, 160, v5
    s_add_u32 s62, s61, 10240
    buffer_load_dwordx4 v52, s[44:47], s62 offen nt lds
    s_add_u32 m0, s61, 11264
    v_xor_b32 v53, 224, v5
    s_add_u32 s62, s61, 11264
    buffer_load_dwordx4 v53, s[44:47], s62 offen nt lds
    s_add_u32 m0, s61, 12288
    v_xor_b32 v52, 32, v5
    s_add_u32 s62, s61, 12288
    buffer_load_dwordx4 v52, s[44:47], s62 offen nt lds
    s_add_u32 m0, s61, 13312
    v_xor_b32 v53, 96, v5
    s_add_u32 s62, s61, 13312
    buffer_load_dwordx4 v53, s[44:47], s62 offen nt lds
    s_add_u32 m0, s61, 14336
    v_xor_b32 v52, 160, v5
    s_add_u32 s62, s61, 14336
    buffer_load_dwordx4 v52, s[44:47], s62 offen nt lds
    s_add_u32 m0, s61, 15360
    v_xor_b32 v53, 224, v5
    s_add_u32 s62, s61, 15360
    buffer_load_dwordx4 v53, s[44:47], s62 offen nt lds
    s_barrier
    s_lshr_b32 s66, s65, 4
    s_and_b32 s67, s65, 15
    s_and_b32 s63, s56, 3
    s_lshr_b32 s64, s56, 2
    v_and_b32 v40, 3, v3
    v_lshlrev_b32 v40, 2, v40
    v_lshrrev_b32 v41, 3, v3
    v_lshl_or_b32 v40, v41, 1, v40
    s_lshl_b32 s61, s63, 15
    v_lshlrev_b32 v41, 10, v3
    v_add_u32 v41, s61, v41
    v_add_u32 v42, 0, v2
    v_xor_b32 v42, v42, v40
    v_lshl_add_u32 v8, v42, 4, v41
    v_add_u32 v42, 4, v2
    v_xor_b32 v42, v42, v40
    v_lshl_add_u32 v9, v42, 4, v41
    v_add_u32 v42, 8, v2
    v_xor_b32 v42, v42, v40
    v_lshl_add_u32 v10, v42, 4, v41
    v_add_u32 v42, 12, v2
    v_xor_b32 v42, v42, v40
    v_lshl_add_u32 v11, v42, 4, v41
    s_lshl_b32 s61, s64, 14
    s_add_u32 s61, s61, 131072
    s_lshl_b32 s62, s63, 15
    s_sub_u32 s61, s61, s62
    v_lshrrev_b32 v43, 1, v2
    v_and_b32 v44, 1, v2
    v_lshrrev_b32 v45, 2, v3
    v_lshl_add_u32 v46, v43, 3, v45
    v_lshlrev_b32 v47, 2, v45
    v_lshl_or_b32 v47, v43, 1, v47
    v_bfe_u32 v48, v3, 1, 1
    v_lshl_add_u32 v48, v44, 1, v48
    s_lshl_b32 s62, s56, 3
    s_add_u32 s62, s62, 0
    v_add_u32 v48, s62, v48
    v_xor_b32 v48, v48, v47
    v_lshlrev_b32 v48, 4, v48
    v_lshl_add_u32 v48, v46, 10, v48
    v_and_b32 v49, 1, v3
    v_lshl_add_u32 v12, v49, 3, v48
    v_bfe_u32 v48, v3, 1, 1
    v_lshl_add_u32 v48, v44, 1, v48
    s_lshl_b32 s62, s56, 3
    s_add_u32 s62, s62, 4
    v_add_u32 v48, s62, v48
    v_xor_b32 v48, v48, v47
    v_lshlrev_b32 v48, 4, v48
    v_lshl_add_u32 v48, v46, 10, v48
    v_and_b32 v49, 1, v3
    v_lshl_add_u32 v13, v49, 3, v48
    v_lshl_add_u32 v46, v43, 3, v45
    v_add_u32 v46, 4, v46
    v_lshlrev_b32 v47, 2, v45
    v_lshl_or_b32 v47, v43, 1, v47
    v_bfe_u32 v48, v3, 1, 1
    v_lshl_add_u32 v48, v44, 1, v48
    s_lshl_b32 s62, s56, 3
    s_add_u32 s62, s62, 0
    v_add_u32 v48, s62, v48
    v_xor_b32 v48, v48, v47
    v_lshlrev_b32 v48, 4, v48
    v_lshl_add_u32 v48, v46, 10, v48
    v_and_b32 v49, 1, v3
    v_lshl_add_u32 v14, v49, 3, v48
    v_bfe_u32 v48, v3, 1, 1
    v_lshl_add_u32 v48, v44, 1, v48
    s_lshl_b32 s62, s56, 3
    s_add_u32 s62, s62, 4
    v_add_u32 v48, s62, v48
    v_xor_b32 v48, v48, v47
    v_lshlrev_b32 v48, 4, v48
    v_lshl_add_u32 v48, v46, 10, v48
    v_and_b32 v49, 1, v3
    v_lshl_add_u32 v15, v49, 3, v48
    v_and_b32 v43, 31, v1
    v_lshrrev_b32 v44, 5, v1
    v_mul_u32_u24 v16, 272, v43
    v_lshl_add_u32 v16, v44, 4, v16
    v_add_u32 v16, 131072, v16
    v_lshlrev_b32 v23, 4, v43
    v_add_u32 v23, 139776, v23
    s_lshl_b32 s62, s64, 4
    v_add_u32 v43, s62, v3
    v_mul_u32_u24 v17, 272, v43
    v_lshl_add_u32 v17, v2, 3, v17
    s_lshl_b32 s62, s63, 6
    s_add_u32 s62, s62, 131072
    v_add_u32 v17, s62, v17
    v_lshlrev_b32 v22, 4, v43
    v_add_u32 v22, 139776, v22
    s_lshl_b32 s62, s63, 2
    v_add_u32 v21, s62, v22
    v_add_u32 v33, s61, v8
    v_mov_b32 v18, 0xff7fffff
    v_mov_b32 v20, 0xff7fffff
    v_mov_b32 v19, 0
    s_mov_b32 s100, s61
    s_cmp_lt_u32 s56, 4
    s_cbranch_scc1 Lqa0_43
    s_waitcnt vmcnt(0)
    s_lshl_b32 s61, s56, 14
    s_add_u32 s61, s61, 131072
    buffer_load_dwordx4 v[128:131], v5, s[44:47], s61 offen offset:0 nt
    buffer_load_dwordx4 v[132:135], v5, s[44:47], s61 offen offset:1024 nt
    buffer_load_dwordx4 v[136:139], v5, s[44:47], s61 offen offset:2048 nt
    buffer_load_dwordx4 v[140:143], v5, s[44:47], s61 offen offset:3072 nt
    s_add_u32 s61, s61, 4096
    buffer_load_dwordx4 v[144:147], v5, s[44:47], s61 offen offset:0 nt
    buffer_load_dwordx4 v[148:151], v5, s[44:47], s61 offen offset:1024 nt
    buffer_load_dwordx4 v[152:155], v5, s[44:47], s61 offen offset:2048 nt
    buffer_load_dwordx4 v[156:159], v5, s[44:47], s61 offen offset:3072 nt
    s_add_u32 s61, s61, 4096
    buffer_load_dwordx4 v[160:163], v5, s[44:47], s61 offen offset:0 nt
    buffer_load_dwordx4 v[164:167], v5, s[44:47], s61 offen offset:1024 nt
    buffer_load_dwordx4 v[168:171], v5, s[44:47], s61 offen offset:2048 nt
    buffer_load_dwordx4 v[172:175], v5, s[44:47], s61 offen offset:3072 nt
    s_add_u32 s61, s61, 4096
    buffer_load_dwordx4 v[176:179], v5, s[44:47], s61 offen offset:0 nt
    buffer_load_dwordx4 v[180:183], v5, s[44:47], s61 offen offset:1024 nt
    buffer_load_dwordx4 v[184:187], v5, s[44:47], s61 offen offset:2048 nt
    buffer_load_dwordx4 v[188:191], v5, s[44:47], s61 offen offset:3072 nt
    s_branch Lqaj_44
Lqa0_43:
    v_mov_b32 v40, 0
    s_mov_b32 s92, 0
Lcf_45:
    buffer_load_dword v41, v40, s[52:55], 0 offen offset:128 sc0 sc1
    s_waitcnt vmcnt(0)
    v_readfirstlane_b32 s57, v41
    s_nop 3
    s_cmp_ge_u32 s57, 64
    s_cbranch_scc1 Lcfd_46
    s_sleep 16
    s_add_u32 s92, s92, 1
    s_cmp_lt_u32 s92, 400000
    s_cbranch_scc1 Lcf_45
Lcfd_46:
    s_lshl_b32 s61, s66, 15
    s_lshl_b32 s62, s56, 13
    s_add_u32 s61, s61, s62
    s_add_u32 s61, s61, 1146880
    s_add_u32 s62, s61, 4096
    s_mov_b32 s92, 0
Lpoll_47:
    buffer_load_dwordx4 v[64:67], v5, s[32:35], s61 offen offset:0 sc0 sc1
    buffer_load_dwordx4 v[68:71], v5, s[32:35], s61 offen offset:1024 sc0 sc1
    buffer_load_dwordx4 v[72:75], v5, s[32:35], s61 offen offset:2048 sc0 sc1
    buffer_load_dwordx4 v[76:79], v5, s[32:35], s61 offen offset:3072 sc0 sc1
    buffer_load_dwordx4 v[80:83], v5, s[32:35], s62 offen offset:0 sc0 sc1
    buffer_load_dwordx4 v[84:87], v5, s[32:35], s62 offen offset:1024 sc0 sc1
    buffer_load_dwordx4 v[88:91], v5, s[32:35], s62 offen offset:2048 sc0 sc1
    buffer_load_dwordx4 v[92:95], v5, s[32:35], s62 offen offset:3072 sc0 sc1
    s_waitcnt vmcnt(0)
    v_mov_b32 v40, v64
    v_max3_u32 v40, v40, v65, v66
    v_max3_u32 v40, v40, v67, v68
    v_max3_u32 v40, v40, v69, v70
    v_max3_u32 v40, v40, v71, v72
    v_max3_u32 v40, v40, v73, v74
    v_max3_u32 v40, v40, v75, v76
    v_max3_u32 v40, v40, v77, v78
    v_max3_u32 v40, v40, v79, v80
    v_max3_u32 v40, v40, v81, v82
    v_max3_u32 v40, v40, v83, v84
    v_max3_u32 v40, v40, v85, v86
    v_max3_u32 v40, v40, v87, v88
    v_max3_u32 v40, v40, v89, v90
    v_max3_u32 v40, v40, v91, v92
    v_max3_u32 v40, v40, v93, v94
    v_max_u32 v40, v40, v95
    v_cmpx_eq_u32 vcc, -1, v40
    s_cbranch_execz Lpolld_48
    s_sleep 4
    s_add_u32 s92, s92, 1
    s_cmp_lt_u32 s92, 400000
    s_cbranch_scc1 Lpoll_47
Lpolld_48:
    s_mov_b64 exec, -1
    s_and_b32 s62, s56, 1
    s_lshl_b32 s62, s62, 5
    s_lshl_b32 s61, s56, 13
    s_add_u32 s61, s61, 131072
    s_add_u32 s57, s62, 0
    v_xor_b32 v40, s57, v5
    v_add_u32 v40, s61, v40
    ds_write_b128 v40, v[64:67] offset:0
    s_add_u32 s57, s62, 64
    v_xor_b32 v41, s57, v5
    v_add_u32 v41, s61, v41
    ds_write_b128 v41, v[68:71] offset:1024
    s_add_u32 s57, s62, 128
    v_xor_b32 v42, s57, v5
    v_add_u32 v42, s61, v42
    ds_write_b128 v42, v[72:75] offset:2048
    s_add_u32 s57, s62, 192
    v_xor_b32 v43, s57, v5
    v_add_u32 v43, s61, v43
    ds_write_b128 v43, v[76:79] offset:3072
    s_add_u32 s57, s62, 0
    v_xor_b32 v40, s57, v5
    v_add_u32 v40, s61, v40
    ds_write_b128 v40, v[80:83] offset:4096
    s_add_u32 s57, s62, 64
    v_xor_b32 v41, s57, v5
    v_add_u32 v41, s61, v41
    ds_write_b128 v41, v[84:87] offset:5120
    s_add_u32 s57, s62, 128
    v_xor_b32 v42, s57, v5
    v_add_u32 v42, s61, v42
    ds_write_b128 v42, v[88:91] offset:6144
    s_add_u32 s57, s62, 192
    v_xor_b32 v43, s57, v5
    v_add_u32 v43, s61, v43
    ds_write_b128 v43, v[92:95] offset:7168
    s_waitcnt lgkmcnt(0)
    s_lshl_b32 s61, s56, 14
    s_add_u32 s61, s61, 131072
    buffer_load_dwordx4 v[128:131], v5, s[44:47], s61 offen offset:0 nt
    buffer_load_dwordx4 v[132:135], v5, s[44:47], s61 offen offset:1024 nt
    buffer_load_dwordx4 v[136:139], v5, s[44:47], s61 offen offset:2048 nt
    buffer_load_dwordx4 v[140:143], v5, s[44:47], s61 offen offset:3072 nt
    s_add_u32 s61, s61, 4096
    buffer_load_dwordx4 v[144:147], v5, s[44:47], s61 offen offset:0 nt
    buffer_load_dwordx4 v[148:151], v5, s[44:47], s61 offen offset:1024 nt
    buffer_load_dwordx4 v[152:155], v5, s[44:47], s61 offen offset:2048 nt
    buffer_load_dwordx4 v[156:159], v5, s[44:47], s61 offen offset:3072 nt
    s_add_u32 s61, s61, 4096
    buffer_load_dwordx4 v[160:163], v5, s[44:47], s61 offen offset:0 nt
    buffer_load_dwordx4 v[164:167], v5, s[44:47], s61 offen offset:1024 nt
    buffer_load_dwordx4 v[168:171], v5, s[44:47], s61 offen offset:2048 nt
    buffer_load_dwordx4 v[172:175], v5, s[44:47], s61 offen offset:3072 nt
    s_add_u32 s61, s61, 4096
    buffer_load_dwordx4 v[176:179], v5, s[44:47], s61 offen offset:0 nt
    buffer_load_dwordx4 v[180:183], v5, s[44:47], s61 offen offset:1024 nt
    buffer_load_dwordx4 v[184:187], v5, s[44:47], s61 offen offset:2048 nt
    buffer_load_dwordx4 v[188:191], v5, s[44:47], s61 offen offset:3072 nt
Lqaj_44:
    s_barrier
    v_add_u32 v40, s100, v8
    v_add_u32 v41, s100, v9
    v_add_u32 v42, s100, v10
    v_add_u32 v43, s100, v11
    ds_read_b128 v[192:195], v40 offset:0
    ds_read_b128 v[196:199], v41 offset:0
    ds_read_b128 v[200:203], v42 offset:0
    ds_read_b128 v[204:207], v43 offset:0
    ds_read_b128 v[208:211], v40 offset:256
    ds_read_b128 v[212:215], v41 offset:256
    ds_read_b128 v[216:219], v42 offset:256
    ds_read_b128 v[220:223], v43 offset:256
    ds_read_b128 v[224:227], v40 offset:512
    ds_read_b128 v[228:231], v41 offset:512
    ds_read_b128 v[232:235], v42 offset:512
    ds_read_b128 v[236:239], v43 offset:512
    ds_read_b128 v[240:243], v40 offset:768
    ds_read_b128 v[244:247], v41 offset:768
    ds_read_b128 v[248:251], v42 offset:768
    ds_read_b128 v[252:255], v43 offset:768
    s_waitcnt lgkmcnt(0)
    s_barrier
    ds_read_b128 v[96:99], v8 offset:0
    ds_read_b128 v[100:103], v8 offset:16384
    ds_read_b128 v[104:107], v9 offset:0
    ds_read_b128 v[108:111], v9 offset:16384
    ds_read_b128 v[112:115], v10 offset:0
    ds_read_b128 v[116:119], v10 offset:16384
    ds_read_b128 v[120:123], v11 offset:0
    ds_read_b128 v[124:127], v11 offset:16384
    s_waitcnt lgkmcnt(7)
    v_mfma_f32_16x16x32_bf16 v[24:27], v[96:99], v[192:195], 0
    ds_read_b128 v[96:99], v8 offset:256
    s_waitcnt lgkmcnt(7)
    v_mfma_f32_16x16x32_bf16 v[28:31], v[100:103], v[192:195], 0
    ds_read_b128 v[100:103], v8 offset:16640
    s_waitcnt lgkmcnt(7)
    v_mfma_f32_16x16x32_bf16 v[24:27], v[104:107], v[196:199], v[24:27]
    ds_read_b128 v[104:107], v9 offset:256
    s_waitcnt lgkmcnt(7)
    v_mfma_f32_16x16x32_bf16 v[28:31], v[108:111], v[196:199], v[28:31]
    ds_read_b128 v[108:111], v9 offset:16640
    s_waitcnt lgkmcnt(7)
    v_mfma_f32_16x16x32_bf16 v[24:27], v[112:115], v[200:203], v[24:27]
    ds_read_b128 v[112:115], v10 offset:256
    s_waitcnt lgkmcnt(7)
    v_mfma_f32_16x16x32_bf16 v[28:31], v[116:119], v[200:203], v[28:31]
    ds_read_b128 v[116:119], v10 offset:16640
    s_waitcnt lgkmcnt(7)
    v_mfma_f32_16x16x32_bf16 v[24:27], v[120:123], v[204:207], v[24:27]
    ds_read_b128 v[120:123], v11 offset:256
    s_waitcnt lgkmcnt(7)
    v_mfma_f32_16x16x32_bf16 v[28:31], v[124:127], v[204:207], v[28:31]
    ds_read_b128 v[124:127], v11 offset:16640
    s_waitcnt lgkmcnt(7)
    v_mfma_f32_16x16x32_bf16 v[24:27], v[96:99], v[208:211], v[24:27]
    ds_read_b128 v[96:99], v8 offset:512
    s_waitcnt lgkmcnt(7)
    v_mfma_f32_16x16x32_bf16 v[28:31], v[100:103], v[208:211], v[28:31]
    ds_read_b128 v[100:103], v8 offset:16896
    s_waitcnt lgkmcnt(7)
    v_mfma_f32_16x16x32_bf16 v[24:27], v[104:107], v[212:215], v[24:27]
    ds_read_b128 v[104:107], v9 offset:512
    s_waitcnt lgkmcnt(7)
    v_mfma_f32_16x16x32_bf16 v[28:31], v[108:111], v[212:215], v[28:31]
    ds_read_b128 v[108:111], v9 offset:16896
    s_waitcnt lgkmcnt(7)
    v_mfma_f32_16x16x32_bf16 v[24:27], v[112:115], v[216:219], v[24:27]
    ds_read_b128 v[112:115], v10 offset:512
    s_waitcnt lgkmcnt(7)
    v_mfma_f32_16x16x32_bf16 v[28:31], v[116:119], v[216:219], v[28:31]
    ds_read_b128 v[116:119], v10 offset:16896
    s_waitcnt lgkmcnt(7)
    v_mfma_f32_16x16x32_bf16 v[24:27], v[120:123], v[220:223], v[24:27]
    ds_read_b128 v[120:123], v11 offset:512
    s_waitcnt lgkmcnt(7)
    v_mfma_f32_16x16x32_bf16 v[28:31], v[124:127], v[220:223], v[28:31]
    ds_read_b128 v[124:127], v11 offset:16896
    s_waitcnt lgkmcnt(7)
    v_mfma_f32_16x16x32_bf16 v[24:27], v[96:99], v[224:227], v[24:27]
    ds_read_b128 v[96:99], v8 offset:768
    s_waitcnt lgkmcnt(7)
    v_mfma_f32_16x16x32_bf16 v[28:31], v[100:103], v[224:227], v[28:31]
    ds_read_b128 v[100:103], v8 offset:17152
    s_waitcnt lgkmcnt(7)
    v_mfma_f32_16x16x32_bf16 v[24:27], v[104:107], v[228:231], v[24:27]
    ds_read_b128 v[104:107], v9 offset:768
    s_waitcnt lgkmcnt(7)
    v_mfma_f32_16x16x32_bf16 v[28:31], v[108:111], v[228:231], v[28:31]
    ds_read_b128 v[108:111], v9 offset:17152
    s_waitcnt lgkmcnt(7)
    v_mfma_f32_16x16x32_bf16 v[24:27], v[112:115], v[232:235], v[24:27]
    ds_read_b128 v[112:115], v10 offset:768
    s_waitcnt lgkmcnt(7)
    v_mfma_f32_16x16x32_bf16 v[28:31], v[116:119], v[232:235], v[28:31]
    ds_read_b128 v[116:119], v10 offset:17152
    s_waitcnt lgkmcnt(7)
    v_mfma_f32_16x16x32_bf16 v[24:27], v[120:123], v[236:239], v[24:27]
    ds_read_b128 v[120:123], v11 offset:768
    s_waitcnt lgkmcnt(7)
    v_mfma_f32_16x16x32_bf16 v[28:31], v[124:127], v[236:239], v[28:31]
    ds_read_b128 v[124:127], v11 offset:17152
    s_waitcnt lgkmcnt(7)
    v_mfma_f32_16x16x32_bf16 v[24:27], v[96:99], v[240:243], v[24:27]
    s_waitcnt lgkmcnt(6)
    v_mfma_f32_16x16x32_bf16 v[28:31], v[100:103], v[240:243], v[28:31]
    s_waitcnt lgkmcnt(5)
    v_mfma_f32_16x16x32_bf16 v[24:27], v[104:107], v[244:247], v[24:27]
    s_waitcnt lgkmcnt(4)
    v_mfma_f32_16x16x32_bf16 v[28:31], v[108:111], v[244:247], v[28:31]
    s_waitcnt lgkmcnt(3)
    v_mfma_f32_16x16x32_bf16 v[24:27], v[112:115], v[248:251], v[24:27]
    s_waitcnt lgkmcnt(2)
    v_mfma_f32_16x16x32_bf16 v[28:31], v[116:119], v[248:251], v[28:31]
    s_waitcnt lgkmcnt(1)
    v_mfma_f32_16x16x32_bf16 v[24:27], v[120:123], v[252:255], v[24:27]
    s_waitcnt lgkmcnt(0)
    v_mfma_f32_16x16x32_bf16 v[28:31], v[124:127], v[252:255], v[28:31]
    s_nop 7
    s_nop 1
    v_max3_f32 v40, v24, v25, v26
    v_max3_f32 v40, v40, v27, v28
    v_max3_f32 v40, v40, v29, v30
    v_max_f32 v40, v40, v31
    v_mov_b32 v41, v40
    s_nop 1
    v_permlane32_swap_b32 v40, v41
    s_nop 1
    v_max_f32 v40, v40, v41
    v_mov_b32 v41, v40
    s_nop 1
    v_permlane16_swap_b32 v40, v41
    s_nop 1
    v_max_f32 v40, v40, v41
    ds_write_b32 v21, v40
    s_waitcnt lgkmcnt(0)
    s_barrier
    ds_read_b128 v[40:43], v22
    ds_read_b128 v[44:47], v23
    s_waitcnt lgkmcnt(1)
    v_max3_f32 v40, v40, v41, v42
    v_max3_f32 v20, v40, v43, v20
    v_sub_f32 v24, v24, v20
    v_sub_f32 v25, v25, v20
    v_sub_f32 v26, v26, v20
    v_sub_f32 v27, v27, v20
    v_sub_f32 v28, v28, v20
    v_sub_f32 v29, v29, v20
    v_sub_f32 v30, v30, v20
    v_sub_f32 v31, v31, v20
    v_exp_f32 v24, v24
    v_exp_f32 v25, v25
    v_exp_f32 v26, v26
    v_exp_f32 v27, v27
    v_exp_f32 v28, v28
    v_exp_f32 v29, v29
    v_exp_f32 v30, v30
    v_exp_f32 v31, v31
    s_waitcnt lgkmcnt(0)
    v_max3_f32 v44, v44, v45, v46
    v_max3_f32 v44, v44, v47, v18
    v_sub_f32 v32, v18, v44
    v_exp_f32 v32, v32
    v_mov_b32 v18, v44
    v_add_f32 v40, v24, v25
    v_add_f32 v40, v40, v26
    v_add_f32 v40, v40, v27
    v_add_f32 v40, v40, v28
    v_add_f32 v40, v40, v29
    v_add_f32 v40, v40, v30
    v_add_f32 v40, v40, v31
    v_cvt_pk_bf16_f32 v48, v24, v25
    v_cvt_pk_bf16_f32 v49, v26, v27
    v_cvt_pk_bf16_f32 v50, v28, v29
    v_cvt_pk_bf16_f32 v51, v30, v31
    ds_write_b64 v17, v[48:49] offset:0
    ds_write_b64 v17, v[50:51] offset:32
    v_mov_b32 v41, v40
    s_nop 1
    v_permlane32_swap_b32 v40, v41
    s_nop 1
    v_add_f32 v40, v40, v41
    v_mov_b32 v41, v40
    s_nop 1
    v_permlane16_swap_b32 v40, v41
    s_nop 1
    v_add_f32 v40, v40, v41
    ds_write_b32 v21, v40 offset:512
    s_waitcnt lgkmcnt(0)
    s_barrier
    ds_read_b128 v[40:43], v23 offset:512
    ds_read_b128 v[96:99], v16 offset:0
    ds_read_b64_tr_b16 v[100:101], v12 offset:0
    ds_read_b64_tr_b16 v[102:103], v14 offset:0
    ds_read_b64_tr_b16 v[104:105], v13 offset:0
    ds_read_b64_tr_b16 v[106:107], v15 offset:0
    ds_read_b128 v[108:111], v16 offset:32
    ds_read_b64_tr_b16 v[112:113], v12 offset:16384
    ds_read_b64_tr_b16 v[114:115], v14 offset:16384
    ds_read_b64_tr_b16 v[116:117], v13 offset:16384
    ds_read_b64_tr_b16 v[118:119], v15 offset:16384
    s_waitcnt lgkmcnt(5)
    v_mfma_f32_32x32x16_bf16 v[64:79], v[100:103], v[96:99], 0
    v_mfma_f32_32x32x16_bf16 v[80:95], v[104:107], v[96:99], 0
    ds_read_b128 v[96:99], v16 offset:64
    ds_read_b64_tr_b16 v[100:101], v12 offset:32768
    ds_read_b64_tr_b16 v[102:103], v14 offset:32768
    ds_read_b64_tr_b16 v[104:105], v13 offset:32768
    ds_read_b64_tr_b16 v[106:107], v15 offset:32768
    s_waitcnt lgkmcnt(5)
    v_mfma_f32_32x32x16_bf16 v[64:79], v[112:115], v[108:111], v[64:79]
    v_mfma_f32_32x32x16_bf16 v[80:95], v[116:119], v[108:111], v[80:95]
    ds_read_b128 v[108:111], v16 offset:96
    ds_read_b64_tr_b16 v[112:113], v12 offset:49152
    ds_read_b64_tr_b16 v[114:115], v14 offset:49152
    ds_read_b64_tr_b16 v[116:117], v13 offset:49152
    ds_read_b64_tr_b16 v[118:119], v15 offset:49152
    s_waitcnt lgkmcnt(5)
    v_mfma_f32_32x32x16_bf16 v[64:79], v[100:103], v[96:99], v[64:79]
    v_mfma_f32_32x32x16_bf16 v[80:95], v[104:107], v[96:99], v[80:95]
    v_add_u32 v12, 0x10000, v12
    v_add_u32 v13, 0x10000, v13
    v_add_u32 v14, 0x10000, v14
    v_add_u32 v15, 0x10000, v15
    ds_read_b128 v[96:99], v16 offset:128
    ds_read_b64_tr_b16 v[100:101], v12 offset:0
    ds_read_b64_tr_b16 v[102:103], v14 offset:0
    ds_read_b64_tr_b16 v[104:105], v13 offset:0
    ds_read_b64_tr_b16 v[106:107], v15 offset:0
    s_waitcnt lgkmcnt(5)
    v_mfma_f32_32x32x16_bf16 v[64:79], v[112:115], v[108:111], v[64:79]
    v_mfma_f32_32x32x16_bf16 v[80:95], v[116:119], v[108:111], v[80:95]
    ds_read_b128 v[108:111], v16 offset:160
    ds_read_b64_tr_b16 v[112:113], v12 offset:16384
    ds_read_b64_tr_b16 v[114:115], v14 offset:16384
    ds_read_b64_tr_b16 v[116:117], v13 offset:16384
    ds_read_b64_tr_b16 v[118:119], v15 offset:16384
    s_waitcnt lgkmcnt(5)
    v_mfma_f32_32x32x16_bf16 v[64:79], v[100:103], v[96:99], v[64:79]
    v_mfma_f32_32x32x16_bf16 v[80:95], v[104:107], v[96:99], v[80:95]
    ds_read_b128 v[96:99], v16 offset:192
    ds_read_b64_tr_b16 v[100:101], v12 offset:32768
    ds_read_b64_tr_b16 v[102:103], v14 offset:32768
    ds_read_b64_tr_b16 v[104:105], v13 offset:32768
    ds_read_b64_tr_b16 v[106:107], v15 offset:32768
    s_waitcnt lgkmcnt(5)
    v_mfma_f32_32x32x16_bf16 v[64:79], v[112:115], v[108:111], v[64:79]
    v_mfma_f32_32x32x16_bf16 v[80:95], v[116:119], v[108:111], v[80:95]
    ds_read_b128 v[108:111], v16 offset:224
    ds_read_b64_tr_b16 v[112:113], v12 offset:49152
    ds_read_b64_tr_b16 v[114:115], v14 offset:49152
    ds_read_b64_tr_b16 v[116:117], v13 offset:49152
    ds_read_b64_tr_b16 v[118:119], v15 offset:49152
    s_waitcnt lgkmcnt(5)
    v_mfma_f32_32x32x16_bf16 v[64:79], v[100:103], v[96:99], v[64:79]
    v_mfma_f32_32x32x16_bf16 v[80:95], v[104:107], v[96:99], v[80:95]
    s_waitcnt lgkmcnt(0)
    v_mfma_f32_32x32x16_bf16 v[64:79], v[112:115], v[108:111], v[64:79]
    v_mfma_f32_32x32x16_bf16 v[80:95], v[116:119], v[108:111], v[80:95]
    v_subrev_u32 v12, 0x10000, v12
    v_subrev_u32 v13, 0x10000, v13
    v_subrev_u32 v14, 0x10000, v14
    v_subrev_u32 v15, 0x10000, v15
    v_add_f32 v40, v40, v41
    v_add_f32 v42, v42, v43
    v_add_f32 v40, v40, v42
    v_fma_f32 v19, v19, v32, v40
    s_barrier
    s_waitcnt vmcnt(0)
    s_lshl_b32 s61, s56, 14
    v_xor_b32 v40, 0, v5
    v_add_u32 v40, s61, v40
    ds_write_b128 v40, v[128:131] offset:0
    v_xor_b32 v41, 64, v5
    v_add_u32 v41, s61, v41
    ds_write_b128 v41, v[132:135] offset:1024
    v_xor_b32 v42, 128, v5
    v_add_u32 v42, s61, v42
    ds_write_b128 v42, v[136:139] offset:2048
    v_xor_b32 v43, 192, v5
    v_add_u32 v43, s61, v43
    ds_write_b128 v43, v[140:143] offset:3072
    v_xor_b32 v40, 0, v5
    v_add_u32 v40, s61, v40
    ds_write_b128 v40, v[144:147] offset:4096
    v_xor_b32 v41, 64, v5
    v_add_u32 v41, s61, v41
    ds_write_b128 v41, v[148:151] offset:5120
    v_xor_b32 v42, 128, v5
    v_add_u32 v42, s61, v42
    ds_write_b128 v42, v[152:155] offset:6144
    v_xor_b32 v43, 192, v5
    v_add_u32 v43, s61, v43
    ds_write_b128 v43, v[156:159] offset:7168
    v_xor_b32 v40, 32, v5
    v_add_u32 v40, s61, v40
    ds_write_b128 v40, v[160:163] offset:8192
    v_xor_b32 v41, 96, v5
    v_add_u32 v41, s61, v41
    ds_write_b128 v41, v[164:167] offset:9216
    v_xor_b32 v42, 160, v5
    v_add_u32 v42, s61, v42
    ds_write_b128 v42, v[168:171] offset:10240
    v_xor_b32 v43, 224, v5
    v_add_u32 v43, s61, v43
    ds_write_b128 v43, v[172:175] offset:11264
    v_xor_b32 v40, 32, v5
    v_add_u32 v40, s61, v40
    ds_write_b128 v40, v[176:179] offset:12288
    v_xor_b32 v41, 96, v5
    v_add_u32 v41, s61, v41
    ds_write_b128 v41, v[180:183] offset:13312
    v_xor_b32 v42, 160, v5
    v_add_u32 v42, s61, v42
    ds_write_b128 v42, v[184:187] offset:14336
    v_xor_b32 v43, 224, v5
    v_add_u32 v43, s61, v43
    ds_write_b128 v43, v[188:191] offset:15360
    s_waitcnt lgkmcnt(0)
    s_barrier
    ds_read_b128 v[96:99], v8 offset:0
    ds_read_b128 v[100:103], v8 offset:16384
    ds_read_b128 v[104:107], v9 offset:0
    ds_read_b128 v[108:111], v9 offset:16384
    ds_read_b128 v[112:115], v10 offset:0
    ds_read_b128 v[116:119], v10 offset:16384
    ds_read_b128 v[120:123], v11 offset:0
    ds_read_b128 v[124:127], v11 offset:16384
    s_waitcnt lgkmcnt(7)
    v_mfma_f32_16x16x32_bf16 v[24:27], v[96:99], v[192:195], 0
    ds_read_b128 v[96:99], v8 offset:256
    s_waitcnt lgkmcnt(7)
    v_mfma_f32_16x16x32_bf16 v[28:31], v[100:103], v[192:195], 0
    ds_read_b128 v[100:103], v8 offset:16640
    s_waitcnt lgkmcnt(7)
    v_mfma_f32_16x16x32_bf16 v[24:27], v[104:107], v[196:199], v[24:27]
    ds_read_b128 v[104:107], v9 offset:256
    s_waitcnt lgkmcnt(7)
    v_mfma_f32_16x16x32_bf16 v[28:31], v[108:111], v[196:199], v[28:31]
    ds_read_b128 v[108:111], v9 offset:16640
    s_waitcnt lgkmcnt(7)
    v_mfma_f32_16x16x32_bf16 v[24:27], v[112:115], v[200:203], v[24:27]
    ds_read_b128 v[112:115], v10 offset:256
    s_waitcnt lgkmcnt(7)
    v_mfma_f32_16x16x32_bf16 v[28:31], v[116:119], v[200:203], v[28:31]
    ds_read_b128 v[116:119], v10 offset:16640
    s_waitcnt lgkmcnt(7)
    v_mfma_f32_16x16x32_bf16 v[24:27], v[120:123], v[204:207], v[24:27]
    ds_read_b128 v[120:123], v11 offset:256
    s_waitcnt lgkmcnt(7)
    v_mfma_f32_16x16x32_bf16 v[28:31], v[124:127], v[204:207], v[28:31]
    ds_read_b128 v[124:127], v11 offset:16640
    s_waitcnt lgkmcnt(7)
    v_mfma_f32_16x16x32_bf16 v[24:27], v[96:99], v[208:211], v[24:27]
    ds_read_b128 v[96:99], v8 offset:512
    s_waitcnt lgkmcnt(7)
    v_mfma_f32_16x16x32_bf16 v[28:31], v[100:103], v[208:211], v[28:31]
    ds_read_b128 v[100:103], v8 offset:16896
    s_waitcnt lgkmcnt(7)
    v_mfma_f32_16x16x32_bf16 v[24:27], v[104:107], v[212:215], v[24:27]
    ds_read_b128 v[104:107], v9 offset:512
    s_waitcnt lgkmcnt(7)
    v_mfma_f32_16x16x32_bf16 v[28:31], v[108:111], v[212:215], v[28:31]
    ds_read_b128 v[108:111], v9 offset:16896
    s_waitcnt lgkmcnt(7)
    v_mfma_f32_16x16x32_bf16 v[24:27], v[112:115], v[216:219], v[24:27]
    ds_read_b128 v[112:115], v10 offset:512
    s_waitcnt lgkmcnt(7)
    v_mfma_f32_16x16x32_bf16 v[28:31], v[116:119], v[216:219], v[28:31]
    ds_read_b128 v[116:119], v10 offset:16896
    s_waitcnt lgkmcnt(7)
    v_mfma_f32_16x16x32_bf16 v[24:27], v[120:123], v[220:223], v[24:27]
    ds_read_b128 v[120:123], v11 offset:512
    s_waitcnt lgkmcnt(7)
    v_mfma_f32_16x16x32_bf16 v[28:31], v[124:127], v[220:223], v[28:31]
    ds_read_b128 v[124:127], v11 offset:16896
    s_waitcnt lgkmcnt(7)
    v_mfma_f32_16x16x32_bf16 v[24:27], v[96:99], v[224:227], v[24:27]
    ds_read_b128 v[96:99], v8 offset:768
    s_waitcnt lgkmcnt(7)
    v_mfma_f32_16x16x32_bf16 v[28:31], v[100:103], v[224:227], v[28:31]
    ds_read_b128 v[100:103], v8 offset:17152
    s_waitcnt lgkmcnt(7)
    v_mfma_f32_16x16x32_bf16 v[24:27], v[104:107], v[228:231], v[24:27]
    ds_read_b128 v[104:107], v9 offset:768
    s_waitcnt lgkmcnt(7)
    v_mfma_f32_16x16x32_bf16 v[28:31], v[108:111], v[228:231], v[28:31]
    ds_read_b128 v[108:111], v9 offset:17152
    s_waitcnt lgkmcnt(7)
    v_mfma_f32_16x16x32_bf16 v[24:27], v[112:115], v[232:235], v[24:27]
    ds_read_b128 v[112:115], v10 offset:768
    s_waitcnt lgkmcnt(7)
    v_mfma_f32_16x16x32_bf16 v[28:31], v[116:119], v[232:235], v[28:31]
    ds_read_b128 v[116:119], v10 offset:17152
    s_waitcnt lgkmcnt(7)
    v_mfma_f32_16x16x32_bf16 v[24:27], v[120:123], v[236:239], v[24:27]
    ds_read_b128 v[120:123], v11 offset:768
    s_waitcnt lgkmcnt(7)
    v_mfma_f32_16x16x32_bf16 v[28:31], v[124:127], v[236:239], v[28:31]
    ds_read_b128 v[124:127], v11 offset:17152
    s_waitcnt lgkmcnt(7)
    v_mfma_f32_16x16x32_bf16 v[24:27], v[96:99], v[240:243], v[24:27]
    s_waitcnt lgkmcnt(6)
    v_mfma_f32_16x16x32_bf16 v[28:31], v[100:103], v[240:243], v[28:31]
    s_waitcnt lgkmcnt(5)
    v_mfma_f32_16x16x32_bf16 v[24:27], v[104:107], v[244:247], v[24:27]
    s_waitcnt lgkmcnt(4)
    v_mfma_f32_16x16x32_bf16 v[28:31], v[108:111], v[244:247], v[28:31]
    s_waitcnt lgkmcnt(3)
    v_mfma_f32_16x16x32_bf16 v[24:27], v[112:115], v[248:251], v[24:27]
    s_waitcnt lgkmcnt(2)
    v_mfma_f32_16x16x32_bf16 v[28:31], v[116:119], v[248:251], v[28:31]
    s_waitcnt lgkmcnt(1)
    v_mfma_f32_16x16x32_bf16 v[24:27], v[120:123], v[252:255], v[24:27]
    s_waitcnt lgkmcnt(0)
    v_mfma_f32_16x16x32_bf16 v[28:31], v[124:127], v[252:255], v[28:31]
    s_nop 7
    s_nop 1
    v_max3_f32 v40, v24, v25, v26
    v_max3_f32 v40, v40, v27, v28
    v_max3_f32 v40, v40, v29, v30
    v_max_f32 v40, v40, v31
    v_mov_b32 v41, v40
    s_nop 1
    v_permlane32_swap_b32 v40, v41
    s_nop 1
    v_max_f32 v40, v40, v41
    v_mov_b32 v41, v40
    s_nop 1
    v_permlane16_swap_b32 v40, v41
    s_nop 1
    v_max_f32 v40, v40, v41
    ds_write_b32 v21, v40
    s_waitcnt lgkmcnt(0)
    s_barrier
    ds_read_b128 v[40:43], v22
    ds_read_b128 v[44:47], v23
    s_waitcnt lgkmcnt(1)
    v_max3_f32 v40, v40, v41, v42
    v_max3_f32 v20, v40, v43, v20
    v_sub_f32 v24, v24, v20
    v_sub_f32 v25, v25, v20
    v_sub_f32 v26, v26, v20
    v_sub_f32 v27, v27, v20
    v_sub_f32 v28, v28, v20
    v_sub_f32 v29, v29, v20
    v_sub_f32 v30, v30, v20
    v_sub_f32 v31, v31, v20
    v_exp_f32 v24, v24
    v_exp_f32 v25, v25
    v_exp_f32 v26, v26
    v_exp_f32 v27, v27
    v_exp_f32 v28, v28
    v_exp_f32 v29, v29
    v_exp_f32 v30, v30
    v_exp_f32 v31, v31
    s_waitcnt lgkmcnt(0)
    v_max3_f32 v44, v44, v45, v46
    v_max3_f32 v44, v44, v47, v18
    v_sub_f32 v32, v18, v44
    v_exp_f32 v32, v32
    v_mov_b32 v18, v44
    v_add_f32 v40, v24, v25
    v_add_f32 v40, v40, v26
    v_add_f32 v40, v40, v27
    v_add_f32 v40, v40, v28
    v_add_f32 v40, v40, v29
    v_add_f32 v40, v40, v30
    v_add_f32 v40, v40, v31
    v_cvt_pk_bf16_f32 v48, v24, v25
    v_cvt_pk_bf16_f32 v49, v26, v27
    v_cvt_pk_bf16_f32 v50, v28, v29
    v_cvt_pk_bf16_f32 v51, v30, v31
    ds_write_b64 v17, v[48:49] offset:0
    ds_write_b64 v17, v[50:51] offset:32
    v_mov_b32 v41, v40
    s_nop 1
    v_permlane32_swap_b32 v40, v41
    s_nop 1
    v_add_f32 v40, v40, v41
    v_mov_b32 v41, v40
    s_nop 1
    v_permlane16_swap_b32 v40, v41
    s_nop 1
    v_add_f32 v40, v40, v41
    ds_write_b32 v21, v40 offset:512
    s_waitcnt lgkmcnt(0)
    s_barrier
    ds_read_b128 v[40:43], v23 offset:512
    v_mul_f32 v64, v64, v32
    v_mul_f32 v65, v65, v32
    v_mul_f32 v66, v66, v32
    v_mul_f32 v67, v67, v32
    v_mul_f32 v68, v68, v32
    v_mul_f32 v69, v69, v32
    v_mul_f32 v70, v70, v32
    v_mul_f32 v71, v71, v32
    v_mul_f32 v72, v72, v32
    v_mul_f32 v73, v73, v32
    v_mul_f32 v74, v74, v32
    v_mul_f32 v75, v75, v32
    v_mul_f32 v76, v76, v32
    v_mul_f32 v77, v77, v32
    v_mul_f32 v78, v78, v32
    v_mul_f32 v79, v79, v32
    v_mul_f32 v80, v80, v32
    v_mul_f32 v81, v81, v32
    v_mul_f32 v82, v82, v32
    v_mul_f32 v83, v83, v32
    v_mul_f32 v84, v84, v32
    v_mul_f32 v85, v85, v32
    v_mul_f32 v86, v86, v32
    v_mul_f32 v87, v87, v32
    v_mul_f32 v88, v88, v32
    v_mul_f32 v89, v89, v32
    v_mul_f32 v90, v90, v32
    v_mul_f32 v91, v91, v32
    v_mul_f32 v92, v92, v32
    v_mul_f32 v93, v93, v32
    v_mul_f32 v94, v94, v32
    v_mul_f32 v95, v95, v32
    ds_read_b128 v[96:99], v16 offset:0
    ds_read_b64_tr_b16 v[100:101], v12 offset:0
    ds_read_b64_tr_b16 v[102:103], v14 offset:0
    ds_read_b64_tr_b16 v[104:105], v13 offset:0
    ds_read_b64_tr_b16 v[106:107], v15 offset:0
    ds_read_b128 v[108:111], v16 offset:32
    ds_read_b64_tr_b16 v[112:113], v12 offset:16384
    ds_read_b64_tr_b16 v[114:115], v14 offset:16384
    ds_read_b64_tr_b16 v[116:117], v13 offset:16384
    ds_read_b64_tr_b16 v[118:119], v15 offset:16384
    s_waitcnt lgkmcnt(5)
    v_mfma_f32_32x32x16_bf16 v[64:79], v[100:103], v[96:99], v[64:79]
    v_mfma_f32_32x32x16_bf16 v[80:95], v[104:107], v[96:99], v[80:95]
    ds_read_b128 v[96:99], v16 offset:64
    ds_read_b64_tr_b16 v[100:101], v12 offset:32768
    ds_read_b64_tr_b16 v[102:103], v14 offset:32768
    ds_read_b64_tr_b16 v[104:105], v13 offset:32768
    ds_read_b64_tr_b16 v[106:107], v15 offset:32768
    s_waitcnt lgkmcnt(5)
    v_mfma_f32_32x32x16_bf16 v[64:79], v[112:115], v[108:111], v[64:79]
    v_mfma_f32_32x32x16_bf16 v[80:95], v[116:119], v[108:111], v[80:95]
    ds_read_b128 v[108:111], v16 offset:96
    ds_read_b64_tr_b16 v[112:113], v12 offset:49152
    ds_read_b64_tr_b16 v[114:115], v14 offset:49152
    ds_read_b64_tr_b16 v[116:117], v13 offset:49152
    ds_read_b64_tr_b16 v[118:119], v15 offset:49152
    s_waitcnt lgkmcnt(5)
    v_mfma_f32_32x32x16_bf16 v[64:79], v[100:103], v[96:99], v[64:79]
    v_mfma_f32_32x32x16_bf16 v[80:95], v[104:107], v[96:99], v[80:95]
    v_add_u32 v12, 0x10000, v12
    v_add_u32 v13, 0x10000, v13
    v_add_u32 v14, 0x10000, v14
    v_add_u32 v15, 0x10000, v15
    ds_read_b128 v[96:99], v16 offset:128
    ds_read_b64_tr_b16 v[100:101], v12 offset:0
    ds_read_b64_tr_b16 v[102:103], v14 offset:0
    ds_read_b64_tr_b16 v[104:105], v13 offset:0
    ds_read_b64_tr_b16 v[106:107], v15 offset:0
    s_waitcnt lgkmcnt(5)
    v_mfma_f32_32x32x16_bf16 v[64:79], v[112:115], v[108:111], v[64:79]
    v_mfma_f32_32x32x16_bf16 v[80:95], v[116:119], v[108:111], v[80:95]
    ds_read_b128 v[108:111], v16 offset:160
    ds_read_b64_tr_b16 v[112:113], v12 offset:16384
    ds_read_b64_tr_b16 v[114:115], v14 offset:16384
    ds_read_b64_tr_b16 v[116:117], v13 offset:16384
    ds_read_b64_tr_b16 v[118:119], v15 offset:16384
    s_waitcnt lgkmcnt(5)
    v_mfma_f32_32x32x16_bf16 v[64:79], v[100:103], v[96:99], v[64:79]
    v_mfma_f32_32x32x16_bf16 v[80:95], v[104:107], v[96:99], v[80:95]
    ds_read_b128 v[96:99], v16 offset:192
    ds_read_b64_tr_b16 v[100:101], v12 offset:32768
    ds_read_b64_tr_b16 v[102:103], v14 offset:32768
    ds_read_b64_tr_b16 v[104:105], v13 offset:32768
    ds_read_b64_tr_b16 v[106:107], v15 offset:32768
    s_waitcnt lgkmcnt(5)
    v_mfma_f32_32x32x16_bf16 v[64:79], v[112:115], v[108:111], v[64:79]
    v_mfma_f32_32x32x16_bf16 v[80:95], v[116:119], v[108:111], v[80:95]
    ds_read_b128 v[108:111], v16 offset:224
    ds_read_b64_tr_b16 v[112:113], v12 offset:49152
    ds_read_b64_tr_b16 v[114:115], v14 offset:49152
    ds_read_b64_tr_b16 v[116:117], v13 offset:49152
    ds_read_b64_tr_b16 v[118:119], v15 offset:49152
    s_waitcnt lgkmcnt(5)
    v_mfma_f32_32x32x16_bf16 v[64:79], v[100:103], v[96:99], v[64:79]
    v_mfma_f32_32x32x16_bf16 v[80:95], v[104:107], v[96:99], v[80:95]
    s_waitcnt lgkmcnt(0)
    v_mfma_f32_32x32x16_bf16 v[64:79], v[112:115], v[108:111], v[64:79]
    v_mfma_f32_32x32x16_bf16 v[80:95], v[116:119], v[108:111], v[80:95]
    v_subrev_u32 v12, 0x10000, v12
    v_subrev_u32 v13, 0x10000, v13
    v_subrev_u32 v14, 0x10000, v14
    v_subrev_u32 v15, 0x10000, v15
    v_add_f32 v40, v40, v41
    v_add_f32 v42, v42, v43
    v_add_f32 v40, v40, v42
    v_fma_f32 v19, v19, v32, v40
    s_barrier
    s_nop 7
    s_nop 3
    v_and_b32 v43, 31, v1
    v_lshrrev_b32 v44, 5, v1
    v_mul_u32_u24 v40, 1040, v43
    v_lshl_add_u32 v40, v44, 3, v40
    s_lshl_b32 s61, s56, 7
    v_add_u32 v40, s61, v40
    v_cvt_pk_bf16_f32 v64, v64, v65
    v_cvt_pk_bf16_f32 v65, v66, v67
    ds_write_b64 v40, v[64:65] offset:0
    v_cvt_pk_bf16_f32 v68, v68, v69
    v_cvt_pk_bf16_f32 v69, v70, v71
    ds_write_b64 v40, v[68:69] offset:16
    v_cvt_pk_bf16_f32 v72, v72, v73
    v_cvt_pk_bf16_f32 v73, v74, v75
    ds_write_b64 v40, v[72:73] offset:32
    v_cvt_pk_bf16_f32 v76, v76, v77
    v_cvt_pk_bf16_f32 v77, v78, v79
    ds_write_b64 v40, v[76:77] offset:48
    v_cvt_pk_bf16_f32 v80, v80, v81
    v_cvt_pk_bf16_f32 v81, v82, v83
    ds_write_b64 v40, v[80:81] offset:64
    v_cvt_pk_bf16_f32 v84, v84, v85
    v_cvt_pk_bf16_f32 v85, v86, v87
    ds_write_b64 v40, v[84:85] offset:80
    v_cvt_pk_bf16_f32 v88, v88, v89
    v_cvt_pk_bf16_f32 v89, v90, v91
    ds_write_b64 v40, v[88:89] offset:96
    v_cvt_pk_bf16_f32 v92, v92, v93
    v_cvt_pk_bf16_f32 v93, v94, v95
    ds_write_b64 v40, v[92:93] offset:112
    v_mov_b32 v46, v18
    v_mov_b32 v47, v19
    v_lshlrev_b32 v45, 8, v43
    s_lshl_b32 s62, s65, 3
    s_add_u32 s62, s62, 1245184
    s_cmp_lg_u32 s56, 0
    s_cbranch_scc1 Lml_49
    s_mov_b64 exec, 0xffffffff
    buffer_store_dwordx2 v[46:47], v45, s[32:35], s62 offen sc0 sc1
    s_mov_b64 exec, -1
Lml_49:
    s_waitcnt lgkmcnt(0)
    s_barrier
    s_mul_i32 s61, s56, 4160
    v_add_u32 v40, s61, v5
    ds_read_b128 v[96:99], v40 offset:0
    ds_read_b128 v[100:103], v40 offset:1040
    ds_read_b128 v[104:107], v40 offset:2080
    ds_read_b128 v[108:111], v40 offset:3120
    s_lshl_b32 s61, s65, 15
    s_lshl_b32 s62, s56, 12
    s_add_u32 s61, s61, s62
    s_add_u32 s61, s61, 2097152
    s_waitcnt lgkmcnt(3)
    buffer_store_dwordx4 v[96:99], v5, s[32:35], s61 offen offset:0 sc0 sc1
    s_waitcnt lgkmcnt(2)
    buffer_store_dwordx4 v[100:103], v5, s[32:35], s61 offen offset:1024 sc0 sc1
    s_waitcnt lgkmcnt(1)
    buffer_store_dwordx4 v[104:107], v5, s[32:35], s61 offen offset:2048 sc0 sc1
    s_waitcnt lgkmcnt(0)
    buffer_store_dwordx4 v[108:111], v5, s[32:35], s61 offen offset:3072 sc0 sc1
    s_waitcnt vmcnt(0)
    s_barrier
    s_cmp_lg_u32 s56, 0
    s_cbranch_scc1 Lpf_50
    v_lshlrev_b32 v40, 14, v1
    v_mov_b32 v41, 0
    s_lshl_b32 s61, s65, 2
    s_add_u32 s61, s61, 0
    s_mov_b64 exec, 0xffffffff
    buffer_store_dword v41, v40, s[32:35], s61 offen sc0 sc1
    s_mov_b64 exec, -1
Lpf_50:
    s_cmp_lg_u32 s56, 0
    s_cbranch_scc1 Lwog_51
    v_lshlrev_b32 v40, 13, v1
    s_lshl_b32 s61, s65, 8
    s_add_u32 s61, s61, 1507328
    s_mov_b32 s92, 0
    s_mov_b64 exec, 3
Lwogl_52:
    buffer_load_dword v41, v40, s[32:35], s61 offen sc0 sc1
    s_waitcnt vmcnt(0)
    v_cmp_gt_u32 vcc, 65656, v41
    s_cbranch_vccz Lwogd_53
    s_sleep 8
    s_add_u32 s92, s92, 1
    s_cmp_lt_u32 s92, 400000
    s_cbranch_scc1 Lwogl_52
Lwogd_53:
    s_mov_b64 exec, -1
Lwog_51:
    s_barrier
    s_mov_b32 s36, s24
    s_mov_b32 s37, s25
    s_and_b32 s37, s37, 0xffff
    s_mov_b32 s38, 4194304
    s_mov_b32 s39, 0x00020000
    s_lshl_b32 s61, s56, 14
    s_lshl_b32 s62, s65, 17
    s_add_u32 s62, s62, s61
    s_add_u32 m0, s61, 0
    v_xor_b32 v52, 0, v5
    buffer_load_dwordx4 v52, s[36:39], s62 offen nt lds
    s_add_u32 s62, s62, 1024
    s_add_u32 m0, s61, 1024
    v_xor_b32 v53, 64, v5
    buffer_load_dwordx4 v53, s[36:39], s62 offen nt lds
    s_add_u32 s62, s62, 1024
    s_add_u32 m0, s61, 2048
    v_xor_b32 v52, 128, v5
    buffer_load_dwordx4 v52, s[36:39], s62 offen nt lds
    s_add_u32 s62, s62, 1024
    s_add_u32 m0, s61, 3072
    v_xor_b32 v53, 192, v5
    buffer_load_dwordx4 v53, s[36:39], s62 offen nt lds
    s_add_u32 s62, s62, 1024
    s_add_u32 m0, s61, 4096
    v_xor_b32 v52, 0, v5
    buffer_load_dwordx4 v52, s[36:39], s62 offen nt lds
    s_add_u32 s62, s62, 1024
    s_add_u32 m0, s61, 5120
    v_xor_b32 v53, 64, v5
    buffer_load_dwordx4 v53, s[36:39], s62 offen nt lds
    s_add_u32 s62, s62, 1024
    s_add_u32 m0, s61, 6144
    v_xor_b32 v52, 128, v5
    buffer_load_dwordx4 v52, s[36:39], s62 offen nt lds
    s_add_u32 s62, s62, 1024
    s_add_u32 m0, s61, 7168
    v_xor_b32 v53, 192, v5
    buffer_load_dwordx4 v53, s[36:39], s62 offen nt lds
    s_add_u32 s62, s62, 1024
    s_add_u32 m0, s61, 8192
    v_xor_b32 v52, 32, v5
    buffer_load_dwordx4 v52, s[36:39], s62 offen nt lds
    s_add_u32 s62, s62, 1024
    s_add_u32 m0, s61, 9216
    v_xor_b32 v53, 96, v5
    buffer_load_dwordx4 v53, s[36:39], s62 offen nt lds
    s_add_u32 s62, s62, 1024
    s_add_u32 m0, s61, 10240
    v_xor_b32 v52, 160, v5
    buffer_load_dwordx4 v52, s[36:39], s62 offen nt lds
    s_add_u32 s62, s62, 1024
    s_add_u32 m0, s61, 11264
    v_xor_b32 v53, 224, v5
    buffer_load_dwordx4 v53, s[36:39], s62 offen nt lds
    s_add_u32 s62, s62, 1024
    s_add_u32 m0, s61, 12288
    v_xor_b32 v52, 32, v5
    buffer_load_dwordx4 v52, s[36:39], s62 offen nt lds
    s_add_u32 s62, s62, 1024
    s_add_u32 m0, s61, 13312
    v_xor_b32 v53, 96, v5
    buffer_load_dwordx4 v53, s[36:39], s62 offen nt lds
    s_add_u32 s62, s62, 1024
    s_add_u32 m0, s61, 14336
    v_xor_b32 v52, 160, v5
    buffer_load_dwordx4 v52, s[36:39], s62 offen nt lds
    s_add_u32 s62, s62, 1024
    s_add_u32 m0, s61, 15360
    v_xor_b32 v53, 224, v5
    buffer_load_dwordx4 v53, s[36:39], s62 offen nt lds
    s_waitcnt vmcnt(0)
    s_barrier
    v_lshrrev_b32 v40, 2, v3
    v_and_b32 v41, 1, v2
    v_lshlrev_b32 v42, 2, v40
    v_lshl_or_b32 v42, v41, 1, v42
    v_lshl_add_u32 v43, v2, 3, v40
    v_lshlrev_b32 v43, 10, v43
    v_and_b32 v44, 1, v3
    v_lshl_add_u32 v43, v44, 3, v43
    v_bfe_u32 v44, v3, 1, 1
    s_lshl_b32 s61, s56, 3
    s_add_u32 s62, s61, 0
    v_add_u32 v45, s62, v44
    v_xor_b32 v45, v45, v42
    v_lshl_add_u32 v48, v45, 4, v43
    s_add_u32 s62, s61, 2
    v_add_u32 v45, s62, v44
    v_xor_b32 v45, v45, v42
    v_lshl_add_u32 v49, v45, 4, v43
    s_add_u32 s62, s61, 4
    v_add_u32 v45, s62, v44
    v_xor_b32 v45, v45, v42
    v_lshl_add_u32 v50, v45, 4, v43
    s_add_u32 s62, s61, 6
    v_add_u32 v45, s62, v44
    v_xor_b32 v45, v45, v42
    v_lshl_add_u32 v51, v45, 4, v43
    ds_read_b64_tr_b16 v[128:129], v48 offset:0
    ds_read_b64_tr_b16 v[130:131], v48 offset:4096
    ds_read_b64_tr_b16 v[144:145], v49 offset:0
    ds_read_b64_tr_b16 v[146:147], v49 offset:4096
    ds_read_b64_tr_b16 v[160:161], v50 offset:0
    ds_read_b64_tr_b16 v[162:163], v50 offset:4096
    ds_read_b64_tr_b16 v[176:177], v51 offset:0
    ds_read_b64_tr_b16 v[178:179], v51 offset:4096
    s_waitcnt lgkmcnt(0)
    ds_read_b64_tr_b16 v[132:133], v48 offset:32768
    ds_read_b64_tr_b16 v[134:135], v48 offset:36864
    ds_read_b64_tr_b16 v[148:149], v49 offset:32768
    ds_read_b64_tr_b16 v[150:151], v49 offset:36864
    ds_read_b64_tr_b16 v[164:165], v50 offset:32768
    ds_read_b64_tr_b16 v[166:167], v50 offset:36864
    ds_read_b64_tr_b16 v[180:181], v51 offset:32768
    ds_read_b64_tr_b16 v[182:183], v51 offset:36864
    s_waitcnt lgkmcnt(0)
    v_add_u32 v48, 0x10000, v48
    v_add_u32 v49, 0x10000, v49
    v_add_u32 v50, 0x10000, v50
    v_add_u32 v51, 0x10000, v51
    ds_read_b64_tr_b16 v[136:137], v48 offset:0
    ds_read_b64_tr_b16 v[138:139], v48 offset:4096
    ds_read_b64_tr_b16 v[152:153], v49 offset:0
    ds_read_b64_tr_b16 v[154:155], v49 offset:4096
    ds_read_b64_tr_b16 v[168:169], v50 offset:0
    ds_read_b64_tr_b16 v[170:171], v50 offset:4096
    ds_read_b64_tr_b16 v[184:185], v51 offset:0
    ds_read_b64_tr_b16 v[186:187], v51 offset:4096
    s_waitcnt lgkmcnt(0)
    ds_read_b64_tr_b16 v[140:141], v48 offset:32768
    ds_read_b64_tr_b16 v[142:143], v48 offset:36864
    ds_read_b64_tr_b16 v[156:157], v49 offset:32768
    ds_read_b64_tr_b16 v[158:159], v49 offset:36864
    ds_read_b64_tr_b16 v[172:173], v50 offset:32768
    ds_read_b64_tr_b16 v[174:175], v50 offset:36864
    ds_read_b64_tr_b16 v[188:189], v51 offset:32768
    ds_read_b64_tr_b16 v[190:191], v51 offset:36864
    s_waitcnt lgkmcnt(0)
    v_lshrrev_b32 v40, 5, v1
    v_mul_u32_u24 v41, 1536, v40
    v_and_b32 v42, 31, v1
    v_lshl_add_u32 v41, v42, 4, v41
    v_mul_u32_u24 v43, 48, v40
    s_mov_b32 s61, 131072
    v_lshlrev_b32 v46, 3, v1
    v_add_u32 v46, s61, v46
    v_and_b32 v47, 1, v3
    v_lshlrev_b32 v47, 8, v47
    v_lshl_add_u32 v47, v2, 4, v47
    v_add_u32 v47, s61, v47
    s_mov_b32 s70, 1040356334
    s_cmp_lg_u32 s56, 0
    s_cbranch_scc1 Lhb1_54
    s_mov_b32 s92, 0
    buffer_load_dwordx4 v[192:195], v41, s[32:35], s93 offen offset:256 sc0 sc1
    buffer_load_dwordx2 v[204:205], v43, s[32:35], s93 offen offset:128 sc0 sc1
    buffer_load_dwordx4 v[196:199], v41, s[32:35], s93 offen offset:768 sc0 sc1
    buffer_load_dwordx2 v[206:207], v43, s[32:35], s93 offen offset:144 sc0 sc1
    buffer_load_dwordx4 v[200:203], v41, s[32:35], s93 offen offset:1280 sc0 sc1
    buffer_load_dwordx2 v[208:209], v43, s[32:35], s93 offen offset:160 sc0 sc1
Lp2_55:
    buffer_load_dwordx4 v[212:215], v41, s[32:35], s93 offen offset:256 sc0 sc1
    buffer_load_dwordx2 v[224:225], v43, s[32:35], s93 offen offset:128 sc0 sc1
    buffer_load_dwordx4 v[216:219], v41, s[32:35], s93 offen offset:768 sc0 sc1
    buffer_load_dwordx2 v[226:227], v43, s[32:35], s93 offen offset:144 sc0 sc1
    buffer_load_dwordx4 v[220:223], v41, s[32:35], s93 offen offset:1280 sc0 sc1
    buffer_load_dwordx2 v[228:229], v43, s[32:35], s93 offen offset:160 sc0 sc1
    s_waitcnt vmcnt(6)
    v_mov_b32 v45, v192
    v_max3_u32 v45, v45, v193, v194
    v_max3_u32 v45, v45, v195, v196
    v_max3_u32 v45, v45, v197, v198
    v_max3_u32 v45, v45, v199, v200
    v_max3_u32 v45, v45, v201, v202
    v_max3_u32 v45, v45, v203, v204
    v_max3_u32 v45, v45, v205, v206
    v_max3_u32 v45, v45, v207, v208
    v_max_u32 v45, v45, v209
    v_cmp_eq_u32 vcc, -1, v45
    s_cbranch_vccz Lp2A_56
    buffer_load_dwordx4 v[192:195], v41, s[32:35], s93 offen offset:256 sc0 sc1
    buffer_load_dwordx2 v[204:205], v43, s[32:35], s93 offen offset:128 sc0 sc1
    buffer_load_dwordx4 v[196:199], v41, s[32:35], s93 offen offset:768 sc0 sc1
    buffer_load_dwordx2 v[206:207], v43, s[32:35], s93 offen offset:144 sc0 sc1
    buffer_load_dwordx4 v[200:203], v41, s[32:35], s93 offen offset:1280 sc0 sc1
    buffer_load_dwordx2 v[208:209], v43, s[32:35], s93 offen offset:160 sc0 sc1
    s_waitcnt vmcnt(6)
    v_mov_b32 v45, v212
    v_max3_u32 v45, v45, v213, v214
    v_max3_u32 v45, v45, v215, v216
    v_max3_u32 v45, v45, v217, v218
    v_max3_u32 v45, v45, v219, v220
    v_max3_u32 v45, v45, v221, v222
    v_max3_u32 v45, v45, v223, v224
    v_max3_u32 v45, v45, v225, v226
    v_max3_u32 v45, v45, v227, v228
    v_max_u32 v45, v45, v229
    v_cmp_eq_u32 vcc, -1, v45
    s_cbranch_vccz Lp2B_57
    s_add_u32 s92, s92, 1
    s_cmp_lt_u32 s92, 400000
    s_cbranch_scc1 Lp2_55
Lp2B_57:
    s_waitcnt vmcnt(0)
    v_mov_b32 v192, v212
    v_mov_b32 v193, v213
    v_mov_b32 v194, v214
    v_mov_b32 v195, v215
    v_mov_b32 v196, v216
    v_mov_b32 v197, v217
    v_mov_b32 v198, v218
    v_mov_b32 v199, v219
    v_mov_b32 v200, v220
    v_mov_b32 v201, v221
    v_mov_b32 v202, v222
    v_mov_b32 v203, v223
    v_mov_b32 v204, v224
    v_mov_b32 v205, v225
    v_mov_b32 v206, v226
    v_mov_b32 v207, v227
    v_mov_b32 v208, v228
    v_mov_b32 v209, v229
    s_branch Lp2D_58
Lp2A_56:
Lp2D_58:
    v_max3_f32 v45, v204, v206, v208
    v_mul_f32 v44, s70, v45
    v_fma_f32 v204, v204, s70, -v44
    v_fma_f32 v206, v206, s70, -v44
    v_fma_f32 v208, v208, s70, -v44
    v_exp_f32 v204, v204
    v_exp_f32 v206, v206
    v_exp_f32 v208, v208
    s_nop 0
    v_mul_f32 v45, v204, v205
    v_fmac_f32 v45, v206, v207
    v_fmac_f32 v45, v208, v209
    v_rcp_f32 v45, v45
    v_mul_f32 v192, v192, v204
    v_mul_f32 v193, v193, v204
    v_mul_f32 v194, v194, v204
    v_mul_f32 v195, v195, v204
    v_fmac_f32 v192, v196, v206
    v_fmac_f32 v193, v197, v206
    v_fmac_f32 v194, v198, v206
    v_fmac_f32 v195, v199, v206
    v_fmac_f32 v192, v200, v208
    v_fmac_f32 v193, v201, v208
    v_fmac_f32 v194, v202, v208
    v_fmac_f32 v195, v203, v208
    v_mul_f32 v192, v192, v45
    v_mul_f32 v193, v193, v45
    v_mul_f32 v194, v194, v45
    v_mul_f32 v195, v195, v45
    v_cvt_pk_bf16_f32 v192, v192, v193
    v_cvt_pk_bf16_f32 v193, v194, v195
    ds_write_b64 v46, v[192:193]
    s_waitcnt lgkmcnt(0)
Lhb1_54:
    s_barrier
    ds_read_b128 v[24:27], v47 offset:0
    ds_read_b128 v[28:31], v47 offset:64
    ds_read_b128 v[32:35], v47 offset:128
    ds_read_b128 v[36:39], v47 offset:192
    s_waitcnt lgkmcnt(3)
    v_mfma_f32_16x16x32_bf16 v[8:11], v[24:27], v[128:131], 0
    v_mfma_f32_16x16x32_bf16 v[12:15], v[24:27], v[144:147], 0
    v_mfma_f32_16x16x32_bf16 v[16:19], v[24:27], v[160:163], 0
    v_mfma_f32_16x16x32_bf16 v[20:23], v[24:27], v[176:179], 0
    s_waitcnt lgkmcnt(2)
    v_mfma_f32_16x16x32_bf16 v[8:11], v[28:31], v[132:135], v[8:11]
    v_mfma_f32_16x16x32_bf16 v[12:15], v[28:31], v[148:151], v[12:15]
    v_mfma_f32_16x16x32_bf16 v[16:19], v[28:31], v[164:167], v[16:19]
    v_mfma_f32_16x16x32_bf16 v[20:23], v[28:31], v[180:183], v[20:23]
    s_waitcnt lgkmcnt(1)
    v_mfma_f32_16x16x32_bf16 v[8:11], v[32:35], v[136:139], v[8:11]
    v_mfma_f32_16x16x32_bf16 v[12:15], v[32:35], v[152:155], v[12:15]
    v_mfma_f32_16x16x32_bf16 v[16:19], v[32:35], v[168:171], v[16:19]
    v_mfma_f32_16x16x32_bf16 v[20:23], v[32:35], v[184:187], v[20:23]
    s_waitcnt lgkmcnt(0)
    v_mfma_f32_16x16x32_bf16 v[8:11], v[36:39], v[140:143], v[8:11]
    v_mfma_f32_16x16x32_bf16 v[12:15], v[36:39], v[156:159], v[12:15]
    v_mfma_f32_16x16x32_bf16 v[16:19], v[36:39], v[172:175], v[16:19]
    v_mfma_f32_16x16x32_bf16 v[20:23], v[36:39], v[188:191], v[20:23]
    v_lshlrev_b32 v40, 2, v3
    s_lshl_b32 s61, s56, 16
    s_lshl_b32 s62, s65, 6
    s_add_u32 s61, s61, s62
    s_add_u32 s61, s61, 3328
    s_nop 4
    s_mov_b64 exec, 0xffff
    s_add_u32 s62, s61, 0
    buffer_store_dword v8, v40, s[32:35], s62 offen sc0 sc1
    s_add_u32 s62, s61, 524288
    buffer_store_dword v9, v40, s[32:35], s62 offen sc0 sc1
    s_add_u32 s62, s61, 16384
    buffer_store_dword v12, v40, s[32:35], s62 offen sc0 sc1
    s_add_u32 s62, s61, 540672
    buffer_store_dword v13, v40, s[32:35], s62 offen sc0 sc1
    s_add_u32 s62, s61, 32768
    buffer_store_dword v16, v40, s[32:35], s62 offen sc0 sc1
    s_add_u32 s62, s61, 557056
    buffer_store_dword v17, v40, s[32:35], s62 offen sc0 sc1
    s_add_u32 s62, s61, 49152
    buffer_store_dword v20, v40, s[32:35], s62 offen sc0 sc1
    s_add_u32 s62, s61, 573440
    buffer_store_dword v21, v40, s[32:35], s62 offen sc0 sc1
    s_mov_b64 exec, -1
    s_branch L_final
L_roleT1:
    s_mov_b32 s65, s75
    s_waitcnt vmcnt(0)
    s_barrier
    s_cmp_lg_u32 s56, 1
    s_cbranch_scc1 Lsc_59
    v_mov_b32 v40, 1
    v_mov_b32 v41, 0
    s_mov_b64 s[94:95], exec
    s_mov_b64 exec, 1
    buffer_atomic_add v40, v41, s[52:55], 0 offen offset:128 sc1
    s_mov_b64 exec, s[94:95]
Lsc_59:
    s_waitcnt vmcnt(0)
    v_perm_b32 v232, v196, v192, s68
    v_perm_b32 v233, v196, v192, s69
    v_perm_b32 v234, v197, v193, s68
    v_perm_b32 v235, v197, v193, s69
    v_perm_b32 v236, v198, v194, s68
    v_perm_b32 v237, v198, v194, s69
    v_perm_b32 v238, v199, v195, s68
    v_perm_b32 v239, v199, v195, s69
    v_dot2_f32_bf16 v212, v232, v208, 0
    v_dot2_f32_bf16 v213, v233, v208, 0
    v_dot2_f32_bf16 v214, v234, v208, 0
    v_dot2_f32_bf16 v215, v235, v208, 0
    v_dot2_f32_bf16 v216, v236, v208, 0
    v_dot2_f32_bf16 v217, v237, v208, 0
    v_dot2_f32_bf16 v218, v238, v208, 0
    v_dot2_f32_bf16 v219, v239, v208, 0
    v_dot2_f32_bf16 v220, v232, v210, 0
    v_dot2_f32_bf16 v221, v233, v210, 0
    v_dot2_f32_bf16 v222, v234, v210, 0
    v_dot2_f32_bf16 v223, v235, v210, 0
    v_dot2_f32_bf16 v224, v236, v210, 0
    v_dot2_f32_bf16 v225, v237, v210, 0
    v_dot2_f32_bf16 v226, v238, v210, 0
    v_dot2_f32_bf16 v227, v239, v210, 0
    v_perm_b32 v232, v204, v200, s68
    v_perm_b32 v233, v204, v200, s69
    v_perm_b32 v234, v205, v201, s68
    v_perm_b32 v235, v205, v201, s69
    v_perm_b32 v236, v206, v202, s68
    v_perm_b32 v237, v206, v202, s69
    v_perm_b32 v238, v207, v203, s68
    v_perm_b32 v239, v207, v203, s69
    v_dot2_f32_bf16 v212, v232, v209, v212
    v_dot2_f32_bf16 v213, v233, v209, v213
    v_dot2_f32_bf16 v214, v234, v209, v214
    v_dot2_f32_bf16 v215, v235, v209, v215
    v_dot2_f32_bf16 v216, v236, v209, v216
    v_dot2_f32_bf16 v217, v237, v209, v217
    v_dot2_f32_bf16 v218, v238, v209, v218
    v_dot2_f32_bf16 v219, v239, v209, v219
    v_dot2_f32_bf16 v220, v232, v211, v220
    v_dot2_f32_bf16 v221, v233, v211, v221
    v_dot2_f32_bf16 v222, v234, v211, v222
    v_dot2_f32_bf16 v223, v235, v211, v223
    v_dot2_f32_bf16 v224, v236, v211, v224
    v_dot2_f32_bf16 v225, v237, v211, v225
    v_dot2_f32_bf16 v226, v238, v211, v226
    v_dot2_f32_bf16 v227, v239, v211, v227
    s_nop 2
    v_permlane32_swap_b32 v212, v220
    v_permlane32_swap_b32 v213, v221
    v_permlane32_swap_b32 v214, v222
    v_permlane32_swap_b32 v215, v223
    v_permlane32_swap_b32 v216, v224
    v_permlane32_swap_b32 v217, v225
    v_permlane32_swap_b32 v218, v226
    v_permlane32_swap_b32 v219, v227
    s_nop 1
    v_add_f32 v212, v212, v220
    v_add_f32 v213, v213, v221
    v_add_f32 v214, v214, v222
    v_add_f32 v215, v215, v223
    v_add_f32 v216, v216, v224
    v_add_f32 v217, v217, v225
    v_add_f32 v218, v218, v226
    v_add_f32 v219, v219, v227
    s_nop 1
    v_permlane16_swap_b32 v212, v216
    v_permlane16_swap_b32 v213, v217
    v_permlane16_swap_b32 v214, v218
    v_permlane16_swap_b32 v215, v219
    s_nop 1
    v_add_f32 v212, v212, v216
    v_add_f32 v213, v213, v217
    v_add_f32 v214, v214, v218
    v_add_f32 v215, v215, v219
    s_nop 1
    v_add_f32_dpp v212, v212, v212 row_ror:8 row_mask:0xf bank_mask:0xf
    v_add_f32_dpp v213, v213, v213 row_ror:8 row_mask:0xf bank_mask:0xf
    v_add_f32_dpp v214, v214, v214 row_ror:8 row_mask:0xf bank_mask:0xf
    v_add_f32_dpp v215, v215, v215 row_ror:8 row_mask:0xf bank_mask:0xf
    v_lshrrev_b32 v232, 5, v228
    v_lshlrev_b32 v232, 8, v232
    v_bfe_u32 v233, v228, 4, 1
    v_lshl_add_u32 v232, v233, 4, v232
    v_lshl_add_u32 v232, v230, 5, v232
    s_lshl_b32 s61, s56, 9
    s_add_u32 s61, s61, 131072
    v_add_u32 v232, s61, v232
    ds_write_b128 v232, v[212:215]
    s_waitcnt lgkmcnt(0)
    s_barrier
    s_cmp_eq_u32 s56, 0
    s_cbranch_scc1 Ls1p0_61
    s_mov_b32 s44, s10
    s_mov_b32 s45, s11
    s_and_b32 s45, s45, 0xffff
    s_mov_b32 s46, 4194304
    s_mov_b32 s47, 0x00020000
    v_xor_b32 v52, v3, v2
    v_lshlrev_b32 v51, 13, v2
    v_xor_b32 v53, 4, v52
    v_xor_b32 v54, 8, v52
    v_xor_b32 v55, 12, v52
    v_lshl_add_u32 v52, v52, 4, v51
    v_lshl_add_u32 v53, v53, 4, v51
    v_lshl_add_u32 v54, v54, 4, v51
    v_lshl_add_u32 v55, v55, 4, v51
    s_lshl_b32 s61, s56, 19
    s_lshl_b32 s62, s65, 8
    s_add_u32 s62, s62, s61
    s_lshl_b32 s61, s56, 14
    s_add_u32 m0, s61, 0
    s_nop 0
    buffer_load_dwordx4 v52, s[44:47], s62 offen nt lds
    s_add_u32 m0, s61, 1024
    s_add_u32 s62, s62, 32768
    buffer_load_dwordx4 v52, s[44:47], s62 offen nt lds
    s_add_u32 m0, s61, 2048
    s_add_u32 s62, s62, 32768
    buffer_load_dwordx4 v52, s[44:47], s62 offen nt lds
    s_add_u32 m0, s61, 3072
    s_add_u32 s62, s62, 32768
    buffer_load_dwordx4 v52, s[44:47], s62 offen nt lds
    s_add_u32 m0, s61, 4096
    s_add_u32 s62, s62, 32768
    buffer_load_dwordx4 v53, s[44:47], s62 offen nt lds
    s_add_u32 m0, s61, 5120
    s_add_u32 s62, s62, 32768
    buffer_load_dwordx4 v53, s[44:47], s62 offen nt lds
    s_add_u32 m0, s61, 6144
    s_add_u32 s62, s62, 32768
    buffer_load_dwordx4 v53, s[44:47], s62 offen nt lds
    s_add_u32 m0, s61, 7168
    s_add_u32 s62, s62, 32768
    buffer_load_dwordx4 v53, s[44:47], s62 offen nt lds
    s_add_u32 m0, s61, 8192
    s_add_u32 s62, s62, 32768
    buffer_load_dwordx4 v54, s[44:47], s62 offen nt lds
    s_add_u32 m0, s61, 9216
    s_add_u32 s62, s62, 32768
    buffer_load_dwordx4 v54, s[44:47], s62 offen nt lds
    s_add_u32 m0, s61, 10240
    s_add_u32 s62, s62, 32768
    buffer_load_dwordx4 v54, s[44:47], s62 offen nt lds
    s_add_u32 m0, s61, 11264
    s_add_u32 s62, s62, 32768
    buffer_load_dwordx4 v54, s[44:47], s62 offen nt lds
    s_add_u32 m0, s61, 12288
    s_add_u32 s62, s62, 32768
    buffer_load_dwordx4 v55, s[44:47], s62 offen nt lds
    s_add_u32 m0, s61, 13312
    s_add_u32 s62, s62, 32768
    buffer_load_dwordx4 v55, s[44:47], s62 offen nt lds
    s_add_u32 m0, s61, 14336
    s_add_u32 s62, s62, 32768
    buffer_load_dwordx4 v55, s[44:47], s62 offen nt lds
    s_add_u32 m0, s61, 15360
    s_add_u32 s62, s62, 32768
    buffer_load_dwordx4 v55, s[44:47], s62 offen nt lds
    s_branch Ls1p_60
Ls1p0_61:
    v_mov_b32 v234, 0
    buffer_load_dword v235, v234, s[52:55], s91 offen offset:0 sc0 sc1
    v_and_b32 v232, 31, v228
    v_lshlrev_b32 v233, 4, v232
    v_add_u32 v233, 131072, v233
    ds_read_b128 v[192:195], v233 offset:0
    ds_read_b128 v[196:199], v233 offset:512
    ds_read_b128 v[200:203], v233 offset:1024
    ds_read_b128 v[204:207], v233 offset:1536
    ds_read_b128 v[208:211], v233 offset:2048
    ds_read_b128 v[212:215], v233 offset:2560
    ds_read_b128 v[216:219], v233 offset:3072
    ds_read_b128 v[220:223], v233 offset:3584
    s_waitcnt lgkmcnt(6)
    v_add_f32 v192, v192, v196
    v_add_f32 v193, v193, v197
    v_add_f32 v194, v194, v198
    v_add_f32 v195, v195, v199
    s_waitcnt lgkmcnt(5)
    v_add_f32 v192, v192, v200
    v_add_f32 v193, v193, v201
    v_add_f32 v194, v194, v202
    v_add_f32 v195, v195, v203
    s_waitcnt lgkmcnt(4)
    v_add_f32 v192, v192, v204
    v_add_f32 v193, v193, v205
    v_add_f32 v194, v194, v206
    v_add_f32 v195, v195, v207
    s_waitcnt lgkmcnt(3)
    v_add_f32 v192, v192, v208
    v_add_f32 v193, v193, v209
    v_add_f32 v194, v194, v210
    v_add_f32 v195, v195, v211
    s_waitcnt lgkmcnt(2)
    v_add_f32 v192, v192, v212
    v_add_f32 v193, v193, v213
    v_add_f32 v194, v194, v214
    v_add_f32 v195, v195, v215
    s_waitcnt lgkmcnt(1)
    v_add_f32 v192, v192, v216
    v_add_f32 v193, v193, v217
    v_add_f32 v194, v194, v218
    v_add_f32 v195, v195, v219
    s_waitcnt lgkmcnt(0)
    v_add_f32 v192, v192, v220
    v_add_f32 v193, v193, v221
    v_add_f32 v194, v194, v222
    v_add_f32 v195, v195, v223
    v_lshrrev_b32 v233, 4, v232
    v_lshlrev_b32 v233, 10, v233
    v_and_b32 v232, 15, v232
    v_lshl_add_u32 v233, v232, 4, v233
    s_waitcnt vmcnt(0)
    s_mov_b32 s92, 0
Lcf_62:
    v_readfirstlane_b32 s57, v235
    s_nop 3
    s_cmp_lg_u32 s57, 0
    s_cbranch_scc1 Lcfd_63
    s_sleep 2
    buffer_load_dword v235, v234, s[52:55], s91 offen offset:0 sc0 sc1
    s_waitcnt vmcnt(0)
    s_add_u32 s92, s92, 1
    s_cmp_lt_u32 s92, 400000
    s_cbranch_scc1 Lcf_62
Lcfd_63:
    s_mov_b64 exec, 0xffffffff
    buffer_store_dwordx4 v[192:195], v233, s[32:35], s3 offen sc0 sc1
    s_mov_b64 exec, -1
    s_mov_b32 s44, s10
    s_mov_b32 s45, s11
    s_and_b32 s45, s45, 0xffff
    s_mov_b32 s46, 4194304
    s_mov_b32 s47, 0x00020000
    v_xor_b32 v52, v3, v2
    v_lshlrev_b32 v51, 13, v2
    v_xor_b32 v53, 4, v52
    v_xor_b32 v54, 8, v52
    v_xor_b32 v55, 12, v52
    v_lshl_add_u32 v52, v52, 4, v51
    v_lshl_add_u32 v53, v53, 4, v51
    v_lshl_add_u32 v54, v54, 4, v51
    v_lshl_add_u32 v55, v55, 4, v51
    s_lshl_b32 s61, s56, 19
    s_lshl_b32 s62, s65, 8
    s_add_u32 s62, s62, s61
    s_lshl_b32 s61, s56, 14
    s_add_u32 m0, s61, 0
    s_nop 0
    buffer_load_dwordx4 v52, s[44:47], s62 offen nt lds
    s_add_u32 m0, s61, 1024
    s_add_u32 s62, s62, 32768
    buffer_load_dwordx4 v52, s[44:47], s62 offen nt lds
    s_add_u32 m0, s61, 2048
    s_add_u32 s62, s62, 32768
    buffer_load_dwordx4 v52, s[44:47], s62 offen nt lds
    s_add_u32 m0, s61, 3072
    s_add_u32 s62, s62, 32768
    buffer_load_dwordx4 v52, s[44:47], s62 offen nt lds
    s_add_u32 m0, s61, 4096
    s_add_u32 s62, s62, 32768
    buffer_load_dwordx4 v53, s[44:47], s62 offen nt lds
    s_add_u32 m0, s61, 5120
    s_add_u32 s62, s62, 32768
    buffer_load_dwordx4 v53, s[44:47], s62 offen nt lds
    s_add_u32 m0, s61, 6144
    s_add_u32 s62, s62, 32768
    buffer_load_dwordx4 v53, s[44:47], s62 offen nt lds
    s_add_u32 m0, s61, 7168
    s_add_u32 s62, s62, 32768
    buffer_load_dwordx4 v53, s[44:47], s62 offen nt lds
    s_add_u32 m0, s61, 8192
    s_add_u32 s62, s62, 32768
    buffer_load_dwordx4 v54, s[44:47], s62 offen nt lds
    s_add_u32 m0, s61, 9216
    s_add_u32 s62, s62, 32768
    buffer_load_dwordx4 v54, s[44:47], s62 offen nt lds
    s_add_u32 m0, s61, 10240
    s_add_u32 s62, s62, 32768
    buffer_load_dwordx4 v54, s[44:47], s62 offen nt lds
    s_add_u32 m0, s61, 11264
    s_add_u32 s62, s62, 32768
    buffer_load_dwordx4 v54, s[44:47], s62 offen nt lds
    s_add_u32 m0, s61, 12288
    s_add_u32 s62, s62, 32768
    buffer_load_dwordx4 v55, s[44:47], s62 offen nt lds
    s_add_u32 m0, s61, 13312
    s_add_u32 s62, s62, 32768
    buffer_load_dwordx4 v55, s[44:47], s62 offen nt lds
    s_add_u32 m0, s61, 14336
    s_add_u32 s62, s62, 32768
    buffer_load_dwordx4 v55, s[44:47], s62 offen nt lds
    s_add_u32 m0, s61, 15360
    s_add_u32 s62, s62, 32768
    buffer_load_dwordx4 v55, s[44:47], s62 offen nt lds
    v_mov_b32 v46, 0
    buffer_load_dword v47, v46, s[52:55], 0 offen offset:128 sc0 sc1
    v_lshlrev_b32 v40, 4, v1
    s_lshl_b32 s61, s65, 11
    s_add_u32 s61, s61, 1310720
    s_mov_b32 s92, 0
Lpoll_64:
    buffer_load_dwordx4 v[24:27], v40, s[32:35], s61 offen offset:0 sc0 sc1
    buffer_load_dwordx4 v[32:35], v40, s[32:35], s61 offen offset:1024 sc0 sc1
    s_waitcnt vmcnt(0)
    v_mov_b32 v41, v24
    v_max3_u32 v41, v41, v25, v26
    v_max3_u32 v41, v41, v27, v32
    v_max3_u32 v41, v41, v33, v34
    v_max_u32 v41, v41, v35
    v_cmpx_eq_u32 vcc, -1, v41
    s_cbranch_execz Lpolld_65
    s_sleep 4
    s_add_u32 s92, s92, 1
    s_cmp_lt_u32 s92, 400000
    s_cbranch_scc1 Lpoll_64
Lpolld_65:
    s_mov_b64 exec, -1
    v_mov_b32 v28, v24
    v_mov_b32 v29, v25
    v_mov_b32 v30, v26
    v_mov_b32 v31, v27
    v_mov_b32 v36, v32
    v_mov_b32 v37, v33
    v_mov_b32 v38, v34
    v_mov_b32 v39, v35
    s_nop 1
    v_permlane32_swap_b32 v24, v28
    v_permlane32_swap_b32 v25, v29
    v_permlane32_swap_b32 v26, v30
    v_permlane32_swap_b32 v27, v31
    v_permlane32_swap_b32 v32, v36
    v_permlane32_swap_b32 v33, v37
    v_permlane32_swap_b32 v34, v38
    v_permlane32_swap_b32 v35, v39
    s_nop 1
    v_add_f32 v24, v24, v28
    v_add_f32 v25, v25, v29
    v_add_f32 v26, v26, v30
    v_add_f32 v27, v27, v31
    v_cvt_pk_bf16_f32 v24, v24, v25
    v_cvt_pk_bf16_f32 v25, v26, v27
    v_add_f32 v32, v32, v36
    v_add_f32 v33, v33, v37
    v_add_f32 v34, v34, v38
    v_add_f32 v35, v35, v39
    v_cvt_pk_bf16_f32 v32, v32, v33
    v_cvt_pk_bf16_f32 v33, v34, v35
    v_readfirstlane_b32 s57, v47
    s_nop 3
    s_cmp_ge_u32 s57, 64
    s_cbranch_scc1 Lcfm_66
    v_mov_b32 v46, 0
    s_mov_b32 s92, 0
Lcf_67:
    buffer_load_dword v47, v46, s[52:55], 0 offen offset:128 sc0 sc1
    s_waitcnt vmcnt(0)
    v_readfirstlane_b32 s57, v47
    s_nop 3
    s_cmp_ge_u32 s57, 64
    s_cbranch_scc1 Lcfd_68
    s_sleep 16
    s_add_u32 s92, s92, 1
    s_cmp_lt_u32 s92, 400000
    s_cbranch_scc1 Lcf_67
Lcfd_68:
Lcfm_66:
    v_and_b32 v42, 31, v1
    v_lshlrev_b32 v42, 3, v42
    v_add_u32 v42, 135168, v42
    ds_write_b64 v42, v[24:25] offset:0
    ds_write_b64 v42, v[32:33] offset:256
    s_waitcnt lgkmcnt(0)
Ls1p_60:
    v_lshrrev_b32 v40, 2, v3
    v_lshlrev_b32 v40, 12, v40
    v_and_b32 v41, 3, v3
    v_lshl_add_u32 v40, v41, 8, v40
    s_lshl_b32 s61, s56, 14
    v_add_u32 v40, s61, v40
    v_xor_b32 v41, v3, v2
    v_xor_b32 v42, 0, v41
    v_lshl_add_u32 v56, v42, 4, v40
    v_xor_b32 v42, 4, v41
    v_lshl_add_u32 v57, v42, 4, v40
    v_xor_b32 v42, 8, v41
    v_lshl_add_u32 v58, v42, 4, v40
    v_xor_b32 v42, 12, v41
    v_lshl_add_u32 v59, v42, 4, v40
    v_and_b32 v43, 1, v3
    v_lshlrev_b32 v43, 8, v43
    v_lshl_add_u32 v43, v2, 4, v43
    v_add_u32 v43, 135168, v43
    v_lshlrev_b32 v44, 15, v3
    v_lshl_add_u32 v44, v2, 5, v44
    s_lshl_b32 s63, s65, 10
    s_lshl_b32 s64, s56, 7
    s_add_u32 s63, s63, s64
    s_add_u32 s63, s63, 1146880
    s_mov_b32 s70, 1040356334
    s_waitcnt vmcnt(0)
    ds_read_b128 v[128:131], v56 offset:0
    ds_read_b128 v[132:135], v57 offset:0
    ds_read_b128 v[136:139], v58 offset:0
    ds_read_b128 v[140:143], v59 offset:0
    ds_read_b128 v[144:147], v56 offset:1024
    ds_read_b128 v[148:151], v57 offset:1024
    ds_read_b128 v[152:155], v58 offset:1024
    ds_read_b128 v[156:159], v59 offset:1024
    ds_read_b128 v[160:163], v56 offset:2048
    ds_read_b128 v[164:167], v57 offset:2048
    ds_read_b128 v[168:171], v58 offset:2048
    ds_read_b128 v[172:175], v59 offset:2048
    ds_read_b128 v[176:179], v56 offset:3072
    ds_read_b128 v[180:183], v57 offset:3072
    ds_read_b128 v[184:187], v58 offset:3072
    ds_read_b128 v[188:191], v59 offset:3072
    s_barrier
    ds_read_b128 v[8:11], v43 offset:0
    ds_read_b128 v[12:15], v43 offset:64
    ds_read_b128 v[16:19], v43 offset:128
    ds_read_b128 v[20:23], v43 offset:192
    s_waitcnt lgkmcnt(0)
    v_mfma_f32_16x16x32_bf16 v[24:27], v[128:131], v[8:11], 0
    v_mfma_f32_16x16x32_bf16 v[28:31], v[144:147], v[8:11], 0
    v_mfma_f32_16x16x32_bf16 v[32:35], v[160:163], v[8:11], 0
    v_mfma_f32_16x16x32_bf16 v[36:39], v[176:179], v[8:11], 0
    v_mfma_f32_16x16x32_bf16 v[24:27], v[132:135], v[12:15], v[24:27]
    v_mfma_f32_16x16x32_bf16 v[28:31], v[148:151], v[12:15], v[28:31]
    v_mfma_f32_16x16x32_bf16 v[32:35], v[164:167], v[12:15], v[32:35]
    v_mfma_f32_16x16x32_bf16 v[36:39], v[180:183], v[12:15], v[36:39]
    v_mfma_f32_16x16x32_bf16 v[24:27], v[136:139], v[16:19], v[24:27]
    v_mfma_f32_16x16x32_bf16 v[28:31], v[152:155], v[16:19], v[28:31]
    v_mfma_f32_16x16x32_bf16 v[32:35], v[168:171], v[16:19], v[32:35]
    v_mfma_f32_16x16x32_bf16 v[36:39], v[184:187], v[16:19], v[36:39]
    v_mfma_f32_16x16x32_bf16 v[24:27], v[140:143], v[20:23], v[24:27]
    v_mfma_f32_16x16x32_bf16 v[28:31], v[156:159], v[20:23], v[28:31]
    v_mfma_f32_16x16x32_bf16 v[32:35], v[172:175], v[20:23], v[32:35]
    v_mfma_f32_16x16x32_bf16 v[36:39], v[188:191], v[20:23], v[36:39]
    s_nop 7
    v_mul_f32 v24, s70, v24
    v_mul_f32 v25, s70, v25
    v_mul_f32 v26, s70, v26
    v_mul_f32 v27, s70, v27
    v_mul_f32 v28, s70, v28
    v_mul_f32 v29, s70, v29
    v_mul_f32 v30, s70, v30
    v_mul_f32 v31, s70, v31
    v_mul_f32 v32, s70, v32
    v_mul_f32 v33, s70, v33
    v_mul_f32 v34, s70, v34
    v_mul_f32 v35, s70, v35
    v_mul_f32 v36, s70, v36
    v_mul_f32 v37, s70, v37
    v_mul_f32 v38, s70, v38
    v_mul_f32 v39, s70, v39
    v_cvt_pk_bf16_f32 v8, v24, v25
    v_cvt_pk_bf16_f32 v9, v26, v27
    v_cvt_pk_bf16_f32 v10, v28, v29
    v_cvt_pk_bf16_f32 v11, v30, v31
    v_cvt_pk_bf16_f32 v12, v32, v33
    v_cvt_pk_bf16_f32 v13, v34, v35
    v_cvt_pk_bf16_f32 v14, v36, v37
    v_cvt_pk_bf16_f32 v15, v38, v39
    s_mov_b32 exec_lo, 0x00030003
    s_mov_b32 exec_hi, 0x00030003
    buffer_store_dwordx4 v[8:11], v44, s[32:35], s63 offen sc0 sc1
    buffer_store_dwordx4 v[12:15], v44, s[32:35], s63 offen offset:16 sc0 sc1
    s_mov_b64 exec, -1
    s_barrier
    s_mov_b32 s44, s12
    s_mov_b32 s45, s13
    s_and_b32 s45, s45, 0xffff
    s_mov_b32 s46, 4194304
    s_mov_b32 s47, 0x00020000
    s_lshl_b32 s61, s56, 19
    s_lshl_b32 s62, s65, 8
    s_add_u32 s61, s61, s62
    buffer_load_dwordx4 v[64:67], v4, s[44:47], s61 offen nt
    s_add_u32 s61, s61, 8192
    buffer_load_dwordx4 v[68:71], v4, s[44:47], s61 offen nt
    s_add_u32 s61, s61, 8192
    buffer_load_dwordx4 v[72:75], v4, s[44:47], s61 offen nt
    s_add_u32 s61, s61, 8192
    buffer_load_dwordx4 v[76:79], v4, s[44:47], s61 offen nt
    s_add_u32 s61, s61, 8192
    buffer_load_dwordx4 v[80:83], v4, s[44:47], s61 offen nt
    s_add_u32 s61, s61, 8192
    buffer_load_dwordx4 v[84:87], v4, s[44:47], s61 offen nt
    s_add_u32 s61, s61, 8192
    buffer_load_dwordx4 v[88:91], v4, s[44:47], s61 offen nt
    s_add_u32 s61, s61, 8192
    buffer_load_dwordx4 v[92:95], v4, s[44:47], s61 offen nt
    s_add_u32 s61, s61, 8192
    buffer_load_dwordx4 v[96:99], v4, s[44:47], s61 offen nt
    s_add_u32 s61, s61, 8192
    buffer_load_dwordx4 v[100:103], v4, s[44:47], s61 offen nt
    s_add_u32 s61, s61, 8192
    buffer_load_dwordx4 v[104:107], v4, s[44:47], s61 offen nt
    s_add_u32 s61, s61, 8192
    buffer_load_dwordx4 v[108:111], v4, s[44:47], s61 offen nt
    s_add_u32 s61, s61, 8192
    buffer_load_dwordx4 v[112:115], v4, s[44:47], s61 offen nt
    s_add_u32 s61, s61, 8192
    buffer_load_dwordx4 v[116:119], v4, s[44:47], s61 offen nt
    s_add_u32 s61, s61, 8192
    buffer_load_dwordx4 v[120:123], v4, s[44:47], s61 offen nt
    s_add_u32 s61, s61, 8192
    buffer_load_dwordx4 v[124:127], v4, s[44:47], s61 offen nt
    s_mov_b32 s36, s14
    s_mov_b32 s37, s15
    s_and_b32 s37, s37, 0xffff
    s_mov_b32 s38, 4194304
    s_mov_b32 s39, 0x00020000
    s_lshl_b32 s61, s56, 14
    s_lshl_b32 s62, s65, 17
    s_add_u32 s62, s62, s61
    s_add_u32 m0, s61, 0
    v_xor_b32 v52, 0, v5
    buffer_load_dwordx4 v52, s[36:39], s62 offen nt lds
    s_add_u32 s62, s62, 1024
    s_add_u32 m0, s61, 1024
    v_xor_b32 v53, 64, v5
    buffer_load_dwordx4 v53, s[36:39], s62 offen nt lds
    s_add_u32 s62, s62, 1024
    s_add_u32 m0, s61, 2048
    v_xor_b32 v52, 128, v5
    buffer_load_dwordx4 v52, s[36:39], s62 offen nt lds
    s_add_u32 s62, s62, 1024
    s_add_u32 m0, s61, 3072
    v_xor_b32 v53, 192, v5
    buffer_load_dwordx4 v53, s[36:39], s62 offen nt lds
    s_add_u32 s62, s62, 1024
    s_add_u32 m0, s61, 4096
    v_xor_b32 v52, 0, v5
    buffer_load_dwordx4 v52, s[36:39], s62 offen nt lds
    s_add_u32 s62, s62, 1024
    s_add_u32 m0, s61, 5120
    v_xor_b32 v53, 64, v5
    buffer_load_dwordx4 v53, s[36:39], s62 offen nt lds
    s_add_u32 s62, s62, 1024
    s_add_u32 m0, s61, 6144
    v_xor_b32 v52, 128, v5
    buffer_load_dwordx4 v52, s[36:39], s62 offen nt lds
    s_add_u32 s62, s62, 1024
    s_add_u32 m0, s61, 7168
    v_xor_b32 v53, 192, v5
    buffer_load_dwordx4 v53, s[36:39], s62 offen nt lds
    s_add_u32 s62, s62, 1024
    s_add_u32 m0, s61, 8192
    v_xor_b32 v52, 32, v5
    buffer_load_dwordx4 v52, s[36:39], s62 offen nt lds
    s_add_u32 s62, s62, 1024
    s_add_u32 m0, s61, 9216
    v_xor_b32 v53, 96, v5
    buffer_load_dwordx4 v53, s[36:39], s62 offen nt lds
    s_add_u32 s62, s62, 1024
    s_add_u32 m0, s61, 10240
    v_xor_b32 v52, 160, v5
    buffer_load_dwordx4 v52, s[36:39], s62 offen nt lds
    s_add_u32 s62, s62, 1024
    s_add_u32 m0, s61, 11264
    v_xor_b32 v53, 224, v5
    buffer_load_dwordx4 v53, s[36:39], s62 offen nt lds
    s_add_u32 s62, s62, 1024
    s_add_u32 m0, s61, 12288
    v_xor_b32 v52, 32, v5
    buffer_load_dwordx4 v52, s[36:39], s62 offen nt lds
    s_add_u32 s62, s62, 1024
    s_add_u32 m0, s61, 13312
    v_xor_b32 v53, 96, v5
    buffer_load_dwordx4 v53, s[36:39], s62 offen nt lds
    s_add_u32 s62, s62, 1024
    s_add_u32 m0, s61, 14336
    v_xor_b32 v52, 160, v5
    buffer_load_dwordx4 v52, s[36:39], s62 offen nt lds
    s_add_u32 s62, s62, 1024
    s_add_u32 m0, s61, 15360
    v_xor_b32 v53, 224, v5
    buffer_load_dwordx4 v53, s[36:39], s62 offen nt lds
    s_waitcnt vmcnt(0)
    s_barrier
    v_lshrrev_b32 v40, 2, v3
    v_and_b32 v41, 1, v2
    v_lshlrev_b32 v42, 2, v40
    v_lshl_or_b32 v42, v41, 1, v42
    v_lshl_add_u32 v43, v2, 3, v40
    v_lshlrev_b32 v43, 10, v43
    v_and_b32 v44, 1, v3
    v_lshl_add_u32 v43, v44, 3, v43
    v_bfe_u32 v44, v3, 1, 1
    s_lshl_b32 s61, s56, 3
    s_add_u32 s62, s61, 0
    v_add_u32 v45, s62, v44
    v_xor_b32 v45, v45, v42
    v_lshl_add_u32 v48, v45, 4, v43
    s_add_u32 s62, s61, 2
    v_add_u32 v45, s62, v44
    v_xor_b32 v45, v45, v42
    v_lshl_add_u32 v49, v45, 4, v43
    s_add_u32 s62, s61, 4
    v_add_u32 v45, s62, v44
    v_xor_b32 v45, v45, v42
    v_lshl_add_u32 v50, v45, 4, v43
    s_add_u32 s62, s61, 6
    v_add_u32 v45, s62, v44
    v_xor_b32 v45, v45, v42
    v_lshl_add_u32 v51, v45, 4, v43
    ds_read_b64_tr_b16 v[128:129], v48 offset:0
    ds_read_b64_tr_b16 v[130:131], v48 offset:4096
    ds_read_b64_tr_b16 v[144:145], v49 offset:0
    ds_read_b64_tr_b16 v[146:147], v49 offset:4096
    ds_read_b64_tr_b16 v[160:161], v50 offset:0
    ds_read_b64_tr_b16 v[162:163], v50 offset:4096
    ds_read_b64_tr_b16 v[176:177], v51 offset:0
    ds_read_b64_tr_b16 v[178:179], v51 offset:4096
    s_waitcnt lgkmcnt(0)
    ds_read_b64_tr_b16 v[132:133], v48 offset:32768
    ds_read_b64_tr_b16 v[134:135], v48 offset:36864
    ds_read_b64_tr_b16 v[148:149], v49 offset:32768
    ds_read_b64_tr_b16 v[150:151], v49 offset:36864
    ds_read_b64_tr_b16 v[164:165], v50 offset:32768
    ds_read_b64_tr_b16 v[166:167], v50 offset:36864
    ds_read_b64_tr_b16 v[180:181], v51 offset:32768
    ds_read_b64_tr_b16 v[182:183], v51 offset:36864
    s_waitcnt lgkmcnt(0)
    v_add_u32 v48, 0x10000, v48
    v_add_u32 v49, 0x10000, v49
    v_add_u32 v50, 0x10000, v50
    v_add_u32 v51, 0x10000, v51
    ds_read_b64_tr_b16 v[136:137], v48 offset:0
    ds_read_b64_tr_b16 v[138:139], v48 offset:4096
    ds_read_b64_tr_b16 v[152:153], v49 offset:0
    ds_read_b64_tr_b16 v[154:155], v49 offset:4096
    ds_read_b64_tr_b16 v[168:169], v50 offset:0
    ds_read_b64_tr_b16 v[170:171], v50 offset:4096
    ds_read_b64_tr_b16 v[184:185], v51 offset:0
    ds_read_b64_tr_b16 v[186:187], v51 offset:4096
    s_waitcnt lgkmcnt(0)
    ds_read_b64_tr_b16 v[140:141], v48 offset:32768
    ds_read_b64_tr_b16 v[142:143], v48 offset:36864
    ds_read_b64_tr_b16 v[156:157], v49 offset:32768
    ds_read_b64_tr_b16 v[158:159], v49 offset:36864
    ds_read_b64_tr_b16 v[172:173], v50 offset:32768
    ds_read_b64_tr_b16 v[174:175], v50 offset:36864
    ds_read_b64_tr_b16 v[188:189], v51 offset:32768
    ds_read_b64_tr_b16 v[190:191], v51 offset:36864
    s_waitcnt lgkmcnt(0)
    v_perm_b32 v192, v68, v64, s68
    v_perm_b32 v193, v76, v72, s68
    v_perm_b32 v194, v84, v80, s68
    v_perm_b32 v195, v92, v88, s68
    v_perm_b32 v196, v68, v64, s69
    v_perm_b32 v197, v76, v72, s69
    v_perm_b32 v198, v84, v80, s69
    v_perm_b32 v199, v92, v88, s69
    v_perm_b32 v200, v69, v65, s68
    v_perm_b32 v201, v77, v73, s68
    v_perm_b32 v202, v85, v81, s68
    v_perm_b32 v203, v93, v89, s68
    v_perm_b32 v204, v69, v65, s69
    v_perm_b32 v205, v77, v73, s69
    v_perm_b32 v206, v85, v81, s69
    v_perm_b32 v207, v93, v89, s69
    v_perm_b32 v208, v70, v66, s68
    v_perm_b32 v209, v78, v74, s68
    v_perm_b32 v210, v86, v82, s68
    v_perm_b32 v211, v94, v90, s68
    v_perm_b32 v212, v70, v66, s69
    v_perm_b32 v213, v78, v74, s69
    v_perm_b32 v214, v86, v82, s69
    v_perm_b32 v215, v94, v90, s69
    v_perm_b32 v216, v71, v67, s68
    v_perm_b32 v217, v79, v75, s68
    v_perm_b32 v218, v87, v83, s68
    v_perm_b32 v219, v95, v91, s68
    v_perm_b32 v220, v71, v67, s69
    v_perm_b32 v221, v79, v75, s69
    v_perm_b32 v222, v87, v83, s69
    v_perm_b32 v223, v95, v91, s69
    v_perm_b32 v224, v100, v96, s68
    v_perm_b32 v225, v108, v104, s68
    v_perm_b32 v226, v116, v112, s68
    v_perm_b32 v227, v124, v120, s68
    v_perm_b32 v228, v100, v96, s69
    v_perm_b32 v229, v108, v104, s69
    v_perm_b32 v230, v116, v112, s69
    v_perm_b32 v231, v124, v120, s69
    v_perm_b32 v232, v101, v97, s68
    v_perm_b32 v233, v109, v105, s68
    v_perm_b32 v234, v117, v113, s68
    v_perm_b32 v235, v125, v121, s68
    v_perm_b32 v236, v101, v97, s69
    v_perm_b32 v237, v109, v105, s69
    v_perm_b32 v238, v117, v113, s69
    v_perm_b32 v239, v125, v121, s69
    v_perm_b32 v240, v102, v98, s68
    v_perm_b32 v241, v110, v106, s68
    v_perm_b32 v242, v118, v114, s68
    v_perm_b32 v243, v126, v122, s68
    v_perm_b32 v244, v102, v98, s69
    v_perm_b32 v245, v110, v106, s69
    v_perm_b32 v246, v118, v114, s69
    v_perm_b32 v247, v126, v122, s69
    v_perm_b32 v248, v103, v99, s68
    v_perm_b32 v249, v111, v107, s68
    v_perm_b32 v250, v119, v115, s68
    v_perm_b32 v251, v127, v123, s68
    v_perm_b32 v252, v103, v99, s69
    v_perm_b32 v253, v111, v107, s69
    v_perm_b32 v254, v119, v115, s69
    v_perm_b32 v255, v127, v123, s69
    s_barrier
    s_cmp_lg_u32 s56, 0
    s_cbranch_scc1 Lwf_69
    v_lshlrev_b32 v40, 2, v1
    s_mov_b64 exec, 0xffffffff
    s_mov_b32 s92, 0
Lpoll_70:
    buffer_load_dword v41, v40, s[32:35], s93 offen offset:0 sc0 sc1
    s_waitcnt vmcnt(0)
    v_mov_b32 v42, v41
    v_cmpx_eq_u32 vcc, -1, v42
    s_cbranch_execz Lpolld_71
    s_sleep 8
    s_add_u32 s92, s92, 1
    s_cmp_lt_u32 s92, 400000
    s_cbranch_scc1 Lpoll_70
Lpolld_71:
    s_mov_b64 exec, -1
Lwf_69:
    s_barrier
    s_lshr_b32 s66, s56, 2
    s_and_b32 s63, s56, 3
    s_lshl_b32 s61, s56, 17
    s_lshl_b32 s62, s65, 10
    s_add_u32 s61, s61, s62
    s_add_u32 s61, s61, 2097152
    v_lshlrev_b32 v40, 3, v3
    s_lshl_b32 s62, s65, 8
    s_lshl_b32 s64, s66, 7
    s_add_u32 s62, s62, s64
    s_add_u32 s62, s62, 1245184
    buffer_load_dwordx2 v[42:43], v40, s[32:35], s62 offen sc0 sc1
    buffer_load_dwordx4 v[64:67], v5, s[32:35], s61 offen sc0 sc1
    s_add_u32 s61, s61, 32768
    buffer_load_dwordx4 v[68:71], v5, s[32:35], s61 offen sc0 sc1
    s_add_u32 s61, s61, 32768
    buffer_load_dwordx4 v[72:75], v5, s[32:35], s61 offen sc0 sc1
    s_add_u32 s61, s61, 32768
    buffer_load_dwordx4 v[76:79], v5, s[32:35], s61 offen sc0 sc1
    s_waitcnt vmcnt(4)
    v_mov_b32 v44, v42
    s_nop 1
    v_max_f32_dpp v44, v44, v44 row_ror:8 row_mask:0xf bank_mask:0xf
    s_nop 1
    v_max_f32_dpp v44, v44, v44 row_ror:4 row_mask:0xf bank_mask:0xf
    s_nop 1
    v_max_f32_dpp v44, v44, v44 row_ror:2 row_mask:0xf bank_mask:0xf
    s_nop 1
    v_max_f32_dpp v44, v44, v44 row_ror:1 row_mask:0xf bank_mask:0xf
    v_sub_f32 v42, v42, v44
    v_exp_f32 v42, v42
    s_nop 0
    v_mul_f32 v43, v43, v42
    s_nop 1
    v_add_f32_dpp v43, v43, v43 row_ror:8 row_mask:0xf bank_mask:0xf
    s_nop 1
    v_add_f32_dpp v43, v43, v43 row_ror:4 row_mask:0xf bank_mask:0xf
    s_nop 1
    v_add_f32_dpp v43, v43, v43 row_ror:2 row_mask:0xf bank_mask:0xf
    s_nop 1
    v_add_f32_dpp v43, v43, v43 row_ror:1 row_mask:0xf bank_mask:0xf
    v_rcp_f32 v43, v43
    s_nop 0
    v_mul_f32 v42, v42, v43
    s_lshl_b32 s63, s63, 2
    s_nop 1
    s_add_u32 s64, s63, 0
    v_readlane_b32 s76, v42, s64
    s_add_u32 s64, s63, 1
    v_readlane_b32 s77, v42, s64
    s_add_u32 s64, s63, 2
    v_readlane_b32 s78, v42, s64
    s_add_u32 s64, s63, 3
    v_readlane_b32 s79, v42, s64
    s_nop 1
    s_waitcnt vmcnt(3)
    v_lshlrev_b32 v48, 16, v64
    v_and_b32 v49, 0xffff0000, v64
    v_lshlrev_b32 v50, 16, v65
    v_and_b32 v51, 0xffff0000, v65
    v_lshlrev_b32 v52, 16, v66
    v_and_b32 v53, 0xffff0000, v66
    v_lshlrev_b32 v54, 16, v67
    v_and_b32 v55, 0xffff0000, v67
    v_mul_f32 v24, s76, v48
    v_mul_f32 v25, s76, v49
    v_mul_f32 v26, s76, v50
    v_mul_f32 v27, s76, v51
    v_mul_f32 v28, s76, v52
    v_mul_f32 v29, s76, v53
    v_mul_f32 v30, s76, v54
    v_mul_f32 v31, s76, v55
    s_waitcnt vmcnt(2)
    v_lshlrev_b32 v48, 16, v68
    v_and_b32 v49, 0xffff0000, v68
    v_lshlrev_b32 v50, 16, v69
    v_and_b32 v51, 0xffff0000, v69
    v_lshlrev_b32 v52, 16, v70
    v_and_b32 v53, 0xffff0000, v70
    v_lshlrev_b32 v54, 16, v71
    v_and_b32 v55, 0xffff0000, v71
    v_fmac_f32 v24, s77, v48
    v_fmac_f32 v25, s77, v49
    v_fmac_f32 v26, s77, v50
    v_fmac_f32 v27, s77, v51
    v_fmac_f32 v28, s77, v52
    v_fmac_f32 v29, s77, v53
    v_fmac_f32 v30, s77, v54
    v_fmac_f32 v31, s77, v55
    s_waitcnt vmcnt(1)
    v_lshlrev_b32 v48, 16, v72
    v_and_b32 v49, 0xffff0000, v72
    v_lshlrev_b32 v50, 16, v73
    v_and_b32 v51, 0xffff0000, v73
    v_lshlrev_b32 v52, 16, v74
    v_and_b32 v53, 0xffff0000, v74
    v_lshlrev_b32 v54, 16, v75
    v_and_b32 v55, 0xffff0000, v75
    v_fmac_f32 v24, s78, v48
    v_fmac_f32 v25, s78, v49
    v_fmac_f32 v26, s78, v50
    v_fmac_f32 v27, s78, v51
    v_fmac_f32 v28, s78, v52
    v_fmac_f32 v29, s78, v53
    v_fmac_f32 v30, s78, v54
    v_fmac_f32 v31, s78, v55
    s_waitcnt vmcnt(0)
    v_lshlrev_b32 v48, 16, v76
    v_and_b32 v49, 0xffff0000, v76
    v_lshlrev_b32 v50, 16, v77
    v_and_b32 v51, 0xffff0000, v77
    v_lshlrev_b32 v52, 16, v78
    v_and_b32 v53, 0xffff0000, v78
    v_lshlrev_b32 v54, 16, v79
    v_and_b32 v55, 0xffff0000, v79
    v_fmac_f32 v24, s79, v48
    v_fmac_f32 v25, s79, v49
    v_fmac_f32 v26, s79, v50
    v_fmac_f32 v27, s79, v51
    v_fmac_f32 v28, s79, v52
    v_fmac_f32 v29, s79, v53
    v_fmac_f32 v30, s79, v54
    v_fmac_f32 v31, s79, v55
    s_lshl_b32 s61, s56, 11
    v_lshlrev_b32 v40, 5, v1
    v_add_u32 v40, s61, v40
    ds_write_b128 v40, v[24:27] offset:16384
    ds_write_b128 v40, v[28:31] offset:16400
    s_waitcnt lgkmcnt(0)
    s_barrier
    v_and_b32 v40, 255, v0
    v_lshlrev_b32 v40, 3, v40
    s_lshl_b32 s61, s66, 13
    v_add_u32 v40, s61, v40
    ds_read_b64 v[24:25], v40 offset:16384
    ds_read_b64 v[26:27], v40 offset:18432
    ds_read_b64 v[28:29], v40 offset:20480
    ds_read_b64 v[30:31], v40 offset:22528
    s_waitcnt lgkmcnt(0)
    v_add_f32 v24, v24, v26
    v_add_f32 v25, v25, v27
    v_add_f32 v24, v24, v28
    v_add_f32 v25, v25, v29
    v_add_f32 v24, v24, v30
    v_add_f32 v25, v25, v31
    v_cvt_pk_bf16_f32 v24, v24, v25
    v_lshlrev_b32 v40, 2, v0
    ds_write_b32 v40, v24 offset:32768
    s_waitcnt lgkmcnt(0)
    s_barrier
    s_lshl_b32 s61, s56, 7
    v_lshlrev_b32 v40, 5, v2
    v_and_b32 v41, 1, v3
    v_lshl_add_u32 v40, v41, 10, v40
    v_add_u32 v40, s61, v40
    ds_read_b128 v[8:11], v40 offset:32768
    ds_read_b128 v[12:15], v40 offset:32784
    s_waitcnt lgkmcnt(1)
    v_mfma_f32_16x16x32_bf16 v[96:99], v[8:11], v[192:195], 0
    v_mfma_f32_16x16x32_bf16 v[100:103], v[8:11], v[196:199], 0
    v_mfma_f32_16x16x32_bf16 v[104:107], v[8:11], v[200:203], 0
    v_mfma_f32_16x16x32_bf16 v[108:111], v[8:11], v[204:207], 0
    v_mfma_f32_16x16x32_bf16 v[112:115], v[8:11], v[208:211], 0
    v_mfma_f32_16x16x32_bf16 v[116:119], v[8:11], v[212:215], 0
    v_mfma_f32_16x16x32_bf16 v[120:123], v[8:11], v[216:219], 0
    v_mfma_f32_16x16x32_bf16 v[124:127], v[8:11], v[220:223], 0
    s_waitcnt lgkmcnt(0)
    v_mfma_f32_16x16x32_bf16 v[96:99], v[12:15], v[224:227], v[96:99]
    v_mfma_f32_16x16x32_bf16 v[100:103], v[12:15], v[228:231], v[100:103]
    v_mfma_f32_16x16x32_bf16 v[104:107], v[12:15], v[232:235], v[104:107]
    v_mfma_f32_16x16x32_bf16 v[108:111], v[12:15], v[236:239], v[108:111]
    v_mfma_f32_16x16x32_bf16 v[112:115], v[12:15], v[240:243], v[112:115]
    v_mfma_f32_16x16x32_bf16 v[116:119], v[12:15], v[244:247], v[116:119]
    v_mfma_f32_16x16x32_bf16 v[120:123], v[12:15], v[248:251], v[120:123]
    v_mfma_f32_16x16x32_bf16 v[124:127], v[12:15], v[252:255], v[124:127]
    v_lshlrev_b32 v40, 5, v3
    s_lshl_b32 s61, s56, 9
    v_add_u32 v40, s61, v40
    s_nop 7
    v_mov_b32 v24, v96
    v_mov_b32 v25, v100
    v_mov_b32 v26, v104
    v_mov_b32 v27, v108
    v_mov_b32 v28, v112
    v_mov_b32 v29, v116
    v_mov_b32 v30, v120
    v_mov_b32 v31, v124
    v_mov_b32 v32, v97
    v_mov_b32 v33, v101
    v_mov_b32 v34, v105
    v_mov_b32 v35, v109
    v_mov_b32 v36, v113
    v_mov_b32 v37, v117
    v_mov_b32 v38, v121
    v_mov_b32 v39, v125
    s_mov_b64 exec, 0xffff
    ds_write_b128 v40, v[24:27] offset:0
    ds_write_b128 v40, v[28:31] offset:16
    ds_write_b128 v40, v[32:35] offset:4096
    ds_write_b128 v40, v[36:39] offset:4112
    s_mov_b64 exec, -1
    s_waitcnt lgkmcnt(0)
    s_barrier
    v_lshrrev_b32 v40, 5, v1
    v_lshlrev_b32 v40, 12, v40
    v_and_b32 v41, 31, v1
    v_lshl_add_u32 v40, v41, 4, v40
    ds_read_b128 v[64:67], v40 offset:0
    ds_read_b128 v[68:71], v40 offset:512
    ds_read_b128 v[72:75], v40 offset:1024
    ds_read_b128 v[76:79], v40 offset:1536
    ds_read_b128 v[80:83], v40 offset:2048
    ds_read_b128 v[84:87], v40 offset:2560
    ds_read_b128 v[88:91], v40 offset:3072
    ds_read_b128 v[92:95], v40 offset:3584
    s_lshl_b32 s61, s56, 9
    s_add_u32 s61, s61, 131072
    v_lshlrev_b32 v46, 3, v1
    v_add_u32 v46, s61, v46
    v_and_b32 v47, 1, v3
    v_lshlrev_b32 v47, 8, v47
    v_lshl_add_u32 v47, v2, 4, v47
    v_add_u32 v47, s61, v47
    s_waitcnt lgkmcnt(6)
    v_add_f32 v64, v64, v68
    v_add_f32 v65, v65, v69
    v_add_f32 v66, v66, v70
    v_add_f32 v67, v67, v71
    s_waitcnt lgkmcnt(5)
    v_add_f32 v64, v64, v72
    v_add_f32 v65, v65, v73
    v_add_f32 v66, v66, v74
    v_add_f32 v67, v67, v75
    s_waitcnt lgkmcnt(4)
    v_add_f32 v64, v64, v76
    v_add_f32 v65, v65, v77
    v_add_f32 v66, v66, v78
    v_add_f32 v67, v67, v79
    s_waitcnt lgkmcnt(3)
    v_add_f32 v64, v64, v80
    v_add_f32 v65, v65, v81
    v_add_f32 v66, v66, v82
    v_add_f32 v67, v67, v83
    s_waitcnt lgkmcnt(2)
    v_add_f32 v64, v64, v84
    v_add_f32 v65, v65, v85
    v_add_f32 v66, v66, v86
    v_add_f32 v67, v67, v87
    s_waitcnt lgkmcnt(1)
    v_add_f32 v64, v64, v88
    v_add_f32 v65, v65, v89
    v_add_f32 v66, v66, v90
    v_add_f32 v67, v67, v91
    s_waitcnt lgkmcnt(0)
    v_add_f32 v64, v64, v92
    v_add_f32 v65, v65, v93
    v_add_f32 v66, v66, v94
    v_add_f32 v67, v67, v95
    v_cvt_pk_bf16_f32 v64, v64, v65
    v_cvt_pk_bf16_f32 v65, v66, v67
    ds_write_b64 v46, v[64:65]
    s_waitcnt lgkmcnt(0)
    ds_read_b128 v[24:27], v47 offset:0
    ds_read_b128 v[28:31], v47 offset:64
    ds_read_b128 v[32:35], v47 offset:128
    ds_read_b128 v[36:39], v47 offset:192
    s_waitcnt lgkmcnt(3)
    v_mfma_f32_16x16x32_bf16 v[8:11], v[24:27], v[128:131], 0
    v_mfma_f32_16x16x32_bf16 v[12:15], v[24:27], v[144:147], 0
    v_mfma_f32_16x16x32_bf16 v[16:19], v[24:27], v[160:163], 0
    v_mfma_f32_16x16x32_bf16 v[20:23], v[24:27], v[176:179], 0
    s_waitcnt lgkmcnt(2)
    v_mfma_f32_16x16x32_bf16 v[8:11], v[28:31], v[132:135], v[8:11]
    v_mfma_f32_16x16x32_bf16 v[12:15], v[28:31], v[148:151], v[12:15]
    v_mfma_f32_16x16x32_bf16 v[16:19], v[28:31], v[164:167], v[16:19]
    v_mfma_f32_16x16x32_bf16 v[20:23], v[28:31], v[180:183], v[20:23]
    s_waitcnt lgkmcnt(1)
    v_mfma_f32_16x16x32_bf16 v[8:11], v[32:35], v[136:139], v[8:11]
    v_mfma_f32_16x16x32_bf16 v[12:15], v[32:35], v[152:155], v[12:15]
    v_mfma_f32_16x16x32_bf16 v[16:19], v[32:35], v[168:171], v[16:19]
    v_mfma_f32_16x16x32_bf16 v[20:23], v[32:35], v[184:187], v[20:23]
    s_waitcnt lgkmcnt(0)
    v_mfma_f32_16x16x32_bf16 v[8:11], v[36:39], v[140:143], v[8:11]
    v_mfma_f32_16x16x32_bf16 v[12:15], v[36:39], v[156:159], v[12:15]
    v_mfma_f32_16x16x32_bf16 v[16:19], v[36:39], v[172:175], v[16:19]
    v_mfma_f32_16x16x32_bf16 v[20:23], v[36:39], v[188:191], v[20:23]
    v_lshlrev_b32 v40, 2, v3
    s_lshl_b32 s61, s56, 16
    s_lshl_b32 s62, s65, 6
    s_add_u32 s61, s61, s62
    s_add_u32 s61, s61, 5376
    s_nop 4
    s_mov_b64 exec, 0xffff
    s_add_u32 s62, s61, 0
    buffer_store_dword v8, v40, s[32:35], s62 offen sc0 sc1
    s_add_u32 s62, s61, 524288
    buffer_store_dword v9, v40, s[32:35], s62 offen sc0 sc1
    s_add_u32 s62, s61, 16384
    buffer_store_dword v12, v40, s[32:35], s62 offen sc0 sc1
    s_add_u32 s62, s61, 540672
    buffer_store_dword v13, v40, s[32:35], s62 offen sc0 sc1
    s_add_u32 s62, s61, 32768
    buffer_store_dword v16, v40, s[32:35], s62 offen sc0 sc1
    s_add_u32 s62, s61, 557056
    buffer_store_dword v17, v40, s[32:35], s62 offen sc0 sc1
    s_add_u32 s62, s61, 49152
    buffer_store_dword v20, v40, s[32:35], s62 offen sc0 sc1
    s_add_u32 s62, s61, 573440
    buffer_store_dword v21, v40, s[32:35], s62 offen sc0 sc1
    s_mov_b64 exec, -1
    s_branch L_final
L_final:
    s_cmp_ge_u32 s56, 2
    s_cbranch_scc1 L_end
    s_lshr_b32 s66, s75, 5
    s_and_b32 s64, s75, 31
    v_lshlrev_b32 v8, 5, v1
    s_lshl_b32 s61, s56, 11
    s_add_u32 s61, s61, 3328
    s_add_u32 s61, s61, s93
    s_mov_b32 s92, 0
    buffer_load_dwordx4 v[12:15], v8, s[32:35], s61 offen sc0 sc1
    buffer_load_dwordx4 v[16:19], v8, s[32:35], s61 offen offset:16 sc0 sc1
Lp2_74:
    buffer_load_dwordx4 v[24:27], v8, s[32:35], s61 offen sc0 sc1
    buffer_load_dwordx4 v[28:31], v8, s[32:35], s61 offen offset:16 sc0 sc1
    s_waitcnt vmcnt(2)
    v_mov_b32 v22, v12
    v_max3_u32 v22, v22, v13, v14
    v_max3_u32 v22, v22, v15, v16
    v_max3_u32 v22, v22, v17, v18
    v_max_u32 v22, v22, v19
    v_cmp_eq_u32 vcc, -1, v22
    s_cbranch_vccz Lp2A_75
    buffer_load_dwordx4 v[12:15], v8, s[32:35], s61 offen sc0 sc1
    buffer_load_dwordx4 v[16:19], v8, s[32:35], s61 offen offset:16 sc0 sc1
    s_waitcnt vmcnt(2)
    v_mov_b32 v22, v24
    v_max3_u32 v22, v22, v25, v26
    v_max3_u32 v22, v22, v27, v28
    v_max3_u32 v22, v22, v29, v30
    v_max_u32 v22, v22, v31
    v_cmp_eq_u32 vcc, -1, v22
    s_cbranch_vccz Lp2B_76
    s_add_u32 s92, s92, 1
    s_cmp_lt_u32 s92, 400000
    s_cbranch_scc1 Lp2_74
Lp2B_76:
    s_waitcnt vmcnt(0)
    v_mov_b32 v12, v24
    v_mov_b32 v13, v25
    v_mov_b32 v14, v26
    v_mov_b32 v15, v27
    v_mov_b32 v16, v28
    v_mov_b32 v17, v29
    v_mov_b32 v18, v30
    v_mov_b32 v19, v31
    s_branch Lp2D_77
Lp2A_75:
Lp2D_77:
Lfsk_72:
    s_nop 1
    v_permlane32_swap_b32 v12, v16
    v_permlane32_swap_b32 v13, v17
    v_permlane32_swap_b32 v14, v18
    v_permlane32_swap_b32 v15, v19
    s_nop 1
    v_add_f32 v12, v12, v16
    v_add_f32 v13, v13, v17
    v_add_f32 v14, v14, v18
    v_add_f32 v15, v15, v19
    s_nop 1
    v_permlane16_swap_b32 v12, v14
    v_permlane16_swap_b32 v13, v15
    s_nop 1
    v_add_f32 v12, v12, v14
    v_add_f32 v13, v13, v15
    s_nop 0
    v_add_f32_dpp v12, v12, v12 row_ror:8 row_mask:0xf bank_mask:0xf
    v_add_f32_dpp v13, v13, v13 row_ror:8 row_mask:0xf bank_mask:0xf
    s_nop 0
    v_add_f32_dpp v12, v12, v12 row_ror:4 row_mask:0xf bank_mask:0xf
    v_add_f32_dpp v13, v13, v13 row_ror:4 row_mask:0xf bank_mask:0xf
    s_nop 0
    v_add_f32_dpp v12, v12, v12 quad_perm:[2,3,0,1] row_mask:0xf bank_mask:0xf
    v_add_f32_dpp v13, v13, v13 quad_perm:[2,3,0,1] row_mask:0xf bank_mask:0xf
    v_cvt_pk_bf16_f32 v12, v12, v13
    v_and_b32 v6, 1, v1
    v_lshlrev_b32 v6, 4, v6
    v_lshl_add_u32 v6, v2, 2, v6
    s_lshl_b32 s57, s66, 11
    s_lshl_b32 s58, s64, 5
    s_add_u32 s57, s57, s58
    s_xor_b32 s58, s56, 1
    s_lshl_b32 s58, s58, 10
    s_add_u32 s57, s57, s58
    s_mov_b32 s36, s26
    s_mov_b32 s37, s27
    s_and_b32 s37, s37, 0xffff
    s_mov_b32 s38, 4096
    s_mov_b32 s39, 0x00020000
    s_mov_b32 exec_lo, 0x00030003
    s_mov_b32 exec_hi, 0x00030003
    buffer_store_dword v12, v6, s[36:39], s57 offen
    s_mov_b64 exec, -1
    s_branch L_end
L_end:
    s_endpgm
.section .rodata,"a"
.p2align 6
.amdhsa_kernel concat_heads__compressed_kv_cla__gqa_block_cached__decode_kernel
  .amdhsa_next_free_vgpr 256
  .amdhsa_next_free_sgpr 102
  .amdhsa_accum_offset 256
  .amdhsa_group_segment_fixed_size 0
  .amdhsa_kernarg_size 112
  .amdhsa_user_sgpr_count 2
  .amdhsa_user_sgpr_kernarg_segment_ptr 1
  .amdhsa_system_sgpr_workgroup_id_x 1
.end_amdhsa_kernel
```

```asm
; @launch grid=(256,1,1) block=(512,1,1) lds=163840
.amdgcn_target "amdgcn-amd-amdhsa--gfx950"
.text
.globl concat_heads__compressed_kv_cla__gqa_block_cached__decode_kernel
.p2align 8
.type concat_heads__compressed_kv_cla__gqa_block_cached__decode_kernel,@function
concat_heads__compressed_kv_cla__gqa_block_cached__decode_kernel:
    s_cmp_ge_u32 s2, 256
    s_cbranch_scc1 L_end
    s_cmp_ge_u32 s2, 8
    s_cbranch_scc1 Lpf_1
    s_getpc_b64 s[4:5]
    s_and_b32 s4, s4, 0xffffff00
    v_lshlrev_b32 v2, 4, v0
    v_min_u32 v3, L_end-concat_heads__compressed_kv_cla__gqa_block_cached__decode_kernel-16, v2
    global_load_dwordx4 v[252:255], v3, s[4:5]
    v_add_u32 v2, 0x2000, v2
    v_min_u32 v3, L_end-concat_heads__compressed_kv_cla__gqa_block_cached__decode_kernel-16, v2
    global_load_dwordx4 v[252:255], v3, s[4:5]
    v_add_u32 v2, 0x2000, v2
    v_min_u32 v3, L_end-concat_heads__compressed_kv_cla__gqa_block_cached__decode_kernel-16, v2
    global_load_dwordx4 v[252:255], v3, s[4:5]
    v_add_u32 v2, 0x2000, v2
    v_min_u32 v3, L_end-concat_heads__compressed_kv_cla__gqa_block_cached__decode_kernel-16, v2
    global_load_dwordx4 v[252:255], v3, s[4:5]
Lpf_1:
    s_load_dwordx16 s[4:19], s[0:1], 0
    s_load_dwordx8 s[20:27], s[0:1], 64
    s_load_dwordx4 s[28:31], s[0:1], 96
    v_lshrrev_b32 v1, 6, v0
    s_lshr_b32 s57, s2, 3
    v_readfirstlane_b32 s56, v1
    s_and_b32 s58, s2, 7
    s_mov_b32 s34, 268435456
    s_mov_b32 s35, 0x00020000
    s_mov_b32 s54, 256
    s_mov_b32 s55, 0x00020000
    s_nop 0
    s_and_b32 s59, s57, 3
    s_lshl_b32 s60, s58, 2
    s_add_u32 s59, s59, s60
    s_bfe_u32 s60, s57, 0x10002
    s_bfe_u32 s62, s57, 0x10003
    s_lshr_b32 s78, s57, 4
    s_lshl_b32 s3, s78, 5
    s_add_u32 s3, s3, s59
    s_lshl_b32 s3, s3, 2
    s_add_u32 s3, s3, s62
    s_lshl_b32 s3, s3, 1
    s_add_u32 s3, s3, s60
    s_lshl_b32 s3, s3, 8
    s_add_u32 s3, s3, 1310720
    s_and_b32 s91, s59, 0xfc
    v_and_b32 v228, 63, v0
    v_lshrrev_b32 v229, 3, v228
    v_and_b32 v230, 7, v228
    v_lshlrev_b32 v231, 3, v229
    v_lshlrev_b32 v232, 15, v229
    v_lshl_add_u32 v232, v230, 4, v232
    s_lshl_b32 s76, s56, 6
    s_lshl_b32 s62, s62, 9
    s_add_u32 s76, s76, s62
    s_lshl_b32 s77, s76, 12
    s_lshl_b32 s59, s59, 8
    s_lshl_b32 s60, s60, 7
    s_add_u32 s77, s77, s59
    s_add_u32 s77, s77, s60
    s_mov_b32 s38, 4194304
    s_mov_b32 s39, 0x00020000
    s_mov_b32 s42, 2048
    s_mov_b32 s43, 0x00020000
    s_mov_b32 s68, 0x05040100
    s_mov_b32 s69, 0x07060302
    s_cmp_lt_u32 s57, 8
    s_cbranch_scc1 L_roleA
    s_waitcnt lgkmcnt(0)
    s_mov_b32 s32, s30
    s_and_b32 s33, s31, 0xffff
    s_mov_b32 s52, s28
    s_and_b32 s53, s29, 0xffff
    s_cmp_eq_u32 s78, 0
    s_cselect_b32 s36, s8, s22
    s_cselect_b32 s37, s9, s23
    s_cselect_b32 s40, s4, s16
    s_cselect_b32 s41, s5, s17
    s_and_b32 s37, s37, 0xffff
    s_and_b32 s41, s41, 0xffff
    buffer_load_dwordx4 v[192:195], v232, s[36:39], s77 offen nt
    s_add_u32 s77, s77, 8192
    buffer_load_dwordx4 v[196:199], v232, s[36:39], s77 offen nt
    s_add_u32 s77, s77, 8192
    buffer_load_dwordx4 v[200:203], v232, s[36:39], s77 offen nt
    s_add_u32 s77, s77, 8192
    buffer_load_dwordx4 v[204:207], v232, s[36:39], s77 offen nt
    buffer_load_dwordx2 v[208:209], v231, s[40:43], s76 offen offset:0
    buffer_load_dwordx2 v[210:211], v231, s[40:43], s76 offen offset:1024
    s_sub_u32 s57, s57, 8
    s_mul_i32 s59, s57, 43
    s_lshr_b32 s59, s59, 8
    s_mul_i32 s60, s59, 6
    s_sub_u32 s60, s57, s60
    s_mul_i32 s66, s60, 86
    s_lshr_b32 s66, s66, 8
    s_mul_i32 s61, s66, 3
    s_sub_u32 s67, s60, s61
    s_mov_b32 s64, s60
    s_mul_i32 s65, s67, 3
    s_add_u32 s65, s65, s58
    s_and_b32 s65, s65, 7
    s_lshl_b32 s65, s65, 2
    s_add_u32 s65, s65, s59
    v_and_b32 v1, 63, v0
    v_lshrrev_b32 v2, 4, v1
    v_and_b32 v3, 15, v1
    s_lshl_b32 s59, s66, 5
    s_add_u32 s59, s59, s65
    s_lshl_b32 s61, s59, 20
    s_lshl_b32 s63, s59, 8
    s_add_u32 s63, s63, 1507328
    v_lshlrev_b32 v4, 4, v1
    s_mov_b32 s70, 1040356334
    v_mov_b32 v60, 0
    s_mul_i32 s71, s67, 7
    s_add_u32 s71, s71, s56
    s_mov_b32 s46, 1048576
    s_mov_b32 s47, 0x00020000
    s_mov_b32 s50, 1048576
    s_mov_b32 s51, 0x00020000
    s_add_u32 s44, s18, s61
    s_addc_u32 s45, s19, 0
    s_and_b32 s45, s45, 0xffff
    s_add_u32 s48, s20, s61
    s_addc_u32 s49, s21, 0
    s_and_b32 s49, s49, 0xffff
    s_barrier
    s_mov_b32 s74, 256
    s_add_u32 s72, s71, 21
    s_cmp_eq_u32 s56, 7
    s_cbranch_scc1 Lpoller_2
    s_add_u32 s88, s71, 0
    s_lshl_b32 s100, s88, 12
    buffer_load_dwordx4 v[64:67], v4, s[44:47], s100 offen offset:0 nt
    buffer_load_dwordx4 v[68:71], v4, s[44:47], s100 offen offset:1024 nt
    buffer_load_dwordx4 v[72:75], v4, s[44:47], s100 offen offset:2048 nt
    buffer_load_dwordx4 v[76:79], v4, s[44:47], s100 offen offset:3072 nt
    s_waitcnt vmcnt(4)
    v_perm_b32 v232, v196, v192, s68
    v_perm_b32 v233, v196, v192, s69
    v_perm_b32 v234, v197, v193, s68
    v_perm_b32 v235, v197, v193, s69
    v_perm_b32 v236, v198, v194, s68
    v_perm_b32 v237, v198, v194, s69
    v_perm_b32 v238, v199, v195, s68
    v_perm_b32 v239, v199, v195, s69
    v_dot2_f32_bf16 v212, v232, v208, 0
    v_dot2_f32_bf16 v213, v233, v208, 0
    v_dot2_f32_bf16 v214, v234, v208, 0
    v_dot2_f32_bf16 v215, v235, v208, 0
    v_dot2_f32_bf16 v216, v236, v208, 0
    v_dot2_f32_bf16 v217, v237, v208, 0
    v_dot2_f32_bf16 v218, v238, v208, 0
    v_dot2_f32_bf16 v219, v239, v208, 0
    v_dot2_f32_bf16 v220, v232, v210, 0
    v_dot2_f32_bf16 v221, v233, v210, 0
    v_dot2_f32_bf16 v222, v234, v210, 0
    v_dot2_f32_bf16 v223, v235, v210, 0
    v_dot2_f32_bf16 v224, v236, v210, 0
    v_dot2_f32_bf16 v225, v237, v210, 0
    v_dot2_f32_bf16 v226, v238, v210, 0
    v_dot2_f32_bf16 v227, v239, v210, 0
    v_perm_b32 v232, v204, v200, s68
    v_perm_b32 v233, v204, v200, s69
    v_perm_b32 v234, v205, v201, s68
    v_perm_b32 v235, v205, v201, s69
    v_perm_b32 v236, v206, v202, s68
    v_perm_b32 v237, v206, v202, s69
    v_perm_b32 v238, v207, v203, s68
    v_perm_b32 v239, v207, v203, s69
    v_dot2_f32_bf16 v212, v232, v209, v212
    v_dot2_f32_bf16 v213, v233, v209, v213
    v_dot2_f32_bf16 v214, v234, v209, v214
    v_dot2_f32_bf16 v215, v235, v209, v215
    v_dot2_f32_bf16 v216, v236, v209, v216
    v_dot2_f32_bf16 v217, v237, v209, v217
    v_dot2_f32_bf16 v218, v238, v209, v218
    v_dot2_f32_bf16 v219, v239, v209, v219
    v_dot2_f32_bf16 v220, v232, v211, v220
    v_dot2_f32_bf16 v221, v233, v211, v221
    v_dot2_f32_bf16 v222, v234, v211, v222
    v_dot2_f32_bf16 v223, v235, v211, v223
    v_dot2_f32_bf16 v224, v236, v211, v224
    v_dot2_f32_bf16 v225, v237, v211, v225
    v_dot2_f32_bf16 v226, v238, v211, v226
    v_dot2_f32_bf16 v227, v239, v211, v227
    s_nop 2
    v_permlane32_swap_b32 v212, v220
    v_permlane32_swap_b32 v213, v221
    v_permlane32_swap_b32 v214, v222
    v_permlane32_swap_b32 v215, v223
    v_permlane32_swap_b32 v216, v224
    v_permlane32_swap_b32 v217, v225
    v_permlane32_swap_b32 v218, v226
    v_permlane32_swap_b32 v219, v227
    s_nop 1
    v_add_f32 v212, v212, v220
    v_add_f32 v213, v213, v221
    v_add_f32 v214, v214, v222
    v_add_f32 v215, v215, v223
    v_add_f32 v216, v216, v224
    v_add_f32 v217, v217, v225
    v_add_f32 v218, v218, v226
    v_add_f32 v219, v219, v227
    s_nop 1
    v_permlane16_swap_b32 v212, v216
    v_permlane16_swap_b32 v213, v217
    v_permlane16_swap_b32 v214, v218
    v_permlane16_swap_b32 v215, v219
    s_nop 1
    v_add_f32 v212, v212, v216
    v_add_f32 v213, v213, v217
    v_add_f32 v214, v214, v218
    v_add_f32 v215, v215, v219
    s_nop 1
    v_add_f32_dpp v212, v212, v212 row_ror:8 row_mask:0xf bank_mask:0xf
    v_add_f32_dpp v213, v213, v213 row_ror:8 row_mask:0xf bank_mask:0xf
    v_add_f32_dpp v214, v214, v214 row_ror:8 row_mask:0xf bank_mask:0xf
    v_add_f32_dpp v215, v215, v215 row_ror:8 row_mask:0xf bank_mask:0xf
    v_lshrrev_b32 v232, 5, v228
    v_lshlrev_b32 v232, 8, v232
    v_bfe_u32 v233, v228, 4, 1
    v_lshl_add_u32 v232, v233, 4, v232
    v_lshl_add_u32 v232, v230, 5, v232
    s_lshl_b32 s61, s56, 9
    s_add_u32 s61, s61, 12288
    v_add_u32 v232, s61, v232
    ds_write_b128 v232, v[212:215]
    s_waitcnt lgkmcnt(0)
    s_barrier
    s_waitcnt vmcnt(3)
    buffer_load_dwordx4 v[80:83], v4, s[48:51], s100 offen offset:0 nt
    s_waitcnt vmcnt(3)
    buffer_load_dwordx4 v[84:87], v4, s[48:51], s100 offen offset:1024 nt
    s_waitcnt vmcnt(3)
    buffer_load_dwordx4 v[88:91], v4, s[48:51], s100 offen offset:2048 nt
    s_waitcnt vmcnt(3)
    buffer_load_dwordx4 v[92:95], v4, s[48:51], s100 offen offset:3072 nt
    s_add_u32 s88, s71, 21
    s_lshl_b32 s100, s88, 12
    s_waitcnt vmcnt(3)
    buffer_load_dwordx4 v[96:99], v4, s[44:47], s100 offen offset:0 nt
    s_waitcnt vmcnt(3)
    buffer_load_dwordx4 v[100:103], v4, s[44:47], s100 offen offset:1024 nt
    s_waitcnt vmcnt(3)
    buffer_load_dwordx4 v[104:107], v4, s[44:47], s100 offen offset:2048 nt
    s_waitcnt vmcnt(3)
    buffer_load_dwordx4 v[108:111], v4, s[44:47], s100 offen offset:3072 nt
    s_waitcnt vmcnt(3)
    buffer_load_dwordx4 v[112:115], v4, s[48:51], s100 offen offset:0 nt
    s_waitcnt vmcnt(3)
    buffer_load_dwordx4 v[116:119], v4, s[48:51], s100 offen offset:1024 nt
    s_waitcnt vmcnt(3)
    buffer_load_dwordx4 v[120:123], v4, s[48:51], s100 offen offset:2048 nt
    s_waitcnt vmcnt(3)
    buffer_load_dwordx4 v[124:127], v4, s[48:51], s100 offen offset:3072 nt
    s_add_u32 s88, s71, 42
    s_lshl_b32 s100, s88, 12
    s_waitcnt vmcnt(3)
    buffer_load_dwordx4 v[128:131], v4, s[44:47], s100 offen offset:0 nt
    s_waitcnt vmcnt(3)
    buffer_load_dwordx4 v[132:135], v4, s[44:47], s100 offen offset:1024 nt
    s_waitcnt vmcnt(3)
    buffer_load_dwordx4 v[136:139], v4, s[44:47], s100 offen offset:2048 nt
    s_waitcnt vmcnt(3)
    buffer_load_dwordx4 v[140:143], v4, s[44:47], s100 offen offset:3072 nt
    s_waitcnt vmcnt(3)
    buffer_load_dwordx4 v[144:147], v4, s[48:51], s100 offen offset:0 nt
    s_waitcnt vmcnt(3)
    buffer_load_dwordx4 v[148:151], v4, s[48:51], s100 offen offset:1024 nt
    s_waitcnt vmcnt(3)
    buffer_load_dwordx4 v[152:155], v4, s[48:51], s100 offen offset:2048 nt
    s_waitcnt vmcnt(3)
    buffer_load_dwordx4 v[156:159], v4, s[48:51], s100 offen offset:3072 nt
    s_add_u32 s88, s71, 63
    s_lshl_b32 s100, s88, 12
    s_waitcnt vmcnt(3)
    buffer_load_dwordx4 v[160:163], v4, s[44:47], s100 offen offset:0 nt
    s_waitcnt vmcnt(3)
    buffer_load_dwordx4 v[164:167], v4, s[44:47], s100 offen offset:1024 nt
    s_waitcnt vmcnt(3)
    buffer_load_dwordx4 v[168:171], v4, s[44:47], s100 offen offset:2048 nt
    s_waitcnt vmcnt(3)
    buffer_load_dwordx4 v[172:175], v4, s[44:47], s100 offen offset:3072 nt
    s_waitcnt vmcnt(3)
    buffer_load_dwordx4 v[176:179], v4, s[48:51], s100 offen offset:0 nt
    s_waitcnt vmcnt(3)
    buffer_load_dwordx4 v[180:183], v4, s[48:51], s100 offen offset:1024 nt
    s_waitcnt vmcnt(3)
    buffer_load_dwordx4 v[184:187], v4, s[48:51], s100 offen offset:2048 nt
    s_waitcnt vmcnt(3)
    buffer_load_dwordx4 v[188:191], v4, s[48:51], s100 offen offset:3072 nt
    s_branch Ljoin_3
Lpoller_2:
    s_setprio 3
    s_waitcnt vmcnt(0)
    v_perm_b32 v232, v196, v192, s68
    v_perm_b32 v233, v196, v192, s69
    v_perm_b32 v234, v197, v193, s68
    v_perm_b32 v235, v197, v193, s69
    v_perm_b32 v236, v198, v194, s68
    v_perm_b32 v237, v198, v194, s69
    v_perm_b32 v238, v199, v195, s68
    v_perm_b32 v239, v199, v195, s69
    v_dot2_f32_bf16 v212, v232, v208, 0
    v_dot2_f32_bf16 v213, v233, v208, 0
    v_dot2_f32_bf16 v214, v234, v208, 0
    v_dot2_f32_bf16 v215, v235, v208, 0
    v_dot2_f32_bf16 v216, v236, v208, 0
    v_dot2_f32_bf16 v217, v237, v208, 0
    v_dot2_f32_bf16 v218, v238, v208, 0
    v_dot2_f32_bf16 v219, v239, v208, 0
    v_dot2_f32_bf16 v220, v232, v210, 0
    v_dot2_f32_bf16 v221, v233, v210, 0
    v_dot2_f32_bf16 v222, v234, v210, 0
    v_dot2_f32_bf16 v223, v235, v210, 0
    v_dot2_f32_bf16 v224, v236, v210, 0
    v_dot2_f32_bf16 v225, v237, v210, 0
    v_dot2_f32_bf16 v226, v238, v210, 0
    v_dot2_f32_bf16 v227, v239, v210, 0
    v_perm_b32 v232, v204, v200, s68
    v_perm_b32 v233, v204, v200, s69
    v_perm_b32 v234, v205, v201, s68
    v_perm_b32 v235, v205, v201, s69
    v_perm_b32 v236, v206, v202, s68
    v_perm_b32 v237, v206, v202, s69
    v_perm_b32 v238, v207, v203, s68
    v_perm_b32 v239, v207, v203, s69
    v_dot2_f32_bf16 v212, v232, v209, v212
    v_dot2_f32_bf16 v213, v233, v209, v213
    v_dot2_f32_bf16 v214, v234, v209, v214
    v_dot2_f32_bf16 v215, v235, v209, v215
    v_dot2_f32_bf16 v216, v236, v209, v216
    v_dot2_f32_bf16 v217, v237, v209, v217
    v_dot2_f32_bf16 v218, v238, v209, v218
    v_dot2_f32_bf16 v219, v239, v209, v219
    v_dot2_f32_bf16 v220, v232, v211, v220
    v_dot2_f32_bf16 v221, v233, v211, v221
    v_dot2_f32_bf16 v222, v234, v211, v222
    v_dot2_f32_bf16 v223, v235, v211, v223
    v_dot2_f32_bf16 v224, v236, v211, v224
    v_dot2_f32_bf16 v225, v237, v211, v225
    v_dot2_f32_bf16 v226, v238, v211, v226
    v_dot2_f32_bf16 v227, v239, v211, v227
    s_nop 2
    v_permlane32_swap_b32 v212, v220
    v_permlane32_swap_b32 v213, v221
    v_permlane32_swap_b32 v214, v222
    v_permlane32_swap_b32 v215, v223
    v_permlane32_swap_b32 v216, v224
    v_permlane32_swap_b32 v217, v225
    v_permlane32_swap_b32 v218, v226
    v_permlane32_swap_b32 v219, v227
    s_nop 1
    v_add_f32 v212, v212, v220
    v_add_f32 v213, v213, v221
    v_add_f32 v214, v214, v222
    v_add_f32 v215, v215, v223
    v_add_f32 v216, v216, v224
    v_add_f32 v217, v217, v225
    v_add_f32 v218, v218, v226
    v_add_f32 v219, v219, v227
    s_nop 1
    v_permlane16_swap_b32 v212, v216
    v_permlane16_swap_b32 v213, v217
    v_permlane16_swap_b32 v214, v218
    v_permlane16_swap_b32 v215, v219
    s_nop 1
    v_add_f32 v212, v212, v216
    v_add_f32 v213, v213, v217
    v_add_f32 v214, v214, v218
    v_add_f32 v215, v215, v219
    s_nop 1
    v_add_f32_dpp v212, v212, v212 row_ror:8 row_mask:0xf bank_mask:0xf
    v_add_f32_dpp v213, v213, v213 row_ror:8 row_mask:0xf bank_mask:0xf
    v_add_f32_dpp v214, v214, v214 row_ror:8 row_mask:0xf bank_mask:0xf
    v_add_f32_dpp v215, v215, v215 row_ror:8 row_mask:0xf bank_mask:0xf
    v_lshrrev_b32 v232, 5, v228
    v_lshlrev_b32 v232, 8, v232
    v_bfe_u32 v233, v228, 4, 1
    v_lshl_add_u32 v232, v233, 4, v232
    v_lshl_add_u32 v232, v230, 5, v232
    s_lshl_b32 s61, s56, 9
    s_add_u32 s61, s61, 12288
    v_add_u32 v232, s61, v232
    ds_write_b128 v232, v[212:215]
    s_waitcnt lgkmcnt(0)
    s_barrier
    v_mov_b32 v234, 0
    buffer_load_dword v235, v234, s[52:55], s91 offen offset:0 sc0 sc1
    v_and_b32 v232, 31, v228
    v_lshlrev_b32 v233, 4, v232
    v_add_u32 v233, 12288, v233
    ds_read_b128 v[192:195], v233 offset:0
    ds_read_b128 v[196:199], v233 offset:512
    ds_read_b128 v[200:203], v233 offset:1024
    ds_read_b128 v[204:207], v233 offset:1536
    ds_read_b128 v[208:211], v233 offset:2048
    ds_read_b128 v[212:215], v233 offset:2560
    ds_read_b128 v[216:219], v233 offset:3072
    ds_read_b128 v[220:223], v233 offset:3584
    s_waitcnt lgkmcnt(6)
    v_add_f32 v192, v192, v196
    v_add_f32 v193, v193, v197
    v_add_f32 v194, v194, v198
    v_add_f32 v195, v195, v199
    s_waitcnt lgkmcnt(5)
    v_add_f32 v192, v192, v200
    v_add_f32 v193, v193, v201
    v_add_f32 v194, v194, v202
    v_add_f32 v195, v195, v203
    s_waitcnt lgkmcnt(4)
    v_add_f32 v192, v192, v204
    v_add_f32 v193, v193, v205
    v_add_f32 v194, v194, v206
    v_add_f32 v195, v195, v207
    s_waitcnt lgkmcnt(3)
    v_add_f32 v192, v192, v208
    v_add_f32 v193, v193, v209
    v_add_f32 v194, v194, v210
    v_add_f32 v195, v195, v211
    s_waitcnt lgkmcnt(2)
    v_add_f32 v192, v192, v212
    v_add_f32 v193, v193, v213
    v_add_f32 v194, v194, v214
    v_add_f32 v195, v195, v215
    s_waitcnt lgkmcnt(1)
    v_add_f32 v192, v192, v216
    v_add_f32 v193, v193, v217
    v_add_f32 v194, v194, v218
    v_add_f32 v195, v195, v219
    s_waitcnt lgkmcnt(0)
    v_add_f32 v192, v192, v220
    v_add_f32 v193, v193, v221
    v_add_f32 v194, v194, v222
    v_add_f32 v195, v195, v223
    v_lshrrev_b32 v233, 4, v232
    v_lshlrev_b32 v233, 10, v233
    v_and_b32 v232, 15, v232
    v_lshl_add_u32 v233, v232, 4, v233
    s_waitcnt vmcnt(0)
    s_mov_b32 s92, 0
Lcf_4:
    v_readfirstlane_b32 s57, v235
    s_nop 3
    s_cmp_lg_u32 s57, 0
    s_cbranch_scc1 Lcfd_5
    s_sleep 2
    buffer_load_dword v235, v234, s[52:55], s91 offen offset:0 sc0 sc1
    s_waitcnt vmcnt(0)
    s_add_u32 s92, s92, 1
    s_cmp_lt_u32 s92, 400000
    s_cbranch_scc1 Lcf_4
Lcfd_5:
    s_mov_b64 exec, 0xffffffff
    buffer_store_dwordx4 v[192:195], v233, s[32:35], s3 offen sc0 sc1
    s_mov_b64 exec, -1
    s_mov_b32 s89, 1540096
    s_load_dword s90, s[30:31], s89
    s_and_b32 s91, s65, 0xfc
    v_mov_b32 v44, 0
    v_mov_b32 v45, 0
    s_mov_b32 s92, 0
Lcf_6:
    v_readfirstlane_b32 s57, v45
    s_nop 3
    s_cmp_lg_u32 s57, 0
    s_cbranch_scc1 Lcfd_7
    s_sleep 2
    buffer_load_dword v45, v44, s[52:55], s91 offen offset:0 sc0 sc1
    s_waitcnt vmcnt(0)
    s_add_u32 s92, s92, 1
    s_cmp_lt_u32 s92, 400000
    s_cbranch_scc1 Lcf_6
Lcfd_7:
    v_lshlrev_b32 v40, 4, v1
    s_lshl_b32 s61, s65, 11
    s_lshl_b32 s62, s66, 10
    s_add_u32 s61, s61, s62
    s_add_u32 s61, s61, 1376256
    s_mov_b32 s92, 0
Lpoll_8:
    buffer_load_dwordx4 v[48:51], v40, s[32:35], s61 offen sc0 sc1
    s_waitcnt vmcnt(0)
    v_mov_b32 v41, v48
    v_max3_u32 v41, v41, v49, v50
    v_max_u32 v41, v41, v51
    v_cmpx_eq_u32 vcc, -1, v41
    s_cbranch_execz Lpolld_9
    s_sleep 4
    s_add_u32 s92, s92, 1
    s_cmp_lt_u32 s92, 400000
    s_cbranch_scc1 Lpoll_8
Lpolld_9:
    s_mov_b64 exec, -1
    v_mov_b32 v52, v48
    v_mov_b32 v53, v49
    v_mov_b32 v54, v50
    v_mov_b32 v55, v51
    s_nop 1
    v_permlane32_swap_b32 v48, v52
    v_permlane32_swap_b32 v49, v53
    v_permlane32_swap_b32 v50, v54
    v_permlane32_swap_b32 v51, v55
    s_nop 1
    v_add_f32 v48, v48, v52
    v_add_f32 v49, v49, v53
    v_add_f32 v50, v50, v54
    v_add_f32 v51, v51, v55
    v_cvt_pk_bf16_f32 v48, v48, v49
    v_cvt_pk_bf16_f32 v49, v50, v51
    v_mov_b32 v44, 0
    s_mov_b32 s92, 0
Lcf_10:
    buffer_load_dword v45, v44, s[52:55], 0 offen offset:128 sc0 sc1
    s_waitcnt vmcnt(0)
    v_readfirstlane_b32 s57, v45
    s_nop 3
    s_cmp_ge_u32 s57, 64
    s_cbranch_scc1 Lcfd_11
    s_sleep 16
    s_add_u32 s92, s92, 1
    s_cmp_lt_u32 s92, 400000
    s_cbranch_scc1 Lcf_10
Lcfd_11:
    v_and_b32 v42, 31, v1
    v_lshlrev_b32 v42, 3, v42
    ds_write_b64 v42, v[48:49] offset:0
    s_waitcnt lgkmcnt(0)
    v_mov_b32 v40, 0xff7fffff
    v_mov_b32 v41, 0
    v_mov_b32 v42, 56
    ds_write_b64 v42, v[40:41] offset:8192
    v_mov_b32 v40, 0
    v_lshlrev_b32 v42, 3, v1
    ds_write_b64 v42, v[40:41] offset:7680
    v_mov_b32 v42, 256
    ds_write_b32 v42, v40
    s_mul_i32 s61, s67, 12
    s_add_u32 s61, s61, 84
    v_add_u32 v40, s61, v1
    v_cmp_gt_u32 vcc, 12, v1
    v_mov_b32 v41, -1
    v_lshlrev_b32 v43, 2, v1
    v_cndmask_b32 v40, v41, v40, vcc
    ds_write_b32 v43, v40 offset:1024
    ds_write_b32 v43, v41 offset:1280
    ds_write_b32 v43, v41 offset:1536
    ds_write_b32 v43, v41 offset:1792
    ds_write_b32 v43, v41 offset:2048
    v_mov_b32 v40, 7
    ds_write_b32 v42, v40
    s_waitcnt lgkmcnt(0)
    s_barrier
    s_mov_b32 s84, 12
    s_mov_b32 s86, 9
    s_mov_b32 s87, 6
    s_mov_b32 s90, 7
    v_mov_b32 v42, 256
    s_mov_b32 s92, 0
Lprod_12:
    s_add_u32 s92, s92, 1
    s_cmp_gt_u32 s92, 400000
    s_cbranch_scc1 Lprods_14
    ds_read_b32 v40, v42
    s_waitcnt lgkmcnt(0)
    v_readfirstlane_b32 s85, v40
    s_nop 3
    s_add_u32 s85, s85, s86
    s_sub_i32 s85, s85, s84
    s_cmp_gt_i32 s85, s87
    s_cbranch_scc1 Lprodg_15
    s_sleep 1
    s_branch Lprod_12
Lprodg_15:
    s_min_u32 s85, s85, s90
    s_add_u32 s88, s30, s63
    s_addc_u32 s89, s31, 0
    s_mov_b32 s62, s85
    s_atomic_add s62, s[88:89], 0x0 glc
    s_bfm_b64 exec, s85, 0
    s_waitcnt lgkmcnt(0)
    v_add_u32 v44, s62, v1
    s_cmp_ge_u32 s62, 65616
    s_cselect_b32 s86, 3, s86
    s_cselect_b32 s87, 1, s87
    s_cselect_b32 s90, 2, s90
    v_add_u32 v44, 4294901880, v44
    v_cmp_gt_u32 vcc, 256, v44
    s_mov_b64 s[94:95], exec
    s_nop 1
    v_mbcnt_lo_u32_b32 v45, vcc_lo, 0
    s_bcnt1_i32_b64 s85, vcc
    v_add_u32 v45, s84, v45
    v_lshlrev_b32 v45, 2, v45
    s_mov_b64 exec, vcc
    s_cbranch_execz Lprodn_16
    ds_write_b32 v45, v44 offset:1024
Lprodn_16:
    s_add_u32 s84, s84, s85
    s_cmp_eq_u64 vcc, s[94:95]
    s_mov_b64 exec, -1
    s_cbranch_scc1 Lprod_12
Lprods_14:
    s_mov_b64 exec, -1
    v_add_u32 v45, s84, v1
    v_lshlrev_b32 v45, 2, v45
    v_mov_b32 v44, 0x1000
    s_mov_b64 exec, 0xff
    ds_write_b32 v45, v44 offset:1024
    s_mov_b64 exec, -1
    s_waitcnt lgkmcnt(0)
    s_barrier
    s_branch L_end
Ljoin_3:
    s_barrier
    v_lshlrev_b32 v40, 4, v3
    ds_read_b128 v[24:27], v40 offset:0
    s_mul_i32 s62, s67, 7
    s_add_u32 s62, s62, s56
    s_add_u32 s73, s62, 84
    s_mul_i32 s61, s67, 12
    s_add_u32 s61, s61, 84
    s_add_u32 s73, s61, s56
    s_mov_b32 s83, 114
    v_mov_b32 v61, 256
    v_mov_b32 v5, 1
    v_mov_b32 v36, 0xff7fffff
    v_mov_b32 v37, 0
    v_mov_b32 v16, 0
    v_mov_b32 v17, 0
    v_mov_b32 v18, 0
    v_mov_b32 v19, 0
    v_mov_b32 v20, 0
    v_mov_b32 v21, 0
    v_mov_b32 v22, 0
    v_mov_b32 v23, 0
    v_lshlrev_b32 v6, 5, v3
    v_lshl_add_u32 v6, v2, 3, v6
    s_lshl_b32 s61, s56, 9
    v_add_u32 v7, s61, v6
    s_waitcnt lgkmcnt(0)
    s_lshl_b32 s100, s73, 12
    s_mov_b32 s71, s73
    v_dot2_f32_bf16 v28, v64, v24, 0
    v_dot2_f32_bf16 v28, v65, v25, v28
    v_dot2_f32_bf16 v28, v66, v26, v28
    v_dot2_f32_bf16 v28, v67, v27, v28
    s_waitcnt vmcnt(3)
    buffer_load_dwordx4 v[64:67], v4, s[44:47], s100 offen offset:0 nt
    v_dot2_f32_bf16 v29, v68, v24, 0
    v_dot2_f32_bf16 v29, v69, v25, v29
    v_dot2_f32_bf16 v29, v70, v26, v29
    v_dot2_f32_bf16 v29, v71, v27, v29
    s_waitcnt vmcnt(3)
    buffer_load_dwordx4 v[68:71], v4, s[44:47], s100 offen offset:1024 nt
    v_dot2_f32_bf16 v30, v72, v24, 0
    v_dot2_f32_bf16 v30, v73, v25, v30
    v_dot2_f32_bf16 v30, v74, v26, v30
    v_dot2_f32_bf16 v30, v75, v27, v30
    s_waitcnt vmcnt(3)
    buffer_load_dwordx4 v[72:75], v4, s[44:47], s100 offen offset:2048 nt
    v_dot2_f32_bf16 v31, v76, v24, 0
    v_dot2_f32_bf16 v31, v77, v25, v31
    v_dot2_f32_bf16 v31, v78, v26, v31
    v_dot2_f32_bf16 v31, v79, v27, v31
    s_waitcnt vmcnt(3)
    buffer_load_dwordx4 v[76:79], v4, s[44:47], s100 offen offset:3072 nt
    s_nop 2
    v_add_f32_dpp v28, v28, v28 row_ror:8 row_mask:0xf bank_mask:0xf
    v_add_f32_dpp v29, v29, v29 row_ror:8 row_mask:0xf bank_mask:0xf
    v_add_f32_dpp v30, v30, v30 row_ror:8 row_mask:0xf bank_mask:0xf
    v_add_f32_dpp v31, v31, v31 row_ror:8 row_mask:0xf bank_mask:0xf
    v_add_f32_dpp v28, v28, v28 row_ror:4 row_mask:0xf bank_mask:0xf
    v_add_f32_dpp v29, v29, v29 row_ror:4 row_mask:0xf bank_mask:0xf
    v_add_f32_dpp v30, v30, v30 row_ror:4 row_mask:0xf bank_mask:0xf
    v_add_f32_dpp v31, v31, v31 row_ror:4 row_mask:0xf bank_mask:0xf
    v_add_f32_dpp v28, v28, v28 row_ror:2 row_mask:0xf bank_mask:0xf
    v_add_f32_dpp v29, v29, v29 row_ror:2 row_mask:0xf bank_mask:0xf
    v_add_f32_dpp v30, v30, v30 row_ror:2 row_mask:0xf bank_mask:0xf
    v_add_f32_dpp v31, v31, v31 row_ror:2 row_mask:0xf bank_mask:0xf
    v_add_f32_dpp v28, v28, v28 row_ror:1 row_mask:0xf bank_mask:0xf
    v_add_f32_dpp v29, v29, v29 row_ror:1 row_mask:0xf bank_mask:0xf
    v_add_f32_dpp v30, v30, v30 row_ror:1 row_mask:0xf bank_mask:0xf
    v_add_f32_dpp v31, v31, v31 row_ror:1 row_mask:0xf bank_mask:0xf
    v_max3_f32 v38, v36, v28, v29
    v_max3_f32 v38, v38, v30, v31
    v_sub_f32 v39, v36, v38
    v_mul_f32 v39, s70, v39
    v_exp_f32 v39, v39
    v_mul_f32 v56, s70, v38
    v_mov_b32 v36, v38
    v_fma_f32 v48, v28, s70, -v56
    v_fma_f32 v49, v29, s70, -v56
    v_fma_f32 v50, v30, s70, -v56
    v_fma_f32 v51, v31, s70, -v56
    v_exp_f32 v48, v48
    v_exp_f32 v49, v49
    v_exp_f32 v50, v50
    v_exp_f32 v51, v51
    v_mul_f32 v37, v37, v39
    v_mul_f32 v16, v16, v39
    v_mul_f32 v17, v17, v39
    v_mul_f32 v18, v18, v39
    v_mul_f32 v19, v19, v39
    v_mul_f32 v20, v20, v39
    v_mul_f32 v21, v21, v39
    v_mul_f32 v22, v22, v39
    v_mul_f32 v23, v23, v39
    v_add_f32 v37, v37, v48
    v_add_f32 v37, v37, v49
    v_add_f32 v37, v37, v50
    v_add_f32 v37, v37, v51
    v_lshlrev_b32 v40, 16, v80
    v_and_b32 v41, 0xffff0000, v80
    v_lshlrev_b32 v42, 16, v81
    v_and_b32 v43, 0xffff0000, v81
    v_lshlrev_b32 v44, 16, v82
    v_and_b32 v45, 0xffff0000, v82
    v_lshlrev_b32 v46, 16, v83
    v_and_b32 v47, 0xffff0000, v83
    s_waitcnt vmcnt(3)
    buffer_load_dwordx4 v[80:83], v4, s[48:51], s100 offen offset:0 nt
    v_fmac_f32 v16, v40, v48
    v_fmac_f32 v17, v41, v48
    v_fmac_f32 v18, v42, v48
    v_fmac_f32 v19, v43, v48
    v_fmac_f32 v20, v44, v48
    v_fmac_f32 v21, v45, v48
    v_fmac_f32 v22, v46, v48
    v_fmac_f32 v23, v47, v48
    v_lshlrev_b32 v40, 16, v84
    v_and_b32 v41, 0xffff0000, v84
    v_lshlrev_b32 v42, 16, v85
    v_and_b32 v43, 0xffff0000, v85
    v_lshlrev_b32 v44, 16, v86
    v_and_b32 v45, 0xffff0000, v86
    v_lshlrev_b32 v46, 16, v87
    v_and_b32 v47, 0xffff0000, v87
    s_waitcnt vmcnt(3)
    buffer_load_dwordx4 v[84:87], v4, s[48:51], s100 offen offset:1024 nt
    v_fmac_f32 v16, v40, v49
    v_fmac_f32 v17, v41, v49
    v_fmac_f32 v18, v42, v49
    v_fmac_f32 v19, v43, v49
    v_fmac_f32 v20, v44, v49
    v_fmac_f32 v21, v45, v49
    v_fmac_f32 v22, v46, v49
    v_fmac_f32 v23, v47, v49
    v_lshlrev_b32 v40, 16, v88
    v_and_b32 v41, 0xffff0000, v88
    v_lshlrev_b32 v42, 16, v89
    v_and_b32 v43, 0xffff0000, v89
    v_lshlrev_b32 v44, 16, v90
    v_and_b32 v45, 0xffff0000, v90
    v_lshlrev_b32 v46, 16, v91
    v_and_b32 v47, 0xffff0000, v91
    s_waitcnt vmcnt(3)
    buffer_load_dwordx4 v[88:91], v4, s[48:51], s100 offen offset:2048 nt
    v_fmac_f32 v16, v40, v50
    v_fmac_f32 v17, v41, v50
    v_fmac_f32 v18, v42, v50
    v_fmac_f32 v19, v43, v50
    v_fmac_f32 v20, v44, v50
    v_fmac_f32 v21, v45, v50
    v_fmac_f32 v22, v46, v50
    v_fmac_f32 v23, v47, v50
    v_lshlrev_b32 v40, 16, v92
    v_and_b32 v41, 0xffff0000, v92
    v_lshlrev_b32 v42, 16, v93
    v_and_b32 v43, 0xffff0000, v93
    v_lshlrev_b32 v44, 16, v94
    v_and_b32 v45, 0xffff0000, v94
    v_lshlrev_b32 v46, 16, v95
    v_and_b32 v47, 0xffff0000, v95
    s_waitcnt vmcnt(3)
    buffer_load_dwordx4 v[92:95], v4, s[48:51], s100 offen offset:3072 nt
    v_fmac_f32 v16, v40, v51
    v_fmac_f32 v17, v41, v51
    v_fmac_f32 v18, v42, v51
    v_fmac_f32 v19, v43, v51
    v_fmac_f32 v20, v44, v51
    v_fmac_f32 v21, v45, v51
    v_fmac_f32 v22, v46, v51
    v_fmac_f32 v23, v47, v51
    s_waitcnt vmcnt(8)
    s_mov_b64 s[94:95], exec
    s_mov_b64 exec, 1
    ds_add_rtn_u32 v59, v61, v5
    s_mov_b64 exec, s[94:95]
    s_waitcnt lgkmcnt(0)
    s_mov_b64 exec, 1
    v_lshlrev_b32 v59, 2, v59
    s_mov_b32 s92, 0
Lpop_21:
    ds_read_b32 v62, v59 offset:1024
    s_waitcnt lgkmcnt(0)
    v_readfirstlane_b32 s73, v62
    s_nop 3
    s_cmp_lg_u32 s73, -1
    s_cbranch_scc1 Lpopd_22
    s_sleep 1
    s_add_u32 s92, s92, 1
    s_cmp_lt_u32 s92, 400000
    s_cbranch_scc1 Lpop_21
Lpopd_22:
    s_mov_b64 exec, -1
    v_dot2_f32_bf16 v28, v128, v24, 0
    v_dot2_f32_bf16 v28, v129, v25, v28
    v_dot2_f32_bf16 v28, v130, v26, v28
    v_dot2_f32_bf16 v28, v131, v27, v28
    v_dot2_f32_bf16 v29, v132, v24, 0
    v_dot2_f32_bf16 v29, v133, v25, v29
    v_dot2_f32_bf16 v29, v134, v26, v29
    v_dot2_f32_bf16 v29, v135, v27, v29
    v_dot2_f32_bf16 v30, v136, v24, 0
    v_dot2_f32_bf16 v30, v137, v25, v30
    v_dot2_f32_bf16 v30, v138, v26, v30
    v_dot2_f32_bf16 v30, v139, v27, v30
    v_dot2_f32_bf16 v31, v140, v24, 0
    v_dot2_f32_bf16 v31, v141, v25, v31
    v_dot2_f32_bf16 v31, v142, v26, v31
    v_dot2_f32_bf16 v31, v143, v27, v31
    s_nop 2
    v_add_f32_dpp v28, v28, v28 row_ror:8 row_mask:0xf bank_mask:0xf
    v_add_f32_dpp v29, v29, v29 row_ror:8 row_mask:0xf bank_mask:0xf
    v_add_f32_dpp v30, v30, v30 row_ror:8 row_mask:0xf bank_mask:0xf
    v_add_f32_dpp v31, v31, v31 row_ror:8 row_mask:0xf bank_mask:0xf
    v_add_f32_dpp v28, v28, v28 row_ror:4 row_mask:0xf bank_mask:0xf
    v_add_f32_dpp v29, v29, v29 row_ror:4 row_mask:0xf bank_mask:0xf
    v_add_f32_dpp v30, v30, v30 row_ror:4 row_mask:0xf bank_mask:0xf
    v_add_f32_dpp v31, v31, v31 row_ror:4 row_mask:0xf bank_mask:0xf
    v_add_f32_dpp v28, v28, v28 row_ror:2 row_mask:0xf bank_mask:0xf
    v_add_f32_dpp v29, v29, v29 row_ror:2 row_mask:0xf bank_mask:0xf
    v_add_f32_dpp v30, v30, v30 row_ror:2 row_mask:0xf bank_mask:0xf
    v_add_f32_dpp v31, v31, v31 row_ror:2 row_mask:0xf bank_mask:0xf
    v_add_f32_dpp v28, v28, v28 row_ror:1 row_mask:0xf bank_mask:0xf
    v_add_f32_dpp v29, v29, v29 row_ror:1 row_mask:0xf bank_mask:0xf
    v_add_f32_dpp v30, v30, v30 row_ror:1 row_mask:0xf bank_mask:0xf
    v_add_f32_dpp v31, v31, v31 row_ror:1 row_mask:0xf bank_mask:0xf
    v_max3_f32 v38, v36, v28, v29
    v_max3_f32 v38, v38, v30, v31
    v_sub_f32 v39, v36, v38
    v_mul_f32 v39, s70, v39
    v_exp_f32 v39, v39
    v_mul_f32 v56, s70, v38
    v_mov_b32 v36, v38
    v_fma_f32 v48, v28, s70, -v56
    v_fma_f32 v49, v29, s70, -v56
    v_fma_f32 v50, v30, s70, -v56
    v_fma_f32 v51, v31, s70, -v56
    v_exp_f32 v48, v48
    v_exp_f32 v49, v49
    v_exp_f32 v50, v50
    v_exp_f32 v51, v51
    v_mul_f32 v37, v37, v39
    v_mul_f32 v16, v16, v39
    v_mul_f32 v17, v17, v39
    v_mul_f32 v18, v18, v39
    v_mul_f32 v19, v19, v39
    v_mul_f32 v20, v20, v39
    v_mul_f32 v21, v21, v39
    v_mul_f32 v22, v22, v39
    v_mul_f32 v23, v23, v39
    v_add_f32 v37, v37, v48
    v_add_f32 v37, v37, v49
    v_add_f32 v37, v37, v50
    v_add_f32 v37, v37, v51
    v_lshlrev_b32 v40, 16, v144
    v_and_b32 v41, 0xffff0000, v144
    v_lshlrev_b32 v42, 16, v145
    v_and_b32 v43, 0xffff0000, v145
    v_lshlrev_b32 v44, 16, v146
    v_and_b32 v45, 0xffff0000, v146
    v_lshlrev_b32 v46, 16, v147
    v_and_b32 v47, 0xffff0000, v147
    v_fmac_f32 v16, v40, v48
    v_fmac_f32 v17, v41, v48
    v_fmac_f32 v18, v42, v48
    v_fmac_f32 v19, v43, v48
    v_fmac_f32 v20, v44, v48
    v_fmac_f32 v21, v45, v48
    v_fmac_f32 v22, v46, v48
    v_fmac_f32 v23, v47, v48
    v_lshlrev_b32 v40, 16, v148
    v_and_b32 v41, 0xffff0000, v148
    v_lshlrev_b32 v42, 16, v149
    v_and_b32 v43, 0xffff0000, v149
    v_lshlrev_b32 v44, 16, v150
    v_and_b32 v45, 0xffff0000, v150
    v_lshlrev_b32 v46, 16, v151
    v_and_b32 v47, 0xffff0000, v151
    v_fmac_f32 v16, v40, v49
    v_fmac_f32 v17, v41, v49
    v_fmac_f32 v18, v42, v49
    v_fmac_f32 v19, v43, v49
    v_fmac_f32 v20, v44, v49
    v_fmac_f32 v21, v45, v49
    v_fmac_f32 v22, v46, v49
    v_fmac_f32 v23, v47, v49
    v_lshlrev_b32 v40, 16, v152
    v_and_b32 v41, 0xffff0000, v152
    v_lshlrev_b32 v42, 16, v153
    v_and_b32 v43, 0xffff0000, v153
    v_lshlrev_b32 v44, 16, v154
    v_and_b32 v45, 0xffff0000, v154
    v_lshlrev_b32 v46, 16, v155
    v_and_b32 v47, 0xffff0000, v155
    v_fmac_f32 v16, v40, v50
    v_fmac_f32 v17, v41, v50
    v_fmac_f32 v18, v42, v50
    v_fmac_f32 v19, v43, v50
    v_fmac_f32 v20, v44, v50
    v_fmac_f32 v21, v45, v50
    v_fmac_f32 v22, v46, v50
    v_fmac_f32 v23, v47, v50
    v_lshlrev_b32 v40, 16, v156
    v_and_b32 v41, 0xffff0000, v156
    v_lshlrev_b32 v42, 16, v157
    v_and_b32 v43, 0xffff0000, v157
    v_lshlrev_b32 v44, 16, v158
    v_and_b32 v45, 0xffff0000, v158
    v_lshlrev_b32 v46, 16, v159
    v_and_b32 v47, 0xffff0000, v159
    v_fmac_f32 v16, v40, v51
    v_fmac_f32 v17, v41, v51
    v_fmac_f32 v18, v42, v51
    v_fmac_f32 v19, v43, v51
    v_fmac_f32 v20, v44, v51
    v_fmac_f32 v21, v45, v51
    v_fmac_f32 v22, v46, v51
    v_fmac_f32 v23, v47, v51
    s_lshl_b32 s100, s73, 12
    s_mov_b32 s72, s73
    v_dot2_f32_bf16 v28, v96, v24, 0
    v_dot2_f32_bf16 v28, v97, v25, v28
    v_dot2_f32_bf16 v28, v98, v26, v28
    v_dot2_f32_bf16 v28, v99, v27, v28
    s_waitcnt vmcnt(3)
    buffer_load_dwordx4 v[96:99], v4, s[44:47], s100 offen offset:0 nt
    v_dot2_f32_bf16 v29, v100, v24, 0
    v_dot2_f32_bf16 v29, v101, v25, v29
    v_dot2_f32_bf16 v29, v102, v26, v29
    v_dot2_f32_bf16 v29, v103, v27, v29
    s_waitcnt vmcnt(3)
    buffer_load_dwordx4 v[100:103], v4, s[44:47], s100 offen offset:1024 nt
    v_dot2_f32_bf16 v30, v104, v24, 0
    v_dot2_f32_bf16 v30, v105, v25, v30
    v_dot2_f32_bf16 v30, v106, v26, v30
    v_dot2_f32_bf16 v30, v107, v27, v30
    s_waitcnt vmcnt(3)
    buffer_load_dwordx4 v[104:107], v4, s[44:47], s100 offen offset:2048 nt
    v_dot2_f32_bf16 v31, v108, v24, 0
    v_dot2_f32_bf16 v31, v109, v25, v31
    v_dot2_f32_bf16 v31, v110, v26, v31
    v_dot2_f32_bf16 v31, v111, v27, v31
    s_waitcnt vmcnt(3)
    buffer_load_dwordx4 v[108:111], v4, s[44:47], s100 offen offset:3072 nt
    s_nop 2
    v_add_f32_dpp v28, v28, v28 row_ror:8 row_mask:0xf bank_mask:0xf
    v_add_f32_dpp v29, v29, v29 row_ror:8 row_mask:0xf bank_mask:0xf
    v_add_f32_dpp v30, v30, v30 row_ror:8 row_mask:0xf bank_mask:0xf
    v_add_f32_dpp v31, v31, v31 row_ror:8 row_mask:0xf bank_mask:0xf
    v_add_f32_dpp v28, v28, v28 row_ror:4 row_mask:0xf bank_mask:0xf
    v_add_f32_dpp v29, v29, v29 row_ror:4 row_mask:0xf bank_mask:0xf
    v_add_f32_dpp v30, v30, v30 row_ror:4 row_mask:0xf bank_mask:0xf
    v_add_f32_dpp v31, v31, v31 row_ror:4 row_mask:0xf bank_mask:0xf
    v_add_f32_dpp v28, v28, v28 row_ror:2 row_mask:0xf bank_mask:0xf
    v_add_f32_dpp v29, v29, v29 row_ror:2 row_mask:0xf bank_mask:0xf
    v_add_f32_dpp v30, v30, v30 row_ror:2 row_mask:0xf bank_mask:0xf
    v_add_f32_dpp v31, v31, v31 row_ror:2 row_mask:0xf bank_mask:0xf
    v_add_f32_dpp v28, v28, v28 row_ror:1 row_mask:0xf bank_mask:0xf
    v_add_f32_dpp v29, v29, v29 row_ror:1 row_mask:0xf bank_mask:0xf
    v_add_f32_dpp v30, v30, v30 row_ror:1 row_mask:0xf bank_mask:0xf
    v_add_f32_dpp v31, v31, v31 row_ror:1 row_mask:0xf bank_mask:0xf
    v_max3_f32 v38, v36, v28, v29
    v_max3_f32 v38, v38, v30, v31
    v_sub_f32 v39, v36, v38
    v_mul_f32 v39, s70, v39
    v_exp_f32 v39, v39
    v_mul_f32 v56, s70, v38
    v_mov_b32 v36, v38
    v_fma_f32 v48, v28, s70, -v56
    v_fma_f32 v49, v29, s70, -v56
    v_fma_f32 v50, v30, s70, -v56
    v_fma_f32 v51, v31, s70, -v56
    v_exp_f32 v48, v48
    v_exp_f32 v49, v49
    v_exp_f32 v50, v50
    v_exp_f32 v51, v51
    v_mul_f32 v37, v37, v39
    v_mul_f32 v16, v16, v39
    v_mul_f32 v17, v17, v39
    v_mul_f32 v18, v18, v39
    v_mul_f32 v19, v19, v39
    v_mul_f32 v20, v20, v39
    v_mul_f32 v21, v21, v39
    v_mul_f32 v22, v22, v39
    v_mul_f32 v23, v23, v39
    v_add_f32 v37, v37, v48
    v_add_f32 v37, v37, v49
    v_add_f32 v37, v37, v50
    v_add_f32 v37, v37, v51
    v_lshlrev_b32 v40, 16, v112
    v_and_b32 v41, 0xffff0000, v112
    v_lshlrev_b32 v42, 16, v113
    v_and_b32 v43, 0xffff0000, v113
    v_lshlrev_b32 v44, 16, v114
    v_and_b32 v45, 0xffff0000, v114
    v_lshlrev_b32 v46, 16, v115
    v_and_b32 v47, 0xffff0000, v115
    s_waitcnt vmcnt(3)
    buffer_load_dwordx4 v[112:115], v4, s[48:51], s100 offen offset:0 nt
    v_fmac_f32 v16, v40, v48
    v_fmac_f32 v17, v41, v48
    v_fmac_f32 v18, v42, v48
    v_fmac_f32 v19, v43, v48
    v_fmac_f32 v20, v44, v48
    v_fmac_f32 v21, v45, v48
    v_fmac_f32 v22, v46, v48
    v_fmac_f32 v23, v47, v48
    v_lshlrev_b32 v40, 16, v116
    v_and_b32 v41, 0xffff0000, v116
    v_lshlrev_b32 v42, 16, v117
    v_and_b32 v43, 0xffff0000, v117
    v_lshlrev_b32 v44, 16, v118
    v_and_b32 v45, 0xffff0000, v118
    v_lshlrev_b32 v46, 16, v119
    v_and_b32 v47, 0xffff0000, v119
    s_waitcnt vmcnt(3)
    buffer_load_dwordx4 v[116:119], v4, s[48:51], s100 offen offset:1024 nt
    v_fmac_f32 v16, v40, v49
    v_fmac_f32 v17, v41, v49
    v_fmac_f32 v18, v42, v49
    v_fmac_f32 v19, v43, v49
    v_fmac_f32 v20, v44, v49
    v_fmac_f32 v21, v45, v49
    v_fmac_f32 v22, v46, v49
    v_fmac_f32 v23, v47, v49
    v_lshlrev_b32 v40, 16, v120
    v_and_b32 v41, 0xffff0000, v120
    v_lshlrev_b32 v42, 16, v121
    v_and_b32 v43, 0xffff0000, v121
    v_lshlrev_b32 v44, 16, v122
    v_and_b32 v45, 0xffff0000, v122
    v_lshlrev_b32 v46, 16, v123
    v_and_b32 v47, 0xffff0000, v123
    s_waitcnt vmcnt(3)
    buffer_load_dwordx4 v[120:123], v4, s[48:51], s100 offen offset:2048 nt
    v_fmac_f32 v16, v40, v50
    v_fmac_f32 v17, v41, v50
    v_fmac_f32 v18, v42, v50
    v_fmac_f32 v19, v43, v50
    v_fmac_f32 v20, v44, v50
    v_fmac_f32 v21, v45, v50
    v_fmac_f32 v22, v46, v50
    v_fmac_f32 v23, v47, v50
    v_lshlrev_b32 v40, 16, v124
    v_and_b32 v41, 0xffff0000, v124
    v_lshlrev_b32 v42, 16, v125
    v_and_b32 v43, 0xffff0000, v125
    v_lshlrev_b32 v44, 16, v126
    v_and_b32 v45, 0xffff0000, v126
    v_lshlrev_b32 v46, 16, v127
    v_and_b32 v47, 0xffff0000, v127
    s_waitcnt vmcnt(3)
    buffer_load_dwordx4 v[124:127], v4, s[48:51], s100 offen offset:3072 nt
    v_fmac_f32 v16, v40, v51
    v_fmac_f32 v17, v41, v51
    v_fmac_f32 v18, v42, v51
    v_fmac_f32 v19, v43, v51
    v_fmac_f32 v20, v44, v51
    v_fmac_f32 v21, v45, v51
    v_fmac_f32 v22, v46, v51
    v_fmac_f32 v23, v47, v51
    s_waitcnt vmcnt(8)
    s_mov_b64 s[94:95], exec
    s_mov_b64 exec, 1
    ds_add_rtn_u32 v59, v61, v5
    s_mov_b64 exec, s[94:95]
    s_waitcnt lgkmcnt(0)
    s_mov_b64 exec, 1
    v_lshlrev_b32 v59, 2, v59
    s_mov_b32 s92, 0
Lpop_23:
    ds_read_b32 v62, v59 offset:1024
    s_waitcnt lgkmcnt(0)
    v_readfirstlane_b32 s73, v62
    s_nop 3
    s_cmp_lg_u32 s73, -1
    s_cbranch_scc1 Lpopd_24
    s_sleep 1
    s_add_u32 s92, s92, 1
    s_cmp_lt_u32 s92, 400000
    s_cbranch_scc1 Lpop_23
Lpopd_24:
    s_mov_b64 exec, -1
    s_waitcnt vmcnt(4)
    v_dot2_f32_bf16 v28, v160, v24, 0
    v_dot2_f32_bf16 v28, v161, v25, v28
    v_dot2_f32_bf16 v28, v162, v26, v28
    v_dot2_f32_bf16 v28, v163, v27, v28
    v_dot2_f32_bf16 v29, v164, v24, 0
    v_dot2_f32_bf16 v29, v165, v25, v29
    v_dot2_f32_bf16 v29, v166, v26, v29
    v_dot2_f32_bf16 v29, v167, v27, v29
    v_dot2_f32_bf16 v30, v168, v24, 0
    v_dot2_f32_bf16 v30, v169, v25, v30
    v_dot2_f32_bf16 v30, v170, v26, v30
    v_dot2_f32_bf16 v30, v171, v27, v30
    v_dot2_f32_bf16 v31, v172, v24, 0
    v_dot2_f32_bf16 v31, v173, v25, v31
    v_dot2_f32_bf16 v31, v174, v26, v31
    v_dot2_f32_bf16 v31, v175, v27, v31
    s_nop 2
    v_add_f32_dpp v28, v28, v28 row_ror:8 row_mask:0xf bank_mask:0xf
    v_add_f32_dpp v29, v29, v29 row_ror:8 row_mask:0xf bank_mask:0xf
    v_add_f32_dpp v30, v30, v30 row_ror:8 row_mask:0xf bank_mask:0xf
    v_add_f32_dpp v31, v31, v31 row_ror:8 row_mask:0xf bank_mask:0xf
    v_add_f32_dpp v28, v28, v28 row_ror:4 row_mask:0xf bank_mask:0xf
    v_add_f32_dpp v29, v29, v29 row_ror:4 row_mask:0xf bank_mask:0xf
    v_add_f32_dpp v30, v30, v30 row_ror:4 row_mask:0xf bank_mask:0xf
    v_add_f32_dpp v31, v31, v31 row_ror:4 row_mask:0xf bank_mask:0xf
    v_add_f32_dpp v28, v28, v28 row_ror:2 row_mask:0xf bank_mask:0xf
    v_add_f32_dpp v29, v29, v29 row_ror:2 row_mask:0xf bank_mask:0xf
    v_add_f32_dpp v30, v30, v30 row_ror:2 row_mask:0xf bank_mask:0xf
    v_add_f32_dpp v31, v31, v31 row_ror:2 row_mask:0xf bank_mask:0xf
    v_add_f32_dpp v28, v28, v28 row_ror:1 row_mask:0xf bank_mask:0xf
    v_add_f32_dpp v29, v29, v29 row_ror:1 row_mask:0xf bank_mask:0xf
    v_add_f32_dpp v30, v30, v30 row_ror:1 row_mask:0xf bank_mask:0xf
    v_add_f32_dpp v31, v31, v31 row_ror:1 row_mask:0xf bank_mask:0xf
    v_max3_f32 v38, v36, v28, v29
    v_max3_f32 v38, v38, v30, v31
    v_sub_f32 v39, v36, v38
    v_mul_f32 v39, s70, v39
    v_exp_f32 v39, v39
    v_mul_f32 v56, s70, v38
    v_mov_b32 v36, v38
    v_fma_f32 v48, v28, s70, -v56
    v_fma_f32 v49, v29, s70, -v56
    v_fma_f32 v50, v30, s70, -v56
    v_fma_f32 v51, v31, s70, -v56
    v_exp_f32 v48, v48
    v_exp_f32 v49, v49
    v_exp_f32 v50, v50
    v_exp_f32 v51, v51
    v_mul_f32 v37, v37, v39
    v_mul_f32 v16, v16, v39
    v_mul_f32 v17, v17, v39
    v_mul_f32 v18, v18, v39
    v_mul_f32 v19, v19, v39
    v_mul_f32 v20, v20, v39
    v_mul_f32 v21, v21, v39
    v_mul_f32 v22, v22, v39
    v_mul_f32 v23, v23, v39
    v_add_f32 v37, v37, v48
    v_add_f32 v37, v37, v49
    v_add_f32 v37, v37, v50
    v_add_f32 v37, v37, v51
    v_lshlrev_b32 v40, 16, v176
    v_and_b32 v41, 0xffff0000, v176
    v_lshlrev_b32 v42, 16, v177
    v_and_b32 v43, 0xffff0000, v177
    v_lshlrev_b32 v44, 16, v178
    v_and_b32 v45, 0xffff0000, v178
    v_lshlrev_b32 v46, 16, v179
    v_and_b32 v47, 0xffff0000, v179
    v_fmac_f32 v16, v40, v48
    v_fmac_f32 v17, v41, v48
    v_fmac_f32 v18, v42, v48
    v_fmac_f32 v19, v43, v48
    v_fmac_f32 v20, v44, v48
    v_fmac_f32 v21, v45, v48
    v_fmac_f32 v22, v46, v48
    v_fmac_f32 v23, v47, v48
    v_lshlrev_b32 v40, 16, v180
    v_and_b32 v41, 0xffff0000, v180
    v_lshlrev_b32 v42, 16, v181
    v_and_b32 v43, 0xffff0000, v181
    v_lshlrev_b32 v44, 16, v182
    v_and_b32 v45, 0xffff0000, v182
    v_lshlrev_b32 v46, 16, v183
    v_and_b32 v47, 0xffff0000, v183
    v_fmac_f32 v16, v40, v49
    v_fmac_f32 v17, v41, v49
    v_fmac_f32 v18, v42, v49
    v_fmac_f32 v19, v43, v49
    v_fmac_f32 v20, v44, v49
    v_fmac_f32 v21, v45, v49
    v_fmac_f32 v22, v46, v49
    v_fmac_f32 v23, v47, v49
    v_lshlrev_b32 v40, 16, v184
    v_and_b32 v41, 0xffff0000, v184
    v_lshlrev_b32 v42, 16, v185
    v_and_b32 v43, 0xffff0000, v185
    v_lshlrev_b32 v44, 16, v186
    v_and_b32 v45, 0xffff0000, v186
    v_lshlrev_b32 v46, 16, v187
    v_and_b32 v47, 0xffff0000, v187
    v_fmac_f32 v16, v40, v50
    v_fmac_f32 v17, v41, v50
    v_fmac_f32 v18, v42, v50
    v_fmac_f32 v19, v43, v50
    v_fmac_f32 v20, v44, v50
    v_fmac_f32 v21, v45, v50
    v_fmac_f32 v22, v46, v50
    v_fmac_f32 v23, v47, v50
    v_lshlrev_b32 v40, 16, v188
    v_and_b32 v41, 0xffff0000, v188
    v_lshlrev_b32 v42, 16, v189
    v_and_b32 v43, 0xffff0000, v189
    v_lshlrev_b32 v44, 16, v190
    v_and_b32 v45, 0xffff0000, v190
    v_lshlrev_b32 v46, 16, v191
    v_and_b32 v47, 0xffff0000, v191
    v_fmac_f32 v16, v40, v51
    v_fmac_f32 v17, v41, v51
    v_fmac_f32 v18, v42, v51
    v_fmac_f32 v19, v43, v51
    v_fmac_f32 v20, v44, v51
    v_fmac_f32 v21, v45, v51
    v_fmac_f32 v22, v46, v51
    v_fmac_f32 v23, v47, v51
LBloop_17:
    s_cmp_ge_u32 s73, s83
    s_cbranch_scc1 LBloop2_19
    s_lshl_b32 s100, s73, 12
    s_mov_b32 s71, s73
    v_dot2_f32_bf16 v28, v64, v24, 0
    v_dot2_f32_bf16 v28, v65, v25, v28
    v_dot2_f32_bf16 v28, v66, v26, v28
    v_dot2_f32_bf16 v28, v67, v27, v28
    s_waitcnt vmcnt(3)
    buffer_load_dwordx4 v[64:67], v4, s[44:47], s100 offen offset:0 nt
    v_dot2_f32_bf16 v29, v68, v24, 0
    v_dot2_f32_bf16 v29, v69, v25, v29
    v_dot2_f32_bf16 v29, v70, v26, v29
    v_dot2_f32_bf16 v29, v71, v27, v29
    s_waitcnt vmcnt(3)
    buffer_load_dwordx4 v[68:71], v4, s[44:47], s100 offen offset:1024 nt
    v_dot2_f32_bf16 v30, v72, v24, 0
    v_dot2_f32_bf16 v30, v73, v25, v30
    v_dot2_f32_bf16 v30, v74, v26, v30
    v_dot2_f32_bf16 v30, v75, v27, v30
    s_waitcnt vmcnt(3)
    buffer_load_dwordx4 v[72:75], v4, s[44:47], s100 offen offset:2048 nt
    v_dot2_f32_bf16 v31, v76, v24, 0
    v_dot2_f32_bf16 v31, v77, v25, v31
    v_dot2_f32_bf16 v31, v78, v26, v31
    v_dot2_f32_bf16 v31, v79, v27, v31
    s_waitcnt vmcnt(3)
    buffer_load_dwordx4 v[76:79], v4, s[44:47], s100 offen offset:3072 nt
    s_nop 2
    v_add_f32_dpp v28, v28, v28 row_ror:8 row_mask:0xf bank_mask:0xf
    v_add_f32_dpp v29, v29, v29 row_ror:8 row_mask:0xf bank_mask:0xf
    v_add_f32_dpp v30, v30, v30 row_ror:8 row_mask:0xf bank_mask:0xf
    v_add_f32_dpp v31, v31, v31 row_ror:8 row_mask:0xf bank_mask:0xf
    v_add_f32_dpp v28, v28, v28 row_ror:4 row_mask:0xf bank_mask:0xf
    v_add_f32_dpp v29, v29, v29 row_ror:4 row_mask:0xf bank_mask:0xf
    v_add_f32_dpp v30, v30, v30 row_ror:4 row_mask:0xf bank_mask:0xf
    v_add_f32_dpp v31, v31, v31 row_ror:4 row_mask:0xf bank_mask:0xf
    v_add_f32_dpp v28, v28, v28 row_ror:2 row_mask:0xf bank_mask:0xf
    v_add_f32_dpp v29, v29, v29 row_ror:2 row_mask:0xf bank_mask:0xf
    v_add_f32_dpp v30, v30, v30 row_ror:2 row_mask:0xf bank_mask:0xf
    v_add_f32_dpp v31, v31, v31 row_ror:2 row_mask:0xf bank_mask:0xf
    v_add_f32_dpp v28, v28, v28 row_ror:1 row_mask:0xf bank_mask:0xf
    v_add_f32_dpp v29, v29, v29 row_ror:1 row_mask:0xf bank_mask:0xf
    v_add_f32_dpp v30, v30, v30 row_ror:1 row_mask:0xf bank_mask:0xf
    v_add_f32_dpp v31, v31, v31 row_ror:1 row_mask:0xf bank_mask:0xf
    v_max3_f32 v38, v36, v28, v29
    v_max3_f32 v38, v38, v30, v31
    v_sub_f32 v39, v36, v38
    v_mul_f32 v39, s70, v39
    v_exp_f32 v39, v39
    v_mul_f32 v56, s70, v38
    v_mov_b32 v36, v38
    v_fma_f32 v48, v28, s70, -v56
    v_fma_f32 v49, v29, s70, -v56
    v_fma_f32 v50, v30, s70, -v56
    v_fma_f32 v51, v31, s70, -v56
    v_exp_f32 v48, v48
    v_exp_f32 v49, v49
    v_exp_f32 v50, v50
    v_exp_f32 v51, v51
    v_mul_f32 v37, v37, v39
    v_mul_f32 v16, v16, v39
    v_mul_f32 v17, v17, v39
    v_mul_f32 v18, v18, v39
    v_mul_f32 v19, v19, v39
    v_mul_f32 v20, v20, v39
    v_mul_f32 v21, v21, v39
    v_mul_f32 v22, v22, v39
    v_mul_f32 v23, v23, v39
    v_add_f32 v37, v37, v48
    v_add_f32 v37, v37, v49
    v_add_f32 v37, v37, v50
    v_add_f32 v37, v37, v51
    v_lshlrev_b32 v40, 16, v80
    v_and_b32 v41, 0xffff0000, v80
    v_lshlrev_b32 v42, 16, v81
    v_and_b32 v43, 0xffff0000, v81
    v_lshlrev_b32 v44, 16, v82
    v_and_b32 v45, 0xffff0000, v82
    v_lshlrev_b32 v46, 16, v83
    v_and_b32 v47, 0xffff0000, v83
    s_waitcnt vmcnt(3)
    buffer_load_dwordx4 v[80:83], v4, s[48:51], s100 offen offset:0 nt
    v_fmac_f32 v16, v40, v48
    v_fmac_f32 v17, v41, v48
    v_fmac_f32 v18, v42, v48
    v_fmac_f32 v19, v43, v48
    v_fmac_f32 v20, v44, v48
    v_fmac_f32 v21, v45, v48
    v_fmac_f32 v22, v46, v48
    v_fmac_f32 v23, v47, v48
    v_lshlrev_b32 v40, 16, v84
    v_and_b32 v41, 0xffff0000, v84
    v_lshlrev_b32 v42, 16, v85
    v_and_b32 v43, 0xffff0000, v85
    v_lshlrev_b32 v44, 16, v86
    v_and_b32 v45, 0xffff0000, v86
    v_lshlrev_b32 v46, 16, v87
    v_and_b32 v47, 0xffff0000, v87
    s_waitcnt vmcnt(3)
    buffer_load_dwordx4 v[84:87], v4, s[48:51], s100 offen offset:1024 nt
    v_fmac_f32 v16, v40, v49
    v_fmac_f32 v17, v41, v49
    v_fmac_f32 v18, v42, v49
    v_fmac_f32 v19, v43, v49
    v_fmac_f32 v20, v44, v49
    v_fmac_f32 v21, v45, v49
    v_fmac_f32 v22, v46, v49
    v_fmac_f32 v23, v47, v49
    v_lshlrev_b32 v40, 16, v88
    v_and_b32 v41, 0xffff0000, v88
    v_lshlrev_b32 v42, 16, v89
    v_and_b32 v43, 0xffff0000, v89
    v_lshlrev_b32 v44, 16, v90
    v_and_b32 v45, 0xffff0000, v90
    v_lshlrev_b32 v46, 16, v91
    v_and_b32 v47, 0xffff0000, v91
    s_waitcnt vmcnt(3)
    buffer_load_dwordx4 v[88:91], v4, s[48:51], s100 offen offset:2048 nt
    v_fmac_f32 v16, v40, v50
    v_fmac_f32 v17, v41, v50
    v_fmac_f32 v18, v42, v50
    v_fmac_f32 v19, v43, v50
    v_fmac_f32 v20, v44, v50
    v_fmac_f32 v21, v45, v50
    v_fmac_f32 v22, v46, v50
    v_fmac_f32 v23, v47, v50
    v_lshlrev_b32 v40, 16, v92
    v_and_b32 v41, 0xffff0000, v92
    v_lshlrev_b32 v42, 16, v93
    v_and_b32 v43, 0xffff0000, v93
    v_lshlrev_b32 v44, 16, v94
    v_and_b32 v45, 0xffff0000, v94
    v_lshlrev_b32 v46, 16, v95
    v_and_b32 v47, 0xffff0000, v95
    s_waitcnt vmcnt(3)
    buffer_load_dwordx4 v[92:95], v4, s[48:51], s100 offen offset:3072 nt
    v_fmac_f32 v16, v40, v51
    v_fmac_f32 v17, v41, v51
    v_fmac_f32 v18, v42, v51
    v_fmac_f32 v19, v43, v51
    v_fmac_f32 v20, v44, v51
    v_fmac_f32 v21, v45, v51
    v_fmac_f32 v22, v46, v51
    v_fmac_f32 v23, v47, v51
    s_waitcnt vmcnt(8)
    s_mov_b64 s[94:95], exec
    s_mov_b64 exec, 1
    ds_add_rtn_u32 v59, v61, v5
    s_mov_b64 exec, s[94:95]
    s_waitcnt lgkmcnt(0)
    s_mov_b64 exec, 1
    v_lshlrev_b32 v59, 2, v59
    s_mov_b32 s92, 0
Lpop_25:
    ds_read_b32 v62, v59 offset:1024
    s_waitcnt lgkmcnt(0)
    v_readfirstlane_b32 s73, v62
    s_nop 3
    s_cmp_lg_u32 s73, -1
    s_cbranch_scc1 Lpopd_26
    s_sleep 1
    s_add_u32 s92, s92, 1
    s_cmp_lt_u32 s92, 400000
    s_cbranch_scc1 Lpop_25
Lpopd_26:
    s_mov_b64 exec, -1
    s_cmp_ge_u32 s73, s83
    s_cbranch_scc1 LBloop2b_20
    s_lshl_b32 s100, s73, 12
    s_mov_b32 s72, s73
    v_dot2_f32_bf16 v28, v96, v24, 0
    v_dot2_f32_bf16 v28, v97, v25, v28
    v_dot2_f32_bf16 v28, v98, v26, v28
    v_dot2_f32_bf16 v28, v99, v27, v28
    s_waitcnt vmcnt(3)
    buffer_load_dwordx4 v[96:99], v4, s[44:47], s100 offen offset:0 nt
    v_dot2_f32_bf16 v29, v100, v24, 0
    v_dot2_f32_bf16 v29, v101, v25, v29
    v_dot2_f32_bf16 v29, v102, v26, v29
    v_dot2_f32_bf16 v29, v103, v27, v29
    s_waitcnt vmcnt(3)
    buffer_load_dwordx4 v[100:103], v4, s[44:47], s100 offen offset:1024 nt
    v_dot2_f32_bf16 v30, v104, v24, 0
    v_dot2_f32_bf16 v30, v105, v25, v30
    v_dot2_f32_bf16 v30, v106, v26, v30
    v_dot2_f32_bf16 v30, v107, v27, v30
    s_waitcnt vmcnt(3)
    buffer_load_dwordx4 v[104:107], v4, s[44:47], s100 offen offset:2048 nt
    v_dot2_f32_bf16 v31, v108, v24, 0
    v_dot2_f32_bf16 v31, v109, v25, v31
    v_dot2_f32_bf16 v31, v110, v26, v31
    v_dot2_f32_bf16 v31, v111, v27, v31
    s_waitcnt vmcnt(3)
    buffer_load_dwordx4 v[108:111], v4, s[44:47], s100 offen offset:3072 nt
    s_nop 2
    v_add_f32_dpp v28, v28, v28 row_ror:8 row_mask:0xf bank_mask:0xf
    v_add_f32_dpp v29, v29, v29 row_ror:8 row_mask:0xf bank_mask:0xf
    v_add_f32_dpp v30, v30, v30 row_ror:8 row_mask:0xf bank_mask:0xf
    v_add_f32_dpp v31, v31, v31 row_ror:8 row_mask:0xf bank_mask:0xf
    v_add_f32_dpp v28, v28, v28 row_ror:4 row_mask:0xf bank_mask:0xf
    v_add_f32_dpp v29, v29, v29 row_ror:4 row_mask:0xf bank_mask:0xf
    v_add_f32_dpp v30, v30, v30 row_ror:4 row_mask:0xf bank_mask:0xf
    v_add_f32_dpp v31, v31, v31 row_ror:4 row_mask:0xf bank_mask:0xf
    v_add_f32_dpp v28, v28, v28 row_ror:2 row_mask:0xf bank_mask:0xf
    v_add_f32_dpp v29, v29, v29 row_ror:2 row_mask:0xf bank_mask:0xf
    v_add_f32_dpp v30, v30, v30 row_ror:2 row_mask:0xf bank_mask:0xf
    v_add_f32_dpp v31, v31, v31 row_ror:2 row_mask:0xf bank_mask:0xf
    v_add_f32_dpp v28, v28, v28 row_ror:1 row_mask:0xf bank_mask:0xf
    v_add_f32_dpp v29, v29, v29 row_ror:1 row_mask:0xf bank_mask:0xf
    v_add_f32_dpp v30, v30, v30 row_ror:1 row_mask:0xf bank_mask:0xf
    v_add_f32_dpp v31, v31, v31 row_ror:1 row_mask:0xf bank_mask:0xf
    v_max3_f32 v38, v36, v28, v29
    v_max3_f32 v38, v38, v30, v31
    v_sub_f32 v39, v36, v38
    v_mul_f32 v39, s70, v39
    v_exp_f32 v39, v39
    v_mul_f32 v56, s70, v38
    v_mov_b32 v36, v38
    v_fma_f32 v48, v28, s70, -v56
    v_fma_f32 v49, v29, s70, -v56
    v_fma_f32 v50, v30, s70, -v56
    v_fma_f32 v51, v31, s70, -v56
    v_exp_f32 v48, v48
    v_exp_f32 v49, v49
    v_exp_f32 v50, v50
    v_exp_f32 v51, v51
    v_mul_f32 v37, v37, v39
    v_mul_f32 v16, v16, v39
    v_mul_f32 v17, v17, v39
    v_mul_f32 v18, v18, v39
    v_mul_f32 v19, v19, v39
    v_mul_f32 v20, v20, v39
    v_mul_f32 v21, v21, v39
    v_mul_f32 v22, v22, v39
    v_mul_f32 v23, v23, v39
    v_add_f32 v37, v37, v48
    v_add_f32 v37, v37, v49
    v_add_f32 v37, v37, v50
    v_add_f32 v37, v37, v51
    v_lshlrev_b32 v40, 16, v112
    v_and_b32 v41, 0xffff0000, v112
    v_lshlrev_b32 v42, 16, v113
    v_and_b32 v43, 0xffff0000, v113
    v_lshlrev_b32 v44, 16, v114
    v_and_b32 v45, 0xffff0000, v114
    v_lshlrev_b32 v46, 16, v115
    v_and_b32 v47, 0xffff0000, v115
    s_waitcnt vmcnt(3)
    buffer_load_dwordx4 v[112:115], v4, s[48:51], s100 offen offset:0 nt
    v_fmac_f32 v16, v40, v48
    v_fmac_f32 v17, v41, v48
    v_fmac_f32 v18, v42, v48
    v_fmac_f32 v19, v43, v48
    v_fmac_f32 v20, v44, v48
    v_fmac_f32 v21, v45, v48
    v_fmac_f32 v22, v46, v48
    v_fmac_f32 v23, v47, v48
    v_lshlrev_b32 v40, 16, v116
    v_and_b32 v41, 0xffff0000, v116
    v_lshlrev_b32 v42, 16, v117
    v_and_b32 v43, 0xffff0000, v117
    v_lshlrev_b32 v44, 16, v118
    v_and_b32 v45, 0xffff0000, v118
    v_lshlrev_b32 v46, 16, v119
    v_and_b32 v47, 0xffff0000, v119
    s_waitcnt vmcnt(3)
    buffer_load_dwordx4 v[116:119], v4, s[48:51], s100 offen offset:1024 nt
    v_fmac_f32 v16, v40, v49
    v_fmac_f32 v17, v41, v49
    v_fmac_f32 v18, v42, v49
    v_fmac_f32 v19, v43, v49
    v_fmac_f32 v20, v44, v49
    v_fmac_f32 v21, v45, v49
    v_fmac_f32 v22, v46, v49
    v_fmac_f32 v23, v47, v49
    v_lshlrev_b32 v40, 16, v120
    v_and_b32 v41, 0xffff0000, v120
    v_lshlrev_b32 v42, 16, v121
    v_and_b32 v43, 0xffff0000, v121
    v_lshlrev_b32 v44, 16, v122
    v_and_b32 v45, 0xffff0000, v122
    v_lshlrev_b32 v46, 16, v123
    v_and_b32 v47, 0xffff0000, v123
    s_waitcnt vmcnt(3)
    buffer_load_dwordx4 v[120:123], v4, s[48:51], s100 offen offset:2048 nt
    v_fmac_f32 v16, v40, v50
    v_fmac_f32 v17, v41, v50
    v_fmac_f32 v18, v42, v50
    v_fmac_f32 v19, v43, v50
    v_fmac_f32 v20, v44, v50
    v_fmac_f32 v21, v45, v50
    v_fmac_f32 v22, v46, v50
    v_fmac_f32 v23, v47, v50
    v_lshlrev_b32 v40, 16, v124
    v_and_b32 v41, 0xffff0000, v124
    v_lshlrev_b32 v42, 16, v125
    v_and_b32 v43, 0xffff0000, v125
    v_lshlrev_b32 v44, 16, v126
    v_and_b32 v45, 0xffff0000, v126
    v_lshlrev_b32 v46, 16, v127
    v_and_b32 v47, 0xffff0000, v127
    s_waitcnt vmcnt(3)
    buffer_load_dwordx4 v[124:127], v4, s[48:51], s100 offen offset:3072 nt
    v_fmac_f32 v16, v40, v51
    v_fmac_f32 v17, v41, v51
    v_fmac_f32 v18, v42, v51
    v_fmac_f32 v19, v43, v51
    v_fmac_f32 v20, v44, v51
    v_fmac_f32 v21, v45, v51
    v_fmac_f32 v22, v46, v51
    v_fmac_f32 v23, v47, v51
    s_waitcnt vmcnt(8)
    s_mov_b64 s[94:95], exec
    s_mov_b64 exec, 1
    ds_add_rtn_u32 v59, v61, v5
    s_mov_b64 exec, s[94:95]
    s_waitcnt lgkmcnt(0)
    s_mov_b64 exec, 1
    v_lshlrev_b32 v59, 2, v59
    s_mov_b32 s92, 0
Lpop_27:
    ds_read_b32 v62, v59 offset:1024
    s_waitcnt lgkmcnt(0)
    v_readfirstlane_b32 s73, v62
    s_nop 3
    s_cmp_lg_u32 s73, -1
    s_cbranch_scc1 Lpopd_28
    s_sleep 1
    s_add_u32 s92, s92, 1
    s_cmp_lt_u32 s92, 400000
    s_cbranch_scc1 Lpop_27
Lpopd_28:
    s_mov_b64 exec, -1
    s_branch LBloop_17
LBloop2_19:
    s_cmp_ge_u32 s73, s74
    s_cbranch_scc1 LBtail0_29
    s_lshl_b32 s100, s73, 12
    s_mov_b32 s71, s73
    v_dot2_f32_bf16 v28, v64, v24, 0
    v_dot2_f32_bf16 v28, v65, v25, v28
    v_dot2_f32_bf16 v28, v66, v26, v28
    v_dot2_f32_bf16 v28, v67, v27, v28
    s_waitcnt vmcnt(13)
    buffer_load_dwordx4 v[64:67], v4, s[44:47], s100 offen offset:0 nt
    v_dot2_f32_bf16 v29, v68, v24, 0
    v_dot2_f32_bf16 v29, v69, v25, v29
    v_dot2_f32_bf16 v29, v70, v26, v29
    v_dot2_f32_bf16 v29, v71, v27, v29
    s_waitcnt vmcnt(13)
    buffer_load_dwordx4 v[68:71], v4, s[44:47], s100 offen offset:1024 nt
    v_dot2_f32_bf16 v30, v72, v24, 0
    v_dot2_f32_bf16 v30, v73, v25, v30
    v_dot2_f32_bf16 v30, v74, v26, v30
    v_dot2_f32_bf16 v30, v75, v27, v30
    s_waitcnt vmcnt(13)
    buffer_load_dwordx4 v[72:75], v4, s[44:47], s100 offen offset:2048 nt
    v_dot2_f32_bf16 v31, v76, v24, 0
    v_dot2_f32_bf16 v31, v77, v25, v31
    v_dot2_f32_bf16 v31, v78, v26, v31
    v_dot2_f32_bf16 v31, v79, v27, v31
    s_waitcnt vmcnt(13)
    buffer_load_dwordx4 v[76:79], v4, s[44:47], s100 offen offset:3072 nt
    s_nop 2
    v_add_f32_dpp v28, v28, v28 row_ror:8 row_mask:0xf bank_mask:0xf
    v_add_f32_dpp v29, v29, v29 row_ror:8 row_mask:0xf bank_mask:0xf
    v_add_f32_dpp v30, v30, v30 row_ror:8 row_mask:0xf bank_mask:0xf
    v_add_f32_dpp v31, v31, v31 row_ror:8 row_mask:0xf bank_mask:0xf
    v_add_f32_dpp v28, v28, v28 row_ror:4 row_mask:0xf bank_mask:0xf
    v_add_f32_dpp v29, v29, v29 row_ror:4 row_mask:0xf bank_mask:0xf
    v_add_f32_dpp v30, v30, v30 row_ror:4 row_mask:0xf bank_mask:0xf
    v_add_f32_dpp v31, v31, v31 row_ror:4 row_mask:0xf bank_mask:0xf
    v_add_f32_dpp v28, v28, v28 row_ror:2 row_mask:0xf bank_mask:0xf
    v_add_f32_dpp v29, v29, v29 row_ror:2 row_mask:0xf bank_mask:0xf
    v_add_f32_dpp v30, v30, v30 row_ror:2 row_mask:0xf bank_mask:0xf
    v_add_f32_dpp v31, v31, v31 row_ror:2 row_mask:0xf bank_mask:0xf
    v_add_f32_dpp v28, v28, v28 row_ror:1 row_mask:0xf bank_mask:0xf
    v_add_f32_dpp v29, v29, v29 row_ror:1 row_mask:0xf bank_mask:0xf
    v_add_f32_dpp v30, v30, v30 row_ror:1 row_mask:0xf bank_mask:0xf
    v_add_f32_dpp v31, v31, v31 row_ror:1 row_mask:0xf bank_mask:0xf
    v_max3_f32 v38, v36, v28, v29
    v_max3_f32 v38, v38, v30, v31
    v_sub_f32 v39, v36, v38
    v_mul_f32 v39, s70, v39
    v_exp_f32 v39, v39
    v_mul_f32 v56, s70, v38
    v_mov_b32 v36, v38
    v_fma_f32 v48, v28, s70, -v56
    v_fma_f32 v49, v29, s70, -v56
    v_fma_f32 v50, v30, s70, -v56
    v_fma_f32 v51, v31, s70, -v56
    v_exp_f32 v48, v48
    v_exp_f32 v49, v49
    v_exp_f32 v50, v50
    v_exp_f32 v51, v51
    v_mul_f32 v37, v37, v39
    v_mul_f32 v16, v16, v39
    v_mul_f32 v17, v17, v39
    v_mul_f32 v18, v18, v39
    v_mul_f32 v19, v19, v39
    v_mul_f32 v20, v20, v39
    v_mul_f32 v21, v21, v39
    v_mul_f32 v22, v22, v39
    v_mul_f32 v23, v23, v39
    v_add_f32 v37, v37, v48
    v_add_f32 v37, v37, v49
    v_add_f32 v37, v37, v50
    v_add_f32 v37, v37, v51
    v_lshlrev_b32 v40, 16, v80
    v_and_b32 v41, 0xffff0000, v80
    v_lshlrev_b32 v42, 16, v81
    v_and_b32 v43, 0xffff0000, v81
    v_lshlrev_b32 v44, 16, v82
    v_and_b32 v45, 0xffff0000, v82
    v_lshlrev_b32 v46, 16, v83
    v_and_b32 v47, 0xffff0000, v83
    s_waitcnt vmcnt(13)
    buffer_load_dwordx4 v[80:83], v4, s[48:51], s100 offen offset:0 nt
    v_fmac_f32 v16, v40, v48
    v_fmac_f32 v17, v41, v48
    v_fmac_f32 v18, v42, v48
    v_fmac_f32 v19, v43, v48
    v_fmac_f32 v20, v44, v48
    v_fmac_f32 v21, v45, v48
    v_fmac_f32 v22, v46, v48
    v_fmac_f32 v23, v47, v48
    v_lshlrev_b32 v40, 16, v84
    v_and_b32 v41, 0xffff0000, v84
    v_lshlrev_b32 v42, 16, v85
    v_and_b32 v43, 0xffff0000, v85
    v_lshlrev_b32 v44, 16, v86
    v_and_b32 v45, 0xffff0000, v86
    v_lshlrev_b32 v46, 16, v87
    v_and_b32 v47, 0xffff0000, v87
    s_waitcnt vmcnt(13)
    buffer_load_dwordx4 v[84:87], v4, s[48:51], s100 offen offset:1024 nt
    v_fmac_f32 v16, v40, v49
    v_fmac_f32 v17, v41, v49
    v_fmac_f32 v18, v42, v49
    v_fmac_f32 v19, v43, v49
    v_fmac_f32 v20, v44, v49
    v_fmac_f32 v21, v45, v49
    v_fmac_f32 v22, v46, v49
    v_fmac_f32 v23, v47, v49
    v_lshlrev_b32 v40, 16, v88
    v_and_b32 v41, 0xffff0000, v88
    v_lshlrev_b32 v42, 16, v89
    v_and_b32 v43, 0xffff0000, v89
    v_lshlrev_b32 v44, 16, v90
    v_and_b32 v45, 0xffff0000, v90
    v_lshlrev_b32 v46, 16, v91
    v_and_b32 v47, 0xffff0000, v91
    s_waitcnt vmcnt(13)
    buffer_load_dwordx4 v[88:91], v4, s[48:51], s100 offen offset:2048 nt
    v_fmac_f32 v16, v40, v50
    v_fmac_f32 v17, v41, v50
    v_fmac_f32 v18, v42, v50
    v_fmac_f32 v19, v43, v50
    v_fmac_f32 v20, v44, v50
    v_fmac_f32 v21, v45, v50
    v_fmac_f32 v22, v46, v50
    v_fmac_f32 v23, v47, v50
    v_lshlrev_b32 v40, 16, v92
    v_and_b32 v41, 0xffff0000, v92
    v_lshlrev_b32 v42, 16, v93
    v_and_b32 v43, 0xffff0000, v93
    v_lshlrev_b32 v44, 16, v94
    v_and_b32 v45, 0xffff0000, v94
    v_lshlrev_b32 v46, 16, v95
    v_and_b32 v47, 0xffff0000, v95
    s_waitcnt vmcnt(13)
    buffer_load_dwordx4 v[92:95], v4, s[48:51], s100 offen offset:3072 nt
    v_fmac_f32 v16, v40, v51
    v_fmac_f32 v17, v41, v51
    v_fmac_f32 v18, v42, v51
    v_fmac_f32 v19, v43, v51
    v_fmac_f32 v20, v44, v51
    v_fmac_f32 v21, v45, v51
    v_fmac_f32 v22, v46, v51
    v_fmac_f32 v23, v47, v51
    s_waitcnt vmcnt(8)
    s_mov_b64 s[94:95], exec
    s_mov_b64 exec, 1
    ds_add_rtn_u32 v59, v61, v5
    s_mov_b64 exec, s[94:95]
    s_waitcnt lgkmcnt(0)
    s_mov_b64 exec, 1
    v_lshlrev_b32 v59, 2, v59
    s_mov_b32 s92, 0
Lpop_31:
    ds_read_b32 v62, v59 offset:1024
    s_waitcnt lgkmcnt(0)
    v_readfirstlane_b32 s73, v62
    s_nop 3
    s_cmp_lg_u32 s73, -1
    s_cbranch_scc1 Lpopd_32
    s_sleep 1
    s_add_u32 s92, s92, 1
    s_cmp_lt_u32 s92, 400000
    s_cbranch_scc1 Lpop_31
Lpopd_32:
    s_mov_b64 exec, -1
LBloop2b_20:
    s_cmp_ge_u32 s73, s74
    s_cbranch_scc1 LBtail1_30
    s_lshl_b32 s100, s73, 12
    s_mov_b32 s72, s73
    v_dot2_f32_bf16 v28, v96, v24, 0
    v_dot2_f32_bf16 v28, v97, v25, v28
    v_dot2_f32_bf16 v28, v98, v26, v28
    v_dot2_f32_bf16 v28, v99, v27, v28
    s_waitcnt vmcnt(13)
    buffer_load_dwordx4 v[96:99], v4, s[44:47], s100 offen offset:0 nt
    v_dot2_f32_bf16 v29, v100, v24, 0
    v_dot2_f32_bf16 v29, v101, v25, v29
    v_dot2_f32_bf16 v29, v102, v26, v29
    v_dot2_f32_bf16 v29, v103, v27, v29
    s_waitcnt vmcnt(13)
    buffer_load_dwordx4 v[100:103], v4, s[44:47], s100 offen offset:1024 nt
    v_dot2_f32_bf16 v30, v104, v24, 0
    v_dot2_f32_bf16 v30, v105, v25, v30
    v_dot2_f32_bf16 v30, v106, v26, v30
    v_dot2_f32_bf16 v30, v107, v27, v30
    s_waitcnt vmcnt(13)
    buffer_load_dwordx4 v[104:107], v4, s[44:47], s100 offen offset:2048 nt
    v_dot2_f32_bf16 v31, v108, v24, 0
    v_dot2_f32_bf16 v31, v109, v25, v31
    v_dot2_f32_bf16 v31, v110, v26, v31
    v_dot2_f32_bf16 v31, v111, v27, v31
    s_waitcnt vmcnt(13)
    buffer_load_dwordx4 v[108:111], v4, s[44:47], s100 offen offset:3072 nt
    s_nop 2
    v_add_f32_dpp v28, v28, v28 row_ror:8 row_mask:0xf bank_mask:0xf
    v_add_f32_dpp v29, v29, v29 row_ror:8 row_mask:0xf bank_mask:0xf
    v_add_f32_dpp v30, v30, v30 row_ror:8 row_mask:0xf bank_mask:0xf
    v_add_f32_dpp v31, v31, v31 row_ror:8 row_mask:0xf bank_mask:0xf
    v_add_f32_dpp v28, v28, v28 row_ror:4 row_mask:0xf bank_mask:0xf
    v_add_f32_dpp v29, v29, v29 row_ror:4 row_mask:0xf bank_mask:0xf
    v_add_f32_dpp v30, v30, v30 row_ror:4 row_mask:0xf bank_mask:0xf
    v_add_f32_dpp v31, v31, v31 row_ror:4 row_mask:0xf bank_mask:0xf
    v_add_f32_dpp v28, v28, v28 row_ror:2 row_mask:0xf bank_mask:0xf
    v_add_f32_dpp v29, v29, v29 row_ror:2 row_mask:0xf bank_mask:0xf
    v_add_f32_dpp v30, v30, v30 row_ror:2 row_mask:0xf bank_mask:0xf
    v_add_f32_dpp v31, v31, v31 row_ror:2 row_mask:0xf bank_mask:0xf
    v_add_f32_dpp v28, v28, v28 row_ror:1 row_mask:0xf bank_mask:0xf
    v_add_f32_dpp v29, v29, v29 row_ror:1 row_mask:0xf bank_mask:0xf
    v_add_f32_dpp v30, v30, v30 row_ror:1 row_mask:0xf bank_mask:0xf
    v_add_f32_dpp v31, v31, v31 row_ror:1 row_mask:0xf bank_mask:0xf
    v_max3_f32 v38, v36, v28, v29
    v_max3_f32 v38, v38, v30, v31
    v_sub_f32 v39, v36, v38
    v_mul_f32 v39, s70, v39
    v_exp_f32 v39, v39
    v_mul_f32 v56, s70, v38
    v_mov_b32 v36, v38
    v_fma_f32 v48, v28, s70, -v56
    v_fma_f32 v49, v29, s70, -v56
    v_fma_f32 v50, v30, s70, -v56
    v_fma_f32 v51, v31, s70, -v56
    v_exp_f32 v48, v48
    v_exp_f32 v49, v49
    v_exp_f32 v50, v50
    v_exp_f32 v51, v51
    v_mul_f32 v37, v37, v39
    v_mul_f32 v16, v16, v39
    v_mul_f32 v17, v17, v39
    v_mul_f32 v18, v18, v39
    v_mul_f32 v19, v19, v39
    v_mul_f32 v20, v20, v39
    v_mul_f32 v21, v21, v39
    v_mul_f32 v22, v22, v39
    v_mul_f32 v23, v23, v39
    v_add_f32 v37, v37, v48
    v_add_f32 v37, v37, v49
    v_add_f32 v37, v37, v50
    v_add_f32 v37, v37, v51
    v_lshlrev_b32 v40, 16, v112
    v_and_b32 v41, 0xffff0000, v112
    v_lshlrev_b32 v42, 16, v113
    v_and_b32 v43, 0xffff0000, v113
    v_lshlrev_b32 v44, 16, v114
    v_and_b32 v45, 0xffff0000, v114
    v_lshlrev_b32 v46, 16, v115
    v_and_b32 v47, 0xffff0000, v115
    s_waitcnt vmcnt(13)
    buffer_load_dwordx4 v[112:115], v4, s[48:51], s100 offen offset:0 nt
    v_fmac_f32 v16, v40, v48
    v_fmac_f32 v17, v41, v48
    v_fmac_f32 v18, v42, v48
    v_fmac_f32 v19, v43, v48
    v_fmac_f32 v20, v44, v48
    v_fmac_f32 v21, v45, v48
    v_fmac_f32 v22, v46, v48
    v_fmac_f32 v23, v47, v48
    v_lshlrev_b32 v40, 16, v116
    v_and_b32 v41, 0xffff0000, v116
    v_lshlrev_b32 v42, 16, v117
    v_and_b32 v43, 0xffff0000, v117
    v_lshlrev_b32 v44, 16, v118
    v_and_b32 v45, 0xffff0000, v118
    v_lshlrev_b32 v46, 16, v119
    v_and_b32 v47, 0xffff0000, v119
    s_waitcnt vmcnt(13)
    buffer_load_dwordx4 v[116:119], v4, s[48:51], s100 offen offset:1024 nt
    v_fmac_f32 v16, v40, v49
    v_fmac_f32 v17, v41, v49
    v_fmac_f32 v18, v42, v49
    v_fmac_f32 v19, v43, v49
    v_fmac_f32 v20, v44, v49
    v_fmac_f32 v21, v45, v49
    v_fmac_f32 v22, v46, v49
    v_fmac_f32 v23, v47, v49
    v_lshlrev_b32 v40, 16, v120
    v_and_b32 v41, 0xffff0000, v120
    v_lshlrev_b32 v42, 16, v121
    v_and_b32 v43, 0xffff0000, v121
    v_lshlrev_b32 v44, 16, v122
    v_and_b32 v45, 0xffff0000, v122
    v_lshlrev_b32 v46, 16, v123
    v_and_b32 v47, 0xffff0000, v123
    s_waitcnt vmcnt(13)
    buffer_load_dwordx4 v[120:123], v4, s[48:51], s100 offen offset:2048 nt
    v_fmac_f32 v16, v40, v50
    v_fmac_f32 v17, v41, v50
    v_fmac_f32 v18, v42, v50
    v_fmac_f32 v19, v43, v50
    v_fmac_f32 v20, v44, v50
    v_fmac_f32 v21, v45, v50
    v_fmac_f32 v22, v46, v50
    v_fmac_f32 v23, v47, v50
    v_lshlrev_b32 v40, 16, v124
    v_and_b32 v41, 0xffff0000, v124
    v_lshlrev_b32 v42, 16, v125
    v_and_b32 v43, 0xffff0000, v125
    v_lshlrev_b32 v44, 16, v126
    v_and_b32 v45, 0xffff0000, v126
    v_lshlrev_b32 v46, 16, v127
    v_and_b32 v47, 0xffff0000, v127
    s_waitcnt vmcnt(13)
    buffer_load_dwordx4 v[124:127], v4, s[48:51], s100 offen offset:3072 nt
    v_fmac_f32 v16, v40, v51
    v_fmac_f32 v17, v41, v51
    v_fmac_f32 v18, v42, v51
    v_fmac_f32 v19, v43, v51
    v_fmac_f32 v20, v44, v51
    v_fmac_f32 v21, v45, v51
    v_fmac_f32 v22, v46, v51
    v_fmac_f32 v23, v47, v51
    s_waitcnt vmcnt(8)
    s_mov_b64 s[94:95], exec
    s_mov_b64 exec, 1
    ds_add_rtn_u32 v59, v61, v5
    s_mov_b64 exec, s[94:95]
    s_waitcnt lgkmcnt(0)
    s_mov_b64 exec, 1
    v_lshlrev_b32 v59, 2, v59
    s_mov_b32 s92, 0
Lpop_33:
    ds_read_b32 v62, v59 offset:1024
    s_waitcnt lgkmcnt(0)
    v_readfirstlane_b32 s73, v62
    s_nop 3
    s_cmp_lg_u32 s73, -1
    s_cbranch_scc1 Lpopd_34
    s_sleep 1
    s_add_u32 s92, s92, 1
    s_cmp_lt_u32 s92, 400000
    s_cbranch_scc1 Lpop_33
Lpopd_34:
    s_mov_b64 exec, -1
    s_branch LBloop2_19
LBtail0_29:
    s_waitcnt vmcnt(15)
    v_dot2_f32_bf16 v28, v64, v24, 0
    v_dot2_f32_bf16 v28, v65, v25, v28
    v_dot2_f32_bf16 v28, v66, v26, v28
    v_dot2_f32_bf16 v28, v67, v27, v28
    s_waitcnt vmcnt(14)
    v_dot2_f32_bf16 v29, v68, v24, 0
    v_dot2_f32_bf16 v29, v69, v25, v29
    v_dot2_f32_bf16 v29, v70, v26, v29
    v_dot2_f32_bf16 v29, v71, v27, v29
    s_waitcnt vmcnt(13)
    v_dot2_f32_bf16 v30, v72, v24, 0
    v_dot2_f32_bf16 v30, v73, v25, v30
    v_dot2_f32_bf16 v30, v74, v26, v30
    v_dot2_f32_bf16 v30, v75, v27, v30
    s_waitcnt vmcnt(12)
    v_dot2_f32_bf16 v31, v76, v24, 0
    v_dot2_f32_bf16 v31, v77, v25, v31
    v_dot2_f32_bf16 v31, v78, v26, v31
    v_dot2_f32_bf16 v31, v79, v27, v31
    s_nop 2
    v_add_f32_dpp v28, v28, v28 row_ror:8 row_mask:0xf bank_mask:0xf
    v_add_f32_dpp v29, v29, v29 row_ror:8 row_mask:0xf bank_mask:0xf
    v_add_f32_dpp v30, v30, v30 row_ror:8 row_mask:0xf bank_mask:0xf
    v_add_f32_dpp v31, v31, v31 row_ror:8 row_mask:0xf bank_mask:0xf
    v_add_f32_dpp v28, v28, v28 row_ror:4 row_mask:0xf bank_mask:0xf
    v_add_f32_dpp v29, v29, v29 row_ror:4 row_mask:0xf bank_mask:0xf
    v_add_f32_dpp v30, v30, v30 row_ror:4 row_mask:0xf bank_mask:0xf
    v_add_f32_dpp v31, v31, v31 row_ror:4 row_mask:0xf bank_mask:0xf
    v_add_f32_dpp v28, v28, v28 row_ror:2 row_mask:0xf bank_mask:0xf
    v_add_f32_dpp v29, v29, v29 row_ror:2 row_mask:0xf bank_mask:0xf
    v_add_f32_dpp v30, v30, v30 row_ror:2 row_mask:0xf bank_mask:0xf
    v_add_f32_dpp v31, v31, v31 row_ror:2 row_mask:0xf bank_mask:0xf
    v_add_f32_dpp v28, v28, v28 row_ror:1 row_mask:0xf bank_mask:0xf
    v_add_f32_dpp v29, v29, v29 row_ror:1 row_mask:0xf bank_mask:0xf
    v_add_f32_dpp v30, v30, v30 row_ror:1 row_mask:0xf bank_mask:0xf
    v_add_f32_dpp v31, v31, v31 row_ror:1 row_mask:0xf bank_mask:0xf
    v_max3_f32 v38, v36, v28, v29
    v_max3_f32 v38, v38, v30, v31
    v_sub_f32 v39, v36, v38
    v_mul_f32 v39, s70, v39
    v_exp_f32 v39, v39
    v_mul_f32 v56, s70, v38
    v_mov_b32 v36, v38
    v_fma_f32 v48, v28, s70, -v56
    v_fma_f32 v49, v29, s70, -v56
    v_fma_f32 v50, v30, s70, -v56
    v_fma_f32 v51, v31, s70, -v56
    v_exp_f32 v48, v48
    v_exp_f32 v49, v49
    v_exp_f32 v50, v50
    v_exp_f32 v51, v51
    v_mul_f32 v37, v37, v39
    v_mul_f32 v16, v16, v39
    v_mul_f32 v17, v17, v39
    v_mul_f32 v18, v18, v39
    v_mul_f32 v19, v19, v39
    v_mul_f32 v20, v20, v39
    v_mul_f32 v21, v21, v39
    v_mul_f32 v22, v22, v39
    v_mul_f32 v23, v23, v39
    v_add_f32 v37, v37, v48
    v_add_f32 v37, v37, v49
    v_add_f32 v37, v37, v50
    v_add_f32 v37, v37, v51
    s_waitcnt vmcnt(11)
    v_lshlrev_b32 v40, 16, v80
    v_and_b32 v41, 0xffff0000, v80
    v_lshlrev_b32 v42, 16, v81
    v_and_b32 v43, 0xffff0000, v81
    v_lshlrev_b32 v44, 16, v82
    v_and_b32 v45, 0xffff0000, v82
    v_lshlrev_b32 v46, 16, v83
    v_and_b32 v47, 0xffff0000, v83
    v_fmac_f32 v16, v40, v48
    v_fmac_f32 v17, v41, v48
    v_fmac_f32 v18, v42, v48
    v_fmac_f32 v19, v43, v48
    v_fmac_f32 v20, v44, v48
    v_fmac_f32 v21, v45, v48
    v_fmac_f32 v22, v46, v48
    v_fmac_f32 v23, v47, v48
    s_waitcnt vmcnt(10)
    v_lshlrev_b32 v40, 16, v84
    v_and_b32 v41, 0xffff0000, v84
    v_lshlrev_b32 v42, 16, v85
    v_and_b32 v43, 0xffff0000, v85
    v_lshlrev_b32 v44, 16, v86
    v_and_b32 v45, 0xffff0000, v86
    v_lshlrev_b32 v46, 16, v87
    v_and_b32 v47, 0xffff0000, v87
    v_fmac_f32 v16, v40, v49
    v_fmac_f32 v17, v41, v49
    v_fmac_f32 v18, v42, v49
    v_fmac_f32 v19, v43, v49
    v_fmac_f32 v20, v44, v49
    v_fmac_f32 v21, v45, v49
    v_fmac_f32 v22, v46, v49
    v_fmac_f32 v23, v47, v49
    s_waitcnt vmcnt(9)
    v_lshlrev_b32 v40, 16, v88
    v_and_b32 v41, 0xffff0000, v88
    v_lshlrev_b32 v42, 16, v89
    v_and_b32 v43, 0xffff0000, v89
    v_lshlrev_b32 v44, 16, v90
    v_and_b32 v45, 0xffff0000, v90
    v_lshlrev_b32 v46, 16, v91
    v_and_b32 v47, 0xffff0000, v91
    v_fmac_f32 v16, v40, v50
    v_fmac_f32 v17, v41, v50
    v_fmac_f32 v18, v42, v50
    v_fmac_f32 v19, v43, v50
    v_fmac_f32 v20, v44, v50
    v_fmac_f32 v21, v45, v50
    v_fmac_f32 v22, v46, v50
    v_fmac_f32 v23, v47, v50
    s_waitcnt vmcnt(8)
    v_lshlrev_b32 v40, 16, v92
    v_and_b32 v41, 0xffff0000, v92
    v_lshlrev_b32 v42, 16, v93
    v_and_b32 v43, 0xffff0000, v93
    v_lshlrev_b32 v44, 16, v94
    v_and_b32 v45, 0xffff0000, v94
    v_lshlrev_b32 v46, 16, v95
    v_and_b32 v47, 0xffff0000, v95
    v_fmac_f32 v16, v40, v51
    v_fmac_f32 v17, v41, v51
    v_fmac_f32 v18, v42, v51
    v_fmac_f32 v19, v43, v51
    v_fmac_f32 v20, v44, v51
    v_fmac_f32 v21, v45, v51
    v_fmac_f32 v22, v46, v51
    v_fmac_f32 v23, v47, v51
    s_waitcnt vmcnt(7)
    v_dot2_f32_bf16 v28, v96, v24, 0
    v_dot2_f32_bf16 v28, v97, v25, v28
    v_dot2_f32_bf16 v28, v98, v26, v28
    v_dot2_f32_bf16 v28, v99, v27, v28
    s_waitcnt vmcnt(6)
    v_dot2_f32_bf16 v29, v100, v24, 0
    v_dot2_f32_bf16 v29, v101, v25, v29
    v_dot2_f32_bf16 v29, v102, v26, v29
    v_dot2_f32_bf16 v29, v103, v27, v29
    s_waitcnt vmcnt(5)
    v_dot2_f32_bf16 v30, v104, v24, 0
    v_dot2_f32_bf16 v30, v105, v25, v30
    v_dot2_f32_bf16 v30, v106, v26, v30
    v_dot2_f32_bf16 v30, v107, v27, v30
    s_waitcnt vmcnt(4)
    v_dot2_f32_bf16 v31, v108, v24, 0
    v_dot2_f32_bf16 v31, v109, v25, v31
    v_dot2_f32_bf16 v31, v110, v26, v31
    v_dot2_f32_bf16 v31, v111, v27, v31
    s_nop 2
    v_add_f32_dpp v28, v28, v28 row_ror:8 row_mask:0xf bank_mask:0xf
    v_add_f32_dpp v29, v29, v29 row_ror:8 row_mask:0xf bank_mask:0xf
    v_add_f32_dpp v30, v30, v30 row_ror:8 row_mask:0xf bank_mask:0xf
    v_add_f32_dpp v31, v31, v31 row_ror:8 row_mask:0xf bank_mask:0xf
    v_add_f32_dpp v28, v28, v28 row_ror:4 row_mask:0xf bank_mask:0xf
    v_add_f32_dpp v29, v29, v29 row_ror:4 row_mask:0xf bank_mask:0xf
    v_add_f32_dpp v30, v30, v30 row_ror:4 row_mask:0xf bank_mask:0xf
    v_add_f32_dpp v31, v31, v31 row_ror:4 row_mask:0xf bank_mask:0xf
    v_add_f32_dpp v28, v28, v28 row_ror:2 row_mask:0xf bank_mask:0xf
    v_add_f32_dpp v29, v29, v29 row_ror:2 row_mask:0xf bank_mask:0xf
    v_add_f32_dpp v30, v30, v30 row_ror:2 row_mask:0xf bank_mask:0xf
    v_add_f32_dpp v31, v31, v31 row_ror:2 row_mask:0xf bank_mask:0xf
    v_add_f32_dpp v28, v28, v28 row_ror:1 row_mask:0xf bank_mask:0xf
    v_add_f32_dpp v29, v29, v29 row_ror:1 row_mask:0xf bank_mask:0xf
    v_add_f32_dpp v30, v30, v30 row_ror:1 row_mask:0xf bank_mask:0xf
    v_add_f32_dpp v31, v31, v31 row_ror:1 row_mask:0xf bank_mask:0xf
    v_max3_f32 v38, v36, v28, v29
    v_max3_f32 v38, v38, v30, v31
    v_sub_f32 v39, v36, v38
    v_mul_f32 v39, s70, v39
    v_exp_f32 v39, v39
    v_mul_f32 v56, s70, v38
    v_mov_b32 v36, v38
    v_fma_f32 v48, v28, s70, -v56
    v_fma_f32 v49, v29, s70, -v56
    v_fma_f32 v50, v30, s70, -v56
    v_fma_f32 v51, v31, s70, -v56
    v_exp_f32 v48, v48
    v_exp_f32 v49, v49
    v_exp_f32 v50, v50
    v_exp_f32 v51, v51
    v_mul_f32 v37, v37, v39
    v_mul_f32 v16, v16, v39
    v_mul_f32 v17, v17, v39
    v_mul_f32 v18, v18, v39
    v_mul_f32 v19, v19, v39
    v_mul_f32 v20, v20, v39
    v_mul_f32 v21, v21, v39
    v_mul_f32 v22, v22, v39
    v_mul_f32 v23, v23, v39
    v_add_f32 v37, v37, v48
    v_add_f32 v37, v37, v49
    v_add_f32 v37, v37, v50
    v_add_f32 v37, v37, v51
    s_waitcnt vmcnt(3)
    v_lshlrev_b32 v40, 16, v112
    v_and_b32 v41, 0xffff0000, v112
    v_lshlrev_b32 v42, 16, v113
    v_and_b32 v43, 0xffff0000, v113
    v_lshlrev_b32 v44, 16, v114
    v_and_b32 v45, 0xffff0000, v114
    v_lshlrev_b32 v46, 16, v115
    v_and_b32 v47, 0xffff0000, v115
    v_fmac_f32 v16, v40, v48
    v_fmac_f32 v17, v41, v48
    v_fmac_f32 v18, v42, v48
    v_fmac_f32 v19, v43, v48
    v_fmac_f32 v20, v44, v48
    v_fmac_f32 v21, v45, v48
    v_fmac_f32 v22, v46, v48
    v_fmac_f32 v23, v47, v48
    s_waitcnt vmcnt(2)
    v_lshlrev_b32 v40, 16, v116
    v_and_b32 v41, 0xffff0000, v116
    v_lshlrev_b32 v42, 16, v117
    v_and_b32 v43, 0xffff0000, v117
    v_lshlrev_b32 v44, 16, v118
    v_and_b32 v45, 0xffff0000, v118
    v_lshlrev_b32 v46, 16, v119
    v_and_b32 v47, 0xffff0000, v119
    v_fmac_f32 v16, v40, v49
    v_fmac_f32 v17, v41, v49
    v_fmac_f32 v18, v42, v49
    v_fmac_f32 v19, v43, v49
    v_fmac_f32 v20, v44, v49
    v_fmac_f32 v21, v45, v49
    v_fmac_f32 v22, v46, v49
    v_fmac_f32 v23, v47, v49
    s_waitcnt vmcnt(1)
    v_lshlrev_b32 v40, 16, v120
    v_and_b32 v41, 0xffff0000, v120
    v_lshlrev_b32 v42, 16, v121
    v_and_b32 v43, 0xffff0000, v121
    v_lshlrev_b32 v44, 16, v122
    v_and_b32 v45, 0xffff0000, v122
    v_lshlrev_b32 v46, 16, v123
    v_and_b32 v47, 0xffff0000, v123
    v_fmac_f32 v16, v40, v50
    v_fmac_f32 v17, v41, v50
    v_fmac_f32 v18, v42, v50
    v_fmac_f32 v19, v43, v50
    v_fmac_f32 v20, v44, v50
    v_fmac_f32 v21, v45, v50
    v_fmac_f32 v22, v46, v50
    v_fmac_f32 v23, v47, v50
    s_waitcnt vmcnt(0)
    v_lshlrev_b32 v40, 16, v124
    v_and_b32 v41, 0xffff0000, v124
    v_lshlrev_b32 v42, 16, v125
    v_and_b32 v43, 0xffff0000, v125
    v_lshlrev_b32 v44, 16, v126
    v_and_b32 v45, 0xffff0000, v126
    v_lshlrev_b32 v46, 16, v127
    v_and_b32 v47, 0xffff0000, v127
    v_fmac_f32 v16, v40, v51
    v_fmac_f32 v17, v41, v51
    v_fmac_f32 v18, v42, v51
    v_fmac_f32 v19, v43, v51
    v_fmac_f32 v20, v44, v51
    v_fmac_f32 v21, v45, v51
    v_fmac_f32 v22, v46, v51
    v_fmac_f32 v23, v47, v51
    s_branch LBdone_18
LBtail1_30:
    s_waitcnt vmcnt(15)
    v_dot2_f32_bf16 v28, v96, v24, 0
    v_dot2_f32_bf16 v28, v97, v25, v28
    v_dot2_f32_bf16 v28, v98, v26, v28
    v_dot2_f32_bf16 v28, v99, v27, v28
    s_waitcnt vmcnt(14)
    v_dot2_f32_bf16 v29, v100, v24, 0
    v_dot2_f32_bf16 v29, v101, v25, v29
    v_dot2_f32_bf16 v29, v102, v26, v29
    v_dot2_f32_bf16 v29, v103, v27, v29
    s_waitcnt vmcnt(13)
    v_dot2_f32_bf16 v30, v104, v24, 0
    v_dot2_f32_bf16 v30, v105, v25, v30
    v_dot2_f32_bf16 v30, v106, v26, v30
    v_dot2_f32_bf16 v30, v107, v27, v30
    s_waitcnt vmcnt(12)
    v_dot2_f32_bf16 v31, v108, v24, 0
    v_dot2_f32_bf16 v31, v109, v25, v31
    v_dot2_f32_bf16 v31, v110, v26, v31
    v_dot2_f32_bf16 v31, v111, v27, v31
    s_nop 2
    v_add_f32_dpp v28, v28, v28 row_ror:8 row_mask:0xf bank_mask:0xf
    v_add_f32_dpp v29, v29, v29 row_ror:8 row_mask:0xf bank_mask:0xf
    v_add_f32_dpp v30, v30, v30 row_ror:8 row_mask:0xf bank_mask:0xf
    v_add_f32_dpp v31, v31, v31 row_ror:8 row_mask:0xf bank_mask:0xf
    v_add_f32_dpp v28, v28, v28 row_ror:4 row_mask:0xf bank_mask:0xf
    v_add_f32_dpp v29, v29, v29 row_ror:4 row_mask:0xf bank_mask:0xf
    v_add_f32_dpp v30, v30, v30 row_ror:4 row_mask:0xf bank_mask:0xf
    v_add_f32_dpp v31, v31, v31 row_ror:4 row_mask:0xf bank_mask:0xf
    v_add_f32_dpp v28, v28, v28 row_ror:2 row_mask:0xf bank_mask:0xf
    v_add_f32_dpp v29, v29, v29 row_ror:2 row_mask:0xf bank_mask:0xf
    v_add_f32_dpp v30, v30, v30 row_ror:2 row_mask:0xf bank_mask:0xf
    v_add_f32_dpp v31, v31, v31 row_ror:2 row_mask:0xf bank_mask:0xf
    v_add_f32_dpp v28, v28, v28 row_ror:1 row_mask:0xf bank_mask:0xf
    v_add_f32_dpp v29, v29, v29 row_ror:1 row_mask:0xf bank_mask:0xf
    v_add_f32_dpp v30, v30, v30 row_ror:1 row_mask:0xf bank_mask:0xf
    v_add_f32_dpp v31, v31, v31 row_ror:1 row_mask:0xf bank_mask:0xf
    v_max3_f32 v38, v36, v28, v29
    v_max3_f32 v38, v38, v30, v31
    v_sub_f32 v39, v36, v38
    v_mul_f32 v39, s70, v39
    v_exp_f32 v39, v39
    v_mul_f32 v56, s70, v38
    v_mov_b32 v36, v38
    v_fma_f32 v48, v28, s70, -v56
    v_fma_f32 v49, v29, s70, -v56
    v_fma_f32 v50, v30, s70, -v56
    v_fma_f32 v51, v31, s70, -v56
    v_exp_f32 v48, v48
    v_exp_f32 v49, v49
    v_exp_f32 v50, v50
    v_exp_f32 v51, v51
    v_mul_f32 v37, v37, v39
    v_mul_f32 v16, v16, v39
    v_mul_f32 v17, v17, v39
    v_mul_f32 v18, v18, v39
    v_mul_f32 v19, v19, v39
    v_mul_f32 v20, v20, v39
    v_mul_f32 v21, v21, v39
    v_mul_f32 v22, v22, v39
    v_mul_f32 v23, v23, v39
    v_add_f32 v37, v37, v48
    v_add_f32 v37, v37, v49
    v_add_f32 v37, v37, v50
    v_add_f32 v37, v37, v51
    s_waitcnt vmcnt(11)
    v_lshlrev_b32 v40, 16, v112
    v_and_b32 v41, 0xffff0000, v112
    v_lshlrev_b32 v42, 16, v113
    v_and_b32 v43, 0xffff0000, v113
    v_lshlrev_b32 v44, 16, v114
    v_and_b32 v45, 0xffff0000, v114
    v_lshlrev_b32 v46, 16, v115
    v_and_b32 v47, 0xffff0000, v115
    v_fmac_f32 v16, v40, v48
    v_fmac_f32 v17, v41, v48
    v_fmac_f32 v18, v42, v48
    v_fmac_f32 v19, v43, v48
    v_fmac_f32 v20, v44, v48
    v_fmac_f32 v21, v45, v48
    v_fmac_f32 v22, v46, v48
    v_fmac_f32 v23, v47, v48
    s_waitcnt vmcnt(10)
    v_lshlrev_b32 v40, 16, v116
    v_and_b32 v41, 0xffff0000, v116
    v_lshlrev_b32 v42, 16, v117
    v_and_b32 v43, 0xffff0000, v117
    v_lshlrev_b32 v44, 16, v118
    v_and_b32 v45, 0xffff0000, v118
    v_lshlrev_b32 v46, 16, v119
    v_and_b32 v47, 0xffff0000, v119
    v_fmac_f32 v16, v40, v49
    v_fmac_f32 v17, v41, v49
    v_fmac_f32 v18, v42, v49
    v_fmac_f32 v19, v43, v49
    v_fmac_f32 v20, v44, v49
    v_fmac_f32 v21, v45, v49
    v_fmac_f32 v22, v46, v49
    v_fmac_f32 v23, v47, v49
    s_waitcnt vmcnt(9)
    v_lshlrev_b32 v40, 16, v120
    v_and_b32 v41, 0xffff0000, v120
    v_lshlrev_b32 v42, 16, v121
    v_and_b32 v43, 0xffff0000, v121
    v_lshlrev_b32 v44, 16, v122
    v_and_b32 v45, 0xffff0000, v122
    v_lshlrev_b32 v46, 16, v123
    v_and_b32 v47, 0xffff0000, v123
    v_fmac_f32 v16, v40, v50
    v_fmac_f32 v17, v41, v50
    v_fmac_f32 v18, v42, v50
    v_fmac_f32 v19, v43, v50
    v_fmac_f32 v20, v44, v50
    v_fmac_f32 v21, v45, v50
    v_fmac_f32 v22, v46, v50
    v_fmac_f32 v23, v47, v50
    s_waitcnt vmcnt(8)
    v_lshlrev_b32 v40, 16, v124
    v_and_b32 v41, 0xffff0000, v124
    v_lshlrev_b32 v42, 16, v125
    v_and_b32 v43, 0xffff0000, v125
    v_lshlrev_b32 v44, 16, v126
    v_and_b32 v45, 0xffff0000, v126
    v_lshlrev_b32 v46, 16, v127
    v_and_b32 v47, 0xffff0000, v127
    v_fmac_f32 v16, v40, v51
    v_fmac_f32 v17, v41, v51
    v_fmac_f32 v18, v42, v51
    v_fmac_f32 v19, v43, v51
    v_fmac_f32 v20, v44, v51
    v_fmac_f32 v21, v45, v51
    v_fmac_f32 v22, v46, v51
    v_fmac_f32 v23, v47, v51
    s_waitcnt vmcnt(7)
    v_dot2_f32_bf16 v28, v64, v24, 0
    v_dot2_f32_bf16 v28, v65, v25, v28
    v_dot2_f32_bf16 v28, v66, v26, v28
    v_dot2_f32_bf16 v28, v67, v27, v28
    s_waitcnt vmcnt(6)
    v_dot2_f32_bf16 v29, v68, v24, 0
    v_dot2_f32_bf16 v29, v69, v25, v29
    v_dot2_f32_bf16 v29, v70, v26, v29
    v_dot2_f32_bf16 v29, v71, v27, v29
    s_waitcnt vmcnt(5)
    v_dot2_f32_bf16 v30, v72, v24, 0
    v_dot2_f32_bf16 v30, v73, v25, v30
    v_dot2_f32_bf16 v30, v74, v26, v30
    v_dot2_f32_bf16 v30, v75, v27, v30
    s_waitcnt vmcnt(4)
    v_dot2_f32_bf16 v31, v76, v24, 0
    v_dot2_f32_bf16 v31, v77, v25, v31
    v_dot2_f32_bf16 v31, v78, v26, v31
    v_dot2_f32_bf16 v31, v79, v27, v31
    s_nop 2
    v_add_f32_dpp v28, v28, v28 row_ror:8 row_mask:0xf bank_mask:0xf
    v_add_f32_dpp v29, v29, v29 row_ror:8 row_mask:0xf bank_mask:0xf
    v_add_f32_dpp v30, v30, v30 row_ror:8 row_mask:0xf bank_mask:0xf
    v_add_f32_dpp v31, v31, v31 row_ror:8 row_mask:0xf bank_mask:0xf
    v_add_f32_dpp v28, v28, v28 row_ror:4 row_mask:0xf bank_mask:0xf
    v_add_f32_dpp v29, v29, v29 row_ror:4 row_mask:0xf bank_mask:0xf
    v_add_f32_dpp v30, v30, v30 row_ror:4 row_mask:0xf bank_mask:0xf
    v_add_f32_dpp v31, v31, v31 row_ror:4 row_mask:0xf bank_mask:0xf
    v_add_f32_dpp v28, v28, v28 row_ror:2 row_mask:0xf bank_mask:0xf
    v_add_f32_dpp v29, v29, v29 row_ror:2 row_mask:0xf bank_mask:0xf
    v_add_f32_dpp v30, v30, v30 row_ror:2 row_mask:0xf bank_mask:0xf
    v_add_f32_dpp v31, v31, v31 row_ror:2 row_mask:0xf bank_mask:0xf
    v_add_f32_dpp v28, v28, v28 row_ror:1 row_mask:0xf bank_mask:0xf
    v_add_f32_dpp v29, v29, v29 row_ror:1 row_mask:0xf bank_mask:0xf
    v_add_f32_dpp v30, v30, v30 row_ror:1 row_mask:0xf bank_mask:0xf
    v_add_f32_dpp v31, v31, v31 row_ror:1 row_mask:0xf bank_mask:0xf
    v_max3_f32 v38, v36, v28, v29
    v_max3_f32 v38, v38, v30, v31
    v_sub_f32 v39, v36, v38
    v_mul_f32 v39, s70, v39
    v_exp_f32 v39, v39
    v_mul_f32 v56, s70, v38
    v_mov_b32 v36, v38
    v_fma_f32 v48, v28, s70, -v56
    v_fma_f32 v49, v29, s70, -v56
    v_fma_f32 v50, v30, s70, -v56
    v_fma_f32 v51, v31, s70, -v56
    v_exp_f32 v48, v48
    v_exp_f32 v49, v49
    v_exp_f32 v50, v50
    v_exp_f32 v51, v51
    v_mul_f32 v37, v37, v39
    v_mul_f32 v16, v16, v39
    v_mul_f32 v17, v17, v39
    v_mul_f32 v18, v18, v39
    v_mul_f32 v19, v19, v39
    v_mul_f32 v20, v20, v39
    v_mul_f32 v21, v21, v39
    v_mul_f32 v22, v22, v39
    v_mul_f32 v23, v23, v39
    v_add_f32 v37, v37, v48
    v_add_f32 v37, v37, v49
    v_add_f32 v37, v37, v50
    v_add_f32 v37, v37, v51
    s_waitcnt vmcnt(3)
    v_lshlrev_b32 v40, 16, v80
    v_and_b32 v41, 0xffff0000, v80
    v_lshlrev_b32 v42, 16, v81
    v_and_b32 v43, 0xffff0000, v81
    v_lshlrev_b32 v44, 16, v82
    v_and_b32 v45, 0xffff0000, v82
    v_lshlrev_b32 v46, 16, v83
    v_and_b32 v47, 0xffff0000, v83
    v_fmac_f32 v16, v40, v48
    v_fmac_f32 v17, v41, v48
    v_fmac_f32 v18, v42, v48
    v_fmac_f32 v19, v43, v48
    v_fmac_f32 v20, v44, v48
    v_fmac_f32 v21, v45, v48
    v_fmac_f32 v22, v46, v48
    v_fmac_f32 v23, v47, v48
    s_waitcnt vmcnt(2)
    v_lshlrev_b32 v40, 16, v84
    v_and_b32 v41, 0xffff0000, v84
    v_lshlrev_b32 v42, 16, v85
    v_and_b32 v43, 0xffff0000, v85
    v_lshlrev_b32 v44, 16, v86
    v_and_b32 v45, 0xffff0000, v86
    v_lshlrev_b32 v46, 16, v87
    v_and_b32 v47, 0xffff0000, v87
    v_fmac_f32 v16, v40, v49
    v_fmac_f32 v17, v41, v49
    v_fmac_f32 v18, v42, v49
    v_fmac_f32 v19, v43, v49
    v_fmac_f32 v20, v44, v49
    v_fmac_f32 v21, v45, v49
    v_fmac_f32 v22, v46, v49
    v_fmac_f32 v23, v47, v49
    s_waitcnt vmcnt(1)
    v_lshlrev_b32 v40, 16, v88
    v_and_b32 v41, 0xffff0000, v88
    v_lshlrev_b32 v42, 16, v89
    v_and_b32 v43, 0xffff0000, v89
    v_lshlrev_b32 v44, 16, v90
    v_and_b32 v45, 0xffff0000, v90
    v_lshlrev_b32 v46, 16, v91
    v_and_b32 v47, 0xffff0000, v91
    v_fmac_f32 v16, v40, v50
    v_fmac_f32 v17, v41, v50
    v_fmac_f32 v18, v42, v50
    v_fmac_f32 v19, v43, v50
    v_fmac_f32 v20, v44, v50
    v_fmac_f32 v21, v45, v50
    v_fmac_f32 v22, v46, v50
    v_fmac_f32 v23, v47, v50
    s_waitcnt vmcnt(0)
    v_lshlrev_b32 v40, 16, v92
    v_and_b32 v41, 0xffff0000, v92
    v_lshlrev_b32 v42, 16, v93
    v_and_b32 v43, 0xffff0000, v93
    v_lshlrev_b32 v44, 16, v94
    v_and_b32 v45, 0xffff0000, v94
    v_lshlrev_b32 v46, 16, v95
    v_and_b32 v47, 0xffff0000, v95
    v_fmac_f32 v16, v40, v51
    v_fmac_f32 v17, v41, v51
    v_fmac_f32 v18, v42, v51
    v_fmac_f32 v19, v43, v51
    v_fmac_f32 v20, v44, v51
    v_fmac_f32 v21, v45, v51
    v_fmac_f32 v22, v46, v51
    v_fmac_f32 v23, v47, v51
LBdone_18:
    v_mov_b32 v38, v36
    v_mov_b32 v40, v38
    s_nop 1
    v_permlane32_swap_b32 v38, v40
    s_nop 1
    v_max_f32 v38, v38, v40
    v_mov_b32 v40, v38
    s_nop 1
    v_permlane16_swap_b32 v38, v40
    s_nop 1
    v_max_f32 v38, v38, v40
    v_sub_f32 v39, v36, v38
    v_mul_f32 v39, s70, v39
    v_exp_f32 v39, v39
    s_nop 0
    v_mul_f32 v37, v37, v39
    v_mul_f32 v16, v16, v39
    v_mul_f32 v17, v17, v39
    v_mul_f32 v18, v18, v39
    v_mul_f32 v19, v19, v39
    v_mul_f32 v20, v20, v39
    v_mul_f32 v21, v21, v39
    v_mul_f32 v22, v22, v39
    v_mul_f32 v23, v23, v39
    v_mov_b32 v40, v37
    s_nop 1
    v_permlane32_swap_b32 v37, v40
    s_nop 1
    v_add_f32 v37, v37, v40
    v_mov_b32 v40, v37
    s_nop 1
    v_permlane16_swap_b32 v37, v40
    s_nop 1
    v_add_f32 v37, v37, v40
    s_nop 2
    v_permlane32_swap_b32 v16, v20
    v_permlane32_swap_b32 v17, v21
    v_permlane32_swap_b32 v18, v22
    v_permlane32_swap_b32 v19, v23
    s_nop 1
    v_add_f32 v16, v16, v20
    v_add_f32 v17, v17, v21
    v_add_f32 v18, v18, v22
    v_add_f32 v19, v19, v23
    s_nop 1
    v_permlane16_swap_b32 v16, v18
    v_permlane16_swap_b32 v17, v19
    s_nop 1
    v_add_f32 v16, v16, v18
    v_add_f32 v17, v17, v19
    ds_write_b64 v7, v[16:17] offset:4096
    v_mov_b32 v40, v38
    v_mov_b32 v41, v37
    s_lshl_b32 s61, s56, 3
    v_mov_b32 v42, s61
    ds_write_b64 v42, v[40:41] offset:8192
    s_waitcnt lgkmcnt(0)
    s_barrier
    s_cmp_lg_u32 s56, 0
    s_cbranch_scc1 L_end
    v_mov_b32 v42, 0
    ds_read_b128 v[28:31], v42 offset:8192
    ds_read_b128 v[32:35], v42 offset:8208
    ds_read_b128 v[48:51], v42 offset:8224
    ds_read_b128 v[52:55], v42 offset:8240
    v_and_b32 v43, 31, v1
    v_lshlrev_b32 v43, 4, v43
    ds_read_b128 v[64:67], v43 offset:4096
    ds_read_b128 v[68:71], v43 offset:4608
    ds_read_b128 v[72:75], v43 offset:5120
    ds_read_b128 v[76:79], v43 offset:5632
    ds_read_b128 v[80:83], v43 offset:6144
    ds_read_b128 v[84:87], v43 offset:6656
    ds_read_b128 v[88:91], v43 offset:7168
    ds_read_b128 v[92:95], v43 offset:7680
    s_waitcnt lgkmcnt(8)
    v_max3_f32 v38, v28, v30, v32
    v_max3_f32 v38, v38, v34, v48
    v_max3_f32 v38, v38, v50, v52
    v_max_f32 v38, v38, v54
    v_mul_f32 v56, s70, v38
    v_fma_f32 v28, v28, s70, -v56
    v_fma_f32 v30, v30, s70, -v56
    v_fma_f32 v32, v32, s70, -v56
    v_fma_f32 v34, v34, s70, -v56
    v_fma_f32 v48, v48, s70, -v56
    v_fma_f32 v50, v50, s70, -v56
    v_fma_f32 v52, v52, s70, -v56
    v_fma_f32 v54, v54, s70, -v56
    v_exp_f32 v28, v28
    v_exp_f32 v30, v30
    v_exp_f32 v32, v32
    v_exp_f32 v34, v34
    v_exp_f32 v48, v48
    v_exp_f32 v50, v50
    v_exp_f32 v52, v52
    v_exp_f32 v54, v54
    s_nop 0
    v_mul_f32 v37, v28, v29
    v_fmac_f32 v37, v30, v31
    v_fmac_f32 v37, v32, v33
    v_fmac_f32 v37, v34, v35
    v_fmac_f32 v37, v48, v49
    v_fmac_f32 v37, v50, v51
    v_fmac_f32 v37, v52, v53
    v_fmac_f32 v37, v54, v55
    s_waitcnt lgkmcnt(0)
    v_mul_f32 v40, v64, v28
    v_mul_f32 v41, v65, v28
    v_mul_f32 v42, v66, v28
    v_mul_f32 v43, v67, v28
    v_fmac_f32 v40, v68, v30
    v_fmac_f32 v41, v69, v30
    v_fmac_f32 v42, v70, v30
    v_fmac_f32 v43, v71, v30
    v_fmac_f32 v40, v72, v32
    v_fmac_f32 v41, v73, v32
    v_fmac_f32 v42, v74, v32
    v_fmac_f32 v43, v75, v32
    v_fmac_f32 v40, v76, v34
    v_fmac_f32 v41, v77, v34
    v_fmac_f32 v42, v78, v34
    v_fmac_f32 v43, v79, v34
    v_fmac_f32 v40, v80, v48
    v_fmac_f32 v41, v81, v48
    v_fmac_f32 v42, v82, v48
    v_fmac_f32 v43, v83, v48
    v_fmac_f32 v40, v84, v50
    v_fmac_f32 v41, v85, v50
    v_fmac_f32 v42, v86, v50
    v_fmac_f32 v43, v87, v50
    v_fmac_f32 v40, v88, v52
    v_fmac_f32 v41, v89, v52
    v_fmac_f32 v42, v90, v52
    v_fmac_f32 v43, v91, v52
    v_fmac_f32 v40, v92, v54
    v_fmac_f32 v41, v93, v54
    v_fmac_f32 v42, v94, v54
    v_fmac_f32 v43, v95, v54
    v_cmp_eq_u32 vcc, 32, v1
    v_mov_b32 v45, 0
    s_nop 0
    v_cndmask_b32 v40, v40, v38, vcc
    v_cndmask_b32 v41, v41, v37, vcc
    v_cndmask_b32 v42, v42, v45, vcc
    v_cndmask_b32 v43, v43, v45, vcc
    v_lshlrev_b32 v44, 4, v1
    s_lshl_b32 s61, s64, 9
    s_add_u32 s61, s61, 256
    v_add_u32 v44, s61, v44
    s_lshl_b32 s61, s64, 4
    s_add_u32 s61, s61, 128
    v_mov_b32 v46, s61
    v_cndmask_b32 v44, v44, v46, vcc
    s_add_u32 s61, s65, 32
    s_mul_i32 s61, s61, 16384
    s_mov_b32 exec_lo, -1
    s_mov_b32 exec_hi, 1
    buffer_store_dwordx4 v[40:43], v44, s[32:35], s61 offen sc0 sc1
    s_mov_b64 exec, -1
    s_branch L_end
L_roleA:
    s_and_b32 s60, s57, 3
    s_lshr_b32 s59, s57, 2
    s_lshl_b32 s59, s59, 5
    s_lshl_b32 s75, s58, 2
    s_add_u32 s75, s75, s60
    s_add_u32 s75, s75, s59
    s_waitcnt lgkmcnt(0)
    s_mov_b32 s32, s30
    s_and_b32 s33, s31, 0xffff
    s_mov_b32 s52, s28
    s_and_b32 s53, s29, 0xffff
    v_and_b32 v1, 63, v0
    v_lshrrev_b32 v2, 4, v1
    v_and_b32 v3, 15, v1
    v_lshlrev_b32 v5, 4, v1
    v_lshlrev_b32 v4, 17, v2
    v_lshl_add_u32 v4, v3, 4, v4
    s_mov_b32 s68, 0x05040100
    s_mov_b32 s69, 0x07060302
    s_mul_i32 s93, s75, 16384
    v_mov_b32 v40, -1
    v_mov_b32 v41, -1
    v_mov_b32 v42, -1
    v_mov_b32 v43, -1
    s_cmp_lg_u32 s57, 0
    s_cbranch_scc1 Lcq_35
    v_lshlrev_b32 v45, 4, v0
    s_lshl_b32 s61, s75, 11
    s_add_u32 s61, s61, 1310720
    buffer_store_dwordx4 v[40:43], v45, s[32:35], s61 offen sc0 sc1
    s_add_u32 s61, s61, 65536
    buffer_store_dwordx4 v[40:43], v45, s[32:35], s61 offen sc0 sc1
    s_waitcnt vmcnt(0)
    s_barrier
    s_cmp_lg_u32 s56, 7
    s_cbranch_scc1 Lcq_35
    v_mov_b32 v45, 1
    v_mov_b32 v46, 0
    s_mov_b64 s[94:95], exec
    s_mov_b64 exec, 1
    buffer_atomic_add v45, v46, s[52:55], s75 offen offset:0 sc1
    s_mov_b64 exec, s[94:95]
Lcq_35:
    v_lshlrev_b32 v44, 4, v0
    v_cmp_gt_u32 vcc, 7424, v44
    s_and_saveexec_b64 s[94:95], vcc
    s_cbranch_execz Lci_36
    buffer_store_dwordx4 v[40:43], v44, s[32:35], s93 offen sc0 sc1
Lci_36:
    s_mov_b64 exec, s[94:95]
    s_cmp_lg_u32 s56, 5
    s_cbranch_scc1 Lcq_37
    v_mov_b32 v46, 0
    v_mov_b32 v47, 65536
    s_lshl_b32 s61, s75, 8
    s_add_u32 s61, s61, 1507328
    s_mov_b64 s[94:95], exec
    s_mov_b64 exec, 1
    buffer_store_dword v47, v46, s[32:35], s61 offen sc0 sc1
    s_mov_b64 exec, s[94:95]
Lcq_37:
    s_cmp_lg_u32 s56, 6
    s_cbranch_scc1 Lcq_38
    s_lshl_b32 s61, s75, 10
    s_add_u32 s61, s61, 1146880
    buffer_store_dwordx4 v[40:43], v5, s[32:35], s61 offen sc0 sc1
Lcq_38:
    s_cmp_eq_u32 s78, 0
    s_cselect_b32 s36, s8, s22
    s_cselect_b32 s37, s9, s23
    s_cselect_b32 s40, s4, s16
    s_cselect_b32 s41, s5, s17
    s_and_b32 s37, s37, 0xffff
    s_and_b32 s41, s41, 0xffff
    buffer_load_dwordx4 v[192:195], v232, s[36:39], s77 offen nt
    s_add_u32 s77, s77, 8192
    buffer_load_dwordx4 v[196:199], v232, s[36:39], s77 offen nt
    s_add_u32 s77, s77, 8192
    buffer_load_dwordx4 v[200:203], v232, s[36:39], s77 offen nt
    s_add_u32 s77, s77, 8192
    buffer_load_dwordx4 v[204:207], v232, s[36:39], s77 offen nt
    buffer_load_dwordx2 v[208:209], v231, s[40:43], s76 offen offset:0
    buffer_load_dwordx2 v[210:211], v231, s[40:43], s76 offen offset:1024
    s_cmp_lt_u32 s75, 32
    s_cbranch_scc1 L_roleT1
    s_sub_u32 s65, s75, 32
    s_waitcnt vmcnt(0)
    s_barrier
    s_cmp_lg_u32 s56, 1
    s_cbranch_scc1 Lsc_39
    v_mov_b32 v40, 1
    v_mov_b32 v41, 0
    s_mov_b64 s[94:95], exec
    s_mov_b64 exec, 1
    buffer_atomic_add v40, v41, s[52:55], 0 offen offset:128 sc1
    s_mov_b64 exec, s[94:95]
Lsc_39:
    s_lshl_b32 s61, s65, 18
    s_add_u32 s44, s6, s61
    s_addc_u32 s45, s7, 0
    s_and_b32 s45, s45, 0xffff
    s_mov_b32 s46, 262144
    s_mov_b32 s47, 0x00020000
    s_waitcnt vmcnt(0)
    v_perm_b32 v232, v196, v192, s68
    v_perm_b32 v233, v196, v192, s69
    v_perm_b32 v234, v197, v193, s68
    v_perm_b32 v235, v197, v193, s69
    v_perm_b32 v236, v198, v194, s68
    v_perm_b32 v237, v198, v194, s69
    v_perm_b32 v238, v199, v195, s68
    v_perm_b32 v239, v199, v195, s69
    v_dot2_f32_bf16 v212, v232, v208, 0
    v_dot2_f32_bf16 v213, v233, v208, 0
    v_dot2_f32_bf16 v214, v234, v208, 0
    v_dot2_f32_bf16 v215, v235, v208, 0
    v_dot2_f32_bf16 v216, v236, v208, 0
    v_dot2_f32_bf16 v217, v237, v208, 0
    v_dot2_f32_bf16 v218, v238, v208, 0
    v_dot2_f32_bf16 v219, v239, v208, 0
    v_dot2_f32_bf16 v220, v232, v210, 0
    v_dot2_f32_bf16 v221, v233, v210, 0
    v_dot2_f32_bf16 v222, v234, v210, 0
    v_dot2_f32_bf16 v223, v235, v210, 0
    v_dot2_f32_bf16 v224, v236, v210, 0
    v_dot2_f32_bf16 v225, v237, v210, 0
    v_dot2_f32_bf16 v226, v238, v210, 0
    v_dot2_f32_bf16 v227, v239, v210, 0
    v_perm_b32 v232, v204, v200, s68
    v_perm_b32 v233, v204, v200, s69
    v_perm_b32 v234, v205, v201, s68
    v_perm_b32 v235, v205, v201, s69
    v_perm_b32 v236, v206, v202, s68
    v_perm_b32 v237, v206, v202, s69
    v_perm_b32 v238, v207, v203, s68
    v_perm_b32 v239, v207, v203, s69
    v_dot2_f32_bf16 v212, v232, v209, v212
    v_dot2_f32_bf16 v213, v233, v209, v213
    v_dot2_f32_bf16 v214, v234, v209, v214
    v_dot2_f32_bf16 v215, v235, v209, v215
    v_dot2_f32_bf16 v216, v236, v209, v216
    v_dot2_f32_bf16 v217, v237, v209, v217
    v_dot2_f32_bf16 v218, v238, v209, v218
    v_dot2_f32_bf16 v219, v239, v209, v219
    v_dot2_f32_bf16 v220, v232, v211, v220
    v_dot2_f32_bf16 v221, v233, v211, v221
    v_dot2_f32_bf16 v222, v234, v211, v222
    v_dot2_f32_bf16 v223, v235, v211, v223
    v_dot2_f32_bf16 v224, v236, v211, v224
    v_dot2_f32_bf16 v225, v237, v211, v225
    v_dot2_f32_bf16 v226, v238, v211, v226
    v_dot2_f32_bf16 v227, v239, v211, v227
    s_nop 2
    v_permlane32_swap_b32 v212, v220
    v_permlane32_swap_b32 v213, v221
    v_permlane32_swap_b32 v214, v222
    v_permlane32_swap_b32 v215, v223
    v_permlane32_swap_b32 v216, v224
    v_permlane32_swap_b32 v217, v225
    v_permlane32_swap_b32 v218, v226
    v_permlane32_swap_b32 v219, v227
    s_nop 1
    v_add_f32 v212, v212, v220
    v_add_f32 v213, v213, v221
    v_add_f32 v214, v214, v222
    v_add_f32 v215, v215, v223
    v_add_f32 v216, v216, v224
    v_add_f32 v217, v217, v225
    v_add_f32 v218, v218, v226
    v_add_f32 v219, v219, v227
    s_nop 1
    v_permlane16_swap_b32 v212, v216
    v_permlane16_swap_b32 v213, v217
    v_permlane16_swap_b32 v214, v218
    v_permlane16_swap_b32 v215, v219
    s_nop 1
    v_add_f32 v212, v212, v216
    v_add_f32 v213, v213, v217
    v_add_f32 v214, v214, v218
    v_add_f32 v215, v215, v219
    s_nop 1
    v_add_f32_dpp v212, v212, v212 row_ror:8 row_mask:0xf bank_mask:0xf
    v_add_f32_dpp v213, v213, v213 row_ror:8 row_mask:0xf bank_mask:0xf
    v_add_f32_dpp v214, v214, v214 row_ror:8 row_mask:0xf bank_mask:0xf
    v_add_f32_dpp v215, v215, v215 row_ror:8 row_mask:0xf bank_mask:0xf
    v_lshrrev_b32 v232, 5, v228
    v_lshlrev_b32 v232, 8, v232
    v_bfe_u32 v233, v228, 4, 1
    v_lshl_add_u32 v232, v233, 4, v232
    v_lshl_add_u32 v232, v230, 5, v232
    s_lshl_b32 s61, s56, 9
    s_add_u32 s61, s61, 147456
    v_add_u32 v232, s61, v232
    ds_write_b128 v232, v[212:215]
    s_waitcnt lgkmcnt(0)
    s_barrier
    s_cmp_lg_u32 s56, 0
    s_cbranch_scc1 Ls1p_40
    v_mov_b32 v234, 0
    buffer_load_dword v235, v234, s[52:55], s91 offen offset:0 sc0 sc1
    v_and_b32 v232, 31, v228
    v_lshlrev_b32 v233, 4, v232
    v_add_u32 v233, 147456, v233
    ds_read_b128 v[192:195], v233 offset:0
    ds_read_b128 v[196:199], v233 offset:512
    ds_read_b128 v[200:203], v233 offset:1024
    ds_read_b128 v[204:207], v233 offset:1536
    ds_read_b128 v[208:211], v233 offset:2048
    ds_read_b128 v[212:215], v233 offset:2560
    ds_read_b128 v[216:219], v233 offset:3072
    ds_read_b128 v[220:223], v233 offset:3584
    s_waitcnt lgkmcnt(6)
    v_add_f32 v192, v192, v196
    v_add_f32 v193, v193, v197
    v_add_f32 v194, v194, v198
    v_add_f32 v195, v195, v199
    s_waitcnt lgkmcnt(5)
    v_add_f32 v192, v192, v200
    v_add_f32 v193, v193, v201
    v_add_f32 v194, v194, v202
    v_add_f32 v195, v195, v203
    s_waitcnt lgkmcnt(4)
    v_add_f32 v192, v192, v204
    v_add_f32 v193, v193, v205
    v_add_f32 v194, v194, v206
    v_add_f32 v195, v195, v207
    s_waitcnt lgkmcnt(3)
    v_add_f32 v192, v192, v208
    v_add_f32 v193, v193, v209
    v_add_f32 v194, v194, v210
    v_add_f32 v195, v195, v211
    s_waitcnt lgkmcnt(2)
    v_add_f32 v192, v192, v212
    v_add_f32 v193, v193, v213
    v_add_f32 v194, v194, v214
    v_add_f32 v195, v195, v215
    s_waitcnt lgkmcnt(1)
    v_add_f32 v192, v192, v216
    v_add_f32 v193, v193, v217
    v_add_f32 v194, v194, v218
    v_add_f32 v195, v195, v219
    s_waitcnt lgkmcnt(0)
    v_add_f32 v192, v192, v220
    v_add_f32 v193, v193, v221
    v_add_f32 v194, v194, v222
    v_add_f32 v195, v195, v223
    v_lshrrev_b32 v233, 4, v232
    v_lshlrev_b32 v233, 10, v233
    v_and_b32 v232, 15, v232
    v_lshl_add_u32 v233, v232, 4, v233
    s_waitcnt vmcnt(0)
    s_mov_b32 s92, 0
Lcf_41:
    v_readfirstlane_b32 s57, v235
    s_nop 3
    s_cmp_lg_u32 s57, 0
    s_cbranch_scc1 Lcfd_42
    s_sleep 2
    buffer_load_dword v235, v234, s[52:55], s91 offen offset:0 sc0 sc1
    s_waitcnt vmcnt(0)
    s_add_u32 s92, s92, 1
    s_cmp_lt_u32 s92, 400000
    s_cbranch_scc1 Lcf_41
Lcfd_42:
    s_mov_b64 exec, 0xffffffff
    buffer_store_dwordx4 v[192:195], v233, s[32:35], s3 offen sc0 sc1
    s_mov_b64 exec, -1
Ls1p_40:
    s_lshl_b32 s61, s56, 14
    s_add_u32 m0, s61, 0
    v_xor_b32 v52, 0, v5
    s_add_u32 s62, s61, 0
    buffer_load_dwordx4 v52, s[44:47], s62 offen nt lds
    s_add_u32 m0, s61, 1024
    v_xor_b32 v53, 64, v5
    s_add_u32 s62, s61, 1024
    buffer_load_dwordx4 v53, s[44:47], s62 offen nt lds
    s_add_u32 m0, s61, 2048
    v_xor_b32 v52, 128, v5
    s_add_u32 s62, s61, 2048
    buffer_load_dwordx4 v52, s[44:47], s62 offen nt lds
    s_add_u32 m0, s61, 3072
    v_xor_b32 v53, 192, v5
    s_add_u32 s62, s61, 3072
    buffer_load_dwordx4 v53, s[44:47], s62 offen nt lds
    s_add_u32 m0, s61, 4096
    v_xor_b32 v52, 0, v5
    s_add_u32 s62, s61, 4096
    buffer_load_dwordx4 v52, s[44:47], s62 offen nt lds
    s_add_u32 m0, s61, 5120
    v_xor_b32 v53, 64, v5
    s_add_u32 s62, s61, 5120
    buffer_load_dwordx4 v53, s[44:47], s62 offen nt lds
    s_add_u32 m0, s61, 6144
    v_xor_b32 v52, 128, v5
    s_add_u32 s62, s61, 6144
    buffer_load_dwordx4 v52, s[44:47], s62 offen nt lds
    s_add_u32 m0, s61, 7168
    v_xor_b32 v53, 192, v5
    s_add_u32 s62, s61, 7168
    buffer_load_dwordx4 v53, s[44:47], s62 offen nt lds
    s_add_u32 m0, s61, 8192
    v_xor_b32 v52, 32, v5
    s_add_u32 s62, s61, 8192
    buffer_load_dwordx4 v52, s[44:47], s62 offen nt lds
    s_add_u32 m0, s61, 9216
    v_xor_b32 v53, 96, v5
    s_add_u32 s62, s61, 9216
    buffer_load_dwordx4 v53, s[44:47], s62 offen nt lds
    s_add_u32 m0, s61, 10240
    v_xor_b32 v52, 160, v5
    s_add_u32 s62, s61, 10240
    buffer_load_dwordx4 v52, s[44:47], s62 offen nt lds
    s_add_u32 m0, s61, 11264
    v_xor_b32 v53, 224, v5
    s_add_u32 s62, s61, 11264
    buffer_load_dwordx4 v53, s[44:47], s62 offen nt lds
    s_add_u32 m0, s61, 12288
    v_xor_b32 v52, 32, v5
    s_add_u32 s62, s61, 12288
    buffer_load_dwordx4 v52, s[44:47], s62 offen nt lds
    s_add_u32 m0, s61, 13312
    v_xor_b32 v53, 96, v5
    s_add_u32 s62, s61, 13312
    buffer_load_dwordx4 v53, s[44:47], s62 offen nt lds
    s_add_u32 m0, s61, 14336
    v_xor_b32 v52, 160, v5
    s_add_u32 s62, s61, 14336
    buffer_load_dwordx4 v52, s[44:47], s62 offen nt lds
    s_add_u32 m0, s61, 15360
    v_xor_b32 v53, 224, v5
    s_add_u32 s62, s61, 15360
    buffer_load_dwordx4 v53, s[44:47], s62 offen nt lds
    s_barrier
    s_lshr_b32 s66, s65, 4
    s_and_b32 s67, s65, 15
    s_and_b32 s63, s56, 3
    s_lshr_b32 s64, s56, 2
    v_and_b32 v40, 3, v3
    v_lshlrev_b32 v40, 2, v40
    v_lshrrev_b32 v41, 3, v3
    v_lshl_or_b32 v40, v41, 1, v40
    s_lshl_b32 s61, s63, 15
    v_lshlrev_b32 v41, 10, v3
    v_add_u32 v41, s61, v41
    v_add_u32 v42, 0, v2
    v_xor_b32 v42, v42, v40
    v_lshl_add_u32 v8, v42, 4, v41
    v_add_u32 v42, 4, v2
    v_xor_b32 v42, v42, v40
    v_lshl_add_u32 v9, v42, 4, v41
    v_add_u32 v42, 8, v2
    v_xor_b32 v42, v42, v40
    v_lshl_add_u32 v10, v42, 4, v41
    v_add_u32 v42, 12, v2
    v_xor_b32 v42, v42, v40
    v_lshl_add_u32 v11, v42, 4, v41
    s_lshl_b32 s61, s64, 14
    s_add_u32 s61, s61, 131072
    s_lshl_b32 s62, s63, 15
    s_sub_u32 s61, s61, s62
    v_lshrrev_b32 v43, 1, v2
    v_and_b32 v44, 1, v2
    v_lshrrev_b32 v45, 2, v3
    v_lshl_add_u32 v46, v43, 3, v45
    v_lshlrev_b32 v47, 2, v45
    v_lshl_or_b32 v47, v43, 1, v47
    v_bfe_u32 v48, v3, 1, 1
    v_lshl_add_u32 v48, v44, 1, v48
    s_lshl_b32 s62, s56, 3
    s_add_u32 s62, s62, 0
    v_add_u32 v48, s62, v48
    v_xor_b32 v48, v48, v47
    v_lshlrev_b32 v48, 4, v48
    v_lshl_add_u32 v48, v46, 10, v48
    v_and_b32 v49, 1, v3
    v_lshl_add_u32 v12, v49, 3, v48
    v_bfe_u32 v48, v3, 1, 1
    v_lshl_add_u32 v48, v44, 1, v48
    s_lshl_b32 s62, s56, 3
    s_add_u32 s62, s62, 4
    v_add_u32 v48, s62, v48
    v_xor_b32 v48, v48, v47
    v_lshlrev_b32 v48, 4, v48
    v_lshl_add_u32 v48, v46, 10, v48
    v_and_b32 v49, 1, v3
    v_lshl_add_u32 v13, v49, 3, v48
    v_lshl_add_u32 v46, v43, 3, v45
    v_add_u32 v46, 4, v46
    v_lshlrev_b32 v47, 2, v45
    v_lshl_or_b32 v47, v43, 1, v47
    v_bfe_u32 v48, v3, 1, 1
    v_lshl_add_u32 v48, v44, 1, v48
    s_lshl_b32 s62, s56, 3
    s_add_u32 s62, s62, 0
    v_add_u32 v48, s62, v48
    v_xor_b32 v48, v48, v47
    v_lshlrev_b32 v48, 4, v48
    v_lshl_add_u32 v48, v46, 10, v48
    v_and_b32 v49, 1, v3
    v_lshl_add_u32 v14, v49, 3, v48
    v_bfe_u32 v48, v3, 1, 1
    v_lshl_add_u32 v48, v44, 1, v48
    s_lshl_b32 s62, s56, 3
    s_add_u32 s62, s62, 4
    v_add_u32 v48, s62, v48
    v_xor_b32 v48, v48, v47
    v_lshlrev_b32 v48, 4, v48
    v_lshl_add_u32 v48, v46, 10, v48
    v_and_b32 v49, 1, v3
    v_lshl_add_u32 v15, v49, 3, v48
    v_and_b32 v43, 31, v1
    v_lshrrev_b32 v44, 5, v1
    v_mul_u32_u24 v16, 272, v43
    v_lshl_add_u32 v16, v44, 4, v16
    v_add_u32 v16, 131072, v16
    v_lshlrev_b32 v23, 4, v43
    v_add_u32 v23, 139776, v23
    s_lshl_b32 s62, s64, 4
    v_add_u32 v43, s62, v3
    v_mul_u32_u24 v17, 272, v43
    v_lshl_add_u32 v17, v2, 3, v17
    s_lshl_b32 s62, s63, 6
    s_add_u32 s62, s62, 131072
    v_add_u32 v17, s62, v17
    v_lshlrev_b32 v22, 4, v43
    v_add_u32 v22, 139776, v22
    s_lshl_b32 s62, s63, 2
    v_add_u32 v21, s62, v22
    v_add_u32 v33, s61, v8
    v_mov_b32 v18, 0xff7fffff
    v_mov_b32 v20, 0xff7fffff
    v_mov_b32 v19, 0
    s_mov_b32 s100, s61
    s_cmp_lt_u32 s56, 4
    s_cbranch_scc1 Lqa0_43
    s_waitcnt vmcnt(0)
    s_lshl_b32 s61, s56, 14
    s_add_u32 s61, s61, 131072
    buffer_load_dwordx4 v[128:131], v5, s[44:47], s61 offen offset:0 nt
    buffer_load_dwordx4 v[132:135], v5, s[44:47], s61 offen offset:1024 nt
    buffer_load_dwordx4 v[136:139], v5, s[44:47], s61 offen offset:2048 nt
    buffer_load_dwordx4 v[140:143], v5, s[44:47], s61 offen offset:3072 nt
    s_add_u32 s61, s61, 4096
    buffer_load_dwordx4 v[144:147], v5, s[44:47], s61 offen offset:0 nt
    buffer_load_dwordx4 v[148:151], v5, s[44:47], s61 offen offset:1024 nt
    buffer_load_dwordx4 v[152:155], v5, s[44:47], s61 offen offset:2048 nt
    buffer_load_dwordx4 v[156:159], v5, s[44:47], s61 offen offset:3072 nt
    s_add_u32 s61, s61, 4096
    buffer_load_dwordx4 v[160:163], v5, s[44:47], s61 offen offset:0 nt
    buffer_load_dwordx4 v[164:167], v5, s[44:47], s61 offen offset:1024 nt
    buffer_load_dwordx4 v[168:171], v5, s[44:47], s61 offen offset:2048 nt
    buffer_load_dwordx4 v[172:175], v5, s[44:47], s61 offen offset:3072 nt
    s_add_u32 s61, s61, 4096
    buffer_load_dwordx4 v[176:179], v5, s[44:47], s61 offen offset:0 nt
    buffer_load_dwordx4 v[180:183], v5, s[44:47], s61 offen offset:1024 nt
    buffer_load_dwordx4 v[184:187], v5, s[44:47], s61 offen offset:2048 nt
    buffer_load_dwordx4 v[188:191], v5, s[44:47], s61 offen offset:3072 nt
    s_branch Lqaj_44
Lqa0_43:
    v_mov_b32 v40, 0
    s_mov_b32 s92, 0
Lcf_45:
    buffer_load_dword v41, v40, s[52:55], 0 offen offset:128 sc0 sc1
    s_waitcnt vmcnt(0)
    v_readfirstlane_b32 s57, v41
    s_nop 3
    s_cmp_ge_u32 s57, 64
    s_cbranch_scc1 Lcfd_46
    s_sleep 16
    s_add_u32 s92, s92, 1
    s_cmp_lt_u32 s92, 400000
    s_cbranch_scc1 Lcf_45
Lcfd_46:
    s_lshl_b32 s61, s66, 15
    s_lshl_b32 s62, s56, 13
    s_add_u32 s61, s61, s62
    s_add_u32 s61, s61, 1146880
    s_add_u32 s62, s61, 4096
    s_mov_b32 s92, 0
Lpoll_47:
    buffer_load_dwordx4 v[64:67], v5, s[32:35], s61 offen offset:0 sc0 sc1
    buffer_load_dwordx4 v[68:71], v5, s[32:35], s61 offen offset:1024 sc0 sc1
    buffer_load_dwordx4 v[72:75], v5, s[32:35], s61 offen offset:2048 sc0 sc1
    buffer_load_dwordx4 v[76:79], v5, s[32:35], s61 offen offset:3072 sc0 sc1
    buffer_load_dwordx4 v[80:83], v5, s[32:35], s62 offen offset:0 sc0 sc1
    buffer_load_dwordx4 v[84:87], v5, s[32:35], s62 offen offset:1024 sc0 sc1
    buffer_load_dwordx4 v[88:91], v5, s[32:35], s62 offen offset:2048 sc0 sc1
    buffer_load_dwordx4 v[92:95], v5, s[32:35], s62 offen offset:3072 sc0 sc1
    s_waitcnt vmcnt(0)
    v_mov_b32 v40, v64
    v_max3_u32 v40, v40, v65, v66
    v_max3_u32 v40, v40, v67, v68
    v_max3_u32 v40, v40, v69, v70
    v_max3_u32 v40, v40, v71, v72
    v_max3_u32 v40, v40, v73, v74
    v_max3_u32 v40, v40, v75, v76
    v_max3_u32 v40, v40, v77, v78
    v_max3_u32 v40, v40, v79, v80
    v_max3_u32 v40, v40, v81, v82
    v_max3_u32 v40, v40, v83, v84
    v_max3_u32 v40, v40, v85, v86
    v_max3_u32 v40, v40, v87, v88
    v_max3_u32 v40, v40, v89, v90
    v_max3_u32 v40, v40, v91, v92
    v_max3_u32 v40, v40, v93, v94
    v_max_u32 v40, v40, v95
    v_cmpx_eq_u32 vcc, -1, v40
    s_cbranch_execz Lpolld_48
    s_sleep 4
    s_add_u32 s92, s92, 1
    s_cmp_lt_u32 s92, 400000
    s_cbranch_scc1 Lpoll_47
Lpolld_48:
    s_mov_b64 exec, -1
    s_and_b32 s62, s56, 1
    s_lshl_b32 s62, s62, 5
    s_lshl_b32 s61, s56, 13
    s_add_u32 s61, s61, 131072
    s_add_u32 s57, s62, 0
    v_xor_b32 v40, s57, v5
    v_add_u32 v40, s61, v40
    ds_write_b128 v40, v[64:67] offset:0
    s_add_u32 s57, s62, 64
    v_xor_b32 v41, s57, v5
    v_add_u32 v41, s61, v41
    ds_write_b128 v41, v[68:71] offset:1024
    s_add_u32 s57, s62, 128
    v_xor_b32 v42, s57, v5
    v_add_u32 v42, s61, v42
    ds_write_b128 v42, v[72:75] offset:2048
    s_add_u32 s57, s62, 192
    v_xor_b32 v43, s57, v5
    v_add_u32 v43, s61, v43
    ds_write_b128 v43, v[76:79] offset:3072
    s_add_u32 s57, s62, 0
    v_xor_b32 v40, s57, v5
    v_add_u32 v40, s61, v40
    ds_write_b128 v40, v[80:83] offset:4096
    s_add_u32 s57, s62, 64
    v_xor_b32 v41, s57, v5
    v_add_u32 v41, s61, v41
    ds_write_b128 v41, v[84:87] offset:5120
    s_add_u32 s57, s62, 128
    v_xor_b32 v42, s57, v5
    v_add_u32 v42, s61, v42
    ds_write_b128 v42, v[88:91] offset:6144
    s_add_u32 s57, s62, 192
    v_xor_b32 v43, s57, v5
    v_add_u32 v43, s61, v43
    ds_write_b128 v43, v[92:95] offset:7168
    s_waitcnt lgkmcnt(0)
    s_lshl_b32 s61, s56, 14
    s_add_u32 s61, s61, 131072
    buffer_load_dwordx4 v[128:131], v5, s[44:47], s61 offen offset:0 nt
    buffer_load_dwordx4 v[132:135], v5, s[44:47], s61 offen offset:1024 nt
    buffer_load_dwordx4 v[136:139], v5, s[44:47], s61 offen offset:2048 nt
    buffer_load_dwordx4 v[140:143], v5, s[44:47], s61 offen offset:3072 nt
    s_add_u32 s61, s61, 4096
    buffer_load_dwordx4 v[144:147], v5, s[44:47], s61 offen offset:0 nt
    buffer_load_dwordx4 v[148:151], v5, s[44:47], s61 offen offset:1024 nt
    buffer_load_dwordx4 v[152:155], v5, s[44:47], s61 offen offset:2048 nt
    buffer_load_dwordx4 v[156:159], v5, s[44:47], s61 offen offset:3072 nt
    s_add_u32 s61, s61, 4096
    buffer_load_dwordx4 v[160:163], v5, s[44:47], s61 offen offset:0 nt
    buffer_load_dwordx4 v[164:167], v5, s[44:47], s61 offen offset:1024 nt
    buffer_load_dwordx4 v[168:171], v5, s[44:47], s61 offen offset:2048 nt
    buffer_load_dwordx4 v[172:175], v5, s[44:47], s61 offen offset:3072 nt
    s_add_u32 s61, s61, 4096
    buffer_load_dwordx4 v[176:179], v5, s[44:47], s61 offen offset:0 nt
    buffer_load_dwordx4 v[180:183], v5, s[44:47], s61 offen offset:1024 nt
    buffer_load_dwordx4 v[184:187], v5, s[44:47], s61 offen offset:2048 nt
    buffer_load_dwordx4 v[188:191], v5, s[44:47], s61 offen offset:3072 nt
Lqaj_44:
    s_barrier
    v_add_u32 v40, s100, v8
    v_add_u32 v41, s100, v9
    v_add_u32 v42, s100, v10
    v_add_u32 v43, s100, v11
    ds_read_b128 v[192:195], v40 offset:0
    ds_read_b128 v[196:199], v41 offset:0
    ds_read_b128 v[200:203], v42 offset:0
    ds_read_b128 v[204:207], v43 offset:0
    ds_read_b128 v[208:211], v40 offset:256
    ds_read_b128 v[212:215], v41 offset:256
    ds_read_b128 v[216:219], v42 offset:256
    ds_read_b128 v[220:223], v43 offset:256
    ds_read_b128 v[224:227], v40 offset:512
    ds_read_b128 v[228:231], v41 offset:512
    ds_read_b128 v[232:235], v42 offset:512
    ds_read_b128 v[236:239], v43 offset:512
    ds_read_b128 v[240:243], v40 offset:768
    ds_read_b128 v[244:247], v41 offset:768
    ds_read_b128 v[248:251], v42 offset:768
    ds_read_b128 v[252:255], v43 offset:768
    s_waitcnt lgkmcnt(0)
    s_barrier
    ds_read_b128 v[96:99], v8 offset:0
    ds_read_b128 v[100:103], v8 offset:16384
    ds_read_b128 v[104:107], v9 offset:0
    ds_read_b128 v[108:111], v9 offset:16384
    ds_read_b128 v[112:115], v10 offset:0
    ds_read_b128 v[116:119], v10 offset:16384
    ds_read_b128 v[120:123], v11 offset:0
    ds_read_b128 v[124:127], v11 offset:16384
    s_waitcnt lgkmcnt(7)
    v_mfma_f32_16x16x32_bf16 v[24:27], v[96:99], v[192:195], 0
    ds_read_b128 v[96:99], v8 offset:256
    s_waitcnt lgkmcnt(7)
    v_mfma_f32_16x16x32_bf16 v[28:31], v[100:103], v[192:195], 0
    ds_read_b128 v[100:103], v8 offset:16640
    s_waitcnt lgkmcnt(7)
    v_mfma_f32_16x16x32_bf16 v[24:27], v[104:107], v[196:199], v[24:27]
    ds_read_b128 v[104:107], v9 offset:256
    s_waitcnt lgkmcnt(7)
    v_mfma_f32_16x16x32_bf16 v[28:31], v[108:111], v[196:199], v[28:31]
    ds_read_b128 v[108:111], v9 offset:16640
    s_waitcnt lgkmcnt(7)
    v_mfma_f32_16x16x32_bf16 v[24:27], v[112:115], v[200:203], v[24:27]
    ds_read_b128 v[112:115], v10 offset:256
    s_waitcnt lgkmcnt(7)
    v_mfma_f32_16x16x32_bf16 v[28:31], v[116:119], v[200:203], v[28:31]
    ds_read_b128 v[116:119], v10 offset:16640
    s_waitcnt lgkmcnt(7)
    v_mfma_f32_16x16x32_bf16 v[24:27], v[120:123], v[204:207], v[24:27]
    ds_read_b128 v[120:123], v11 offset:256
    s_waitcnt lgkmcnt(7)
    v_mfma_f32_16x16x32_bf16 v[28:31], v[124:127], v[204:207], v[28:31]
    ds_read_b128 v[124:127], v11 offset:16640
    s_waitcnt lgkmcnt(7)
    v_mfma_f32_16x16x32_bf16 v[24:27], v[96:99], v[208:211], v[24:27]
    ds_read_b128 v[96:99], v8 offset:512
    s_waitcnt lgkmcnt(7)
    v_mfma_f32_16x16x32_bf16 v[28:31], v[100:103], v[208:211], v[28:31]
    ds_read_b128 v[100:103], v8 offset:16896
    s_waitcnt lgkmcnt(7)
    v_mfma_f32_16x16x32_bf16 v[24:27], v[104:107], v[212:215], v[24:27]
    ds_read_b128 v[104:107], v9 offset:512
    s_waitcnt lgkmcnt(7)
    v_mfma_f32_16x16x32_bf16 v[28:31], v[108:111], v[212:215], v[28:31]
    ds_read_b128 v[108:111], v9 offset:16896
    s_waitcnt lgkmcnt(7)
    v_mfma_f32_16x16x32_bf16 v[24:27], v[112:115], v[216:219], v[24:27]
    ds_read_b128 v[112:115], v10 offset:512
    s_waitcnt lgkmcnt(7)
    v_mfma_f32_16x16x32_bf16 v[28:31], v[116:119], v[216:219], v[28:31]
    ds_read_b128 v[116:119], v10 offset:16896
    s_waitcnt lgkmcnt(7)
    v_mfma_f32_16x16x32_bf16 v[24:27], v[120:123], v[220:223], v[24:27]
    ds_read_b128 v[120:123], v11 offset:512
    s_waitcnt lgkmcnt(7)
    v_mfma_f32_16x16x32_bf16 v[28:31], v[124:127], v[220:223], v[28:31]
    ds_read_b128 v[124:127], v11 offset:16896
    s_waitcnt lgkmcnt(7)
    v_mfma_f32_16x16x32_bf16 v[24:27], v[96:99], v[224:227], v[24:27]
    ds_read_b128 v[96:99], v8 offset:768
    s_waitcnt lgkmcnt(7)
    v_mfma_f32_16x16x32_bf16 v[28:31], v[100:103], v[224:227], v[28:31]
    ds_read_b128 v[100:103], v8 offset:17152
    s_waitcnt lgkmcnt(7)
    v_mfma_f32_16x16x32_bf16 v[24:27], v[104:107], v[228:231], v[24:27]
    ds_read_b128 v[104:107], v9 offset:768
    s_waitcnt lgkmcnt(7)
    v_mfma_f32_16x16x32_bf16 v[28:31], v[108:111], v[228:231], v[28:31]
    ds_read_b128 v[108:111], v9 offset:17152
    s_waitcnt lgkmcnt(7)
    v_mfma_f32_16x16x32_bf16 v[24:27], v[112:115], v[232:235], v[24:27]
    ds_read_b128 v[112:115], v10 offset:768
    s_waitcnt lgkmcnt(7)
    v_mfma_f32_16x16x32_bf16 v[28:31], v[116:119], v[232:235], v[28:31]
    ds_read_b128 v[116:119], v10 offset:17152
    s_waitcnt lgkmcnt(7)
    v_mfma_f32_16x16x32_bf16 v[24:27], v[120:123], v[236:239], v[24:27]
    ds_read_b128 v[120:123], v11 offset:768
    s_waitcnt lgkmcnt(7)
    v_mfma_f32_16x16x32_bf16 v[28:31], v[124:127], v[236:239], v[28:31]
    ds_read_b128 v[124:127], v11 offset:17152
    s_waitcnt lgkmcnt(7)
    v_mfma_f32_16x16x32_bf16 v[24:27], v[96:99], v[240:243], v[24:27]
    s_waitcnt lgkmcnt(6)
    v_mfma_f32_16x16x32_bf16 v[28:31], v[100:103], v[240:243], v[28:31]
    s_waitcnt lgkmcnt(5)
    v_mfma_f32_16x16x32_bf16 v[24:27], v[104:107], v[244:247], v[24:27]
    s_waitcnt lgkmcnt(4)
    v_mfma_f32_16x16x32_bf16 v[28:31], v[108:111], v[244:247], v[28:31]
    s_waitcnt lgkmcnt(3)
    v_mfma_f32_16x16x32_bf16 v[24:27], v[112:115], v[248:251], v[24:27]
    s_waitcnt lgkmcnt(2)
    v_mfma_f32_16x16x32_bf16 v[28:31], v[116:119], v[248:251], v[28:31]
    s_waitcnt lgkmcnt(1)
    v_mfma_f32_16x16x32_bf16 v[24:27], v[120:123], v[252:255], v[24:27]
    s_waitcnt lgkmcnt(0)
    v_mfma_f32_16x16x32_bf16 v[28:31], v[124:127], v[252:255], v[28:31]
    s_nop 7
    s_nop 1
    v_max3_f32 v40, v24, v25, v26
    v_max3_f32 v40, v40, v27, v28
    v_max3_f32 v40, v40, v29, v30
    v_max_f32 v40, v40, v31
    v_mov_b32 v41, v40
    s_nop 1
    v_permlane32_swap_b32 v40, v41
    s_nop 1
    v_max_f32 v40, v40, v41
    v_mov_b32 v41, v40
    s_nop 1
    v_permlane16_swap_b32 v40, v41
    s_nop 1
    v_max_f32 v40, v40, v41
    ds_write_b32 v21, v40
    s_waitcnt lgkmcnt(0)
    s_barrier
    ds_read_b128 v[40:43], v22
    ds_read_b128 v[44:47], v23
    s_waitcnt lgkmcnt(1)
    v_max3_f32 v40, v40, v41, v42
    v_max3_f32 v20, v40, v43, v20
    v_sub_f32 v24, v24, v20
    v_sub_f32 v25, v25, v20
    v_sub_f32 v26, v26, v20
    v_sub_f32 v27, v27, v20
    v_sub_f32 v28, v28, v20
    v_sub_f32 v29, v29, v20
    v_sub_f32 v30, v30, v20
    v_sub_f32 v31, v31, v20
    v_exp_f32 v24, v24
    v_exp_f32 v25, v25
    v_exp_f32 v26, v26
    v_exp_f32 v27, v27
    v_exp_f32 v28, v28
    v_exp_f32 v29, v29
    v_exp_f32 v30, v30
    v_exp_f32 v31, v31
    s_waitcnt lgkmcnt(0)
    v_max3_f32 v44, v44, v45, v46
    v_max3_f32 v44, v44, v47, v18
    v_sub_f32 v32, v18, v44
    v_exp_f32 v32, v32
    v_mov_b32 v18, v44
    v_add_f32 v40, v24, v25
    v_add_f32 v40, v40, v26
    v_add_f32 v40, v40, v27
    v_add_f32 v40, v40, v28
    v_add_f32 v40, v40, v29
    v_add_f32 v40, v40, v30
    v_add_f32 v40, v40, v31
    v_cvt_pk_bf16_f32 v48, v24, v25
    v_cvt_pk_bf16_f32 v49, v26, v27
    v_cvt_pk_bf16_f32 v50, v28, v29
    v_cvt_pk_bf16_f32 v51, v30, v31
    ds_write_b64 v17, v[48:49] offset:0
    ds_write_b64 v17, v[50:51] offset:32
    v_mov_b32 v41, v40
    s_nop 1
    v_permlane32_swap_b32 v40, v41
    s_nop 1
    v_add_f32 v40, v40, v41
    v_mov_b32 v41, v40
    s_nop 1
    v_permlane16_swap_b32 v40, v41
    s_nop 1
    v_add_f32 v40, v40, v41
    ds_write_b32 v21, v40 offset:512
    s_waitcnt lgkmcnt(0)
    s_barrier
    ds_read_b128 v[40:43], v23 offset:512
    ds_read_b128 v[96:99], v16 offset:0
    ds_read_b64_tr_b16 v[100:101], v12 offset:0
    ds_read_b64_tr_b16 v[102:103], v14 offset:0
    ds_read_b64_tr_b16 v[104:105], v13 offset:0
    ds_read_b64_tr_b16 v[106:107], v15 offset:0
    ds_read_b128 v[108:111], v16 offset:32
    ds_read_b64_tr_b16 v[112:113], v12 offset:16384
    ds_read_b64_tr_b16 v[114:115], v14 offset:16384
    ds_read_b64_tr_b16 v[116:117], v13 offset:16384
    ds_read_b64_tr_b16 v[118:119], v15 offset:16384
    s_waitcnt lgkmcnt(5)
    v_mfma_f32_32x32x16_bf16 v[64:79], v[100:103], v[96:99], 0
    v_mfma_f32_32x32x16_bf16 v[80:95], v[104:107], v[96:99], 0
    ds_read_b128 v[96:99], v16 offset:64
    ds_read_b64_tr_b16 v[100:101], v12 offset:32768
    ds_read_b64_tr_b16 v[102:103], v14 offset:32768
    ds_read_b64_tr_b16 v[104:105], v13 offset:32768
    ds_read_b64_tr_b16 v[106:107], v15 offset:32768
    s_waitcnt lgkmcnt(5)
    v_mfma_f32_32x32x16_bf16 v[64:79], v[112:115], v[108:111], v[64:79]
    v_mfma_f32_32x32x16_bf16 v[80:95], v[116:119], v[108:111], v[80:95]
    ds_read_b128 v[108:111], v16 offset:96
    ds_read_b64_tr_b16 v[112:113], v12 offset:49152
    ds_read_b64_tr_b16 v[114:115], v14 offset:49152
    ds_read_b64_tr_b16 v[116:117], v13 offset:49152
    ds_read_b64_tr_b16 v[118:119], v15 offset:49152
    s_waitcnt lgkmcnt(5)
    v_mfma_f32_32x32x16_bf16 v[64:79], v[100:103], v[96:99], v[64:79]
    v_mfma_f32_32x32x16_bf16 v[80:95], v[104:107], v[96:99], v[80:95]
    v_add_u32 v12, 0x10000, v12
    v_add_u32 v13, 0x10000, v13
    v_add_u32 v14, 0x10000, v14
    v_add_u32 v15, 0x10000, v15
    ds_read_b128 v[96:99], v16 offset:128
    ds_read_b64_tr_b16 v[100:101], v12 offset:0
    ds_read_b64_tr_b16 v[102:103], v14 offset:0
    ds_read_b64_tr_b16 v[104:105], v13 offset:0
    ds_read_b64_tr_b16 v[106:107], v15 offset:0
    s_waitcnt lgkmcnt(5)
    v_mfma_f32_32x32x16_bf16 v[64:79], v[112:115], v[108:111], v[64:79]
    v_mfma_f32_32x32x16_bf16 v[80:95], v[116:119], v[108:111], v[80:95]
    ds_read_b128 v[108:111], v16 offset:160
    ds_read_b64_tr_b16 v[112:113], v12 offset:16384
    ds_read_b64_tr_b16 v[114:115], v14 offset:16384
    ds_read_b64_tr_b16 v[116:117], v13 offset:16384
    ds_read_b64_tr_b16 v[118:119], v15 offset:16384
    s_waitcnt lgkmcnt(5)
    v_mfma_f32_32x32x16_bf16 v[64:79], v[100:103], v[96:99], v[64:79]
    v_mfma_f32_32x32x16_bf16 v[80:95], v[104:107], v[96:99], v[80:95]
    ds_read_b128 v[96:99], v16 offset:192
    ds_read_b64_tr_b16 v[100:101], v12 offset:32768
    ds_read_b64_tr_b16 v[102:103], v14 offset:32768
    ds_read_b64_tr_b16 v[104:105], v13 offset:32768
    ds_read_b64_tr_b16 v[106:107], v15 offset:32768
    s_waitcnt lgkmcnt(5)
    v_mfma_f32_32x32x16_bf16 v[64:79], v[112:115], v[108:111], v[64:79]
    v_mfma_f32_32x32x16_bf16 v[80:95], v[116:119], v[108:111], v[80:95]
    ds_read_b128 v[108:111], v16 offset:224
    ds_read_b64_tr_b16 v[112:113], v12 offset:49152
    ds_read_b64_tr_b16 v[114:115], v14 offset:49152
    ds_read_b64_tr_b16 v[116:117], v13 offset:49152
    ds_read_b64_tr_b16 v[118:119], v15 offset:49152
    s_waitcnt lgkmcnt(5)
    v_mfma_f32_32x32x16_bf16 v[64:79], v[100:103], v[96:99], v[64:79]
    v_mfma_f32_32x32x16_bf16 v[80:95], v[104:107], v[96:99], v[80:95]
    s_waitcnt lgkmcnt(0)
    v_mfma_f32_32x32x16_bf16 v[64:79], v[112:115], v[108:111], v[64:79]
    v_mfma_f32_32x32x16_bf16 v[80:95], v[116:119], v[108:111], v[80:95]
    v_subrev_u32 v12, 0x10000, v12
    v_subrev_u32 v13, 0x10000, v13
    v_subrev_u32 v14, 0x10000, v14
    v_subrev_u32 v15, 0x10000, v15
    v_add_f32 v40, v40, v41
    v_add_f32 v42, v42, v43
    v_add_f32 v40, v40, v42
    v_fma_f32 v19, v19, v32, v40
    s_barrier
    s_waitcnt vmcnt(0)
    s_lshl_b32 s61, s56, 14
    v_xor_b32 v40, 0, v5
    v_add_u32 v40, s61, v40
    ds_write_b128 v40, v[128:131] offset:0
    v_xor_b32 v41, 64, v5
    v_add_u32 v41, s61, v41
    ds_write_b128 v41, v[132:135] offset:1024
    v_xor_b32 v42, 128, v5
    v_add_u32 v42, s61, v42
    ds_write_b128 v42, v[136:139] offset:2048
    v_xor_b32 v43, 192, v5
    v_add_u32 v43, s61, v43
    ds_write_b128 v43, v[140:143] offset:3072
    v_xor_b32 v40, 0, v5
    v_add_u32 v40, s61, v40
    ds_write_b128 v40, v[144:147] offset:4096
    v_xor_b32 v41, 64, v5
    v_add_u32 v41, s61, v41
    ds_write_b128 v41, v[148:151] offset:5120
    v_xor_b32 v42, 128, v5
    v_add_u32 v42, s61, v42
    ds_write_b128 v42, v[152:155] offset:6144
    v_xor_b32 v43, 192, v5
    v_add_u32 v43, s61, v43
    ds_write_b128 v43, v[156:159] offset:7168
    v_xor_b32 v40, 32, v5
    v_add_u32 v40, s61, v40
    ds_write_b128 v40, v[160:163] offset:8192
    v_xor_b32 v41, 96, v5
    v_add_u32 v41, s61, v41
    ds_write_b128 v41, v[164:167] offset:9216
    v_xor_b32 v42, 160, v5
    v_add_u32 v42, s61, v42
    ds_write_b128 v42, v[168:171] offset:10240
    v_xor_b32 v43, 224, v5
    v_add_u32 v43, s61, v43
    ds_write_b128 v43, v[172:175] offset:11264
    v_xor_b32 v40, 32, v5
    v_add_u32 v40, s61, v40
    ds_write_b128 v40, v[176:179] offset:12288
    v_xor_b32 v41, 96, v5
    v_add_u32 v41, s61, v41
    ds_write_b128 v41, v[180:183] offset:13312
    v_xor_b32 v42, 160, v5
    v_add_u32 v42, s61, v42
    ds_write_b128 v42, v[184:187] offset:14336
    v_xor_b32 v43, 224, v5
    v_add_u32 v43, s61, v43
    ds_write_b128 v43, v[188:191] offset:15360
    s_waitcnt lgkmcnt(0)
    s_barrier
    ds_read_b128 v[96:99], v8 offset:0
    ds_read_b128 v[100:103], v8 offset:16384
    ds_read_b128 v[104:107], v9 offset:0
    ds_read_b128 v[108:111], v9 offset:16384
    ds_read_b128 v[112:115], v10 offset:0
    ds_read_b128 v[116:119], v10 offset:16384
    ds_read_b128 v[120:123], v11 offset:0
    ds_read_b128 v[124:127], v11 offset:16384
    s_waitcnt lgkmcnt(7)
    v_mfma_f32_16x16x32_bf16 v[24:27], v[96:99], v[192:195], 0
    ds_read_b128 v[96:99], v8 offset:256
    s_waitcnt lgkmcnt(7)
    v_mfma_f32_16x16x32_bf16 v[28:31], v[100:103], v[192:195], 0
    ds_read_b128 v[100:103], v8 offset:16640
    s_waitcnt lgkmcnt(7)
    v_mfma_f32_16x16x32_bf16 v[24:27], v[104:107], v[196:199], v[24:27]
    ds_read_b128 v[104:107], v9 offset:256
    s_waitcnt lgkmcnt(7)
    v_mfma_f32_16x16x32_bf16 v[28:31], v[108:111], v[196:199], v[28:31]
    ds_read_b128 v[108:111], v9 offset:16640
    s_waitcnt lgkmcnt(7)
    v_mfma_f32_16x16x32_bf16 v[24:27], v[112:115], v[200:203], v[24:27]
    ds_read_b128 v[112:115], v10 offset:256
    s_waitcnt lgkmcnt(7)
    v_mfma_f32_16x16x32_bf16 v[28:31], v[116:119], v[200:203], v[28:31]
    ds_read_b128 v[116:119], v10 offset:16640
    s_waitcnt lgkmcnt(7)
    v_mfma_f32_16x16x32_bf16 v[24:27], v[120:123], v[204:207], v[24:27]
    ds_read_b128 v[120:123], v11 offset:256
    s_waitcnt lgkmcnt(7)
    v_mfma_f32_16x16x32_bf16 v[28:31], v[124:127], v[204:207], v[28:31]
    ds_read_b128 v[124:127], v11 offset:16640
    s_waitcnt lgkmcnt(7)
    v_mfma_f32_16x16x32_bf16 v[24:27], v[96:99], v[208:211], v[24:27]
    ds_read_b128 v[96:99], v8 offset:512
    s_waitcnt lgkmcnt(7)
    v_mfma_f32_16x16x32_bf16 v[28:31], v[100:103], v[208:211], v[28:31]
    ds_read_b128 v[100:103], v8 offset:16896
    s_waitcnt lgkmcnt(7)
    v_mfma_f32_16x16x32_bf16 v[24:27], v[104:107], v[212:215], v[24:27]
    ds_read_b128 v[104:107], v9 offset:512
    s_waitcnt lgkmcnt(7)
    v_mfma_f32_16x16x32_bf16 v[28:31], v[108:111], v[212:215], v[28:31]
    ds_read_b128 v[108:111], v9 offset:16896
    s_waitcnt lgkmcnt(7)
    v_mfma_f32_16x16x32_bf16 v[24:27], v[112:115], v[216:219], v[24:27]
    ds_read_b128 v[112:115], v10 offset:512
    s_waitcnt lgkmcnt(7)
    v_mfma_f32_16x16x32_bf16 v[28:31], v[116:119], v[216:219], v[28:31]
    ds_read_b128 v[116:119], v10 offset:16896
    s_waitcnt lgkmcnt(7)
    v_mfma_f32_16x16x32_bf16 v[24:27], v[120:123], v[220:223], v[24:27]
    ds_read_b128 v[120:123], v11 offset:512
    s_waitcnt lgkmcnt(7)
    v_mfma_f32_16x16x32_bf16 v[28:31], v[124:127], v[220:223], v[28:31]
    ds_read_b128 v[124:127], v11 offset:16896
    s_waitcnt lgkmcnt(7)
    v_mfma_f32_16x16x32_bf16 v[24:27], v[96:99], v[224:227], v[24:27]
    ds_read_b128 v[96:99], v8 offset:768
    s_waitcnt lgkmcnt(7)
    v_mfma_f32_16x16x32_bf16 v[28:31], v[100:103], v[224:227], v[28:31]
    ds_read_b128 v[100:103], v8 offset:17152
    s_waitcnt lgkmcnt(7)
    v_mfma_f32_16x16x32_bf16 v[24:27], v[104:107], v[228:231], v[24:27]
    ds_read_b128 v[104:107], v9 offset:768
    s_waitcnt lgkmcnt(7)
    v_mfma_f32_16x16x32_bf16 v[28:31], v[108:111], v[228:231], v[28:31]
    ds_read_b128 v[108:111], v9 offset:17152
    s_waitcnt lgkmcnt(7)
    v_mfma_f32_16x16x32_bf16 v[24:27], v[112:115], v[232:235], v[24:27]
    ds_read_b128 v[112:115], v10 offset:768
    s_waitcnt lgkmcnt(7)
    v_mfma_f32_16x16x32_bf16 v[28:31], v[116:119], v[232:235], v[28:31]
    ds_read_b128 v[116:119], v10 offset:17152
    s_waitcnt lgkmcnt(7)
    v_mfma_f32_16x16x32_bf16 v[24:27], v[120:123], v[236:239], v[24:27]
    ds_read_b128 v[120:123], v11 offset:768
    s_waitcnt lgkmcnt(7)
    v_mfma_f32_16x16x32_bf16 v[28:31], v[124:127], v[236:239], v[28:31]
    ds_read_b128 v[124:127], v11 offset:17152
    s_waitcnt lgkmcnt(7)
    v_mfma_f32_16x16x32_bf16 v[24:27], v[96:99], v[240:243], v[24:27]
    s_waitcnt lgkmcnt(6)
    v_mfma_f32_16x16x32_bf16 v[28:31], v[100:103], v[240:243], v[28:31]
    s_waitcnt lgkmcnt(5)
    v_mfma_f32_16x16x32_bf16 v[24:27], v[104:107], v[244:247], v[24:27]
    s_waitcnt lgkmcnt(4)
    v_mfma_f32_16x16x32_bf16 v[28:31], v[108:111], v[244:247], v[28:31]
    s_waitcnt lgkmcnt(3)
    v_mfma_f32_16x16x32_bf16 v[24:27], v[112:115], v[248:251], v[24:27]
    s_waitcnt lgkmcnt(2)
    v_mfma_f32_16x16x32_bf16 v[28:31], v[116:119], v[248:251], v[28:31]
    s_waitcnt lgkmcnt(1)
    v_mfma_f32_16x16x32_bf16 v[24:27], v[120:123], v[252:255], v[24:27]
    s_waitcnt lgkmcnt(0)
    v_mfma_f32_16x16x32_bf16 v[28:31], v[124:127], v[252:255], v[28:31]
    s_nop 7
    s_nop 1
    v_max3_f32 v40, v24, v25, v26
    v_max3_f32 v40, v40, v27, v28
    v_max3_f32 v40, v40, v29, v30
    v_max_f32 v40, v40, v31
    v_mov_b32 v41, v40
    s_nop 1
    v_permlane32_swap_b32 v40, v41
    s_nop 1
    v_max_f32 v40, v40, v41
    v_mov_b32 v41, v40
    s_nop 1
    v_permlane16_swap_b32 v40, v41
    s_nop 1
    v_max_f32 v40, v40, v41
    ds_write_b32 v21, v40
    s_waitcnt lgkmcnt(0)
    s_barrier
    ds_read_b128 v[40:43], v22
    ds_read_b128 v[44:47], v23
    s_waitcnt lgkmcnt(1)
    v_max3_f32 v40, v40, v41, v42
    v_max3_f32 v20, v40, v43, v20
    v_sub_f32 v24, v24, v20
    v_sub_f32 v25, v25, v20
    v_sub_f32 v26, v26, v20
    v_sub_f32 v27, v27, v20
    v_sub_f32 v28, v28, v20
    v_sub_f32 v29, v29, v20
    v_sub_f32 v30, v30, v20
    v_sub_f32 v31, v31, v20
    v_exp_f32 v24, v24
    v_exp_f32 v25, v25
    v_exp_f32 v26, v26
    v_exp_f32 v27, v27
    v_exp_f32 v28, v28
    v_exp_f32 v29, v29
    v_exp_f32 v30, v30
    v_exp_f32 v31, v31
    s_waitcnt lgkmcnt(0)
    v_max3_f32 v44, v44, v45, v46
    v_max3_f32 v44, v44, v47, v18
    v_sub_f32 v32, v18, v44
    v_exp_f32 v32, v32
    v_mov_b32 v18, v44
    v_add_f32 v40, v24, v25
    v_add_f32 v40, v40, v26
    v_add_f32 v40, v40, v27
    v_add_f32 v40, v40, v28
    v_add_f32 v40, v40, v29
    v_add_f32 v40, v40, v30
    v_add_f32 v40, v40, v31
    v_cvt_pk_bf16_f32 v48, v24, v25
    v_cvt_pk_bf16_f32 v49, v26, v27
    v_cvt_pk_bf16_f32 v50, v28, v29
    v_cvt_pk_bf16_f32 v51, v30, v31
    ds_write_b64 v17, v[48:49] offset:0
    ds_write_b64 v17, v[50:51] offset:32
    v_mov_b32 v41, v40
    s_nop 1
    v_permlane32_swap_b32 v40, v41
    s_nop 1
    v_add_f32 v40, v40, v41
    v_mov_b32 v41, v40
    s_nop 1
    v_permlane16_swap_b32 v40, v41
    s_nop 1
    v_add_f32 v40, v40, v41
    ds_write_b32 v21, v40 offset:512
    s_waitcnt lgkmcnt(0)
    s_barrier
    ds_read_b128 v[40:43], v23 offset:512
    v_mul_f32 v64, v64, v32
    v_mul_f32 v65, v65, v32
    v_mul_f32 v66, v66, v32
    v_mul_f32 v67, v67, v32
    v_mul_f32 v68, v68, v32
    v_mul_f32 v69, v69, v32
    v_mul_f32 v70, v70, v32
    v_mul_f32 v71, v71, v32
    v_mul_f32 v72, v72, v32
    v_mul_f32 v73, v73, v32
    v_mul_f32 v74, v74, v32
    v_mul_f32 v75, v75, v32
    v_mul_f32 v76, v76, v32
    v_mul_f32 v77, v77, v32
    v_mul_f32 v78, v78, v32
    v_mul_f32 v79, v79, v32
    v_mul_f32 v80, v80, v32
    v_mul_f32 v81, v81, v32
    v_mul_f32 v82, v82, v32
    v_mul_f32 v83, v83, v32
    v_mul_f32 v84, v84, v32
    v_mul_f32 v85, v85, v32
    v_mul_f32 v86, v86, v32
    v_mul_f32 v87, v87, v32
    v_mul_f32 v88, v88, v32
    v_mul_f32 v89, v89, v32
    v_mul_f32 v90, v90, v32
    v_mul_f32 v91, v91, v32
    v_mul_f32 v92, v92, v32
    v_mul_f32 v93, v93, v32
    v_mul_f32 v94, v94, v32
    v_mul_f32 v95, v95, v32
    ds_read_b128 v[96:99], v16 offset:0
    ds_read_b64_tr_b16 v[100:101], v12 offset:0
    ds_read_b64_tr_b16 v[102:103], v14 offset:0
    ds_read_b64_tr_b16 v[104:105], v13 offset:0
    ds_read_b64_tr_b16 v[106:107], v15 offset:0
    ds_read_b128 v[108:111], v16 offset:32
    ds_read_b64_tr_b16 v[112:113], v12 offset:16384
    ds_read_b64_tr_b16 v[114:115], v14 offset:16384
    ds_read_b64_tr_b16 v[116:117], v13 offset:16384
    ds_read_b64_tr_b16 v[118:119], v15 offset:16384
    s_waitcnt lgkmcnt(5)
    v_mfma_f32_32x32x16_bf16 v[64:79], v[100:103], v[96:99], v[64:79]
    v_mfma_f32_32x32x16_bf16 v[80:95], v[104:107], v[96:99], v[80:95]
    ds_read_b128 v[96:99], v16 offset:64
    ds_read_b64_tr_b16 v[100:101], v12 offset:32768
    ds_read_b64_tr_b16 v[102:103], v14 offset:32768
    ds_read_b64_tr_b16 v[104:105], v13 offset:32768
    ds_read_b64_tr_b16 v[106:107], v15 offset:32768
    s_waitcnt lgkmcnt(5)
    v_mfma_f32_32x32x16_bf16 v[64:79], v[112:115], v[108:111], v[64:79]
    v_mfma_f32_32x32x16_bf16 v[80:95], v[116:119], v[108:111], v[80:95]
    ds_read_b128 v[108:111], v16 offset:96
    ds_read_b64_tr_b16 v[112:113], v12 offset:49152
    ds_read_b64_tr_b16 v[114:115], v14 offset:49152
    ds_read_b64_tr_b16 v[116:117], v13 offset:49152
    ds_read_b64_tr_b16 v[118:119], v15 offset:49152
    s_waitcnt lgkmcnt(5)
    v_mfma_f32_32x32x16_bf16 v[64:79], v[100:103], v[96:99], v[64:79]
    v_mfma_f32_32x32x16_bf16 v[80:95], v[104:107], v[96:99], v[80:95]
    v_add_u32 v12, 0x10000, v12
    v_add_u32 v13, 0x10000, v13
    v_add_u32 v14, 0x10000, v14
    v_add_u32 v15, 0x10000, v15
    ds_read_b128 v[96:99], v16 offset:128
    ds_read_b64_tr_b16 v[100:101], v12 offset:0
    ds_read_b64_tr_b16 v[102:103], v14 offset:0
    ds_read_b64_tr_b16 v[104:105], v13 offset:0
    ds_read_b64_tr_b16 v[106:107], v15 offset:0
    s_waitcnt lgkmcnt(5)
    v_mfma_f32_32x32x16_bf16 v[64:79], v[112:115], v[108:111], v[64:79]
    v_mfma_f32_32x32x16_bf16 v[80:95], v[116:119], v[108:111], v[80:95]
    ds_read_b128 v[108:111], v16 offset:160
    ds_read_b64_tr_b16 v[112:113], v12 offset:16384
    ds_read_b64_tr_b16 v[114:115], v14 offset:16384
    ds_read_b64_tr_b16 v[116:117], v13 offset:16384
    ds_read_b64_tr_b16 v[118:119], v15 offset:16384
    s_waitcnt lgkmcnt(5)
    v_mfma_f32_32x32x16_bf16 v[64:79], v[100:103], v[96:99], v[64:79]
    v_mfma_f32_32x32x16_bf16 v[80:95], v[104:107], v[96:99], v[80:95]
    ds_read_b128 v[96:99], v16 offset:192
    ds_read_b64_tr_b16 v[100:101], v12 offset:32768
    ds_read_b64_tr_b16 v[102:103], v14 offset:32768
    ds_read_b64_tr_b16 v[104:105], v13 offset:32768
    ds_read_b64_tr_b16 v[106:107], v15 offset:32768
    s_waitcnt lgkmcnt(5)
    v_mfma_f32_32x32x16_bf16 v[64:79], v[112:115], v[108:111], v[64:79]
    v_mfma_f32_32x32x16_bf16 v[80:95], v[116:119], v[108:111], v[80:95]
    ds_read_b128 v[108:111], v16 offset:224
    ds_read_b64_tr_b16 v[112:113], v12 offset:49152
    ds_read_b64_tr_b16 v[114:115], v14 offset:49152
    ds_read_b64_tr_b16 v[116:117], v13 offset:49152
    ds_read_b64_tr_b16 v[118:119], v15 offset:49152
    s_waitcnt lgkmcnt(5)
    v_mfma_f32_32x32x16_bf16 v[64:79], v[100:103], v[96:99], v[64:79]
    v_mfma_f32_32x32x16_bf16 v[80:95], v[104:107], v[96:99], v[80:95]
    s_waitcnt lgkmcnt(0)
    v_mfma_f32_32x32x16_bf16 v[64:79], v[112:115], v[108:111], v[64:79]
    v_mfma_f32_32x32x16_bf16 v[80:95], v[116:119], v[108:111], v[80:95]
    v_subrev_u32 v12, 0x10000, v12
    v_subrev_u32 v13, 0x10000, v13
    v_subrev_u32 v14, 0x10000, v14
    v_subrev_u32 v15, 0x10000, v15
    v_add_f32 v40, v40, v41
    v_add_f32 v42, v42, v43
    v_add_f32 v40, v40, v42
    v_fma_f32 v19, v19, v32, v40
    s_barrier
    s_nop 7
    s_nop 3
    v_and_b32 v43, 31, v1
    v_lshrrev_b32 v44, 5, v1
    v_mul_u32_u24 v40, 1040, v43
    v_lshl_add_u32 v40, v44, 3, v40
    s_lshl_b32 s61, s56, 7
    v_add_u32 v40, s61, v40
    v_cvt_pk_bf16_f32 v64, v64, v65
    v_cvt_pk_bf16_f32 v65, v66, v67
    ds_write_b64 v40, v[64:65] offset:0
    v_cvt_pk_bf16_f32 v68, v68, v69
    v_cvt_pk_bf16_f32 v69, v70, v71
    ds_write_b64 v40, v[68:69] offset:16
    v_cvt_pk_bf16_f32 v72, v72, v73
    v_cvt_pk_bf16_f32 v73, v74, v75
    ds_write_b64 v40, v[72:73] offset:32
    v_cvt_pk_bf16_f32 v76, v76, v77
    v_cvt_pk_bf16_f32 v77, v78, v79
    ds_write_b64 v40, v[76:77] offset:48
    v_cvt_pk_bf16_f32 v80, v80, v81
    v_cvt_pk_bf16_f32 v81, v82, v83
    ds_write_b64 v40, v[80:81] offset:64
    v_cvt_pk_bf16_f32 v84, v84, v85
    v_cvt_pk_bf16_f32 v85, v86, v87
    ds_write_b64 v40, v[84:85] offset:80
    v_cvt_pk_bf16_f32 v88, v88, v89
    v_cvt_pk_bf16_f32 v89, v90, v91
    ds_write_b64 v40, v[88:89] offset:96
    v_cvt_pk_bf16_f32 v92, v92, v93
    v_cvt_pk_bf16_f32 v93, v94, v95
    ds_write_b64 v40, v[92:93] offset:112
    v_mov_b32 v46, v18
    v_mov_b32 v47, v19
    v_lshlrev_b32 v45, 8, v43
    s_lshl_b32 s62, s65, 3
    s_add_u32 s62, s62, 1245184
    s_cmp_lg_u32 s56, 0
    s_cbranch_scc1 Lml_49
    s_mov_b64 exec, 0xffffffff
    buffer_store_dwordx2 v[46:47], v45, s[32:35], s62 offen sc0 sc1
    s_mov_b64 exec, -1
Lml_49:
    s_waitcnt lgkmcnt(0)
    s_barrier
    s_mul_i32 s61, s56, 4160
    v_add_u32 v40, s61, v5
    ds_read_b128 v[96:99], v40 offset:0
    ds_read_b128 v[100:103], v40 offset:1040
    ds_read_b128 v[104:107], v40 offset:2080
    ds_read_b128 v[108:111], v40 offset:3120
    s_lshl_b32 s61, s65, 15
    s_lshl_b32 s62, s56, 12
    s_add_u32 s61, s61, s62
    s_add_u32 s61, s61, 2097152
    s_waitcnt lgkmcnt(3)
    buffer_store_dwordx4 v[96:99], v5, s[32:35], s61 offen offset:0 sc0 sc1
    s_waitcnt lgkmcnt(2)
    buffer_store_dwordx4 v[100:103], v5, s[32:35], s61 offen offset:1024 sc0 sc1
    s_waitcnt lgkmcnt(1)
    buffer_store_dwordx4 v[104:107], v5, s[32:35], s61 offen offset:2048 sc0 sc1
    s_waitcnt lgkmcnt(0)
    buffer_store_dwordx4 v[108:111], v5, s[32:35], s61 offen offset:3072 sc0 sc1
    s_waitcnt vmcnt(0)
    s_barrier
    s_cmp_lg_u32 s56, 0
    s_cbranch_scc1 Lpf_50
    v_lshlrev_b32 v40, 14, v1
    v_mov_b32 v41, 0
    s_lshl_b32 s61, s65, 2
    s_add_u32 s61, s61, 0
    s_mov_b64 exec, 0xffffffff
    buffer_store_dword v41, v40, s[32:35], s61 offen sc0 sc1
    s_mov_b64 exec, -1
Lpf_50:
    s_cmp_lg_u32 s56, 0
    s_cbranch_scc1 Lwog_51
    v_lshlrev_b32 v40, 13, v1
    s_lshl_b32 s61, s65, 8
    s_add_u32 s61, s61, 1507328
    s_mov_b32 s92, 0
    s_mov_b64 exec, 3
Lwogl_52:
    buffer_load_dword v41, v40, s[32:35], s61 offen sc0 sc1
    s_waitcnt vmcnt(0)
    v_cmp_gt_u32 vcc, 65626, v41
    s_cbranch_vccz Lwogd_53
    s_sleep 8
    s_add_u32 s92, s92, 1
    s_cmp_lt_u32 s92, 400000
    s_cbranch_scc1 Lwogl_52
Lwogd_53:
    s_mov_b64 exec, -1
Lwog_51:
    s_barrier
    s_mov_b32 s36, s24
    s_mov_b32 s37, s25
    s_and_b32 s37, s37, 0xffff
    s_mov_b32 s38, 4194304
    s_mov_b32 s39, 0x00020000
    s_lshl_b32 s61, s56, 14
    s_lshl_b32 s62, s65, 17
    s_add_u32 s62, s62, s61
    s_add_u32 m0, s61, 0
    v_xor_b32 v52, 0, v5
    buffer_load_dwordx4 v52, s[36:39], s62 offen nt lds
    s_add_u32 s62, s62, 1024
    s_add_u32 m0, s61, 1024
    v_xor_b32 v53, 64, v5
    buffer_load_dwordx4 v53, s[36:39], s62 offen nt lds
    s_add_u32 s62, s62, 1024
    s_add_u32 m0, s61, 2048
    v_xor_b32 v52, 128, v5
    buffer_load_dwordx4 v52, s[36:39], s62 offen nt lds
    s_add_u32 s62, s62, 1024
    s_add_u32 m0, s61, 3072
    v_xor_b32 v53, 192, v5
    buffer_load_dwordx4 v53, s[36:39], s62 offen nt lds
    s_add_u32 s62, s62, 1024
    s_add_u32 m0, s61, 4096
    v_xor_b32 v52, 0, v5
    buffer_load_dwordx4 v52, s[36:39], s62 offen nt lds
    s_add_u32 s62, s62, 1024
    s_add_u32 m0, s61, 5120
    v_xor_b32 v53, 64, v5
    buffer_load_dwordx4 v53, s[36:39], s62 offen nt lds
    s_add_u32 s62, s62, 1024
    s_add_u32 m0, s61, 6144
    v_xor_b32 v52, 128, v5
    buffer_load_dwordx4 v52, s[36:39], s62 offen nt lds
    s_add_u32 s62, s62, 1024
    s_add_u32 m0, s61, 7168
    v_xor_b32 v53, 192, v5
    buffer_load_dwordx4 v53, s[36:39], s62 offen nt lds
    s_add_u32 s62, s62, 1024
    s_add_u32 m0, s61, 8192
    v_xor_b32 v52, 32, v5
    buffer_load_dwordx4 v52, s[36:39], s62 offen nt lds
    s_add_u32 s62, s62, 1024
    s_add_u32 m0, s61, 9216
    v_xor_b32 v53, 96, v5
    buffer_load_dwordx4 v53, s[36:39], s62 offen nt lds
    s_add_u32 s62, s62, 1024
    s_add_u32 m0, s61, 10240
    v_xor_b32 v52, 160, v5
    buffer_load_dwordx4 v52, s[36:39], s62 offen nt lds
    s_add_u32 s62, s62, 1024
    s_add_u32 m0, s61, 11264
    v_xor_b32 v53, 224, v5
    buffer_load_dwordx4 v53, s[36:39], s62 offen nt lds
    s_add_u32 s62, s62, 1024
    s_add_u32 m0, s61, 12288
    v_xor_b32 v52, 32, v5
    buffer_load_dwordx4 v52, s[36:39], s62 offen nt lds
    s_add_u32 s62, s62, 1024
    s_add_u32 m0, s61, 13312
    v_xor_b32 v53, 96, v5
    buffer_load_dwordx4 v53, s[36:39], s62 offen nt lds
    s_add_u32 s62, s62, 1024
    s_add_u32 m0, s61, 14336
    v_xor_b32 v52, 160, v5
    buffer_load_dwordx4 v52, s[36:39], s62 offen nt lds
    s_add_u32 s62, s62, 1024
    s_add_u32 m0, s61, 15360
    v_xor_b32 v53, 224, v5
    buffer_load_dwordx4 v53, s[36:39], s62 offen nt lds
    s_waitcnt vmcnt(0)
    s_barrier
    v_lshrrev_b32 v40, 2, v3
    v_and_b32 v41, 1, v2
    v_lshlrev_b32 v42, 2, v40
    v_lshl_or_b32 v42, v41, 1, v42
    v_lshl_add_u32 v43, v2, 3, v40
    v_lshlrev_b32 v43, 10, v43
    v_and_b32 v44, 1, v3
    v_lshl_add_u32 v43, v44, 3, v43
    v_bfe_u32 v44, v3, 1, 1
    s_lshl_b32 s61, s56, 3
    s_add_u32 s62, s61, 0
    v_add_u32 v45, s62, v44
    v_xor_b32 v45, v45, v42
    v_lshl_add_u32 v48, v45, 4, v43
    s_add_u32 s62, s61, 2
    v_add_u32 v45, s62, v44
    v_xor_b32 v45, v45, v42
    v_lshl_add_u32 v49, v45, 4, v43
    s_add_u32 s62, s61, 4
    v_add_u32 v45, s62, v44
    v_xor_b32 v45, v45, v42
    v_lshl_add_u32 v50, v45, 4, v43
    s_add_u32 s62, s61, 6
    v_add_u32 v45, s62, v44
    v_xor_b32 v45, v45, v42
    v_lshl_add_u32 v51, v45, 4, v43
    ds_read_b64_tr_b16 v[128:129], v48 offset:0
    ds_read_b64_tr_b16 v[130:131], v48 offset:4096
    ds_read_b64_tr_b16 v[144:145], v49 offset:0
    ds_read_b64_tr_b16 v[146:147], v49 offset:4096
    ds_read_b64_tr_b16 v[160:161], v50 offset:0
    ds_read_b64_tr_b16 v[162:163], v50 offset:4096
    ds_read_b64_tr_b16 v[176:177], v51 offset:0
    ds_read_b64_tr_b16 v[178:179], v51 offset:4096
    s_waitcnt lgkmcnt(0)
    ds_read_b64_tr_b16 v[132:133], v48 offset:32768
    ds_read_b64_tr_b16 v[134:135], v48 offset:36864
    ds_read_b64_tr_b16 v[148:149], v49 offset:32768
    ds_read_b64_tr_b16 v[150:151], v49 offset:36864
    ds_read_b64_tr_b16 v[164:165], v50 offset:32768
    ds_read_b64_tr_b16 v[166:167], v50 offset:36864
    ds_read_b64_tr_b16 v[180:181], v51 offset:32768
    ds_read_b64_tr_b16 v[182:183], v51 offset:36864
    s_waitcnt lgkmcnt(0)
    v_add_u32 v48, 0x10000, v48
    v_add_u32 v49, 0x10000, v49
    v_add_u32 v50, 0x10000, v50
    v_add_u32 v51, 0x10000, v51
    ds_read_b64_tr_b16 v[136:137], v48 offset:0
    ds_read_b64_tr_b16 v[138:139], v48 offset:4096
    ds_read_b64_tr_b16 v[152:153], v49 offset:0
    ds_read_b64_tr_b16 v[154:155], v49 offset:4096
    ds_read_b64_tr_b16 v[168:169], v50 offset:0
    ds_read_b64_tr_b16 v[170:171], v50 offset:4096
    ds_read_b64_tr_b16 v[184:185], v51 offset:0
    ds_read_b64_tr_b16 v[186:187], v51 offset:4096
    s_waitcnt lgkmcnt(0)
    ds_read_b64_tr_b16 v[140:141], v48 offset:32768
    ds_read_b64_tr_b16 v[142:143], v48 offset:36864
    ds_read_b64_tr_b16 v[156:157], v49 offset:32768
    ds_read_b64_tr_b16 v[158:159], v49 offset:36864
    ds_read_b64_tr_b16 v[172:173], v50 offset:32768
    ds_read_b64_tr_b16 v[174:175], v50 offset:36864
    ds_read_b64_tr_b16 v[188:189], v51 offset:32768
    ds_read_b64_tr_b16 v[190:191], v51 offset:36864
    s_waitcnt lgkmcnt(0)
    v_lshrrev_b32 v40, 5, v1
    v_mul_u32_u24 v41, 1536, v40
    v_and_b32 v42, 31, v1
    v_lshl_add_u32 v41, v42, 4, v41
    v_mul_u32_u24 v43, 48, v40
    s_mov_b32 s61, 131072
    v_lshlrev_b32 v46, 3, v1
    v_add_u32 v46, s61, v46
    v_and_b32 v47, 1, v3
    v_lshlrev_b32 v47, 8, v47
    v_lshl_add_u32 v47, v2, 4, v47
    v_add_u32 v47, s61, v47
    s_mov_b32 s70, 1040356334
    s_cmp_lg_u32 s56, 0
    s_cbranch_scc1 Lhb1_54
    s_mov_b32 s92, 0
    buffer_load_dwordx4 v[192:195], v41, s[32:35], s93 offen offset:256 sc0 sc1
    buffer_load_dwordx2 v[204:205], v43, s[32:35], s93 offen offset:128 sc0 sc1
    buffer_load_dwordx4 v[196:199], v41, s[32:35], s93 offen offset:768 sc0 sc1
    buffer_load_dwordx2 v[206:207], v43, s[32:35], s93 offen offset:144 sc0 sc1
    buffer_load_dwordx4 v[200:203], v41, s[32:35], s93 offen offset:1280 sc0 sc1
    buffer_load_dwordx2 v[208:209], v43, s[32:35], s93 offen offset:160 sc0 sc1
Lp2_55:
    buffer_load_dwordx4 v[212:215], v41, s[32:35], s93 offen offset:256 sc0 sc1
    buffer_load_dwordx2 v[224:225], v43, s[32:35], s93 offen offset:128 sc0 sc1
    buffer_load_dwordx4 v[216:219], v41, s[32:35], s93 offen offset:768 sc0 sc1
    buffer_load_dwordx2 v[226:227], v43, s[32:35], s93 offen offset:144 sc0 sc1
    buffer_load_dwordx4 v[220:223], v41, s[32:35], s93 offen offset:1280 sc0 sc1
    buffer_load_dwordx2 v[228:229], v43, s[32:35], s93 offen offset:160 sc0 sc1
    s_waitcnt vmcnt(6)
    v_mov_b32 v45, v192
    v_max3_u32 v45, v45, v193, v194
    v_max3_u32 v45, v45, v195, v196
    v_max3_u32 v45, v45, v197, v198
    v_max3_u32 v45, v45, v199, v200
    v_max3_u32 v45, v45, v201, v202
    v_max3_u32 v45, v45, v203, v204
    v_max3_u32 v45, v45, v205, v206
    v_max3_u32 v45, v45, v207, v208
    v_max_u32 v45, v45, v209
    v_cmp_eq_u32 vcc, -1, v45
    s_cbranch_vccz Lp2A_56
    buffer_load_dwordx4 v[192:195], v41, s[32:35], s93 offen offset:256 sc0 sc1
    buffer_load_dwordx2 v[204:205], v43, s[32:35], s93 offen offset:128 sc0 sc1
    buffer_load_dwordx4 v[196:199], v41, s[32:35], s93 offen offset:768 sc0 sc1
    buffer_load_dwordx2 v[206:207], v43, s[32:35], s93 offen offset:144 sc0 sc1
    buffer_load_dwordx4 v[200:203], v41, s[32:35], s93 offen offset:1280 sc0 sc1
    buffer_load_dwordx2 v[208:209], v43, s[32:35], s93 offen offset:160 sc0 sc1
    s_waitcnt vmcnt(6)
    v_mov_b32 v45, v212
    v_max3_u32 v45, v45, v213, v214
    v_max3_u32 v45, v45, v215, v216
    v_max3_u32 v45, v45, v217, v218
    v_max3_u32 v45, v45, v219, v220
    v_max3_u32 v45, v45, v221, v222
    v_max3_u32 v45, v45, v223, v224
    v_max3_u32 v45, v45, v225, v226
    v_max3_u32 v45, v45, v227, v228
    v_max_u32 v45, v45, v229
    v_cmp_eq_u32 vcc, -1, v45
    s_cbranch_vccz Lp2B_57
    s_add_u32 s92, s92, 1
    s_cmp_lt_u32 s92, 400000
    s_cbranch_scc1 Lp2_55
Lp2B_57:
    s_waitcnt vmcnt(0)
    v_mov_b32 v192, v212
    v_mov_b32 v193, v213
    v_mov_b32 v194, v214
    v_mov_b32 v195, v215
    v_mov_b32 v196, v216
    v_mov_b32 v197, v217
    v_mov_b32 v198, v218
    v_mov_b32 v199, v219
    v_mov_b32 v200, v220
    v_mov_b32 v201, v221
    v_mov_b32 v202, v222
    v_mov_b32 v203, v223
    v_mov_b32 v204, v224
    v_mov_b32 v205, v225
    v_mov_b32 v206, v226
    v_mov_b32 v207, v227
    v_mov_b32 v208, v228
    v_mov_b32 v209, v229
    s_branch Lp2D_58
Lp2A_56:
Lp2D_58:
    v_max3_f32 v45, v204, v206, v208
    v_mul_f32 v44, s70, v45
    v_fma_f32 v204, v204, s70, -v44
    v_fma_f32 v206, v206, s70, -v44
    v_fma_f32 v208, v208, s70, -v44
    v_exp_f32 v204, v204
    v_exp_f32 v206, v206
    v_exp_f32 v208, v208
    s_nop 0
    v_mul_f32 v45, v204, v205
    v_fmac_f32 v45, v206, v207
    v_fmac_f32 v45, v208, v209
    v_rcp_f32 v45, v45
    v_mul_f32 v192, v192, v204
    v_mul_f32 v193, v193, v204
    v_mul_f32 v194, v194, v204
    v_mul_f32 v195, v195, v204
    v_fmac_f32 v192, v196, v206
    v_fmac_f32 v193, v197, v206
    v_fmac_f32 v194, v198, v206
    v_fmac_f32 v195, v199, v206
    v_fmac_f32 v192, v200, v208
    v_fmac_f32 v193, v201, v208
    v_fmac_f32 v194, v202, v208
    v_fmac_f32 v195, v203, v208
    v_mul_f32 v192, v192, v45
    v_mul_f32 v193, v193, v45
    v_mul_f32 v194, v194, v45
    v_mul_f32 v195, v195, v45
    v_cvt_pk_bf16_f32 v192, v192, v193
    v_cvt_pk_bf16_f32 v193, v194, v195
    ds_write_b64 v46, v[192:193]
    s_waitcnt lgkmcnt(0)
Lhb1_54:
    s_barrier
    ds_read_b128 v[24:27], v47 offset:0
    ds_read_b128 v[28:31], v47 offset:64
    ds_read_b128 v[32:35], v47 offset:128
    ds_read_b128 v[36:39], v47 offset:192
    s_waitcnt lgkmcnt(3)
    v_mfma_f32_16x16x32_bf16 v[8:11], v[24:27], v[128:131], 0
    v_mfma_f32_16x16x32_bf16 v[12:15], v[24:27], v[144:147], 0
    v_mfma_f32_16x16x32_bf16 v[16:19], v[24:27], v[160:163], 0
    v_mfma_f32_16x16x32_bf16 v[20:23], v[24:27], v[176:179], 0
    s_waitcnt lgkmcnt(2)
    v_mfma_f32_16x16x32_bf16 v[8:11], v[28:31], v[132:135], v[8:11]
    v_mfma_f32_16x16x32_bf16 v[12:15], v[28:31], v[148:151], v[12:15]
    v_mfma_f32_16x16x32_bf16 v[16:19], v[28:31], v[164:167], v[16:19]
    v_mfma_f32_16x16x32_bf16 v[20:23], v[28:31], v[180:183], v[20:23]
    s_waitcnt lgkmcnt(1)
    v_mfma_f32_16x16x32_bf16 v[8:11], v[32:35], v[136:139], v[8:11]
    v_mfma_f32_16x16x32_bf16 v[12:15], v[32:35], v[152:155], v[12:15]
    v_mfma_f32_16x16x32_bf16 v[16:19], v[32:35], v[168:171], v[16:19]
    v_mfma_f32_16x16x32_bf16 v[20:23], v[32:35], v[184:187], v[20:23]
    s_waitcnt lgkmcnt(0)
    v_mfma_f32_16x16x32_bf16 v[8:11], v[36:39], v[140:143], v[8:11]
    v_mfma_f32_16x16x32_bf16 v[12:15], v[36:39], v[156:159], v[12:15]
    v_mfma_f32_16x16x32_bf16 v[16:19], v[36:39], v[172:175], v[16:19]
    v_mfma_f32_16x16x32_bf16 v[20:23], v[36:39], v[188:191], v[20:23]
    v_lshlrev_b32 v40, 2, v3
    s_lshl_b32 s61, s56, 16
    s_lshl_b32 s62, s65, 6
    s_add_u32 s61, s61, s62
    s_add_u32 s61, s61, 3328
    s_nop 4
    s_mov_b64 exec, 0xffff
    s_add_u32 s62, s61, 0
    buffer_store_dword v8, v40, s[32:35], s62 offen sc0 sc1
    s_add_u32 s62, s61, 524288
    buffer_store_dword v9, v40, s[32:35], s62 offen sc0 sc1
    s_add_u32 s62, s61, 16384
    buffer_store_dword v12, v40, s[32:35], s62 offen sc0 sc1
    s_add_u32 s62, s61, 540672
    buffer_store_dword v13, v40, s[32:35], s62 offen sc0 sc1
    s_add_u32 s62, s61, 32768
    buffer_store_dword v16, v40, s[32:35], s62 offen sc0 sc1
    s_add_u32 s62, s61, 557056
    buffer_store_dword v17, v40, s[32:35], s62 offen sc0 sc1
    s_add_u32 s62, s61, 49152
    buffer_store_dword v20, v40, s[32:35], s62 offen sc0 sc1
    s_add_u32 s62, s61, 573440
    buffer_store_dword v21, v40, s[32:35], s62 offen sc0 sc1
    s_mov_b64 exec, -1
    s_branch L_final
L_roleT1:
    s_mov_b32 s65, s75
    s_waitcnt vmcnt(0)
    s_barrier
    s_cmp_lg_u32 s56, 1
    s_cbranch_scc1 Lsc_59
    v_mov_b32 v40, 1
    v_mov_b32 v41, 0
    s_mov_b64 s[94:95], exec
    s_mov_b64 exec, 1
    buffer_atomic_add v40, v41, s[52:55], 0 offen offset:128 sc1
    s_mov_b64 exec, s[94:95]
Lsc_59:
    s_waitcnt vmcnt(0)
    v_perm_b32 v232, v196, v192, s68
    v_perm_b32 v233, v196, v192, s69
    v_perm_b32 v234, v197, v193, s68
    v_perm_b32 v235, v197, v193, s69
    v_perm_b32 v236, v198, v194, s68
    v_perm_b32 v237, v198, v194, s69
    v_perm_b32 v238, v199, v195, s68
    v_perm_b32 v239, v199, v195, s69
    v_dot2_f32_bf16 v212, v232, v208, 0
    v_dot2_f32_bf16 v213, v233, v208, 0
    v_dot2_f32_bf16 v214, v234, v208, 0
    v_dot2_f32_bf16 v215, v235, v208, 0
    v_dot2_f32_bf16 v216, v236, v208, 0
    v_dot2_f32_bf16 v217, v237, v208, 0
    v_dot2_f32_bf16 v218, v238, v208, 0
    v_dot2_f32_bf16 v219, v239, v208, 0
    v_dot2_f32_bf16 v220, v232, v210, 0
    v_dot2_f32_bf16 v221, v233, v210, 0
    v_dot2_f32_bf16 v222, v234, v210, 0
    v_dot2_f32_bf16 v223, v235, v210, 0
    v_dot2_f32_bf16 v224, v236, v210, 0
    v_dot2_f32_bf16 v225, v237, v210, 0
    v_dot2_f32_bf16 v226, v238, v210, 0
    v_dot2_f32_bf16 v227, v239, v210, 0
    v_perm_b32 v232, v204, v200, s68
    v_perm_b32 v233, v204, v200, s69
    v_perm_b32 v234, v205, v201, s68
    v_perm_b32 v235, v205, v201, s69
    v_perm_b32 v236, v206, v202, s68
    v_perm_b32 v237, v206, v202, s69
    v_perm_b32 v238, v207, v203, s68
    v_perm_b32 v239, v207, v203, s69
    v_dot2_f32_bf16 v212, v232, v209, v212
    v_dot2_f32_bf16 v213, v233, v209, v213
    v_dot2_f32_bf16 v214, v234, v209, v214
    v_dot2_f32_bf16 v215, v235, v209, v215
    v_dot2_f32_bf16 v216, v236, v209, v216
    v_dot2_f32_bf16 v217, v237, v209, v217
    v_dot2_f32_bf16 v218, v238, v209, v218
    v_dot2_f32_bf16 v219, v239, v209, v219
    v_dot2_f32_bf16 v220, v232, v211, v220
    v_dot2_f32_bf16 v221, v233, v211, v221
    v_dot2_f32_bf16 v222, v234, v211, v222
    v_dot2_f32_bf16 v223, v235, v211, v223
    v_dot2_f32_bf16 v224, v236, v211, v224
    v_dot2_f32_bf16 v225, v237, v211, v225
    v_dot2_f32_bf16 v226, v238, v211, v226
    v_dot2_f32_bf16 v227, v239, v211, v227
    s_nop 2
    v_permlane32_swap_b32 v212, v220
    v_permlane32_swap_b32 v213, v221
    v_permlane32_swap_b32 v214, v222
    v_permlane32_swap_b32 v215, v223
    v_permlane32_swap_b32 v216, v224
    v_permlane32_swap_b32 v217, v225
    v_permlane32_swap_b32 v218, v226
    v_permlane32_swap_b32 v219, v227
    s_nop 1
    v_add_f32 v212, v212, v220
    v_add_f32 v213, v213, v221
    v_add_f32 v214, v214, v222
    v_add_f32 v215, v215, v223
    v_add_f32 v216, v216, v224
    v_add_f32 v217, v217, v225
    v_add_f32 v218, v218, v226
    v_add_f32 v219, v219, v227
    s_nop 1
    v_permlane16_swap_b32 v212, v216
    v_permlane16_swap_b32 v213, v217
    v_permlane16_swap_b32 v214, v218
    v_permlane16_swap_b32 v215, v219
    s_nop 1
    v_add_f32 v212, v212, v216
    v_add_f32 v213, v213, v217
    v_add_f32 v214, v214, v218
    v_add_f32 v215, v215, v219
    s_nop 1
    v_add_f32_dpp v212, v212, v212 row_ror:8 row_mask:0xf bank_mask:0xf
    v_add_f32_dpp v213, v213, v213 row_ror:8 row_mask:0xf bank_mask:0xf
    v_add_f32_dpp v214, v214, v214 row_ror:8 row_mask:0xf bank_mask:0xf
    v_add_f32_dpp v215, v215, v215 row_ror:8 row_mask:0xf bank_mask:0xf
    v_lshrrev_b32 v232, 5, v228
    v_lshlrev_b32 v232, 8, v232
    v_bfe_u32 v233, v228, 4, 1
    v_lshl_add_u32 v232, v233, 4, v232
    v_lshl_add_u32 v232, v230, 5, v232
    s_lshl_b32 s61, s56, 9
    s_add_u32 s61, s61, 131072
    v_add_u32 v232, s61, v232
    ds_write_b128 v232, v[212:215]
    s_waitcnt lgkmcnt(0)
    s_barrier
    s_cmp_eq_u32 s56, 0
    s_cbranch_scc1 Ls1p0_61
    s_mov_b32 s44, s10
    s_mov_b32 s45, s11
    s_and_b32 s45, s45, 0xffff
    s_mov_b32 s46, 4194304
    s_mov_b32 s47, 0x00020000
    v_xor_b32 v52, v3, v2
    v_lshlrev_b32 v51, 13, v2
    v_xor_b32 v53, 4, v52
    v_xor_b32 v54, 8, v52
    v_xor_b32 v55, 12, v52
    v_lshl_add_u32 v52, v52, 4, v51
    v_lshl_add_u32 v53, v53, 4, v51
    v_lshl_add_u32 v54, v54, 4, v51
    v_lshl_add_u32 v55, v55, 4, v51
    s_lshl_b32 s61, s56, 19
    s_lshl_b32 s62, s65, 8
    s_add_u32 s62, s62, s61
    s_lshl_b32 s61, s56, 14
    s_add_u32 m0, s61, 0
    s_nop 0
    buffer_load_dwordx4 v52, s[44:47], s62 offen nt lds
    s_add_u32 m0, s61, 1024
    s_add_u32 s62, s62, 32768
    buffer_load_dwordx4 v52, s[44:47], s62 offen nt lds
    s_add_u32 m0, s61, 2048
    s_add_u32 s62, s62, 32768
    buffer_load_dwordx4 v52, s[44:47], s62 offen nt lds
    s_add_u32 m0, s61, 3072
    s_add_u32 s62, s62, 32768
    buffer_load_dwordx4 v52, s[44:47], s62 offen nt lds
    s_add_u32 m0, s61, 4096
    s_add_u32 s62, s62, 32768
    buffer_load_dwordx4 v53, s[44:47], s62 offen nt lds
    s_add_u32 m0, s61, 5120
    s_add_u32 s62, s62, 32768
    buffer_load_dwordx4 v53, s[44:47], s62 offen nt lds
    s_add_u32 m0, s61, 6144
    s_add_u32 s62, s62, 32768
    buffer_load_dwordx4 v53, s[44:47], s62 offen nt lds
    s_add_u32 m0, s61, 7168
    s_add_u32 s62, s62, 32768
    buffer_load_dwordx4 v53, s[44:47], s62 offen nt lds
    s_add_u32 m0, s61, 8192
    s_add_u32 s62, s62, 32768
    buffer_load_dwordx4 v54, s[44:47], s62 offen nt lds
    s_add_u32 m0, s61, 9216
    s_add_u32 s62, s62, 32768
    buffer_load_dwordx4 v54, s[44:47], s62 offen nt lds
    s_add_u32 m0, s61, 10240
    s_add_u32 s62, s62, 32768
    buffer_load_dwordx4 v54, s[44:47], s62 offen nt lds
    s_add_u32 m0, s61, 11264
    s_add_u32 s62, s62, 32768
    buffer_load_dwordx4 v54, s[44:47], s62 offen nt lds
    s_add_u32 m0, s61, 12288
    s_add_u32 s62, s62, 32768
    buffer_load_dwordx4 v55, s[44:47], s62 offen nt lds
    s_add_u32 m0, s61, 13312
    s_add_u32 s62, s62, 32768
    buffer_load_dwordx4 v55, s[44:47], s62 offen nt lds
    s_add_u32 m0, s61, 14336
    s_add_u32 s62, s62, 32768
    buffer_load_dwordx4 v55, s[44:47], s62 offen nt lds
    s_add_u32 m0, s61, 15360
    s_add_u32 s62, s62, 32768
    buffer_load_dwordx4 v55, s[44:47], s62 offen nt lds
    s_branch Ls1p_60
Ls1p0_61:
    v_mov_b32 v234, 0
    buffer_load_dword v235, v234, s[52:55], s91 offen offset:0 sc0 sc1
    v_and_b32 v232, 31, v228
    v_lshlrev_b32 v233, 4, v232
    v_add_u32 v233, 131072, v233
    ds_read_b128 v[192:195], v233 offset:0
    ds_read_b128 v[196:199], v233 offset:512
    ds_read_b128 v[200:203], v233 offset:1024
    ds_read_b128 v[204:207], v233 offset:1536
    ds_read_b128 v[208:211], v233 offset:2048
    ds_read_b128 v[212:215], v233 offset:2560
    ds_read_b128 v[216:219], v233 offset:3072
    ds_read_b128 v[220:223], v233 offset:3584
    s_waitcnt lgkmcnt(6)
    v_add_f32 v192, v192, v196
    v_add_f32 v193, v193, v197
    v_add_f32 v194, v194, v198
    v_add_f32 v195, v195, v199
    s_waitcnt lgkmcnt(5)
    v_add_f32 v192, v192, v200
    v_add_f32 v193, v193, v201
    v_add_f32 v194, v194, v202
    v_add_f32 v195, v195, v203
    s_waitcnt lgkmcnt(4)
    v_add_f32 v192, v192, v204
    v_add_f32 v193, v193, v205
    v_add_f32 v194, v194, v206
    v_add_f32 v195, v195, v207
    s_waitcnt lgkmcnt(3)
    v_add_f32 v192, v192, v208
    v_add_f32 v193, v193, v209
    v_add_f32 v194, v194, v210
    v_add_f32 v195, v195, v211
    s_waitcnt lgkmcnt(2)
    v_add_f32 v192, v192, v212
    v_add_f32 v193, v193, v213
    v_add_f32 v194, v194, v214
    v_add_f32 v195, v195, v215
    s_waitcnt lgkmcnt(1)
    v_add_f32 v192, v192, v216
    v_add_f32 v193, v193, v217
    v_add_f32 v194, v194, v218
    v_add_f32 v195, v195, v219
    s_waitcnt lgkmcnt(0)
    v_add_f32 v192, v192, v220
    v_add_f32 v193, v193, v221
    v_add_f32 v194, v194, v222
    v_add_f32 v195, v195, v223
    v_lshrrev_b32 v233, 4, v232
    v_lshlrev_b32 v233, 10, v233
    v_and_b32 v232, 15, v232
    v_lshl_add_u32 v233, v232, 4, v233
    s_waitcnt vmcnt(0)
    s_mov_b32 s92, 0
Lcf_62:
    v_readfirstlane_b32 s57, v235
    s_nop 3
    s_cmp_lg_u32 s57, 0
    s_cbranch_scc1 Lcfd_63
    s_sleep 2
    buffer_load_dword v235, v234, s[52:55], s91 offen offset:0 sc0 sc1
    s_waitcnt vmcnt(0)
    s_add_u32 s92, s92, 1
    s_cmp_lt_u32 s92, 400000
    s_cbranch_scc1 Lcf_62
Lcfd_63:
    s_mov_b64 exec, 0xffffffff
    buffer_store_dwordx4 v[192:195], v233, s[32:35], s3 offen sc0 sc1
    s_mov_b64 exec, -1
    s_mov_b32 s44, s10
    s_mov_b32 s45, s11
    s_and_b32 s45, s45, 0xffff
    s_mov_b32 s46, 4194304
    s_mov_b32 s47, 0x00020000
    v_xor_b32 v52, v3, v2
    v_lshlrev_b32 v51, 13, v2
    v_xor_b32 v53, 4, v52
    v_xor_b32 v54, 8, v52
    v_xor_b32 v55, 12, v52
    v_lshl_add_u32 v52, v52, 4, v51
    v_lshl_add_u32 v53, v53, 4, v51
    v_lshl_add_u32 v54, v54, 4, v51
    v_lshl_add_u32 v55, v55, 4, v51
    s_lshl_b32 s61, s56, 19
    s_lshl_b32 s62, s65, 8
    s_add_u32 s62, s62, s61
    s_lshl_b32 s61, s56, 14
    s_add_u32 m0, s61, 0
    s_nop 0
    buffer_load_dwordx4 v52, s[44:47], s62 offen nt lds
    s_add_u32 m0, s61, 1024
    s_add_u32 s62, s62, 32768
    buffer_load_dwordx4 v52, s[44:47], s62 offen nt lds
    s_add_u32 m0, s61, 2048
    s_add_u32 s62, s62, 32768
    buffer_load_dwordx4 v52, s[44:47], s62 offen nt lds
    s_add_u32 m0, s61, 3072
    s_add_u32 s62, s62, 32768
    buffer_load_dwordx4 v52, s[44:47], s62 offen nt lds
    s_add_u32 m0, s61, 4096
    s_add_u32 s62, s62, 32768
    buffer_load_dwordx4 v53, s[44:47], s62 offen nt lds
    s_add_u32 m0, s61, 5120
    s_add_u32 s62, s62, 32768
    buffer_load_dwordx4 v53, s[44:47], s62 offen nt lds
    s_add_u32 m0, s61, 6144
    s_add_u32 s62, s62, 32768
    buffer_load_dwordx4 v53, s[44:47], s62 offen nt lds
    s_add_u32 m0, s61, 7168
    s_add_u32 s62, s62, 32768
    buffer_load_dwordx4 v53, s[44:47], s62 offen nt lds
    s_add_u32 m0, s61, 8192
    s_add_u32 s62, s62, 32768
    buffer_load_dwordx4 v54, s[44:47], s62 offen nt lds
    s_add_u32 m0, s61, 9216
    s_add_u32 s62, s62, 32768
    buffer_load_dwordx4 v54, s[44:47], s62 offen nt lds
    s_add_u32 m0, s61, 10240
    s_add_u32 s62, s62, 32768
    buffer_load_dwordx4 v54, s[44:47], s62 offen nt lds
    s_add_u32 m0, s61, 11264
    s_add_u32 s62, s62, 32768
    buffer_load_dwordx4 v54, s[44:47], s62 offen nt lds
    s_add_u32 m0, s61, 12288
    s_add_u32 s62, s62, 32768
    buffer_load_dwordx4 v55, s[44:47], s62 offen nt lds
    s_add_u32 m0, s61, 13312
    s_add_u32 s62, s62, 32768
    buffer_load_dwordx4 v55, s[44:47], s62 offen nt lds
    s_add_u32 m0, s61, 14336
    s_add_u32 s62, s62, 32768
    buffer_load_dwordx4 v55, s[44:47], s62 offen nt lds
    s_add_u32 m0, s61, 15360
    s_add_u32 s62, s62, 32768
    buffer_load_dwordx4 v55, s[44:47], s62 offen nt lds
    v_mov_b32 v46, 0
    buffer_load_dword v47, v46, s[52:55], 0 offen offset:128 sc0 sc1
    v_lshlrev_b32 v40, 4, v1
    s_lshl_b32 s61, s65, 11
    s_add_u32 s61, s61, 1310720
    s_mov_b32 s92, 0
Lpoll_64:
    buffer_load_dwordx4 v[24:27], v40, s[32:35], s61 offen offset:0 sc0 sc1
    buffer_load_dwordx4 v[32:35], v40, s[32:35], s61 offen offset:1024 sc0 sc1
    s_waitcnt vmcnt(0)
    v_mov_b32 v41, v24
    v_max3_u32 v41, v41, v25, v26
    v_max3_u32 v41, v41, v27, v32
    v_max3_u32 v41, v41, v33, v34
    v_max_u32 v41, v41, v35
    v_cmpx_eq_u32 vcc, -1, v41
    s_cbranch_execz Lpolld_65
    s_sleep 4
    s_add_u32 s92, s92, 1
    s_cmp_lt_u32 s92, 400000
    s_cbranch_scc1 Lpoll_64
Lpolld_65:
    s_mov_b64 exec, -1
    v_mov_b32 v28, v24
    v_mov_b32 v29, v25
    v_mov_b32 v30, v26
    v_mov_b32 v31, v27
    v_mov_b32 v36, v32
    v_mov_b32 v37, v33
    v_mov_b32 v38, v34
    v_mov_b32 v39, v35
    s_nop 1
    v_permlane32_swap_b32 v24, v28
    v_permlane32_swap_b32 v25, v29
    v_permlane32_swap_b32 v26, v30
    v_permlane32_swap_b32 v27, v31
    v_permlane32_swap_b32 v32, v36
    v_permlane32_swap_b32 v33, v37
    v_permlane32_swap_b32 v34, v38
    v_permlane32_swap_b32 v35, v39
    s_nop 1
    v_add_f32 v24, v24, v28
    v_add_f32 v25, v25, v29
    v_add_f32 v26, v26, v30
    v_add_f32 v27, v27, v31
    v_cvt_pk_bf16_f32 v24, v24, v25
    v_cvt_pk_bf16_f32 v25, v26, v27
    v_add_f32 v32, v32, v36
    v_add_f32 v33, v33, v37
    v_add_f32 v34, v34, v38
    v_add_f32 v35, v35, v39
    v_cvt_pk_bf16_f32 v32, v32, v33
    v_cvt_pk_bf16_f32 v33, v34, v35
    v_readfirstlane_b32 s57, v47
    s_nop 3
    s_cmp_ge_u32 s57, 64
    s_cbranch_scc1 Lcfm_66
    v_mov_b32 v46, 0
    s_mov_b32 s92, 0
Lcf_67:
    buffer_load_dword v47, v46, s[52:55], 0 offen offset:128 sc0 sc1
    s_waitcnt vmcnt(0)
    v_readfirstlane_b32 s57, v47
    s_nop 3
    s_cmp_ge_u32 s57, 64
    s_cbranch_scc1 Lcfd_68
    s_sleep 16
    s_add_u32 s92, s92, 1
    s_cmp_lt_u32 s92, 400000
    s_cbranch_scc1 Lcf_67
Lcfd_68:
Lcfm_66:
    v_and_b32 v42, 31, v1
    v_lshlrev_b32 v42, 3, v42
    v_add_u32 v42, 135168, v42
    ds_write_b64 v42, v[24:25] offset:0
    ds_write_b64 v42, v[32:33] offset:256
    s_waitcnt lgkmcnt(0)
Ls1p_60:
    v_lshrrev_b32 v40, 2, v3
    v_lshlrev_b32 v40, 12, v40
    v_and_b32 v41, 3, v3
    v_lshl_add_u32 v40, v41, 8, v40
    s_lshl_b32 s61, s56, 14
    v_add_u32 v40, s61, v40
    v_xor_b32 v41, v3, v2
    v_xor_b32 v42, 0, v41
    v_lshl_add_u32 v56, v42, 4, v40
    v_xor_b32 v42, 4, v41
    v_lshl_add_u32 v57, v42, 4, v40
    v_xor_b32 v42, 8, v41
    v_lshl_add_u32 v58, v42, 4, v40
    v_xor_b32 v42, 12, v41
    v_lshl_add_u32 v59, v42, 4, v40
    v_and_b32 v43, 1, v3
    v_lshlrev_b32 v43, 8, v43
    v_lshl_add_u32 v43, v2, 4, v43
    v_add_u32 v43, 135168, v43
    v_lshlrev_b32 v44, 15, v3
    v_lshl_add_u32 v44, v2, 5, v44
    s_lshl_b32 s63, s65, 10
    s_lshl_b32 s64, s56, 7
    s_add_u32 s63, s63, s64
    s_add_u32 s63, s63, 1146880
    s_mov_b32 s70, 1040356334
    s_waitcnt vmcnt(0)
    ds_read_b128 v[128:131], v56 offset:0
    ds_read_b128 v[132:135], v57 offset:0
    ds_read_b128 v[136:139], v58 offset:0
    ds_read_b128 v[140:143], v59 offset:0
    ds_read_b128 v[144:147], v56 offset:1024
    ds_read_b128 v[148:151], v57 offset:1024
    ds_read_b128 v[152:155], v58 offset:1024
    ds_read_b128 v[156:159], v59 offset:1024
    ds_read_b128 v[160:163], v56 offset:2048
    ds_read_b128 v[164:167], v57 offset:2048
    ds_read_b128 v[168:171], v58 offset:2048
    ds_read_b128 v[172:175], v59 offset:2048
    ds_read_b128 v[176:179], v56 offset:3072
    ds_read_b128 v[180:183], v57 offset:3072
    ds_read_b128 v[184:187], v58 offset:3072
    ds_read_b128 v[188:191], v59 offset:3072
    s_barrier
    ds_read_b128 v[8:11], v43 offset:0
    ds_read_b128 v[12:15], v43 offset:64
    ds_read_b128 v[16:19], v43 offset:128
    ds_read_b128 v[20:23], v43 offset:192
    s_waitcnt lgkmcnt(0)
    v_mfma_f32_16x16x32_bf16 v[24:27], v[128:131], v[8:11], 0
    v_mfma_f32_16x16x32_bf16 v[28:31], v[144:147], v[8:11], 0
    v_mfma_f32_16x16x32_bf16 v[32:35], v[160:163], v[8:11], 0
    v_mfma_f32_16x16x32_bf16 v[36:39], v[176:179], v[8:11], 0
    v_mfma_f32_16x16x32_bf16 v[24:27], v[132:135], v[12:15], v[24:27]
    v_mfma_f32_16x16x32_bf16 v[28:31], v[148:151], v[12:15], v[28:31]
    v_mfma_f32_16x16x32_bf16 v[32:35], v[164:167], v[12:15], v[32:35]
    v_mfma_f32_16x16x32_bf16 v[36:39], v[180:183], v[12:15], v[36:39]
    v_mfma_f32_16x16x32_bf16 v[24:27], v[136:139], v[16:19], v[24:27]
    v_mfma_f32_16x16x32_bf16 v[28:31], v[152:155], v[16:19], v[28:31]
    v_mfma_f32_16x16x32_bf16 v[32:35], v[168:171], v[16:19], v[32:35]
    v_mfma_f32_16x16x32_bf16 v[36:39], v[184:187], v[16:19], v[36:39]
    v_mfma_f32_16x16x32_bf16 v[24:27], v[140:143], v[20:23], v[24:27]
    v_mfma_f32_16x16x32_bf16 v[28:31], v[156:159], v[20:23], v[28:31]
    v_mfma_f32_16x16x32_bf16 v[32:35], v[172:175], v[20:23], v[32:35]
    v_mfma_f32_16x16x32_bf16 v[36:39], v[188:191], v[20:23], v[36:39]
    s_nop 7
    v_mul_f32 v24, s70, v24
    v_mul_f32 v25, s70, v25
    v_mul_f32 v26, s70, v26
    v_mul_f32 v27, s70, v27
    v_mul_f32 v28, s70, v28
    v_mul_f32 v29, s70, v29
    v_mul_f32 v30, s70, v30
    v_mul_f32 v31, s70, v31
    v_mul_f32 v32, s70, v32
    v_mul_f32 v33, s70, v33
    v_mul_f32 v34, s70, v34
    v_mul_f32 v35, s70, v35
    v_mul_f32 v36, s70, v36
    v_mul_f32 v37, s70, v37
    v_mul_f32 v38, s70, v38
    v_mul_f32 v39, s70, v39
    v_cvt_pk_bf16_f32 v8, v24, v25
    v_cvt_pk_bf16_f32 v9, v26, v27
    v_cvt_pk_bf16_f32 v10, v28, v29
    v_cvt_pk_bf16_f32 v11, v30, v31
    v_cvt_pk_bf16_f32 v12, v32, v33
    v_cvt_pk_bf16_f32 v13, v34, v35
    v_cvt_pk_bf16_f32 v14, v36, v37
    v_cvt_pk_bf16_f32 v15, v38, v39
    s_mov_b32 exec_lo, 0x00030003
    s_mov_b32 exec_hi, 0x00030003
    buffer_store_dwordx4 v[8:11], v44, s[32:35], s63 offen sc0 sc1
    buffer_store_dwordx4 v[12:15], v44, s[32:35], s63 offen offset:16 sc0 sc1
    s_mov_b64 exec, -1
    s_barrier
    s_mov_b32 s44, s12
    s_mov_b32 s45, s13
    s_and_b32 s45, s45, 0xffff
    s_mov_b32 s46, 4194304
    s_mov_b32 s47, 0x00020000
    s_lshl_b32 s61, s56, 19
    s_lshl_b32 s62, s65, 8
    s_add_u32 s61, s61, s62
    buffer_load_dwordx4 v[64:67], v4, s[44:47], s61 offen nt
    s_add_u32 s61, s61, 8192
    buffer_load_dwordx4 v[68:71], v4, s[44:47], s61 offen nt
    s_add_u32 s61, s61, 8192
    buffer_load_dwordx4 v[72:75], v4, s[44:47], s61 offen nt
    s_add_u32 s61, s61, 8192
    buffer_load_dwordx4 v[76:79], v4, s[44:47], s61 offen nt
    s_add_u32 s61, s61, 8192
    buffer_load_dwordx4 v[80:83], v4, s[44:47], s61 offen nt
    s_add_u32 s61, s61, 8192
    buffer_load_dwordx4 v[84:87], v4, s[44:47], s61 offen nt
    s_add_u32 s61, s61, 8192
    buffer_load_dwordx4 v[88:91], v4, s[44:47], s61 offen nt
    s_add_u32 s61, s61, 8192
    buffer_load_dwordx4 v[92:95], v4, s[44:47], s61 offen nt
    s_add_u32 s61, s61, 8192
    buffer_load_dwordx4 v[96:99], v4, s[44:47], s61 offen nt
    s_add_u32 s61, s61, 8192
    buffer_load_dwordx4 v[100:103], v4, s[44:47], s61 offen nt
    s_add_u32 s61, s61, 8192
    buffer_load_dwordx4 v[104:107], v4, s[44:47], s61 offen nt
    s_add_u32 s61, s61, 8192
    buffer_load_dwordx4 v[108:111], v4, s[44:47], s61 offen nt
    s_add_u32 s61, s61, 8192
    buffer_load_dwordx4 v[112:115], v4, s[44:47], s61 offen nt
    s_add_u32 s61, s61, 8192
    buffer_load_dwordx4 v[116:119], v4, s[44:47], s61 offen nt
    s_add_u32 s61, s61, 8192
    buffer_load_dwordx4 v[120:123], v4, s[44:47], s61 offen nt
    s_add_u32 s61, s61, 8192
    buffer_load_dwordx4 v[124:127], v4, s[44:47], s61 offen nt
    s_mov_b32 s36, s14
    s_mov_b32 s37, s15
    s_and_b32 s37, s37, 0xffff
    s_mov_b32 s38, 4194304
    s_mov_b32 s39, 0x00020000
    s_lshl_b32 s61, s56, 14
    s_lshl_b32 s62, s65, 17
    s_add_u32 s62, s62, s61
    s_add_u32 m0, s61, 0
    v_xor_b32 v52, 0, v5
    buffer_load_dwordx4 v52, s[36:39], s62 offen nt lds
    s_add_u32 s62, s62, 1024
    s_add_u32 m0, s61, 1024
    v_xor_b32 v53, 64, v5
    buffer_load_dwordx4 v53, s[36:39], s62 offen nt lds
    s_add_u32 s62, s62, 1024
    s_add_u32 m0, s61, 2048
    v_xor_b32 v52, 128, v5
    buffer_load_dwordx4 v52, s[36:39], s62 offen nt lds
    s_add_u32 s62, s62, 1024
    s_add_u32 m0, s61, 3072
    v_xor_b32 v53, 192, v5
    buffer_load_dwordx4 v53, s[36:39], s62 offen nt lds
    s_add_u32 s62, s62, 1024
    s_add_u32 m0, s61, 4096
    v_xor_b32 v52, 0, v5
    buffer_load_dwordx4 v52, s[36:39], s62 offen nt lds
    s_add_u32 s62, s62, 1024
    s_add_u32 m0, s61, 5120
    v_xor_b32 v53, 64, v5
    buffer_load_dwordx4 v53, s[36:39], s62 offen nt lds
    s_add_u32 s62, s62, 1024
    s_add_u32 m0, s61, 6144
    v_xor_b32 v52, 128, v5
    buffer_load_dwordx4 v52, s[36:39], s62 offen nt lds
    s_add_u32 s62, s62, 1024
    s_add_u32 m0, s61, 7168
    v_xor_b32 v53, 192, v5
    buffer_load_dwordx4 v53, s[36:39], s62 offen nt lds
    s_add_u32 s62, s62, 1024
    s_add_u32 m0, s61, 8192
    v_xor_b32 v52, 32, v5
    buffer_load_dwordx4 v52, s[36:39], s62 offen nt lds
    s_add_u32 s62, s62, 1024
    s_add_u32 m0, s61, 9216
    v_xor_b32 v53, 96, v5
    buffer_load_dwordx4 v53, s[36:39], s62 offen nt lds
    s_add_u32 s62, s62, 1024
    s_add_u32 m0, s61, 10240
    v_xor_b32 v52, 160, v5
    buffer_load_dwordx4 v52, s[36:39], s62 offen nt lds
    s_add_u32 s62, s62, 1024
    s_add_u32 m0, s61, 11264
    v_xor_b32 v53, 224, v5
    buffer_load_dwordx4 v53, s[36:39], s62 offen nt lds
    s_add_u32 s62, s62, 1024
    s_add_u32 m0, s61, 12288
    v_xor_b32 v52, 32, v5
    buffer_load_dwordx4 v52, s[36:39], s62 offen nt lds
    s_add_u32 s62, s62, 1024
    s_add_u32 m0, s61, 13312
    v_xor_b32 v53, 96, v5
    buffer_load_dwordx4 v53, s[36:39], s62 offen nt lds
    s_add_u32 s62, s62, 1024
    s_add_u32 m0, s61, 14336
    v_xor_b32 v52, 160, v5
    buffer_load_dwordx4 v52, s[36:39], s62 offen nt lds
    s_add_u32 s62, s62, 1024
    s_add_u32 m0, s61, 15360
    v_xor_b32 v53, 224, v5
    buffer_load_dwordx4 v53, s[36:39], s62 offen nt lds
    s_waitcnt vmcnt(0)
    s_barrier
    v_lshrrev_b32 v40, 2, v3
    v_and_b32 v41, 1, v2
    v_lshlrev_b32 v42, 2, v40
    v_lshl_or_b32 v42, v41, 1, v42
    v_lshl_add_u32 v43, v2, 3, v40
    v_lshlrev_b32 v43, 10, v43
    v_and_b32 v44, 1, v3
    v_lshl_add_u32 v43, v44, 3, v43
    v_bfe_u32 v44, v3, 1, 1
    s_lshl_b32 s61, s56, 3
    s_add_u32 s62, s61, 0
    v_add_u32 v45, s62, v44
    v_xor_b32 v45, v45, v42
    v_lshl_add_u32 v48, v45, 4, v43
    s_add_u32 s62, s61, 2
    v_add_u32 v45, s62, v44
    v_xor_b32 v45, v45, v42
    v_lshl_add_u32 v49, v45, 4, v43
    s_add_u32 s62, s61, 4
    v_add_u32 v45, s62, v44
    v_xor_b32 v45, v45, v42
    v_lshl_add_u32 v50, v45, 4, v43
    s_add_u32 s62, s61, 6
    v_add_u32 v45, s62, v44
    v_xor_b32 v45, v45, v42
    v_lshl_add_u32 v51, v45, 4, v43
    ds_read_b64_tr_b16 v[128:129], v48 offset:0
    ds_read_b64_tr_b16 v[130:131], v48 offset:4096
    ds_read_b64_tr_b16 v[144:145], v49 offset:0
    ds_read_b64_tr_b16 v[146:147], v49 offset:4096
    ds_read_b64_tr_b16 v[160:161], v50 offset:0
    ds_read_b64_tr_b16 v[162:163], v50 offset:4096
    ds_read_b64_tr_b16 v[176:177], v51 offset:0
    ds_read_b64_tr_b16 v[178:179], v51 offset:4096
    s_waitcnt lgkmcnt(0)
    ds_read_b64_tr_b16 v[132:133], v48 offset:32768
    ds_read_b64_tr_b16 v[134:135], v48 offset:36864
    ds_read_b64_tr_b16 v[148:149], v49 offset:32768
    ds_read_b64_tr_b16 v[150:151], v49 offset:36864
    ds_read_b64_tr_b16 v[164:165], v50 offset:32768
    ds_read_b64_tr_b16 v[166:167], v50 offset:36864
    ds_read_b64_tr_b16 v[180:181], v51 offset:32768
    ds_read_b64_tr_b16 v[182:183], v51 offset:36864
    s_waitcnt lgkmcnt(0)
    v_add_u32 v48, 0x10000, v48
    v_add_u32 v49, 0x10000, v49
    v_add_u32 v50, 0x10000, v50
    v_add_u32 v51, 0x10000, v51
    ds_read_b64_tr_b16 v[136:137], v48 offset:0
    ds_read_b64_tr_b16 v[138:139], v48 offset:4096
    ds_read_b64_tr_b16 v[152:153], v49 offset:0
    ds_read_b64_tr_b16 v[154:155], v49 offset:4096
    ds_read_b64_tr_b16 v[168:169], v50 offset:0
    ds_read_b64_tr_b16 v[170:171], v50 offset:4096
    ds_read_b64_tr_b16 v[184:185], v51 offset:0
    ds_read_b64_tr_b16 v[186:187], v51 offset:4096
    s_waitcnt lgkmcnt(0)
    ds_read_b64_tr_b16 v[140:141], v48 offset:32768
    ds_read_b64_tr_b16 v[142:143], v48 offset:36864
    ds_read_b64_tr_b16 v[156:157], v49 offset:32768
    ds_read_b64_tr_b16 v[158:159], v49 offset:36864
    ds_read_b64_tr_b16 v[172:173], v50 offset:32768
    ds_read_b64_tr_b16 v[174:175], v50 offset:36864
    ds_read_b64_tr_b16 v[188:189], v51 offset:32768
    ds_read_b64_tr_b16 v[190:191], v51 offset:36864
    s_waitcnt lgkmcnt(0)
    v_perm_b32 v192, v68, v64, s68
    v_perm_b32 v193, v76, v72, s68
    v_perm_b32 v194, v84, v80, s68
    v_perm_b32 v195, v92, v88, s68
    v_perm_b32 v196, v68, v64, s69
    v_perm_b32 v197, v76, v72, s69
    v_perm_b32 v198, v84, v80, s69
    v_perm_b32 v199, v92, v88, s69
    v_perm_b32 v200, v69, v65, s68
    v_perm_b32 v201, v77, v73, s68
    v_perm_b32 v202, v85, v81, s68
    v_perm_b32 v203, v93, v89, s68
    v_perm_b32 v204, v69, v65, s69
    v_perm_b32 v205, v77, v73, s69
    v_perm_b32 v206, v85, v81, s69
    v_perm_b32 v207, v93, v89, s69
    v_perm_b32 v208, v70, v66, s68
    v_perm_b32 v209, v78, v74, s68
    v_perm_b32 v210, v86, v82, s68
    v_perm_b32 v211, v94, v90, s68
    v_perm_b32 v212, v70, v66, s69
    v_perm_b32 v213, v78, v74, s69
    v_perm_b32 v214, v86, v82, s69
    v_perm_b32 v215, v94, v90, s69
    v_perm_b32 v216, v71, v67, s68
    v_perm_b32 v217, v79, v75, s68
    v_perm_b32 v218, v87, v83, s68
    v_perm_b32 v219, v95, v91, s68
    v_perm_b32 v220, v71, v67, s69
    v_perm_b32 v221, v79, v75, s69
    v_perm_b32 v222, v87, v83, s69
    v_perm_b32 v223, v95, v91, s69
    v_perm_b32 v224, v100, v96, s68
    v_perm_b32 v225, v108, v104, s68
    v_perm_b32 v226, v116, v112, s68
    v_perm_b32 v227, v124, v120, s68
    v_perm_b32 v228, v100, v96, s69
    v_perm_b32 v229, v108, v104, s69
    v_perm_b32 v230, v116, v112, s69
    v_perm_b32 v231, v124, v120, s69
    v_perm_b32 v232, v101, v97, s68
    v_perm_b32 v233, v109, v105, s68
    v_perm_b32 v234, v117, v113, s68
    v_perm_b32 v235, v125, v121, s68
    v_perm_b32 v236, v101, v97, s69
    v_perm_b32 v237, v109, v105, s69
    v_perm_b32 v238, v117, v113, s69
    v_perm_b32 v239, v125, v121, s69
    v_perm_b32 v240, v102, v98, s68
    v_perm_b32 v241, v110, v106, s68
    v_perm_b32 v242, v118, v114, s68
    v_perm_b32 v243, v126, v122, s68
    v_perm_b32 v244, v102, v98, s69
    v_perm_b32 v245, v110, v106, s69
    v_perm_b32 v246, v118, v114, s69
    v_perm_b32 v247, v126, v122, s69
    v_perm_b32 v248, v103, v99, s68
    v_perm_b32 v249, v111, v107, s68
    v_perm_b32 v250, v119, v115, s68
    v_perm_b32 v251, v127, v123, s68
    v_perm_b32 v252, v103, v99, s69
    v_perm_b32 v253, v111, v107, s69
    v_perm_b32 v254, v119, v115, s69
    v_perm_b32 v255, v127, v123, s69
    s_barrier
    s_cmp_lg_u32 s56, 0
    s_cbranch_scc1 Lwf_69
    v_lshlrev_b32 v40, 2, v1
    s_mov_b64 exec, 0xffffffff
    s_mov_b32 s92, 0
Lpoll_70:
    buffer_load_dword v41, v40, s[32:35], s93 offen offset:0 sc0 sc1
    s_waitcnt vmcnt(0)
    v_mov_b32 v42, v41
    v_cmpx_eq_u32 vcc, -1, v42
    s_cbranch_execz Lpolld_71
    s_sleep 8
    s_add_u32 s92, s92, 1
    s_cmp_lt_u32 s92, 400000
    s_cbranch_scc1 Lpoll_70
Lpolld_71:
    s_mov_b64 exec, -1
Lwf_69:
    s_barrier
    s_lshr_b32 s66, s56, 2
    s_and_b32 s63, s56, 3
    s_lshl_b32 s61, s56, 17
    s_lshl_b32 s62, s65, 10
    s_add_u32 s61, s61, s62
    s_add_u32 s61, s61, 2097152
    v_lshlrev_b32 v40, 3, v3
    s_lshl_b32 s62, s65, 8
    s_lshl_b32 s64, s66, 7
    s_add_u32 s62, s62, s64
    s_add_u32 s62, s62, 1245184
    buffer_load_dwordx2 v[42:43], v40, s[32:35], s62 offen sc0 sc1
    buffer_load_dwordx4 v[64:67], v5, s[32:35], s61 offen sc0 sc1
    s_add_u32 s61, s61, 32768
    buffer_load_dwordx4 v[68:71], v5, s[32:35], s61 offen sc0 sc1
    s_add_u32 s61, s61, 32768
    buffer_load_dwordx4 v[72:75], v5, s[32:35], s61 offen sc0 sc1
    s_add_u32 s61, s61, 32768
    buffer_load_dwordx4 v[76:79], v5, s[32:35], s61 offen sc0 sc1
    s_waitcnt vmcnt(4)
    v_mov_b32 v44, v42
    s_nop 1
    v_max_f32_dpp v44, v44, v44 row_ror:8 row_mask:0xf bank_mask:0xf
    s_nop 1
    v_max_f32_dpp v44, v44, v44 row_ror:4 row_mask:0xf bank_mask:0xf
    s_nop 1
    v_max_f32_dpp v44, v44, v44 row_ror:2 row_mask:0xf bank_mask:0xf
    s_nop 1
    v_max_f32_dpp v44, v44, v44 row_ror:1 row_mask:0xf bank_mask:0xf
    v_sub_f32 v42, v42, v44
    v_exp_f32 v42, v42
    s_nop 0
    v_mul_f32 v43, v43, v42
    s_nop 1
    v_add_f32_dpp v43, v43, v43 row_ror:8 row_mask:0xf bank_mask:0xf
    s_nop 1
    v_add_f32_dpp v43, v43, v43 row_ror:4 row_mask:0xf bank_mask:0xf
    s_nop 1
    v_add_f32_dpp v43, v43, v43 row_ror:2 row_mask:0xf bank_mask:0xf
    s_nop 1
    v_add_f32_dpp v43, v43, v43 row_ror:1 row_mask:0xf bank_mask:0xf
    v_rcp_f32 v43, v43
    s_nop 0
    v_mul_f32 v42, v42, v43
    s_lshl_b32 s63, s63, 2
    s_nop 1
    s_add_u32 s64, s63, 0
    v_readlane_b32 s76, v42, s64
    s_add_u32 s64, s63, 1
    v_readlane_b32 s77, v42, s64
    s_add_u32 s64, s63, 2
    v_readlane_b32 s78, v42, s64
    s_add_u32 s64, s63, 3
    v_readlane_b32 s79, v42, s64
    s_nop 1
    s_waitcnt vmcnt(3)
    v_lshlrev_b32 v48, 16, v64
    v_and_b32 v49, 0xffff0000, v64
    v_lshlrev_b32 v50, 16, v65
    v_and_b32 v51, 0xffff0000, v65
    v_lshlrev_b32 v52, 16, v66
    v_and_b32 v53, 0xffff0000, v66
    v_lshlrev_b32 v54, 16, v67
    v_and_b32 v55, 0xffff0000, v67
    v_mul_f32 v24, s76, v48
    v_mul_f32 v25, s76, v49
    v_mul_f32 v26, s76, v50
    v_mul_f32 v27, s76, v51
    v_mul_f32 v28, s76, v52
    v_mul_f32 v29, s76, v53
    v_mul_f32 v30, s76, v54
    v_mul_f32 v31, s76, v55
    s_waitcnt vmcnt(2)
    v_lshlrev_b32 v48, 16, v68
    v_and_b32 v49, 0xffff0000, v68
    v_lshlrev_b32 v50, 16, v69
    v_and_b32 v51, 0xffff0000, v69
    v_lshlrev_b32 v52, 16, v70
    v_and_b32 v53, 0xffff0000, v70
    v_lshlrev_b32 v54, 16, v71
    v_and_b32 v55, 0xffff0000, v71
    v_fmac_f32 v24, s77, v48
    v_fmac_f32 v25, s77, v49
    v_fmac_f32 v26, s77, v50
    v_fmac_f32 v27, s77, v51
    v_fmac_f32 v28, s77, v52
    v_fmac_f32 v29, s77, v53
    v_fmac_f32 v30, s77, v54
    v_fmac_f32 v31, s77, v55
    s_waitcnt vmcnt(1)
    v_lshlrev_b32 v48, 16, v72
    v_and_b32 v49, 0xffff0000, v72
    v_lshlrev_b32 v50, 16, v73
    v_and_b32 v51, 0xffff0000, v73
    v_lshlrev_b32 v52, 16, v74
    v_and_b32 v53, 0xffff0000, v74
    v_lshlrev_b32 v54, 16, v75
    v_and_b32 v55, 0xffff0000, v75
    v_fmac_f32 v24, s78, v48
    v_fmac_f32 v25, s78, v49
    v_fmac_f32 v26, s78, v50
    v_fmac_f32 v27, s78, v51
    v_fmac_f32 v28, s78, v52
    v_fmac_f32 v29, s78, v53
    v_fmac_f32 v30, s78, v54
    v_fmac_f32 v31, s78, v55
    s_waitcnt vmcnt(0)
    v_lshlrev_b32 v48, 16, v76
    v_and_b32 v49, 0xffff0000, v76
    v_lshlrev_b32 v50, 16, v77
    v_and_b32 v51, 0xffff0000, v77
    v_lshlrev_b32 v52, 16, v78
    v_and_b32 v53, 0xffff0000, v78
    v_lshlrev_b32 v54, 16, v79
    v_and_b32 v55, 0xffff0000, v79
    v_fmac_f32 v24, s79, v48
    v_fmac_f32 v25, s79, v49
    v_fmac_f32 v26, s79, v50
    v_fmac_f32 v27, s79, v51
    v_fmac_f32 v28, s79, v52
    v_fmac_f32 v29, s79, v53
    v_fmac_f32 v30, s79, v54
    v_fmac_f32 v31, s79, v55
    s_lshl_b32 s61, s56, 11
    v_lshlrev_b32 v40, 5, v1
    v_add_u32 v40, s61, v40
    ds_write_b128 v40, v[24:27] offset:16384
    ds_write_b128 v40, v[28:31] offset:16400
    s_waitcnt lgkmcnt(0)
    s_barrier
    v_and_b32 v40, 255, v0
    v_lshlrev_b32 v40, 3, v40
    s_lshl_b32 s61, s66, 13
    v_add_u32 v40, s61, v40
    ds_read_b64 v[24:25], v40 offset:16384
    ds_read_b64 v[26:27], v40 offset:18432
    ds_read_b64 v[28:29], v40 offset:20480
    ds_read_b64 v[30:31], v40 offset:22528
    s_waitcnt lgkmcnt(0)
    v_add_f32 v24, v24, v26
    v_add_f32 v25, v25, v27
    v_add_f32 v24, v24, v28
    v_add_f32 v25, v25, v29
    v_add_f32 v24, v24, v30
    v_add_f32 v25, v25, v31
    v_cvt_pk_bf16_f32 v24, v24, v25
    v_lshlrev_b32 v40, 2, v0
    ds_write_b32 v40, v24 offset:32768
    s_waitcnt lgkmcnt(0)
    s_barrier
    s_lshl_b32 s61, s56, 7
    v_lshlrev_b32 v40, 5, v2
    v_and_b32 v41, 1, v3
    v_lshl_add_u32 v40, v41, 10, v40
    v_add_u32 v40, s61, v40
    ds_read_b128 v[8:11], v40 offset:32768
    ds_read_b128 v[12:15], v40 offset:32784
    s_waitcnt lgkmcnt(1)
    v_mfma_f32_16x16x32_bf16 v[96:99], v[8:11], v[192:195], 0
    v_mfma_f32_16x16x32_bf16 v[100:103], v[8:11], v[196:199], 0
    v_mfma_f32_16x16x32_bf16 v[104:107], v[8:11], v[200:203], 0
    v_mfma_f32_16x16x32_bf16 v[108:111], v[8:11], v[204:207], 0
    v_mfma_f32_16x16x32_bf16 v[112:115], v[8:11], v[208:211], 0
    v_mfma_f32_16x16x32_bf16 v[116:119], v[8:11], v[212:215], 0
    v_mfma_f32_16x16x32_bf16 v[120:123], v[8:11], v[216:219], 0
    v_mfma_f32_16x16x32_bf16 v[124:127], v[8:11], v[220:223], 0
    s_waitcnt lgkmcnt(0)
    v_mfma_f32_16x16x32_bf16 v[96:99], v[12:15], v[224:227], v[96:99]
    v_mfma_f32_16x16x32_bf16 v[100:103], v[12:15], v[228:231], v[100:103]
    v_mfma_f32_16x16x32_bf16 v[104:107], v[12:15], v[232:235], v[104:107]
    v_mfma_f32_16x16x32_bf16 v[108:111], v[12:15], v[236:239], v[108:111]
    v_mfma_f32_16x16x32_bf16 v[112:115], v[12:15], v[240:243], v[112:115]
    v_mfma_f32_16x16x32_bf16 v[116:119], v[12:15], v[244:247], v[116:119]
    v_mfma_f32_16x16x32_bf16 v[120:123], v[12:15], v[248:251], v[120:123]
    v_mfma_f32_16x16x32_bf16 v[124:127], v[12:15], v[252:255], v[124:127]
    v_lshlrev_b32 v40, 5, v3
    s_lshl_b32 s61, s56, 9
    v_add_u32 v40, s61, v40
    s_nop 7
    v_mov_b32 v24, v96
    v_mov_b32 v25, v100
    v_mov_b32 v26, v104
    v_mov_b32 v27, v108
    v_mov_b32 v28, v112
    v_mov_b32 v29, v116
    v_mov_b32 v30, v120
    v_mov_b32 v31, v124
    v_mov_b32 v32, v97
    v_mov_b32 v33, v101
    v_mov_b32 v34, v105
    v_mov_b32 v35, v109
    v_mov_b32 v36, v113
    v_mov_b32 v37, v117
    v_mov_b32 v38, v121
    v_mov_b32 v39, v125
    s_mov_b64 exec, 0xffff
    ds_write_b128 v40, v[24:27] offset:0
    ds_write_b128 v40, v[28:31] offset:16
    ds_write_b128 v40, v[32:35] offset:4096
    ds_write_b128 v40, v[36:39] offset:4112
    s_mov_b64 exec, -1
    s_waitcnt lgkmcnt(0)
    s_barrier
    v_lshrrev_b32 v40, 5, v1
    v_lshlrev_b32 v40, 12, v40
    v_and_b32 v41, 31, v1
    v_lshl_add_u32 v40, v41, 4, v40
    ds_read_b128 v[64:67], v40 offset:0
    ds_read_b128 v[68:71], v40 offset:512
    ds_read_b128 v[72:75], v40 offset:1024
    ds_read_b128 v[76:79], v40 offset:1536
    ds_read_b128 v[80:83], v40 offset:2048
    ds_read_b128 v[84:87], v40 offset:2560
    ds_read_b128 v[88:91], v40 offset:3072
    ds_read_b128 v[92:95], v40 offset:3584
    s_lshl_b32 s61, s56, 9
    s_add_u32 s61, s61, 131072
    v_lshlrev_b32 v46, 3, v1
    v_add_u32 v46, s61, v46
    v_and_b32 v47, 1, v3
    v_lshlrev_b32 v47, 8, v47
    v_lshl_add_u32 v47, v2, 4, v47
    v_add_u32 v47, s61, v47
    s_waitcnt lgkmcnt(6)
    v_add_f32 v64, v64, v68
    v_add_f32 v65, v65, v69
    v_add_f32 v66, v66, v70
    v_add_f32 v67, v67, v71
    s_waitcnt lgkmcnt(5)
    v_add_f32 v64, v64, v72
    v_add_f32 v65, v65, v73
    v_add_f32 v66, v66, v74
    v_add_f32 v67, v67, v75
    s_waitcnt lgkmcnt(4)
    v_add_f32 v64, v64, v76
    v_add_f32 v65, v65, v77
    v_add_f32 v66, v66, v78
    v_add_f32 v67, v67, v79
    s_waitcnt lgkmcnt(3)
    v_add_f32 v64, v64, v80
    v_add_f32 v65, v65, v81
    v_add_f32 v66, v66, v82
    v_add_f32 v67, v67, v83
    s_waitcnt lgkmcnt(2)
    v_add_f32 v64, v64, v84
    v_add_f32 v65, v65, v85
    v_add_f32 v66, v66, v86
    v_add_f32 v67, v67, v87
    s_waitcnt lgkmcnt(1)
    v_add_f32 v64, v64, v88
    v_add_f32 v65, v65, v89
    v_add_f32 v66, v66, v90
    v_add_f32 v67, v67, v91
    s_waitcnt lgkmcnt(0)
    v_add_f32 v64, v64, v92
    v_add_f32 v65, v65, v93
    v_add_f32 v66, v66, v94
    v_add_f32 v67, v67, v95
    v_cvt_pk_bf16_f32 v64, v64, v65
    v_cvt_pk_bf16_f32 v65, v66, v67
    ds_write_b64 v46, v[64:65]
    s_waitcnt lgkmcnt(0)
    ds_read_b128 v[24:27], v47 offset:0
    ds_read_b128 v[28:31], v47 offset:64
    ds_read_b128 v[32:35], v47 offset:128
    ds_read_b128 v[36:39], v47 offset:192
    s_waitcnt lgkmcnt(3)
    v_mfma_f32_16x16x32_bf16 v[8:11], v[24:27], v[128:131], 0
    v_mfma_f32_16x16x32_bf16 v[12:15], v[24:27], v[144:147], 0
    v_mfma_f32_16x16x32_bf16 v[16:19], v[24:27], v[160:163], 0
    v_mfma_f32_16x16x32_bf16 v[20:23], v[24:27], v[176:179], 0
    s_waitcnt lgkmcnt(2)
    v_mfma_f32_16x16x32_bf16 v[8:11], v[28:31], v[132:135], v[8:11]
    v_mfma_f32_16x16x32_bf16 v[12:15], v[28:31], v[148:151], v[12:15]
    v_mfma_f32_16x16x32_bf16 v[16:19], v[28:31], v[164:167], v[16:19]
    v_mfma_f32_16x16x32_bf16 v[20:23], v[28:31], v[180:183], v[20:23]
    s_waitcnt lgkmcnt(1)
    v_mfma_f32_16x16x32_bf16 v[8:11], v[32:35], v[136:139], v[8:11]
    v_mfma_f32_16x16x32_bf16 v[12:15], v[32:35], v[152:155], v[12:15]
    v_mfma_f32_16x16x32_bf16 v[16:19], v[32:35], v[168:171], v[16:19]
    v_mfma_f32_16x16x32_bf16 v[20:23], v[32:35], v[184:187], v[20:23]
    s_waitcnt lgkmcnt(0)
    v_mfma_f32_16x16x32_bf16 v[8:11], v[36:39], v[140:143], v[8:11]
    v_mfma_f32_16x16x32_bf16 v[12:15], v[36:39], v[156:159], v[12:15]
    v_mfma_f32_16x16x32_bf16 v[16:19], v[36:39], v[172:175], v[16:19]
    v_mfma_f32_16x16x32_bf16 v[20:23], v[36:39], v[188:191], v[20:23]
    v_lshlrev_b32 v40, 2, v3
    s_lshl_b32 s61, s56, 16
    s_lshl_b32 s62, s65, 6
    s_add_u32 s61, s61, s62
    s_add_u32 s61, s61, 5376
    s_nop 4
    s_mov_b64 exec, 0xffff
    s_add_u32 s62, s61, 0
    buffer_store_dword v8, v40, s[32:35], s62 offen sc0 sc1
    s_add_u32 s62, s61, 524288
    buffer_store_dword v9, v40, s[32:35], s62 offen sc0 sc1
    s_add_u32 s62, s61, 16384
    buffer_store_dword v12, v40, s[32:35], s62 offen sc0 sc1
    s_add_u32 s62, s61, 540672
    buffer_store_dword v13, v40, s[32:35], s62 offen sc0 sc1
    s_add_u32 s62, s61, 32768
    buffer_store_dword v16, v40, s[32:35], s62 offen sc0 sc1
    s_add_u32 s62, s61, 557056
    buffer_store_dword v17, v40, s[32:35], s62 offen sc0 sc1
    s_add_u32 s62, s61, 49152
    buffer_store_dword v20, v40, s[32:35], s62 offen sc0 sc1
    s_add_u32 s62, s61, 573440
    buffer_store_dword v21, v40, s[32:35], s62 offen sc0 sc1
    s_mov_b64 exec, -1
    s_branch L_final
L_final:
    s_cmp_ge_u32 s56, 2
    s_cbranch_scc1 L_end
    s_lshr_b32 s66, s75, 5
    s_and_b32 s64, s75, 31
    v_lshlrev_b32 v8, 5, v1
    s_lshl_b32 s61, s56, 11
    s_add_u32 s61, s61, 3328
    s_add_u32 s61, s61, s93
    v_and_b32 v6, 1, v1
    v_lshlrev_b32 v6, 4, v6
    v_lshl_add_u32 v6, v2, 2, v6
    s_lshl_b32 s57, s66, 11
    s_lshl_b32 s58, s64, 5
    s_add_u32 s57, s57, s58
    s_xor_b32 s58, s56, 1
    s_lshl_b32 s58, s58, 10
    s_add_u32 s57, s57, s58
    s_mov_b32 s36, s26
    s_mov_b32 s37, s27
    s_and_b32 s37, s37, 0xffff
    s_mov_b32 s38, 4096
    s_mov_b32 s39, 0x00020000
    s_mov_b32 s92, 0
    buffer_load_dwordx4 v[12:15], v8, s[32:35], s61 offen sc0 sc1
    buffer_load_dwordx4 v[16:19], v8, s[32:35], s61 offen offset:16 sc0 sc1
Lp2_74:
    buffer_load_dwordx4 v[24:27], v8, s[32:35], s61 offen sc0 sc1
    buffer_load_dwordx4 v[28:31], v8, s[32:35], s61 offen offset:16 sc0 sc1
    s_waitcnt vmcnt(2)
    v_mov_b32 v22, v12
    v_max3_u32 v22, v22, v13, v14
    v_max3_u32 v22, v22, v15, v16
    v_max3_u32 v22, v22, v17, v18
    v_max_u32 v22, v22, v19
    v_cmp_eq_u32 vcc, -1, v22
    s_cbranch_vccz Lp2A_75
    buffer_load_dwordx4 v[12:15], v8, s[32:35], s61 offen sc0 sc1
    buffer_load_dwordx4 v[16:19], v8, s[32:35], s61 offen offset:16 sc0 sc1
    s_waitcnt vmcnt(2)
    v_mov_b32 v22, v24
    v_max3_u32 v22, v22, v25, v26
    v_max3_u32 v22, v22, v27, v28
    v_max3_u32 v22, v22, v29, v30
    v_max_u32 v22, v22, v31
    v_cmp_eq_u32 vcc, -1, v22
    s_cbranch_vccz Lp2B_76
    s_add_u32 s92, s92, 1
    s_cmp_lt_u32 s92, 400000
    s_cbranch_scc1 Lp2_74
Lp2B_76:
    s_waitcnt vmcnt(0)
    v_mov_b32 v12, v24
    v_mov_b32 v13, v25
    v_mov_b32 v14, v26
    v_mov_b32 v15, v27
    v_mov_b32 v16, v28
    v_mov_b32 v17, v29
    v_mov_b32 v18, v30
    v_mov_b32 v19, v31
    s_branch Lp2D_77
Lp2A_75:
Lp2D_77:
Lfsk_72:
    s_nop 1
    v_permlane32_swap_b32 v12, v16
    v_permlane32_swap_b32 v13, v17
    v_permlane32_swap_b32 v14, v18
    v_permlane32_swap_b32 v15, v19
    s_nop 1
    v_add_f32 v12, v12, v16
    v_add_f32 v13, v13, v17
    v_add_f32 v14, v14, v18
    v_add_f32 v15, v15, v19
    s_nop 1
    v_permlane16_swap_b32 v12, v14
    v_permlane16_swap_b32 v13, v15
    s_nop 1
    v_add_f32 v12, v12, v14
    v_add_f32 v13, v13, v15
    s_nop 0
    v_add_f32_dpp v12, v12, v12 row_ror:8 row_mask:0xf bank_mask:0xf
    v_add_f32_dpp v13, v13, v13 row_ror:8 row_mask:0xf bank_mask:0xf
    s_nop 0
    v_add_f32_dpp v12, v12, v12 row_ror:4 row_mask:0xf bank_mask:0xf
    v_add_f32_dpp v13, v13, v13 row_ror:4 row_mask:0xf bank_mask:0xf
    s_nop 0
    v_add_f32_dpp v12, v12, v12 quad_perm:[2,3,0,1] row_mask:0xf bank_mask:0xf
    v_add_f32_dpp v13, v13, v13 quad_perm:[2,3,0,1] row_mask:0xf bank_mask:0xf
    v_cvt_pk_bf16_f32 v12, v12, v13
    s_mov_b32 exec_lo, 0x00030003
    s_mov_b32 exec_hi, 0x00030003
    buffer_store_dword v12, v6, s[36:39], s57 offen
    s_mov_b64 exec, -1
    s_branch L_end
L_end:
    s_endpgm
.section .rodata,"a"
.p2align 6
.amdhsa_kernel concat_heads__compressed_kv_cla__gqa_block_cached__decode_kernel
  .amdhsa_next_free_vgpr 256
  .amdhsa_next_free_sgpr 102
  .amdhsa_accum_offset 256
  .amdhsa_group_segment_fixed_size 0
  .amdhsa_kernarg_size 112
  .amdhsa_user_sgpr_count 2
  .amdhsa_user_sgpr_kernarg_segment_ptr 1
  .amdhsa_system_sgpr_workgroup_id_x 1
.end_amdhsa_kernel
```

```asm
; @launch grid=(256,1,1) block=(512,1,1) lds=163840
.amdgcn_target "amdgcn-amd-amdhsa--gfx950"
.text
.globl concat_heads__compressed_kv_cla__gqa_block_cached__decode_kernel
.p2align 8
.type concat_heads__compressed_kv_cla__gqa_block_cached__decode_kernel,@function
concat_heads__compressed_kv_cla__gqa_block_cached__decode_kernel:
    s_load_dwordx16 s[4:19], s[0:1], 0
    s_load_dwordx8 s[20:27], s[0:1], 64
    s_load_dwordx4 s[28:31], s[0:1], 96
    s_cmp_ge_u32 s2, 256
    s_cbranch_scc1 L_end
    s_cmp_ge_u32 s2, 8
    s_cbranch_scc1 Lpf_1
    s_getpc_b64 s[60:61]
    s_and_b32 s60, s60, 0xffffff00
    v_lshlrev_b32 v2, 4, v0
    v_min_u32 v3, L_end-concat_heads__compressed_kv_cla__gqa_block_cached__decode_kernel-16, v2
    global_load_dwordx4 v[252:255], v3, s[60:61]
    v_add_u32 v2, 0x2000, v2
    v_min_u32 v3, L_end-concat_heads__compressed_kv_cla__gqa_block_cached__decode_kernel-16, v2
    global_load_dwordx4 v[252:255], v3, s[60:61]
    v_add_u32 v2, 0x2000, v2
    v_min_u32 v3, L_end-concat_heads__compressed_kv_cla__gqa_block_cached__decode_kernel-16, v2
    global_load_dwordx4 v[252:255], v3, s[60:61]
    v_add_u32 v2, 0x2000, v2
    v_min_u32 v3, L_end-concat_heads__compressed_kv_cla__gqa_block_cached__decode_kernel-16, v2
    global_load_dwordx4 v[252:255], v3, s[60:61]
Lpf_1:
    v_lshrrev_b32 v1, 6, v0
    s_lshr_b32 s57, s2, 3
    v_readfirstlane_b32 s56, v1
    s_and_b32 s58, s2, 7
    s_nop 0
    s_and_b32 s59, s57, 3
    s_lshl_b32 s60, s58, 2
    s_add_u32 s86, s59, s60
    s_bfe_u32 s87, s57, 0x10002
    s_bfe_u32 s88, s57, 0x10003
    s_lshr_b32 s78, s57, 4
    v_and_b32 v228, 63, v0
    v_lshrrev_b32 v229, 3, v228
    v_and_b32 v230, 7, v228
    v_lshlrev_b32 v232, 15, v229
    v_lshl_add_u32 v232, v230, 4, v232
    s_lshl_b32 s76, s56, 6
    s_lshl_b32 s62, s88, 9
    s_add_u32 s76, s76, s62
    s_lshl_b32 s77, s76, 12
    s_lshl_b32 s59, s86, 8
    s_lshl_b32 s60, s87, 7
    s_add_u32 s77, s77, s59
    s_add_u32 s77, s77, s60
    s_mov_b32 s38, 4194304
    s_mov_b32 s39, 0x00020000
    s_cmp_lt_u32 s57, 8
    s_cbranch_scc1 L_roleA
    s_waitcnt lgkmcnt(0)
    s_cmp_eq_u32 s78, 0
    s_cselect_b32 s36, s8, s22
    s_cselect_b32 s37, s9, s23
    s_cselect_b32 s40, s4, s16
    s_cselect_b32 s41, s5, s17
    s_and_b32 s37, s37, 0xffff
    buffer_load_dwordx4 v[192:195], v232, s[36:39], s77 offen nt
    s_add_u32 s77, s77, 8192
    buffer_load_dwordx4 v[196:199], v232, s[36:39], s77 offen nt
    s_add_u32 s77, s77, 8192
    buffer_load_dwordx4 v[200:203], v232, s[36:39], s77 offen nt
    s_add_u32 s77, s77, 8192
    buffer_load_dwordx4 v[204:207], v232, s[36:39], s77 offen nt
    s_and_b32 s41, s41, 0xffff
    s_mov_b32 s42, 2048
    s_mov_b32 s43, 0x00020000
    v_lshlrev_b32 v231, 3, v229
    buffer_load_dwordx2 v[208:209], v231, s[40:43], s76 offen offset:0
    buffer_load_dwordx2 v[210:211], v231, s[40:43], s76 offen offset:1024
    s_lshl_b32 s3, s78, 5
    s_add_u32 s3, s3, s86
    s_lshl_b32 s3, s3, 2
    s_add_u32 s3, s3, s88
    s_lshl_b32 s3, s3, 1
    s_add_u32 s3, s3, s87
    s_lshl_b32 s3, s3, 8
    s_add_u32 s3, s3, 1310720
    s_and_b32 s91, s86, 0xfc
    s_mov_b32 s68, 0x05040100
    s_mov_b32 s69, 0x07060302
    s_mov_b32 s32, s30
    s_and_b32 s33, s31, 0xffff
    s_mov_b32 s34, 268435456
    s_mov_b32 s35, 0x00020000
    s_mov_b32 s52, s28
    s_and_b32 s53, s29, 0xffff
    s_mov_b32 s54, 256
    s_mov_b32 s55, 0x00020000
    s_sub_u32 s57, s57, 8
    s_mul_i32 s59, s57, 43
    s_lshr_b32 s59, s59, 8
    s_mul_i32 s60, s59, 6
    s_sub_u32 s60, s57, s60
    s_mul_i32 s66, s60, 86
    s_lshr_b32 s66, s66, 8
    s_mul_i32 s61, s66, 3
    s_sub_u32 s67, s60, s61
    s_mov_b32 s64, s60
    s_mul_i32 s65, s67, 3
    s_add_u32 s65, s65, s58
    s_and_b32 s65, s65, 7
    s_lshl_b32 s65, s65, 2
    s_add_u32 s65, s65, s59
    v_and_b32 v1, 63, v0
    v_lshrrev_b32 v2, 4, v1
    v_and_b32 v3, 15, v1
    s_lshl_b32 s59, s66, 5
    s_add_u32 s59, s59, s65
    s_lshl_b32 s61, s59, 20
    s_lshl_b32 s63, s59, 8
    s_add_u32 s63, s63, 1507328
    v_lshlrev_b32 v4, 4, v1
    s_mov_b32 s70, 1040356334
    v_mov_b32 v60, 0
    s_mul_i32 s71, s67, 7
    s_add_u32 s71, s71, s56
    s_mov_b32 s46, 1048576
    s_mov_b32 s47, 0x00020000
    s_mov_b32 s50, 1048576
    s_mov_b32 s51, 0x00020000
    s_add_u32 s44, s18, s61
    s_addc_u32 s45, s19, 0
    s_and_b32 s45, s45, 0xffff
    s_add_u32 s48, s20, s61
    s_addc_u32 s49, s21, 0
    s_and_b32 s49, s49, 0xffff
    s_barrier
    s_mov_b32 s74, 256
    s_add_u32 s72, s71, 21
    s_cmp_eq_u32 s56, 7
    s_cbranch_scc1 Lpoller_2
    s_add_u32 s88, s71, 0
    s_lshl_b32 s100, s88, 12
    buffer_load_dwordx4 v[64:67], v4, s[44:47], s100 offen offset:0 nt
    buffer_load_dwordx4 v[68:71], v4, s[44:47], s100 offen offset:1024 nt
    buffer_load_dwordx4 v[72:75], v4, s[44:47], s100 offen offset:2048 nt
    buffer_load_dwordx4 v[76:79], v4, s[44:47], s100 offen offset:3072 nt
    s_waitcnt vmcnt(4)
    v_perm_b32 v232, v196, v192, s68
    v_perm_b32 v233, v196, v192, s69
    v_perm_b32 v234, v197, v193, s68
    v_perm_b32 v235, v197, v193, s69
    v_perm_b32 v236, v198, v194, s68
    v_perm_b32 v237, v198, v194, s69
    v_perm_b32 v238, v199, v195, s68
    v_perm_b32 v239, v199, v195, s69
    v_dot2_f32_bf16 v212, v232, v208, 0
    v_dot2_f32_bf16 v213, v233, v208, 0
    v_dot2_f32_bf16 v214, v234, v208, 0
    v_dot2_f32_bf16 v215, v235, v208, 0
    v_dot2_f32_bf16 v216, v236, v208, 0
    v_dot2_f32_bf16 v217, v237, v208, 0
    v_dot2_f32_bf16 v218, v238, v208, 0
    v_dot2_f32_bf16 v219, v239, v208, 0
    v_dot2_f32_bf16 v220, v232, v210, 0
    v_dot2_f32_bf16 v221, v233, v210, 0
    v_dot2_f32_bf16 v222, v234, v210, 0
    v_dot2_f32_bf16 v223, v235, v210, 0
    v_dot2_f32_bf16 v224, v236, v210, 0
    v_dot2_f32_bf16 v225, v237, v210, 0
    v_dot2_f32_bf16 v226, v238, v210, 0
    v_dot2_f32_bf16 v227, v239, v210, 0
    v_perm_b32 v232, v204, v200, s68
    v_perm_b32 v233, v204, v200, s69
    v_perm_b32 v234, v205, v201, s68
    v_perm_b32 v235, v205, v201, s69
    v_perm_b32 v236, v206, v202, s68
    v_perm_b32 v237, v206, v202, s69
    v_perm_b32 v238, v207, v203, s68
    v_perm_b32 v239, v207, v203, s69
    v_dot2_f32_bf16 v212, v232, v209, v212
    v_dot2_f32_bf16 v213, v233, v209, v213
    v_dot2_f32_bf16 v214, v234, v209, v214
    v_dot2_f32_bf16 v215, v235, v209, v215
    v_dot2_f32_bf16 v216, v236, v209, v216
    v_dot2_f32_bf16 v217, v237, v209, v217
    v_dot2_f32_bf16 v218, v238, v209, v218
    v_dot2_f32_bf16 v219, v239, v209, v219
    v_dot2_f32_bf16 v220, v232, v211, v220
    v_dot2_f32_bf16 v221, v233, v211, v221
    v_dot2_f32_bf16 v222, v234, v211, v222
    v_dot2_f32_bf16 v223, v235, v211, v223
    v_dot2_f32_bf16 v224, v236, v211, v224
    v_dot2_f32_bf16 v225, v237, v211, v225
    v_dot2_f32_bf16 v226, v238, v211, v226
    v_dot2_f32_bf16 v227, v239, v211, v227
    s_nop 2
    v_permlane32_swap_b32 v212, v220
    v_permlane32_swap_b32 v213, v221
    v_permlane32_swap_b32 v214, v222
    v_permlane32_swap_b32 v215, v223
    v_permlane32_swap_b32 v216, v224
    v_permlane32_swap_b32 v217, v225
    v_permlane32_swap_b32 v218, v226
    v_permlane32_swap_b32 v219, v227
    s_nop 1
    v_add_f32 v212, v212, v220
    v_add_f32 v213, v213, v221
    v_add_f32 v214, v214, v222
    v_add_f32 v215, v215, v223
    v_add_f32 v216, v216, v224
    v_add_f32 v217, v217, v225
    v_add_f32 v218, v218, v226
    v_add_f32 v219, v219, v227
    s_nop 1
    v_permlane16_swap_b32 v212, v216
    v_permlane16_swap_b32 v213, v217
    v_permlane16_swap_b32 v214, v218
    v_permlane16_swap_b32 v215, v219
    s_nop 1
    v_add_f32 v212, v212, v216
    v_add_f32 v213, v213, v217
    v_add_f32 v214, v214, v218
    v_add_f32 v215, v215, v219
    s_nop 1
    v_add_f32_dpp v212, v212, v212 row_ror:8 row_mask:0xf bank_mask:0xf
    v_add_f32_dpp v213, v213, v213 row_ror:8 row_mask:0xf bank_mask:0xf
    v_add_f32_dpp v214, v214, v214 row_ror:8 row_mask:0xf bank_mask:0xf
    v_add_f32_dpp v215, v215, v215 row_ror:8 row_mask:0xf bank_mask:0xf
    v_lshrrev_b32 v232, 5, v228
    v_lshlrev_b32 v232, 8, v232
    v_bfe_u32 v233, v228, 4, 1
    v_lshl_add_u32 v232, v233, 4, v232
    v_lshl_add_u32 v232, v230, 5, v232
    s_lshl_b32 s61, s56, 9
    s_add_u32 s61, s61, 12288
    v_add_u32 v232, s61, v232
    ds_write_b128 v232, v[212:215]
    s_waitcnt lgkmcnt(0)
    s_barrier
    s_waitcnt vmcnt(3)
    buffer_load_dwordx4 v[80:83], v4, s[48:51], s100 offen offset:0 nt
    s_waitcnt vmcnt(3)
    buffer_load_dwordx4 v[84:87], v4, s[48:51], s100 offen offset:1024 nt
    s_waitcnt vmcnt(3)
    buffer_load_dwordx4 v[88:91], v4, s[48:51], s100 offen offset:2048 nt
    s_waitcnt vmcnt(3)
    buffer_load_dwordx4 v[92:95], v4, s[48:51], s100 offen offset:3072 nt
    s_add_u32 s88, s71, 21
    s_lshl_b32 s100, s88, 12
    s_waitcnt vmcnt(3)
    buffer_load_dwordx4 v[96:99], v4, s[44:47], s100 offen offset:0 nt
    s_waitcnt vmcnt(3)
    buffer_load_dwordx4 v[100:103], v4, s[44:47], s100 offen offset:1024 nt
    s_waitcnt vmcnt(3)
    buffer_load_dwordx4 v[104:107], v4, s[44:47], s100 offen offset:2048 nt
    s_waitcnt vmcnt(3)
    buffer_load_dwordx4 v[108:111], v4, s[44:47], s100 offen offset:3072 nt
    s_waitcnt vmcnt(3)
    buffer_load_dwordx4 v[112:115], v4, s[48:51], s100 offen offset:0 nt
    s_waitcnt vmcnt(3)
    buffer_load_dwordx4 v[116:119], v4, s[48:51], s100 offen offset:1024 nt
    s_waitcnt vmcnt(3)
    buffer_load_dwordx4 v[120:123], v4, s[48:51], s100 offen offset:2048 nt
    s_waitcnt vmcnt(3)
    buffer_load_dwordx4 v[124:127], v4, s[48:51], s100 offen offset:3072 nt
    s_add_u32 s88, s71, 42
    s_lshl_b32 s100, s88, 12
    s_waitcnt vmcnt(3)
    buffer_load_dwordx4 v[128:131], v4, s[44:47], s100 offen offset:0 nt
    s_waitcnt vmcnt(3)
    buffer_load_dwordx4 v[132:135], v4, s[44:47], s100 offen offset:1024 nt
    s_waitcnt vmcnt(3)
    buffer_load_dwordx4 v[136:139], v4, s[44:47], s100 offen offset:2048 nt
    s_waitcnt vmcnt(3)
    buffer_load_dwordx4 v[140:143], v4, s[44:47], s100 offen offset:3072 nt
    s_waitcnt vmcnt(3)
    buffer_load_dwordx4 v[144:147], v4, s[48:51], s100 offen offset:0 nt
    s_waitcnt vmcnt(3)
    buffer_load_dwordx4 v[148:151], v4, s[48:51], s100 offen offset:1024 nt
    s_waitcnt vmcnt(3)
    buffer_load_dwordx4 v[152:155], v4, s[48:51], s100 offen offset:2048 nt
    s_waitcnt vmcnt(3)
    buffer_load_dwordx4 v[156:159], v4, s[48:51], s100 offen offset:3072 nt
    s_add_u32 s88, s71, 63
    s_lshl_b32 s100, s88, 12
    s_waitcnt vmcnt(3)
    buffer_load_dwordx4 v[160:163], v4, s[44:47], s100 offen offset:0 nt
    s_waitcnt vmcnt(3)
    buffer_load_dwordx4 v[164:167], v4, s[44:47], s100 offen offset:1024 nt
    s_waitcnt vmcnt(3)
    buffer_load_dwordx4 v[168:171], v4, s[44:47], s100 offen offset:2048 nt
    s_waitcnt vmcnt(3)
    buffer_load_dwordx4 v[172:175], v4, s[44:47], s100 offen offset:3072 nt
    s_waitcnt vmcnt(3)
    buffer_load_dwordx4 v[176:179], v4, s[48:51], s100 offen offset:0 nt
    s_waitcnt vmcnt(3)
    buffer_load_dwordx4 v[180:183], v4, s[48:51], s100 offen offset:1024 nt
    s_waitcnt vmcnt(3)
    buffer_load_dwordx4 v[184:187], v4, s[48:51], s100 offen offset:2048 nt
    s_waitcnt vmcnt(3)
    buffer_load_dwordx4 v[188:191], v4, s[48:51], s100 offen offset:3072 nt
    s_branch Ljoin_3
Lpoller_2:
    s_setprio 3
    s_waitcnt vmcnt(0)
    v_perm_b32 v232, v196, v192, s68
    v_perm_b32 v233, v196, v192, s69
    v_perm_b32 v234, v197, v193, s68
    v_perm_b32 v235, v197, v193, s69
    v_perm_b32 v236, v198, v194, s68
    v_perm_b32 v237, v198, v194, s69
    v_perm_b32 v238, v199, v195, s68
    v_perm_b32 v239, v199, v195, s69
    v_dot2_f32_bf16 v212, v232, v208, 0
    v_dot2_f32_bf16 v213, v233, v208, 0
    v_dot2_f32_bf16 v214, v234, v208, 0
    v_dot2_f32_bf16 v215, v235, v208, 0
    v_dot2_f32_bf16 v216, v236, v208, 0
    v_dot2_f32_bf16 v217, v237, v208, 0
    v_dot2_f32_bf16 v218, v238, v208, 0
    v_dot2_f32_bf16 v219, v239, v208, 0
    v_dot2_f32_bf16 v220, v232, v210, 0
    v_dot2_f32_bf16 v221, v233, v210, 0
    v_dot2_f32_bf16 v222, v234, v210, 0
    v_dot2_f32_bf16 v223, v235, v210, 0
    v_dot2_f32_bf16 v224, v236, v210, 0
    v_dot2_f32_bf16 v225, v237, v210, 0
    v_dot2_f32_bf16 v226, v238, v210, 0
    v_dot2_f32_bf16 v227, v239, v210, 0
    v_perm_b32 v232, v204, v200, s68
    v_perm_b32 v233, v204, v200, s69
    v_perm_b32 v234, v205, v201, s68
    v_perm_b32 v235, v205, v201, s69
    v_perm_b32 v236, v206, v202, s68
    v_perm_b32 v237, v206, v202, s69
    v_perm_b32 v238, v207, v203, s68
    v_perm_b32 v239, v207, v203, s69
    v_dot2_f32_bf16 v212, v232, v209, v212
    v_dot2_f32_bf16 v213, v233, v209, v213
    v_dot2_f32_bf16 v214, v234, v209, v214
    v_dot2_f32_bf16 v215, v235, v209, v215
    v_dot2_f32_bf16 v216, v236, v209, v216
    v_dot2_f32_bf16 v217, v237, v209, v217
    v_dot2_f32_bf16 v218, v238, v209, v218
    v_dot2_f32_bf16 v219, v239, v209, v219
    v_dot2_f32_bf16 v220, v232, v211, v220
    v_dot2_f32_bf16 v221, v233, v211, v221
    v_dot2_f32_bf16 v222, v234, v211, v222
    v_dot2_f32_bf16 v223, v235, v211, v223
    v_dot2_f32_bf16 v224, v236, v211, v224
    v_dot2_f32_bf16 v225, v237, v211, v225
    v_dot2_f32_bf16 v226, v238, v211, v226
    v_dot2_f32_bf16 v227, v239, v211, v227
    s_nop 2
    v_permlane32_swap_b32 v212, v220
    v_permlane32_swap_b32 v213, v221
    v_permlane32_swap_b32 v214, v222
    v_permlane32_swap_b32 v215, v223
    v_permlane32_swap_b32 v216, v224
    v_permlane32_swap_b32 v217, v225
    v_permlane32_swap_b32 v218, v226
    v_permlane32_swap_b32 v219, v227
    s_nop 1
    v_add_f32 v212, v212, v220
    v_add_f32 v213, v213, v221
    v_add_f32 v214, v214, v222
    v_add_f32 v215, v215, v223
    v_add_f32 v216, v216, v224
    v_add_f32 v217, v217, v225
    v_add_f32 v218, v218, v226
    v_add_f32 v219, v219, v227
    s_nop 1
    v_permlane16_swap_b32 v212, v216
    v_permlane16_swap_b32 v213, v217
    v_permlane16_swap_b32 v214, v218
    v_permlane16_swap_b32 v215, v219
    s_nop 1
    v_add_f32 v212, v212, v216
    v_add_f32 v213, v213, v217
    v_add_f32 v214, v214, v218
    v_add_f32 v215, v215, v219
    s_nop 1
    v_add_f32_dpp v212, v212, v212 row_ror:8 row_mask:0xf bank_mask:0xf
    v_add_f32_dpp v213, v213, v213 row_ror:8 row_mask:0xf bank_mask:0xf
    v_add_f32_dpp v214, v214, v214 row_ror:8 row_mask:0xf bank_mask:0xf
    v_add_f32_dpp v215, v215, v215 row_ror:8 row_mask:0xf bank_mask:0xf
    v_lshrrev_b32 v232, 5, v228
    v_lshlrev_b32 v232, 8, v232
    v_bfe_u32 v233, v228, 4, 1
    v_lshl_add_u32 v232, v233, 4, v232
    v_lshl_add_u32 v232, v230, 5, v232
    s_lshl_b32 s61, s56, 9
    s_add_u32 s61, s61, 12288
    v_add_u32 v232, s61, v232
    ds_write_b128 v232, v[212:215]
    s_waitcnt lgkmcnt(0)
    s_barrier
    v_mov_b32 v234, 0
    buffer_load_dword v235, v234, s[52:55], s91 offen offset:0 sc0 sc1
    v_and_b32 v232, 31, v228
    v_lshlrev_b32 v233, 4, v232
    v_add_u32 v233, 12288, v233
    ds_read_b128 v[192:195], v233 offset:0
    ds_read_b128 v[196:199], v233 offset:512
    ds_read_b128 v[200:203], v233 offset:1024
    ds_read_b128 v[204:207], v233 offset:1536
    ds_read_b128 v[208:211], v233 offset:2048
    ds_read_b128 v[212:215], v233 offset:2560
    ds_read_b128 v[216:219], v233 offset:3072
    ds_read_b128 v[220:223], v233 offset:3584
    s_waitcnt lgkmcnt(6)
    v_add_f32 v192, v192, v196
    v_add_f32 v193, v193, v197
    v_add_f32 v194, v194, v198
    v_add_f32 v195, v195, v199
    s_waitcnt lgkmcnt(5)
    v_add_f32 v192, v192, v200
    v_add_f32 v193, v193, v201
    v_add_f32 v194, v194, v202
    v_add_f32 v195, v195, v203
    s_waitcnt lgkmcnt(4)
    v_add_f32 v192, v192, v204
    v_add_f32 v193, v193, v205
    v_add_f32 v194, v194, v206
    v_add_f32 v195, v195, v207
    s_waitcnt lgkmcnt(3)
    v_add_f32 v192, v192, v208
    v_add_f32 v193, v193, v209
    v_add_f32 v194, v194, v210
    v_add_f32 v195, v195, v211
    s_waitcnt lgkmcnt(2)
    v_add_f32 v192, v192, v212
    v_add_f32 v193, v193, v213
    v_add_f32 v194, v194, v214
    v_add_f32 v195, v195, v215
    s_waitcnt lgkmcnt(1)
    v_add_f32 v192, v192, v216
    v_add_f32 v193, v193, v217
    v_add_f32 v194, v194, v218
    v_add_f32 v195, v195, v219
    s_waitcnt lgkmcnt(0)
    v_add_f32 v192, v192, v220
    v_add_f32 v193, v193, v221
    v_add_f32 v194, v194, v222
    v_add_f32 v195, v195, v223
    v_lshrrev_b32 v233, 4, v232
    v_lshlrev_b32 v233, 10, v233
    v_and_b32 v232, 15, v232
    v_lshl_add_u32 v233, v232, 4, v233
    s_waitcnt vmcnt(0)
    s_mov_b32 s92, 0
Lcf_4:
    v_readfirstlane_b32 s57, v235
    s_nop 3
    s_cmp_lg_u32 s57, 0
    s_cbranch_scc1 Lcfd_5
    s_sleep 2
    buffer_load_dword v235, v234, s[52:55], s91 offen offset:0 sc0 sc1
    s_waitcnt vmcnt(0)
    s_add_u32 s92, s92, 1
    s_cmp_lt_u32 s92, 400000
    s_cbranch_scc1 Lcf_4
Lcfd_5:
    s_mov_b64 exec, 0xffffffff
    buffer_store_dwordx4 v[192:195], v233, s[32:35], s3 offen sc0 sc1
    s_mov_b64 exec, -1
    s_cmp_ge_u32 s64, 4
    s_cselect_b32 s100, s14, s24
    s_cselect_b32 s101, s15, s25
    s_lshl_b32 s61, s65, 17
    v_mov_b32 v46, s61
    s_mov_b64 exec, 1
    global_load_dword v250, v46, s[100:101] nt
    s_mov_b64 exec, -1
    s_mov_b32 s89, 1540096
    s_load_dword s90, s[30:31], s89
    s_and_b32 s91, s65, 0xfc
    v_mov_b32 v44, 0
    v_mov_b32 v45, 0
    s_mov_b32 s92, 0
Lcf_6:
    v_readfirstlane_b32 s57, v45
    s_nop 3
    s_cmp_lg_u32 s57, 0
    s_cbranch_scc1 Lcfd_7
    s_sleep 2
    buffer_load_dword v45, v44, s[52:55], s91 offen offset:0 sc0 sc1
    s_waitcnt vmcnt(0)
    s_add_u32 s92, s92, 1
    s_cmp_lt_u32 s92, 400000
    s_cbranch_scc1 Lcf_6
Lcfd_7:
    v_lshlrev_b32 v40, 4, v1
    s_lshl_b32 s61, s65, 11
    s_lshl_b32 s62, s66, 10
    s_add_u32 s61, s61, s62
    s_add_u32 s61, s61, 1376256
    s_mov_b32 s92, 0
Lpoll_8:
    buffer_load_dwordx4 v[48:51], v40, s[32:35], s61 offen sc0 sc1
    s_waitcnt vmcnt(0)
    v_mov_b32 v41, v48
    v_max3_u32 v41, v41, v49, v50
    v_max_u32 v41, v41, v51
    v_cmpx_eq_u32 vcc, -1, v41
    s_cbranch_execz Lpolld_9
    s_sleep 4
    s_add_u32 s92, s92, 1
    s_cmp_lt_u32 s92, 400000
    s_cbranch_scc1 Lpoll_8
Lpolld_9:
    s_mov_b64 exec, -1
    v_mov_b32 v52, v48
    v_mov_b32 v53, v49
    v_mov_b32 v54, v50
    v_mov_b32 v55, v51
    s_nop 1
    v_permlane32_swap_b32 v48, v52
    v_permlane32_swap_b32 v49, v53
    v_permlane32_swap_b32 v50, v54
    v_permlane32_swap_b32 v51, v55
    s_nop 1
    v_add_f32 v48, v48, v52
    v_add_f32 v49, v49, v53
    v_add_f32 v50, v50, v54
    v_add_f32 v51, v51, v55
    v_cvt_pk_bf16_f32 v48, v48, v49
    v_cvt_pk_bf16_f32 v49, v50, v51
    v_mov_b32 v44, 0
    s_mov_b32 s92, 0
Lcf_10:
    buffer_load_dword v45, v44, s[52:55], 0 offen offset:128 sc0 sc1
    s_waitcnt vmcnt(0)
    v_readfirstlane_b32 s57, v45
    s_nop 3
    s_cmp_ge_u32 s57, 64
    s_cbranch_scc1 Lcfd_11
    s_sleep 16
    s_add_u32 s92, s92, 1
    s_cmp_lt_u32 s92, 400000
    s_cbranch_scc1 Lcf_10
Lcfd_11:
    v_and_b32 v42, 31, v1
    v_lshlrev_b32 v42, 3, v42
    ds_write_b64 v42, v[48:49] offset:0
    s_waitcnt lgkmcnt(0)
    v_mov_b32 v40, 0xff7fffff
    v_mov_b32 v41, 0
    v_mov_b32 v42, 56
    ds_write_b64 v42, v[40:41] offset:8192
    v_mov_b32 v40, 0
    v_lshlrev_b32 v42, 3, v1
    ds_write_b64 v42, v[40:41] offset:7680
    v_mov_b32 v42, 256
    ds_write_b32 v42, v40
    v_mov_b32 v41, 0
    v_mov_b32 v43, 260
    ds_write_b32 v43, v41
    ds_write_b32 v43, v41 offset:4
    v_mov_b32 v43, 98816
    ds_write_b32 v43, v41
    s_mul_i32 s61, s67, 12
    s_add_u32 s61, s61, 84
    v_add_u32 v40, s61, v1
    v_cmp_gt_u32 vcc, 12, v1
    v_mov_b32 v41, -1
    v_lshlrev_b32 v43, 2, v1
    v_cndmask_b32 v40, v41, v40, vcc
    ds_write_b32 v43, v40 offset:1024
    ds_write_b32 v43, v41 offset:1280
    ds_write_b32 v43, v41 offset:1536
    ds_write_b32 v43, v41 offset:1792
    ds_write_b32 v43, v41 offset:2048
    v_mov_b32 v40, 7
    ds_write_b32 v42, v40
    s_waitcnt lgkmcnt(0)
    s_barrier
    s_mov_b32 s84, 12
    s_mov_b32 s86, 9
    s_mov_b32 s87, 6
    s_mov_b32 s90, 7
    v_mov_b32 v42, 256
    s_mov_b32 s92, 0
Lprod_12:
    s_add_u32 s92, s92, 1
    s_cmp_gt_u32 s92, 400000
    s_cbranch_scc1 Lprods_14
    ds_read_b32 v40, v42
    s_waitcnt lgkmcnt(0)
    v_readfirstlane_b32 s85, v40
    s_nop 3
    s_add_u32 s85, s85, s86
    s_sub_i32 s85, s85, s84
    s_cmp_gt_i32 s85, s87
    s_cbranch_scc1 Lprodg_15
    s_sleep 1
    s_branch Lprod_12
Lprodg_15:
    s_min_u32 s85, s85, s90
    s_add_u32 s88, s30, s63
    s_addc_u32 s89, s31, 0
    s_mov_b32 s62, s85
    s_atomic_add s62, s[88:89], 0x0 glc
    s_bfm_b64 exec, s85, 0
    s_waitcnt lgkmcnt(0)
    v_add_u32 v44, s62, v1
    s_cmp_ge_u32 s62, 65616
    s_cselect_b32 s86, 3, s86
    s_cselect_b32 s87, 1, s87
    s_cselect_b32 s90, 2, s90
    v_add_u32 v44, 4294901880, v44
    v_cmp_gt_u32 vcc, 256, v44
    s_mov_b64 s[94:95], exec
    s_nop 1
    v_mbcnt_lo_u32_b32 v45, vcc_lo, 0
    s_bcnt1_i32_b64 s85, vcc
    v_add_u32 v45, s84, v45
    v_lshlrev_b32 v45, 2, v45
    s_mov_b64 exec, vcc
    s_cbranch_execz Lprodn_16
    ds_write_b32 v45, v44 offset:1024
Lprodn_16:
    s_add_u32 s84, s84, s85
    s_cmp_eq_u64 vcc, s[94:95]
    s_mov_b64 exec, -1
    s_cbranch_scc1 Lprod_12
Lprods_14:
    s_mov_b64 exec, -1
    v_add_u32 v45, s84, v1
    v_lshlrev_b32 v45, 2, v45
    v_mov_b32 v44, 0x1000
    s_mov_b64 exec, 0xff
    ds_write_b32 v45, v44 offset:1024
    s_mov_b64 exec, -1
    s_waitcnt lgkmcnt(0)
    v_mov_b32 v43, 260
    s_mov_b32 s92, 0
Ldk_19:
    ds_read_b32 v40, v43
    s_waitcnt lgkmcnt(0)
    v_readfirstlane_b32 s62, v40
    s_nop 3
    s_cmp_ge_u32 s62, 3
    s_cbranch_scc1 Ldkd_20
    s_sleep 1
    s_add_u32 s92, s92, 1
    s_cmp_lt_u32 s92, 400000
    s_cbranch_scc1 Ldk_19
Ldkd_20:
    s_and_b32 s79, s64, 3
    s_lshl_b32 s79, s79, 3
    s_cmp_ge_u32 s64, 4
    s_cselect_b32 s80, 5376, 0
    s_cselect_b32 s62, 0, 1
    s_mul_i32 s62, s62, 3328
    s_add_u32 s80, s80, s62
    s_cmp_ge_u32 s64, 4
    s_cselect_b32 s100, s14, s24
    s_cselect_b32 s101, s15, s25
    s_lshl_b32 s62, s79, 5
    s_mov_b32 s36, s100
    s_mov_b32 s37, s101
    s_and_b32 s37, s37, 0xffff
    s_mov_b32 s38, 4194304
    s_mov_b32 s39, 0x00020000
    v_or_b32 v40, 0, v2
    v_lshlrev_b32 v40, 1, v40
    v_xor_b32 v40, v40, v3
    v_lshlrev_b32 v40, 4, v40
    v_lshl_add_u32 v44, v2, 10, v40
    v_or_b32 v40, 4, v2
    v_lshlrev_b32 v40, 1, v40
    v_xor_b32 v40, v40, v3
    v_lshlrev_b32 v40, 4, v40
    v_lshl_add_u32 v45, v2, 10, v40
    s_lshl_b32 s61, s65, 17
    s_add_u32 s61, s61, s62
    s_mov_b32 m0, 65536
    s_nop 0
    buffer_load_dwordx4 v44, s[36:39], s61 offen nt lds
    s_mov_b32 m0, 66560
    s_add_u32 s61, s61, 4096
    buffer_load_dwordx4 v44, s[36:39], s61 offen nt lds
    s_mov_b32 m0, 67584
    s_add_u32 s61, s61, 4096
    buffer_load_dwordx4 v45, s[36:39], s61 offen nt lds
    s_mov_b32 m0, 68608
    s_add_u32 s61, s61, 4096
    buffer_load_dwordx4 v45, s[36:39], s61 offen nt lds
    s_mov_b32 m0, 69632
    s_add_u32 s61, s61, 4096
    buffer_load_dwordx4 v44, s[36:39], s61 offen nt lds
    s_mov_b32 m0, 70656
    s_add_u32 s61, s61, 4096
    buffer_load_dwordx4 v44, s[36:39], s61 offen nt lds
    s_mov_b32 m0, 71680
    s_add_u32 s61, s61, 4096
    buffer_load_dwordx4 v45, s[36:39], s61 offen nt lds
    s_mov_b32 m0, 72704
    s_add_u32 s61, s61, 4096
    buffer_load_dwordx4 v45, s[36:39], s61 offen nt lds
    s_mov_b32 m0, 73728
    s_add_u32 s61, s61, 4096
    buffer_load_dwordx4 v44, s[36:39], s61 offen nt lds
    s_mov_b32 m0, 74752
    s_add_u32 s61, s61, 4096
    buffer_load_dwordx4 v44, s[36:39], s61 offen nt lds
    s_mov_b32 m0, 75776
    s_add_u32 s61, s61, 4096
    buffer_load_dwordx4 v45, s[36:39], s61 offen nt lds
    s_mov_b32 m0, 76800
    s_add_u32 s61, s61, 4096
    buffer_load_dwordx4 v45, s[36:39], s61 offen nt lds
    s_mov_b32 m0, 77824
    s_add_u32 s61, s61, 4096
    buffer_load_dwordx4 v44, s[36:39], s61 offen nt lds
    s_mov_b32 m0, 78848
    s_add_u32 s61, s61, 4096
    buffer_load_dwordx4 v44, s[36:39], s61 offen nt lds
    s_mov_b32 m0, 79872
    s_add_u32 s61, s61, 4096
    buffer_load_dwordx4 v45, s[36:39], s61 offen nt lds
    s_mov_b32 m0, 80896
    s_add_u32 s61, s61, 4096
    buffer_load_dwordx4 v45, s[36:39], s61 offen nt lds
    s_mov_b32 m0, 81920
    s_add_u32 s61, s61, 4096
    buffer_load_dwordx4 v44, s[36:39], s61 offen nt lds
    s_mov_b32 m0, 82944
    s_add_u32 s61, s61, 4096
    buffer_load_dwordx4 v44, s[36:39], s61 offen nt lds
    s_mov_b32 m0, 83968
    s_add_u32 s61, s61, 4096
    buffer_load_dwordx4 v45, s[36:39], s61 offen nt lds
    s_mov_b32 m0, 84992
    s_add_u32 s61, s61, 4096
    buffer_load_dwordx4 v45, s[36:39], s61 offen nt lds
    s_mov_b32 m0, 86016
    s_add_u32 s61, s61, 4096
    buffer_load_dwordx4 v44, s[36:39], s61 offen nt lds
    s_mov_b32 m0, 87040
    s_add_u32 s61, s61, 4096
    buffer_load_dwordx4 v44, s[36:39], s61 offen nt lds
    s_mov_b32 m0, 88064
    s_add_u32 s61, s61, 4096
    buffer_load_dwordx4 v45, s[36:39], s61 offen nt lds
    s_mov_b32 m0, 89088
    s_add_u32 s61, s61, 4096
    buffer_load_dwordx4 v45, s[36:39], s61 offen nt lds
    s_mov_b32 m0, 90112
    s_add_u32 s61, s61, 4096
    buffer_load_dwordx4 v44, s[36:39], s61 offen nt lds
    s_mov_b32 m0, 91136
    s_add_u32 s61, s61, 4096
    buffer_load_dwordx4 v44, s[36:39], s61 offen nt lds
    s_mov_b32 m0, 92160
    s_add_u32 s61, s61, 4096
    buffer_load_dwordx4 v45, s[36:39], s61 offen nt lds
    s_mov_b32 m0, 93184
    s_add_u32 s61, s61, 4096
    buffer_load_dwordx4 v45, s[36:39], s61 offen nt lds
    s_mov_b32 m0, 94208
    s_add_u32 s61, s61, 4096
    buffer_load_dwordx4 v44, s[36:39], s61 offen nt lds
    s_mov_b32 m0, 95232
    s_add_u32 s61, s61, 4096
    buffer_load_dwordx4 v44, s[36:39], s61 offen nt lds
    s_mov_b32 m0, 96256
    s_add_u32 s61, s61, 4096
    buffer_load_dwordx4 v45, s[36:39], s61 offen nt lds
    s_mov_b32 m0, 97280
    s_add_u32 s61, s61, 4096
    buffer_load_dwordx4 v45, s[36:39], s61 offen nt lds
    s_barrier
    s_cmp_ge_u32 s64, 4
    s_cbranch_scc1 Ljoba_21
    s_waitcnt vmcnt(0)
    v_mov_b32 v40, 1
    v_mov_b32 v43, 98816
    ds_write_b32 v43, v40
    s_waitcnt lgkmcnt(0)
    s_branch L_dist
Ljoba_21:
    s_add_u32 s61, s65, 32
    s_mul_i32 s61, s61, 16384
    s_add_u32 s61, s61, 7424
    v_lshlrev_b32 v46, 3, v1
    s_mov_b32 s92, 0
Lpoll_22:
    buffer_load_dwordx2 v[48:49], v46, s[32:35], s61 offen sc0 sc1
    s_waitcnt vmcnt(0)
    v_mov_b32 v45, v48
    v_max_u32 v45, v45, v49
    v_cmpx_eq_u32 vcc, -1, v45
    s_cbranch_execz Lpolld_23
    s_sleep 2
    s_add_u32 s92, s92, 1
    s_cmp_lt_u32 s92, 400000
    s_cbranch_scc1 Lpoll_22
Lpolld_23:
    s_mov_b64 exec, -1
    v_add_u32 v46, 98304, v46
    ds_write_b64 v46, v[48:49]
    s_waitcnt lgkmcnt(0)
    v_mov_b32 v40, 1
    v_mov_b32 v43, 98816
    ds_write_b32 v43, v40
    s_waitcnt lgkmcnt(0)
    s_branch L_dist
    s_barrier
    s_branch L_end
Ljoin_3:
    s_barrier
    v_lshlrev_b32 v40, 4, v3
    ds_read_b128 v[24:27], v40 offset:0
    s_mul_i32 s62, s67, 7
    s_add_u32 s62, s62, s56
    s_add_u32 s73, s62, 84
    s_mul_i32 s61, s67, 12
    s_add_u32 s61, s61, 84
    s_add_u32 s73, s61, s56
    s_mov_b32 s83, 114
    v_mov_b32 v61, 256
    v_mov_b32 v5, 1
    v_mov_b32 v36, 0xff7fffff
    v_mov_b32 v37, 0
    v_mov_b32 v16, 0
    v_mov_b32 v17, 0
    v_mov_b32 v18, 0
    v_mov_b32 v19, 0
    v_mov_b32 v20, 0
    v_mov_b32 v21, 0
    v_mov_b32 v22, 0
    v_mov_b32 v23, 0
    v_lshlrev_b32 v6, 5, v3
    v_lshl_add_u32 v6, v2, 3, v6
    s_lshl_b32 s61, s56, 9
    v_add_u32 v7, s61, v6
    s_waitcnt lgkmcnt(0)
    s_lshl_b32 s100, s73, 12
    s_mov_b32 s71, s73
    v_dot2_f32_bf16 v28, v64, v24, 0
    v_dot2_f32_bf16 v28, v65, v25, v28
    v_dot2_f32_bf16 v28, v66, v26, v28
    v_dot2_f32_bf16 v28, v67, v27, v28
    s_waitcnt vmcnt(3)
    buffer_load_dwordx4 v[64:67], v4, s[44:47], s100 offen offset:0 nt
    v_dot2_f32_bf16 v29, v68, v24, 0
    v_dot2_f32_bf16 v29, v69, v25, v29
    v_dot2_f32_bf16 v29, v70, v26, v29
    v_dot2_f32_bf16 v29, v71, v27, v29
    s_waitcnt vmcnt(3)
    buffer_load_dwordx4 v[68:71], v4, s[44:47], s100 offen offset:1024 nt
    v_dot2_f32_bf16 v30, v72, v24, 0
    v_dot2_f32_bf16 v30, v73, v25, v30
    v_dot2_f32_bf16 v30, v74, v26, v30
    v_dot2_f32_bf16 v30, v75, v27, v30
    s_waitcnt vmcnt(3)
    buffer_load_dwordx4 v[72:75], v4, s[44:47], s100 offen offset:2048 nt
    v_dot2_f32_bf16 v31, v76, v24, 0
    v_dot2_f32_bf16 v31, v77, v25, v31
    v_dot2_f32_bf16 v31, v78, v26, v31
    v_dot2_f32_bf16 v31, v79, v27, v31
    s_waitcnt vmcnt(3)
    buffer_load_dwordx4 v[76:79], v4, s[44:47], s100 offen offset:3072 nt
    s_nop 2
    v_add_f32_dpp v28, v28, v28 row_ror:8 row_mask:0xf bank_mask:0xf
    v_add_f32_dpp v29, v29, v29 row_ror:8 row_mask:0xf bank_mask:0xf
    v_add_f32_dpp v30, v30, v30 row_ror:8 row_mask:0xf bank_mask:0xf
    v_add_f32_dpp v31, v31, v31 row_ror:8 row_mask:0xf bank_mask:0xf
    v_add_f32_dpp v28, v28, v28 row_ror:4 row_mask:0xf bank_mask:0xf
    v_add_f32_dpp v29, v29, v29 row_ror:4 row_mask:0xf bank_mask:0xf
    v_add_f32_dpp v30, v30, v30 row_ror:4 row_mask:0xf bank_mask:0xf
    v_add_f32_dpp v31, v31, v31 row_ror:4 row_mask:0xf bank_mask:0xf
    v_add_f32_dpp v28, v28, v28 row_ror:2 row_mask:0xf bank_mask:0xf
    v_add_f32_dpp v29, v29, v29 row_ror:2 row_mask:0xf bank_mask:0xf
    v_add_f32_dpp v30, v30, v30 row_ror:2 row_mask:0xf bank_mask:0xf
    v_add_f32_dpp v31, v31, v31 row_ror:2 row_mask:0xf bank_mask:0xf
    v_add_f32_dpp v28, v28, v28 row_ror:1 row_mask:0xf bank_mask:0xf
    v_add_f32_dpp v29, v29, v29 row_ror:1 row_mask:0xf bank_mask:0xf
    v_add_f32_dpp v30, v30, v30 row_ror:1 row_mask:0xf bank_mask:0xf
    v_add_f32_dpp v31, v31, v31 row_ror:1 row_mask:0xf bank_mask:0xf
    v_max3_f32 v38, v36, v28, v29
    v_max3_f32 v38, v38, v30, v31
    v_sub_f32 v39, v36, v38
    v_mul_f32 v39, s70, v39
    v_exp_f32 v39, v39
    v_mul_f32 v56, s70, v38
    v_mov_b32 v36, v38
    v_fma_f32 v48, v28, s70, -v56
    v_fma_f32 v49, v29, s70, -v56
    v_fma_f32 v50, v30, s70, -v56
    v_fma_f32 v51, v31, s70, -v56
    v_exp_f32 v48, v48
    v_exp_f32 v49, v49
    v_exp_f32 v50, v50
    v_exp_f32 v51, v51
    v_mul_f32 v37, v37, v39
    v_mul_f32 v16, v16, v39
    v_mul_f32 v17, v17, v39
    v_mul_f32 v18, v18, v39
    v_mul_f32 v19, v19, v39
    v_mul_f32 v20, v20, v39
    v_mul_f32 v21, v21, v39
    v_mul_f32 v22, v22, v39
    v_mul_f32 v23, v23, v39
    v_add_f32 v37, v37, v48
    v_add_f32 v37, v37, v49
    v_add_f32 v37, v37, v50
    v_add_f32 v37, v37, v51
    v_lshlrev_b32 v40, 16, v80
    v_and_b32 v41, 0xffff0000, v80
    v_lshlrev_b32 v42, 16, v81
    v_and_b32 v43, 0xffff0000, v81
    v_lshlrev_b32 v44, 16, v82
    v_and_b32 v45, 0xffff0000, v82
    v_lshlrev_b32 v46, 16, v83
    v_and_b32 v47, 0xffff0000, v83
    s_waitcnt vmcnt(3)
    buffer_load_dwordx4 v[80:83], v4, s[48:51], s100 offen offset:0 nt
    v_fmac_f32 v16, v40, v48
    v_fmac_f32 v17, v41, v48
    v_fmac_f32 v18, v42, v48
    v_fmac_f32 v19, v43, v48
    v_fmac_f32 v20, v44, v48
    v_fmac_f32 v21, v45, v48
    v_fmac_f32 v22, v46, v48
    v_fmac_f32 v23, v47, v48
    v_lshlrev_b32 v40, 16, v84
    v_and_b32 v41, 0xffff0000, v84
    v_lshlrev_b32 v42, 16, v85
    v_and_b32 v43, 0xffff0000, v85
    v_lshlrev_b32 v44, 16, v86
    v_and_b32 v45, 0xffff0000, v86
    v_lshlrev_b32 v46, 16, v87
    v_and_b32 v47, 0xffff0000, v87
    s_waitcnt vmcnt(3)
    buffer_load_dwordx4 v[84:87], v4, s[48:51], s100 offen offset:1024 nt
    v_fmac_f32 v16, v40, v49
    v_fmac_f32 v17, v41, v49
    v_fmac_f32 v18, v42, v49
    v_fmac_f32 v19, v43, v49
    v_fmac_f32 v20, v44, v49
    v_fmac_f32 v21, v45, v49
    v_fmac_f32 v22, v46, v49
    v_fmac_f32 v23, v47, v49
    v_lshlrev_b32 v40, 16, v88
    v_and_b32 v41, 0xffff0000, v88
    v_lshlrev_b32 v42, 16, v89
    v_and_b32 v43, 0xffff0000, v89
    v_lshlrev_b32 v44, 16, v90
    v_and_b32 v45, 0xffff0000, v90
    v_lshlrev_b32 v46, 16, v91
    v_and_b32 v47, 0xffff0000, v91
    s_waitcnt vmcnt(3)
    buffer_load_dwordx4 v[88:91], v4, s[48:51], s100 offen offset:2048 nt
    v_fmac_f32 v16, v40, v50
    v_fmac_f32 v17, v41, v50
    v_fmac_f32 v18, v42, v50
    v_fmac_f32 v19, v43, v50
    v_fmac_f32 v20, v44, v50
    v_fmac_f32 v21, v45, v50
    v_fmac_f32 v22, v46, v50
    v_fmac_f32 v23, v47, v50
    v_lshlrev_b32 v40, 16, v92
    v_and_b32 v41, 0xffff0000, v92
    v_lshlrev_b32 v42, 16, v93
    v_and_b32 v43, 0xffff0000, v93
    v_lshlrev_b32 v44, 16, v94
    v_and_b32 v45, 0xffff0000, v94
    v_lshlrev_b32 v46, 16, v95
    v_and_b32 v47, 0xffff0000, v95
    s_waitcnt vmcnt(3)
    buffer_load_dwordx4 v[92:95], v4, s[48:51], s100 offen offset:3072 nt
    v_fmac_f32 v16, v40, v51
    v_fmac_f32 v17, v41, v51
    v_fmac_f32 v18, v42, v51
    v_fmac_f32 v19, v43, v51
    v_fmac_f32 v20, v44, v51
    v_fmac_f32 v21, v45, v51
    v_fmac_f32 v22, v46, v51
    v_fmac_f32 v23, v47, v51
    s_waitcnt vmcnt(8)
    s_mov_b64 s[94:95], exec
    s_mov_b64 exec, 1
    ds_add_rtn_u32 v59, v61, v5
    s_mov_b64 exec, s[94:95]
    s_waitcnt lgkmcnt(0)
    s_mov_b64 exec, 1
    v_lshlrev_b32 v59, 2, v59
    s_mov_b32 s92, 0
Lpop_28:
    ds_read_b32 v62, v59 offset:1024
    s_waitcnt lgkmcnt(0)
    v_readfirstlane_b32 s73, v62
    s_nop 3
    s_cmp_lg_u32 s73, -1
    s_cbranch_scc1 Lpopd_29
    s_sleep 1
    s_add_u32 s92, s92, 1
    s_cmp_lt_u32 s92, 400000
    s_cbranch_scc1 Lpop_28
Lpopd_29:
    s_mov_b64 exec, -1
Lquit_30:
    v_dot2_f32_bf16 v28, v128, v24, 0
    v_dot2_f32_bf16 v28, v129, v25, v28
    v_dot2_f32_bf16 v28, v130, v26, v28
    v_dot2_f32_bf16 v28, v131, v27, v28
    v_dot2_f32_bf16 v29, v132, v24, 0
    v_dot2_f32_bf16 v29, v133, v25, v29
    v_dot2_f32_bf16 v29, v134, v26, v29
    v_dot2_f32_bf16 v29, v135, v27, v29
    v_dot2_f32_bf16 v30, v136, v24, 0
    v_dot2_f32_bf16 v30, v137, v25, v30
    v_dot2_f32_bf16 v30, v138, v26, v30
    v_dot2_f32_bf16 v30, v139, v27, v30
    v_dot2_f32_bf16 v31, v140, v24, 0
    v_dot2_f32_bf16 v31, v141, v25, v31
    v_dot2_f32_bf16 v31, v142, v26, v31
    v_dot2_f32_bf16 v31, v143, v27, v31
    s_nop 2
    v_add_f32_dpp v28, v28, v28 row_ror:8 row_mask:0xf bank_mask:0xf
    v_add_f32_dpp v29, v29, v29 row_ror:8 row_mask:0xf bank_mask:0xf
    v_add_f32_dpp v30, v30, v30 row_ror:8 row_mask:0xf bank_mask:0xf
    v_add_f32_dpp v31, v31, v31 row_ror:8 row_mask:0xf bank_mask:0xf
    v_add_f32_dpp v28, v28, v28 row_ror:4 row_mask:0xf bank_mask:0xf
    v_add_f32_dpp v29, v29, v29 row_ror:4 row_mask:0xf bank_mask:0xf
    v_add_f32_dpp v30, v30, v30 row_ror:4 row_mask:0xf bank_mask:0xf
    v_add_f32_dpp v31, v31, v31 row_ror:4 row_mask:0xf bank_mask:0xf
    v_add_f32_dpp v28, v28, v28 row_ror:2 row_mask:0xf bank_mask:0xf
    v_add_f32_dpp v29, v29, v29 row_ror:2 row_mask:0xf bank_mask:0xf
    v_add_f32_dpp v30, v30, v30 row_ror:2 row_mask:0xf bank_mask:0xf
    v_add_f32_dpp v31, v31, v31 row_ror:2 row_mask:0xf bank_mask:0xf
    v_add_f32_dpp v28, v28, v28 row_ror:1 row_mask:0xf bank_mask:0xf
    v_add_f32_dpp v29, v29, v29 row_ror:1 row_mask:0xf bank_mask:0xf
    v_add_f32_dpp v30, v30, v30 row_ror:1 row_mask:0xf bank_mask:0xf
    v_add_f32_dpp v31, v31, v31 row_ror:1 row_mask:0xf bank_mask:0xf
    v_max3_f32 v38, v36, v28, v29
    v_max3_f32 v38, v38, v30, v31
    v_sub_f32 v39, v36, v38
    v_mul_f32 v39, s70, v39
    v_exp_f32 v39, v39
    v_mul_f32 v56, s70, v38
    v_mov_b32 v36, v38
    v_fma_f32 v48, v28, s70, -v56
    v_fma_f32 v49, v29, s70, -v56
    v_fma_f32 v50, v30, s70, -v56
    v_fma_f32 v51, v31, s70, -v56
    v_exp_f32 v48, v48
    v_exp_f32 v49, v49
    v_exp_f32 v50, v50
    v_exp_f32 v51, v51
    v_mul_f32 v37, v37, v39
    v_mul_f32 v16, v16, v39
    v_mul_f32 v17, v17, v39
    v_mul_f32 v18, v18, v39
    v_mul_f32 v19, v19, v39
    v_mul_f32 v20, v20, v39
    v_mul_f32 v21, v21, v39
    v_mul_f32 v22, v22, v39
    v_mul_f32 v23, v23, v39
    v_add_f32 v37, v37, v48
    v_add_f32 v37, v37, v49
    v_add_f32 v37, v37, v50
    v_add_f32 v37, v37, v51
    v_lshlrev_b32 v40, 16, v144
    v_and_b32 v41, 0xffff0000, v144
    v_lshlrev_b32 v42, 16, v145
    v_and_b32 v43, 0xffff0000, v145
    v_lshlrev_b32 v44, 16, v146
    v_and_b32 v45, 0xffff0000, v146
    v_lshlrev_b32 v46, 16, v147
    v_and_b32 v47, 0xffff0000, v147
    v_fmac_f32 v16, v40, v48
    v_fmac_f32 v17, v41, v48
    v_fmac_f32 v18, v42, v48
    v_fmac_f32 v19, v43, v48
    v_fmac_f32 v20, v44, v48
    v_fmac_f32 v21, v45, v48
    v_fmac_f32 v22, v46, v48
    v_fmac_f32 v23, v47, v48
    v_lshlrev_b32 v40, 16, v148
    v_and_b32 v41, 0xffff0000, v148
    v_lshlrev_b32 v42, 16, v149
    v_and_b32 v43, 0xffff0000, v149
    v_lshlrev_b32 v44, 16, v150
    v_and_b32 v45, 0xffff0000, v150
    v_lshlrev_b32 v46, 16, v151
    v_and_b32 v47, 0xffff0000, v151
    v_fmac_f32 v16, v40, v49
    v_fmac_f32 v17, v41, v49
    v_fmac_f32 v18, v42, v49
    v_fmac_f32 v19, v43, v49
    v_fmac_f32 v20, v44, v49
    v_fmac_f32 v21, v45, v49
    v_fmac_f32 v22, v46, v49
    v_fmac_f32 v23, v47, v49
    v_lshlrev_b32 v40, 16, v152
    v_and_b32 v41, 0xffff0000, v152
    v_lshlrev_b32 v42, 16, v153
    v_and_b32 v43, 0xffff0000, v153
    v_lshlrev_b32 v44, 16, v154
    v_and_b32 v45, 0xffff0000, v154
    v_lshlrev_b32 v46, 16, v155
    v_and_b32 v47, 0xffff0000, v155
    v_fmac_f32 v16, v40, v50
    v_fmac_f32 v17, v41, v50
    v_fmac_f32 v18, v42, v50
    v_fmac_f32 v19, v43, v50
    v_fmac_f32 v20, v44, v50
    v_fmac_f32 v21, v45, v50
    v_fmac_f32 v22, v46, v50
    v_fmac_f32 v23, v47, v50
    v_lshlrev_b32 v40, 16, v156
    v_and_b32 v41, 0xffff0000, v156
    v_lshlrev_b32 v42, 16, v157
    v_and_b32 v43, 0xffff0000, v157
    v_lshlrev_b32 v44, 16, v158
    v_and_b32 v45, 0xffff0000, v158
    v_lshlrev_b32 v46, 16, v159
    v_and_b32 v47, 0xffff0000, v159
    v_fmac_f32 v16, v40, v51
    v_fmac_f32 v17, v41, v51
    v_fmac_f32 v18, v42, v51
    v_fmac_f32 v19, v43, v51
    v_fmac_f32 v20, v44, v51
    v_fmac_f32 v21, v45, v51
    v_fmac_f32 v22, v46, v51
    v_fmac_f32 v23, v47, v51
    s_lshl_b32 s100, s73, 12
    s_mov_b32 s72, s73
    v_dot2_f32_bf16 v28, v96, v24, 0
    v_dot2_f32_bf16 v28, v97, v25, v28
    v_dot2_f32_bf16 v28, v98, v26, v28
    v_dot2_f32_bf16 v28, v99, v27, v28
    s_waitcnt vmcnt(3)
    buffer_load_dwordx4 v[96:99], v4, s[44:47], s100 offen offset:0 nt
    v_dot2_f32_bf16 v29, v100, v24, 0
    v_dot2_f32_bf16 v29, v101, v25, v29
    v_dot2_f32_bf16 v29, v102, v26, v29
    v_dot2_f32_bf16 v29, v103, v27, v29
    s_waitcnt vmcnt(3)
    buffer_load_dwordx4 v[100:103], v4, s[44:47], s100 offen offset:1024 nt
    v_dot2_f32_bf16 v30, v104, v24, 0
    v_dot2_f32_bf16 v30, v105, v25, v30
    v_dot2_f32_bf16 v30, v106, v26, v30
    v_dot2_f32_bf16 v30, v107, v27, v30
    s_waitcnt vmcnt(3)
    buffer_load_dwordx4 v[104:107], v4, s[44:47], s100 offen offset:2048 nt
    v_dot2_f32_bf16 v31, v108, v24, 0
    v_dot2_f32_bf16 v31, v109, v25, v31
    v_dot2_f32_bf16 v31, v110, v26, v31
    v_dot2_f32_bf16 v31, v111, v27, v31
    s_waitcnt vmcnt(3)
    buffer_load_dwordx4 v[108:111], v4, s[44:47], s100 offen offset:3072 nt
    s_nop 2
    v_add_f32_dpp v28, v28, v28 row_ror:8 row_mask:0xf bank_mask:0xf
    v_add_f32_dpp v29, v29, v29 row_ror:8 row_mask:0xf bank_mask:0xf
    v_add_f32_dpp v30, v30, v30 row_ror:8 row_mask:0xf bank_mask:0xf
    v_add_f32_dpp v31, v31, v31 row_ror:8 row_mask:0xf bank_mask:0xf
    v_add_f32_dpp v28, v28, v28 row_ror:4 row_mask:0xf bank_mask:0xf
    v_add_f32_dpp v29, v29, v29 row_ror:4 row_mask:0xf bank_mask:0xf
    v_add_f32_dpp v30, v30, v30 row_ror:4 row_mask:0xf bank_mask:0xf
    v_add_f32_dpp v31, v31, v31 row_ror:4 row_mask:0xf bank_mask:0xf
    v_add_f32_dpp v28, v28, v28 row_ror:2 row_mask:0xf bank_mask:0xf
    v_add_f32_dpp v29, v29, v29 row_ror:2 row_mask:0xf bank_mask:0xf
    v_add_f32_dpp v30, v30, v30 row_ror:2 row_mask:0xf bank_mask:0xf
    v_add_f32_dpp v31, v31, v31 row_ror:2 row_mask:0xf bank_mask:0xf
    v_add_f32_dpp v28, v28, v28 row_ror:1 row_mask:0xf bank_mask:0xf
    v_add_f32_dpp v29, v29, v29 row_ror:1 row_mask:0xf bank_mask:0xf
    v_add_f32_dpp v30, v30, v30 row_ror:1 row_mask:0xf bank_mask:0xf
    v_add_f32_dpp v31, v31, v31 row_ror:1 row_mask:0xf bank_mask:0xf
    v_max3_f32 v38, v36, v28, v29
    v_max3_f32 v38, v38, v30, v31
    v_sub_f32 v39, v36, v38
    v_mul_f32 v39, s70, v39
    v_exp_f32 v39, v39
    v_mul_f32 v56, s70, v38
    v_mov_b32 v36, v38
    v_fma_f32 v48, v28, s70, -v56
    v_fma_f32 v49, v29, s70, -v56
    v_fma_f32 v50, v30, s70, -v56
    v_fma_f32 v51, v31, s70, -v56
    v_exp_f32 v48, v48
    v_exp_f32 v49, v49
    v_exp_f32 v50, v50
    v_exp_f32 v51, v51
    v_mul_f32 v37, v37, v39
    v_mul_f32 v16, v16, v39
    v_mul_f32 v17, v17, v39
    v_mul_f32 v18, v18, v39
    v_mul_f32 v19, v19, v39
    v_mul_f32 v20, v20, v39
    v_mul_f32 v21, v21, v39
    v_mul_f32 v22, v22, v39
    v_mul_f32 v23, v23, v39
    v_add_f32 v37, v37, v48
    v_add_f32 v37, v37, v49
    v_add_f32 v37, v37, v50
    v_add_f32 v37, v37, v51
    v_lshlrev_b32 v40, 16, v112
    v_and_b32 v41, 0xffff0000, v112
    v_lshlrev_b32 v42, 16, v113
    v_and_b32 v43, 0xffff0000, v113
    v_lshlrev_b32 v44, 16, v114
    v_and_b32 v45, 0xffff0000, v114
    v_lshlrev_b32 v46, 16, v115
    v_and_b32 v47, 0xffff0000, v115
    s_waitcnt vmcnt(3)
    buffer_load_dwordx4 v[112:115], v4, s[48:51], s100 offen offset:0 nt
    v_fmac_f32 v16, v40, v48
    v_fmac_f32 v17, v41, v48
    v_fmac_f32 v18, v42, v48
    v_fmac_f32 v19, v43, v48
    v_fmac_f32 v20, v44, v48
    v_fmac_f32 v21, v45, v48
    v_fmac_f32 v22, v46, v48
    v_fmac_f32 v23, v47, v48
    v_lshlrev_b32 v40, 16, v116
    v_and_b32 v41, 0xffff0000, v116
    v_lshlrev_b32 v42, 16, v117
    v_and_b32 v43, 0xffff0000, v117
    v_lshlrev_b32 v44, 16, v118
    v_and_b32 v45, 0xffff0000, v118
    v_lshlrev_b32 v46, 16, v119
    v_and_b32 v47, 0xffff0000, v119
    s_waitcnt vmcnt(3)
    buffer_load_dwordx4 v[116:119], v4, s[48:51], s100 offen offset:1024 nt
    v_fmac_f32 v16, v40, v49
    v_fmac_f32 v17, v41, v49
    v_fmac_f32 v18, v42, v49
    v_fmac_f32 v19, v43, v49
    v_fmac_f32 v20, v44, v49
    v_fmac_f32 v21, v45, v49
    v_fmac_f32 v22, v46, v49
    v_fmac_f32 v23, v47, v49
    v_lshlrev_b32 v40, 16, v120
    v_and_b32 v41, 0xffff0000, v120
    v_lshlrev_b32 v42, 16, v121
    v_and_b32 v43, 0xffff0000, v121
    v_lshlrev_b32 v44, 16, v122
    v_and_b32 v45, 0xffff0000, v122
    v_lshlrev_b32 v46, 16, v123
    v_and_b32 v47, 0xffff0000, v123
    s_waitcnt vmcnt(3)
    buffer_load_dwordx4 v[120:123], v4, s[48:51], s100 offen offset:2048 nt
    v_fmac_f32 v16, v40, v50
    v_fmac_f32 v17, v41, v50
    v_fmac_f32 v18, v42, v50
    v_fmac_f32 v19, v43, v50
    v_fmac_f32 v20, v44, v50
    v_fmac_f32 v21, v45, v50
    v_fmac_f32 v22, v46, v50
    v_fmac_f32 v23, v47, v50
    v_lshlrev_b32 v40, 16, v124
    v_and_b32 v41, 0xffff0000, v124
    v_lshlrev_b32 v42, 16, v125
    v_and_b32 v43, 0xffff0000, v125
    v_lshlrev_b32 v44, 16, v126
    v_and_b32 v45, 0xffff0000, v126
    v_lshlrev_b32 v46, 16, v127
    v_and_b32 v47, 0xffff0000, v127
    s_waitcnt vmcnt(3)
    buffer_load_dwordx4 v[124:127], v4, s[48:51], s100 offen offset:3072 nt
    v_fmac_f32 v16, v40, v51
    v_fmac_f32 v17, v41, v51
    v_fmac_f32 v18, v42, v51
    v_fmac_f32 v19, v43, v51
    v_fmac_f32 v20, v44, v51
    v_fmac_f32 v21, v45, v51
    v_fmac_f32 v22, v46, v51
    v_fmac_f32 v23, v47, v51
    s_waitcnt vmcnt(8)
    s_mov_b64 s[94:95], exec
    s_mov_b64 exec, 1
    ds_add_rtn_u32 v59, v61, v5
    s_mov_b64 exec, s[94:95]
    s_waitcnt lgkmcnt(0)
    s_mov_b64 exec, 1
    v_lshlrev_b32 v59, 2, v59
    s_mov_b32 s92, 0
Lpop_31:
    ds_read_b32 v62, v59 offset:1024
    s_waitcnt lgkmcnt(0)
    v_readfirstlane_b32 s73, v62
    s_nop 3
    s_cmp_lg_u32 s73, -1
    s_cbranch_scc1 Lpopd_32
    s_sleep 1
    s_add_u32 s92, s92, 1
    s_cmp_lt_u32 s92, 400000
    s_cbranch_scc1 Lpop_31
Lpopd_32:
    s_mov_b64 exec, -1
Lquit_33:
    s_waitcnt vmcnt(4)
    v_dot2_f32_bf16 v28, v160, v24, 0
    v_dot2_f32_bf16 v28, v161, v25, v28
    v_dot2_f32_bf16 v28, v162, v26, v28
    v_dot2_f32_bf16 v28, v163, v27, v28
    v_dot2_f32_bf16 v29, v164, v24, 0
    v_dot2_f32_bf16 v29, v165, v25, v29
    v_dot2_f32_bf16 v29, v166, v26, v29
    v_dot2_f32_bf16 v29, v167, v27, v29
    v_dot2_f32_bf16 v30, v168, v24, 0
    v_dot2_f32_bf16 v30, v169, v25, v30
    v_dot2_f32_bf16 v30, v170, v26, v30
    v_dot2_f32_bf16 v30, v171, v27, v30
    v_dot2_f32_bf16 v31, v172, v24, 0
    v_dot2_f32_bf16 v31, v173, v25, v31
    v_dot2_f32_bf16 v31, v174, v26, v31
    v_dot2_f32_bf16 v31, v175, v27, v31
    s_nop 2
    v_add_f32_dpp v28, v28, v28 row_ror:8 row_mask:0xf bank_mask:0xf
    v_add_f32_dpp v29, v29, v29 row_ror:8 row_mask:0xf bank_mask:0xf
    v_add_f32_dpp v30, v30, v30 row_ror:8 row_mask:0xf bank_mask:0xf
    v_add_f32_dpp v31, v31, v31 row_ror:8 row_mask:0xf bank_mask:0xf
    v_add_f32_dpp v28, v28, v28 row_ror:4 row_mask:0xf bank_mask:0xf
    v_add_f32_dpp v29, v29, v29 row_ror:4 row_mask:0xf bank_mask:0xf
    v_add_f32_dpp v30, v30, v30 row_ror:4 row_mask:0xf bank_mask:0xf
    v_add_f32_dpp v31, v31, v31 row_ror:4 row_mask:0xf bank_mask:0xf
    v_add_f32_dpp v28, v28, v28 row_ror:2 row_mask:0xf bank_mask:0xf
    v_add_f32_dpp v29, v29, v29 row_ror:2 row_mask:0xf bank_mask:0xf
    v_add_f32_dpp v30, v30, v30 row_ror:2 row_mask:0xf bank_mask:0xf
    v_add_f32_dpp v31, v31, v31 row_ror:2 row_mask:0xf bank_mask:0xf
    v_add_f32_dpp v28, v28, v28 row_ror:1 row_mask:0xf bank_mask:0xf
    v_add_f32_dpp v29, v29, v29 row_ror:1 row_mask:0xf bank_mask:0xf
    v_add_f32_dpp v30, v30, v30 row_ror:1 row_mask:0xf bank_mask:0xf
    v_add_f32_dpp v31, v31, v31 row_ror:1 row_mask:0xf bank_mask:0xf
    v_max3_f32 v38, v36, v28, v29
    v_max3_f32 v38, v38, v30, v31
    v_sub_f32 v39, v36, v38
    v_mul_f32 v39, s70, v39
    v_exp_f32 v39, v39
    v_mul_f32 v56, s70, v38
    v_mov_b32 v36, v38
    v_fma_f32 v48, v28, s70, -v56
    v_fma_f32 v49, v29, s70, -v56
    v_fma_f32 v50, v30, s70, -v56
    v_fma_f32 v51, v31, s70, -v56
    v_exp_f32 v48, v48
    v_exp_f32 v49, v49
    v_exp_f32 v50, v50
    v_exp_f32 v51, v51
    v_mul_f32 v37, v37, v39
    v_mul_f32 v16, v16, v39
    v_mul_f32 v17, v17, v39
    v_mul_f32 v18, v18, v39
    v_mul_f32 v19, v19, v39
    v_mul_f32 v20, v20, v39
    v_mul_f32 v21, v21, v39
    v_mul_f32 v22, v22, v39
    v_mul_f32 v23, v23, v39
    v_add_f32 v37, v37, v48
    v_add_f32 v37, v37, v49
    v_add_f32 v37, v37, v50
    v_add_f32 v37, v37, v51
    v_lshlrev_b32 v40, 16, v176
    v_and_b32 v41, 0xffff0000, v176
    v_lshlrev_b32 v42, 16, v177
    v_and_b32 v43, 0xffff0000, v177
    v_lshlrev_b32 v44, 16, v178
    v_and_b32 v45, 0xffff0000, v178
    v_lshlrev_b32 v46, 16, v179
    v_and_b32 v47, 0xffff0000, v179
    v_fmac_f32 v16, v40, v48
    v_fmac_f32 v17, v41, v48
    v_fmac_f32 v18, v42, v48
    v_fmac_f32 v19, v43, v48
    v_fmac_f32 v20, v44, v48
    v_fmac_f32 v21, v45, v48
    v_fmac_f32 v22, v46, v48
    v_fmac_f32 v23, v47, v48
    v_lshlrev_b32 v40, 16, v180
    v_and_b32 v41, 0xffff0000, v180
    v_lshlrev_b32 v42, 16, v181
    v_and_b32 v43, 0xffff0000, v181
    v_lshlrev_b32 v44, 16, v182
    v_and_b32 v45, 0xffff0000, v182
    v_lshlrev_b32 v46, 16, v183
    v_and_b32 v47, 0xffff0000, v183
    v_fmac_f32 v16, v40, v49
    v_fmac_f32 v17, v41, v49
    v_fmac_f32 v18, v42, v49
    v_fmac_f32 v19, v43, v49
    v_fmac_f32 v20, v44, v49
    v_fmac_f32 v21, v45, v49
    v_fmac_f32 v22, v46, v49
    v_fmac_f32 v23, v47, v49
    v_lshlrev_b32 v40, 16, v184
    v_and_b32 v41, 0xffff0000, v184
    v_lshlrev_b32 v42, 16, v185
    v_and_b32 v43, 0xffff0000, v185
    v_lshlrev_b32 v44, 16, v186
    v_and_b32 v45, 0xffff0000, v186
    v_lshlrev_b32 v46, 16, v187
    v_and_b32 v47, 0xffff0000, v187
    v_fmac_f32 v16, v40, v50
    v_fmac_f32 v17, v41, v50
    v_fmac_f32 v18, v42, v50
    v_fmac_f32 v19, v43, v50
    v_fmac_f32 v20, v44, v50
    v_fmac_f32 v21, v45, v50
    v_fmac_f32 v22, v46, v50
    v_fmac_f32 v23, v47, v50
    v_lshlrev_b32 v40, 16, v188
    v_and_b32 v41, 0xffff0000, v188
    v_lshlrev_b32 v42, 16, v189
    v_and_b32 v43, 0xffff0000, v189
    v_lshlrev_b32 v44, 16, v190
    v_and_b32 v45, 0xffff0000, v190
    v_lshlrev_b32 v46, 16, v191
    v_and_b32 v47, 0xffff0000, v191
    v_fmac_f32 v16, v40, v51
    v_fmac_f32 v17, v41, v51
    v_fmac_f32 v18, v42, v51
    v_fmac_f32 v19, v43, v51
    v_fmac_f32 v20, v44, v51
    v_fmac_f32 v21, v45, v51
    v_fmac_f32 v22, v46, v51
    v_fmac_f32 v23, v47, v51
LBloop_24:
    s_cmp_ge_u32 s73, s83
    s_cbranch_scc1 LBloop2_26
    s_lshl_b32 s100, s73, 12
    s_mov_b32 s71, s73
    v_dot2_f32_bf16 v28, v64, v24, 0
    v_dot2_f32_bf16 v28, v65, v25, v28
    v_dot2_f32_bf16 v28, v66, v26, v28
    v_dot2_f32_bf16 v28, v67, v27, v28
    s_waitcnt vmcnt(3)
    buffer_load_dwordx4 v[64:67], v4, s[44:47], s100 offen offset:0 nt
    v_dot2_f32_bf16 v29, v68, v24, 0
    v_dot2_f32_bf16 v29, v69, v25, v29
    v_dot2_f32_bf16 v29, v70, v26, v29
    v_dot2_f32_bf16 v29, v71, v27, v29
    s_waitcnt vmcnt(3)
    buffer_load_dwordx4 v[68:71], v4, s[44:47], s100 offen offset:1024 nt
    v_dot2_f32_bf16 v30, v72, v24, 0
    v_dot2_f32_bf16 v30, v73, v25, v30
    v_dot2_f32_bf16 v30, v74, v26, v30
    v_dot2_f32_bf16 v30, v75, v27, v30
    s_waitcnt vmcnt(3)
    buffer_load_dwordx4 v[72:75], v4, s[44:47], s100 offen offset:2048 nt
    v_dot2_f32_bf16 v31, v76, v24, 0
    v_dot2_f32_bf16 v31, v77, v25, v31
    v_dot2_f32_bf16 v31, v78, v26, v31
    v_dot2_f32_bf16 v31, v79, v27, v31
    s_waitcnt vmcnt(3)
    buffer_load_dwordx4 v[76:79], v4, s[44:47], s100 offen offset:3072 nt
    s_nop 2
    v_add_f32_dpp v28, v28, v28 row_ror:8 row_mask:0xf bank_mask:0xf
    v_add_f32_dpp v29, v29, v29 row_ror:8 row_mask:0xf bank_mask:0xf
    v_add_f32_dpp v30, v30, v30 row_ror:8 row_mask:0xf bank_mask:0xf
    v_add_f32_dpp v31, v31, v31 row_ror:8 row_mask:0xf bank_mask:0xf
    v_add_f32_dpp v28, v28, v28 row_ror:4 row_mask:0xf bank_mask:0xf
    v_add_f32_dpp v29, v29, v29 row_ror:4 row_mask:0xf bank_mask:0xf
    v_add_f32_dpp v30, v30, v30 row_ror:4 row_mask:0xf bank_mask:0xf
    v_add_f32_dpp v31, v31, v31 row_ror:4 row_mask:0xf bank_mask:0xf
    v_add_f32_dpp v28, v28, v28 row_ror:2 row_mask:0xf bank_mask:0xf
    v_add_f32_dpp v29, v29, v29 row_ror:2 row_mask:0xf bank_mask:0xf
    v_add_f32_dpp v30, v30, v30 row_ror:2 row_mask:0xf bank_mask:0xf
    v_add_f32_dpp v31, v31, v31 row_ror:2 row_mask:0xf bank_mask:0xf
    v_add_f32_dpp v28, v28, v28 row_ror:1 row_mask:0xf bank_mask:0xf
    v_add_f32_dpp v29, v29, v29 row_ror:1 row_mask:0xf bank_mask:0xf
    v_add_f32_dpp v30, v30, v30 row_ror:1 row_mask:0xf bank_mask:0xf
    v_add_f32_dpp v31, v31, v31 row_ror:1 row_mask:0xf bank_mask:0xf
    v_max3_f32 v38, v36, v28, v29
    v_max3_f32 v38, v38, v30, v31
    v_sub_f32 v39, v36, v38
    v_mul_f32 v39, s70, v39
    v_exp_f32 v39, v39
    v_mul_f32 v56, s70, v38
    v_mov_b32 v36, v38
    v_fma_f32 v48, v28, s70, -v56
    v_fma_f32 v49, v29, s70, -v56
    v_fma_f32 v50, v30, s70, -v56
    v_fma_f32 v51, v31, s70, -v56
    v_exp_f32 v48, v48
    v_exp_f32 v49, v49
    v_exp_f32 v50, v50
    v_exp_f32 v51, v51
    v_mul_f32 v37, v37, v39
    v_mul_f32 v16, v16, v39
    v_mul_f32 v17, v17, v39
    v_mul_f32 v18, v18, v39
    v_mul_f32 v19, v19, v39
    v_mul_f32 v20, v20, v39
    v_mul_f32 v21, v21, v39
    v_mul_f32 v22, v22, v39
    v_mul_f32 v23, v23, v39
    v_add_f32 v37, v37, v48
    v_add_f32 v37, v37, v49
    v_add_f32 v37, v37, v50
    v_add_f32 v37, v37, v51
    v_lshlrev_b32 v40, 16, v80
    v_and_b32 v41, 0xffff0000, v80
    v_lshlrev_b32 v42, 16, v81
    v_and_b32 v43, 0xffff0000, v81
    v_lshlrev_b32 v44, 16, v82
    v_and_b32 v45, 0xffff0000, v82
    v_lshlrev_b32 v46, 16, v83
    v_and_b32 v47, 0xffff0000, v83
    s_waitcnt vmcnt(3)
    buffer_load_dwordx4 v[80:83], v4, s[48:51], s100 offen offset:0 nt
    v_fmac_f32 v16, v40, v48
    v_fmac_f32 v17, v41, v48
    v_fmac_f32 v18, v42, v48
    v_fmac_f32 v19, v43, v48
    v_fmac_f32 v20, v44, v48
    v_fmac_f32 v21, v45, v48
    v_fmac_f32 v22, v46, v48
    v_fmac_f32 v23, v47, v48
    v_lshlrev_b32 v40, 16, v84
    v_and_b32 v41, 0xffff0000, v84
    v_lshlrev_b32 v42, 16, v85
    v_and_b32 v43, 0xffff0000, v85
    v_lshlrev_b32 v44, 16, v86
    v_and_b32 v45, 0xffff0000, v86
    v_lshlrev_b32 v46, 16, v87
    v_and_b32 v47, 0xffff0000, v87
    s_waitcnt vmcnt(3)
    buffer_load_dwordx4 v[84:87], v4, s[48:51], s100 offen offset:1024 nt
    v_fmac_f32 v16, v40, v49
    v_fmac_f32 v17, v41, v49
    v_fmac_f32 v18, v42, v49
    v_fmac_f32 v19, v43, v49
    v_fmac_f32 v20, v44, v49
    v_fmac_f32 v21, v45, v49
    v_fmac_f32 v22, v46, v49
    v_fmac_f32 v23, v47, v49
    v_lshlrev_b32 v40, 16, v88
    v_and_b32 v41, 0xffff0000, v88
    v_lshlrev_b32 v42, 16, v89
    v_and_b32 v43, 0xffff0000, v89
    v_lshlrev_b32 v44, 16, v90
    v_and_b32 v45, 0xffff0000, v90
    v_lshlrev_b32 v46, 16, v91
    v_and_b32 v47, 0xffff0000, v91
    s_waitcnt vmcnt(3)
    buffer_load_dwordx4 v[88:91], v4, s[48:51], s100 offen offset:2048 nt
    v_fmac_f32 v16, v40, v50
    v_fmac_f32 v17, v41, v50
    v_fmac_f32 v18, v42, v50
    v_fmac_f32 v19, v43, v50
    v_fmac_f32 v20, v44, v50
    v_fmac_f32 v21, v45, v50
    v_fmac_f32 v22, v46, v50
    v_fmac_f32 v23, v47, v50
    v_lshlrev_b32 v40, 16, v92
    v_and_b32 v41, 0xffff0000, v92
    v_lshlrev_b32 v42, 16, v93
    v_and_b32 v43, 0xffff0000, v93
    v_lshlrev_b32 v44, 16, v94
    v_and_b32 v45, 0xffff0000, v94
    v_lshlrev_b32 v46, 16, v95
    v_and_b32 v47, 0xffff0000, v95
    s_waitcnt vmcnt(3)
    buffer_load_dwordx4 v[92:95], v4, s[48:51], s100 offen offset:3072 nt
    v_fmac_f32 v16, v40, v51
    v_fmac_f32 v17, v41, v51
    v_fmac_f32 v18, v42, v51
    v_fmac_f32 v19, v43, v51
    v_fmac_f32 v20, v44, v51
    v_fmac_f32 v21, v45, v51
    v_fmac_f32 v22, v46, v51
    v_fmac_f32 v23, v47, v51
    s_waitcnt vmcnt(8)
    s_mov_b64 s[94:95], exec
    s_mov_b64 exec, 1
    ds_add_rtn_u32 v59, v61, v5
    s_mov_b64 exec, s[94:95]
    s_waitcnt lgkmcnt(0)
    s_mov_b64 exec, 1
    v_lshlrev_b32 v59, 2, v59
    s_mov_b32 s92, 0
Lpop_34:
    ds_read_b32 v62, v59 offset:1024
    s_waitcnt lgkmcnt(0)
    v_readfirstlane_b32 s73, v62
    s_nop 3
    s_cmp_lg_u32 s73, -1
    s_cbranch_scc1 Lpopd_35
    s_sleep 1
    s_add_u32 s92, s92, 1
    s_cmp_lt_u32 s92, 400000
    s_cbranch_scc1 Lpop_34
Lpopd_35:
    s_mov_b64 exec, -1
Lquit_36:
    s_cmp_ge_u32 s73, s83
    s_cbranch_scc1 LBloop2b_27
    s_lshl_b32 s100, s73, 12
    s_mov_b32 s72, s73
    v_dot2_f32_bf16 v28, v96, v24, 0
    v_dot2_f32_bf16 v28, v97, v25, v28
    v_dot2_f32_bf16 v28, v98, v26, v28
    v_dot2_f32_bf16 v28, v99, v27, v28
    s_waitcnt vmcnt(3)
    buffer_load_dwordx4 v[96:99], v4, s[44:47], s100 offen offset:0 nt
    v_dot2_f32_bf16 v29, v100, v24, 0
    v_dot2_f32_bf16 v29, v101, v25, v29
    v_dot2_f32_bf16 v29, v102, v26, v29
    v_dot2_f32_bf16 v29, v103, v27, v29
    s_waitcnt vmcnt(3)
    buffer_load_dwordx4 v[100:103], v4, s[44:47], s100 offen offset:1024 nt
    v_dot2_f32_bf16 v30, v104, v24, 0
    v_dot2_f32_bf16 v30, v105, v25, v30
    v_dot2_f32_bf16 v30, v106, v26, v30
    v_dot2_f32_bf16 v30, v107, v27, v30
    s_waitcnt vmcnt(3)
    buffer_load_dwordx4 v[104:107], v4, s[44:47], s100 offen offset:2048 nt
    v_dot2_f32_bf16 v31, v108, v24, 0
    v_dot2_f32_bf16 v31, v109, v25, v31
    v_dot2_f32_bf16 v31, v110, v26, v31
    v_dot2_f32_bf16 v31, v111, v27, v31
    s_waitcnt vmcnt(3)
    buffer_load_dwordx4 v[108:111], v4, s[44:47], s100 offen offset:3072 nt
    s_nop 2
    v_add_f32_dpp v28, v28, v28 row_ror:8 row_mask:0xf bank_mask:0xf
    v_add_f32_dpp v29, v29, v29 row_ror:8 row_mask:0xf bank_mask:0xf
    v_add_f32_dpp v30, v30, v30 row_ror:8 row_mask:0xf bank_mask:0xf
    v_add_f32_dpp v31, v31, v31 row_ror:8 row_mask:0xf bank_mask:0xf
    v_add_f32_dpp v28, v28, v28 row_ror:4 row_mask:0xf bank_mask:0xf
    v_add_f32_dpp v29, v29, v29 row_ror:4 row_mask:0xf bank_mask:0xf
    v_add_f32_dpp v30, v30, v30 row_ror:4 row_mask:0xf bank_mask:0xf
    v_add_f32_dpp v31, v31, v31 row_ror:4 row_mask:0xf bank_mask:0xf
    v_add_f32_dpp v28, v28, v28 row_ror:2 row_mask:0xf bank_mask:0xf
    v_add_f32_dpp v29, v29, v29 row_ror:2 row_mask:0xf bank_mask:0xf
    v_add_f32_dpp v30, v30, v30 row_ror:2 row_mask:0xf bank_mask:0xf
    v_add_f32_dpp v31, v31, v31 row_ror:2 row_mask:0xf bank_mask:0xf
    v_add_f32_dpp v28, v28, v28 row_ror:1 row_mask:0xf bank_mask:0xf
    v_add_f32_dpp v29, v29, v29 row_ror:1 row_mask:0xf bank_mask:0xf
    v_add_f32_dpp v30, v30, v30 row_ror:1 row_mask:0xf bank_mask:0xf
    v_add_f32_dpp v31, v31, v31 row_ror:1 row_mask:0xf bank_mask:0xf
    v_max3_f32 v38, v36, v28, v29
    v_max3_f32 v38, v38, v30, v31
    v_sub_f32 v39, v36, v38
    v_mul_f32 v39, s70, v39
    v_exp_f32 v39, v39
    v_mul_f32 v56, s70, v38
    v_mov_b32 v36, v38
    v_fma_f32 v48, v28, s70, -v56
    v_fma_f32 v49, v29, s70, -v56
    v_fma_f32 v50, v30, s70, -v56
    v_fma_f32 v51, v31, s70, -v56
    v_exp_f32 v48, v48
    v_exp_f32 v49, v49
    v_exp_f32 v50, v50
    v_exp_f32 v51, v51
    v_mul_f32 v37, v37, v39
    v_mul_f32 v16, v16, v39
    v_mul_f32 v17, v17, v39
    v_mul_f32 v18, v18, v39
    v_mul_f32 v19, v19, v39
    v_mul_f32 v20, v20, v39
    v_mul_f32 v21, v21, v39
    v_mul_f32 v22, v22, v39
    v_mul_f32 v23, v23, v39
    v_add_f32 v37, v37, v48
    v_add_f32 v37, v37, v49
    v_add_f32 v37, v37, v50
    v_add_f32 v37, v37, v51
    v_lshlrev_b32 v40, 16, v112
    v_and_b32 v41, 0xffff0000, v112
    v_lshlrev_b32 v42, 16, v113
    v_and_b32 v43, 0xffff0000, v113
    v_lshlrev_b32 v44, 16, v114
    v_and_b32 v45, 0xffff0000, v114
    v_lshlrev_b32 v46, 16, v115
    v_and_b32 v47, 0xffff0000, v115
    s_waitcnt vmcnt(3)
    buffer_load_dwordx4 v[112:115], v4, s[48:51], s100 offen offset:0 nt
    v_fmac_f32 v16, v40, v48
    v_fmac_f32 v17, v41, v48
    v_fmac_f32 v18, v42, v48
    v_fmac_f32 v19, v43, v48
    v_fmac_f32 v20, v44, v48
    v_fmac_f32 v21, v45, v48
    v_fmac_f32 v22, v46, v48
    v_fmac_f32 v23, v47, v48
    v_lshlrev_b32 v40, 16, v116
    v_and_b32 v41, 0xffff0000, v116
    v_lshlrev_b32 v42, 16, v117
    v_and_b32 v43, 0xffff0000, v117
    v_lshlrev_b32 v44, 16, v118
    v_and_b32 v45, 0xffff0000, v118
    v_lshlrev_b32 v46, 16, v119
    v_and_b32 v47, 0xffff0000, v119
    s_waitcnt vmcnt(3)
    buffer_load_dwordx4 v[116:119], v4, s[48:51], s100 offen offset:1024 nt
    v_fmac_f32 v16, v40, v49
    v_fmac_f32 v17, v41, v49
    v_fmac_f32 v18, v42, v49
    v_fmac_f32 v19, v43, v49
    v_fmac_f32 v20, v44, v49
    v_fmac_f32 v21, v45, v49
    v_fmac_f32 v22, v46, v49
    v_fmac_f32 v23, v47, v49
    v_lshlrev_b32 v40, 16, v120
    v_and_b32 v41, 0xffff0000, v120
    v_lshlrev_b32 v42, 16, v121
    v_and_b32 v43, 0xffff0000, v121
    v_lshlrev_b32 v44, 16, v122
    v_and_b32 v45, 0xffff0000, v122
    v_lshlrev_b32 v46, 16, v123
    v_and_b32 v47, 0xffff0000, v123
    s_waitcnt vmcnt(3)
    buffer_load_dwordx4 v[120:123], v4, s[48:51], s100 offen offset:2048 nt
    v_fmac_f32 v16, v40, v50
    v_fmac_f32 v17, v41, v50
    v_fmac_f32 v18, v42, v50
    v_fmac_f32 v19, v43, v50
    v_fmac_f32 v20, v44, v50
    v_fmac_f32 v21, v45, v50
    v_fmac_f32 v22, v46, v50
    v_fmac_f32 v23, v47, v50
    v_lshlrev_b32 v40, 16, v124
    v_and_b32 v41, 0xffff0000, v124
    v_lshlrev_b32 v42, 16, v125
    v_and_b32 v43, 0xffff0000, v125
    v_lshlrev_b32 v44, 16, v126
    v_and_b32 v45, 0xffff0000, v126
    v_lshlrev_b32 v46, 16, v127
    v_and_b32 v47, 0xffff0000, v127
    s_waitcnt vmcnt(3)
    buffer_load_dwordx4 v[124:127], v4, s[48:51], s100 offen offset:3072 nt
    v_fmac_f32 v16, v40, v51
    v_fmac_f32 v17, v41, v51
    v_fmac_f32 v18, v42, v51
    v_fmac_f32 v19, v43, v51
    v_fmac_f32 v20, v44, v51
    v_fmac_f32 v21, v45, v51
    v_fmac_f32 v22, v46, v51
    v_fmac_f32 v23, v47, v51
    s_waitcnt vmcnt(8)
    s_mov_b64 s[94:95], exec
    s_mov_b64 exec, 1
    ds_add_rtn_u32 v59, v61, v5
    s_mov_b64 exec, s[94:95]
    s_waitcnt lgkmcnt(0)
    s_mov_b64 exec, 1
    v_lshlrev_b32 v59, 2, v59
    s_mov_b32 s92, 0
Lpop_37:
    ds_read_b32 v62, v59 offset:1024
    s_waitcnt lgkmcnt(0)
    v_readfirstlane_b32 s73, v62
    s_nop 3
    s_cmp_lg_u32 s73, -1
    s_cbranch_scc1 Lpopd_38
    s_sleep 1
    s_add_u32 s92, s92, 1
    s_cmp_lt_u32 s92, 400000
    s_cbranch_scc1 Lpop_37
Lpopd_38:
    s_mov_b64 exec, -1
Lquit_39:
    s_branch LBloop_24
LBloop2_26:
    s_cmp_ge_u32 s73, s74
    s_cbranch_scc1 LBtail0_40
    s_lshl_b32 s100, s73, 12
    s_mov_b32 s71, s73
    v_dot2_f32_bf16 v28, v64, v24, 0
    v_dot2_f32_bf16 v28, v65, v25, v28
    v_dot2_f32_bf16 v28, v66, v26, v28
    v_dot2_f32_bf16 v28, v67, v27, v28
    s_waitcnt vmcnt(13)
    buffer_load_dwordx4 v[64:67], v4, s[44:47], s100 offen offset:0 nt
    v_dot2_f32_bf16 v29, v68, v24, 0
    v_dot2_f32_bf16 v29, v69, v25, v29
    v_dot2_f32_bf16 v29, v70, v26, v29
    v_dot2_f32_bf16 v29, v71, v27, v29
    s_waitcnt vmcnt(13)
    buffer_load_dwordx4 v[68:71], v4, s[44:47], s100 offen offset:1024 nt
    v_dot2_f32_bf16 v30, v72, v24, 0
    v_dot2_f32_bf16 v30, v73, v25, v30
    v_dot2_f32_bf16 v30, v74, v26, v30
    v_dot2_f32_bf16 v30, v75, v27, v30
    s_waitcnt vmcnt(13)
    buffer_load_dwordx4 v[72:75], v4, s[44:47], s100 offen offset:2048 nt
    v_dot2_f32_bf16 v31, v76, v24, 0
    v_dot2_f32_bf16 v31, v77, v25, v31
    v_dot2_f32_bf16 v31, v78, v26, v31
    v_dot2_f32_bf16 v31, v79, v27, v31
    s_waitcnt vmcnt(13)
    buffer_load_dwordx4 v[76:79], v4, s[44:47], s100 offen offset:3072 nt
    s_nop 2
    v_add_f32_dpp v28, v28, v28 row_ror:8 row_mask:0xf bank_mask:0xf
    v_add_f32_dpp v29, v29, v29 row_ror:8 row_mask:0xf bank_mask:0xf
    v_add_f32_dpp v30, v30, v30 row_ror:8 row_mask:0xf bank_mask:0xf
    v_add_f32_dpp v31, v31, v31 row_ror:8 row_mask:0xf bank_mask:0xf
    v_add_f32_dpp v28, v28, v28 row_ror:4 row_mask:0xf bank_mask:0xf
    v_add_f32_dpp v29, v29, v29 row_ror:4 row_mask:0xf bank_mask:0xf
    v_add_f32_dpp v30, v30, v30 row_ror:4 row_mask:0xf bank_mask:0xf
    v_add_f32_dpp v31, v31, v31 row_ror:4 row_mask:0xf bank_mask:0xf
    v_add_f32_dpp v28, v28, v28 row_ror:2 row_mask:0xf bank_mask:0xf
    v_add_f32_dpp v29, v29, v29 row_ror:2 row_mask:0xf bank_mask:0xf
    v_add_f32_dpp v30, v30, v30 row_ror:2 row_mask:0xf bank_mask:0xf
    v_add_f32_dpp v31, v31, v31 row_ror:2 row_mask:0xf bank_mask:0xf
    v_add_f32_dpp v28, v28, v28 row_ror:1 row_mask:0xf bank_mask:0xf
    v_add_f32_dpp v29, v29, v29 row_ror:1 row_mask:0xf bank_mask:0xf
    v_add_f32_dpp v30, v30, v30 row_ror:1 row_mask:0xf bank_mask:0xf
    v_add_f32_dpp v31, v31, v31 row_ror:1 row_mask:0xf bank_mask:0xf
    v_max3_f32 v38, v36, v28, v29
    v_max3_f32 v38, v38, v30, v31
    v_sub_f32 v39, v36, v38
    v_mul_f32 v39, s70, v39
    v_exp_f32 v39, v39
    v_mul_f32 v56, s70, v38
    v_mov_b32 v36, v38
    v_fma_f32 v48, v28, s70, -v56
    v_fma_f32 v49, v29, s70, -v56
    v_fma_f32 v50, v30, s70, -v56
    v_fma_f32 v51, v31, s70, -v56
    v_exp_f32 v48, v48
    v_exp_f32 v49, v49
    v_exp_f32 v50, v50
    v_exp_f32 v51, v51
    v_mul_f32 v37, v37, v39
    v_mul_f32 v16, v16, v39
    v_mul_f32 v17, v17, v39
    v_mul_f32 v18, v18, v39
    v_mul_f32 v19, v19, v39
    v_mul_f32 v20, v20, v39
    v_mul_f32 v21, v21, v39
    v_mul_f32 v22, v22, v39
    v_mul_f32 v23, v23, v39
    v_add_f32 v37, v37, v48
    v_add_f32 v37, v37, v49
    v_add_f32 v37, v37, v50
    v_add_f32 v37, v37, v51
    v_lshlrev_b32 v40, 16, v80
    v_and_b32 v41, 0xffff0000, v80
    v_lshlrev_b32 v42, 16, v81
    v_and_b32 v43, 0xffff0000, v81
    v_lshlrev_b32 v44, 16, v82
    v_and_b32 v45, 0xffff0000, v82
    v_lshlrev_b32 v46, 16, v83
    v_and_b32 v47, 0xffff0000, v83
    s_waitcnt vmcnt(13)
    buffer_load_dwordx4 v[80:83], v4, s[48:51], s100 offen offset:0 nt
    v_fmac_f32 v16, v40, v48
    v_fmac_f32 v17, v41, v48
    v_fmac_f32 v18, v42, v48
    v_fmac_f32 v19, v43, v48
    v_fmac_f32 v20, v44, v48
    v_fmac_f32 v21, v45, v48
    v_fmac_f32 v22, v46, v48
    v_fmac_f32 v23, v47, v48
    v_lshlrev_b32 v40, 16, v84
    v_and_b32 v41, 0xffff0000, v84
    v_lshlrev_b32 v42, 16, v85
    v_and_b32 v43, 0xffff0000, v85
    v_lshlrev_b32 v44, 16, v86
    v_and_b32 v45, 0xffff0000, v86
    v_lshlrev_b32 v46, 16, v87
    v_and_b32 v47, 0xffff0000, v87
    s_waitcnt vmcnt(13)
    buffer_load_dwordx4 v[84:87], v4, s[48:51], s100 offen offset:1024 nt
    v_fmac_f32 v16, v40, v49
    v_fmac_f32 v17, v41, v49
    v_fmac_f32 v18, v42, v49
    v_fmac_f32 v19, v43, v49
    v_fmac_f32 v20, v44, v49
    v_fmac_f32 v21, v45, v49
    v_fmac_f32 v22, v46, v49
    v_fmac_f32 v23, v47, v49
    v_lshlrev_b32 v40, 16, v88
    v_and_b32 v41, 0xffff0000, v88
    v_lshlrev_b32 v42, 16, v89
    v_and_b32 v43, 0xffff0000, v89
    v_lshlrev_b32 v44, 16, v90
    v_and_b32 v45, 0xffff0000, v90
    v_lshlrev_b32 v46, 16, v91
    v_and_b32 v47, 0xffff0000, v91
    s_waitcnt vmcnt(13)
    buffer_load_dwordx4 v[88:91], v4, s[48:51], s100 offen offset:2048 nt
    v_fmac_f32 v16, v40, v50
    v_fmac_f32 v17, v41, v50
    v_fmac_f32 v18, v42, v50
    v_fmac_f32 v19, v43, v50
    v_fmac_f32 v20, v44, v50
    v_fmac_f32 v21, v45, v50
    v_fmac_f32 v22, v46, v50
    v_fmac_f32 v23, v47, v50
    v_lshlrev_b32 v40, 16, v92
    v_and_b32 v41, 0xffff0000, v92
    v_lshlrev_b32 v42, 16, v93
    v_and_b32 v43, 0xffff0000, v93
    v_lshlrev_b32 v44, 16, v94
    v_and_b32 v45, 0xffff0000, v94
    v_lshlrev_b32 v46, 16, v95
    v_and_b32 v47, 0xffff0000, v95
    s_waitcnt vmcnt(13)
    buffer_load_dwordx4 v[92:95], v4, s[48:51], s100 offen offset:3072 nt
    v_fmac_f32 v16, v40, v51
    v_fmac_f32 v17, v41, v51
    v_fmac_f32 v18, v42, v51
    v_fmac_f32 v19, v43, v51
    v_fmac_f32 v20, v44, v51
    v_fmac_f32 v21, v45, v51
    v_fmac_f32 v22, v46, v51
    v_fmac_f32 v23, v47, v51
    s_waitcnt vmcnt(8)
    s_mov_b64 s[94:95], exec
    s_mov_b64 exec, 1
    ds_add_rtn_u32 v59, v61, v5
    s_mov_b64 exec, s[94:95]
    s_waitcnt lgkmcnt(0)
    s_mov_b64 exec, 1
    v_lshlrev_b32 v59, 2, v59
    s_mov_b32 s92, 0
Lpop_42:
    ds_read_b32 v62, v59 offset:1024
    s_waitcnt lgkmcnt(0)
    v_readfirstlane_b32 s73, v62
    s_nop 3
    s_cmp_lg_u32 s73, -1
    s_cbranch_scc1 Lpopd_43
    s_sleep 1
    s_add_u32 s92, s92, 1
    s_cmp_lt_u32 s92, 400000
    s_cbranch_scc1 Lpop_42
Lpopd_43:
    s_mov_b64 exec, -1
Lquit_44:
LBloop2b_27:
    s_cmp_ge_u32 s73, s74
    s_cbranch_scc1 LBtail1_41
    s_lshl_b32 s100, s73, 12
    s_mov_b32 s72, s73
    v_dot2_f32_bf16 v28, v96, v24, 0
    v_dot2_f32_bf16 v28, v97, v25, v28
    v_dot2_f32_bf16 v28, v98, v26, v28
    v_dot2_f32_bf16 v28, v99, v27, v28
    s_waitcnt vmcnt(13)
    buffer_load_dwordx4 v[96:99], v4, s[44:47], s100 offen offset:0 nt
    v_dot2_f32_bf16 v29, v100, v24, 0
    v_dot2_f32_bf16 v29, v101, v25, v29
    v_dot2_f32_bf16 v29, v102, v26, v29
    v_dot2_f32_bf16 v29, v103, v27, v29
    s_waitcnt vmcnt(13)
    buffer_load_dwordx4 v[100:103], v4, s[44:47], s100 offen offset:1024 nt
    v_dot2_f32_bf16 v30, v104, v24, 0
    v_dot2_f32_bf16 v30, v105, v25, v30
    v_dot2_f32_bf16 v30, v106, v26, v30
    v_dot2_f32_bf16 v30, v107, v27, v30
    s_waitcnt vmcnt(13)
    buffer_load_dwordx4 v[104:107], v4, s[44:47], s100 offen offset:2048 nt
    v_dot2_f32_bf16 v31, v108, v24, 0
    v_dot2_f32_bf16 v31, v109, v25, v31
    v_dot2_f32_bf16 v31, v110, v26, v31
    v_dot2_f32_bf16 v31, v111, v27, v31
    s_waitcnt vmcnt(13)
    buffer_load_dwordx4 v[108:111], v4, s[44:47], s100 offen offset:3072 nt
    s_nop 2
    v_add_f32_dpp v28, v28, v28 row_ror:8 row_mask:0xf bank_mask:0xf
    v_add_f32_dpp v29, v29, v29 row_ror:8 row_mask:0xf bank_mask:0xf
    v_add_f32_dpp v30, v30, v30 row_ror:8 row_mask:0xf bank_mask:0xf
    v_add_f32_dpp v31, v31, v31 row_ror:8 row_mask:0xf bank_mask:0xf
    v_add_f32_dpp v28, v28, v28 row_ror:4 row_mask:0xf bank_mask:0xf
    v_add_f32_dpp v29, v29, v29 row_ror:4 row_mask:0xf bank_mask:0xf
    v_add_f32_dpp v30, v30, v30 row_ror:4 row_mask:0xf bank_mask:0xf
    v_add_f32_dpp v31, v31, v31 row_ror:4 row_mask:0xf bank_mask:0xf
    v_add_f32_dpp v28, v28, v28 row_ror:2 row_mask:0xf bank_mask:0xf
    v_add_f32_dpp v29, v29, v29 row_ror:2 row_mask:0xf bank_mask:0xf
    v_add_f32_dpp v30, v30, v30 row_ror:2 row_mask:0xf bank_mask:0xf
    v_add_f32_dpp v31, v31, v31 row_ror:2 row_mask:0xf bank_mask:0xf
    v_add_f32_dpp v28, v28, v28 row_ror:1 row_mask:0xf bank_mask:0xf
    v_add_f32_dpp v29, v29, v29 row_ror:1 row_mask:0xf bank_mask:0xf
    v_add_f32_dpp v30, v30, v30 row_ror:1 row_mask:0xf bank_mask:0xf
    v_add_f32_dpp v31, v31, v31 row_ror:1 row_mask:0xf bank_mask:0xf
    v_max3_f32 v38, v36, v28, v29
    v_max3_f32 v38, v38, v30, v31
    v_sub_f32 v39, v36, v38
    v_mul_f32 v39, s70, v39
    v_exp_f32 v39, v39
    v_mul_f32 v56, s70, v38
    v_mov_b32 v36, v38
    v_fma_f32 v48, v28, s70, -v56
    v_fma_f32 v49, v29, s70, -v56
    v_fma_f32 v50, v30, s70, -v56
    v_fma_f32 v51, v31, s70, -v56
    v_exp_f32 v48, v48
    v_exp_f32 v49, v49
    v_exp_f32 v50, v50
    v_exp_f32 v51, v51
    v_mul_f32 v37, v37, v39
    v_mul_f32 v16, v16, v39
    v_mul_f32 v17, v17, v39
    v_mul_f32 v18, v18, v39
    v_mul_f32 v19, v19, v39
    v_mul_f32 v20, v20, v39
    v_mul_f32 v21, v21, v39
    v_mul_f32 v22, v22, v39
    v_mul_f32 v23, v23, v39
    v_add_f32 v37, v37, v48
    v_add_f32 v37, v37, v49
    v_add_f32 v37, v37, v50
    v_add_f32 v37, v37, v51
    v_lshlrev_b32 v40, 16, v112
    v_and_b32 v41, 0xffff0000, v112
    v_lshlrev_b32 v42, 16, v113
    v_and_b32 v43, 0xffff0000, v113
    v_lshlrev_b32 v44, 16, v114
    v_and_b32 v45, 0xffff0000, v114
    v_lshlrev_b32 v46, 16, v115
    v_and_b32 v47, 0xffff0000, v115
    s_waitcnt vmcnt(13)
    buffer_load_dwordx4 v[112:115], v4, s[48:51], s100 offen offset:0 nt
    v_fmac_f32 v16, v40, v48
    v_fmac_f32 v17, v41, v48
    v_fmac_f32 v18, v42, v48
    v_fmac_f32 v19, v43, v48
    v_fmac_f32 v20, v44, v48
    v_fmac_f32 v21, v45, v48
    v_fmac_f32 v22, v46, v48
    v_fmac_f32 v23, v47, v48
    v_lshlrev_b32 v40, 16, v116
    v_and_b32 v41, 0xffff0000, v116
    v_lshlrev_b32 v42, 16, v117
    v_and_b32 v43, 0xffff0000, v117
    v_lshlrev_b32 v44, 16, v118
    v_and_b32 v45, 0xffff0000, v118
    v_lshlrev_b32 v46, 16, v119
    v_and_b32 v47, 0xffff0000, v119
    s_waitcnt vmcnt(13)
    buffer_load_dwordx4 v[116:119], v4, s[48:51], s100 offen offset:1024 nt
    v_fmac_f32 v16, v40, v49
    v_fmac_f32 v17, v41, v49
    v_fmac_f32 v18, v42, v49
    v_fmac_f32 v19, v43, v49
    v_fmac_f32 v20, v44, v49
    v_fmac_f32 v21, v45, v49
    v_fmac_f32 v22, v46, v49
    v_fmac_f32 v23, v47, v49
    v_lshlrev_b32 v40, 16, v120
    v_and_b32 v41, 0xffff0000, v120
    v_lshlrev_b32 v42, 16, v121
    v_and_b32 v43, 0xffff0000, v121
    v_lshlrev_b32 v44, 16, v122
    v_and_b32 v45, 0xffff0000, v122
    v_lshlrev_b32 v46, 16, v123
    v_and_b32 v47, 0xffff0000, v123
    s_waitcnt vmcnt(13)
    buffer_load_dwordx4 v[120:123], v4, s[48:51], s100 offen offset:2048 nt
    v_fmac_f32 v16, v40, v50
    v_fmac_f32 v17, v41, v50
    v_fmac_f32 v18, v42, v50
    v_fmac_f32 v19, v43, v50
    v_fmac_f32 v20, v44, v50
    v_fmac_f32 v21, v45, v50
    v_fmac_f32 v22, v46, v50
    v_fmac_f32 v23, v47, v50
    v_lshlrev_b32 v40, 16, v124
    v_and_b32 v41, 0xffff0000, v124
    v_lshlrev_b32 v42, 16, v125
    v_and_b32 v43, 0xffff0000, v125
    v_lshlrev_b32 v44, 16, v126
    v_and_b32 v45, 0xffff0000, v126
    v_lshlrev_b32 v46, 16, v127
    v_and_b32 v47, 0xffff0000, v127
    s_waitcnt vmcnt(13)
    buffer_load_dwordx4 v[124:127], v4, s[48:51], s100 offen offset:3072 nt
    v_fmac_f32 v16, v40, v51
    v_fmac_f32 v17, v41, v51
    v_fmac_f32 v18, v42, v51
    v_fmac_f32 v19, v43, v51
    v_fmac_f32 v20, v44, v51
    v_fmac_f32 v21, v45, v51
    v_fmac_f32 v22, v46, v51
    v_fmac_f32 v23, v47, v51
    s_waitcnt vmcnt(8)
    s_mov_b64 s[94:95], exec
    s_mov_b64 exec, 1
    ds_add_rtn_u32 v59, v61, v5
    s_mov_b64 exec, s[94:95]
    s_waitcnt lgkmcnt(0)
    s_mov_b64 exec, 1
    v_lshlrev_b32 v59, 2, v59
    s_mov_b32 s92, 0
Lpop_45:
    ds_read_b32 v62, v59 offset:1024
    s_waitcnt lgkmcnt(0)
    v_readfirstlane_b32 s73, v62
    s_nop 3
    s_cmp_lg_u32 s73, -1
    s_cbranch_scc1 Lpopd_46
    s_sleep 1
    s_add_u32 s92, s92, 1
    s_cmp_lt_u32 s92, 400000
    s_cbranch_scc1 Lpop_45
Lpopd_46:
    s_mov_b64 exec, -1
Lquit_47:
    s_branch LBloop2_26
LBtail0_40:
    s_waitcnt vmcnt(15)
    v_dot2_f32_bf16 v28, v64, v24, 0
    v_dot2_f32_bf16 v28, v65, v25, v28
    v_dot2_f32_bf16 v28, v66, v26, v28
    v_dot2_f32_bf16 v28, v67, v27, v28
    s_waitcnt vmcnt(14)
    v_dot2_f32_bf16 v29, v68, v24, 0
    v_dot2_f32_bf16 v29, v69, v25, v29
    v_dot2_f32_bf16 v29, v70, v26, v29
    v_dot2_f32_bf16 v29, v71, v27, v29
    s_waitcnt vmcnt(13)
    v_dot2_f32_bf16 v30, v72, v24, 0
    v_dot2_f32_bf16 v30, v73, v25, v30
    v_dot2_f32_bf16 v30, v74, v26, v30
    v_dot2_f32_bf16 v30, v75, v27, v30
    s_waitcnt vmcnt(12)
    v_dot2_f32_bf16 v31, v76, v24, 0
    v_dot2_f32_bf16 v31, v77, v25, v31
    v_dot2_f32_bf16 v31, v78, v26, v31
    v_dot2_f32_bf16 v31, v79, v27, v31
    s_nop 2
    v_add_f32_dpp v28, v28, v28 row_ror:8 row_mask:0xf bank_mask:0xf
    v_add_f32_dpp v29, v29, v29 row_ror:8 row_mask:0xf bank_mask:0xf
    v_add_f32_dpp v30, v30, v30 row_ror:8 row_mask:0xf bank_mask:0xf
    v_add_f32_dpp v31, v31, v31 row_ror:8 row_mask:0xf bank_mask:0xf
    v_add_f32_dpp v28, v28, v28 row_ror:4 row_mask:0xf bank_mask:0xf
    v_add_f32_dpp v29, v29, v29 row_ror:4 row_mask:0xf bank_mask:0xf
    v_add_f32_dpp v30, v30, v30 row_ror:4 row_mask:0xf bank_mask:0xf
    v_add_f32_dpp v31, v31, v31 row_ror:4 row_mask:0xf bank_mask:0xf
    v_add_f32_dpp v28, v28, v28 row_ror:2 row_mask:0xf bank_mask:0xf
    v_add_f32_dpp v29, v29, v29 row_ror:2 row_mask:0xf bank_mask:0xf
    v_add_f32_dpp v30, v30, v30 row_ror:2 row_mask:0xf bank_mask:0xf
    v_add_f32_dpp v31, v31, v31 row_ror:2 row_mask:0xf bank_mask:0xf
    v_add_f32_dpp v28, v28, v28 row_ror:1 row_mask:0xf bank_mask:0xf
    v_add_f32_dpp v29, v29, v29 row_ror:1 row_mask:0xf bank_mask:0xf
    v_add_f32_dpp v30, v30, v30 row_ror:1 row_mask:0xf bank_mask:0xf
    v_add_f32_dpp v31, v31, v31 row_ror:1 row_mask:0xf bank_mask:0xf
    v_max3_f32 v38, v36, v28, v29
    v_max3_f32 v38, v38, v30, v31
    v_sub_f32 v39, v36, v38
    v_mul_f32 v39, s70, v39
    v_exp_f32 v39, v39
    v_mul_f32 v56, s70, v38
    v_mov_b32 v36, v38
    v_fma_f32 v48, v28, s70, -v56
    v_fma_f32 v49, v29, s70, -v56
    v_fma_f32 v50, v30, s70, -v56
    v_fma_f32 v51, v31, s70, -v56
    v_exp_f32 v48, v48
    v_exp_f32 v49, v49
    v_exp_f32 v50, v50
    v_exp_f32 v51, v51
    v_mul_f32 v37, v37, v39
    v_mul_f32 v16, v16, v39
    v_mul_f32 v17, v17, v39
    v_mul_f32 v18, v18, v39
    v_mul_f32 v19, v19, v39
    v_mul_f32 v20, v20, v39
    v_mul_f32 v21, v21, v39
    v_mul_f32 v22, v22, v39
    v_mul_f32 v23, v23, v39
    v_add_f32 v37, v37, v48
    v_add_f32 v37, v37, v49
    v_add_f32 v37, v37, v50
    v_add_f32 v37, v37, v51
    s_waitcnt vmcnt(11)
    v_lshlrev_b32 v40, 16, v80
    v_and_b32 v41, 0xffff0000, v80
    v_lshlrev_b32 v42, 16, v81
    v_and_b32 v43, 0xffff0000, v81
    v_lshlrev_b32 v44, 16, v82
    v_and_b32 v45, 0xffff0000, v82
    v_lshlrev_b32 v46, 16, v83
    v_and_b32 v47, 0xffff0000, v83
    v_fmac_f32 v16, v40, v48
    v_fmac_f32 v17, v41, v48
    v_fmac_f32 v18, v42, v48
    v_fmac_f32 v19, v43, v48
    v_fmac_f32 v20, v44, v48
    v_fmac_f32 v21, v45, v48
    v_fmac_f32 v22, v46, v48
    v_fmac_f32 v23, v47, v48
    s_waitcnt vmcnt(10)
    v_lshlrev_b32 v40, 16, v84
    v_and_b32 v41, 0xffff0000, v84
    v_lshlrev_b32 v42, 16, v85
    v_and_b32 v43, 0xffff0000, v85
    v_lshlrev_b32 v44, 16, v86
    v_and_b32 v45, 0xffff0000, v86
    v_lshlrev_b32 v46, 16, v87
    v_and_b32 v47, 0xffff0000, v87
    v_fmac_f32 v16, v40, v49
    v_fmac_f32 v17, v41, v49
    v_fmac_f32 v18, v42, v49
    v_fmac_f32 v19, v43, v49
    v_fmac_f32 v20, v44, v49
    v_fmac_f32 v21, v45, v49
    v_fmac_f32 v22, v46, v49
    v_fmac_f32 v23, v47, v49
    s_waitcnt vmcnt(9)
    v_lshlrev_b32 v40, 16, v88
    v_and_b32 v41, 0xffff0000, v88
    v_lshlrev_b32 v42, 16, v89
    v_and_b32 v43, 0xffff0000, v89
    v_lshlrev_b32 v44, 16, v90
    v_and_b32 v45, 0xffff0000, v90
    v_lshlrev_b32 v46, 16, v91
    v_and_b32 v47, 0xffff0000, v91
    v_fmac_f32 v16, v40, v50
    v_fmac_f32 v17, v41, v50
    v_fmac_f32 v18, v42, v50
    v_fmac_f32 v19, v43, v50
    v_fmac_f32 v20, v44, v50
    v_fmac_f32 v21, v45, v50
    v_fmac_f32 v22, v46, v50
    v_fmac_f32 v23, v47, v50
    s_waitcnt vmcnt(8)
    v_lshlrev_b32 v40, 16, v92
    v_and_b32 v41, 0xffff0000, v92
    v_lshlrev_b32 v42, 16, v93
    v_and_b32 v43, 0xffff0000, v93
    v_lshlrev_b32 v44, 16, v94
    v_and_b32 v45, 0xffff0000, v94
    v_lshlrev_b32 v46, 16, v95
    v_and_b32 v47, 0xffff0000, v95
    v_fmac_f32 v16, v40, v51
    v_fmac_f32 v17, v41, v51
    v_fmac_f32 v18, v42, v51
    v_fmac_f32 v19, v43, v51
    v_fmac_f32 v20, v44, v51
    v_fmac_f32 v21, v45, v51
    v_fmac_f32 v22, v46, v51
    v_fmac_f32 v23, v47, v51
    s_waitcnt vmcnt(7)
    v_dot2_f32_bf16 v28, v96, v24, 0
    v_dot2_f32_bf16 v28, v97, v25, v28
    v_dot2_f32_bf16 v28, v98, v26, v28
    v_dot2_f32_bf16 v28, v99, v27, v28
    s_waitcnt vmcnt(6)
    v_dot2_f32_bf16 v29, v100, v24, 0
    v_dot2_f32_bf16 v29, v101, v25, v29
    v_dot2_f32_bf16 v29, v102, v26, v29
    v_dot2_f32_bf16 v29, v103, v27, v29
    s_waitcnt vmcnt(5)
    v_dot2_f32_bf16 v30, v104, v24, 0
    v_dot2_f32_bf16 v30, v105, v25, v30
    v_dot2_f32_bf16 v30, v106, v26, v30
    v_dot2_f32_bf16 v30, v107, v27, v30
    s_waitcnt vmcnt(4)
    v_dot2_f32_bf16 v31, v108, v24, 0
    v_dot2_f32_bf16 v31, v109, v25, v31
    v_dot2_f32_bf16 v31, v110, v26, v31
    v_dot2_f32_bf16 v31, v111, v27, v31
    s_nop 2
    v_add_f32_dpp v28, v28, v28 row_ror:8 row_mask:0xf bank_mask:0xf
    v_add_f32_dpp v29, v29, v29 row_ror:8 row_mask:0xf bank_mask:0xf
    v_add_f32_dpp v30, v30, v30 row_ror:8 row_mask:0xf bank_mask:0xf
    v_add_f32_dpp v31, v31, v31 row_ror:8 row_mask:0xf bank_mask:0xf
    v_add_f32_dpp v28, v28, v28 row_ror:4 row_mask:0xf bank_mask:0xf
    v_add_f32_dpp v29, v29, v29 row_ror:4 row_mask:0xf bank_mask:0xf
    v_add_f32_dpp v30, v30, v30 row_ror:4 row_mask:0xf bank_mask:0xf
    v_add_f32_dpp v31, v31, v31 row_ror:4 row_mask:0xf bank_mask:0xf
    v_add_f32_dpp v28, v28, v28 row_ror:2 row_mask:0xf bank_mask:0xf
    v_add_f32_dpp v29, v29, v29 row_ror:2 row_mask:0xf bank_mask:0xf
    v_add_f32_dpp v30, v30, v30 row_ror:2 row_mask:0xf bank_mask:0xf
    v_add_f32_dpp v31, v31, v31 row_ror:2 row_mask:0xf bank_mask:0xf
    v_add_f32_dpp v28, v28, v28 row_ror:1 row_mask:0xf bank_mask:0xf
    v_add_f32_dpp v29, v29, v29 row_ror:1 row_mask:0xf bank_mask:0xf
    v_add_f32_dpp v30, v30, v30 row_ror:1 row_mask:0xf bank_mask:0xf
    v_add_f32_dpp v31, v31, v31 row_ror:1 row_mask:0xf bank_mask:0xf
    v_max3_f32 v38, v36, v28, v29
    v_max3_f32 v38, v38, v30, v31
    v_sub_f32 v39, v36, v38
    v_mul_f32 v39, s70, v39
    v_exp_f32 v39, v39
    v_mul_f32 v56, s70, v38
    v_mov_b32 v36, v38
    v_fma_f32 v48, v28, s70, -v56
    v_fma_f32 v49, v29, s70, -v56
    v_fma_f32 v50, v30, s70, -v56
    v_fma_f32 v51, v31, s70, -v56
    v_exp_f32 v48, v48
    v_exp_f32 v49, v49
    v_exp_f32 v50, v50
    v_exp_f32 v51, v51
    v_mul_f32 v37, v37, v39
    v_mul_f32 v16, v16, v39
    v_mul_f32 v17, v17, v39
    v_mul_f32 v18, v18, v39
    v_mul_f32 v19, v19, v39
    v_mul_f32 v20, v20, v39
    v_mul_f32 v21, v21, v39
    v_mul_f32 v22, v22, v39
    v_mul_f32 v23, v23, v39
    v_add_f32 v37, v37, v48
    v_add_f32 v37, v37, v49
    v_add_f32 v37, v37, v50
    v_add_f32 v37, v37, v51
    s_waitcnt vmcnt(3)
    v_lshlrev_b32 v40, 16, v112
    v_and_b32 v41, 0xffff0000, v112
    v_lshlrev_b32 v42, 16, v113
    v_and_b32 v43, 0xffff0000, v113
    v_lshlrev_b32 v44, 16, v114
    v_and_b32 v45, 0xffff0000, v114
    v_lshlrev_b32 v46, 16, v115
    v_and_b32 v47, 0xffff0000, v115
    v_fmac_f32 v16, v40, v48
    v_fmac_f32 v17, v41, v48
    v_fmac_f32 v18, v42, v48
    v_fmac_f32 v19, v43, v48
    v_fmac_f32 v20, v44, v48
    v_fmac_f32 v21, v45, v48
    v_fmac_f32 v22, v46, v48
    v_fmac_f32 v23, v47, v48
    s_waitcnt vmcnt(2)
    v_lshlrev_b32 v40, 16, v116
    v_and_b32 v41, 0xffff0000, v116
    v_lshlrev_b32 v42, 16, v117
    v_and_b32 v43, 0xffff0000, v117
    v_lshlrev_b32 v44, 16, v118
    v_and_b32 v45, 0xffff0000, v118
    v_lshlrev_b32 v46, 16, v119
    v_and_b32 v47, 0xffff0000, v119
    v_fmac_f32 v16, v40, v49
    v_fmac_f32 v17, v41, v49
    v_fmac_f32 v18, v42, v49
    v_fmac_f32 v19, v43, v49
    v_fmac_f32 v20, v44, v49
    v_fmac_f32 v21, v45, v49
    v_fmac_f32 v22, v46, v49
    v_fmac_f32 v23, v47, v49
    s_waitcnt vmcnt(1)
    v_lshlrev_b32 v40, 16, v120
    v_and_b32 v41, 0xffff0000, v120
    v_lshlrev_b32 v42, 16, v121
    v_and_b32 v43, 0xffff0000, v121
    v_lshlrev_b32 v44, 16, v122
    v_and_b32 v45, 0xffff0000, v122
    v_lshlrev_b32 v46, 16, v123
    v_and_b32 v47, 0xffff0000, v123
    v_fmac_f32 v16, v40, v50
    v_fmac_f32 v17, v41, v50
    v_fmac_f32 v18, v42, v50
    v_fmac_f32 v19, v43, v50
    v_fmac_f32 v20, v44, v50
    v_fmac_f32 v21, v45, v50
    v_fmac_f32 v22, v46, v50
    v_fmac_f32 v23, v47, v50
    s_waitcnt vmcnt(0)
    v_lshlrev_b32 v40, 16, v124
    v_and_b32 v41, 0xffff0000, v124
    v_lshlrev_b32 v42, 16, v125
    v_and_b32 v43, 0xffff0000, v125
    v_lshlrev_b32 v44, 16, v126
    v_and_b32 v45, 0xffff0000, v126
    v_lshlrev_b32 v46, 16, v127
    v_and_b32 v47, 0xffff0000, v127
    v_fmac_f32 v16, v40, v51
    v_fmac_f32 v17, v41, v51
    v_fmac_f32 v18, v42, v51
    v_fmac_f32 v19, v43, v51
    v_fmac_f32 v20, v44, v51
    v_fmac_f32 v21, v45, v51
    v_fmac_f32 v22, v46, v51
    v_fmac_f32 v23, v47, v51
    s_branch LBdone_25
LBtail1_41:
    s_waitcnt vmcnt(15)
    v_dot2_f32_bf16 v28, v96, v24, 0
    v_dot2_f32_bf16 v28, v97, v25, v28
    v_dot2_f32_bf16 v28, v98, v26, v28
    v_dot2_f32_bf16 v28, v99, v27, v28
    s_waitcnt vmcnt(14)
    v_dot2_f32_bf16 v29, v100, v24, 0
    v_dot2_f32_bf16 v29, v101, v25, v29
    v_dot2_f32_bf16 v29, v102, v26, v29
    v_dot2_f32_bf16 v29, v103, v27, v29
    s_waitcnt vmcnt(13)
    v_dot2_f32_bf16 v30, v104, v24, 0
    v_dot2_f32_bf16 v30, v105, v25, v30
    v_dot2_f32_bf16 v30, v106, v26, v30
    v_dot2_f32_bf16 v30, v107, v27, v30
    s_waitcnt vmcnt(12)
    v_dot2_f32_bf16 v31, v108, v24, 0
    v_dot2_f32_bf16 v31, v109, v25, v31
    v_dot2_f32_bf16 v31, v110, v26, v31
    v_dot2_f32_bf16 v31, v111, v27, v31
    s_nop 2
    v_add_f32_dpp v28, v28, v28 row_ror:8 row_mask:0xf bank_mask:0xf
    v_add_f32_dpp v29, v29, v29 row_ror:8 row_mask:0xf bank_mask:0xf
    v_add_f32_dpp v30, v30, v30 row_ror:8 row_mask:0xf bank_mask:0xf
    v_add_f32_dpp v31, v31, v31 row_ror:8 row_mask:0xf bank_mask:0xf
    v_add_f32_dpp v28, v28, v28 row_ror:4 row_mask:0xf bank_mask:0xf
    v_add_f32_dpp v29, v29, v29 row_ror:4 row_mask:0xf bank_mask:0xf
    v_add_f32_dpp v30, v30, v30 row_ror:4 row_mask:0xf bank_mask:0xf
    v_add_f32_dpp v31, v31, v31 row_ror:4 row_mask:0xf bank_mask:0xf
    v_add_f32_dpp v28, v28, v28 row_ror:2 row_mask:0xf bank_mask:0xf
    v_add_f32_dpp v29, v29, v29 row_ror:2 row_mask:0xf bank_mask:0xf
    v_add_f32_dpp v30, v30, v30 row_ror:2 row_mask:0xf bank_mask:0xf
    v_add_f32_dpp v31, v31, v31 row_ror:2 row_mask:0xf bank_mask:0xf
    v_add_f32_dpp v28, v28, v28 row_ror:1 row_mask:0xf bank_mask:0xf
    v_add_f32_dpp v29, v29, v29 row_ror:1 row_mask:0xf bank_mask:0xf
    v_add_f32_dpp v30, v30, v30 row_ror:1 row_mask:0xf bank_mask:0xf
    v_add_f32_dpp v31, v31, v31 row_ror:1 row_mask:0xf bank_mask:0xf
    v_max3_f32 v38, v36, v28, v29
    v_max3_f32 v38, v38, v30, v31
    v_sub_f32 v39, v36, v38
    v_mul_f32 v39, s70, v39
    v_exp_f32 v39, v39
    v_mul_f32 v56, s70, v38
    v_mov_b32 v36, v38
    v_fma_f32 v48, v28, s70, -v56
    v_fma_f32 v49, v29, s70, -v56
    v_fma_f32 v50, v30, s70, -v56
    v_fma_f32 v51, v31, s70, -v56
    v_exp_f32 v48, v48
    v_exp_f32 v49, v49
    v_exp_f32 v50, v50
    v_exp_f32 v51, v51
    v_mul_f32 v37, v37, v39
    v_mul_f32 v16, v16, v39
    v_mul_f32 v17, v17, v39
    v_mul_f32 v18, v18, v39
    v_mul_f32 v19, v19, v39
    v_mul_f32 v20, v20, v39
    v_mul_f32 v21, v21, v39
    v_mul_f32 v22, v22, v39
    v_mul_f32 v23, v23, v39
    v_add_f32 v37, v37, v48
    v_add_f32 v37, v37, v49
    v_add_f32 v37, v37, v50
    v_add_f32 v37, v37, v51
    s_waitcnt vmcnt(11)
    v_lshlrev_b32 v40, 16, v112
    v_and_b32 v41, 0xffff0000, v112
    v_lshlrev_b32 v42, 16, v113
    v_and_b32 v43, 0xffff0000, v113
    v_lshlrev_b32 v44, 16, v114
    v_and_b32 v45, 0xffff0000, v114
    v_lshlrev_b32 v46, 16, v115
    v_and_b32 v47, 0xffff0000, v115
    v_fmac_f32 v16, v40, v48
    v_fmac_f32 v17, v41, v48
    v_fmac_f32 v18, v42, v48
    v_fmac_f32 v19, v43, v48
    v_fmac_f32 v20, v44, v48
    v_fmac_f32 v21, v45, v48
    v_fmac_f32 v22, v46, v48
    v_fmac_f32 v23, v47, v48
    s_waitcnt vmcnt(10)
    v_lshlrev_b32 v40, 16, v116
    v_and_b32 v41, 0xffff0000, v116
    v_lshlrev_b32 v42, 16, v117
    v_and_b32 v43, 0xffff0000, v117
    v_lshlrev_b32 v44, 16, v118
    v_and_b32 v45, 0xffff0000, v118
    v_lshlrev_b32 v46, 16, v119
    v_and_b32 v47, 0xffff0000, v119
    v_fmac_f32 v16, v40, v49
    v_fmac_f32 v17, v41, v49
    v_fmac_f32 v18, v42, v49
    v_fmac_f32 v19, v43, v49
    v_fmac_f32 v20, v44, v49
    v_fmac_f32 v21, v45, v49
    v_fmac_f32 v22, v46, v49
    v_fmac_f32 v23, v47, v49
    s_waitcnt vmcnt(9)
    v_lshlrev_b32 v40, 16, v120
    v_and_b32 v41, 0xffff0000, v120
    v_lshlrev_b32 v42, 16, v121
    v_and_b32 v43, 0xffff0000, v121
    v_lshlrev_b32 v44, 16, v122
    v_and_b32 v45, 0xffff0000, v122
    v_lshlrev_b32 v46, 16, v123
    v_and_b32 v47, 0xffff0000, v123
    v_fmac_f32 v16, v40, v50
    v_fmac_f32 v17, v41, v50
    v_fmac_f32 v18, v42, v50
    v_fmac_f32 v19, v43, v50
    v_fmac_f32 v20, v44, v50
    v_fmac_f32 v21, v45, v50
    v_fmac_f32 v22, v46, v50
    v_fmac_f32 v23, v47, v50
    s_waitcnt vmcnt(8)
    v_lshlrev_b32 v40, 16, v124
    v_and_b32 v41, 0xffff0000, v124
    v_lshlrev_b32 v42, 16, v125
    v_and_b32 v43, 0xffff0000, v125
    v_lshlrev_b32 v44, 16, v126
    v_and_b32 v45, 0xffff0000, v126
    v_lshlrev_b32 v46, 16, v127
    v_and_b32 v47, 0xffff0000, v127
    v_fmac_f32 v16, v40, v51
    v_fmac_f32 v17, v41, v51
    v_fmac_f32 v18, v42, v51
    v_fmac_f32 v19, v43, v51
    v_fmac_f32 v20, v44, v51
    v_fmac_f32 v21, v45, v51
    v_fmac_f32 v22, v46, v51
    v_fmac_f32 v23, v47, v51
    s_waitcnt vmcnt(7)
    v_dot2_f32_bf16 v28, v64, v24, 0
    v_dot2_f32_bf16 v28, v65, v25, v28
    v_dot2_f32_bf16 v28, v66, v26, v28
    v_dot2_f32_bf16 v28, v67, v27, v28
    s_waitcnt vmcnt(6)
    v_dot2_f32_bf16 v29, v68, v24, 0
    v_dot2_f32_bf16 v29, v69, v25, v29
    v_dot2_f32_bf16 v29, v70, v26, v29
    v_dot2_f32_bf16 v29, v71, v27, v29
    s_waitcnt vmcnt(5)
    v_dot2_f32_bf16 v30, v72, v24, 0
    v_dot2_f32_bf16 v30, v73, v25, v30
    v_dot2_f32_bf16 v30, v74, v26, v30
    v_dot2_f32_bf16 v30, v75, v27, v30
    s_waitcnt vmcnt(4)
    v_dot2_f32_bf16 v31, v76, v24, 0
    v_dot2_f32_bf16 v31, v77, v25, v31
    v_dot2_f32_bf16 v31, v78, v26, v31
    v_dot2_f32_bf16 v31, v79, v27, v31
    s_nop 2
    v_add_f32_dpp v28, v28, v28 row_ror:8 row_mask:0xf bank_mask:0xf
    v_add_f32_dpp v29, v29, v29 row_ror:8 row_mask:0xf bank_mask:0xf
    v_add_f32_dpp v30, v30, v30 row_ror:8 row_mask:0xf bank_mask:0xf
    v_add_f32_dpp v31, v31, v31 row_ror:8 row_mask:0xf bank_mask:0xf
    v_add_f32_dpp v28, v28, v28 row_ror:4 row_mask:0xf bank_mask:0xf
    v_add_f32_dpp v29, v29, v29 row_ror:4 row_mask:0xf bank_mask:0xf
    v_add_f32_dpp v30, v30, v30 row_ror:4 row_mask:0xf bank_mask:0xf
    v_add_f32_dpp v31, v31, v31 row_ror:4 row_mask:0xf bank_mask:0xf
    v_add_f32_dpp v28, v28, v28 row_ror:2 row_mask:0xf bank_mask:0xf
    v_add_f32_dpp v29, v29, v29 row_ror:2 row_mask:0xf bank_mask:0xf
    v_add_f32_dpp v30, v30, v30 row_ror:2 row_mask:0xf bank_mask:0xf
    v_add_f32_dpp v31, v31, v31 row_ror:2 row_mask:0xf bank_mask:0xf
    v_add_f32_dpp v28, v28, v28 row_ror:1 row_mask:0xf bank_mask:0xf
    v_add_f32_dpp v29, v29, v29 row_ror:1 row_mask:0xf bank_mask:0xf
    v_add_f32_dpp v30, v30, v30 row_ror:1 row_mask:0xf bank_mask:0xf
    v_add_f32_dpp v31, v31, v31 row_ror:1 row_mask:0xf bank_mask:0xf
    v_max3_f32 v38, v36, v28, v29
    v_max3_f32 v38, v38, v30, v31
    v_sub_f32 v39, v36, v38
    v_mul_f32 v39, s70, v39
    v_exp_f32 v39, v39
    v_mul_f32 v56, s70, v38
    v_mov_b32 v36, v38
    v_fma_f32 v48, v28, s70, -v56
    v_fma_f32 v49, v29, s70, -v56
    v_fma_f32 v50, v30, s70, -v56
    v_fma_f32 v51, v31, s70, -v56
    v_exp_f32 v48, v48
    v_exp_f32 v49, v49
    v_exp_f32 v50, v50
    v_exp_f32 v51, v51
    v_mul_f32 v37, v37, v39
    v_mul_f32 v16, v16, v39
    v_mul_f32 v17, v17, v39
    v_mul_f32 v18, v18, v39
    v_mul_f32 v19, v19, v39
    v_mul_f32 v20, v20, v39
    v_mul_f32 v21, v21, v39
    v_mul_f32 v22, v22, v39
    v_mul_f32 v23, v23, v39
    v_add_f32 v37, v37, v48
    v_add_f32 v37, v37, v49
    v_add_f32 v37, v37, v50
    v_add_f32 v37, v37, v51
    s_waitcnt vmcnt(3)
    v_lshlrev_b32 v40, 16, v80
    v_and_b32 v41, 0xffff0000, v80
    v_lshlrev_b32 v42, 16, v81
    v_and_b32 v43, 0xffff0000, v81
    v_lshlrev_b32 v44, 16, v82
    v_and_b32 v45, 0xffff0000, v82
    v_lshlrev_b32 v46, 16, v83
    v_and_b32 v47, 0xffff0000, v83
    v_fmac_f32 v16, v40, v48
    v_fmac_f32 v17, v41, v48
    v_fmac_f32 v18, v42, v48
    v_fmac_f32 v19, v43, v48
    v_fmac_f32 v20, v44, v48
    v_fmac_f32 v21, v45, v48
    v_fmac_f32 v22, v46, v48
    v_fmac_f32 v23, v47, v48
    s_waitcnt vmcnt(2)
    v_lshlrev_b32 v40, 16, v84
    v_and_b32 v41, 0xffff0000, v84
    v_lshlrev_b32 v42, 16, v85
    v_and_b32 v43, 0xffff0000, v85
    v_lshlrev_b32 v44, 16, v86
    v_and_b32 v45, 0xffff0000, v86
    v_lshlrev_b32 v46, 16, v87
    v_and_b32 v47, 0xffff0000, v87
    v_fmac_f32 v16, v40, v49
    v_fmac_f32 v17, v41, v49
    v_fmac_f32 v18, v42, v49
    v_fmac_f32 v19, v43, v49
    v_fmac_f32 v20, v44, v49
    v_fmac_f32 v21, v45, v49
    v_fmac_f32 v22, v46, v49
    v_fmac_f32 v23, v47, v49
    s_waitcnt vmcnt(1)
    v_lshlrev_b32 v40, 16, v88
    v_and_b32 v41, 0xffff0000, v88
    v_lshlrev_b32 v42, 16, v89
    v_and_b32 v43, 0xffff0000, v89
    v_lshlrev_b32 v44, 16, v90
    v_and_b32 v45, 0xffff0000, v90
    v_lshlrev_b32 v46, 16, v91
    v_and_b32 v47, 0xffff0000, v91
    v_fmac_f32 v16, v40, v50
    v_fmac_f32 v17, v41, v50
    v_fmac_f32 v18, v42, v50
    v_fmac_f32 v19, v43, v50
    v_fmac_f32 v20, v44, v50
    v_fmac_f32 v21, v45, v50
    v_fmac_f32 v22, v46, v50
    v_fmac_f32 v23, v47, v50
    s_waitcnt vmcnt(0)
    v_lshlrev_b32 v40, 16, v92
    v_and_b32 v41, 0xffff0000, v92
    v_lshlrev_b32 v42, 16, v93
    v_and_b32 v43, 0xffff0000, v93
    v_lshlrev_b32 v44, 16, v94
    v_and_b32 v45, 0xffff0000, v94
    v_lshlrev_b32 v46, 16, v95
    v_and_b32 v47, 0xffff0000, v95
    v_fmac_f32 v16, v40, v51
    v_fmac_f32 v17, v41, v51
    v_fmac_f32 v18, v42, v51
    v_fmac_f32 v19, v43, v51
    v_fmac_f32 v20, v44, v51
    v_fmac_f32 v21, v45, v51
    v_fmac_f32 v22, v46, v51
    v_fmac_f32 v23, v47, v51
LBdone_25:
    v_mov_b32 v40, 260
    s_mov_b64 exec, 1
    ds_add_u32 v40, v5
    s_mov_b64 exec, -1
    v_mov_b32 v38, v36
    v_mov_b32 v40, v38
    s_nop 1
    v_permlane32_swap_b32 v38, v40
    s_nop 1
    v_max_f32 v38, v38, v40
    v_mov_b32 v40, v38
    s_nop 1
    v_permlane16_swap_b32 v38, v40
    s_nop 1
    v_max_f32 v38, v38, v40
    v_sub_f32 v39, v36, v38
    v_mul_f32 v39, s70, v39
    v_exp_f32 v39, v39
    s_nop 0
    v_mul_f32 v37, v37, v39
    v_mul_f32 v16, v16, v39
    v_mul_f32 v17, v17, v39
    v_mul_f32 v18, v18, v39
    v_mul_f32 v19, v19, v39
    v_mul_f32 v20, v20, v39
    v_mul_f32 v21, v21, v39
    v_mul_f32 v22, v22, v39
    v_mul_f32 v23, v23, v39
    v_mov_b32 v40, v37
    s_nop 1
    v_permlane32_swap_b32 v37, v40
    s_nop 1
    v_add_f32 v37, v37, v40
    v_mov_b32 v40, v37
    s_nop 1
    v_permlane16_swap_b32 v37, v40
    s_nop 1
    v_add_f32 v37, v37, v40
    s_nop 2
    v_permlane32_swap_b32 v16, v20
    v_permlane32_swap_b32 v17, v21
    v_permlane32_swap_b32 v18, v22
    v_permlane32_swap_b32 v19, v23
    s_nop 1
    v_add_f32 v16, v16, v20
    v_add_f32 v17, v17, v21
    v_add_f32 v18, v18, v22
    v_add_f32 v19, v19, v23
    s_nop 1
    v_permlane16_swap_b32 v16, v18
    v_permlane16_swap_b32 v17, v19
    s_nop 1
    v_add_f32 v16, v16, v18
    v_add_f32 v17, v17, v19
    ds_write_b64 v7, v[16:17] offset:4096
    v_mov_b32 v40, v38
    v_mov_b32 v41, v37
    s_lshl_b32 s61, s56, 3
    v_mov_b32 v42, s61
    ds_write_b64 v42, v[40:41] offset:8192
    s_waitcnt lgkmcnt(0)
    s_barrier
    s_cmp_eq_u32 s56, 0
    s_cbranch_scc1 Lw0_48
    s_cmp_ge_u32 s56, 4
    s_cbranch_scc1 Lmm_49
    s_barrier
    s_branch L_end
Lmm_49:
    s_and_b32 s79, s64, 3
    s_lshl_b32 s79, s79, 3
    s_cmp_ge_u32 s64, 4
    s_cselect_b32 s80, 5376, 0
    s_cselect_b32 s62, 0, 1
    s_mul_i32 s62, s62, 3328
    s_add_u32 s80, s80, s62
L_distw:
    v_mov_b32 v43, 98816
    s_mov_b32 s92, 0
Lflg_50:
    ds_read_b32 v40, v43
    s_waitcnt lgkmcnt(0)
    v_readfirstlane_b32 s62, v40
    s_nop 3
    s_cmp_lg_u32 s62, 0
    s_cbranch_scc1 Lflgd_51
    s_sleep 1
    s_add_u32 s92, s92, 1
    s_cmp_lt_u32 s92, 400000
    s_cbranch_scc1 Lflg_50
Lflgd_51:
L_dist:
    v_lshrrev_b32 v40, 2, v3
    v_and_b32 v41, 1, v2
    v_lshl_or_b32 v42, v41, 2, v40
    v_lshlrev_b32 v42, 1, v42
    v_lshl_add_u32 v43, v2, 3, v40
    v_lshlrev_b32 v43, 8, v43
    v_and_b32 v44, 1, v3
    v_lshl_add_u32 v43, v44, 3, v43
    v_add_u32 v43, 65536, v43
    v_bfe_u32 v44, v3, 1, 1
    s_sub_u32 s61, s56, 4
    s_lshl_b32 s61, s61, 1
    s_add_u32 s62, s61, 0
    s_lshl_b32 s62, s62, 1
    v_add_u32 v45, s62, v44
    v_xor_b32 v45, v45, v42
    v_lshl_add_u32 v28, v45, 4, v43
    s_add_u32 s62, s61, 1
    s_lshl_b32 s62, s62, 1
    v_add_u32 v45, s62, v44
    v_xor_b32 v45, v45, v42
    v_lshl_add_u32 v29, v45, 4, v43
    ds_read_b64_tr_b16 v[64:65], v28 offset:0
    ds_read_b64_tr_b16 v[66:67], v28 offset:1024
    ds_read_b64_tr_b16 v[68:69], v28 offset:8192
    ds_read_b64_tr_b16 v[70:71], v28 offset:9216
    ds_read_b64_tr_b16 v[72:73], v28 offset:16384
    ds_read_b64_tr_b16 v[74:75], v28 offset:17408
    ds_read_b64_tr_b16 v[76:77], v28 offset:24576
    ds_read_b64_tr_b16 v[78:79], v28 offset:25600
    ds_read_b64_tr_b16 v[80:81], v29 offset:0
    ds_read_b64_tr_b16 v[82:83], v29 offset:1024
    ds_read_b64_tr_b16 v[84:85], v29 offset:8192
    ds_read_b64_tr_b16 v[86:87], v29 offset:9216
    ds_read_b64_tr_b16 v[88:89], v29 offset:16384
    ds_read_b64_tr_b16 v[90:91], v29 offset:17408
    ds_read_b64_tr_b16 v[92:93], v29 offset:24576
    ds_read_b64_tr_b16 v[94:95], v29 offset:25600
    v_and_b32 v40, 1, v3
    v_lshlrev_b32 v40, 8, v40
    v_lshl_add_u32 v40, v2, 4, v40
    v_add_u32 v40, 98304, v40
    v_lshlrev_b32 v41, 19, v3
    v_lshl_add_u32 v41, v2, 4, v41
    s_add_u32 s61, s61, s79
    s_mul_i32 s61, s61, 16384
    s_lshl_b32 s62, s65, 6
    s_add_u32 s61, s61, s62
    s_add_u32 s61, s61, s80
    s_add_u32 s62, s61, 16384
    s_waitcnt lgkmcnt(0)
    s_barrier
    ds_read_b128 v[128:131], v40 offset:0
    ds_read_b128 v[132:135], v40 offset:64
    ds_read_b128 v[136:139], v40 offset:128
    ds_read_b128 v[140:143], v40 offset:192
    s_waitcnt lgkmcnt(3)
    v_mfma_f32_16x16x32_bf16 v[144:147], v[64:67], v[128:131], 0
    v_mfma_f32_16x16x32_bf16 v[148:151], v[80:83], v[128:131], 0
    s_waitcnt lgkmcnt(2)
    v_mfma_f32_16x16x32_bf16 v[144:147], v[68:71], v[132:135], v[144:147]
    v_mfma_f32_16x16x32_bf16 v[148:151], v[84:87], v[132:135], v[148:151]
    s_waitcnt lgkmcnt(1)
    v_mfma_f32_16x16x32_bf16 v[144:147], v[72:75], v[136:139], v[144:147]
    v_mfma_f32_16x16x32_bf16 v[148:151], v[88:91], v[136:139], v[148:151]
    s_waitcnt lgkmcnt(0)
    v_mfma_f32_16x16x32_bf16 v[144:147], v[76:79], v[140:143], v[144:147]
    v_mfma_f32_16x16x32_bf16 v[148:151], v[92:95], v[140:143], v[148:151]
    s_mov_b32 exec_lo, 0x00030003
    s_mov_b32 exec_hi, 0x00030003
    s_nop 4
    buffer_store_dwordx4 v[144:147], v41, s[32:35], s61 offen sc0 sc1
    s_nop 0
    buffer_store_dwordx4 v[148:151], v41, s[32:35], s62 offen sc0 sc1
    s_mov_b64 exec, -1
    s_branch L_end
Lw0_48:
    v_mov_b32 v42, 0
    ds_read_b128 v[28:31], v42 offset:8192
    ds_read_b128 v[32:35], v42 offset:8208
    ds_read_b128 v[48:51], v42 offset:8224
    ds_read_b128 v[52:55], v42 offset:8240
    v_and_b32 v43, 31, v1
    v_lshlrev_b32 v43, 4, v43
    ds_read_b128 v[64:67], v43 offset:4096
    ds_read_b128 v[68:71], v43 offset:4608
    ds_read_b128 v[72:75], v43 offset:5120
    ds_read_b128 v[76:79], v43 offset:5632
    ds_read_b128 v[80:83], v43 offset:6144
    ds_read_b128 v[84:87], v43 offset:6656
    ds_read_b128 v[88:91], v43 offset:7168
    ds_read_b128 v[92:95], v43 offset:7680
    s_waitcnt lgkmcnt(8)
    v_max3_f32 v38, v28, v30, v32
    v_max3_f32 v38, v38, v34, v48
    v_max3_f32 v38, v38, v50, v52
    v_max_f32 v38, v38, v54
    v_mul_f32 v56, s70, v38
    v_fma_f32 v28, v28, s70, -v56
    v_fma_f32 v30, v30, s70, -v56
    v_fma_f32 v32, v32, s70, -v56
    v_fma_f32 v34, v34, s70, -v56
    v_fma_f32 v48, v48, s70, -v56
    v_fma_f32 v50, v50, s70, -v56
    v_fma_f32 v52, v52, s70, -v56
    v_fma_f32 v54, v54, s70, -v56
    v_exp_f32 v28, v28
    v_exp_f32 v30, v30
    v_exp_f32 v32, v32
    v_exp_f32 v34, v34
    v_exp_f32 v48, v48
    v_exp_f32 v50, v50
    v_exp_f32 v52, v52
    v_exp_f32 v54, v54
    s_nop 0
    v_mul_f32 v37, v28, v29
    v_fmac_f32 v37, v30, v31
    v_fmac_f32 v37, v32, v33
    v_fmac_f32 v37, v34, v35
    v_fmac_f32 v37, v48, v49
    v_fmac_f32 v37, v50, v51
    v_fmac_f32 v37, v52, v53
    v_fmac_f32 v37, v54, v55
    s_waitcnt lgkmcnt(0)
    v_mul_f32 v40, v64, v28
    v_mul_f32 v41, v65, v28
    v_mul_f32 v42, v66, v28
    v_mul_f32 v43, v67, v28
    v_fmac_f32 v40, v68, v30
    v_fmac_f32 v41, v69, v30
    v_fmac_f32 v42, v70, v30
    v_fmac_f32 v43, v71, v30
    v_fmac_f32 v40, v72, v32
    v_fmac_f32 v41, v73, v32
    v_fmac_f32 v42, v74, v32
    v_fmac_f32 v43, v75, v32
    v_fmac_f32 v40, v76, v34
    v_fmac_f32 v41, v77, v34
    v_fmac_f32 v42, v78, v34
    v_fmac_f32 v43, v79, v34
    v_fmac_f32 v40, v80, v48
    v_fmac_f32 v41, v81, v48
    v_fmac_f32 v42, v82, v48
    v_fmac_f32 v43, v83, v48
    v_fmac_f32 v40, v84, v50
    v_fmac_f32 v41, v85, v50
    v_fmac_f32 v42, v86, v50
    v_fmac_f32 v43, v87, v50
    v_fmac_f32 v40, v88, v52
    v_fmac_f32 v41, v89, v52
    v_fmac_f32 v42, v90, v52
    v_fmac_f32 v43, v91, v52
    v_fmac_f32 v40, v92, v54
    v_fmac_f32 v41, v93, v54
    v_fmac_f32 v42, v94, v54
    v_fmac_f32 v43, v95, v54
    v_cmp_eq_u32 vcc, 32, v1
    v_mov_b32 v45, 0
    s_nop 0
    v_cndmask_b32 v40, v40, v38, vcc
    v_cndmask_b32 v41, v41, v37, vcc
    v_cndmask_b32 v42, v42, v45, vcc
    v_cndmask_b32 v43, v43, v45, vcc
    v_lshlrev_b32 v44, 4, v1
    s_lshl_b32 s61, s64, 9
    s_add_u32 s61, s61, 256
    v_add_u32 v44, s61, v44
    s_lshl_b32 s61, s64, 4
    s_add_u32 s61, s61, 128
    v_mov_b32 v46, s61
    v_cndmask_b32 v44, v44, v46, vcc
    s_add_u32 s61, s65, 32
    s_mul_i32 s61, s61, 16384
    s_mov_b32 exec_lo, -1
    s_mov_b32 exec_hi, 1
    buffer_store_dwordx4 v[40:43], v44, s[32:35], s61 offen sc0 sc1
    s_mov_b64 exec, -1
    s_cmp_ge_u32 s64, 4
    s_cbranch_scc1 Lb2_52
    v_lshrrev_b32 v40, 5, v1
    v_mul_u32_u24 v41, 1536, v40
    v_and_b32 v42, 31, v1
    v_lshl_add_u32 v41, v42, 4, v41
    v_mul_u32_u24 v43, 48, v40
    v_lshlrev_b32 v46, 3, v1
    s_mov_b32 s92, 0
    buffer_load_dwordx4 v[64:67], v41, s[32:35], s61 offen offset:256 sc0 sc1
    buffer_load_dwordx2 v[76:77], v43, s[32:35], s61 offen offset:128 sc0 sc1
    buffer_load_dwordx4 v[68:71], v41, s[32:35], s61 offen offset:768 sc0 sc1
    buffer_load_dwordx2 v[78:79], v43, s[32:35], s61 offen offset:144 sc0 sc1
    buffer_load_dwordx4 v[72:75], v41, s[32:35], s61 offen offset:1280 sc0 sc1
    buffer_load_dwordx2 v[80:81], v43, s[32:35], s61 offen offset:160 sc0 sc1
Lp2_53:
    buffer_load_dwordx4 v[84:87], v41, s[32:35], s61 offen offset:256 sc0 sc1
    buffer_load_dwordx2 v[96:97], v43, s[32:35], s61 offen offset:128 sc0 sc1
    buffer_load_dwordx4 v[88:91], v41, s[32:35], s61 offen offset:768 sc0 sc1
    buffer_load_dwordx2 v[98:99], v43, s[32:35], s61 offen offset:144 sc0 sc1
    buffer_load_dwordx4 v[92:95], v41, s[32:35], s61 offen offset:1280 sc0 sc1
    buffer_load_dwordx2 v[100:101], v43, s[32:35], s61 offen offset:160 sc0 sc1
    s_waitcnt vmcnt(6)
    v_mov_b32 v45, v64
    v_max3_u32 v45, v45, v65, v66
    v_max3_u32 v45, v45, v67, v68
    v_max3_u32 v45, v45, v69, v70
    v_max3_u32 v45, v45, v71, v72
    v_max3_u32 v45, v45, v73, v74
    v_max3_u32 v45, v45, v75, v76
    v_max3_u32 v45, v45, v77, v78
    v_max3_u32 v45, v45, v79, v80
    v_max_u32 v45, v45, v81
    v_cmp_eq_u32 vcc, -1, v45
    s_cbranch_vccz Lp2A_54
    buffer_load_dwordx4 v[64:67], v41, s[32:35], s61 offen offset:256 sc0 sc1
    buffer_load_dwordx2 v[76:77], v43, s[32:35], s61 offen offset:128 sc0 sc1
    buffer_load_dwordx4 v[68:71], v41, s[32:35], s61 offen offset:768 sc0 sc1
    buffer_load_dwordx2 v[78:79], v43, s[32:35], s61 offen offset:144 sc0 sc1
    buffer_load_dwordx4 v[72:75], v41, s[32:35], s61 offen offset:1280 sc0 sc1
    buffer_load_dwordx2 v[80:81], v43, s[32:35], s61 offen offset:160 sc0 sc1
    s_waitcnt vmcnt(6)
    v_mov_b32 v45, v84
    v_max3_u32 v45, v45, v85, v86
    v_max3_u32 v45, v45, v87, v88
    v_max3_u32 v45, v45, v89, v90
    v_max3_u32 v45, v45, v91, v92
    v_max3_u32 v45, v45, v93, v94
    v_max3_u32 v45, v45, v95, v96
    v_max3_u32 v45, v45, v97, v98
    v_max3_u32 v45, v45, v99, v100
    v_max_u32 v45, v45, v101
    v_cmp_eq_u32 vcc, -1, v45
    s_cbranch_vccz Lp2B_55
    s_add_u32 s92, s92, 1
    s_cmp_lt_u32 s92, 400000
    s_cbranch_scc1 Lp2_53
Lp2B_55:
    s_waitcnt vmcnt(0)
    v_mov_b32 v64, v84
    v_mov_b32 v65, v85
    v_mov_b32 v66, v86
    v_mov_b32 v67, v87
    v_mov_b32 v68, v88
    v_mov_b32 v69, v89
    v_mov_b32 v70, v90
    v_mov_b32 v71, v91
    v_mov_b32 v72, v92
    v_mov_b32 v73, v93
    v_mov_b32 v74, v94
    v_mov_b32 v75, v95
    v_mov_b32 v76, v96
    v_mov_b32 v77, v97
    v_mov_b32 v78, v98
    v_mov_b32 v79, v99
    v_mov_b32 v80, v100
    v_mov_b32 v81, v101
    s_branch Lp2D_56
Lp2A_54:
Lp2D_56:
    v_max3_f32 v45, v76, v78, v80
    v_mul_f32 v44, s70, v45
    v_fma_f32 v76, v76, s70, -v44
    v_fma_f32 v78, v78, s70, -v44
    v_fma_f32 v80, v80, s70, -v44
    v_exp_f32 v76, v76
    v_exp_f32 v78, v78
    v_exp_f32 v80, v80
    s_nop 0
    v_mul_f32 v45, v76, v77
    v_fmac_f32 v45, v78, v79
    v_fmac_f32 v45, v80, v81
    v_rcp_f32 v45, v45
    v_mul_f32 v64, v64, v76
    v_mul_f32 v65, v65, v76
    v_mul_f32 v66, v66, v76
    v_mul_f32 v67, v67, v76
    v_fmac_f32 v64, v68, v78
    v_fmac_f32 v65, v69, v78
    v_fmac_f32 v66, v70, v78
    v_fmac_f32 v67, v71, v78
    v_fmac_f32 v64, v72, v80
    v_fmac_f32 v65, v73, v80
    v_fmac_f32 v66, v74, v80
    v_fmac_f32 v67, v75, v80
    v_mul_f32 v64, v64, v45
    v_mul_f32 v65, v65, v45
    v_mul_f32 v66, v66, v45
    v_mul_f32 v67, v67, v45
    v_cvt_pk_bf16_f32 v64, v64, v65
    v_cvt_pk_bf16_f32 v65, v66, v67
    v_add_u32 v46, 98304, v46
    ds_write_b64 v46, v[64:65]
    s_waitcnt lgkmcnt(0)
Lb2_52:
    s_barrier
    s_branch L_end
L_roleA:
    s_and_b32 s60, s57, 3
    s_lshr_b32 s59, s57, 2
    s_lshl_b32 s59, s59, 5
    s_lshl_b32 s75, s58, 2
    s_add_u32 s75, s75, s60
    s_add_u32 s75, s75, s59
    s_waitcnt lgkmcnt(0)
    s_mov_b32 s32, s30
    s_and_b32 s33, s31, 0xffff
    s_mov_b32 s34, 268435456
    s_mov_b32 s35, 0x00020000
    s_mov_b32 s52, s28
    s_and_b32 s53, s29, 0xffff
    s_mov_b32 s54, 256
    s_mov_b32 s55, 0x00020000
    v_and_b32 v1, 63, v0
    v_lshrrev_b32 v2, 4, v1
    v_and_b32 v3, 15, v1
    v_lshlrev_b32 v5, 4, v1
    v_lshlrev_b32 v4, 17, v2
    v_lshl_add_u32 v4, v3, 4, v4
    s_mov_b32 s68, 0x05040100
    s_mov_b32 s69, 0x07060302
    s_mul_i32 s93, s75, 16384
    v_mov_b32 v40, -1
    v_mov_b32 v41, -1
    v_mov_b32 v42, -1
    v_mov_b32 v43, -1
    s_cmp_lg_u32 s57, 0
    s_cbranch_scc1 Lcq_57
    v_lshlrev_b32 v45, 4, v0
    s_lshl_b32 s61, s75, 11
    s_add_u32 s61, s61, 1310720
    buffer_store_dwordx4 v[40:43], v45, s[32:35], s61 offen sc0 sc1
    s_add_u32 s61, s61, 65536
    buffer_store_dwordx4 v[40:43], v45, s[32:35], s61 offen sc0 sc1
    s_waitcnt vmcnt(0)
    s_barrier
    s_cmp_lg_u32 s56, 7
    s_cbranch_scc1 Lcq_57
    v_mov_b32 v45, 1
    v_mov_b32 v46, 0
    s_mov_b64 s[94:95], exec
    s_mov_b64 exec, 1
    buffer_atomic_add v45, v46, s[52:55], s75 offen offset:0 sc1
    s_mov_b64 exec, s[94:95]
Lcq_57:
    v_lshlrev_b32 v44, 4, v0
    v_cmp_gt_u32 vcc, 7936, v44
    s_and_saveexec_b64 s[94:95], vcc
    s_cbranch_execz Lci_58
    buffer_store_dwordx4 v[40:43], v44, s[32:35], s93 offen sc0 sc1
Lci_58:
    s_mov_b64 exec, s[94:95]
    s_cmp_lg_u32 s56, 5
    s_cbranch_scc1 Lcq_59
    v_mov_b32 v46, 0
    v_mov_b32 v47, 65536
    s_lshl_b32 s61, s75, 8
    s_add_u32 s61, s61, 1507328
    s_mov_b64 s[94:95], exec
    s_mov_b64 exec, 1
    buffer_store_dword v47, v46, s[32:35], s61 offen sc0 sc1
    s_mov_b64 exec, s[94:95]
Lcq_59:
    s_cmp_lg_u32 s56, 6
    s_cbranch_scc1 Lcq_60
    s_lshl_b32 s61, s75, 10
    s_add_u32 s61, s61, 1146880
    buffer_store_dwordx4 v[40:43], v5, s[32:35], s61 offen sc0 sc1
Lcq_60:
    s_cmp_eq_u32 s78, 0
    s_cselect_b32 s36, s8, s22
    s_cselect_b32 s37, s9, s23
    s_cselect_b32 s40, s4, s16
    s_cselect_b32 s41, s5, s17
    s_and_b32 s37, s37, 0xffff
    buffer_load_dwordx4 v[192:195], v232, s[36:39], s77 offen nt
    s_add_u32 s77, s77, 8192
    buffer_load_dwordx4 v[196:199], v232, s[36:39], s77 offen nt
    s_add_u32 s77, s77, 8192
    buffer_load_dwordx4 v[200:203], v232, s[36:39], s77 offen nt
    s_add_u32 s77, s77, 8192
    buffer_load_dwordx4 v[204:207], v232, s[36:39], s77 offen nt
    s_and_b32 s41, s41, 0xffff
    s_mov_b32 s42, 2048
    s_mov_b32 s43, 0x00020000
    v_lshlrev_b32 v231, 3, v229
    buffer_load_dwordx2 v[208:209], v231, s[40:43], s76 offen offset:0
    buffer_load_dwordx2 v[210:211], v231, s[40:43], s76 offen offset:1024
    s_lshl_b32 s3, s78, 5
    s_add_u32 s3, s3, s86
    s_lshl_b32 s3, s3, 2
    s_add_u32 s3, s3, s88
    s_lshl_b32 s3, s3, 1
    s_add_u32 s3, s3, s87
    s_lshl_b32 s3, s3, 8
    s_add_u32 s3, s3, 1310720
    s_and_b32 s91, s86, 0xfc
    s_mov_b32 s68, 0x05040100
    s_mov_b32 s69, 0x07060302
    s_cmp_lt_u32 s75, 32
    s_cbranch_scc1 L_roleT1
    s_sub_u32 s65, s75, 32
    s_waitcnt vmcnt(0)
    s_barrier
    s_cmp_lg_u32 s56, 1
    s_cbranch_scc1 Lsc_61
    v_mov_b32 v40, 1
    v_mov_b32 v41, 0
    s_mov_b64 s[94:95], exec
    s_mov_b64 exec, 1
    buffer_atomic_add v40, v41, s[52:55], 0 offen offset:128 sc1
    s_mov_b64 exec, s[94:95]
Lsc_61:
    s_lshl_b32 s61, s65, 18
    s_add_u32 s44, s6, s61
    s_addc_u32 s45, s7, 0
    s_and_b32 s45, s45, 0xffff
    s_mov_b32 s46, 262144
    s_mov_b32 s47, 0x00020000
    s_waitcnt vmcnt(0)
    v_perm_b32 v232, v196, v192, s68
    v_perm_b32 v233, v196, v192, s69
    v_perm_b32 v234, v197, v193, s68
    v_perm_b32 v235, v197, v193, s69
    v_perm_b32 v236, v198, v194, s68
    v_perm_b32 v237, v198, v194, s69
    v_perm_b32 v238, v199, v195, s68
    v_perm_b32 v239, v199, v195, s69
    v_dot2_f32_bf16 v212, v232, v208, 0
    v_dot2_f32_bf16 v213, v233, v208, 0
    v_dot2_f32_bf16 v214, v234, v208, 0
    v_dot2_f32_bf16 v215, v235, v208, 0
    v_dot2_f32_bf16 v216, v236, v208, 0
    v_dot2_f32_bf16 v217, v237, v208, 0
    v_dot2_f32_bf16 v218, v238, v208, 0
    v_dot2_f32_bf16 v219, v239, v208, 0
    v_dot2_f32_bf16 v220, v232, v210, 0
    v_dot2_f32_bf16 v221, v233, v210, 0
    v_dot2_f32_bf16 v222, v234, v210, 0
    v_dot2_f32_bf16 v223, v235, v210, 0
    v_dot2_f32_bf16 v224, v236, v210, 0
    v_dot2_f32_bf16 v225, v237, v210, 0
    v_dot2_f32_bf16 v226, v238, v210, 0
    v_dot2_f32_bf16 v227, v239, v210, 0
    v_perm_b32 v232, v204, v200, s68
    v_perm_b32 v233, v204, v200, s69
    v_perm_b32 v234, v205, v201, s68
    v_perm_b32 v235, v205, v201, s69
    v_perm_b32 v236, v206, v202, s68
    v_perm_b32 v237, v206, v202, s69
    v_perm_b32 v238, v207, v203, s68
    v_perm_b32 v239, v207, v203, s69
    v_dot2_f32_bf16 v212, v232, v209, v212
    v_dot2_f32_bf16 v213, v233, v209, v213
    v_dot2_f32_bf16 v214, v234, v209, v214
    v_dot2_f32_bf16 v215, v235, v209, v215
    v_dot2_f32_bf16 v216, v236, v209, v216
    v_dot2_f32_bf16 v217, v237, v209, v217
    v_dot2_f32_bf16 v218, v238, v209, v218
    v_dot2_f32_bf16 v219, v239, v209, v219
    v_dot2_f32_bf16 v220, v232, v211, v220
    v_dot2_f32_bf16 v221, v233, v211, v221
    v_dot2_f32_bf16 v222, v234, v211, v222
    v_dot2_f32_bf16 v223, v235, v211, v223
    v_dot2_f32_bf16 v224, v236, v211, v224
    v_dot2_f32_bf16 v225, v237, v211, v225
    v_dot2_f32_bf16 v226, v238, v211, v226
    v_dot2_f32_bf16 v227, v239, v211, v227
    s_nop 2
    v_permlane32_swap_b32 v212, v220
    v_permlane32_swap_b32 v213, v221
    v_permlane32_swap_b32 v214, v222
    v_permlane32_swap_b32 v215, v223
    v_permlane32_swap_b32 v216, v224
    v_permlane32_swap_b32 v217, v225
    v_permlane32_swap_b32 v218, v226
    v_permlane32_swap_b32 v219, v227
    s_nop 1
    v_add_f32 v212, v212, v220
    v_add_f32 v213, v213, v221
    v_add_f32 v214, v214, v222
    v_add_f32 v215, v215, v223
    v_add_f32 v216, v216, v224
    v_add_f32 v217, v217, v225
    v_add_f32 v218, v218, v226
    v_add_f32 v219, v219, v227
    s_nop 1
    v_permlane16_swap_b32 v212, v216
    v_permlane16_swap_b32 v213, v217
    v_permlane16_swap_b32 v214, v218
    v_permlane16_swap_b32 v215, v219
    s_nop 1
    v_add_f32 v212, v212, v216
    v_add_f32 v213, v213, v217
    v_add_f32 v214, v214, v218
    v_add_f32 v215, v215, v219
    s_nop 1
    v_add_f32_dpp v212, v212, v212 row_ror:8 row_mask:0xf bank_mask:0xf
    v_add_f32_dpp v213, v213, v213 row_ror:8 row_mask:0xf bank_mask:0xf
    v_add_f32_dpp v214, v214, v214 row_ror:8 row_mask:0xf bank_mask:0xf
    v_add_f32_dpp v215, v215, v215 row_ror:8 row_mask:0xf bank_mask:0xf
    v_lshrrev_b32 v232, 5, v228
    v_lshlrev_b32 v232, 8, v232
    v_bfe_u32 v233, v228, 4, 1
    v_lshl_add_u32 v232, v233, 4, v232
    v_lshl_add_u32 v232, v230, 5, v232
    s_lshl_b32 s61, s56, 9
    s_add_u32 s61, s61, 147456
    v_add_u32 v232, s61, v232
    ds_write_b128 v232, v[212:215]
    s_waitcnt lgkmcnt(0)
    s_barrier
    s_cmp_lg_u32 s56, 0
    s_cbranch_scc1 Ls1p_62
    v_mov_b32 v234, 0
    buffer_load_dword v235, v234, s[52:55], s91 offen offset:0 sc0 sc1
    v_and_b32 v232, 31, v228
    v_lshlrev_b32 v233, 4, v232
    v_add_u32 v233, 147456, v233
    ds_read_b128 v[192:195], v233 offset:0
    ds_read_b128 v[196:199], v233 offset:512
    ds_read_b128 v[200:203], v233 offset:1024
    ds_read_b128 v[204:207], v233 offset:1536
    ds_read_b128 v[208:211], v233 offset:2048
    ds_read_b128 v[212:215], v233 offset:2560
    ds_read_b128 v[216:219], v233 offset:3072
    ds_read_b128 v[220:223], v233 offset:3584
    s_waitcnt lgkmcnt(6)
    v_add_f32 v192, v192, v196
    v_add_f32 v193, v193, v197
    v_add_f32 v194, v194, v198
    v_add_f32 v195, v195, v199
    s_waitcnt lgkmcnt(5)
    v_add_f32 v192, v192, v200
    v_add_f32 v193, v193, v201
    v_add_f32 v194, v194, v202
    v_add_f32 v195, v195, v203
    s_waitcnt lgkmcnt(4)
    v_add_f32 v192, v192, v204
    v_add_f32 v193, v193, v205
    v_add_f32 v194, v194, v206
    v_add_f32 v195, v195, v207
    s_waitcnt lgkmcnt(3)
    v_add_f32 v192, v192, v208
    v_add_f32 v193, v193, v209
    v_add_f32 v194, v194, v210
    v_add_f32 v195, v195, v211
    s_waitcnt lgkmcnt(2)
    v_add_f32 v192, v192, v212
    v_add_f32 v193, v193, v213
    v_add_f32 v194, v194, v214
    v_add_f32 v195, v195, v215
    s_waitcnt lgkmcnt(1)
    v_add_f32 v192, v192, v216
    v_add_f32 v193, v193, v217
    v_add_f32 v194, v194, v218
    v_add_f32 v195, v195, v219
    s_waitcnt lgkmcnt(0)
    v_add_f32 v192, v192, v220
    v_add_f32 v193, v193, v221
    v_add_f32 v194, v194, v222
    v_add_f32 v195, v195, v223
    v_lshrrev_b32 v233, 4, v232
    v_lshlrev_b32 v233, 10, v233
    v_and_b32 v232, 15, v232
    v_lshl_add_u32 v233, v232, 4, v233
    s_waitcnt vmcnt(0)
    s_mov_b32 s92, 0
Lcf_63:
    v_readfirstlane_b32 s57, v235
    s_nop 3
    s_cmp_lg_u32 s57, 0
    s_cbranch_scc1 Lcfd_64
    s_sleep 2
    buffer_load_dword v235, v234, s[52:55], s91 offen offset:0 sc0 sc1
    s_waitcnt vmcnt(0)
    s_add_u32 s92, s92, 1
    s_cmp_lt_u32 s92, 400000
    s_cbranch_scc1 Lcf_63
Lcfd_64:
    s_mov_b64 exec, 0xffffffff
    buffer_store_dwordx4 v[192:195], v233, s[32:35], s3 offen sc0 sc1
    s_mov_b64 exec, -1
Ls1p_62:
    s_lshl_b32 s61, s56, 14
    s_add_u32 m0, s61, 0
    v_xor_b32 v52, 0, v5
    s_add_u32 s62, s61, 0
    buffer_load_dwordx4 v52, s[44:47], s62 offen nt lds
    s_add_u32 m0, s61, 1024
    v_xor_b32 v53, 64, v5
    s_add_u32 s62, s61, 1024
    buffer_load_dwordx4 v53, s[44:47], s62 offen nt lds
    s_add_u32 m0, s61, 2048
    v_xor_b32 v52, 128, v5
    s_add_u32 s62, s61, 2048
    buffer_load_dwordx4 v52, s[44:47], s62 offen nt lds
    s_add_u32 m0, s61, 3072
    v_xor_b32 v53, 192, v5
    s_add_u32 s62, s61, 3072
    buffer_load_dwordx4 v53, s[44:47], s62 offen nt lds
    s_add_u32 m0, s61, 4096
    v_xor_b32 v52, 0, v5
    s_add_u32 s62, s61, 4096
    buffer_load_dwordx4 v52, s[44:47], s62 offen nt lds
    s_add_u32 m0, s61, 5120
    v_xor_b32 v53, 64, v5
    s_add_u32 s62, s61, 5120
    buffer_load_dwordx4 v53, s[44:47], s62 offen nt lds
    s_add_u32 m0, s61, 6144
    v_xor_b32 v52, 128, v5
    s_add_u32 s62, s61, 6144
    buffer_load_dwordx4 v52, s[44:47], s62 offen nt lds
    s_add_u32 m0, s61, 7168
    v_xor_b32 v53, 192, v5
    s_add_u32 s62, s61, 7168
    buffer_load_dwordx4 v53, s[44:47], s62 offen nt lds
    s_add_u32 m0, s61, 8192
    v_xor_b32 v52, 32, v5
    s_add_u32 s62, s61, 8192
    buffer_load_dwordx4 v52, s[44:47], s62 offen nt lds
    s_add_u32 m0, s61, 9216
    v_xor_b32 v53, 96, v5
    s_add_u32 s62, s61, 9216
    buffer_load_dwordx4 v53, s[44:47], s62 offen nt lds
    s_add_u32 m0, s61, 10240
    v_xor_b32 v52, 160, v5
    s_add_u32 s62, s61, 10240
    buffer_load_dwordx4 v52, s[44:47], s62 offen nt lds
    s_add_u32 m0, s61, 11264
    v_xor_b32 v53, 224, v5
    s_add_u32 s62, s61, 11264
    buffer_load_dwordx4 v53, s[44:47], s62 offen nt lds
    s_add_u32 m0, s61, 12288
    v_xor_b32 v52, 32, v5
    s_add_u32 s62, s61, 12288
    buffer_load_dwordx4 v52, s[44:47], s62 offen nt lds
    s_add_u32 m0, s61, 13312
    v_xor_b32 v53, 96, v5
    s_add_u32 s62, s61, 13312
    buffer_load_dwordx4 v53, s[44:47], s62 offen nt lds
    s_add_u32 m0, s61, 14336
    v_xor_b32 v52, 160, v5
    s_add_u32 s62, s61, 14336
    buffer_load_dwordx4 v52, s[44:47], s62 offen nt lds
    s_add_u32 m0, s61, 15360
    v_xor_b32 v53, 224, v5
    s_add_u32 s62, s61, 15360
    buffer_load_dwordx4 v53, s[44:47], s62 offen nt lds
    s_barrier
    s_lshr_b32 s66, s65, 4
    s_and_b32 s67, s65, 15
    s_and_b32 s63, s56, 3
    s_lshr_b32 s64, s56, 2
    v_and_b32 v40, 3, v3
    v_lshlrev_b32 v40, 2, v40
    v_lshrrev_b32 v41, 3, v3
    v_lshl_or_b32 v40, v41, 1, v40
    s_lshl_b32 s61, s63, 15
    v_lshlrev_b32 v41, 10, v3
    v_add_u32 v41, s61, v41
    v_add_u32 v42, 0, v2
    v_xor_b32 v42, v42, v40
    v_lshl_add_u32 v8, v42, 4, v41
    v_add_u32 v42, 4, v2
    v_xor_b32 v42, v42, v40
    v_lshl_add_u32 v9, v42, 4, v41
    v_add_u32 v42, 8, v2
    v_xor_b32 v42, v42, v40
    v_lshl_add_u32 v10, v42, 4, v41
    v_add_u32 v42, 12, v2
    v_xor_b32 v42, v42, v40
    v_lshl_add_u32 v11, v42, 4, v41
    s_lshl_b32 s61, s64, 14
    s_add_u32 s61, s61, 131072
    s_lshl_b32 s62, s63, 15
    s_sub_u32 s61, s61, s62
    v_lshrrev_b32 v43, 1, v2
    v_and_b32 v44, 1, v2
    v_lshrrev_b32 v45, 2, v3
    v_lshl_add_u32 v46, v43, 3, v45
    v_lshlrev_b32 v47, 2, v45
    v_lshl_or_b32 v47, v43, 1, v47
    v_bfe_u32 v48, v3, 1, 1
    v_lshl_add_u32 v48, v44, 1, v48
    s_lshl_b32 s62, s56, 3
    s_add_u32 s62, s62, 0
    v_add_u32 v48, s62, v48
    v_xor_b32 v48, v48, v47
    v_lshlrev_b32 v48, 4, v48
    v_lshl_add_u32 v48, v46, 10, v48
    v_and_b32 v49, 1, v3
    v_lshl_add_u32 v12, v49, 3, v48
    v_bfe_u32 v48, v3, 1, 1
    v_lshl_add_u32 v48, v44, 1, v48
    s_lshl_b32 s62, s56, 3
    s_add_u32 s62, s62, 4
    v_add_u32 v48, s62, v48
    v_xor_b32 v48, v48, v47
    v_lshlrev_b32 v48, 4, v48
    v_lshl_add_u32 v48, v46, 10, v48
    v_and_b32 v49, 1, v3
    v_lshl_add_u32 v13, v49, 3, v48
    v_lshl_add_u32 v46, v43, 3, v45
    v_add_u32 v46, 4, v46
    v_lshlrev_b32 v47, 2, v45
    v_lshl_or_b32 v47, v43, 1, v47
    v_bfe_u32 v48, v3, 1, 1
    v_lshl_add_u32 v48, v44, 1, v48
    s_lshl_b32 s62, s56, 3
    s_add_u32 s62, s62, 0
    v_add_u32 v48, s62, v48
    v_xor_b32 v48, v48, v47
    v_lshlrev_b32 v48, 4, v48
    v_lshl_add_u32 v48, v46, 10, v48
    v_and_b32 v49, 1, v3
    v_lshl_add_u32 v14, v49, 3, v48
    v_bfe_u32 v48, v3, 1, 1
    v_lshl_add_u32 v48, v44, 1, v48
    s_lshl_b32 s62, s56, 3
    s_add_u32 s62, s62, 4
    v_add_u32 v48, s62, v48
    v_xor_b32 v48, v48, v47
    v_lshlrev_b32 v48, 4, v48
    v_lshl_add_u32 v48, v46, 10, v48
    v_and_b32 v49, 1, v3
    v_lshl_add_u32 v15, v49, 3, v48
    v_and_b32 v43, 31, v1
    v_lshrrev_b32 v44, 5, v1
    v_mul_u32_u24 v16, 272, v43
    v_lshl_add_u32 v16, v44, 4, v16
    v_add_u32 v16, 131072, v16
    v_lshlrev_b32 v23, 4, v43
    v_add_u32 v23, 139776, v23
    s_lshl_b32 s62, s64, 4
    v_add_u32 v43, s62, v3
    v_mul_u32_u24 v17, 272, v43
    v_lshl_add_u32 v17, v2, 3, v17
    s_lshl_b32 s62, s63, 6
    s_add_u32 s62, s62, 131072
    v_add_u32 v17, s62, v17
    v_lshlrev_b32 v22, 4, v43
    v_add_u32 v22, 139776, v22
    s_lshl_b32 s62, s63, 2
    v_add_u32 v21, s62, v22
    v_add_u32 v33, s61, v8
    v_mov_b32 v18, 0xff7fffff
    v_mov_b32 v20, 0xff7fffff
    v_mov_b32 v19, 0
    s_mov_b32 s100, s61
    s_cmp_lt_u32 s56, 4
    s_cbranch_scc1 Lqa0_65
    s_waitcnt vmcnt(0)
    s_lshl_b32 s61, s56, 14
    s_add_u32 s61, s61, 131072
    buffer_load_dwordx4 v[128:131], v5, s[44:47], s61 offen offset:0 nt
    buffer_load_dwordx4 v[132:135], v5, s[44:47], s61 offen offset:1024 nt
    buffer_load_dwordx4 v[136:139], v5, s[44:47], s61 offen offset:2048 nt
    buffer_load_dwordx4 v[140:143], v5, s[44:47], s61 offen offset:3072 nt
    s_add_u32 s61, s61, 4096
    buffer_load_dwordx4 v[144:147], v5, s[44:47], s61 offen offset:0 nt
    buffer_load_dwordx4 v[148:151], v5, s[44:47], s61 offen offset:1024 nt
    buffer_load_dwordx4 v[152:155], v5, s[44:47], s61 offen offset:2048 nt
    buffer_load_dwordx4 v[156:159], v5, s[44:47], s61 offen offset:3072 nt
    s_add_u32 s61, s61, 4096
    buffer_load_dwordx4 v[160:163], v5, s[44:47], s61 offen offset:0 nt
    buffer_load_dwordx4 v[164:167], v5, s[44:47], s61 offen offset:1024 nt
    buffer_load_dwordx4 v[168:171], v5, s[44:47], s61 offen offset:2048 nt
    buffer_load_dwordx4 v[172:175], v5, s[44:47], s61 offen offset:3072 nt
    s_add_u32 s61, s61, 4096
    buffer_load_dwordx4 v[176:179], v5, s[44:47], s61 offen offset:0 nt
    buffer_load_dwordx4 v[180:183], v5, s[44:47], s61 offen offset:1024 nt
    buffer_load_dwordx4 v[184:187], v5, s[44:47], s61 offen offset:2048 nt
    buffer_load_dwordx4 v[188:191], v5, s[44:47], s61 offen offset:3072 nt
    s_branch Lqaj_66
Lqa0_65:
    v_mov_b32 v40, 0
    s_mov_b32 s92, 0
Lcf_67:
    buffer_load_dword v41, v40, s[52:55], 0 offen offset:128 sc0 sc1
    s_waitcnt vmcnt(0)
    v_readfirstlane_b32 s57, v41
    s_nop 3
    s_cmp_ge_u32 s57, 64
    s_cbranch_scc1 Lcfd_68
    s_sleep 16
    s_add_u32 s92, s92, 1
    s_cmp_lt_u32 s92, 400000
    s_cbranch_scc1 Lcf_67
Lcfd_68:
    s_lshl_b32 s61, s66, 15
    s_lshl_b32 s62, s56, 13
    s_add_u32 s61, s61, s62
    s_add_u32 s61, s61, 1146880
    s_add_u32 s62, s61, 4096
    s_mov_b32 s92, 0
Lpoll_69:
    buffer_load_dwordx4 v[64:67], v5, s[32:35], s61 offen offset:0 sc0 sc1
    buffer_load_dwordx4 v[68:71], v5, s[32:35], s61 offen offset:1024 sc0 sc1
    buffer_load_dwordx4 v[72:75], v5, s[32:35], s61 offen offset:2048 sc0 sc1
    buffer_load_dwordx4 v[76:79], v5, s[32:35], s61 offen offset:3072 sc0 sc1
    buffer_load_dwordx4 v[80:83], v5, s[32:35], s62 offen offset:0 sc0 sc1
    buffer_load_dwordx4 v[84:87], v5, s[32:35], s62 offen offset:1024 sc0 sc1
    buffer_load_dwordx4 v[88:91], v5, s[32:35], s62 offen offset:2048 sc0 sc1
    buffer_load_dwordx4 v[92:95], v5, s[32:35], s62 offen offset:3072 sc0 sc1
    s_waitcnt vmcnt(0)
    v_mov_b32 v40, v64
    v_max3_u32 v40, v40, v65, v66
    v_max3_u32 v40, v40, v67, v68
    v_max3_u32 v40, v40, v69, v70
    v_max3_u32 v40, v40, v71, v72
    v_max3_u32 v40, v40, v73, v74
    v_max3_u32 v40, v40, v75, v76
    v_max3_u32 v40, v40, v77, v78
    v_max3_u32 v40, v40, v79, v80
    v_max3_u32 v40, v40, v81, v82
    v_max3_u32 v40, v40, v83, v84
    v_max3_u32 v40, v40, v85, v86
    v_max3_u32 v40, v40, v87, v88
    v_max3_u32 v40, v40, v89, v90
    v_max3_u32 v40, v40, v91, v92
    v_max3_u32 v40, v40, v93, v94
    v_max_u32 v40, v40, v95
    v_cmpx_eq_u32 vcc, -1, v40
    s_cbranch_execz Lpolld_70
    s_sleep 4
    s_add_u32 s92, s92, 1
    s_cmp_lt_u32 s92, 400000
    s_cbranch_scc1 Lpoll_69
Lpolld_70:
    s_mov_b64 exec, -1
    s_and_b32 s62, s56, 1
    s_lshl_b32 s62, s62, 5
    s_lshl_b32 s61, s56, 13
    s_add_u32 s61, s61, 131072
    s_add_u32 s57, s62, 0
    v_xor_b32 v40, s57, v5
    v_add_u32 v40, s61, v40
    ds_write_b128 v40, v[64:67] offset:0
    s_add_u32 s57, s62, 64
    v_xor_b32 v41, s57, v5
    v_add_u32 v41, s61, v41
    ds_write_b128 v41, v[68:71] offset:1024
    s_add_u32 s57, s62, 128
    v_xor_b32 v42, s57, v5
    v_add_u32 v42, s61, v42
    ds_write_b128 v42, v[72:75] offset:2048
    s_add_u32 s57, s62, 192
    v_xor_b32 v43, s57, v5
    v_add_u32 v43, s61, v43
    ds_write_b128 v43, v[76:79] offset:3072
    s_add_u32 s57, s62, 0
    v_xor_b32 v40, s57, v5
    v_add_u32 v40, s61, v40
    ds_write_b128 v40, v[80:83] offset:4096
    s_add_u32 s57, s62, 64
    v_xor_b32 v41, s57, v5
    v_add_u32 v41, s61, v41
    ds_write_b128 v41, v[84:87] offset:5120
    s_add_u32 s57, s62, 128
    v_xor_b32 v42, s57, v5
    v_add_u32 v42, s61, v42
    ds_write_b128 v42, v[88:91] offset:6144
    s_add_u32 s57, s62, 192
    v_xor_b32 v43, s57, v5
    v_add_u32 v43, s61, v43
    ds_write_b128 v43, v[92:95] offset:7168
    s_waitcnt lgkmcnt(0)
    s_lshl_b32 s61, s56, 14
    s_add_u32 s61, s61, 131072
    buffer_load_dwordx4 v[128:131], v5, s[44:47], s61 offen offset:0 nt
    buffer_load_dwordx4 v[132:135], v5, s[44:47], s61 offen offset:1024 nt
    buffer_load_dwordx4 v[136:139], v5, s[44:47], s61 offen offset:2048 nt
    buffer_load_dwordx4 v[140:143], v5, s[44:47], s61 offen offset:3072 nt
    s_add_u32 s61, s61, 4096
    buffer_load_dwordx4 v[144:147], v5, s[44:47], s61 offen offset:0 nt
    buffer_load_dwordx4 v[148:151], v5, s[44:47], s61 offen offset:1024 nt
    buffer_load_dwordx4 v[152:155], v5, s[44:47], s61 offen offset:2048 nt
    buffer_load_dwordx4 v[156:159], v5, s[44:47], s61 offen offset:3072 nt
    s_add_u32 s61, s61, 4096
    buffer_load_dwordx4 v[160:163], v5, s[44:47], s61 offen offset:0 nt
    buffer_load_dwordx4 v[164:167], v5, s[44:47], s61 offen offset:1024 nt
    buffer_load_dwordx4 v[168:171], v5, s[44:47], s61 offen offset:2048 nt
    buffer_load_dwordx4 v[172:175], v5, s[44:47], s61 offen offset:3072 nt
    s_add_u32 s61, s61, 4096
    buffer_load_dwordx4 v[176:179], v5, s[44:47], s61 offen offset:0 nt
    buffer_load_dwordx4 v[180:183], v5, s[44:47], s61 offen offset:1024 nt
    buffer_load_dwordx4 v[184:187], v5, s[44:47], s61 offen offset:2048 nt
    buffer_load_dwordx4 v[188:191], v5, s[44:47], s61 offen offset:3072 nt
Lqaj_66:
    s_barrier
    v_add_u32 v40, s100, v8
    v_add_u32 v41, s100, v9
    v_add_u32 v42, s100, v10
    v_add_u32 v43, s100, v11
    ds_read_b128 v[192:195], v40 offset:0
    ds_read_b128 v[196:199], v41 offset:0
    ds_read_b128 v[200:203], v42 offset:0
    ds_read_b128 v[204:207], v43 offset:0
    ds_read_b128 v[208:211], v40 offset:256
    ds_read_b128 v[212:215], v41 offset:256
    ds_read_b128 v[216:219], v42 offset:256
    ds_read_b128 v[220:223], v43 offset:256
    ds_read_b128 v[224:227], v40 offset:512
    ds_read_b128 v[228:231], v41 offset:512
    ds_read_b128 v[232:235], v42 offset:512
    ds_read_b128 v[236:239], v43 offset:512
    ds_read_b128 v[240:243], v40 offset:768
    ds_read_b128 v[244:247], v41 offset:768
    ds_read_b128 v[248:251], v42 offset:768
    ds_read_b128 v[252:255], v43 offset:768
    s_waitcnt lgkmcnt(0)
    s_barrier
    ds_read_b128 v[96:99], v8 offset:0
    ds_read_b128 v[100:103], v8 offset:16384
    ds_read_b128 v[104:107], v9 offset:0
    ds_read_b128 v[108:111], v9 offset:16384
    ds_read_b128 v[112:115], v10 offset:0
    ds_read_b128 v[116:119], v10 offset:16384
    ds_read_b128 v[120:123], v11 offset:0
    ds_read_b128 v[124:127], v11 offset:16384
    s_waitcnt lgkmcnt(7)
    v_mfma_f32_16x16x32_bf16 v[24:27], v[96:99], v[192:195], 0
    ds_read_b128 v[96:99], v8 offset:256
    s_waitcnt lgkmcnt(7)
    v_mfma_f32_16x16x32_bf16 v[28:31], v[100:103], v[192:195], 0
    ds_read_b128 v[100:103], v8 offset:16640
    s_waitcnt lgkmcnt(7)
    v_mfma_f32_16x16x32_bf16 v[24:27], v[104:107], v[196:199], v[24:27]
    ds_read_b128 v[104:107], v9 offset:256
    s_waitcnt lgkmcnt(7)
    v_mfma_f32_16x16x32_bf16 v[28:31], v[108:111], v[196:199], v[28:31]
    ds_read_b128 v[108:111], v9 offset:16640
    s_waitcnt lgkmcnt(7)
    v_mfma_f32_16x16x32_bf16 v[24:27], v[112:115], v[200:203], v[24:27]
    ds_read_b128 v[112:115], v10 offset:256
    s_waitcnt lgkmcnt(7)
    v_mfma_f32_16x16x32_bf16 v[28:31], v[116:119], v[200:203], v[28:31]
    ds_read_b128 v[116:119], v10 offset:16640
    s_waitcnt lgkmcnt(7)
    v_mfma_f32_16x16x32_bf16 v[24:27], v[120:123], v[204:207], v[24:27]
    ds_read_b128 v[120:123], v11 offset:256
    s_waitcnt lgkmcnt(7)
    v_mfma_f32_16x16x32_bf16 v[28:31], v[124:127], v[204:207], v[28:31]
    ds_read_b128 v[124:127], v11 offset:16640
    s_waitcnt lgkmcnt(7)
    v_mfma_f32_16x16x32_bf16 v[24:27], v[96:99], v[208:211], v[24:27]
    ds_read_b128 v[96:99], v8 offset:512
    s_waitcnt lgkmcnt(7)
    v_mfma_f32_16x16x32_bf16 v[28:31], v[100:103], v[208:211], v[28:31]
    ds_read_b128 v[100:103], v8 offset:16896
    s_waitcnt lgkmcnt(7)
    v_mfma_f32_16x16x32_bf16 v[24:27], v[104:107], v[212:215], v[24:27]
    ds_read_b128 v[104:107], v9 offset:512
    s_waitcnt lgkmcnt(7)
    v_mfma_f32_16x16x32_bf16 v[28:31], v[108:111], v[212:215], v[28:31]
    ds_read_b128 v[108:111], v9 offset:16896
    s_waitcnt lgkmcnt(7)
    v_mfma_f32_16x16x32_bf16 v[24:27], v[112:115], v[216:219], v[24:27]
    ds_read_b128 v[112:115], v10 offset:512
    s_waitcnt lgkmcnt(7)
    v_mfma_f32_16x16x32_bf16 v[28:31], v[116:119], v[216:219], v[28:31]
    ds_read_b128 v[116:119], v10 offset:16896
    s_waitcnt lgkmcnt(7)
    v_mfma_f32_16x16x32_bf16 v[24:27], v[120:123], v[220:223], v[24:27]
    ds_read_b128 v[120:123], v11 offset:512
    s_waitcnt lgkmcnt(7)
    v_mfma_f32_16x16x32_bf16 v[28:31], v[124:127], v[220:223], v[28:31]
    ds_read_b128 v[124:127], v11 offset:16896
    s_waitcnt lgkmcnt(7)
    v_mfma_f32_16x16x32_bf16 v[24:27], v[96:99], v[224:227], v[24:27]
    ds_read_b128 v[96:99], v8 offset:768
    s_waitcnt lgkmcnt(7)
    v_mfma_f32_16x16x32_bf16 v[28:31], v[100:103], v[224:227], v[28:31]
    ds_read_b128 v[100:103], v8 offset:17152
    s_waitcnt lgkmcnt(7)
    v_mfma_f32_16x16x32_bf16 v[24:27], v[104:107], v[228:231], v[24:27]
    ds_read_b128 v[104:107], v9 offset:768
    s_waitcnt lgkmcnt(7)
    v_mfma_f32_16x16x32_bf16 v[28:31], v[108:111], v[228:231], v[28:31]
    ds_read_b128 v[108:111], v9 offset:17152
    s_waitcnt lgkmcnt(7)
    v_mfma_f32_16x16x32_bf16 v[24:27], v[112:115], v[232:235], v[24:27]
    ds_read_b128 v[112:115], v10 offset:768
    s_waitcnt lgkmcnt(7)
    v_mfma_f32_16x16x32_bf16 v[28:31], v[116:119], v[232:235], v[28:31]
    ds_read_b128 v[116:119], v10 offset:17152
    s_waitcnt lgkmcnt(7)
    v_mfma_f32_16x16x32_bf16 v[24:27], v[120:123], v[236:239], v[24:27]
    ds_read_b128 v[120:123], v11 offset:768
    s_waitcnt lgkmcnt(7)
    v_mfma_f32_16x16x32_bf16 v[28:31], v[124:127], v[236:239], v[28:31]
    ds_read_b128 v[124:127], v11 offset:17152
    s_waitcnt lgkmcnt(7)
    v_mfma_f32_16x16x32_bf16 v[24:27], v[96:99], v[240:243], v[24:27]
    s_waitcnt lgkmcnt(6)
    v_mfma_f32_16x16x32_bf16 v[28:31], v[100:103], v[240:243], v[28:31]
    s_waitcnt lgkmcnt(5)
    v_mfma_f32_16x16x32_bf16 v[24:27], v[104:107], v[244:247], v[24:27]
    s_waitcnt lgkmcnt(4)
    v_mfma_f32_16x16x32_bf16 v[28:31], v[108:111], v[244:247], v[28:31]
    s_waitcnt lgkmcnt(3)
    v_mfma_f32_16x16x32_bf16 v[24:27], v[112:115], v[248:251], v[24:27]
    s_waitcnt lgkmcnt(2)
    v_mfma_f32_16x16x32_bf16 v[28:31], v[116:119], v[248:251], v[28:31]
    s_waitcnt lgkmcnt(1)
    v_mfma_f32_16x16x32_bf16 v[24:27], v[120:123], v[252:255], v[24:27]
    s_waitcnt lgkmcnt(0)
    v_mfma_f32_16x16x32_bf16 v[28:31], v[124:127], v[252:255], v[28:31]
    s_nop 7
    s_nop 1
    v_max3_f32 v40, v24, v25, v26
    v_max3_f32 v40, v40, v27, v28
    v_max3_f32 v40, v40, v29, v30
    v_max_f32 v40, v40, v31
    v_mov_b32 v41, v40
    s_nop 1
    v_permlane32_swap_b32 v40, v41
    s_nop 1
    v_max_f32 v40, v40, v41
    v_mov_b32 v41, v40
    s_nop 1
    v_permlane16_swap_b32 v40, v41
    s_nop 1
    v_max_f32 v40, v40, v41
    ds_write_b32 v21, v40
    s_waitcnt lgkmcnt(0)
    s_barrier
    ds_read_b128 v[40:43], v22
    ds_read_b128 v[44:47], v23
    s_waitcnt lgkmcnt(1)
    v_max3_f32 v40, v40, v41, v42
    v_max3_f32 v20, v40, v43, v20
    v_sub_f32 v24, v24, v20
    v_sub_f32 v25, v25, v20
    v_sub_f32 v26, v26, v20
    v_sub_f32 v27, v27, v20
    v_sub_f32 v28, v28, v20
    v_sub_f32 v29, v29, v20
    v_sub_f32 v30, v30, v20
    v_sub_f32 v31, v31, v20
    v_exp_f32 v24, v24
    v_exp_f32 v25, v25
    v_exp_f32 v26, v26
    v_exp_f32 v27, v27
    v_exp_f32 v28, v28
    v_exp_f32 v29, v29
    v_exp_f32 v30, v30
    v_exp_f32 v31, v31
    s_waitcnt lgkmcnt(0)
    v_max3_f32 v44, v44, v45, v46
    v_max3_f32 v44, v44, v47, v18
    v_sub_f32 v32, v18, v44
    v_exp_f32 v32, v32
    v_mov_b32 v18, v44
    v_add_f32 v40, v24, v25
    v_add_f32 v40, v40, v26
    v_add_f32 v40, v40, v27
    v_add_f32 v40, v40, v28
    v_add_f32 v40, v40, v29
    v_add_f32 v40, v40, v30
    v_add_f32 v40, v40, v31
    v_cvt_pk_bf16_f32 v48, v24, v25
    v_cvt_pk_bf16_f32 v49, v26, v27
    v_cvt_pk_bf16_f32 v50, v28, v29
    v_cvt_pk_bf16_f32 v51, v30, v31
    ds_write_b64 v17, v[48:49] offset:0
    ds_write_b64 v17, v[50:51] offset:32
    v_mov_b32 v41, v40
    s_nop 1
    v_permlane32_swap_b32 v40, v41
    s_nop 1
    v_add_f32 v40, v40, v41
    v_mov_b32 v41, v40
    s_nop 1
    v_permlane16_swap_b32 v40, v41
    s_nop 1
    v_add_f32 v40, v40, v41
    ds_write_b32 v21, v40 offset:512
    s_waitcnt lgkmcnt(0)
    s_barrier
    ds_read_b128 v[40:43], v23 offset:512
    ds_read_b128 v[96:99], v16 offset:0
    ds_read_b64_tr_b16 v[100:101], v12 offset:0
    ds_read_b64_tr_b16 v[102:103], v14 offset:0
    ds_read_b64_tr_b16 v[104:105], v13 offset:0
    ds_read_b64_tr_b16 v[106:107], v15 offset:0
    ds_read_b128 v[108:111], v16 offset:32
    ds_read_b64_tr_b16 v[112:113], v12 offset:16384
    ds_read_b64_tr_b16 v[114:115], v14 offset:16384
    ds_read_b64_tr_b16 v[116:117], v13 offset:16384
    ds_read_b64_tr_b16 v[118:119], v15 offset:16384
    s_waitcnt lgkmcnt(5)
    v_mfma_f32_32x32x16_bf16 v[64:79], v[100:103], v[96:99], 0
    v_mfma_f32_32x32x16_bf16 v[80:95], v[104:107], v[96:99], 0
    ds_read_b128 v[96:99], v16 offset:64
    ds_read_b64_tr_b16 v[100:101], v12 offset:32768
    ds_read_b64_tr_b16 v[102:103], v14 offset:32768
    ds_read_b64_tr_b16 v[104:105], v13 offset:32768
    ds_read_b64_tr_b16 v[106:107], v15 offset:32768
    s_waitcnt lgkmcnt(5)
    v_mfma_f32_32x32x16_bf16 v[64:79], v[112:115], v[108:111], v[64:79]
    v_mfma_f32_32x32x16_bf16 v[80:95], v[116:119], v[108:111], v[80:95]
    ds_read_b128 v[108:111], v16 offset:96
    ds_read_b64_tr_b16 v[112:113], v12 offset:49152
    ds_read_b64_tr_b16 v[114:115], v14 offset:49152
    ds_read_b64_tr_b16 v[116:117], v13 offset:49152
    ds_read_b64_tr_b16 v[118:119], v15 offset:49152
    s_waitcnt lgkmcnt(5)
    v_mfma_f32_32x32x16_bf16 v[64:79], v[100:103], v[96:99], v[64:79]
    v_mfma_f32_32x32x16_bf16 v[80:95], v[104:107], v[96:99], v[80:95]
    v_add_u32 v12, 0x10000, v12
    v_add_u32 v13, 0x10000, v13
    v_add_u32 v14, 0x10000, v14
    v_add_u32 v15, 0x10000, v15
    ds_read_b128 v[96:99], v16 offset:128
    ds_read_b64_tr_b16 v[100:101], v12 offset:0
    ds_read_b64_tr_b16 v[102:103], v14 offset:0
    ds_read_b64_tr_b16 v[104:105], v13 offset:0
    ds_read_b64_tr_b16 v[106:107], v15 offset:0
    s_waitcnt lgkmcnt(5)
    v_mfma_f32_32x32x16_bf16 v[64:79], v[112:115], v[108:111], v[64:79]
    v_mfma_f32_32x32x16_bf16 v[80:95], v[116:119], v[108:111], v[80:95]
    ds_read_b128 v[108:111], v16 offset:160
    ds_read_b64_tr_b16 v[112:113], v12 offset:16384
    ds_read_b64_tr_b16 v[114:115], v14 offset:16384
    ds_read_b64_tr_b16 v[116:117], v13 offset:16384
    ds_read_b64_tr_b16 v[118:119], v15 offset:16384
    s_waitcnt lgkmcnt(5)
    v_mfma_f32_32x32x16_bf16 v[64:79], v[100:103], v[96:99], v[64:79]
    v_mfma_f32_32x32x16_bf16 v[80:95], v[104:107], v[96:99], v[80:95]
    ds_read_b128 v[96:99], v16 offset:192
    ds_read_b64_tr_b16 v[100:101], v12 offset:32768
    ds_read_b64_tr_b16 v[102:103], v14 offset:32768
    ds_read_b64_tr_b16 v[104:105], v13 offset:32768
    ds_read_b64_tr_b16 v[106:107], v15 offset:32768
    s_waitcnt lgkmcnt(5)
    v_mfma_f32_32x32x16_bf16 v[64:79], v[112:115], v[108:111], v[64:79]
    v_mfma_f32_32x32x16_bf16 v[80:95], v[116:119], v[108:111], v[80:95]
    ds_read_b128 v[108:111], v16 offset:224
    ds_read_b64_tr_b16 v[112:113], v12 offset:49152
    ds_read_b64_tr_b16 v[114:115], v14 offset:49152
    ds_read_b64_tr_b16 v[116:117], v13 offset:49152
    ds_read_b64_tr_b16 v[118:119], v15 offset:49152
    s_waitcnt lgkmcnt(5)
    v_mfma_f32_32x32x16_bf16 v[64:79], v[100:103], v[96:99], v[64:79]
    v_mfma_f32_32x32x16_bf16 v[80:95], v[104:107], v[96:99], v[80:95]
    s_waitcnt lgkmcnt(0)
    v_mfma_f32_32x32x16_bf16 v[64:79], v[112:115], v[108:111], v[64:79]
    v_mfma_f32_32x32x16_bf16 v[80:95], v[116:119], v[108:111], v[80:95]
    v_subrev_u32 v12, 0x10000, v12
    v_subrev_u32 v13, 0x10000, v13
    v_subrev_u32 v14, 0x10000, v14
    v_subrev_u32 v15, 0x10000, v15
    v_add_f32 v40, v40, v41
    v_add_f32 v42, v42, v43
    v_add_f32 v40, v40, v42
    v_fma_f32 v19, v19, v32, v40
    s_barrier
    s_waitcnt vmcnt(0)
    s_lshl_b32 s61, s56, 14
    v_xor_b32 v40, 0, v5
    v_add_u32 v40, s61, v40
    ds_write_b128 v40, v[128:131] offset:0
    v_xor_b32 v41, 64, v5
    v_add_u32 v41, s61, v41
    ds_write_b128 v41, v[132:135] offset:1024
    v_xor_b32 v42, 128, v5
    v_add_u32 v42, s61, v42
    ds_write_b128 v42, v[136:139] offset:2048
    v_xor_b32 v43, 192, v5
    v_add_u32 v43, s61, v43
    ds_write_b128 v43, v[140:143] offset:3072
    v_xor_b32 v40, 0, v5
    v_add_u32 v40, s61, v40
    ds_write_b128 v40, v[144:147] offset:4096
    v_xor_b32 v41, 64, v5
    v_add_u32 v41, s61, v41
    ds_write_b128 v41, v[148:151] offset:5120
    v_xor_b32 v42, 128, v5
    v_add_u32 v42, s61, v42
    ds_write_b128 v42, v[152:155] offset:6144
    v_xor_b32 v43, 192, v5
    v_add_u32 v43, s61, v43
    ds_write_b128 v43, v[156:159] offset:7168
    v_xor_b32 v40, 32, v5
    v_add_u32 v40, s61, v40
    ds_write_b128 v40, v[160:163] offset:8192
    v_xor_b32 v41, 96, v5
    v_add_u32 v41, s61, v41
    ds_write_b128 v41, v[164:167] offset:9216
    v_xor_b32 v42, 160, v5
    v_add_u32 v42, s61, v42
    ds_write_b128 v42, v[168:171] offset:10240
    v_xor_b32 v43, 224, v5
    v_add_u32 v43, s61, v43
    ds_write_b128 v43, v[172:175] offset:11264
    v_xor_b32 v40, 32, v5
    v_add_u32 v40, s61, v40
    ds_write_b128 v40, v[176:179] offset:12288
    v_xor_b32 v41, 96, v5
    v_add_u32 v41, s61, v41
    ds_write_b128 v41, v[180:183] offset:13312
    v_xor_b32 v42, 160, v5
    v_add_u32 v42, s61, v42
    ds_write_b128 v42, v[184:187] offset:14336
    v_xor_b32 v43, 224, v5
    v_add_u32 v43, s61, v43
    ds_write_b128 v43, v[188:191] offset:15360
    s_waitcnt lgkmcnt(0)
    s_barrier
    ds_read_b128 v[96:99], v8 offset:0
    ds_read_b128 v[100:103], v8 offset:16384
    ds_read_b128 v[104:107], v9 offset:0
    ds_read_b128 v[108:111], v9 offset:16384
    ds_read_b128 v[112:115], v10 offset:0
    ds_read_b128 v[116:119], v10 offset:16384
    ds_read_b128 v[120:123], v11 offset:0
    ds_read_b128 v[124:127], v11 offset:16384
    s_waitcnt lgkmcnt(7)
    v_mfma_f32_16x16x32_bf16 v[24:27], v[96:99], v[192:195], 0
    ds_read_b128 v[96:99], v8 offset:256
    s_waitcnt lgkmcnt(7)
    v_mfma_f32_16x16x32_bf16 v[28:31], v[100:103], v[192:195], 0
    ds_read_b128 v[100:103], v8 offset:16640
    s_waitcnt lgkmcnt(7)
    v_mfma_f32_16x16x32_bf16 v[24:27], v[104:107], v[196:199], v[24:27]
    ds_read_b128 v[104:107], v9 offset:256
    s_waitcnt lgkmcnt(7)
    v_mfma_f32_16x16x32_bf16 v[28:31], v[108:111], v[196:199], v[28:31]
    ds_read_b128 v[108:111], v9 offset:16640
    s_waitcnt lgkmcnt(7)
    v_mfma_f32_16x16x32_bf16 v[24:27], v[112:115], v[200:203], v[24:27]
    ds_read_b128 v[112:115], v10 offset:256
    s_waitcnt lgkmcnt(7)
    v_mfma_f32_16x16x32_bf16 v[28:31], v[116:119], v[200:203], v[28:31]
    ds_read_b128 v[116:119], v10 offset:16640
    s_waitcnt lgkmcnt(7)
    v_mfma_f32_16x16x32_bf16 v[24:27], v[120:123], v[204:207], v[24:27]
    ds_read_b128 v[120:123], v11 offset:256
    s_waitcnt lgkmcnt(7)
    v_mfma_f32_16x16x32_bf16 v[28:31], v[124:127], v[204:207], v[28:31]
    ds_read_b128 v[124:127], v11 offset:16640
    s_waitcnt lgkmcnt(7)
    v_mfma_f32_16x16x32_bf16 v[24:27], v[96:99], v[208:211], v[24:27]
    ds_read_b128 v[96:99], v8 offset:512
    s_waitcnt lgkmcnt(7)
    v_mfma_f32_16x16x32_bf16 v[28:31], v[100:103], v[208:211], v[28:31]
    ds_read_b128 v[100:103], v8 offset:16896
    s_waitcnt lgkmcnt(7)
    v_mfma_f32_16x16x32_bf16 v[24:27], v[104:107], v[212:215], v[24:27]
    ds_read_b128 v[104:107], v9 offset:512
    s_waitcnt lgkmcnt(7)
    v_mfma_f32_16x16x32_bf16 v[28:31], v[108:111], v[212:215], v[28:31]
    ds_read_b128 v[108:111], v9 offset:16896
    s_waitcnt lgkmcnt(7)
    v_mfma_f32_16x16x32_bf16 v[24:27], v[112:115], v[216:219], v[24:27]
    ds_read_b128 v[112:115], v10 offset:512
    s_waitcnt lgkmcnt(7)
    v_mfma_f32_16x16x32_bf16 v[28:31], v[116:119], v[216:219], v[28:31]
    ds_read_b128 v[116:119], v10 offset:16896
    s_waitcnt lgkmcnt(7)
    v_mfma_f32_16x16x32_bf16 v[24:27], v[120:123], v[220:223], v[24:27]
    ds_read_b128 v[120:123], v11 offset:512
    s_waitcnt lgkmcnt(7)
    v_mfma_f32_16x16x32_bf16 v[28:31], v[124:127], v[220:223], v[28:31]
    ds_read_b128 v[124:127], v11 offset:16896
    s_waitcnt lgkmcnt(7)
    v_mfma_f32_16x16x32_bf16 v[24:27], v[96:99], v[224:227], v[24:27]
    ds_read_b128 v[96:99], v8 offset:768
    s_waitcnt lgkmcnt(7)
    v_mfma_f32_16x16x32_bf16 v[28:31], v[100:103], v[224:227], v[28:31]
    ds_read_b128 v[100:103], v8 offset:17152
    s_waitcnt lgkmcnt(7)
    v_mfma_f32_16x16x32_bf16 v[24:27], v[104:107], v[228:231], v[24:27]
    ds_read_b128 v[104:107], v9 offset:768
    s_waitcnt lgkmcnt(7)
    v_mfma_f32_16x16x32_bf16 v[28:31], v[108:111], v[228:231], v[28:31]
    ds_read_b128 v[108:111], v9 offset:17152
    s_waitcnt lgkmcnt(7)
    v_mfma_f32_16x16x32_bf16 v[24:27], v[112:115], v[232:235], v[24:27]
    ds_read_b128 v[112:115], v10 offset:768
    s_waitcnt lgkmcnt(7)
    v_mfma_f32_16x16x32_bf16 v[28:31], v[116:119], v[232:235], v[28:31]
    ds_read_b128 v[116:119], v10 offset:17152
    s_waitcnt lgkmcnt(7)
    v_mfma_f32_16x16x32_bf16 v[24:27], v[120:123], v[236:239], v[24:27]
    ds_read_b128 v[120:123], v11 offset:768
    s_waitcnt lgkmcnt(7)
    v_mfma_f32_16x16x32_bf16 v[28:31], v[124:127], v[236:239], v[28:31]
    ds_read_b128 v[124:127], v11 offset:17152
    s_waitcnt lgkmcnt(7)
    v_mfma_f32_16x16x32_bf16 v[24:27], v[96:99], v[240:243], v[24:27]
    s_waitcnt lgkmcnt(6)
    v_mfma_f32_16x16x32_bf16 v[28:31], v[100:103], v[240:243], v[28:31]
    s_waitcnt lgkmcnt(5)
    v_mfma_f32_16x16x32_bf16 v[24:27], v[104:107], v[244:247], v[24:27]
    s_waitcnt lgkmcnt(4)
    v_mfma_f32_16x16x32_bf16 v[28:31], v[108:111], v[244:247], v[28:31]
    s_waitcnt lgkmcnt(3)
    v_mfma_f32_16x16x32_bf16 v[24:27], v[112:115], v[248:251], v[24:27]
    s_waitcnt lgkmcnt(2)
    v_mfma_f32_16x16x32_bf16 v[28:31], v[116:119], v[248:251], v[28:31]
    s_waitcnt lgkmcnt(1)
    v_mfma_f32_16x16x32_bf16 v[24:27], v[120:123], v[252:255], v[24:27]
    s_waitcnt lgkmcnt(0)
    v_mfma_f32_16x16x32_bf16 v[28:31], v[124:127], v[252:255], v[28:31]
    s_nop 7
    s_nop 1
    v_max3_f32 v40, v24, v25, v26
    v_max3_f32 v40, v40, v27, v28
    v_max3_f32 v40, v40, v29, v30
    v_max_f32 v40, v40, v31
    v_mov_b32 v41, v40
    s_nop 1
    v_permlane32_swap_b32 v40, v41
    s_nop 1
    v_max_f32 v40, v40, v41
    v_mov_b32 v41, v40
    s_nop 1
    v_permlane16_swap_b32 v40, v41
    s_nop 1
    v_max_f32 v40, v40, v41
    ds_write_b32 v21, v40
    s_waitcnt lgkmcnt(0)
    s_barrier
    ds_read_b128 v[40:43], v22
    ds_read_b128 v[44:47], v23
    s_waitcnt lgkmcnt(1)
    v_max3_f32 v40, v40, v41, v42
    v_max3_f32 v20, v40, v43, v20
    v_sub_f32 v24, v24, v20
    v_sub_f32 v25, v25, v20
    v_sub_f32 v26, v26, v20
    v_sub_f32 v27, v27, v20
    v_sub_f32 v28, v28, v20
    v_sub_f32 v29, v29, v20
    v_sub_f32 v30, v30, v20
    v_sub_f32 v31, v31, v20
    v_exp_f32 v24, v24
    v_exp_f32 v25, v25
    v_exp_f32 v26, v26
    v_exp_f32 v27, v27
    v_exp_f32 v28, v28
    v_exp_f32 v29, v29
    v_exp_f32 v30, v30
    v_exp_f32 v31, v31
    s_waitcnt lgkmcnt(0)
    v_max3_f32 v44, v44, v45, v46
    v_max3_f32 v44, v44, v47, v18
    v_sub_f32 v32, v18, v44
    v_exp_f32 v32, v32
    v_mov_b32 v18, v44
    v_add_f32 v40, v24, v25
    v_add_f32 v40, v40, v26
    v_add_f32 v40, v40, v27
    v_add_f32 v40, v40, v28
    v_add_f32 v40, v40, v29
    v_add_f32 v40, v40, v30
    v_add_f32 v40, v40, v31
    v_cvt_pk_bf16_f32 v48, v24, v25
    v_cvt_pk_bf16_f32 v49, v26, v27
    v_cvt_pk_bf16_f32 v50, v28, v29
    v_cvt_pk_bf16_f32 v51, v30, v31
    ds_write_b64 v17, v[48:49] offset:0
    ds_write_b64 v17, v[50:51] offset:32
    v_mov_b32 v41, v40
    s_nop 1
    v_permlane32_swap_b32 v40, v41
    s_nop 1
    v_add_f32 v40, v40, v41
    v_mov_b32 v41, v40
    s_nop 1
    v_permlane16_swap_b32 v40, v41
    s_nop 1
    v_add_f32 v40, v40, v41
    ds_write_b32 v21, v40 offset:512
    s_waitcnt lgkmcnt(0)
    s_barrier
    ds_read_b128 v[40:43], v23 offset:512
    v_mul_f32 v64, v64, v32
    v_mul_f32 v65, v65, v32
    v_mul_f32 v66, v66, v32
    v_mul_f32 v67, v67, v32
    v_mul_f32 v68, v68, v32
    v_mul_f32 v69, v69, v32
    v_mul_f32 v70, v70, v32
    v_mul_f32 v71, v71, v32
    v_mul_f32 v72, v72, v32
    v_mul_f32 v73, v73, v32
    v_mul_f32 v74, v74, v32
    v_mul_f32 v75, v75, v32
    v_mul_f32 v76, v76, v32
    v_mul_f32 v77, v77, v32
    v_mul_f32 v78, v78, v32
    v_mul_f32 v79, v79, v32
    v_mul_f32 v80, v80, v32
    v_mul_f32 v81, v81, v32
    v_mul_f32 v82, v82, v32
    v_mul_f32 v83, v83, v32
    v_mul_f32 v84, v84, v32
    v_mul_f32 v85, v85, v32
    v_mul_f32 v86, v86, v32
    v_mul_f32 v87, v87, v32
    v_mul_f32 v88, v88, v32
    v_mul_f32 v89, v89, v32
    v_mul_f32 v90, v90, v32
    v_mul_f32 v91, v91, v32
    v_mul_f32 v92, v92, v32
    v_mul_f32 v93, v93, v32
    v_mul_f32 v94, v94, v32
    v_mul_f32 v95, v95, v32
    ds_read_b128 v[96:99], v16 offset:0
    ds_read_b64_tr_b16 v[100:101], v12 offset:0
    ds_read_b64_tr_b16 v[102:103], v14 offset:0
    ds_read_b64_tr_b16 v[104:105], v13 offset:0
    ds_read_b64_tr_b16 v[106:107], v15 offset:0
    ds_read_b128 v[108:111], v16 offset:32
    ds_read_b64_tr_b16 v[112:113], v12 offset:16384
    ds_read_b64_tr_b16 v[114:115], v14 offset:16384
    ds_read_b64_tr_b16 v[116:117], v13 offset:16384
    ds_read_b64_tr_b16 v[118:119], v15 offset:16384
    s_waitcnt lgkmcnt(5)
    v_mfma_f32_32x32x16_bf16 v[64:79], v[100:103], v[96:99], v[64:79]
    v_mfma_f32_32x32x16_bf16 v[80:95], v[104:107], v[96:99], v[80:95]
    ds_read_b128 v[96:99], v16 offset:64
    ds_read_b64_tr_b16 v[100:101], v12 offset:32768
    ds_read_b64_tr_b16 v[102:103], v14 offset:32768
    ds_read_b64_tr_b16 v[104:105], v13 offset:32768
    ds_read_b64_tr_b16 v[106:107], v15 offset:32768
    s_waitcnt lgkmcnt(5)
    v_mfma_f32_32x32x16_bf16 v[64:79], v[112:115], v[108:111], v[64:79]
    v_mfma_f32_32x32x16_bf16 v[80:95], v[116:119], v[108:111], v[80:95]
    ds_read_b128 v[108:111], v16 offset:96
    ds_read_b64_tr_b16 v[112:113], v12 offset:49152
    ds_read_b64_tr_b16 v[114:115], v14 offset:49152
    ds_read_b64_tr_b16 v[116:117], v13 offset:49152
    ds_read_b64_tr_b16 v[118:119], v15 offset:49152
    s_waitcnt lgkmcnt(5)
    v_mfma_f32_32x32x16_bf16 v[64:79], v[100:103], v[96:99], v[64:79]
    v_mfma_f32_32x32x16_bf16 v[80:95], v[104:107], v[96:99], v[80:95]
    v_add_u32 v12, 0x10000, v12
    v_add_u32 v13, 0x10000, v13
    v_add_u32 v14, 0x10000, v14
    v_add_u32 v15, 0x10000, v15
    ds_read_b128 v[96:99], v16 offset:128
    ds_read_b64_tr_b16 v[100:101], v12 offset:0
    ds_read_b64_tr_b16 v[102:103], v14 offset:0
    ds_read_b64_tr_b16 v[104:105], v13 offset:0
    ds_read_b64_tr_b16 v[106:107], v15 offset:0
    s_waitcnt lgkmcnt(5)
    v_mfma_f32_32x32x16_bf16 v[64:79], v[112:115], v[108:111], v[64:79]
    v_mfma_f32_32x32x16_bf16 v[80:95], v[116:119], v[108:111], v[80:95]
    ds_read_b128 v[108:111], v16 offset:160
    ds_read_b64_tr_b16 v[112:113], v12 offset:16384
    ds_read_b64_tr_b16 v[114:115], v14 offset:16384
    ds_read_b64_tr_b16 v[116:117], v13 offset:16384
    ds_read_b64_tr_b16 v[118:119], v15 offset:16384
    s_waitcnt lgkmcnt(5)
    v_mfma_f32_32x32x16_bf16 v[64:79], v[100:103], v[96:99], v[64:79]
    v_mfma_f32_32x32x16_bf16 v[80:95], v[104:107], v[96:99], v[80:95]
    ds_read_b128 v[96:99], v16 offset:192
    ds_read_b64_tr_b16 v[100:101], v12 offset:32768
    ds_read_b64_tr_b16 v[102:103], v14 offset:32768
    ds_read_b64_tr_b16 v[104:105], v13 offset:32768
    ds_read_b64_tr_b16 v[106:107], v15 offset:32768
    s_waitcnt lgkmcnt(5)
    v_mfma_f32_32x32x16_bf16 v[64:79], v[112:115], v[108:111], v[64:79]
    v_mfma_f32_32x32x16_bf16 v[80:95], v[116:119], v[108:111], v[80:95]
    ds_read_b128 v[108:111], v16 offset:224
    ds_read_b64_tr_b16 v[112:113], v12 offset:49152
    ds_read_b64_tr_b16 v[114:115], v14 offset:49152
    ds_read_b64_tr_b16 v[116:117], v13 offset:49152
    ds_read_b64_tr_b16 v[118:119], v15 offset:49152
    s_waitcnt lgkmcnt(5)
    v_mfma_f32_32x32x16_bf16 v[64:79], v[100:103], v[96:99], v[64:79]
    v_mfma_f32_32x32x16_bf16 v[80:95], v[104:107], v[96:99], v[80:95]
    s_waitcnt lgkmcnt(0)
    v_mfma_f32_32x32x16_bf16 v[64:79], v[112:115], v[108:111], v[64:79]
    v_mfma_f32_32x32x16_bf16 v[80:95], v[116:119], v[108:111], v[80:95]
    v_subrev_u32 v12, 0x10000, v12
    v_subrev_u32 v13, 0x10000, v13
    v_subrev_u32 v14, 0x10000, v14
    v_subrev_u32 v15, 0x10000, v15
    v_add_f32 v40, v40, v41
    v_add_f32 v42, v42, v43
    v_add_f32 v40, v40, v42
    v_fma_f32 v19, v19, v32, v40
    s_barrier
    s_nop 7
    s_nop 3
    v_and_b32 v43, 31, v1
    v_lshrrev_b32 v44, 5, v1
    v_mul_u32_u24 v40, 1040, v43
    v_lshl_add_u32 v40, v44, 3, v40
    s_lshl_b32 s61, s56, 7
    v_add_u32 v40, s61, v40
    v_cvt_pk_bf16_f32 v64, v64, v65
    v_cvt_pk_bf16_f32 v65, v66, v67
    ds_write_b64 v40, v[64:65] offset:0
    v_cvt_pk_bf16_f32 v68, v68, v69
    v_cvt_pk_bf16_f32 v69, v70, v71
    ds_write_b64 v40, v[68:69] offset:16
    v_cvt_pk_bf16_f32 v72, v72, v73
    v_cvt_pk_bf16_f32 v73, v74, v75
    ds_write_b64 v40, v[72:73] offset:32
    v_cvt_pk_bf16_f32 v76, v76, v77
    v_cvt_pk_bf16_f32 v77, v78, v79
    ds_write_b64 v40, v[76:77] offset:48
    v_cvt_pk_bf16_f32 v80, v80, v81
    v_cvt_pk_bf16_f32 v81, v82, v83
    ds_write_b64 v40, v[80:81] offset:64
    v_cvt_pk_bf16_f32 v84, v84, v85
    v_cvt_pk_bf16_f32 v85, v86, v87
    ds_write_b64 v40, v[84:85] offset:80
    v_cvt_pk_bf16_f32 v88, v88, v89
    v_cvt_pk_bf16_f32 v89, v90, v91
    ds_write_b64 v40, v[88:89] offset:96
    v_cvt_pk_bf16_f32 v92, v92, v93
    v_cvt_pk_bf16_f32 v93, v94, v95
    ds_write_b64 v40, v[92:93] offset:112
    v_mov_b32 v46, v18
    v_mov_b32 v47, v19
    v_lshlrev_b32 v45, 8, v43
    s_lshl_b32 s62, s65, 3
    s_add_u32 s62, s62, 1245184
    s_cmp_lg_u32 s56, 0
    s_cbranch_scc1 Lml_71
    s_mov_b64 exec, 0xffffffff
    buffer_store_dwordx2 v[46:47], v45, s[32:35], s62 offen sc0 sc1
    s_mov_b64 exec, -1
Lml_71:
    v_mov_b32 v40, 0
    v_mov_b32 v43, 98816
    ds_write_b32 v43, v40
    s_waitcnt lgkmcnt(0)
    s_barrier
    s_mul_i32 s61, s56, 4160
    v_add_u32 v40, s61, v5
    ds_read_b128 v[96:99], v40 offset:0
    ds_read_b128 v[100:103], v40 offset:1040
    ds_read_b128 v[104:107], v40 offset:2080
    ds_read_b128 v[108:111], v40 offset:3120
    s_lshl_b32 s61, s65, 15
    s_lshl_b32 s62, s56, 12
    s_add_u32 s61, s61, s62
    s_add_u32 s61, s61, 2097152
    s_waitcnt lgkmcnt(3)
    buffer_store_dwordx4 v[96:99], v5, s[32:35], s61 offen offset:0 sc0 sc1
    s_waitcnt lgkmcnt(2)
    buffer_store_dwordx4 v[100:103], v5, s[32:35], s61 offen offset:1024 sc0 sc1
    s_waitcnt lgkmcnt(1)
    buffer_store_dwordx4 v[104:107], v5, s[32:35], s61 offen offset:2048 sc0 sc1
    s_waitcnt lgkmcnt(0)
    buffer_store_dwordx4 v[108:111], v5, s[32:35], s61 offen offset:3072 sc0 sc1
    s_waitcnt vmcnt(0)
    s_barrier
    s_cmp_lg_u32 s56, 0
    s_cbranch_scc1 Lpf_72
    v_lshlrev_b32 v40, 14, v1
    v_mov_b32 v41, 0
    s_lshl_b32 s61, s65, 2
    s_add_u32 s61, s61, 0
    s_mov_b64 exec, 0xffffffff
    buffer_store_dword v41, v40, s[32:35], s61 offen sc0 sc1
    s_mov_b64 exec, -1
Lpf_72:
    s_mov_b32 s79, 24
    s_mov_b32 s80, 5376
    s_cmp_lt_u32 s56, 4
    s_cbranch_scc1 Ld03_74
    s_cmp_lg_u32 s56, 7
    s_cbranch_scc1 L_distw
    v_lshlrev_b32 v40, 13, v1
    s_lshl_b32 s61, s65, 8
    s_add_u32 s61, s61, 1507328
    s_mov_b32 s92, 0
    s_mov_b64 exec, 3
Lwogl_75:
    buffer_load_dword v41, v40, s[32:35], s61 offen sc0 sc1
    s_waitcnt vmcnt(0)
    v_cmp_gt_u32 vcc, 65646, v41
    s_cbranch_vccz Lwogd_76
    s_sleep 8
    s_add_u32 s92, s92, 1
    s_cmp_lt_u32 s92, 400000
    s_cbranch_scc1 Lwogl_75
Lwogd_76:
    s_mov_b64 exec, -1
    s_mov_b32 s62, 768
    s_mov_b32 s36, s14
    s_mov_b32 s37, s15
    s_and_b32 s37, s37, 0xffff
    s_mov_b32 s38, 4194304
    s_mov_b32 s39, 0x00020000
    v_or_b32 v40, 0, v2
    v_lshlrev_b32 v40, 1, v40
    v_xor_b32 v40, v40, v3
    v_lshlrev_b32 v40, 4, v40
    v_lshl_add_u32 v44, v2, 10, v40
    v_or_b32 v40, 4, v2
    v_lshlrev_b32 v40, 1, v40
    v_xor_b32 v40, v40, v3
    v_lshlrev_b32 v40, 4, v40
    v_lshl_add_u32 v45, v2, 10, v40
    s_lshl_b32 s61, s65, 17
    s_add_u32 s61, s61, s62
    s_mov_b32 m0, 65536
    s_nop 0
    buffer_load_dwordx4 v44, s[36:39], s61 offen nt lds
    s_mov_b32 m0, 66560
    s_add_u32 s61, s61, 4096
    buffer_load_dwordx4 v44, s[36:39], s61 offen nt lds
    s_mov_b32 m0, 67584
    s_add_u32 s61, s61, 4096
    buffer_load_dwordx4 v45, s[36:39], s61 offen nt lds
    s_mov_b32 m0, 68608
    s_add_u32 s61, s61, 4096
    buffer_load_dwordx4 v45, s[36:39], s61 offen nt lds
    s_mov_b32 m0, 69632
    s_add_u32 s61, s61, 4096
    buffer_load_dwordx4 v44, s[36:39], s61 offen nt lds
    s_mov_b32 m0, 70656
    s_add_u32 s61, s61, 4096
    buffer_load_dwordx4 v44, s[36:39], s61 offen nt lds
    s_mov_b32 m0, 71680
    s_add_u32 s61, s61, 4096
    buffer_load_dwordx4 v45, s[36:39], s61 offen nt lds
    s_mov_b32 m0, 72704
    s_add_u32 s61, s61, 4096
    buffer_load_dwordx4 v45, s[36:39], s61 offen nt lds
    s_mov_b32 m0, 73728
    s_add_u32 s61, s61, 4096
    buffer_load_dwordx4 v44, s[36:39], s61 offen nt lds
    s_mov_b32 m0, 74752
    s_add_u32 s61, s61, 4096
    buffer_load_dwordx4 v44, s[36:39], s61 offen nt lds
    s_mov_b32 m0, 75776
    s_add_u32 s61, s61, 4096
    buffer_load_dwordx4 v45, s[36:39], s61 offen nt lds
    s_mov_b32 m0, 76800
    s_add_u32 s61, s61, 4096
    buffer_load_dwordx4 v45, s[36:39], s61 offen nt lds
    s_mov_b32 m0, 77824
    s_add_u32 s61, s61, 4096
    buffer_load_dwordx4 v44, s[36:39], s61 offen nt lds
    s_mov_b32 m0, 78848
    s_add_u32 s61, s61, 4096
    buffer_load_dwordx4 v44, s[36:39], s61 offen nt lds
    s_mov_b32 m0, 79872
    s_add_u32 s61, s61, 4096
    buffer_load_dwordx4 v45, s[36:39], s61 offen nt lds
    s_mov_b32 m0, 80896
    s_add_u32 s61, s61, 4096
    buffer_load_dwordx4 v45, s[36:39], s61 offen nt lds
    s_mov_b32 m0, 81920
    s_add_u32 s61, s61, 4096
    buffer_load_dwordx4 v44, s[36:39], s61 offen nt lds
    s_mov_b32 m0, 82944
    s_add_u32 s61, s61, 4096
    buffer_load_dwordx4 v44, s[36:39], s61 offen nt lds
    s_mov_b32 m0, 83968
    s_add_u32 s61, s61, 4096
    buffer_load_dwordx4 v45, s[36:39], s61 offen nt lds
    s_mov_b32 m0, 84992
    s_add_u32 s61, s61, 4096
    buffer_load_dwordx4 v45, s[36:39], s61 offen nt lds
    s_mov_b32 m0, 86016
    s_add_u32 s61, s61, 4096
    buffer_load_dwordx4 v44, s[36:39], s61 offen nt lds
    s_mov_b32 m0, 87040
    s_add_u32 s61, s61, 4096
    buffer_load_dwordx4 v44, s[36:39], s61 offen nt lds
    s_mov_b32 m0, 88064
    s_add_u32 s61, s61, 4096
    buffer_load_dwordx4 v45, s[36:39], s61 offen nt lds
    s_mov_b32 m0, 89088
    s_add_u32 s61, s61, 4096
    buffer_load_dwordx4 v45, s[36:39], s61 offen nt lds
    s_mov_b32 m0, 90112
    s_add_u32 s61, s61, 4096
    buffer_load_dwordx4 v44, s[36:39], s61 offen nt lds
    s_mov_b32 m0, 91136
    s_add_u32 s61, s61, 4096
    buffer_load_dwordx4 v44, s[36:39], s61 offen nt lds
    s_mov_b32 m0, 92160
    s_add_u32 s61, s61, 4096
    buffer_load_dwordx4 v45, s[36:39], s61 offen nt lds
    s_mov_b32 m0, 93184
    s_add_u32 s61, s61, 4096
    buffer_load_dwordx4 v45, s[36:39], s61 offen nt lds
    s_mov_b32 m0, 94208
    s_add_u32 s61, s61, 4096
    buffer_load_dwordx4 v44, s[36:39], s61 offen nt lds
    s_mov_b32 m0, 95232
    s_add_u32 s61, s61, 4096
    buffer_load_dwordx4 v44, s[36:39], s61 offen nt lds
    s_mov_b32 m0, 96256
    s_add_u32 s61, s61, 4096
    buffer_load_dwordx4 v45, s[36:39], s61 offen nt lds
    s_mov_b32 m0, 97280
    s_add_u32 s61, s61, 4096
    buffer_load_dwordx4 v45, s[36:39], s61 offen nt lds
    s_add_u32 s61, s65, 32
    s_mul_i32 s61, s61, 16384
    s_add_u32 s61, s61, 7424
    v_lshlrev_b32 v46, 3, v1
    s_mov_b32 s92, 0
Lpoll_77:
    buffer_load_dwordx2 v[48:49], v46, s[32:35], s61 offen sc0 sc1
    s_waitcnt vmcnt(0)
    v_mov_b32 v45, v48
    v_max_u32 v45, v45, v49
    v_cmpx_eq_u32 vcc, -1, v45
    s_cbranch_execz Lpolld_78
    s_sleep 2
    s_add_u32 s92, s92, 1
    s_cmp_lt_u32 s92, 400000
    s_cbranch_scc1 Lpoll_77
Lpolld_78:
    s_mov_b64 exec, -1
    v_add_u32 v46, 98304, v46
    ds_write_b64 v46, v[48:49]
    s_waitcnt lgkmcnt(0)
    v_mov_b32 v40, 1
    v_mov_b32 v43, 98816
    ds_write_b32 v43, v40
    s_waitcnt lgkmcnt(0)
    s_branch L_dist
Ld03_74:
    s_barrier
    s_branch L_final
L_roleT1:
    s_mov_b32 s65, s75
    s_waitcnt vmcnt(0)
    s_barrier
    s_cmp_lg_u32 s56, 1
    s_cbranch_scc1 Lsc_79
    v_mov_b32 v40, 1
    v_mov_b32 v41, 0
    s_mov_b64 s[94:95], exec
    s_mov_b64 exec, 1
    buffer_atomic_add v40, v41, s[52:55], 0 offen offset:128 sc1
    s_mov_b64 exec, s[94:95]
Lsc_79:
    s_waitcnt vmcnt(0)
    v_perm_b32 v232, v196, v192, s68
    v_perm_b32 v233, v196, v192, s69
    v_perm_b32 v234, v197, v193, s68
    v_perm_b32 v235, v197, v193, s69
    v_perm_b32 v236, v198, v194, s68
    v_perm_b32 v237, v198, v194, s69
    v_perm_b32 v238, v199, v195, s68
    v_perm_b32 v239, v199, v195, s69
    v_dot2_f32_bf16 v212, v232, v208, 0
    v_dot2_f32_bf16 v213, v233, v208, 0
    v_dot2_f32_bf16 v214, v234, v208, 0
    v_dot2_f32_bf16 v215, v235, v208, 0
    v_dot2_f32_bf16 v216, v236, v208, 0
    v_dot2_f32_bf16 v217, v237, v208, 0
    v_dot2_f32_bf16 v218, v238, v208, 0
    v_dot2_f32_bf16 v219, v239, v208, 0
    v_dot2_f32_bf16 v220, v232, v210, 0
    v_dot2_f32_bf16 v221, v233, v210, 0
    v_dot2_f32_bf16 v222, v234, v210, 0
    v_dot2_f32_bf16 v223, v235, v210, 0
    v_dot2_f32_bf16 v224, v236, v210, 0
    v_dot2_f32_bf16 v225, v237, v210, 0
    v_dot2_f32_bf16 v226, v238, v210, 0
    v_dot2_f32_bf16 v227, v239, v210, 0
    v_perm_b32 v232, v204, v200, s68
    v_perm_b32 v233, v204, v200, s69
    v_perm_b32 v234, v205, v201, s68
    v_perm_b32 v235, v205, v201, s69
    v_perm_b32 v236, v206, v202, s68
    v_perm_b32 v237, v206, v202, s69
    v_perm_b32 v238, v207, v203, s68
    v_perm_b32 v239, v207, v203, s69
    v_dot2_f32_bf16 v212, v232, v209, v212
    v_dot2_f32_bf16 v213, v233, v209, v213
    v_dot2_f32_bf16 v214, v234, v209, v214
    v_dot2_f32_bf16 v215, v235, v209, v215
    v_dot2_f32_bf16 v216, v236, v209, v216
    v_dot2_f32_bf16 v217, v237, v209, v217
    v_dot2_f32_bf16 v218, v238, v209, v218
    v_dot2_f32_bf16 v219, v239, v209, v219
    v_dot2_f32_bf16 v220, v232, v211, v220
    v_dot2_f32_bf16 v221, v233, v211, v221
    v_dot2_f32_bf16 v222, v234, v211, v222
    v_dot2_f32_bf16 v223, v235, v211, v223
    v_dot2_f32_bf16 v224, v236, v211, v224
    v_dot2_f32_bf16 v225, v237, v211, v225
    v_dot2_f32_bf16 v226, v238, v211, v226
    v_dot2_f32_bf16 v227, v239, v211, v227
    s_nop 2
    v_permlane32_swap_b32 v212, v220
    v_permlane32_swap_b32 v213, v221
    v_permlane32_swap_b32 v214, v222
    v_permlane32_swap_b32 v215, v223
    v_permlane32_swap_b32 v216, v224
    v_permlane32_swap_b32 v217, v225
    v_permlane32_swap_b32 v218, v226
    v_permlane32_swap_b32 v219, v227
    s_nop 1
    v_add_f32 v212, v212, v220
    v_add_f32 v213, v213, v221
    v_add_f32 v214, v214, v222
    v_add_f32 v215, v215, v223
    v_add_f32 v216, v216, v224
    v_add_f32 v217, v217, v225
    v_add_f32 v218, v218, v226
    v_add_f32 v219, v219, v227
    s_nop 1
    v_permlane16_swap_b32 v212, v216
    v_permlane16_swap_b32 v213, v217
    v_permlane16_swap_b32 v214, v218
    v_permlane16_swap_b32 v215, v219
    s_nop 1
    v_add_f32 v212, v212, v216
    v_add_f32 v213, v213, v217
    v_add_f32 v214, v214, v218
    v_add_f32 v215, v215, v219
    s_nop 1
    v_add_f32_dpp v212, v212, v212 row_ror:8 row_mask:0xf bank_mask:0xf
    v_add_f32_dpp v213, v213, v213 row_ror:8 row_mask:0xf bank_mask:0xf
    v_add_f32_dpp v214, v214, v214 row_ror:8 row_mask:0xf bank_mask:0xf
    v_add_f32_dpp v215, v215, v215 row_ror:8 row_mask:0xf bank_mask:0xf
    v_lshrrev_b32 v232, 5, v228
    v_lshlrev_b32 v232, 8, v232
    v_bfe_u32 v233, v228, 4, 1
    v_lshl_add_u32 v232, v233, 4, v232
    v_lshl_add_u32 v232, v230, 5, v232
    s_lshl_b32 s61, s56, 9
    s_add_u32 s61, s61, 131072
    v_add_u32 v232, s61, v232
    ds_write_b128 v232, v[212:215]
    s_waitcnt lgkmcnt(0)
    s_barrier
    s_cmp_eq_u32 s56, 0
    s_cbranch_scc1 Ls1p0_81
    s_mov_b32 s44, s10
    s_mov_b32 s45, s11
    s_and_b32 s45, s45, 0xffff
    s_mov_b32 s46, 4194304
    s_mov_b32 s47, 0x00020000
    v_xor_b32 v52, v3, v2
    v_lshlrev_b32 v51, 13, v2
    v_xor_b32 v53, 4, v52
    v_xor_b32 v54, 8, v52
    v_xor_b32 v55, 12, v52
    v_lshl_add_u32 v52, v52, 4, v51
    v_lshl_add_u32 v53, v53, 4, v51
    v_lshl_add_u32 v54, v54, 4, v51
    v_lshl_add_u32 v55, v55, 4, v51
    s_lshl_b32 s61, s56, 19
    s_lshl_b32 s62, s65, 8
    s_add_u32 s62, s62, s61
    s_lshl_b32 s61, s56, 14
    s_add_u32 m0, s61, 0
    s_nop 0
    buffer_load_dwordx4 v52, s[44:47], s62 offen nt lds
    s_add_u32 m0, s61, 1024
    s_add_u32 s62, s62, 32768
    buffer_load_dwordx4 v52, s[44:47], s62 offen nt lds
    s_add_u32 m0, s61, 2048
    s_add_u32 s62, s62, 32768
    buffer_load_dwordx4 v52, s[44:47], s62 offen nt lds
    s_add_u32 m0, s61, 3072
    s_add_u32 s62, s62, 32768
    buffer_load_dwordx4 v52, s[44:47], s62 offen nt lds
    s_add_u32 m0, s61, 4096
    s_add_u32 s62, s62, 32768
    buffer_load_dwordx4 v53, s[44:47], s62 offen nt lds
    s_add_u32 m0, s61, 5120
    s_add_u32 s62, s62, 32768
    buffer_load_dwordx4 v53, s[44:47], s62 offen nt lds
    s_add_u32 m0, s61, 6144
    s_add_u32 s62, s62, 32768
    buffer_load_dwordx4 v53, s[44:47], s62 offen nt lds
    s_add_u32 m0, s61, 7168
    s_add_u32 s62, s62, 32768
    buffer_load_dwordx4 v53, s[44:47], s62 offen nt lds
    s_add_u32 m0, s61, 8192
    s_add_u32 s62, s62, 32768
    buffer_load_dwordx4 v54, s[44:47], s62 offen nt lds
    s_add_u32 m0, s61, 9216
    s_add_u32 s62, s62, 32768
    buffer_load_dwordx4 v54, s[44:47], s62 offen nt lds
    s_add_u32 m0, s61, 10240
    s_add_u32 s62, s62, 32768
    buffer_load_dwordx4 v54, s[44:47], s62 offen nt lds
    s_add_u32 m0, s61, 11264
    s_add_u32 s62, s62, 32768
    buffer_load_dwordx4 v54, s[44:47], s62 offen nt lds
    s_add_u32 m0, s61, 12288
    s_add_u32 s62, s62, 32768
    buffer_load_dwordx4 v55, s[44:47], s62 offen nt lds
    s_add_u32 m0, s61, 13312
    s_add_u32 s62, s62, 32768
    buffer_load_dwordx4 v55, s[44:47], s62 offen nt lds
    s_add_u32 m0, s61, 14336
    s_add_u32 s62, s62, 32768
    buffer_load_dwordx4 v55, s[44:47], s62 offen nt lds
    s_add_u32 m0, s61, 15360
    s_add_u32 s62, s62, 32768
    buffer_load_dwordx4 v55, s[44:47], s62 offen nt lds
    s_branch Ls1p_80
Ls1p0_81:
    v_mov_b32 v234, 0
    buffer_load_dword v235, v234, s[52:55], s91 offen offset:0 sc0 sc1
    v_and_b32 v232, 31, v228
    v_lshlrev_b32 v233, 4, v232
    v_add_u32 v233, 131072, v233
    ds_read_b128 v[192:195], v233 offset:0
    ds_read_b128 v[196:199], v233 offset:512
    ds_read_b128 v[200:203], v233 offset:1024
    ds_read_b128 v[204:207], v233 offset:1536
    ds_read_b128 v[208:211], v233 offset:2048
    ds_read_b128 v[212:215], v233 offset:2560
    ds_read_b128 v[216:219], v233 offset:3072
    ds_read_b128 v[220:223], v233 offset:3584
    s_waitcnt lgkmcnt(6)
    v_add_f32 v192, v192, v196
    v_add_f32 v193, v193, v197
    v_add_f32 v194, v194, v198
    v_add_f32 v195, v195, v199
    s_waitcnt lgkmcnt(5)
    v_add_f32 v192, v192, v200
    v_add_f32 v193, v193, v201
    v_add_f32 v194, v194, v202
    v_add_f32 v195, v195, v203
    s_waitcnt lgkmcnt(4)
    v_add_f32 v192, v192, v204
    v_add_f32 v193, v193, v205
    v_add_f32 v194, v194, v206
    v_add_f32 v195, v195, v207
    s_waitcnt lgkmcnt(3)
    v_add_f32 v192, v192, v208
    v_add_f32 v193, v193, v209
    v_add_f32 v194, v194, v210
    v_add_f32 v195, v195, v211
    s_waitcnt lgkmcnt(2)
    v_add_f32 v192, v192, v212
    v_add_f32 v193, v193, v213
    v_add_f32 v194, v194, v214
    v_add_f32 v195, v195, v215
    s_waitcnt lgkmcnt(1)
    v_add_f32 v192, v192, v216
    v_add_f32 v193, v193, v217
    v_add_f32 v194, v194, v218
    v_add_f32 v195, v195, v219
    s_waitcnt lgkmcnt(0)
    v_add_f32 v192, v192, v220
    v_add_f32 v193, v193, v221
    v_add_f32 v194, v194, v222
    v_add_f32 v195, v195, v223
    v_lshrrev_b32 v233, 4, v232
    v_lshlrev_b32 v233, 10, v233
    v_and_b32 v232, 15, v232
    v_lshl_add_u32 v233, v232, 4, v233
    s_waitcnt vmcnt(0)
    s_mov_b32 s92, 0
Lcf_82:
    v_readfirstlane_b32 s57, v235
    s_nop 3
    s_cmp_lg_u32 s57, 0
    s_cbranch_scc1 Lcfd_83
    s_sleep 2
    buffer_load_dword v235, v234, s[52:55], s91 offen offset:0 sc0 sc1
    s_waitcnt vmcnt(0)
    s_add_u32 s92, s92, 1
    s_cmp_lt_u32 s92, 400000
    s_cbranch_scc1 Lcf_82
Lcfd_83:
    s_mov_b64 exec, 0xffffffff
    buffer_store_dwordx4 v[192:195], v233, s[32:35], s3 offen sc0 sc1
    s_mov_b64 exec, -1
    s_mov_b32 s44, s10
    s_mov_b32 s45, s11
    s_and_b32 s45, s45, 0xffff
    s_mov_b32 s46, 4194304
    s_mov_b32 s47, 0x00020000
    v_xor_b32 v52, v3, v2
    v_lshlrev_b32 v51, 13, v2
    v_xor_b32 v53, 4, v52
    v_xor_b32 v54, 8, v52
    v_xor_b32 v55, 12, v52
    v_lshl_add_u32 v52, v52, 4, v51
    v_lshl_add_u32 v53, v53, 4, v51
    v_lshl_add_u32 v54, v54, 4, v51
    v_lshl_add_u32 v55, v55, 4, v51
    s_lshl_b32 s61, s56, 19
    s_lshl_b32 s62, s65, 8
    s_add_u32 s62, s62, s61
    s_lshl_b32 s61, s56, 14
    s_add_u32 m0, s61, 0
    s_nop 0
    buffer_load_dwordx4 v52, s[44:47], s62 offen nt lds
    s_add_u32 m0, s61, 1024
    s_add_u32 s62, s62, 32768
    buffer_load_dwordx4 v52, s[44:47], s62 offen nt lds
    s_add_u32 m0, s61, 2048
    s_add_u32 s62, s62, 32768
    buffer_load_dwordx4 v52, s[44:47], s62 offen nt lds
    s_add_u32 m0, s61, 3072
    s_add_u32 s62, s62, 32768
    buffer_load_dwordx4 v52, s[44:47], s62 offen nt lds
    s_add_u32 m0, s61, 4096
    s_add_u32 s62, s62, 32768
    buffer_load_dwordx4 v53, s[44:47], s62 offen nt lds
    s_add_u32 m0, s61, 5120
    s_add_u32 s62, s62, 32768
    buffer_load_dwordx4 v53, s[44:47], s62 offen nt lds
    s_add_u32 m0, s61, 6144
    s_add_u32 s62, s62, 32768
    buffer_load_dwordx4 v53, s[44:47], s62 offen nt lds
    s_add_u32 m0, s61, 7168
    s_add_u32 s62, s62, 32768
    buffer_load_dwordx4 v53, s[44:47], s62 offen nt lds
    s_add_u32 m0, s61, 8192
    s_add_u32 s62, s62, 32768
    buffer_load_dwordx4 v54, s[44:47], s62 offen nt lds
    s_add_u32 m0, s61, 9216
    s_add_u32 s62, s62, 32768
    buffer_load_dwordx4 v54, s[44:47], s62 offen nt lds
    s_add_u32 m0, s61, 10240
    s_add_u32 s62, s62, 32768
    buffer_load_dwordx4 v54, s[44:47], s62 offen nt lds
    s_add_u32 m0, s61, 11264
    s_add_u32 s62, s62, 32768
    buffer_load_dwordx4 v54, s[44:47], s62 offen nt lds
    s_add_u32 m0, s61, 12288
    s_add_u32 s62, s62, 32768
    buffer_load_dwordx4 v55, s[44:47], s62 offen nt lds
    s_add_u32 m0, s61, 13312
    s_add_u32 s62, s62, 32768
    buffer_load_dwordx4 v55, s[44:47], s62 offen nt lds
    s_add_u32 m0, s61, 14336
    s_add_u32 s62, s62, 32768
    buffer_load_dwordx4 v55, s[44:47], s62 offen nt lds
    s_add_u32 m0, s61, 15360
    s_add_u32 s62, s62, 32768
    buffer_load_dwordx4 v55, s[44:47], s62 offen nt lds
    v_mov_b32 v46, 0
    buffer_load_dword v47, v46, s[52:55], 0 offen offset:128 sc0 sc1
    v_lshlrev_b32 v40, 4, v1
    s_lshl_b32 s61, s65, 11
    s_add_u32 s61, s61, 1310720
    s_mov_b32 s92, 0
Lpoll_84:
    buffer_load_dwordx4 v[24:27], v40, s[32:35], s61 offen offset:0 sc0 sc1
    buffer_load_dwordx4 v[32:35], v40, s[32:35], s61 offen offset:1024 sc0 sc1
    s_waitcnt vmcnt(0)
    v_mov_b32 v41, v24
    v_max3_u32 v41, v41, v25, v26
    v_max3_u32 v41, v41, v27, v32
    v_max3_u32 v41, v41, v33, v34
    v_max_u32 v41, v41, v35
    v_cmpx_eq_u32 vcc, -1, v41
    s_cbranch_execz Lpolld_85
    s_sleep 4
    s_add_u32 s92, s92, 1
    s_cmp_lt_u32 s92, 400000
    s_cbranch_scc1 Lpoll_84
Lpolld_85:
    s_mov_b64 exec, -1
    v_mov_b32 v28, v24
    v_mov_b32 v29, v25
    v_mov_b32 v30, v26
    v_mov_b32 v31, v27
    v_mov_b32 v36, v32
    v_mov_b32 v37, v33
    v_mov_b32 v38, v34
    v_mov_b32 v39, v35
    s_nop 1
    v_permlane32_swap_b32 v24, v28
    v_permlane32_swap_b32 v25, v29
    v_permlane32_swap_b32 v26, v30
    v_permlane32_swap_b32 v27, v31
    v_permlane32_swap_b32 v32, v36
    v_permlane32_swap_b32 v33, v37
    v_permlane32_swap_b32 v34, v38
    v_permlane32_swap_b32 v35, v39
    s_nop 1
    v_add_f32 v24, v24, v28
    v_add_f32 v25, v25, v29
    v_add_f32 v26, v26, v30
    v_add_f32 v27, v27, v31
    v_cvt_pk_bf16_f32 v24, v24, v25
    v_cvt_pk_bf16_f32 v25, v26, v27
    v_add_f32 v32, v32, v36
    v_add_f32 v33, v33, v37
    v_add_f32 v34, v34, v38
    v_add_f32 v35, v35, v39
    v_cvt_pk_bf16_f32 v32, v32, v33
    v_cvt_pk_bf16_f32 v33, v34, v35
    v_readfirstlane_b32 s57, v47
    s_nop 3
    s_cmp_ge_u32 s57, 64
    s_cbranch_scc1 Lcfm_86
    v_mov_b32 v46, 0
    s_mov_b32 s92, 0
Lcf_87:
    buffer_load_dword v47, v46, s[52:55], 0 offen offset:128 sc0 sc1
    s_waitcnt vmcnt(0)
    v_readfirstlane_b32 s57, v47
    s_nop 3
    s_cmp_ge_u32 s57, 64
    s_cbranch_scc1 Lcfd_88
    s_sleep 16
    s_add_u32 s92, s92, 1
    s_cmp_lt_u32 s92, 400000
    s_cbranch_scc1 Lcf_87
Lcfd_88:
Lcfm_86:
    v_and_b32 v42, 31, v1
    v_lshlrev_b32 v42, 3, v42
    v_add_u32 v42, 135168, v42
    ds_write_b64 v42, v[24:25] offset:0
    ds_write_b64 v42, v[32:33] offset:256
    s_waitcnt lgkmcnt(0)
Ls1p_80:
    v_lshrrev_b32 v40, 2, v3
    v_lshlrev_b32 v40, 12, v40
    v_and_b32 v41, 3, v3
    v_lshl_add_u32 v40, v41, 8, v40
    s_lshl_b32 s61, s56, 14
    v_add_u32 v40, s61, v40
    v_xor_b32 v41, v3, v2
    v_xor_b32 v42, 0, v41
    v_lshl_add_u32 v56, v42, 4, v40
    v_xor_b32 v42, 4, v41
    v_lshl_add_u32 v57, v42, 4, v40
    v_xor_b32 v42, 8, v41
    v_lshl_add_u32 v58, v42, 4, v40
    v_xor_b32 v42, 12, v41
    v_lshl_add_u32 v59, v42, 4, v40
    v_and_b32 v43, 1, v3
    v_lshlrev_b32 v43, 8, v43
    v_lshl_add_u32 v43, v2, 4, v43
    v_add_u32 v43, 135168, v43
    v_lshlrev_b32 v44, 15, v3
    v_lshl_add_u32 v44, v2, 5, v44
    s_lshl_b32 s63, s65, 10
    s_lshl_b32 s64, s56, 7
    s_add_u32 s63, s63, s64
    s_add_u32 s63, s63, 1146880
    s_mov_b32 s70, 1040356334
    s_waitcnt vmcnt(0)
    ds_read_b128 v[128:131], v56 offset:0
    ds_read_b128 v[132:135], v57 offset:0
    ds_read_b128 v[136:139], v58 offset:0
    ds_read_b128 v[140:143], v59 offset:0
    ds_read_b128 v[144:147], v56 offset:1024
    ds_read_b128 v[148:151], v57 offset:1024
    ds_read_b128 v[152:155], v58 offset:1024
    ds_read_b128 v[156:159], v59 offset:1024
    ds_read_b128 v[160:163], v56 offset:2048
    ds_read_b128 v[164:167], v57 offset:2048
    ds_read_b128 v[168:171], v58 offset:2048
    ds_read_b128 v[172:175], v59 offset:2048
    ds_read_b128 v[176:179], v56 offset:3072
    ds_read_b128 v[180:183], v57 offset:3072
    ds_read_b128 v[184:187], v58 offset:3072
    ds_read_b128 v[188:191], v59 offset:3072
    s_barrier
    ds_read_b128 v[8:11], v43 offset:0
    ds_read_b128 v[12:15], v43 offset:64
    ds_read_b128 v[16:19], v43 offset:128
    ds_read_b128 v[20:23], v43 offset:192
    s_waitcnt lgkmcnt(0)
    v_mfma_f32_16x16x32_bf16 v[24:27], v[128:131], v[8:11], 0
    v_mfma_f32_16x16x32_bf16 v[28:31], v[144:147], v[8:11], 0
    v_mfma_f32_16x16x32_bf16 v[32:35], v[160:163], v[8:11], 0
    v_mfma_f32_16x16x32_bf16 v[36:39], v[176:179], v[8:11], 0
    v_mfma_f32_16x16x32_bf16 v[24:27], v[132:135], v[12:15], v[24:27]
    v_mfma_f32_16x16x32_bf16 v[28:31], v[148:151], v[12:15], v[28:31]
    v_mfma_f32_16x16x32_bf16 v[32:35], v[164:167], v[12:15], v[32:35]
    v_mfma_f32_16x16x32_bf16 v[36:39], v[180:183], v[12:15], v[36:39]
    v_mfma_f32_16x16x32_bf16 v[24:27], v[136:139], v[16:19], v[24:27]
    v_mfma_f32_16x16x32_bf16 v[28:31], v[152:155], v[16:19], v[28:31]
    v_mfma_f32_16x16x32_bf16 v[32:35], v[168:171], v[16:19], v[32:35]
    v_mfma_f32_16x16x32_bf16 v[36:39], v[184:187], v[16:19], v[36:39]
    v_mfma_f32_16x16x32_bf16 v[24:27], v[140:143], v[20:23], v[24:27]
    v_mfma_f32_16x16x32_bf16 v[28:31], v[156:159], v[20:23], v[28:31]
    v_mfma_f32_16x16x32_bf16 v[32:35], v[172:175], v[20:23], v[32:35]
    v_mfma_f32_16x16x32_bf16 v[36:39], v[188:191], v[20:23], v[36:39]
    s_nop 7
    v_mul_f32 v24, s70, v24
    v_mul_f32 v25, s70, v25
    v_mul_f32 v26, s70, v26
    v_mul_f32 v27, s70, v27
    v_mul_f32 v28, s70, v28
    v_mul_f32 v29, s70, v29
    v_mul_f32 v30, s70, v30
    v_mul_f32 v31, s70, v31
    v_mul_f32 v32, s70, v32
    v_mul_f32 v33, s70, v33
    v_mul_f32 v34, s70, v34
    v_mul_f32 v35, s70, v35
    v_mul_f32 v36, s70, v36
    v_mul_f32 v37, s70, v37
    v_mul_f32 v38, s70, v38
    v_mul_f32 v39, s70, v39
    v_cvt_pk_bf16_f32 v8, v24, v25
    v_cvt_pk_bf16_f32 v9, v26, v27
    v_cvt_pk_bf16_f32 v10, v28, v29
    v_cvt_pk_bf16_f32 v11, v30, v31
    v_cvt_pk_bf16_f32 v12, v32, v33
    v_cvt_pk_bf16_f32 v13, v34, v35
    v_cvt_pk_bf16_f32 v14, v36, v37
    v_cvt_pk_bf16_f32 v15, v38, v39
    s_mov_b32 exec_lo, 0x00030003
    s_mov_b32 exec_hi, 0x00030003
    buffer_store_dwordx4 v[8:11], v44, s[32:35], s63 offen sc0 sc1
    buffer_store_dwordx4 v[12:15], v44, s[32:35], s63 offen offset:16 sc0 sc1
    s_mov_b64 exec, -1
    s_barrier
    s_mov_b32 s44, s12
    s_mov_b32 s45, s13
    s_and_b32 s45, s45, 0xffff
    s_mov_b32 s46, 4194304
    s_mov_b32 s47, 0x00020000
    s_lshl_b32 s61, s56, 19
    s_lshl_b32 s62, s65, 8
    s_add_u32 s61, s61, s62
    buffer_load_dwordx4 v[64:67], v4, s[44:47], s61 offen nt
    s_add_u32 s61, s61, 8192
    buffer_load_dwordx4 v[68:71], v4, s[44:47], s61 offen nt
    s_add_u32 s61, s61, 8192
    buffer_load_dwordx4 v[72:75], v4, s[44:47], s61 offen nt
    s_add_u32 s61, s61, 8192
    buffer_load_dwordx4 v[76:79], v4, s[44:47], s61 offen nt
    s_add_u32 s61, s61, 8192
    buffer_load_dwordx4 v[80:83], v4, s[44:47], s61 offen nt
    s_add_u32 s61, s61, 8192
    buffer_load_dwordx4 v[84:87], v4, s[44:47], s61 offen nt
    s_add_u32 s61, s61, 8192
    buffer_load_dwordx4 v[88:91], v4, s[44:47], s61 offen nt
    s_add_u32 s61, s61, 8192
    buffer_load_dwordx4 v[92:95], v4, s[44:47], s61 offen nt
    s_add_u32 s61, s61, 8192
    buffer_load_dwordx4 v[96:99], v4, s[44:47], s61 offen nt
    s_add_u32 s61, s61, 8192
    buffer_load_dwordx4 v[100:103], v4, s[44:47], s61 offen nt
    s_add_u32 s61, s61, 8192
    buffer_load_dwordx4 v[104:107], v4, s[44:47], s61 offen nt
    s_add_u32 s61, s61, 8192
    buffer_load_dwordx4 v[108:111], v4, s[44:47], s61 offen nt
    s_add_u32 s61, s61, 8192
    buffer_load_dwordx4 v[112:115], v4, s[44:47], s61 offen nt
    s_add_u32 s61, s61, 8192
    buffer_load_dwordx4 v[116:119], v4, s[44:47], s61 offen nt
    s_add_u32 s61, s61, 8192
    buffer_load_dwordx4 v[120:123], v4, s[44:47], s61 offen nt
    s_add_u32 s61, s61, 8192
    buffer_load_dwordx4 v[124:127], v4, s[44:47], s61 offen nt
    s_waitcnt vmcnt(0)
    v_perm_b32 v192, v68, v64, s68
    v_perm_b32 v193, v76, v72, s68
    v_perm_b32 v194, v84, v80, s68
    v_perm_b32 v195, v92, v88, s68
    v_perm_b32 v196, v68, v64, s69
    v_perm_b32 v197, v76, v72, s69
    v_perm_b32 v198, v84, v80, s69
    v_perm_b32 v199, v92, v88, s69
    v_perm_b32 v200, v69, v65, s68
    v_perm_b32 v201, v77, v73, s68
    v_perm_b32 v202, v85, v81, s68
    v_perm_b32 v203, v93, v89, s68
    v_perm_b32 v204, v69, v65, s69
    v_perm_b32 v205, v77, v73, s69
    v_perm_b32 v206, v85, v81, s69
    v_perm_b32 v207, v93, v89, s69
    v_perm_b32 v208, v70, v66, s68
    v_perm_b32 v209, v78, v74, s68
    v_perm_b32 v210, v86, v82, s68
    v_perm_b32 v211, v94, v90, s68
    v_perm_b32 v212, v70, v66, s69
    v_perm_b32 v213, v78, v74, s69
    v_perm_b32 v214, v86, v82, s69
    v_perm_b32 v215, v94, v90, s69
    v_perm_b32 v216, v71, v67, s68
    v_perm_b32 v217, v79, v75, s68
    v_perm_b32 v218, v87, v83, s68
    v_perm_b32 v219, v95, v91, s68
    v_perm_b32 v220, v71, v67, s69
    v_perm_b32 v221, v79, v75, s69
    v_perm_b32 v222, v87, v83, s69
    v_perm_b32 v223, v95, v91, s69
    v_perm_b32 v224, v100, v96, s68
    v_perm_b32 v225, v108, v104, s68
    v_perm_b32 v226, v116, v112, s68
    v_perm_b32 v227, v124, v120, s68
    v_perm_b32 v228, v100, v96, s69
    v_perm_b32 v229, v108, v104, s69
    v_perm_b32 v230, v116, v112, s69
    v_perm_b32 v231, v124, v120, s69
    v_perm_b32 v232, v101, v97, s68
    v_perm_b32 v233, v109, v105, s68
    v_perm_b32 v234, v117, v113, s68
    v_perm_b32 v235, v125, v121, s68
    v_perm_b32 v236, v101, v97, s69
    v_perm_b32 v237, v109, v105, s69
    v_perm_b32 v238, v117, v113, s69
    v_perm_b32 v239, v125, v121, s69
    v_perm_b32 v240, v102, v98, s68
    v_perm_b32 v241, v110, v106, s68
    v_perm_b32 v242, v118, v114, s68
    v_perm_b32 v243, v126, v122, s68
    v_perm_b32 v244, v102, v98, s69
    v_perm_b32 v245, v110, v106, s69
    v_perm_b32 v246, v118, v114, s69
    v_perm_b32 v247, v126, v122, s69
    v_perm_b32 v248, v103, v99, s68
    v_perm_b32 v249, v111, v107, s68
    v_perm_b32 v250, v119, v115, s68
    v_perm_b32 v251, v127, v123, s68
    v_perm_b32 v252, v103, v99, s69
    v_perm_b32 v253, v111, v107, s69
    v_perm_b32 v254, v119, v115, s69
    v_perm_b32 v255, v127, v123, s69
    s_barrier
    s_cmp_lg_u32 s56, 0
    s_cbranch_scc1 Lwf_89
    v_lshlrev_b32 v40, 2, v1
    s_mov_b64 exec, 0xffffffff
    s_mov_b32 s92, 0
Lpoll_90:
    buffer_load_dword v41, v40, s[32:35], s93 offen offset:0 sc0 sc1
    s_waitcnt vmcnt(0)
    v_mov_b32 v42, v41
    v_cmpx_eq_u32 vcc, -1, v42
    s_cbranch_execz Lpolld_91
    s_sleep 8
    s_add_u32 s92, s92, 1
    s_cmp_lt_u32 s92, 400000
    s_cbranch_scc1 Lpoll_90
Lpolld_91:
    s_mov_b64 exec, -1
Lwf_89:
    s_barrier
    s_lshr_b32 s66, s56, 2
    s_and_b32 s63, s56, 3
    s_lshl_b32 s61, s56, 17
    s_lshl_b32 s62, s65, 10
    s_add_u32 s61, s61, s62
    s_add_u32 s61, s61, 2097152
    v_lshlrev_b32 v40, 3, v3
    s_lshl_b32 s62, s65, 8
    s_lshl_b32 s64, s66, 7
    s_add_u32 s62, s62, s64
    s_add_u32 s62, s62, 1245184
    buffer_load_dwordx2 v[42:43], v40, s[32:35], s62 offen sc0 sc1
    buffer_load_dwordx4 v[64:67], v5, s[32:35], s61 offen sc0 sc1
    s_add_u32 s61, s61, 32768
    buffer_load_dwordx4 v[68:71], v5, s[32:35], s61 offen sc0 sc1
    s_add_u32 s61, s61, 32768
    buffer_load_dwordx4 v[72:75], v5, s[32:35], s61 offen sc0 sc1
    s_add_u32 s61, s61, 32768
    buffer_load_dwordx4 v[76:79], v5, s[32:35], s61 offen sc0 sc1
    s_waitcnt vmcnt(4)
    v_mov_b32 v44, v42
    s_nop 1
    v_max_f32_dpp v44, v44, v44 row_ror:8 row_mask:0xf bank_mask:0xf
    s_nop 1
    v_max_f32_dpp v44, v44, v44 row_ror:4 row_mask:0xf bank_mask:0xf
    s_nop 1
    v_max_f32_dpp v44, v44, v44 row_ror:2 row_mask:0xf bank_mask:0xf
    s_nop 1
    v_max_f32_dpp v44, v44, v44 row_ror:1 row_mask:0xf bank_mask:0xf
    v_sub_f32 v42, v42, v44
    v_exp_f32 v42, v42
    s_nop 0
    v_mul_f32 v43, v43, v42
    s_nop 1
    v_add_f32_dpp v43, v43, v43 row_ror:8 row_mask:0xf bank_mask:0xf
    s_nop 1
    v_add_f32_dpp v43, v43, v43 row_ror:4 row_mask:0xf bank_mask:0xf
    s_nop 1
    v_add_f32_dpp v43, v43, v43 row_ror:2 row_mask:0xf bank_mask:0xf
    s_nop 1
    v_add_f32_dpp v43, v43, v43 row_ror:1 row_mask:0xf bank_mask:0xf
    v_rcp_f32 v43, v43
    s_nop 0
    v_mul_f32 v42, v42, v43
    s_lshl_b32 s63, s63, 2
    s_nop 1
    s_add_u32 s64, s63, 0
    v_readlane_b32 s76, v42, s64
    s_add_u32 s64, s63, 1
    v_readlane_b32 s77, v42, s64
    s_add_u32 s64, s63, 2
    v_readlane_b32 s78, v42, s64
    s_add_u32 s64, s63, 3
    v_readlane_b32 s79, v42, s64
    s_nop 1
    s_waitcnt vmcnt(3)
    v_lshlrev_b32 v48, 16, v64
    v_and_b32 v49, 0xffff0000, v64
    v_lshlrev_b32 v50, 16, v65
    v_and_b32 v51, 0xffff0000, v65
    v_lshlrev_b32 v52, 16, v66
    v_and_b32 v53, 0xffff0000, v66
    v_lshlrev_b32 v54, 16, v67
    v_and_b32 v55, 0xffff0000, v67
    v_mul_f32 v24, s76, v48
    v_mul_f32 v25, s76, v49
    v_mul_f32 v26, s76, v50
    v_mul_f32 v27, s76, v51
    v_mul_f32 v28, s76, v52
    v_mul_f32 v29, s76, v53
    v_mul_f32 v30, s76, v54
    v_mul_f32 v31, s76, v55
    s_waitcnt vmcnt(2)
    v_lshlrev_b32 v48, 16, v68
    v_and_b32 v49, 0xffff0000, v68
    v_lshlrev_b32 v50, 16, v69
    v_and_b32 v51, 0xffff0000, v69
    v_lshlrev_b32 v52, 16, v70
    v_and_b32 v53, 0xffff0000, v70
    v_lshlrev_b32 v54, 16, v71
    v_and_b32 v55, 0xffff0000, v71
    v_fmac_f32 v24, s77, v48
    v_fmac_f32 v25, s77, v49
    v_fmac_f32 v26, s77, v50
    v_fmac_f32 v27, s77, v51
    v_fmac_f32 v28, s77, v52
    v_fmac_f32 v29, s77, v53
    v_fmac_f32 v30, s77, v54
    v_fmac_f32 v31, s77, v55
    s_waitcnt vmcnt(1)
    v_lshlrev_b32 v48, 16, v72
    v_and_b32 v49, 0xffff0000, v72
    v_lshlrev_b32 v50, 16, v73
    v_and_b32 v51, 0xffff0000, v73
    v_lshlrev_b32 v52, 16, v74
    v_and_b32 v53, 0xffff0000, v74
    v_lshlrev_b32 v54, 16, v75
    v_and_b32 v55, 0xffff0000, v75
    v_fmac_f32 v24, s78, v48
    v_fmac_f32 v25, s78, v49
    v_fmac_f32 v26, s78, v50
    v_fmac_f32 v27, s78, v51
    v_fmac_f32 v28, s78, v52
    v_fmac_f32 v29, s78, v53
    v_fmac_f32 v30, s78, v54
    v_fmac_f32 v31, s78, v55
    s_waitcnt vmcnt(0)
    v_lshlrev_b32 v48, 16, v76
    v_and_b32 v49, 0xffff0000, v76
    v_lshlrev_b32 v50, 16, v77
    v_and_b32 v51, 0xffff0000, v77
    v_lshlrev_b32 v52, 16, v78
    v_and_b32 v53, 0xffff0000, v78
    v_lshlrev_b32 v54, 16, v79
    v_and_b32 v55, 0xffff0000, v79
    v_fmac_f32 v24, s79, v48
    v_fmac_f32 v25, s79, v49
    v_fmac_f32 v26, s79, v50
    v_fmac_f32 v27, s79, v51
    v_fmac_f32 v28, s79, v52
    v_fmac_f32 v29, s79, v53
    v_fmac_f32 v30, s79, v54
    v_fmac_f32 v31, s79, v55
    s_mov_b32 s36, s14
    s_mov_b32 s37, s15
    s_and_b32 s37, s37, 0xffff
    s_mov_b32 s38, 4194304
    s_mov_b32 s39, 0x00020000
    v_or_b32 v40, 0, v2
    v_lshlrev_b32 v40, 1, v40
    v_xor_b32 v40, v40, v3
    v_lshlrev_b32 v40, 4, v40
    v_lshl_add_u32 v44, v2, 10, v40
    v_or_b32 v40, 4, v2
    v_lshlrev_b32 v40, 1, v40
    v_xor_b32 v40, v40, v3
    v_lshlrev_b32 v40, 4, v40
    v_lshl_add_u32 v45, v2, 10, v40
    s_lshl_b32 s61, s65, 17
    s_lshl_b32 s62, s56, 14
    s_add_u32 s61, s61, s62
    s_add_u32 s61, s61, 512
    s_lshl_b32 s62, s56, 12
    s_add_u32 s62, s62, 65536
    s_add_u32 m0, s62, 0
    s_nop 0
    buffer_load_dwordx4 v44, s[36:39], s61 offen nt lds
    s_add_u32 m0, s62, 1024
    s_add_u32 s61, s61, 4096
    buffer_load_dwordx4 v44, s[36:39], s61 offen nt lds
    s_add_u32 m0, s62, 2048
    s_add_u32 s61, s61, 4096
    buffer_load_dwordx4 v45, s[36:39], s61 offen nt lds
    s_add_u32 m0, s62, 3072
    s_add_u32 s61, s61, 4096
    buffer_load_dwordx4 v45, s[36:39], s61 offen nt lds
    s_lshl_b32 s61, s56, 11
    v_lshlrev_b32 v40, 5, v1
    v_add_u32 v40, s61, v40
    ds_write_b128 v40, v[24:27] offset:16384
    ds_write_b128 v40, v[28:31] offset:16400
    s_waitcnt lgkmcnt(0)
    s_barrier
    v_and_b32 v40, 255, v0
    v_lshlrev_b32 v40, 3, v40
    s_lshl_b32 s61, s66, 13
    v_add_u32 v40, s61, v40
    ds_read_b64 v[24:25], v40 offset:16384
    ds_read_b64 v[26:27], v40 offset:18432
    ds_read_b64 v[28:29], v40 offset:20480
    ds_read_b64 v[30:31], v40 offset:22528
    s_waitcnt lgkmcnt(0)
    v_add_f32 v24, v24, v26
    v_add_f32 v25, v25, v27
    v_add_f32 v24, v24, v28
    v_add_f32 v25, v25, v29
    v_add_f32 v24, v24, v30
    v_add_f32 v25, v25, v31
    v_cvt_pk_bf16_f32 v24, v24, v25
    v_lshlrev_b32 v40, 2, v0
    ds_write_b32 v40, v24 offset:32768
    s_waitcnt lgkmcnt(0)
    s_barrier
    s_lshl_b32 s61, s56, 7
    v_lshlrev_b32 v40, 5, v2
    v_and_b32 v41, 1, v3
    v_lshl_add_u32 v40, v41, 10, v40
    v_add_u32 v40, s61, v40
    ds_read_b128 v[8:11], v40 offset:32768
    ds_read_b128 v[12:15], v40 offset:32784
    s_waitcnt lgkmcnt(1)
    v_mfma_f32_16x16x32_bf16 v[96:99], v[8:11], v[192:195], 0
    v_mfma_f32_16x16x32_bf16 v[100:103], v[8:11], v[196:199], 0
    v_mfma_f32_16x16x32_bf16 v[104:107], v[8:11], v[200:203], 0
    v_mfma_f32_16x16x32_bf16 v[108:111], v[8:11], v[204:207], 0
    v_mfma_f32_16x16x32_bf16 v[112:115], v[8:11], v[208:211], 0
    v_mfma_f32_16x16x32_bf16 v[116:119], v[8:11], v[212:215], 0
    v_mfma_f32_16x16x32_bf16 v[120:123], v[8:11], v[216:219], 0
    v_mfma_f32_16x16x32_bf16 v[124:127], v[8:11], v[220:223], 0
    s_waitcnt lgkmcnt(0)
    v_mfma_f32_16x16x32_bf16 v[96:99], v[12:15], v[224:227], v[96:99]
    v_mfma_f32_16x16x32_bf16 v[100:103], v[12:15], v[228:231], v[100:103]
    v_mfma_f32_16x16x32_bf16 v[104:107], v[12:15], v[232:235], v[104:107]
    v_mfma_f32_16x16x32_bf16 v[108:111], v[12:15], v[236:239], v[108:111]
    v_mfma_f32_16x16x32_bf16 v[112:115], v[12:15], v[240:243], v[112:115]
    v_mfma_f32_16x16x32_bf16 v[116:119], v[12:15], v[244:247], v[116:119]
    v_mfma_f32_16x16x32_bf16 v[120:123], v[12:15], v[248:251], v[120:123]
    v_mfma_f32_16x16x32_bf16 v[124:127], v[12:15], v[252:255], v[124:127]
    v_lshlrev_b32 v40, 5, v3
    s_lshl_b32 s61, s56, 9
    v_add_u32 v40, s61, v40
    s_nop 7
    v_mov_b32 v24, v96
    v_mov_b32 v25, v100
    v_mov_b32 v26, v104
    v_mov_b32 v27, v108
    v_mov_b32 v28, v112
    v_mov_b32 v29, v116
    v_mov_b32 v30, v120
    v_mov_b32 v31, v124
    v_mov_b32 v32, v97
    v_mov_b32 v33, v101
    v_mov_b32 v34, v105
    v_mov_b32 v35, v109
    v_mov_b32 v36, v113
    v_mov_b32 v37, v117
    v_mov_b32 v38, v121
    v_mov_b32 v39, v125
    s_mov_b64 exec, 0xffff
    ds_write_b128 v40, v[24:27] offset:0
    ds_write_b128 v40, v[28:31] offset:16
    ds_write_b128 v40, v[32:35] offset:4096
    ds_write_b128 v40, v[36:39] offset:4112
    s_mov_b64 exec, -1
    s_waitcnt lgkmcnt(0)
    s_waitcnt vmcnt(0)
    s_barrier
    s_mov_b32 s79, 16
    s_mov_b32 s80, 5376
    s_cmp_ge_u32 s56, 4
    s_cbranch_scc1 L_dist
    s_cmp_lg_u32 s56, 0
    s_cbranch_scc1 Lt103_92
    v_lshrrev_b32 v40, 5, v1
    v_lshlrev_b32 v40, 12, v40
    v_and_b32 v41, 31, v1
    v_lshl_add_u32 v40, v41, 4, v40
    ds_read_b128 v[64:67], v40 offset:0
    ds_read_b128 v[68:71], v40 offset:512
    ds_read_b128 v[72:75], v40 offset:1024
    ds_read_b128 v[76:79], v40 offset:1536
    ds_read_b128 v[80:83], v40 offset:2048
    ds_read_b128 v[84:87], v40 offset:2560
    ds_read_b128 v[88:91], v40 offset:3072
    ds_read_b128 v[92:95], v40 offset:3584
    v_lshlrev_b32 v46, 3, v1
    v_add_u32 v47, 98304, v46
    s_add_u32 s61, s65, 32
    s_mul_i32 s61, s61, 16384
    s_add_u32 s61, s61, 7424
    s_waitcnt lgkmcnt(6)
    v_add_f32 v64, v64, v68
    v_add_f32 v65, v65, v69
    v_add_f32 v66, v66, v70
    v_add_f32 v67, v67, v71
    s_waitcnt lgkmcnt(5)
    v_add_f32 v64, v64, v72
    v_add_f32 v65, v65, v73
    v_add_f32 v66, v66, v74
    v_add_f32 v67, v67, v75
    s_waitcnt lgkmcnt(4)
    v_add_f32 v64, v64, v76
    v_add_f32 v65, v65, v77
    v_add_f32 v66, v66, v78
    v_add_f32 v67, v67, v79
    s_waitcnt lgkmcnt(3)
    v_add_f32 v64, v64, v80
    v_add_f32 v65, v65, v81
    v_add_f32 v66, v66, v82
    v_add_f32 v67, v67, v83
    s_waitcnt lgkmcnt(2)
    v_add_f32 v64, v64, v84
    v_add_f32 v65, v65, v85
    v_add_f32 v66, v66, v86
    v_add_f32 v67, v67, v87
    s_waitcnt lgkmcnt(1)
    v_add_f32 v64, v64, v88
    v_add_f32 v65, v65, v89
    v_add_f32 v66, v66, v90
    v_add_f32 v67, v67, v91
    s_waitcnt lgkmcnt(0)
    v_add_f32 v64, v64, v92
    v_add_f32 v65, v65, v93
    v_add_f32 v66, v66, v94
    v_add_f32 v67, v67, v95
    v_cvt_pk_bf16_f32 v64, v64, v65
    v_cvt_pk_bf16_f32 v65, v66, v67
    buffer_store_dwordx2 v[64:65], v46, s[32:35], s61 offen sc0 sc1
    ds_write_b64 v47, v[64:65]
    s_waitcnt lgkmcnt(0)
Lt103_92:
    s_barrier
    s_branch L_final
L_final:
    s_cmp_ge_u32 s56, 2
    s_cbranch_scc1 L_end
    s_lshr_b32 s66, s75, 5
    s_and_b32 s64, s75, 31
    v_lshlrev_b32 v8, 5, v1
    s_lshl_b32 s61, s56, 11
    s_add_u32 s61, s61, 3328
    s_add_u32 s61, s61, s93
    v_and_b32 v6, 1, v1
    v_lshlrev_b32 v6, 4, v6
    v_lshl_add_u32 v6, v2, 2, v6
    s_lshl_b32 s57, s66, 11
    s_lshl_b32 s58, s64, 5
    s_add_u32 s57, s57, s58
    s_xor_b32 s58, s56, 1
    s_lshl_b32 s58, s58, 10
    s_add_u32 s57, s57, s58
    s_mov_b32 s36, s26
    s_mov_b32 s37, s27
    s_and_b32 s37, s37, 0xffff
    s_mov_b32 s38, 4096
    s_mov_b32 s39, 0x00020000
    s_mov_b32 s92, 0
    buffer_load_dwordx4 v[12:15], v8, s[32:35], s61 offen sc0 sc1
    buffer_load_dwordx4 v[16:19], v8, s[32:35], s61 offen offset:16 sc0 sc1
Lp2_95:
    buffer_load_dwordx4 v[24:27], v8, s[32:35], s61 offen sc0 sc1
    buffer_load_dwordx4 v[28:31], v8, s[32:35], s61 offen offset:16 sc0 sc1
    s_waitcnt vmcnt(2)
    v_mov_b32 v22, v12
    v_max3_u32 v22, v22, v13, v14
    v_max3_u32 v22, v22, v15, v16
    v_max3_u32 v22, v22, v17, v18
    v_max_u32 v22, v22, v19
    v_cmp_eq_u32 vcc, -1, v22
    s_cbranch_vccz Lp2A_96
    buffer_load_dwordx4 v[12:15], v8, s[32:35], s61 offen sc0 sc1
    buffer_load_dwordx4 v[16:19], v8, s[32:35], s61 offen offset:16 sc0 sc1
    s_waitcnt vmcnt(2)
    v_mov_b32 v22, v24
    v_max3_u32 v22, v22, v25, v26
    v_max3_u32 v22, v22, v27, v28
    v_max3_u32 v22, v22, v29, v30
    v_max_u32 v22, v22, v31
    v_cmp_eq_u32 vcc, -1, v22
    s_cbranch_vccz Lp2B_97
    s_add_u32 s92, s92, 1
    s_cmp_lt_u32 s92, 400000
    s_cbranch_scc1 Lp2_95
Lp2B_97:
    s_waitcnt vmcnt(0)
    v_mov_b32 v12, v24
    v_mov_b32 v13, v25
    v_mov_b32 v14, v26
    v_mov_b32 v15, v27
    v_mov_b32 v16, v28
    v_mov_b32 v17, v29
    v_mov_b32 v18, v30
    v_mov_b32 v19, v31
    s_branch Lp2D_98
Lp2A_96:
Lp2D_98:
Lfsk_93:
    s_nop 1
    v_permlane32_swap_b32 v12, v16
    v_permlane32_swap_b32 v13, v17
    v_permlane32_swap_b32 v14, v18
    v_permlane32_swap_b32 v15, v19
    s_nop 1
    v_add_f32 v12, v12, v16
    v_add_f32 v13, v13, v17
    v_add_f32 v14, v14, v18
    v_add_f32 v15, v15, v19
    s_nop 1
    v_permlane16_swap_b32 v12, v14
    v_permlane16_swap_b32 v13, v15
    s_nop 1
    v_add_f32 v12, v12, v14
    v_add_f32 v13, v13, v15
    s_nop 0
    v_add_f32_dpp v12, v12, v12 row_ror:8 row_mask:0xf bank_mask:0xf
    v_add_f32_dpp v13, v13, v13 row_ror:8 row_mask:0xf bank_mask:0xf
    s_nop 0
    v_add_f32_dpp v12, v12, v12 row_ror:4 row_mask:0xf bank_mask:0xf
    v_add_f32_dpp v13, v13, v13 row_ror:4 row_mask:0xf bank_mask:0xf
    s_nop 0
    v_add_f32_dpp v12, v12, v12 quad_perm:[2,3,0,1] row_mask:0xf bank_mask:0xf
    v_add_f32_dpp v13, v13, v13 quad_perm:[2,3,0,1] row_mask:0xf bank_mask:0xf
    v_cvt_pk_bf16_f32 v12, v12, v13
    s_mov_b32 exec_lo, 0x00030003
    s_mov_b32 exec_hi, 0x00030003
    buffer_store_dword v12, v6, s[36:39], s57 offen
    s_mov_b64 exec, -1
    s_branch L_end
L_end:
    s_endpgm
.section .rodata,"a"
.p2align 6
.amdhsa_kernel concat_heads__compressed_kv_cla__gqa_block_cached__decode_kernel
  .amdhsa_next_free_vgpr 256
  .amdhsa_next_free_sgpr 102
  .amdhsa_accum_offset 256
  .amdhsa_group_segment_fixed_size 0
  .amdhsa_kernarg_size 112
  .amdhsa_user_sgpr_count 2
  .amdhsa_user_sgpr_kernarg_segment_ptr 1
  .amdhsa_system_sgpr_workgroup_id_x 1
.end_amdhsa_kernel
```

```asm
; @launch grid=(256,1,1) block=(512,1,1) lds=163840
.amdgcn_target "amdgcn-amd-amdhsa--gfx950"
.text
.globl concat_heads__compressed_kv_cla__gqa_block_cached__decode_kernel
.p2align 8
.type concat_heads__compressed_kv_cla__gqa_block_cached__decode_kernel,@function
concat_heads__compressed_kv_cla__gqa_block_cached__decode_kernel:
    s_load_dwordx16 s[4:19], s[0:1], 0
    s_load_dwordx8 s[20:27], s[0:1], 64
    s_load_dwordx4 s[28:31], s[0:1], 96
    s_cmp_ge_u32 s2, 256
    s_cbranch_scc1 L_end
    s_cmp_ge_u32 s2, 8
    s_cbranch_scc1 Lpf_1
    s_getpc_b64 s[60:61]
    s_and_b32 s60, s60, 0xffffff00
    v_lshlrev_b32 v2, 4, v0
    v_min_u32 v3, L_end-concat_heads__compressed_kv_cla__gqa_block_cached__decode_kernel-16, v2
    global_load_dwordx4 v[252:255], v3, s[60:61]
    v_add_u32 v2, 0x2000, v2
    v_min_u32 v3, L_end-concat_heads__compressed_kv_cla__gqa_block_cached__decode_kernel-16, v2
    global_load_dwordx4 v[252:255], v3, s[60:61]
    v_add_u32 v2, 0x2000, v2
    v_min_u32 v3, L_end-concat_heads__compressed_kv_cla__gqa_block_cached__decode_kernel-16, v2
    global_load_dwordx4 v[252:255], v3, s[60:61]
    v_add_u32 v2, 0x2000, v2
    v_min_u32 v3, L_end-concat_heads__compressed_kv_cla__gqa_block_cached__decode_kernel-16, v2
    global_load_dwordx4 v[252:255], v3, s[60:61]
Lpf_1:
    v_lshrrev_b32 v1, 6, v0
    s_lshr_b32 s57, s2, 3
    v_readfirstlane_b32 s56, v1
    s_and_b32 s58, s2, 7
    s_nop 0
    s_and_b32 s59, s57, 3
    s_lshl_b32 s60, s58, 2
    s_add_u32 s86, s59, s60
    s_bfe_u32 s87, s57, 0x10002
    s_bfe_u32 s88, s57, 0x10003
    s_lshr_b32 s78, s57, 4
    v_and_b32 v228, 63, v0
    v_lshrrev_b32 v229, 3, v228
    v_and_b32 v230, 7, v228
    v_lshlrev_b32 v232, 15, v229
    v_lshl_add_u32 v232, v230, 4, v232
    s_lshl_b32 s76, s56, 6
    s_lshl_b32 s62, s88, 9
    s_add_u32 s76, s76, s62
    s_lshl_b32 s77, s76, 12
    s_lshl_b32 s59, s86, 8
    s_lshl_b32 s60, s87, 7
    s_add_u32 s77, s77, s59
    s_add_u32 s77, s77, s60
    s_mov_b32 s38, 4194304
    s_mov_b32 s39, 0x00020000
    s_cmp_lt_u32 s57, 8
    s_cbranch_scc1 L_roleA
    s_waitcnt lgkmcnt(0)
    s_cmp_eq_u32 s78, 0
    s_cselect_b32 s36, s8, s22
    s_cselect_b32 s37, s9, s23
    s_cselect_b32 s40, s4, s16
    s_cselect_b32 s41, s5, s17
    s_and_b32 s37, s37, 0xffff
    buffer_load_dwordx4 v[192:195], v232, s[36:39], s77 offen nt
    s_add_u32 s77, s77, 8192
    buffer_load_dwordx4 v[196:199], v232, s[36:39], s77 offen nt
    s_add_u32 s77, s77, 8192
    buffer_load_dwordx4 v[200:203], v232, s[36:39], s77 offen nt
    s_add_u32 s77, s77, 8192
    buffer_load_dwordx4 v[204:207], v232, s[36:39], s77 offen nt
    s_and_b32 s41, s41, 0xffff
    s_mov_b32 s42, 2048
    s_mov_b32 s43, 0x00020000
    v_lshlrev_b32 v231, 3, v229
    buffer_load_dwordx2 v[208:209], v231, s[40:43], s76 offen offset:0
    buffer_load_dwordx2 v[210:211], v231, s[40:43], s76 offen offset:1024
    s_lshl_b32 s3, s78, 5
    s_add_u32 s3, s3, s86
    s_lshl_b32 s3, s3, 2
    s_add_u32 s3, s3, s88
    s_lshl_b32 s3, s3, 1
    s_add_u32 s3, s3, s87
    s_lshl_b32 s3, s3, 8
    s_add_u32 s3, s3, 1310720
    s_and_b32 s91, s86, 0xfc
    s_mov_b32 s68, 0x05040100
    s_mov_b32 s69, 0x07060302
    s_mov_b32 s32, s30
    s_and_b32 s33, s31, 0xffff
    s_mov_b32 s34, 268435456
    s_mov_b32 s35, 0x00020000
    s_mov_b32 s52, s28
    s_and_b32 s53, s29, 0xffff
    s_mov_b32 s54, 256
    s_mov_b32 s55, 0x00020000
    s_sub_u32 s57, s57, 8
    s_mul_i32 s59, s57, 43
    s_lshr_b32 s59, s59, 8
    s_mul_i32 s60, s59, 6
    s_sub_u32 s60, s57, s60
    s_mul_i32 s66, s60, 86
    s_lshr_b32 s66, s66, 8
    s_mul_i32 s61, s66, 3
    s_sub_u32 s67, s60, s61
    s_mov_b32 s64, s60
    s_mul_i32 s65, s67, 3
    s_add_u32 s65, s65, s58
    s_and_b32 s65, s65, 7
    s_lshl_b32 s65, s65, 2
    s_add_u32 s65, s65, s59
    v_and_b32 v1, 63, v0
    v_lshrrev_b32 v2, 4, v1
    v_and_b32 v3, 15, v1
    s_lshl_b32 s59, s66, 5
    s_add_u32 s59, s59, s65
    s_lshl_b32 s61, s59, 20
    s_lshl_b32 s63, s59, 8
    s_add_u32 s63, s63, 1507328
    v_lshlrev_b32 v4, 4, v1
    s_mov_b32 s70, 1040356334
    v_mov_b32 v60, 0
    s_mul_i32 s71, s67, 7
    s_add_u32 s71, s71, s56
    s_mov_b32 s46, 1048576
    s_mov_b32 s47, 0x00020000
    s_mov_b32 s50, 1048576
    s_mov_b32 s51, 0x00020000
    s_add_u32 s44, s18, s61
    s_addc_u32 s45, s19, 0
    s_and_b32 s45, s45, 0xffff
    s_add_u32 s48, s20, s61
    s_addc_u32 s49, s21, 0
    s_and_b32 s49, s49, 0xffff
    s_barrier
    s_mov_b32 s74, 512
    s_add_u32 s72, s71, 21
    s_cmp_eq_u32 s56, 7
    s_cbranch_scc1 Lpoller_2
    s_add_u32 s88, s71, 0
    s_lshl_b32 s88, s88, 1
    s_lshl_b32 s100, s88, 11
    buffer_load_dwordx4 v[64:67], v4, s[44:47], s100 offen offset:0 nt
    buffer_load_dwordx4 v[68:71], v4, s[44:47], s100 offen offset:1024 nt
    buffer_load_dwordx4 v[72:75], v4, s[48:51], s100 offen offset:0 nt
    buffer_load_dwordx4 v[76:79], v4, s[48:51], s100 offen offset:1024 nt
    s_add_u32 s88, s71, 0
    s_lshl_b32 s88, s88, 1
    s_add_u32 s88, s88, 1
    s_lshl_b32 s100, s88, 11
    s_waitcnt vmcnt(4)
    v_perm_b32 v232, v196, v192, s68
    v_perm_b32 v233, v196, v192, s69
    v_perm_b32 v234, v197, v193, s68
    v_perm_b32 v235, v197, v193, s69
    v_perm_b32 v236, v198, v194, s68
    v_perm_b32 v237, v198, v194, s69
    v_perm_b32 v238, v199, v195, s68
    v_perm_b32 v239, v199, v195, s69
    v_dot2_f32_bf16 v212, v232, v208, 0
    v_dot2_f32_bf16 v213, v233, v208, 0
    v_dot2_f32_bf16 v214, v234, v208, 0
    v_dot2_f32_bf16 v215, v235, v208, 0
    v_dot2_f32_bf16 v216, v236, v208, 0
    v_dot2_f32_bf16 v217, v237, v208, 0
    v_dot2_f32_bf16 v218, v238, v208, 0
    v_dot2_f32_bf16 v219, v239, v208, 0
    v_dot2_f32_bf16 v220, v232, v210, 0
    v_dot2_f32_bf16 v221, v233, v210, 0
    v_dot2_f32_bf16 v222, v234, v210, 0
    v_dot2_f32_bf16 v223, v235, v210, 0
    v_dot2_f32_bf16 v224, v236, v210, 0
    v_dot2_f32_bf16 v225, v237, v210, 0
    v_dot2_f32_bf16 v226, v238, v210, 0
    v_dot2_f32_bf16 v227, v239, v210, 0
    v_perm_b32 v232, v204, v200, s68
    v_perm_b32 v233, v204, v200, s69
    v_perm_b32 v234, v205, v201, s68
    v_perm_b32 v235, v205, v201, s69
    v_perm_b32 v236, v206, v202, s68
    v_perm_b32 v237, v206, v202, s69
    v_perm_b32 v238, v207, v203, s68
    v_perm_b32 v239, v207, v203, s69
    v_dot2_f32_bf16 v212, v232, v209, v212
    v_dot2_f32_bf16 v213, v233, v209, v213
    v_dot2_f32_bf16 v214, v234, v209, v214
    v_dot2_f32_bf16 v215, v235, v209, v215
    v_dot2_f32_bf16 v216, v236, v209, v216
    v_dot2_f32_bf16 v217, v237, v209, v217
    v_dot2_f32_bf16 v218, v238, v209, v218
    v_dot2_f32_bf16 v219, v239, v209, v219
    v_dot2_f32_bf16 v220, v232, v211, v220
    v_dot2_f32_bf16 v221, v233, v211, v221
    v_dot2_f32_bf16 v222, v234, v211, v222
    v_dot2_f32_bf16 v223, v235, v211, v223
    v_dot2_f32_bf16 v224, v236, v211, v224
    v_dot2_f32_bf16 v225, v237, v211, v225
    v_dot2_f32_bf16 v226, v238, v211, v226
    v_dot2_f32_bf16 v227, v239, v211, v227
    s_nop 2
    v_permlane32_swap_b32 v212, v220
    v_permlane32_swap_b32 v213, v221
    v_permlane32_swap_b32 v214, v222
    v_permlane32_swap_b32 v215, v223
    v_permlane32_swap_b32 v216, v224
    v_permlane32_swap_b32 v217, v225
    v_permlane32_swap_b32 v218, v226
    v_permlane32_swap_b32 v219, v227
    s_nop 1
    v_add_f32 v212, v212, v220
    v_add_f32 v213, v213, v221
    v_add_f32 v214, v214, v222
    v_add_f32 v215, v215, v223
    v_add_f32 v216, v216, v224
    v_add_f32 v217, v217, v225
    v_add_f32 v218, v218, v226
    v_add_f32 v219, v219, v227
    s_nop 1
    v_permlane16_swap_b32 v212, v216
    v_permlane16_swap_b32 v213, v217
    v_permlane16_swap_b32 v214, v218
    v_permlane16_swap_b32 v215, v219
    s_nop 1
    v_add_f32 v212, v212, v216
    v_add_f32 v213, v213, v217
    v_add_f32 v214, v214, v218
    v_add_f32 v215, v215, v219
    s_nop 1
    v_add_f32_dpp v212, v212, v212 row_ror:8 row_mask:0xf bank_mask:0xf
    v_add_f32_dpp v213, v213, v213 row_ror:8 row_mask:0xf bank_mask:0xf
    v_add_f32_dpp v214, v214, v214 row_ror:8 row_mask:0xf bank_mask:0xf
    v_add_f32_dpp v215, v215, v215 row_ror:8 row_mask:0xf bank_mask:0xf
    v_lshrrev_b32 v232, 5, v228
    v_lshlrev_b32 v232, 8, v232
    v_bfe_u32 v233, v228, 4, 1
    v_lshl_add_u32 v232, v233, 4, v232
    v_lshl_add_u32 v232, v230, 5, v232
    s_lshl_b32 s61, s56, 9
    s_add_u32 s61, s61, 12288
    v_add_u32 v232, s61, v232
    ds_write_b128 v232, v[212:215]
    s_waitcnt lgkmcnt(0)
    s_barrier
    s_waitcnt vmcnt(3)
    buffer_load_dwordx4 v[80:83], v4, s[44:47], s100 offen offset:0 nt
    s_waitcnt vmcnt(3)
    buffer_load_dwordx4 v[84:87], v4, s[44:47], s100 offen offset:1024 nt
    s_waitcnt vmcnt(3)
    buffer_load_dwordx4 v[88:91], v4, s[48:51], s100 offen offset:0 nt
    s_waitcnt vmcnt(3)
    buffer_load_dwordx4 v[92:95], v4, s[48:51], s100 offen offset:1024 nt
    s_add_u32 s88, s71, 21
    s_lshl_b32 s88, s88, 1
    s_lshl_b32 s100, s88, 11
    s_waitcnt vmcnt(3)
    buffer_load_dwordx4 v[96:99], v4, s[44:47], s100 offen offset:0 nt
    s_waitcnt vmcnt(3)
    buffer_load_dwordx4 v[100:103], v4, s[44:47], s100 offen offset:1024 nt
    s_waitcnt vmcnt(3)
    buffer_load_dwordx4 v[104:107], v4, s[48:51], s100 offen offset:0 nt
    s_waitcnt vmcnt(3)
    buffer_load_dwordx4 v[108:111], v4, s[48:51], s100 offen offset:1024 nt
    s_add_u32 s88, s71, 21
    s_lshl_b32 s88, s88, 1
    s_add_u32 s88, s88, 1
    s_lshl_b32 s100, s88, 11
    s_waitcnt vmcnt(3)
    buffer_load_dwordx4 v[112:115], v4, s[44:47], s100 offen offset:0 nt
    s_waitcnt vmcnt(3)
    buffer_load_dwordx4 v[116:119], v4, s[44:47], s100 offen offset:1024 nt
    s_waitcnt vmcnt(3)
    buffer_load_dwordx4 v[120:123], v4, s[48:51], s100 offen offset:0 nt
    s_waitcnt vmcnt(3)
    buffer_load_dwordx4 v[124:127], v4, s[48:51], s100 offen offset:1024 nt
    s_add_u32 s88, s71, 42
    s_lshl_b32 s88, s88, 1
    s_lshl_b32 s100, s88, 11
    s_waitcnt vmcnt(3)
    buffer_load_dwordx4 v[128:131], v4, s[44:47], s100 offen offset:0 nt
    s_waitcnt vmcnt(3)
    buffer_load_dwordx4 v[132:135], v4, s[44:47], s100 offen offset:1024 nt
    s_waitcnt vmcnt(3)
    buffer_load_dwordx4 v[136:139], v4, s[48:51], s100 offen offset:0 nt
    s_waitcnt vmcnt(3)
    buffer_load_dwordx4 v[140:143], v4, s[48:51], s100 offen offset:1024 nt
    s_add_u32 s88, s71, 42
    s_lshl_b32 s88, s88, 1
    s_add_u32 s88, s88, 1
    s_lshl_b32 s100, s88, 11
    s_waitcnt vmcnt(3)
    buffer_load_dwordx4 v[144:147], v4, s[44:47], s100 offen offset:0 nt
    s_waitcnt vmcnt(3)
    buffer_load_dwordx4 v[148:151], v4, s[44:47], s100 offen offset:1024 nt
    s_waitcnt vmcnt(3)
    buffer_load_dwordx4 v[152:155], v4, s[48:51], s100 offen offset:0 nt
    s_waitcnt vmcnt(3)
    buffer_load_dwordx4 v[156:159], v4, s[48:51], s100 offen offset:1024 nt
    s_add_u32 s88, s71, 63
    s_lshl_b32 s88, s88, 1
    s_lshl_b32 s100, s88, 11
    s_waitcnt vmcnt(3)
    buffer_load_dwordx4 v[160:163], v4, s[44:47], s100 offen offset:0 nt
    s_waitcnt vmcnt(3)
    buffer_load_dwordx4 v[164:167], v4, s[44:47], s100 offen offset:1024 nt
    s_waitcnt vmcnt(3)
    buffer_load_dwordx4 v[168:171], v4, s[48:51], s100 offen offset:0 nt
    s_waitcnt vmcnt(3)
    buffer_load_dwordx4 v[172:175], v4, s[48:51], s100 offen offset:1024 nt
    s_add_u32 s88, s71, 63
    s_lshl_b32 s88, s88, 1
    s_add_u32 s88, s88, 1
    s_lshl_b32 s100, s88, 11
    s_waitcnt vmcnt(3)
    buffer_load_dwordx4 v[176:179], v4, s[44:47], s100 offen offset:0 nt
    s_waitcnt vmcnt(3)
    buffer_load_dwordx4 v[180:183], v4, s[44:47], s100 offen offset:1024 nt
    s_waitcnt vmcnt(3)
    buffer_load_dwordx4 v[184:187], v4, s[48:51], s100 offen offset:0 nt
    s_waitcnt vmcnt(3)
    buffer_load_dwordx4 v[188:191], v4, s[48:51], s100 offen offset:1024 nt
    s_branch Ljoin_3
Lpoller_2:
    s_setprio 3
    s_waitcnt vmcnt(0)
    v_perm_b32 v232, v196, v192, s68
    v_perm_b32 v233, v196, v192, s69
    v_perm_b32 v234, v197, v193, s68
    v_perm_b32 v235, v197, v193, s69
    v_perm_b32 v236, v198, v194, s68
    v_perm_b32 v237, v198, v194, s69
    v_perm_b32 v238, v199, v195, s68
    v_perm_b32 v239, v199, v195, s69
    v_dot2_f32_bf16 v212, v232, v208, 0
    v_dot2_f32_bf16 v213, v233, v208, 0
    v_dot2_f32_bf16 v214, v234, v208, 0
    v_dot2_f32_bf16 v215, v235, v208, 0
    v_dot2_f32_bf16 v216, v236, v208, 0
    v_dot2_f32_bf16 v217, v237, v208, 0
    v_dot2_f32_bf16 v218, v238, v208, 0
    v_dot2_f32_bf16 v219, v239, v208, 0
    v_dot2_f32_bf16 v220, v232, v210, 0
    v_dot2_f32_bf16 v221, v233, v210, 0
    v_dot2_f32_bf16 v222, v234, v210, 0
    v_dot2_f32_bf16 v223, v235, v210, 0
    v_dot2_f32_bf16 v224, v236, v210, 0
    v_dot2_f32_bf16 v225, v237, v210, 0
    v_dot2_f32_bf16 v226, v238, v210, 0
    v_dot2_f32_bf16 v227, v239, v210, 0
    v_perm_b32 v232, v204, v200, s68
    v_perm_b32 v233, v204, v200, s69
    v_perm_b32 v234, v205, v201, s68
    v_perm_b32 v235, v205, v201, s69
    v_perm_b32 v236, v206, v202, s68
    v_perm_b32 v237, v206, v202, s69
    v_perm_b32 v238, v207, v203, s68
    v_perm_b32 v239, v207, v203, s69
    v_dot2_f32_bf16 v212, v232, v209, v212
    v_dot2_f32_bf16 v213, v233, v209, v213
    v_dot2_f32_bf16 v214, v234, v209, v214
    v_dot2_f32_bf16 v215, v235, v209, v215
    v_dot2_f32_bf16 v216, v236, v209, v216
    v_dot2_f32_bf16 v217, v237, v209, v217
    v_dot2_f32_bf16 v218, v238, v209, v218
    v_dot2_f32_bf16 v219, v239, v209, v219
    v_dot2_f32_bf16 v220, v232, v211, v220
    v_dot2_f32_bf16 v221, v233, v211, v221
    v_dot2_f32_bf16 v222, v234, v211, v222
    v_dot2_f32_bf16 v223, v235, v211, v223
    v_dot2_f32_bf16 v224, v236, v211, v224
    v_dot2_f32_bf16 v225, v237, v211, v225
    v_dot2_f32_bf16 v226, v238, v211, v226
    v_dot2_f32_bf16 v227, v239, v211, v227
    s_nop 2
    v_permlane32_swap_b32 v212, v220
    v_permlane32_swap_b32 v213, v221
    v_permlane32_swap_b32 v214, v222
    v_permlane32_swap_b32 v215, v223
    v_permlane32_swap_b32 v216, v224
    v_permlane32_swap_b32 v217, v225
    v_permlane32_swap_b32 v218, v226
    v_permlane32_swap_b32 v219, v227
    s_nop 1
    v_add_f32 v212, v212, v220
    v_add_f32 v213, v213, v221
    v_add_f32 v214, v214, v222
    v_add_f32 v215, v215, v223
    v_add_f32 v216, v216, v224
    v_add_f32 v217, v217, v225
    v_add_f32 v218, v218, v226
    v_add_f32 v219, v219, v227
    s_nop 1
    v_permlane16_swap_b32 v212, v216
    v_permlane16_swap_b32 v213, v217
    v_permlane16_swap_b32 v214, v218
    v_permlane16_swap_b32 v215, v219
    s_nop 1
    v_add_f32 v212, v212, v216
    v_add_f32 v213, v213, v217
    v_add_f32 v214, v214, v218
    v_add_f32 v215, v215, v219
    s_nop 1
    v_add_f32_dpp v212, v212, v212 row_ror:8 row_mask:0xf bank_mask:0xf
    v_add_f32_dpp v213, v213, v213 row_ror:8 row_mask:0xf bank_mask:0xf
    v_add_f32_dpp v214, v214, v214 row_ror:8 row_mask:0xf bank_mask:0xf
    v_add_f32_dpp v215, v215, v215 row_ror:8 row_mask:0xf bank_mask:0xf
    v_lshrrev_b32 v232, 5, v228
    v_lshlrev_b32 v232, 8, v232
    v_bfe_u32 v233, v228, 4, 1
    v_lshl_add_u32 v232, v233, 4, v232
    v_lshl_add_u32 v232, v230, 5, v232
    s_lshl_b32 s61, s56, 9
    s_add_u32 s61, s61, 12288
    v_add_u32 v232, s61, v232
    ds_write_b128 v232, v[212:215]
    s_waitcnt lgkmcnt(0)
    s_barrier
    v_mov_b32 v234, 0
    buffer_load_dword v235, v234, s[52:55], s91 offen offset:0 sc0 sc1
    v_and_b32 v232, 31, v228
    v_lshlrev_b32 v233, 4, v232
    v_add_u32 v233, 12288, v233
    ds_read_b128 v[192:195], v233 offset:0
    ds_read_b128 v[196:199], v233 offset:512
    ds_read_b128 v[200:203], v233 offset:1024
    ds_read_b128 v[204:207], v233 offset:1536
    ds_read_b128 v[208:211], v233 offset:2048
    ds_read_b128 v[212:215], v233 offset:2560
    ds_read_b128 v[216:219], v233 offset:3072
    ds_read_b128 v[220:223], v233 offset:3584
    s_waitcnt lgkmcnt(6)
    v_add_f32 v192, v192, v196
    v_add_f32 v193, v193, v197
    v_add_f32 v194, v194, v198
    v_add_f32 v195, v195, v199
    s_waitcnt lgkmcnt(5)
    v_add_f32 v192, v192, v200
    v_add_f32 v193, v193, v201
    v_add_f32 v194, v194, v202
    v_add_f32 v195, v195, v203
    s_waitcnt lgkmcnt(4)
    v_add_f32 v192, v192, v204
    v_add_f32 v193, v193, v205
    v_add_f32 v194, v194, v206
    v_add_f32 v195, v195, v207
    s_waitcnt lgkmcnt(3)
    v_add_f32 v192, v192, v208
    v_add_f32 v193, v193, v209
    v_add_f32 v194, v194, v210
    v_add_f32 v195, v195, v211
    s_waitcnt lgkmcnt(2)
    v_add_f32 v192, v192, v212
    v_add_f32 v193, v193, v213
    v_add_f32 v194, v194, v214
    v_add_f32 v195, v195, v215
    s_waitcnt lgkmcnt(1)
    v_add_f32 v192, v192, v216
    v_add_f32 v193, v193, v217
    v_add_f32 v194, v194, v218
    v_add_f32 v195, v195, v219
    s_waitcnt lgkmcnt(0)
    v_add_f32 v192, v192, v220
    v_add_f32 v193, v193, v221
    v_add_f32 v194, v194, v222
    v_add_f32 v195, v195, v223
    v_lshrrev_b32 v233, 4, v232
    v_lshlrev_b32 v233, 10, v233
    v_and_b32 v232, 15, v232
    v_lshl_add_u32 v233, v232, 4, v233
    s_waitcnt vmcnt(0)
    s_mov_b32 s92, 0
Lcf_4:
    v_readfirstlane_b32 s57, v235
    s_nop 3
    s_cmp_lg_u32 s57, 0
    s_cbranch_scc1 Lcfd_5
    s_sleep 2
    buffer_load_dword v235, v234, s[52:55], s91 offen offset:0 sc0 sc1
    s_waitcnt vmcnt(0)
    s_add_u32 s92, s92, 1
    s_cmp_lt_u32 s92, 400000
    s_cbranch_scc1 Lcf_4
Lcfd_5:
    s_mov_b64 exec, 0xffffffff
    buffer_store_dwordx4 v[192:195], v233, s[32:35], s3 offen sc0 sc1
    s_mov_b64 exec, -1
    s_cmp_ge_u32 s64, 4
    s_cselect_b32 s100, s14, s24
    s_cselect_b32 s101, s15, s25
    s_lshl_b32 s61, s65, 17
    v_mov_b32 v46, s61
    s_mov_b64 exec, 1
    global_load_dword v250, v46, s[100:101] nt
    s_mov_b64 exec, -1
    s_mov_b32 s89, 1540096
    s_load_dword s90, s[30:31], s89
    s_and_b32 s91, s65, 0xfc
    v_mov_b32 v44, 0
    v_mov_b32 v45, 0
    s_mov_b32 s92, 0
Lcf_6:
    v_readfirstlane_b32 s57, v45
    s_nop 3
    s_cmp_lg_u32 s57, 0
    s_cbranch_scc1 Lcfd_7
    s_sleep 2
    buffer_load_dword v45, v44, s[52:55], s91 offen offset:0 sc0 sc1
    s_waitcnt vmcnt(0)
    s_add_u32 s92, s92, 1
    s_cmp_lt_u32 s92, 400000
    s_cbranch_scc1 Lcf_6
Lcfd_7:
    v_lshlrev_b32 v40, 4, v1
    s_lshl_b32 s61, s65, 11
    s_lshl_b32 s62, s66, 10
    s_add_u32 s61, s61, s62
    s_add_u32 s61, s61, 1376256
    s_mov_b32 s92, 0
Lpoll_8:
    buffer_load_dwordx4 v[48:51], v40, s[32:35], s61 offen sc0 sc1
    s_waitcnt vmcnt(0)
    v_mov_b32 v41, v48
    v_max3_u32 v41, v41, v49, v50
    v_max_u32 v41, v41, v51
    v_cmpx_eq_u32 vcc, -1, v41
    s_cbranch_execz Lpolld_9
    s_sleep 4
    s_add_u32 s92, s92, 1
    s_cmp_lt_u32 s92, 400000
    s_cbranch_scc1 Lpoll_8
Lpolld_9:
    s_mov_b64 exec, -1
    v_mov_b32 v52, v48
    v_mov_b32 v53, v49
    v_mov_b32 v54, v50
    v_mov_b32 v55, v51
    s_nop 1
    v_permlane32_swap_b32 v48, v52
    v_permlane32_swap_b32 v49, v53
    v_permlane32_swap_b32 v50, v54
    v_permlane32_swap_b32 v51, v55
    s_nop 1
    v_add_f32 v48, v48, v52
    v_add_f32 v49, v49, v53
    v_add_f32 v50, v50, v54
    v_add_f32 v51, v51, v55
    v_cvt_pk_bf16_f32 v48, v48, v49
    v_cvt_pk_bf16_f32 v49, v50, v51
    v_mov_b32 v44, 0
    s_mov_b32 s92, 0
Lcf_10:
    buffer_load_dword v45, v44, s[52:55], 0 offen offset:128 sc0 sc1
    s_waitcnt vmcnt(0)
    v_readfirstlane_b32 s57, v45
    s_nop 3
    s_cmp_ge_u32 s57, 64
    s_cbranch_scc1 Lcfd_11
    s_sleep 16
    s_add_u32 s92, s92, 1
    s_cmp_lt_u32 s92, 400000
    s_cbranch_scc1 Lcf_10
Lcfd_11:
    v_and_b32 v42, 31, v1
    v_lshlrev_b32 v42, 3, v42
    ds_write_b64 v42, v[48:49] offset:0
    s_waitcnt lgkmcnt(0)
    v_mov_b32 v40, 0xff7fffff
    v_mov_b32 v41, 0
    v_mov_b32 v42, 56
    ds_write_b64 v42, v[40:41] offset:8192
    v_mov_b32 v40, 0
    v_lshlrev_b32 v42, 3, v1
    ds_write_b64 v42, v[40:41] offset:7680
    v_mov_b32 v42, 256
    ds_write_b32 v42, v40
    v_mov_b32 v41, 0
    v_mov_b32 v43, 260
    ds_write_b32 v43, v41
    ds_write_b32 v43, v41 offset:4
    v_mov_b32 v43, 98816
    ds_write_b32 v43, v41
    s_mul_i32 s61, s67, 24
    s_add_u32 s61, s61, 168
    v_add_u32 v40, s61, v1
    v_cmp_gt_u32 vcc, 24, v1
    v_mov_b32 v41, -1
    v_lshlrev_b32 v43, 2, v1
    v_cndmask_b32 v40, v41, v40, vcc
    ds_write_b32 v43, v40 offset:1024
    ds_write_b32 v43, v41 offset:1280
    ds_write_b32 v43, v41 offset:1536
    ds_write_b32 v43, v41 offset:1792
    ds_write_b32 v43, v41 offset:2048
    ds_write_b32 v43, v41 offset:2304
    ds_write_b32 v43, v41 offset:2560
    ds_write_b32 v43, v41 offset:2816
    v_mov_b32 v40, 7
    ds_write_b32 v42, v40
    s_waitcnt lgkmcnt(0)
    s_barrier
    s_mov_b32 s84, 24
    s_mov_b32 s86, 18
    s_mov_b32 s87, 13
    s_mov_b32 s90, 14
    v_mov_b32 v42, 256
    s_mov_b32 s92, 0
Lprod_12:
    s_add_u32 s92, s92, 1
    s_cmp_gt_u32 s92, 400000
    s_cbranch_scc1 Lprods_14
    ds_read_b32 v40, v42
    s_waitcnt lgkmcnt(0)
    v_readfirstlane_b32 s85, v40
    s_nop 3
    s_add_u32 s85, s85, s86
    s_sub_i32 s85, s85, s84
    s_cmp_gt_i32 s85, s87
    s_cbranch_scc1 Lprodg_15
    s_sleep 1
    s_branch Lprod_12
Lprodg_15:
    s_min_u32 s85, s85, s90
    s_add_u32 s88, s30, s63
    s_addc_u32 s89, s31, 0
    s_mov_b32 s62, s85
    s_atomic_add s62, s[88:89], 0x0 glc
    s_bfm_b64 exec, s85, 0
    s_waitcnt lgkmcnt(0)
    v_add_u32 v44, s62, v1
    s_cmp_ge_u32 s62, 65676
    s_cselect_b32 s86, 8, s86
    s_cselect_b32 s87, 5, s87
    s_cselect_b32 s90, 6, s90
    v_add_u32 v44, 4294902000, v44
    v_cmp_gt_u32 vcc, 512, v44
    s_mov_b64 s[94:95], exec
    s_nop 1
    v_mbcnt_lo_u32_b32 v45, vcc_lo, 0
    s_bcnt1_i32_b64 s85, vcc
    v_add_u32 v45, s84, v45
    v_lshlrev_b32 v45, 2, v45
    s_mov_b64 exec, vcc
    s_cbranch_execz Lprodn_16
    ds_write_b32 v45, v44 offset:1024
Lprodn_16:
    s_add_u32 s84, s84, s85
    s_cmp_eq_u64 vcc, s[94:95]
    s_mov_b64 exec, -1
    s_cbranch_scc1 Lprod_12
Lprods_14:
    s_mov_b64 exec, -1
    v_add_u32 v45, s84, v1
    v_lshlrev_b32 v45, 2, v45
    v_mov_b32 v44, 0x1000
    s_mov_b64 exec, 0xff
    ds_write_b32 v45, v44 offset:1024
    s_mov_b64 exec, -1
    s_waitcnt lgkmcnt(0)
    v_mov_b32 v43, 260
    s_mov_b32 s92, 0
Ldk_19:
    ds_read_b32 v40, v43
    s_waitcnt lgkmcnt(0)
    v_readfirstlane_b32 s62, v40
    s_nop 3
    s_cmp_ge_u32 s62, 3
    s_cbranch_scc1 Ldkd_20
    s_sleep 1
    s_add_u32 s92, s92, 1
    s_cmp_lt_u32 s92, 400000
    s_cbranch_scc1 Ldk_19
Ldkd_20:
    s_and_b32 s79, s64, 3
    s_lshl_b32 s79, s79, 3
    s_cmp_ge_u32 s64, 4
    s_cselect_b32 s80, 5376, 0
    s_cselect_b32 s62, 0, 1
    s_mul_i32 s62, s62, 3328
    s_add_u32 s80, s80, s62
    s_cmp_ge_u32 s64, 4
    s_cselect_b32 s100, s14, s24
    s_cselect_b32 s101, s15, s25
    s_lshl_b32 s62, s79, 5
    s_mov_b32 s36, s100
    s_mov_b32 s37, s101
    s_and_b32 s37, s37, 0xffff
    s_mov_b32 s38, 4194304
    s_mov_b32 s39, 0x00020000
    v_or_b32 v40, 0, v2
    v_lshlrev_b32 v40, 1, v40
    v_xor_b32 v40, v40, v3
    v_lshlrev_b32 v40, 4, v40
    v_lshl_add_u32 v44, v2, 10, v40
    v_or_b32 v40, 4, v2
    v_lshlrev_b32 v40, 1, v40
    v_xor_b32 v40, v40, v3
    v_lshlrev_b32 v40, 4, v40
    v_lshl_add_u32 v45, v2, 10, v40
    s_lshl_b32 s61, s65, 17
    s_add_u32 s61, s61, s62
    s_mov_b32 m0, 65536
    s_nop 0
    buffer_load_dwordx4 v44, s[36:39], s61 offen nt lds
    s_mov_b32 m0, 66560
    s_add_u32 s61, s61, 4096
    buffer_load_dwordx4 v44, s[36:39], s61 offen nt lds
    s_mov_b32 m0, 67584
    s_add_u32 s61, s61, 4096
    buffer_load_dwordx4 v45, s[36:39], s61 offen nt lds
    s_mov_b32 m0, 68608
    s_add_u32 s61, s61, 4096
    buffer_load_dwordx4 v45, s[36:39], s61 offen nt lds
    s_mov_b32 m0, 69632
    s_add_u32 s61, s61, 4096
    buffer_load_dwordx4 v44, s[36:39], s61 offen nt lds
    s_mov_b32 m0, 70656
    s_add_u32 s61, s61, 4096
    buffer_load_dwordx4 v44, s[36:39], s61 offen nt lds
    s_mov_b32 m0, 71680
    s_add_u32 s61, s61, 4096
    buffer_load_dwordx4 v45, s[36:39], s61 offen nt lds
    s_mov_b32 m0, 72704
    s_add_u32 s61, s61, 4096
    buffer_load_dwordx4 v45, s[36:39], s61 offen nt lds
    s_mov_b32 m0, 73728
    s_add_u32 s61, s61, 4096
    buffer_load_dwordx4 v44, s[36:39], s61 offen nt lds
    s_mov_b32 m0, 74752
    s_add_u32 s61, s61, 4096
    buffer_load_dwordx4 v44, s[36:39], s61 offen nt lds
    s_mov_b32 m0, 75776
    s_add_u32 s61, s61, 4096
    buffer_load_dwordx4 v45, s[36:39], s61 offen nt lds
    s_mov_b32 m0, 76800
    s_add_u32 s61, s61, 4096
    buffer_load_dwordx4 v45, s[36:39], s61 offen nt lds
    s_mov_b32 m0, 77824
    s_add_u32 s61, s61, 4096
    buffer_load_dwordx4 v44, s[36:39], s61 offen nt lds
    s_mov_b32 m0, 78848
    s_add_u32 s61, s61, 4096
    buffer_load_dwordx4 v44, s[36:39], s61 offen nt lds
    s_mov_b32 m0, 79872
    s_add_u32 s61, s61, 4096
    buffer_load_dwordx4 v45, s[36:39], s61 offen nt lds
    s_mov_b32 m0, 80896
    s_add_u32 s61, s61, 4096
    buffer_load_dwordx4 v45, s[36:39], s61 offen nt lds
    s_mov_b32 m0, 81920
    s_add_u32 s61, s61, 4096
    buffer_load_dwordx4 v44, s[36:39], s61 offen nt lds
    s_mov_b32 m0, 82944
    s_add_u32 s61, s61, 4096
    buffer_load_dwordx4 v44, s[36:39], s61 offen nt lds
    s_mov_b32 m0, 83968
    s_add_u32 s61, s61, 4096
    buffer_load_dwordx4 v45, s[36:39], s61 offen nt lds
    s_mov_b32 m0, 84992
    s_add_u32 s61, s61, 4096
    buffer_load_dwordx4 v45, s[36:39], s61 offen nt lds
    s_mov_b32 m0, 86016
    s_add_u32 s61, s61, 4096
    buffer_load_dwordx4 v44, s[36:39], s61 offen nt lds
    s_mov_b32 m0, 87040
    s_add_u32 s61, s61, 4096
    buffer_load_dwordx4 v44, s[36:39], s61 offen nt lds
    s_mov_b32 m0, 88064
    s_add_u32 s61, s61, 4096
    buffer_load_dwordx4 v45, s[36:39], s61 offen nt lds
    s_mov_b32 m0, 89088
    s_add_u32 s61, s61, 4096
    buffer_load_dwordx4 v45, s[36:39], s61 offen nt lds
    s_mov_b32 m0, 90112
    s_add_u32 s61, s61, 4096
    buffer_load_dwordx4 v44, s[36:39], s61 offen nt lds
    s_mov_b32 m0, 91136
    s_add_u32 s61, s61, 4096
    buffer_load_dwordx4 v44, s[36:39], s61 offen nt lds
    s_mov_b32 m0, 92160
    s_add_u32 s61, s61, 4096
    buffer_load_dwordx4 v45, s[36:39], s61 offen nt lds
    s_mov_b32 m0, 93184
    s_add_u32 s61, s61, 4096
    buffer_load_dwordx4 v45, s[36:39], s61 offen nt lds
    s_mov_b32 m0, 94208
    s_add_u32 s61, s61, 4096
    buffer_load_dwordx4 v44, s[36:39], s61 offen nt lds
    s_mov_b32 m0, 95232
    s_add_u32 s61, s61, 4096
    buffer_load_dwordx4 v44, s[36:39], s61 offen nt lds
    s_mov_b32 m0, 96256
    s_add_u32 s61, s61, 4096
    buffer_load_dwordx4 v45, s[36:39], s61 offen nt lds
    s_mov_b32 m0, 97280
    s_add_u32 s61, s61, 4096
    buffer_load_dwordx4 v45, s[36:39], s61 offen nt lds
    s_barrier
    s_cmp_ge_u32 s64, 4
    s_cbranch_scc1 Ljoba_21
    s_waitcnt vmcnt(0)
    v_mov_b32 v40, 1
    v_mov_b32 v43, 98816
    ds_write_b32 v43, v40
    s_waitcnt lgkmcnt(0)
    s_branch L_dist
Ljoba_21:
    s_add_u32 s61, s65, 32
    s_mul_i32 s61, s61, 16384
    s_add_u32 s61, s61, 7424
    v_lshlrev_b32 v46, 3, v1
    s_mov_b32 s92, 0
Lpoll_22:
    buffer_load_dwordx2 v[48:49], v46, s[32:35], s61 offen sc0 sc1
    s_waitcnt vmcnt(0)
    v_mov_b32 v45, v48
    v_max_u32 v45, v45, v49
    v_cmpx_eq_u32 vcc, -1, v45
    s_cbranch_execz Lpolld_23
    s_sleep 2
    s_add_u32 s92, s92, 1
    s_cmp_lt_u32 s92, 400000
    s_cbranch_scc1 Lpoll_22
Lpolld_23:
    s_mov_b64 exec, -1
    v_add_u32 v46, 98304, v46
    ds_write_b64 v46, v[48:49]
    s_waitcnt lgkmcnt(0)
    v_mov_b32 v40, 1
    v_mov_b32 v43, 98816
    ds_write_b32 v43, v40
    s_waitcnt lgkmcnt(0)
    s_branch L_dist
    s_barrier
    s_branch L_end
Ljoin_3:
    s_barrier
    v_lshlrev_b32 v40, 4, v3
    ds_read_b128 v[24:27], v40 offset:0
    s_mul_i32 s62, s67, 7
    s_add_u32 s62, s62, s56
    s_add_u32 s73, s62, 168
    s_mul_i32 s61, s67, 24
    s_add_u32 s61, s61, 168
    s_add_u32 s73, s61, s56
    s_mov_b32 s83, 228
    v_mov_b32 v61, 256
    v_mov_b32 v5, 1
    v_mov_b32 v36, 0xff7fffff
    v_mov_b32 v37, 0
    v_mov_b32 v16, 0
    v_mov_b32 v17, 0
    v_mov_b32 v18, 0
    v_mov_b32 v19, 0
    v_mov_b32 v20, 0
    v_mov_b32 v21, 0
    v_mov_b32 v22, 0
    v_mov_b32 v23, 0
    v_lshlrev_b32 v6, 5, v3
    v_lshl_add_u32 v6, v2, 3, v6
    s_lshl_b32 s61, s56, 9
    v_add_u32 v7, s61, v6
    s_waitcnt lgkmcnt(0)
    s_lshl_b32 s100, s73, 11
    s_mov_b32 s71, s73
    v_dot2_f32_bf16 v28, v64, v24, 0
    v_dot2_f32_bf16 v28, v65, v25, v28
    v_dot2_f32_bf16 v28, v66, v26, v28
    v_dot2_f32_bf16 v28, v67, v27, v28
    s_waitcnt vmcnt(6)
    buffer_load_dwordx4 v[64:67], v4, s[44:47], s100 offen offset:0 nt
    v_dot2_f32_bf16 v29, v68, v24, 0
    v_dot2_f32_bf16 v29, v69, v25, v29
    v_dot2_f32_bf16 v29, v70, v26, v29
    v_dot2_f32_bf16 v29, v71, v27, v29
    s_waitcnt vmcnt(6)
    buffer_load_dwordx4 v[68:71], v4, s[44:47], s100 offen offset:1024 nt
    s_nop 2
    v_add_f32_dpp v28, v28, v28 row_ror:8 row_mask:0xf bank_mask:0xf
    v_add_f32_dpp v29, v29, v29 row_ror:8 row_mask:0xf bank_mask:0xf
    s_nop 0
    v_add_f32_dpp v28, v28, v28 row_ror:4 row_mask:0xf bank_mask:0xf
    v_add_f32_dpp v29, v29, v29 row_ror:4 row_mask:0xf bank_mask:0xf
    s_nop 0
    v_add_f32_dpp v28, v28, v28 row_ror:2 row_mask:0xf bank_mask:0xf
    v_add_f32_dpp v29, v29, v29 row_ror:2 row_mask:0xf bank_mask:0xf
    s_nop 0
    v_add_f32_dpp v28, v28, v28 row_ror:1 row_mask:0xf bank_mask:0xf
    v_add_f32_dpp v29, v29, v29 row_ror:1 row_mask:0xf bank_mask:0xf
    s_nop 0
    v_max3_f32 v38, v36, v28, v29
    v_sub_f32 v39, v36, v38
    v_mul_f32 v39, s70, v39
    v_exp_f32 v39, v39
    v_mul_f32 v56, s70, v38
    v_mov_b32 v36, v38
    v_fma_f32 v48, v28, s70, -v56
    v_fma_f32 v49, v29, s70, -v56
    v_exp_f32 v48, v48
    v_exp_f32 v49, v49
    v_mul_f32 v37, v37, v39
    v_mul_f32 v16, v16, v39
    v_mul_f32 v17, v17, v39
    v_mul_f32 v18, v18, v39
    v_mul_f32 v19, v19, v39
    v_mul_f32 v20, v20, v39
    v_mul_f32 v21, v21, v39
    v_mul_f32 v22, v22, v39
    v_mul_f32 v23, v23, v39
    v_add_f32 v37, v37, v48
    v_add_f32 v37, v37, v49
    v_lshlrev_b32 v40, 16, v72
    v_and_b32 v41, 0xffff0000, v72
    v_lshlrev_b32 v42, 16, v73
    v_and_b32 v43, 0xffff0000, v73
    v_lshlrev_b32 v44, 16, v74
    v_and_b32 v45, 0xffff0000, v74
    v_lshlrev_b32 v46, 16, v75
    v_and_b32 v47, 0xffff0000, v75
    s_waitcnt vmcnt(6)
    buffer_load_dwordx4 v[72:75], v4, s[48:51], s100 offen offset:0 nt
    v_fmac_f32 v16, v40, v48
    v_fmac_f32 v17, v41, v48
    v_fmac_f32 v18, v42, v48
    v_fmac_f32 v19, v43, v48
    v_fmac_f32 v20, v44, v48
    v_fmac_f32 v21, v45, v48
    v_fmac_f32 v22, v46, v48
    v_fmac_f32 v23, v47, v48
    v_lshlrev_b32 v40, 16, v76
    v_and_b32 v41, 0xffff0000, v76
    v_lshlrev_b32 v42, 16, v77
    v_and_b32 v43, 0xffff0000, v77
    v_lshlrev_b32 v44, 16, v78
    v_and_b32 v45, 0xffff0000, v78
    v_lshlrev_b32 v46, 16, v79
    v_and_b32 v47, 0xffff0000, v79
    s_waitcnt vmcnt(6)
    buffer_load_dwordx4 v[76:79], v4, s[48:51], s100 offen offset:1024 nt
    v_fmac_f32 v16, v40, v49
    v_fmac_f32 v17, v41, v49
    v_fmac_f32 v18, v42, v49
    v_fmac_f32 v19, v43, v49
    v_fmac_f32 v20, v44, v49
    v_fmac_f32 v21, v45, v49
    v_fmac_f32 v22, v46, v49
    v_fmac_f32 v23, v47, v49
    s_waitcnt vmcnt(6)
    s_mov_b64 s[94:95], exec
    s_mov_b64 exec, 1
    ds_add_rtn_u32 v59, v61, v5
    s_mov_b64 exec, s[94:95]
    s_waitcnt lgkmcnt(0)
    s_mov_b64 exec, 1
    v_lshlrev_b32 v59, 2, v59
    s_mov_b32 s92, 0
Lpop_28:
    ds_read_b32 v62, v59 offset:1024
    s_waitcnt lgkmcnt(0)
    v_readfirstlane_b32 s73, v62
    s_nop 3
    s_cmp_lg_u32 s73, -1
    s_cbranch_scc1 Lpopd_29
    s_sleep 1
    s_add_u32 s92, s92, 1
    s_cmp_lt_u32 s92, 400000
    s_cbranch_scc1 Lpop_28
Lpopd_29:
    s_mov_b64 exec, -1
Lquit_30:
    s_waitcnt vmcnt(24)
    v_dot2_f32_bf16 v28, v96, v24, 0
    v_dot2_f32_bf16 v28, v97, v25, v28
    v_dot2_f32_bf16 v28, v98, v26, v28
    v_dot2_f32_bf16 v28, v99, v27, v28
    v_dot2_f32_bf16 v29, v100, v24, 0
    v_dot2_f32_bf16 v29, v101, v25, v29
    v_dot2_f32_bf16 v29, v102, v26, v29
    v_dot2_f32_bf16 v29, v103, v27, v29
    s_nop 2
    v_add_f32_dpp v28, v28, v28 row_ror:8 row_mask:0xf bank_mask:0xf
    v_add_f32_dpp v29, v29, v29 row_ror:8 row_mask:0xf bank_mask:0xf
    s_nop 0
    v_add_f32_dpp v28, v28, v28 row_ror:4 row_mask:0xf bank_mask:0xf
    v_add_f32_dpp v29, v29, v29 row_ror:4 row_mask:0xf bank_mask:0xf
    s_nop 0
    v_add_f32_dpp v28, v28, v28 row_ror:2 row_mask:0xf bank_mask:0xf
    v_add_f32_dpp v29, v29, v29 row_ror:2 row_mask:0xf bank_mask:0xf
    s_nop 0
    v_add_f32_dpp v28, v28, v28 row_ror:1 row_mask:0xf bank_mask:0xf
    v_add_f32_dpp v29, v29, v29 row_ror:1 row_mask:0xf bank_mask:0xf
    s_nop 0
    v_max3_f32 v38, v36, v28, v29
    v_sub_f32 v39, v36, v38
    v_mul_f32 v39, s70, v39
    v_exp_f32 v39, v39
    v_mul_f32 v56, s70, v38
    v_mov_b32 v36, v38
    v_fma_f32 v48, v28, s70, -v56
    v_fma_f32 v49, v29, s70, -v56
    v_exp_f32 v48, v48
    v_exp_f32 v49, v49
    v_mul_f32 v37, v37, v39
    v_mul_f32 v16, v16, v39
    v_mul_f32 v17, v17, v39
    v_mul_f32 v18, v18, v39
    v_mul_f32 v19, v19, v39
    v_mul_f32 v20, v20, v39
    v_mul_f32 v21, v21, v39
    v_mul_f32 v22, v22, v39
    v_mul_f32 v23, v23, v39
    v_add_f32 v37, v37, v48
    v_add_f32 v37, v37, v49
    v_lshlrev_b32 v40, 16, v104
    v_and_b32 v41, 0xffff0000, v104
    v_lshlrev_b32 v42, 16, v105
    v_and_b32 v43, 0xffff0000, v105
    v_lshlrev_b32 v44, 16, v106
    v_and_b32 v45, 0xffff0000, v106
    v_lshlrev_b32 v46, 16, v107
    v_and_b32 v47, 0xffff0000, v107
    v_fmac_f32 v16, v40, v48
    v_fmac_f32 v17, v41, v48
    v_fmac_f32 v18, v42, v48
    v_fmac_f32 v19, v43, v48
    v_fmac_f32 v20, v44, v48
    v_fmac_f32 v21, v45, v48
    v_fmac_f32 v22, v46, v48
    v_fmac_f32 v23, v47, v48
    v_lshlrev_b32 v40, 16, v108
    v_and_b32 v41, 0xffff0000, v108
    v_lshlrev_b32 v42, 16, v109
    v_and_b32 v43, 0xffff0000, v109
    v_lshlrev_b32 v44, 16, v110
    v_and_b32 v45, 0xffff0000, v110
    v_lshlrev_b32 v46, 16, v111
    v_and_b32 v47, 0xffff0000, v111
    v_fmac_f32 v16, v40, v49
    v_fmac_f32 v17, v41, v49
    v_fmac_f32 v18, v42, v49
    v_fmac_f32 v19, v43, v49
    v_fmac_f32 v20, v44, v49
    v_fmac_f32 v21, v45, v49
    v_fmac_f32 v22, v46, v49
    v_fmac_f32 v23, v47, v49
    s_waitcnt vmcnt(20)
    v_dot2_f32_bf16 v28, v112, v24, 0
    v_dot2_f32_bf16 v28, v113, v25, v28
    v_dot2_f32_bf16 v28, v114, v26, v28
    v_dot2_f32_bf16 v28, v115, v27, v28
    v_dot2_f32_bf16 v29, v116, v24, 0
    v_dot2_f32_bf16 v29, v117, v25, v29
    v_dot2_f32_bf16 v29, v118, v26, v29
    v_dot2_f32_bf16 v29, v119, v27, v29
    s_nop 2
    v_add_f32_dpp v28, v28, v28 row_ror:8 row_mask:0xf bank_mask:0xf
    v_add_f32_dpp v29, v29, v29 row_ror:8 row_mask:0xf bank_mask:0xf
    s_nop 0
    v_add_f32_dpp v28, v28, v28 row_ror:4 row_mask:0xf bank_mask:0xf
    v_add_f32_dpp v29, v29, v29 row_ror:4 row_mask:0xf bank_mask:0xf
    s_nop 0
    v_add_f32_dpp v28, v28, v28 row_ror:2 row_mask:0xf bank_mask:0xf
    v_add_f32_dpp v29, v29, v29 row_ror:2 row_mask:0xf bank_mask:0xf
    s_nop 0
    v_add_f32_dpp v28, v28, v28 row_ror:1 row_mask:0xf bank_mask:0xf
    v_add_f32_dpp v29, v29, v29 row_ror:1 row_mask:0xf bank_mask:0xf
    s_nop 0
    v_max3_f32 v38, v36, v28, v29
    v_sub_f32 v39, v36, v38
    v_mul_f32 v39, s70, v39
    v_exp_f32 v39, v39
    v_mul_f32 v56, s70, v38
    v_mov_b32 v36, v38
    v_fma_f32 v48, v28, s70, -v56
    v_fma_f32 v49, v29, s70, -v56
    v_exp_f32 v48, v48
    v_exp_f32 v49, v49
    v_mul_f32 v37, v37, v39
    v_mul_f32 v16, v16, v39
    v_mul_f32 v17, v17, v39
    v_mul_f32 v18, v18, v39
    v_mul_f32 v19, v19, v39
    v_mul_f32 v20, v20, v39
    v_mul_f32 v21, v21, v39
    v_mul_f32 v22, v22, v39
    v_mul_f32 v23, v23, v39
    v_add_f32 v37, v37, v48
    v_add_f32 v37, v37, v49
    v_lshlrev_b32 v40, 16, v120
    v_and_b32 v41, 0xffff0000, v120
    v_lshlrev_b32 v42, 16, v121
    v_and_b32 v43, 0xffff0000, v121
    v_lshlrev_b32 v44, 16, v122
    v_and_b32 v45, 0xffff0000, v122
    v_lshlrev_b32 v46, 16, v123
    v_and_b32 v47, 0xffff0000, v123
    v_fmac_f32 v16, v40, v48
    v_fmac_f32 v17, v41, v48
    v_fmac_f32 v18, v42, v48
    v_fmac_f32 v19, v43, v48
    v_fmac_f32 v20, v44, v48
    v_fmac_f32 v21, v45, v48
    v_fmac_f32 v22, v46, v48
    v_fmac_f32 v23, v47, v48
    v_lshlrev_b32 v40, 16, v124
    v_and_b32 v41, 0xffff0000, v124
    v_lshlrev_b32 v42, 16, v125
    v_and_b32 v43, 0xffff0000, v125
    v_lshlrev_b32 v44, 16, v126
    v_and_b32 v45, 0xffff0000, v126
    v_lshlrev_b32 v46, 16, v127
    v_and_b32 v47, 0xffff0000, v127
    v_fmac_f32 v16, v40, v49
    v_fmac_f32 v17, v41, v49
    v_fmac_f32 v18, v42, v49
    v_fmac_f32 v19, v43, v49
    v_fmac_f32 v20, v44, v49
    v_fmac_f32 v21, v45, v49
    v_fmac_f32 v22, v46, v49
    v_fmac_f32 v23, v47, v49
    s_waitcnt vmcnt(16)
    v_dot2_f32_bf16 v28, v128, v24, 0
    v_dot2_f32_bf16 v28, v129, v25, v28
    v_dot2_f32_bf16 v28, v130, v26, v28
    v_dot2_f32_bf16 v28, v131, v27, v28
    v_dot2_f32_bf16 v29, v132, v24, 0
    v_dot2_f32_bf16 v29, v133, v25, v29
    v_dot2_f32_bf16 v29, v134, v26, v29
    v_dot2_f32_bf16 v29, v135, v27, v29
    s_nop 2
    v_add_f32_dpp v28, v28, v28 row_ror:8 row_mask:0xf bank_mask:0xf
    v_add_f32_dpp v29, v29, v29 row_ror:8 row_mask:0xf bank_mask:0xf
    s_nop 0
    v_add_f32_dpp v28, v28, v28 row_ror:4 row_mask:0xf bank_mask:0xf
    v_add_f32_dpp v29, v29, v29 row_ror:4 row_mask:0xf bank_mask:0xf
    s_nop 0
    v_add_f32_dpp v28, v28, v28 row_ror:2 row_mask:0xf bank_mask:0xf
    v_add_f32_dpp v29, v29, v29 row_ror:2 row_mask:0xf bank_mask:0xf
    s_nop 0
    v_add_f32_dpp v28, v28, v28 row_ror:1 row_mask:0xf bank_mask:0xf
    v_add_f32_dpp v29, v29, v29 row_ror:1 row_mask:0xf bank_mask:0xf
    s_nop 0
    v_max3_f32 v38, v36, v28, v29
    v_sub_f32 v39, v36, v38
    v_mul_f32 v39, s70, v39
    v_exp_f32 v39, v39
    v_mul_f32 v56, s70, v38
    v_mov_b32 v36, v38
    v_fma_f32 v48, v28, s70, -v56
    v_fma_f32 v49, v29, s70, -v56
    v_exp_f32 v48, v48
    v_exp_f32 v49, v49
    v_mul_f32 v37, v37, v39
    v_mul_f32 v16, v16, v39
    v_mul_f32 v17, v17, v39
    v_mul_f32 v18, v18, v39
    v_mul_f32 v19, v19, v39
    v_mul_f32 v20, v20, v39
    v_mul_f32 v21, v21, v39
    v_mul_f32 v22, v22, v39
    v_mul_f32 v23, v23, v39
    v_add_f32 v37, v37, v48
    v_add_f32 v37, v37, v49
    v_lshlrev_b32 v40, 16, v136
    v_and_b32 v41, 0xffff0000, v136
    v_lshlrev_b32 v42, 16, v137
    v_and_b32 v43, 0xffff0000, v137
    v_lshlrev_b32 v44, 16, v138
    v_and_b32 v45, 0xffff0000, v138
    v_lshlrev_b32 v46, 16, v139
    v_and_b32 v47, 0xffff0000, v139
    v_fmac_f32 v16, v40, v48
    v_fmac_f32 v17, v41, v48
    v_fmac_f32 v18, v42, v48
    v_fmac_f32 v19, v43, v48
    v_fmac_f32 v20, v44, v48
    v_fmac_f32 v21, v45, v48
    v_fmac_f32 v22, v46, v48
    v_fmac_f32 v23, v47, v48
    v_lshlrev_b32 v40, 16, v140
    v_and_b32 v41, 0xffff0000, v140
    v_lshlrev_b32 v42, 16, v141
    v_and_b32 v43, 0xffff0000, v141
    v_lshlrev_b32 v44, 16, v142
    v_and_b32 v45, 0xffff0000, v142
    v_lshlrev_b32 v46, 16, v143
    v_and_b32 v47, 0xffff0000, v143
    v_fmac_f32 v16, v40, v49
    v_fmac_f32 v17, v41, v49
    v_fmac_f32 v18, v42, v49
    v_fmac_f32 v19, v43, v49
    v_fmac_f32 v20, v44, v49
    v_fmac_f32 v21, v45, v49
    v_fmac_f32 v22, v46, v49
    v_fmac_f32 v23, v47, v49
    s_lshl_b32 s100, s73, 11
    s_mov_b32 s72, s73
    v_dot2_f32_bf16 v28, v80, v24, 0
    v_dot2_f32_bf16 v28, v81, v25, v28
    v_dot2_f32_bf16 v28, v82, v26, v28
    v_dot2_f32_bf16 v28, v83, v27, v28
    s_waitcnt vmcnt(6)
    buffer_load_dwordx4 v[80:83], v4, s[44:47], s100 offen offset:0 nt
    v_dot2_f32_bf16 v29, v84, v24, 0
    v_dot2_f32_bf16 v29, v85, v25, v29
    v_dot2_f32_bf16 v29, v86, v26, v29
    v_dot2_f32_bf16 v29, v87, v27, v29
    s_waitcnt vmcnt(6)
    buffer_load_dwordx4 v[84:87], v4, s[44:47], s100 offen offset:1024 nt
    s_nop 2
    v_add_f32_dpp v28, v28, v28 row_ror:8 row_mask:0xf bank_mask:0xf
    v_add_f32_dpp v29, v29, v29 row_ror:8 row_mask:0xf bank_mask:0xf
    s_nop 0
    v_add_f32_dpp v28, v28, v28 row_ror:4 row_mask:0xf bank_mask:0xf
    v_add_f32_dpp v29, v29, v29 row_ror:4 row_mask:0xf bank_mask:0xf
    s_nop 0
    v_add_f32_dpp v28, v28, v28 row_ror:2 row_mask:0xf bank_mask:0xf
    v_add_f32_dpp v29, v29, v29 row_ror:2 row_mask:0xf bank_mask:0xf
    s_nop 0
    v_add_f32_dpp v28, v28, v28 row_ror:1 row_mask:0xf bank_mask:0xf
    v_add_f32_dpp v29, v29, v29 row_ror:1 row_mask:0xf bank_mask:0xf
    s_nop 0
    v_max3_f32 v38, v36, v28, v29
    v_sub_f32 v39, v36, v38
    v_mul_f32 v39, s70, v39
    v_exp_f32 v39, v39
    v_mul_f32 v56, s70, v38
    v_mov_b32 v36, v38
    v_fma_f32 v48, v28, s70, -v56
    v_fma_f32 v49, v29, s70, -v56
    v_exp_f32 v48, v48
    v_exp_f32 v49, v49
    v_mul_f32 v37, v37, v39
    v_mul_f32 v16, v16, v39
    v_mul_f32 v17, v17, v39
    v_mul_f32 v18, v18, v39
    v_mul_f32 v19, v19, v39
    v_mul_f32 v20, v20, v39
    v_mul_f32 v21, v21, v39
    v_mul_f32 v22, v22, v39
    v_mul_f32 v23, v23, v39
    v_add_f32 v37, v37, v48
    v_add_f32 v37, v37, v49
    v_lshlrev_b32 v40, 16, v88
    v_and_b32 v41, 0xffff0000, v88
    v_lshlrev_b32 v42, 16, v89
    v_and_b32 v43, 0xffff0000, v89
    v_lshlrev_b32 v44, 16, v90
    v_and_b32 v45, 0xffff0000, v90
    v_lshlrev_b32 v46, 16, v91
    v_and_b32 v47, 0xffff0000, v91
    s_waitcnt vmcnt(6)
    buffer_load_dwordx4 v[88:91], v4, s[48:51], s100 offen offset:0 nt
    v_fmac_f32 v16, v40, v48
    v_fmac_f32 v17, v41, v48
    v_fmac_f32 v18, v42, v48
    v_fmac_f32 v19, v43, v48
    v_fmac_f32 v20, v44, v48
    v_fmac_f32 v21, v45, v48
    v_fmac_f32 v22, v46, v48
    v_fmac_f32 v23, v47, v48
    v_lshlrev_b32 v40, 16, v92
    v_and_b32 v41, 0xffff0000, v92
    v_lshlrev_b32 v42, 16, v93
    v_and_b32 v43, 0xffff0000, v93
    v_lshlrev_b32 v44, 16, v94
    v_and_b32 v45, 0xffff0000, v94
    v_lshlrev_b32 v46, 16, v95
    v_and_b32 v47, 0xffff0000, v95
    s_waitcnt vmcnt(6)
    buffer_load_dwordx4 v[92:95], v4, s[48:51], s100 offen offset:1024 nt
    v_fmac_f32 v16, v40, v49
    v_fmac_f32 v17, v41, v49
    v_fmac_f32 v18, v42, v49
    v_fmac_f32 v19, v43, v49
    v_fmac_f32 v20, v44, v49
    v_fmac_f32 v21, v45, v49
    v_fmac_f32 v22, v46, v49
    v_fmac_f32 v23, v47, v49
    s_waitcnt vmcnt(6)
    s_mov_b64 s[94:95], exec
    s_mov_b64 exec, 1
    ds_add_rtn_u32 v59, v61, v5
    s_mov_b64 exec, s[94:95]
    s_waitcnt lgkmcnt(0)
    s_mov_b64 exec, 1
    v_lshlrev_b32 v59, 2, v59
    s_mov_b32 s92, 0
Lpop_31:
    ds_read_b32 v62, v59 offset:1024
    s_waitcnt lgkmcnt(0)
    v_readfirstlane_b32 s73, v62
    s_nop 3
    s_cmp_lg_u32 s73, -1
    s_cbranch_scc1 Lpopd_32
    s_sleep 1
    s_add_u32 s92, s92, 1
    s_cmp_lt_u32 s92, 400000
    s_cbranch_scc1 Lpop_31
Lpopd_32:
    s_mov_b64 exec, -1
Lquit_33:
    s_waitcnt vmcnt(16)
    v_dot2_f32_bf16 v28, v144, v24, 0
    v_dot2_f32_bf16 v28, v145, v25, v28
    v_dot2_f32_bf16 v28, v146, v26, v28
    v_dot2_f32_bf16 v28, v147, v27, v28
    v_dot2_f32_bf16 v29, v148, v24, 0
    v_dot2_f32_bf16 v29, v149, v25, v29
    v_dot2_f32_bf16 v29, v150, v26, v29
    v_dot2_f32_bf16 v29, v151, v27, v29
    s_nop 2
    v_add_f32_dpp v28, v28, v28 row_ror:8 row_mask:0xf bank_mask:0xf
    v_add_f32_dpp v29, v29, v29 row_ror:8 row_mask:0xf bank_mask:0xf
    s_nop 0
    v_add_f32_dpp v28, v28, v28 row_ror:4 row_mask:0xf bank_mask:0xf
    v_add_f32_dpp v29, v29, v29 row_ror:4 row_mask:0xf bank_mask:0xf
    s_nop 0
    v_add_f32_dpp v28, v28, v28 row_ror:2 row_mask:0xf bank_mask:0xf
    v_add_f32_dpp v29, v29, v29 row_ror:2 row_mask:0xf bank_mask:0xf
    s_nop 0
    v_add_f32_dpp v28, v28, v28 row_ror:1 row_mask:0xf bank_mask:0xf
    v_add_f32_dpp v29, v29, v29 row_ror:1 row_mask:0xf bank_mask:0xf
    s_nop 0
    v_max3_f32 v38, v36, v28, v29
    v_sub_f32 v39, v36, v38
    v_mul_f32 v39, s70, v39
    v_exp_f32 v39, v39
    v_mul_f32 v56, s70, v38
    v_mov_b32 v36, v38
    v_fma_f32 v48, v28, s70, -v56
    v_fma_f32 v49, v29, s70, -v56
    v_exp_f32 v48, v48
    v_exp_f32 v49, v49
    v_mul_f32 v37, v37, v39
    v_mul_f32 v16, v16, v39
    v_mul_f32 v17, v17, v39
    v_mul_f32 v18, v18, v39
    v_mul_f32 v19, v19, v39
    v_mul_f32 v20, v20, v39
    v_mul_f32 v21, v21, v39
    v_mul_f32 v22, v22, v39
    v_mul_f32 v23, v23, v39
    v_add_f32 v37, v37, v48
    v_add_f32 v37, v37, v49
    v_lshlrev_b32 v40, 16, v152
    v_and_b32 v41, 0xffff0000, v152
    v_lshlrev_b32 v42, 16, v153
    v_and_b32 v43, 0xffff0000, v153
    v_lshlrev_b32 v44, 16, v154
    v_and_b32 v45, 0xffff0000, v154
    v_lshlrev_b32 v46, 16, v155
    v_and_b32 v47, 0xffff0000, v155
    v_fmac_f32 v16, v40, v48
    v_fmac_f32 v17, v41, v48
    v_fmac_f32 v18, v42, v48
    v_fmac_f32 v19, v43, v48
    v_fmac_f32 v20, v44, v48
    v_fmac_f32 v21, v45, v48
    v_fmac_f32 v22, v46, v48
    v_fmac_f32 v23, v47, v48
    v_lshlrev_b32 v40, 16, v156
    v_and_b32 v41, 0xffff0000, v156
    v_lshlrev_b32 v42, 16, v157
    v_and_b32 v43, 0xffff0000, v157
    v_lshlrev_b32 v44, 16, v158
    v_and_b32 v45, 0xffff0000, v158
    v_lshlrev_b32 v46, 16, v159
    v_and_b32 v47, 0xffff0000, v159
    v_fmac_f32 v16, v40, v49
    v_fmac_f32 v17, v41, v49
    v_fmac_f32 v18, v42, v49
    v_fmac_f32 v19, v43, v49
    v_fmac_f32 v20, v44, v49
    v_fmac_f32 v21, v45, v49
    v_fmac_f32 v22, v46, v49
    v_fmac_f32 v23, v47, v49
    s_waitcnt vmcnt(12)
    v_dot2_f32_bf16 v28, v160, v24, 0
    v_dot2_f32_bf16 v28, v161, v25, v28
    v_dot2_f32_bf16 v28, v162, v26, v28
    v_dot2_f32_bf16 v28, v163, v27, v28
    v_dot2_f32_bf16 v29, v164, v24, 0
    v_dot2_f32_bf16 v29, v165, v25, v29
    v_dot2_f32_bf16 v29, v166, v26, v29
    v_dot2_f32_bf16 v29, v167, v27, v29
    s_nop 2
    v_add_f32_dpp v28, v28, v28 row_ror:8 row_mask:0xf bank_mask:0xf
    v_add_f32_dpp v29, v29, v29 row_ror:8 row_mask:0xf bank_mask:0xf
    s_nop 0
    v_add_f32_dpp v28, v28, v28 row_ror:4 row_mask:0xf bank_mask:0xf
    v_add_f32_dpp v29, v29, v29 row_ror:4 row_mask:0xf bank_mask:0xf
    s_nop 0
    v_add_f32_dpp v28, v28, v28 row_ror:2 row_mask:0xf bank_mask:0xf
    v_add_f32_dpp v29, v29, v29 row_ror:2 row_mask:0xf bank_mask:0xf
    s_nop 0
    v_add_f32_dpp v28, v28, v28 row_ror:1 row_mask:0xf bank_mask:0xf
    v_add_f32_dpp v29, v29, v29 row_ror:1 row_mask:0xf bank_mask:0xf
    s_nop 0
    v_max3_f32 v38, v36, v28, v29
    v_sub_f32 v39, v36, v38
    v_mul_f32 v39, s70, v39
    v_exp_f32 v39, v39
    v_mul_f32 v56, s70, v38
    v_mov_b32 v36, v38
    v_fma_f32 v48, v28, s70, -v56
    v_fma_f32 v49, v29, s70, -v56
    v_exp_f32 v48, v48
    v_exp_f32 v49, v49
    v_mul_f32 v37, v37, v39
    v_mul_f32 v16, v16, v39
    v_mul_f32 v17, v17, v39
    v_mul_f32 v18, v18, v39
    v_mul_f32 v19, v19, v39
    v_mul_f32 v20, v20, v39
    v_mul_f32 v21, v21, v39
    v_mul_f32 v22, v22, v39
    v_mul_f32 v23, v23, v39
    v_add_f32 v37, v37, v48
    v_add_f32 v37, v37, v49
    v_lshlrev_b32 v40, 16, v168
    v_and_b32 v41, 0xffff0000, v168
    v_lshlrev_b32 v42, 16, v169
    v_and_b32 v43, 0xffff0000, v169
    v_lshlrev_b32 v44, 16, v170
    v_and_b32 v45, 0xffff0000, v170
    v_lshlrev_b32 v46, 16, v171
    v_and_b32 v47, 0xffff0000, v171
    v_fmac_f32 v16, v40, v48
    v_fmac_f32 v17, v41, v48
    v_fmac_f32 v18, v42, v48
    v_fmac_f32 v19, v43, v48
    v_fmac_f32 v20, v44, v48
    v_fmac_f32 v21, v45, v48
    v_fmac_f32 v22, v46, v48
    v_fmac_f32 v23, v47, v48
    v_lshlrev_b32 v40, 16, v172
    v_and_b32 v41, 0xffff0000, v172
    v_lshlrev_b32 v42, 16, v173
    v_and_b32 v43, 0xffff0000, v173
    v_lshlrev_b32 v44, 16, v174
    v_and_b32 v45, 0xffff0000, v174
    v_lshlrev_b32 v46, 16, v175
    v_and_b32 v47, 0xffff0000, v175
    v_fmac_f32 v16, v40, v49
    v_fmac_f32 v17, v41, v49
    v_fmac_f32 v18, v42, v49
    v_fmac_f32 v19, v43, v49
    v_fmac_f32 v20, v44, v49
    v_fmac_f32 v21, v45, v49
    v_fmac_f32 v22, v46, v49
    v_fmac_f32 v23, v47, v49
    s_waitcnt vmcnt(8)
    v_dot2_f32_bf16 v28, v176, v24, 0
    v_dot2_f32_bf16 v28, v177, v25, v28
    v_dot2_f32_bf16 v28, v178, v26, v28
    v_dot2_f32_bf16 v28, v179, v27, v28
    v_dot2_f32_bf16 v29, v180, v24, 0
    v_dot2_f32_bf16 v29, v181, v25, v29
    v_dot2_f32_bf16 v29, v182, v26, v29
    v_dot2_f32_bf16 v29, v183, v27, v29
    s_nop 2
    v_add_f32_dpp v28, v28, v28 row_ror:8 row_mask:0xf bank_mask:0xf
    v_add_f32_dpp v29, v29, v29 row_ror:8 row_mask:0xf bank_mask:0xf
    s_nop 0
    v_add_f32_dpp v28, v28, v28 row_ror:4 row_mask:0xf bank_mask:0xf
    v_add_f32_dpp v29, v29, v29 row_ror:4 row_mask:0xf bank_mask:0xf
    s_nop 0
    v_add_f32_dpp v28, v28, v28 row_ror:2 row_mask:0xf bank_mask:0xf
    v_add_f32_dpp v29, v29, v29 row_ror:2 row_mask:0xf bank_mask:0xf
    s_nop 0
    v_add_f32_dpp v28, v28, v28 row_ror:1 row_mask:0xf bank_mask:0xf
    v_add_f32_dpp v29, v29, v29 row_ror:1 row_mask:0xf bank_mask:0xf
    s_nop 0
    v_max3_f32 v38, v36, v28, v29
    v_sub_f32 v39, v36, v38
    v_mul_f32 v39, s70, v39
    v_exp_f32 v39, v39
    v_mul_f32 v56, s70, v38
    v_mov_b32 v36, v38
    v_fma_f32 v48, v28, s70, -v56
    v_fma_f32 v49, v29, s70, -v56
    v_exp_f32 v48, v48
    v_exp_f32 v49, v49
    v_mul_f32 v37, v37, v39
    v_mul_f32 v16, v16, v39
    v_mul_f32 v17, v17, v39
    v_mul_f32 v18, v18, v39
    v_mul_f32 v19, v19, v39
    v_mul_f32 v20, v20, v39
    v_mul_f32 v21, v21, v39
    v_mul_f32 v22, v22, v39
    v_mul_f32 v23, v23, v39
    v_add_f32 v37, v37, v48
    v_add_f32 v37, v37, v49
    v_lshlrev_b32 v40, 16, v184
    v_and_b32 v41, 0xffff0000, v184
    v_lshlrev_b32 v42, 16, v185
    v_and_b32 v43, 0xffff0000, v185
    v_lshlrev_b32 v44, 16, v186
    v_and_b32 v45, 0xffff0000, v186
    v_lshlrev_b32 v46, 16, v187
    v_and_b32 v47, 0xffff0000, v187
    v_fmac_f32 v16, v40, v48
    v_fmac_f32 v17, v41, v48
    v_fmac_f32 v18, v42, v48
    v_fmac_f32 v19, v43, v48
    v_fmac_f32 v20, v44, v48
    v_fmac_f32 v21, v45, v48
    v_fmac_f32 v22, v46, v48
    v_fmac_f32 v23, v47, v48
    v_lshlrev_b32 v40, 16, v188
    v_and_b32 v41, 0xffff0000, v188
    v_lshlrev_b32 v42, 16, v189
    v_and_b32 v43, 0xffff0000, v189
    v_lshlrev_b32 v44, 16, v190
    v_and_b32 v45, 0xffff0000, v190
    v_lshlrev_b32 v46, 16, v191
    v_and_b32 v47, 0xffff0000, v191
    v_fmac_f32 v16, v40, v49
    v_fmac_f32 v17, v41, v49
    v_fmac_f32 v18, v42, v49
    v_fmac_f32 v19, v43, v49
    v_fmac_f32 v20, v44, v49
    v_fmac_f32 v21, v45, v49
    v_fmac_f32 v22, v46, v49
    v_fmac_f32 v23, v47, v49
LBloop2_26:
    s_cmp_ge_u32 s73, s74
    s_cbranch_scc1 LBtail0_34
    s_lshl_b32 s100, s73, 11
    s_mov_b32 s71, s73
    v_dot2_f32_bf16 v28, v64, v24, 0
    v_dot2_f32_bf16 v28, v65, v25, v28
    v_dot2_f32_bf16 v28, v66, v26, v28
    v_dot2_f32_bf16 v28, v67, v27, v28
    s_waitcnt vmcnt(6)
    buffer_load_dwordx4 v[64:67], v4, s[44:47], s100 offen offset:0 nt
    v_dot2_f32_bf16 v29, v68, v24, 0
    v_dot2_f32_bf16 v29, v69, v25, v29
    v_dot2_f32_bf16 v29, v70, v26, v29
    v_dot2_f32_bf16 v29, v71, v27, v29
    s_waitcnt vmcnt(6)
    buffer_load_dwordx4 v[68:71], v4, s[44:47], s100 offen offset:1024 nt
    s_nop 2
    v_add_f32_dpp v28, v28, v28 row_ror:8 row_mask:0xf bank_mask:0xf
    v_add_f32_dpp v29, v29, v29 row_ror:8 row_mask:0xf bank_mask:0xf
    s_nop 0
    v_add_f32_dpp v28, v28, v28 row_ror:4 row_mask:0xf bank_mask:0xf
    v_add_f32_dpp v29, v29, v29 row_ror:4 row_mask:0xf bank_mask:0xf
    s_nop 0
    v_add_f32_dpp v28, v28, v28 row_ror:2 row_mask:0xf bank_mask:0xf
    v_add_f32_dpp v29, v29, v29 row_ror:2 row_mask:0xf bank_mask:0xf
    s_nop 0
    v_add_f32_dpp v28, v28, v28 row_ror:1 row_mask:0xf bank_mask:0xf
    v_add_f32_dpp v29, v29, v29 row_ror:1 row_mask:0xf bank_mask:0xf
    s_nop 0
    v_max3_f32 v38, v36, v28, v29
    v_sub_f32 v39, v36, v38
    v_mul_f32 v39, s70, v39
    v_exp_f32 v39, v39
    v_mul_f32 v56, s70, v38
    v_mov_b32 v36, v38
    v_fma_f32 v48, v28, s70, -v56
    v_fma_f32 v49, v29, s70, -v56
    v_exp_f32 v48, v48
    v_exp_f32 v49, v49
    v_mul_f32 v37, v37, v39
    v_mul_f32 v16, v16, v39
    v_mul_f32 v17, v17, v39
    v_mul_f32 v18, v18, v39
    v_mul_f32 v19, v19, v39
    v_mul_f32 v20, v20, v39
    v_mul_f32 v21, v21, v39
    v_mul_f32 v22, v22, v39
    v_mul_f32 v23, v23, v39
    v_add_f32 v37, v37, v48
    v_add_f32 v37, v37, v49
    v_lshlrev_b32 v40, 16, v72
    v_and_b32 v41, 0xffff0000, v72
    v_lshlrev_b32 v42, 16, v73
    v_and_b32 v43, 0xffff0000, v73
    v_lshlrev_b32 v44, 16, v74
    v_and_b32 v45, 0xffff0000, v74
    v_lshlrev_b32 v46, 16, v75
    v_and_b32 v47, 0xffff0000, v75
    s_waitcnt vmcnt(6)
    buffer_load_dwordx4 v[72:75], v4, s[48:51], s100 offen offset:0 nt
    v_fmac_f32 v16, v40, v48
    v_fmac_f32 v17, v41, v48
    v_fmac_f32 v18, v42, v48
    v_fmac_f32 v19, v43, v48
    v_fmac_f32 v20, v44, v48
    v_fmac_f32 v21, v45, v48
    v_fmac_f32 v22, v46, v48
    v_fmac_f32 v23, v47, v48
    v_lshlrev_b32 v40, 16, v76
    v_and_b32 v41, 0xffff0000, v76
    v_lshlrev_b32 v42, 16, v77
    v_and_b32 v43, 0xffff0000, v77
    v_lshlrev_b32 v44, 16, v78
    v_and_b32 v45, 0xffff0000, v78
    v_lshlrev_b32 v46, 16, v79
    v_and_b32 v47, 0xffff0000, v79
    s_waitcnt vmcnt(6)
    buffer_load_dwordx4 v[76:79], v4, s[48:51], s100 offen offset:1024 nt
    v_fmac_f32 v16, v40, v49
    v_fmac_f32 v17, v41, v49
    v_fmac_f32 v18, v42, v49
    v_fmac_f32 v19, v43, v49
    v_fmac_f32 v20, v44, v49
    v_fmac_f32 v21, v45, v49
    v_fmac_f32 v22, v46, v49
    v_fmac_f32 v23, v47, v49
    s_waitcnt vmcnt(6)
    s_mov_b64 s[94:95], exec
    s_mov_b64 exec, 1
    ds_add_rtn_u32 v59, v61, v5
    s_mov_b64 exec, s[94:95]
    s_waitcnt lgkmcnt(0)
    s_mov_b64 exec, 1
    v_lshlrev_b32 v59, 2, v59
    s_mov_b32 s92, 0
Lpop_36:
    ds_read_b32 v62, v59 offset:1024
    s_waitcnt lgkmcnt(0)
    v_readfirstlane_b32 s73, v62
    s_nop 3
    s_cmp_lg_u32 s73, -1
    s_cbranch_scc1 Lpopd_37
    s_sleep 1
    s_add_u32 s92, s92, 1
    s_cmp_lt_u32 s92, 400000
    s_cbranch_scc1 Lpop_36
Lpopd_37:
    s_mov_b64 exec, -1
Lquit_38:
LBloop2b_27:
    s_cmp_ge_u32 s73, s74
    s_cbranch_scc1 LBtail1_35
    s_lshl_b32 s100, s73, 11
    s_mov_b32 s72, s73
    v_dot2_f32_bf16 v28, v80, v24, 0
    v_dot2_f32_bf16 v28, v81, v25, v28
    v_dot2_f32_bf16 v28, v82, v26, v28
    v_dot2_f32_bf16 v28, v83, v27, v28
    s_waitcnt vmcnt(6)
    buffer_load_dwordx4 v[80:83], v4, s[44:47], s100 offen offset:0 nt
    v_dot2_f32_bf16 v29, v84, v24, 0
    v_dot2_f32_bf16 v29, v85, v25, v29
    v_dot2_f32_bf16 v29, v86, v26, v29
    v_dot2_f32_bf16 v29, v87, v27, v29
    s_waitcnt vmcnt(6)
    buffer_load_dwordx4 v[84:87], v4, s[44:47], s100 offen offset:1024 nt
    s_nop 2
    v_add_f32_dpp v28, v28, v28 row_ror:8 row_mask:0xf bank_mask:0xf
    v_add_f32_dpp v29, v29, v29 row_ror:8 row_mask:0xf bank_mask:0xf
    s_nop 0
    v_add_f32_dpp v28, v28, v28 row_ror:4 row_mask:0xf bank_mask:0xf
    v_add_f32_dpp v29, v29, v29 row_ror:4 row_mask:0xf bank_mask:0xf
    s_nop 0
    v_add_f32_dpp v28, v28, v28 row_ror:2 row_mask:0xf bank_mask:0xf
    v_add_f32_dpp v29, v29, v29 row_ror:2 row_mask:0xf bank_mask:0xf
    s_nop 0
    v_add_f32_dpp v28, v28, v28 row_ror:1 row_mask:0xf bank_mask:0xf
    v_add_f32_dpp v29, v29, v29 row_ror:1 row_mask:0xf bank_mask:0xf
    s_nop 0
    v_max3_f32 v38, v36, v28, v29
    v_sub_f32 v39, v36, v38
    v_mul_f32 v39, s70, v39
    v_exp_f32 v39, v39
    v_mul_f32 v56, s70, v38
    v_mov_b32 v36, v38
    v_fma_f32 v48, v28, s70, -v56
    v_fma_f32 v49, v29, s70, -v56
    v_exp_f32 v48, v48
    v_exp_f32 v49, v49
    v_mul_f32 v37, v37, v39
    v_mul_f32 v16, v16, v39
    v_mul_f32 v17, v17, v39
    v_mul_f32 v18, v18, v39
    v_mul_f32 v19, v19, v39
    v_mul_f32 v20, v20, v39
    v_mul_f32 v21, v21, v39
    v_mul_f32 v22, v22, v39
    v_mul_f32 v23, v23, v39
    v_add_f32 v37, v37, v48
    v_add_f32 v37, v37, v49
    v_lshlrev_b32 v40, 16, v88
    v_and_b32 v41, 0xffff0000, v88
    v_lshlrev_b32 v42, 16, v89
    v_and_b32 v43, 0xffff0000, v89
    v_lshlrev_b32 v44, 16, v90
    v_and_b32 v45, 0xffff0000, v90
    v_lshlrev_b32 v46, 16, v91
    v_and_b32 v47, 0xffff0000, v91
    s_waitcnt vmcnt(6)
    buffer_load_dwordx4 v[88:91], v4, s[48:51], s100 offen offset:0 nt
    v_fmac_f32 v16, v40, v48
    v_fmac_f32 v17, v41, v48
    v_fmac_f32 v18, v42, v48
    v_fmac_f32 v19, v43, v48
    v_fmac_f32 v20, v44, v48
    v_fmac_f32 v21, v45, v48
    v_fmac_f32 v22, v46, v48
    v_fmac_f32 v23, v47, v48
    v_lshlrev_b32 v40, 16, v92
    v_and_b32 v41, 0xffff0000, v92
    v_lshlrev_b32 v42, 16, v93
    v_and_b32 v43, 0xffff0000, v93
    v_lshlrev_b32 v44, 16, v94
    v_and_b32 v45, 0xffff0000, v94
    v_lshlrev_b32 v46, 16, v95
    v_and_b32 v47, 0xffff0000, v95
    s_waitcnt vmcnt(6)
    buffer_load_dwordx4 v[92:95], v4, s[48:51], s100 offen offset:1024 nt
    v_fmac_f32 v16, v40, v49
    v_fmac_f32 v17, v41, v49
    v_fmac_f32 v18, v42, v49
    v_fmac_f32 v19, v43, v49
    v_fmac_f32 v20, v44, v49
    v_fmac_f32 v21, v45, v49
    v_fmac_f32 v22, v46, v49
    v_fmac_f32 v23, v47, v49
    s_waitcnt vmcnt(6)
    s_mov_b64 s[94:95], exec
    s_mov_b64 exec, 1
    ds_add_rtn_u32 v59, v61, v5
    s_mov_b64 exec, s[94:95]
    s_waitcnt lgkmcnt(0)
    s_mov_b64 exec, 1
    v_lshlrev_b32 v59, 2, v59
    s_mov_b32 s92, 0
Lpop_39:
    ds_read_b32 v62, v59 offset:1024
    s_waitcnt lgkmcnt(0)
    v_readfirstlane_b32 s73, v62
    s_nop 3
    s_cmp_lg_u32 s73, -1
    s_cbranch_scc1 Lpopd_40
    s_sleep 1
    s_add_u32 s92, s92, 1
    s_cmp_lt_u32 s92, 400000
    s_cbranch_scc1 Lpop_39
Lpopd_40:
    s_mov_b64 exec, -1
Lquit_41:
    s_branch LBloop2_26
LBtail0_34:
    s_waitcnt vmcnt(7)
    v_dot2_f32_bf16 v28, v64, v24, 0
    v_dot2_f32_bf16 v28, v65, v25, v28
    v_dot2_f32_bf16 v28, v66, v26, v28
    v_dot2_f32_bf16 v28, v67, v27, v28
    s_waitcnt vmcnt(6)
    v_dot2_f32_bf16 v29, v68, v24, 0
    v_dot2_f32_bf16 v29, v69, v25, v29
    v_dot2_f32_bf16 v29, v70, v26, v29
    v_dot2_f32_bf16 v29, v71, v27, v29
    s_nop 2
    v_add_f32_dpp v28, v28, v28 row_ror:8 row_mask:0xf bank_mask:0xf
    v_add_f32_dpp v29, v29, v29 row_ror:8 row_mask:0xf bank_mask:0xf
    s_nop 0
    v_add_f32_dpp v28, v28, v28 row_ror:4 row_mask:0xf bank_mask:0xf
    v_add_f32_dpp v29, v29, v29 row_ror:4 row_mask:0xf bank_mask:0xf
    s_nop 0
    v_add_f32_dpp v28, v28, v28 row_ror:2 row_mask:0xf bank_mask:0xf
    v_add_f32_dpp v29, v29, v29 row_ror:2 row_mask:0xf bank_mask:0xf
    s_nop 0
    v_add_f32_dpp v28, v28, v28 row_ror:1 row_mask:0xf bank_mask:0xf
    v_add_f32_dpp v29, v29, v29 row_ror:1 row_mask:0xf bank_mask:0xf
    s_nop 0
    v_max3_f32 v38, v36, v28, v29
    v_sub_f32 v39, v36, v38
    v_mul_f32 v39, s70, v39
    v_exp_f32 v39, v39
    v_mul_f32 v56, s70, v38
    v_mov_b32 v36, v38
    v_fma_f32 v48, v28, s70, -v56
    v_fma_f32 v49, v29, s70, -v56
    v_exp_f32 v48, v48
    v_exp_f32 v49, v49
    v_mul_f32 v37, v37, v39
    v_mul_f32 v16, v16, v39
    v_mul_f32 v17, v17, v39
    v_mul_f32 v18, v18, v39
    v_mul_f32 v19, v19, v39
    v_mul_f32 v20, v20, v39
    v_mul_f32 v21, v21, v39
    v_mul_f32 v22, v22, v39
    v_mul_f32 v23, v23, v39
    v_add_f32 v37, v37, v48
    v_add_f32 v37, v37, v49
    s_waitcnt vmcnt(5)
    v_lshlrev_b32 v40, 16, v72
    v_and_b32 v41, 0xffff0000, v72
    v_lshlrev_b32 v42, 16, v73
    v_and_b32 v43, 0xffff0000, v73
    v_lshlrev_b32 v44, 16, v74
    v_and_b32 v45, 0xffff0000, v74
    v_lshlrev_b32 v46, 16, v75
    v_and_b32 v47, 0xffff0000, v75
    v_fmac_f32 v16, v40, v48
    v_fmac_f32 v17, v41, v48
    v_fmac_f32 v18, v42, v48
    v_fmac_f32 v19, v43, v48
    v_fmac_f32 v20, v44, v48
    v_fmac_f32 v21, v45, v48
    v_fmac_f32 v22, v46, v48
    v_fmac_f32 v23, v47, v48
    s_waitcnt vmcnt(4)
    v_lshlrev_b32 v40, 16, v76
    v_and_b32 v41, 0xffff0000, v76
    v_lshlrev_b32 v42, 16, v77
    v_and_b32 v43, 0xffff0000, v77
    v_lshlrev_b32 v44, 16, v78
    v_and_b32 v45, 0xffff0000, v78
    v_lshlrev_b32 v46, 16, v79
    v_and_b32 v47, 0xffff0000, v79
    v_fmac_f32 v16, v40, v49
    v_fmac_f32 v17, v41, v49
    v_fmac_f32 v18, v42, v49
    v_fmac_f32 v19, v43, v49
    v_fmac_f32 v20, v44, v49
    v_fmac_f32 v21, v45, v49
    v_fmac_f32 v22, v46, v49
    v_fmac_f32 v23, v47, v49
    s_waitcnt vmcnt(3)
    v_dot2_f32_bf16 v28, v80, v24, 0
    v_dot2_f32_bf16 v28, v81, v25, v28
    v_dot2_f32_bf16 v28, v82, v26, v28
    v_dot2_f32_bf16 v28, v83, v27, v28
    s_waitcnt vmcnt(2)
    v_dot2_f32_bf16 v29, v84, v24, 0
    v_dot2_f32_bf16 v29, v85, v25, v29
    v_dot2_f32_bf16 v29, v86, v26, v29
    v_dot2_f32_bf16 v29, v87, v27, v29
    s_nop 2
    v_add_f32_dpp v28, v28, v28 row_ror:8 row_mask:0xf bank_mask:0xf
    v_add_f32_dpp v29, v29, v29 row_ror:8 row_mask:0xf bank_mask:0xf
    s_nop 0
    v_add_f32_dpp v28, v28, v28 row_ror:4 row_mask:0xf bank_mask:0xf
    v_add_f32_dpp v29, v29, v29 row_ror:4 row_mask:0xf bank_mask:0xf
    s_nop 0
    v_add_f32_dpp v28, v28, v28 row_ror:2 row_mask:0xf bank_mask:0xf
    v_add_f32_dpp v29, v29, v29 row_ror:2 row_mask:0xf bank_mask:0xf
    s_nop 0
    v_add_f32_dpp v28, v28, v28 row_ror:1 row_mask:0xf bank_mask:0xf
    v_add_f32_dpp v29, v29, v29 row_ror:1 row_mask:0xf bank_mask:0xf
    s_nop 0
    v_max3_f32 v38, v36, v28, v29
    v_sub_f32 v39, v36, v38
    v_mul_f32 v39, s70, v39
    v_exp_f32 v39, v39
    v_mul_f32 v56, s70, v38
    v_mov_b32 v36, v38
    v_fma_f32 v48, v28, s70, -v56
    v_fma_f32 v49, v29, s70, -v56
    v_exp_f32 v48, v48
    v_exp_f32 v49, v49
    v_mul_f32 v37, v37, v39
    v_mul_f32 v16, v16, v39
    v_mul_f32 v17, v17, v39
    v_mul_f32 v18, v18, v39
    v_mul_f32 v19, v19, v39
    v_mul_f32 v20, v20, v39
    v_mul_f32 v21, v21, v39
    v_mul_f32 v22, v22, v39
    v_mul_f32 v23, v23, v39
    v_add_f32 v37, v37, v48
    v_add_f32 v37, v37, v49
    s_waitcnt vmcnt(1)
    v_lshlrev_b32 v40, 16, v88
    v_and_b32 v41, 0xffff0000, v88
    v_lshlrev_b32 v42, 16, v89
    v_and_b32 v43, 0xffff0000, v89
    v_lshlrev_b32 v44, 16, v90
    v_and_b32 v45, 0xffff0000, v90
    v_lshlrev_b32 v46, 16, v91
    v_and_b32 v47, 0xffff0000, v91
    v_fmac_f32 v16, v40, v48
    v_fmac_f32 v17, v41, v48
    v_fmac_f32 v18, v42, v48
    v_fmac_f32 v19, v43, v48
    v_fmac_f32 v20, v44, v48
    v_fmac_f32 v21, v45, v48
    v_fmac_f32 v22, v46, v48
    v_fmac_f32 v23, v47, v48
    s_waitcnt vmcnt(0)
    v_lshlrev_b32 v40, 16, v92
    v_and_b32 v41, 0xffff0000, v92
    v_lshlrev_b32 v42, 16, v93
    v_and_b32 v43, 0xffff0000, v93
    v_lshlrev_b32 v44, 16, v94
    v_and_b32 v45, 0xffff0000, v94
    v_lshlrev_b32 v46, 16, v95
    v_and_b32 v47, 0xffff0000, v95
    v_fmac_f32 v16, v40, v49
    v_fmac_f32 v17, v41, v49
    v_fmac_f32 v18, v42, v49
    v_fmac_f32 v19, v43, v49
    v_fmac_f32 v20, v44, v49
    v_fmac_f32 v21, v45, v49
    v_fmac_f32 v22, v46, v49
    v_fmac_f32 v23, v47, v49
    s_branch LBdone_25
LBtail1_35:
    s_waitcnt vmcnt(7)
    v_dot2_f32_bf16 v28, v80, v24, 0
    v_dot2_f32_bf16 v28, v81, v25, v28
    v_dot2_f32_bf16 v28, v82, v26, v28
    v_dot2_f32_bf16 v28, v83, v27, v28
    s_waitcnt vmcnt(6)
    v_dot2_f32_bf16 v29, v84, v24, 0
    v_dot2_f32_bf16 v29, v85, v25, v29
    v_dot2_f32_bf16 v29, v86, v26, v29
    v_dot2_f32_bf16 v29, v87, v27, v29
    s_nop 2
    v_add_f32_dpp v28, v28, v28 row_ror:8 row_mask:0xf bank_mask:0xf
    v_add_f32_dpp v29, v29, v29 row_ror:8 row_mask:0xf bank_mask:0xf
    s_nop 0
    v_add_f32_dpp v28, v28, v28 row_ror:4 row_mask:0xf bank_mask:0xf
    v_add_f32_dpp v29, v29, v29 row_ror:4 row_mask:0xf bank_mask:0xf
    s_nop 0
    v_add_f32_dpp v28, v28, v28 row_ror:2 row_mask:0xf bank_mask:0xf
    v_add_f32_dpp v29, v29, v29 row_ror:2 row_mask:0xf bank_mask:0xf
    s_nop 0
    v_add_f32_dpp v28, v28, v28 row_ror:1 row_mask:0xf bank_mask:0xf
    v_add_f32_dpp v29, v29, v29 row_ror:1 row_mask:0xf bank_mask:0xf
    s_nop 0
    v_max3_f32 v38, v36, v28, v29
    v_sub_f32 v39, v36, v38
    v_mul_f32 v39, s70, v39
    v_exp_f32 v39, v39
    v_mul_f32 v56, s70, v38
    v_mov_b32 v36, v38
    v_fma_f32 v48, v28, s70, -v56
    v_fma_f32 v49, v29, s70, -v56
    v_exp_f32 v48, v48
    v_exp_f32 v49, v49
    v_mul_f32 v37, v37, v39
    v_mul_f32 v16, v16, v39
    v_mul_f32 v17, v17, v39
    v_mul_f32 v18, v18, v39
    v_mul_f32 v19, v19, v39
    v_mul_f32 v20, v20, v39
    v_mul_f32 v21, v21, v39
    v_mul_f32 v22, v22, v39
    v_mul_f32 v23, v23, v39
    v_add_f32 v37, v37, v48
    v_add_f32 v37, v37, v49
    s_waitcnt vmcnt(5)
    v_lshlrev_b32 v40, 16, v88
    v_and_b32 v41, 0xffff0000, v88
    v_lshlrev_b32 v42, 16, v89
    v_and_b32 v43, 0xffff0000, v89
    v_lshlrev_b32 v44, 16, v90
    v_and_b32 v45, 0xffff0000, v90
    v_lshlrev_b32 v46, 16, v91
    v_and_b32 v47, 0xffff0000, v91
    v_fmac_f32 v16, v40, v48
    v_fmac_f32 v17, v41, v48
    v_fmac_f32 v18, v42, v48
    v_fmac_f32 v19, v43, v48
    v_fmac_f32 v20, v44, v48
    v_fmac_f32 v21, v45, v48
    v_fmac_f32 v22, v46, v48
    v_fmac_f32 v23, v47, v48
    s_waitcnt vmcnt(4)
    v_lshlrev_b32 v40, 16, v92
    v_and_b32 v41, 0xffff0000, v92
    v_lshlrev_b32 v42, 16, v93
    v_and_b32 v43, 0xffff0000, v93
    v_lshlrev_b32 v44, 16, v94
    v_and_b32 v45, 0xffff0000, v94
    v_lshlrev_b32 v46, 16, v95
    v_and_b32 v47, 0xffff0000, v95
    v_fmac_f32 v16, v40, v49
    v_fmac_f32 v17, v41, v49
    v_fmac_f32 v18, v42, v49
    v_fmac_f32 v19, v43, v49
    v_fmac_f32 v20, v44, v49
    v_fmac_f32 v21, v45, v49
    v_fmac_f32 v22, v46, v49
    v_fmac_f32 v23, v47, v49
    s_waitcnt vmcnt(3)
    v_dot2_f32_bf16 v28, v64, v24, 0
    v_dot2_f32_bf16 v28, v65, v25, v28
    v_dot2_f32_bf16 v28, v66, v26, v28
    v_dot2_f32_bf16 v28, v67, v27, v28
    s_waitcnt vmcnt(2)
    v_dot2_f32_bf16 v29, v68, v24, 0
    v_dot2_f32_bf16 v29, v69, v25, v29
    v_dot2_f32_bf16 v29, v70, v26, v29
    v_dot2_f32_bf16 v29, v71, v27, v29
    s_nop 2
    v_add_f32_dpp v28, v28, v28 row_ror:8 row_mask:0xf bank_mask:0xf
    v_add_f32_dpp v29, v29, v29 row_ror:8 row_mask:0xf bank_mask:0xf
    s_nop 0
    v_add_f32_dpp v28, v28, v28 row_ror:4 row_mask:0xf bank_mask:0xf
    v_add_f32_dpp v29, v29, v29 row_ror:4 row_mask:0xf bank_mask:0xf
    s_nop 0
    v_add_f32_dpp v28, v28, v28 row_ror:2 row_mask:0xf bank_mask:0xf
    v_add_f32_dpp v29, v29, v29 row_ror:2 row_mask:0xf bank_mask:0xf
    s_nop 0
    v_add_f32_dpp v28, v28, v28 row_ror:1 row_mask:0xf bank_mask:0xf
    v_add_f32_dpp v29, v29, v29 row_ror:1 row_mask:0xf bank_mask:0xf
    s_nop 0
    v_max3_f32 v38, v36, v28, v29
    v_sub_f32 v39, v36, v38
    v_mul_f32 v39, s70, v39
    v_exp_f32 v39, v39
    v_mul_f32 v56, s70, v38
    v_mov_b32 v36, v38
    v_fma_f32 v48, v28, s70, -v56
    v_fma_f32 v49, v29, s70, -v56
    v_exp_f32 v48, v48
    v_exp_f32 v49, v49
    v_mul_f32 v37, v37, v39
    v_mul_f32 v16, v16, v39
    v_mul_f32 v17, v17, v39
    v_mul_f32 v18, v18, v39
    v_mul_f32 v19, v19, v39
    v_mul_f32 v20, v20, v39
    v_mul_f32 v21, v21, v39
    v_mul_f32 v22, v22, v39
    v_mul_f32 v23, v23, v39
    v_add_f32 v37, v37, v48
    v_add_f32 v37, v37, v49
    s_waitcnt vmcnt(1)
    v_lshlrev_b32 v40, 16, v72
    v_and_b32 v41, 0xffff0000, v72
    v_lshlrev_b32 v42, 16, v73
    v_and_b32 v43, 0xffff0000, v73
    v_lshlrev_b32 v44, 16, v74
    v_and_b32 v45, 0xffff0000, v74
    v_lshlrev_b32 v46, 16, v75
    v_and_b32 v47, 0xffff0000, v75
    v_fmac_f32 v16, v40, v48
    v_fmac_f32 v17, v41, v48
    v_fmac_f32 v18, v42, v48
    v_fmac_f32 v19, v43, v48
    v_fmac_f32 v20, v44, v48
    v_fmac_f32 v21, v45, v48
    v_fmac_f32 v22, v46, v48
    v_fmac_f32 v23, v47, v48
    s_waitcnt vmcnt(0)
    v_lshlrev_b32 v40, 16, v76
    v_and_b32 v41, 0xffff0000, v76
    v_lshlrev_b32 v42, 16, v77
    v_and_b32 v43, 0xffff0000, v77
    v_lshlrev_b32 v44, 16, v78
    v_and_b32 v45, 0xffff0000, v78
    v_lshlrev_b32 v46, 16, v79
    v_and_b32 v47, 0xffff0000, v79
    v_fmac_f32 v16, v40, v49
    v_fmac_f32 v17, v41, v49
    v_fmac_f32 v18, v42, v49
    v_fmac_f32 v19, v43, v49
    v_fmac_f32 v20, v44, v49
    v_fmac_f32 v21, v45, v49
    v_fmac_f32 v22, v46, v49
    v_fmac_f32 v23, v47, v49
LBdone_25:
    v_mov_b32 v40, 260
    s_mov_b64 exec, 1
    ds_add_u32 v40, v5
    s_mov_b64 exec, -1
    v_mov_b32 v38, v36
    v_mov_b32 v40, v38
    s_nop 1
    v_permlane32_swap_b32 v38, v40
    s_nop 1
    v_max_f32 v38, v38, v40
    v_mov_b32 v40, v38
    s_nop 1
    v_permlane16_swap_b32 v38, v40
    s_nop 1
    v_max_f32 v38, v38, v40
    v_sub_f32 v39, v36, v38
    v_mul_f32 v39, s70, v39
    v_exp_f32 v39, v39
    s_nop 0
    v_mul_f32 v37, v37, v39
    v_mul_f32 v16, v16, v39
    v_mul_f32 v17, v17, v39
    v_mul_f32 v18, v18, v39
    v_mul_f32 v19, v19, v39
    v_mul_f32 v20, v20, v39
    v_mul_f32 v21, v21, v39
    v_mul_f32 v22, v22, v39
    v_mul_f32 v23, v23, v39
    v_mov_b32 v40, v37
    s_nop 1
    v_permlane32_swap_b32 v37, v40
    s_nop 1
    v_add_f32 v37, v37, v40
    v_mov_b32 v40, v37
    s_nop 1
    v_permlane16_swap_b32 v37, v40
    s_nop 1
    v_add_f32 v37, v37, v40
    s_nop 2
    v_permlane32_swap_b32 v16, v20
    v_permlane32_swap_b32 v17, v21
    v_permlane32_swap_b32 v18, v22
    v_permlane32_swap_b32 v19, v23
    s_nop 1
    v_add_f32 v16, v16, v20
    v_add_f32 v17, v17, v21
    v_add_f32 v18, v18, v22
    v_add_f32 v19, v19, v23
    s_nop 1
    v_permlane16_swap_b32 v16, v18
    v_permlane16_swap_b32 v17, v19
    s_nop 1
    v_add_f32 v16, v16, v18
    v_add_f32 v17, v17, v19
    ds_write_b64 v7, v[16:17] offset:4096
    v_mov_b32 v40, v38
    v_mov_b32 v41, v37
    s_lshl_b32 s61, s56, 3
    v_mov_b32 v42, s61
    ds_write_b64 v42, v[40:41] offset:8192
    s_waitcnt lgkmcnt(0)
    s_barrier
    s_cmp_eq_u32 s56, 0
    s_cbranch_scc1 Lw0_42
    s_cmp_ge_u32 s56, 4
    s_cbranch_scc1 Lmm_43
    s_barrier
    s_branch L_end
Lmm_43:
    s_and_b32 s79, s64, 3
    s_lshl_b32 s79, s79, 3
    s_cmp_ge_u32 s64, 4
    s_cselect_b32 s80, 5376, 0
    s_cselect_b32 s62, 0, 1
    s_mul_i32 s62, s62, 3328
    s_add_u32 s80, s80, s62
L_distw:
    v_mov_b32 v43, 98816
    s_mov_b32 s92, 0
Lflg_44:
    ds_read_b32 v40, v43
    s_waitcnt lgkmcnt(0)
    v_readfirstlane_b32 s62, v40
    s_nop 3
    s_cmp_lg_u32 s62, 0
    s_cbranch_scc1 Lflgd_45
    s_sleep 1
    s_add_u32 s92, s92, 1
    s_cmp_lt_u32 s92, 400000
    s_cbranch_scc1 Lflg_44
Lflgd_45:
L_dist:
    v_lshrrev_b32 v40, 2, v3
    v_and_b32 v41, 1, v2
    v_lshl_or_b32 v42, v41, 2, v40
    v_lshlrev_b32 v42, 1, v42
    v_lshl_add_u32 v43, v2, 3, v40
    v_lshlrev_b32 v43, 8, v43
    v_and_b32 v44, 1, v3
    v_lshl_add_u32 v43, v44, 3, v43
    v_add_u32 v43, 65536, v43
    v_bfe_u32 v44, v3, 1, 1
    s_sub_u32 s61, s56, 4
    s_lshl_b32 s61, s61, 1
    s_add_u32 s62, s61, 0
    s_lshl_b32 s62, s62, 1
    v_add_u32 v45, s62, v44
    v_xor_b32 v45, v45, v42
    v_lshl_add_u32 v28, v45, 4, v43
    s_add_u32 s62, s61, 1
    s_lshl_b32 s62, s62, 1
    v_add_u32 v45, s62, v44
    v_xor_b32 v45, v45, v42
    v_lshl_add_u32 v29, v45, 4, v43
    ds_read_b64_tr_b16 v[64:65], v28 offset:0
    ds_read_b64_tr_b16 v[66:67], v28 offset:1024
    ds_read_b64_tr_b16 v[68:69], v28 offset:8192
    ds_read_b64_tr_b16 v[70:71], v28 offset:9216
    ds_read_b64_tr_b16 v[72:73], v28 offset:16384
    ds_read_b64_tr_b16 v[74:75], v28 offset:17408
    ds_read_b64_tr_b16 v[76:77], v28 offset:24576
    ds_read_b64_tr_b16 v[78:79], v28 offset:25600
    ds_read_b64_tr_b16 v[80:81], v29 offset:0
    ds_read_b64_tr_b16 v[82:83], v29 offset:1024
    ds_read_b64_tr_b16 v[84:85], v29 offset:8192
    ds_read_b64_tr_b16 v[86:87], v29 offset:9216
    ds_read_b64_tr_b16 v[88:89], v29 offset:16384
    ds_read_b64_tr_b16 v[90:91], v29 offset:17408
    ds_read_b64_tr_b16 v[92:93], v29 offset:24576
    ds_read_b64_tr_b16 v[94:95], v29 offset:25600
    v_and_b32 v40, 1, v3
    v_lshlrev_b32 v40, 8, v40
    v_lshl_add_u32 v40, v2, 4, v40
    v_add_u32 v40, 98304, v40
    v_lshlrev_b32 v41, 19, v3
    v_lshl_add_u32 v41, v2, 4, v41
    s_add_u32 s61, s61, s79
    s_mul_i32 s61, s61, 16384
    s_lshl_b32 s62, s65, 6
    s_add_u32 s61, s61, s62
    s_add_u32 s61, s61, s80
    s_add_u32 s62, s61, 16384
    s_waitcnt lgkmcnt(0)
    s_barrier
    ds_read_b128 v[128:131], v40 offset:0
    ds_read_b128 v[132:135], v40 offset:64
    ds_read_b128 v[136:139], v40 offset:128
    ds_read_b128 v[140:143], v40 offset:192
    s_waitcnt lgkmcnt(3)
    v_mfma_f32_16x16x32_bf16 v[144:147], v[64:67], v[128:131], 0
    v_mfma_f32_16x16x32_bf16 v[148:151], v[80:83], v[128:131], 0
    s_waitcnt lgkmcnt(2)
    v_mfma_f32_16x16x32_bf16 v[144:147], v[68:71], v[132:135], v[144:147]
    v_mfma_f32_16x16x32_bf16 v[148:151], v[84:87], v[132:135], v[148:151]
    s_waitcnt lgkmcnt(1)
    v_mfma_f32_16x16x32_bf16 v[144:147], v[72:75], v[136:139], v[144:147]
    v_mfma_f32_16x16x32_bf16 v[148:151], v[88:91], v[136:139], v[148:151]
    s_waitcnt lgkmcnt(0)
    v_mfma_f32_16x16x32_bf16 v[144:147], v[76:79], v[140:143], v[144:147]
    v_mfma_f32_16x16x32_bf16 v[148:151], v[92:95], v[140:143], v[148:151]
    s_mov_b32 exec_lo, 0x00030003
    s_mov_b32 exec_hi, 0x00030003
    s_nop 4
    buffer_store_dwordx4 v[144:147], v41, s[32:35], s61 offen sc0 sc1
    s_nop 0
    buffer_store_dwordx4 v[148:151], v41, s[32:35], s62 offen sc0 sc1
    s_mov_b64 exec, -1
    s_branch L_end
Lw0_42:
    v_mov_b32 v42, 0
    ds_read_b128 v[28:31], v42 offset:8192
    ds_read_b128 v[32:35], v42 offset:8208
    ds_read_b128 v[48:51], v42 offset:8224
    ds_read_b128 v[52:55], v42 offset:8240
    v_and_b32 v43, 31, v1
    v_lshlrev_b32 v43, 4, v43
    ds_read_b128 v[64:67], v43 offset:4096
    ds_read_b128 v[68:71], v43 offset:4608
    ds_read_b128 v[72:75], v43 offset:5120
    ds_read_b128 v[76:79], v43 offset:5632
    ds_read_b128 v[80:83], v43 offset:6144
    ds_read_b128 v[84:87], v43 offset:6656
    ds_read_b128 v[88:91], v43 offset:7168
    ds_read_b128 v[92:95], v43 offset:7680
    s_waitcnt lgkmcnt(8)
    v_max3_f32 v38, v28, v30, v32
    v_max3_f32 v38, v38, v34, v48
    v_max3_f32 v38, v38, v50, v52
    v_max_f32 v38, v38, v54
    v_mul_f32 v56, s70, v38
    v_fma_f32 v28, v28, s70, -v56
    v_fma_f32 v30, v30, s70, -v56
    v_fma_f32 v32, v32, s70, -v56
    v_fma_f32 v34, v34, s70, -v56
    v_fma_f32 v48, v48, s70, -v56
    v_fma_f32 v50, v50, s70, -v56
    v_fma_f32 v52, v52, s70, -v56
    v_fma_f32 v54, v54, s70, -v56
    v_exp_f32 v28, v28
    v_exp_f32 v30, v30
    v_exp_f32 v32, v32
    v_exp_f32 v34, v34
    v_exp_f32 v48, v48
    v_exp_f32 v50, v50
    v_exp_f32 v52, v52
    v_exp_f32 v54, v54
    s_nop 0
    v_mul_f32 v37, v28, v29
    v_fmac_f32 v37, v30, v31
    v_fmac_f32 v37, v32, v33
    v_fmac_f32 v37, v34, v35
    v_fmac_f32 v37, v48, v49
    v_fmac_f32 v37, v50, v51
    v_fmac_f32 v37, v52, v53
    v_fmac_f32 v37, v54, v55
    s_waitcnt lgkmcnt(0)
    v_mul_f32 v40, v64, v28
    v_mul_f32 v41, v65, v28
    v_mul_f32 v42, v66, v28
    v_mul_f32 v43, v67, v28
    v_fmac_f32 v40, v68, v30
    v_fmac_f32 v41, v69, v30
    v_fmac_f32 v42, v70, v30
    v_fmac_f32 v43, v71, v30
    v_fmac_f32 v40, v72, v32
    v_fmac_f32 v41, v73, v32
    v_fmac_f32 v42, v74, v32
    v_fmac_f32 v43, v75, v32
    v_fmac_f32 v40, v76, v34
    v_fmac_f32 v41, v77, v34
    v_fmac_f32 v42, v78, v34
    v_fmac_f32 v43, v79, v34
    v_fmac_f32 v40, v80, v48
    v_fmac_f32 v41, v81, v48
    v_fmac_f32 v42, v82, v48
    v_fmac_f32 v43, v83, v48
    v_fmac_f32 v40, v84, v50
    v_fmac_f32 v41, v85, v50
    v_fmac_f32 v42, v86, v50
    v_fmac_f32 v43, v87, v50
    v_fmac_f32 v40, v88, v52
    v_fmac_f32 v41, v89, v52
    v_fmac_f32 v42, v90, v52
    v_fmac_f32 v43, v91, v52
    v_fmac_f32 v40, v92, v54
    v_fmac_f32 v41, v93, v54
    v_fmac_f32 v42, v94, v54
    v_fmac_f32 v43, v95, v54
    v_cmp_eq_u32 vcc, 32, v1
    v_mov_b32 v45, 0
    s_nop 0
    v_cndmask_b32 v40, v40, v38, vcc
    v_cndmask_b32 v41, v41, v37, vcc
    v_cndmask_b32 v42, v42, v45, vcc
    v_cndmask_b32 v43, v43, v45, vcc
    v_lshlrev_b32 v44, 4, v1
    s_lshl_b32 s61, s64, 9
    s_add_u32 s61, s61, 256
    v_add_u32 v44, s61, v44
    s_lshl_b32 s61, s64, 4
    s_add_u32 s61, s61, 128
    v_mov_b32 v46, s61
    v_cndmask_b32 v44, v44, v46, vcc
    s_add_u32 s61, s65, 32
    s_mul_i32 s61, s61, 16384
    s_mov_b32 exec_lo, -1
    s_mov_b32 exec_hi, 1
    buffer_store_dwordx4 v[40:43], v44, s[32:35], s61 offen sc0 sc1
    s_mov_b64 exec, -1
    s_cmp_ge_u32 s64, 4
    s_cbranch_scc1 Lb2_46
    v_lshrrev_b32 v40, 5, v1
    v_mul_u32_u24 v41, 1536, v40
    v_and_b32 v42, 31, v1
    v_lshl_add_u32 v41, v42, 4, v41
    v_mul_u32_u24 v43, 48, v40
    v_lshlrev_b32 v46, 3, v1
    s_mov_b32 s92, 0
    buffer_load_dwordx4 v[64:67], v41, s[32:35], s61 offen offset:256 sc0 sc1
    buffer_load_dwordx2 v[76:77], v43, s[32:35], s61 offen offset:128 sc0 sc1
    buffer_load_dwordx4 v[68:71], v41, s[32:35], s61 offen offset:768 sc0 sc1
    buffer_load_dwordx2 v[78:79], v43, s[32:35], s61 offen offset:144 sc0 sc1
    buffer_load_dwordx4 v[72:75], v41, s[32:35], s61 offen offset:1280 sc0 sc1
    buffer_load_dwordx2 v[80:81], v43, s[32:35], s61 offen offset:160 sc0 sc1
Lp2_47:
    buffer_load_dwordx4 v[84:87], v41, s[32:35], s61 offen offset:256 sc0 sc1
    buffer_load_dwordx2 v[96:97], v43, s[32:35], s61 offen offset:128 sc0 sc1
    buffer_load_dwordx4 v[88:91], v41, s[32:35], s61 offen offset:768 sc0 sc1
    buffer_load_dwordx2 v[98:99], v43, s[32:35], s61 offen offset:144 sc0 sc1
    buffer_load_dwordx4 v[92:95], v41, s[32:35], s61 offen offset:1280 sc0 sc1
    buffer_load_dwordx2 v[100:101], v43, s[32:35], s61 offen offset:160 sc0 sc1
    s_waitcnt vmcnt(6)
    v_mov_b32 v45, v64
    v_max3_u32 v45, v45, v65, v66
    v_max3_u32 v45, v45, v67, v68
    v_max3_u32 v45, v45, v69, v70
    v_max3_u32 v45, v45, v71, v72
    v_max3_u32 v45, v45, v73, v74
    v_max3_u32 v45, v45, v75, v76
    v_max3_u32 v45, v45, v77, v78
    v_max3_u32 v45, v45, v79, v80
    v_max_u32 v45, v45, v81
    v_cmp_eq_u32 vcc, -1, v45
    s_cbranch_vccz Lp2A_48
    buffer_load_dwordx4 v[64:67], v41, s[32:35], s61 offen offset:256 sc0 sc1
    buffer_load_dwordx2 v[76:77], v43, s[32:35], s61 offen offset:128 sc0 sc1
    buffer_load_dwordx4 v[68:71], v41, s[32:35], s61 offen offset:768 sc0 sc1
    buffer_load_dwordx2 v[78:79], v43, s[32:35], s61 offen offset:144 sc0 sc1
    buffer_load_dwordx4 v[72:75], v41, s[32:35], s61 offen offset:1280 sc0 sc1
    buffer_load_dwordx2 v[80:81], v43, s[32:35], s61 offen offset:160 sc0 sc1
    s_waitcnt vmcnt(6)
    v_mov_b32 v45, v84
    v_max3_u32 v45, v45, v85, v86
    v_max3_u32 v45, v45, v87, v88
    v_max3_u32 v45, v45, v89, v90
    v_max3_u32 v45, v45, v91, v92
    v_max3_u32 v45, v45, v93, v94
    v_max3_u32 v45, v45, v95, v96
    v_max3_u32 v45, v45, v97, v98
    v_max3_u32 v45, v45, v99, v100
    v_max_u32 v45, v45, v101
    v_cmp_eq_u32 vcc, -1, v45
    s_cbranch_vccz Lp2B_49
    s_add_u32 s92, s92, 1
    s_cmp_lt_u32 s92, 400000
    s_cbranch_scc1 Lp2_47
Lp2B_49:
    s_waitcnt vmcnt(0)
    v_mov_b32 v64, v84
    v_mov_b32 v65, v85
    v_mov_b32 v66, v86
    v_mov_b32 v67, v87
    v_mov_b32 v68, v88
    v_mov_b32 v69, v89
    v_mov_b32 v70, v90
    v_mov_b32 v71, v91
    v_mov_b32 v72, v92
    v_mov_b32 v73, v93
    v_mov_b32 v74, v94
    v_mov_b32 v75, v95
    v_mov_b32 v76, v96
    v_mov_b32 v77, v97
    v_mov_b32 v78, v98
    v_mov_b32 v79, v99
    v_mov_b32 v80, v100
    v_mov_b32 v81, v101
    s_branch Lp2D_50
Lp2A_48:
Lp2D_50:
    v_max3_f32 v45, v76, v78, v80
    v_mul_f32 v44, s70, v45
    v_fma_f32 v76, v76, s70, -v44
    v_fma_f32 v78, v78, s70, -v44
    v_fma_f32 v80, v80, s70, -v44
    v_exp_f32 v76, v76
    v_exp_f32 v78, v78
    v_exp_f32 v80, v80
    s_nop 0
    v_mul_f32 v45, v76, v77
    v_fmac_f32 v45, v78, v79
    v_fmac_f32 v45, v80, v81
    v_rcp_f32 v45, v45
    v_mul_f32 v64, v64, v76
    v_mul_f32 v65, v65, v76
    v_mul_f32 v66, v66, v76
    v_mul_f32 v67, v67, v76
    v_fmac_f32 v64, v68, v78
    v_fmac_f32 v65, v69, v78
    v_fmac_f32 v66, v70, v78
    v_fmac_f32 v67, v71, v78
    v_fmac_f32 v64, v72, v80
    v_fmac_f32 v65, v73, v80
    v_fmac_f32 v66, v74, v80
    v_fmac_f32 v67, v75, v80
    v_mul_f32 v64, v64, v45
    v_mul_f32 v65, v65, v45
    v_mul_f32 v66, v66, v45
    v_mul_f32 v67, v67, v45
    v_cvt_pk_bf16_f32 v64, v64, v65
    v_cvt_pk_bf16_f32 v65, v66, v67
    v_add_u32 v46, 98304, v46
    ds_write_b64 v46, v[64:65]
    s_waitcnt lgkmcnt(0)
Lb2_46:
    s_barrier
    s_branch L_end
L_roleA:
    s_and_b32 s60, s57, 3
    s_lshr_b32 s59, s57, 2
    s_lshl_b32 s59, s59, 5
    s_lshl_b32 s75, s58, 2
    s_add_u32 s75, s75, s60
    s_add_u32 s75, s75, s59
    s_waitcnt lgkmcnt(0)
    s_mov_b32 s32, s30
    s_and_b32 s33, s31, 0xffff
    s_mov_b32 s34, 268435456
    s_mov_b32 s35, 0x00020000
    s_mov_b32 s52, s28
    s_and_b32 s53, s29, 0xffff
    s_mov_b32 s54, 256
    s_mov_b32 s55, 0x00020000
    v_and_b32 v1, 63, v0
    v_lshrrev_b32 v2, 4, v1
    v_and_b32 v3, 15, v1
    v_lshlrev_b32 v5, 4, v1
    v_lshlrev_b32 v4, 17, v2
    v_lshl_add_u32 v4, v3, 4, v4
    s_mov_b32 s68, 0x05040100
    s_mov_b32 s69, 0x07060302
    s_mul_i32 s93, s75, 16384
    v_mov_b32 v40, -1
    v_mov_b32 v41, -1
    v_mov_b32 v42, -1
    v_mov_b32 v43, -1
    s_cmp_lg_u32 s57, 0
    s_cbranch_scc1 Lcq_51
    v_lshlrev_b32 v45, 4, v0
    s_lshl_b32 s61, s75, 11
    s_add_u32 s61, s61, 1310720
    buffer_store_dwordx4 v[40:43], v45, s[32:35], s61 offen sc0 sc1
    s_add_u32 s61, s61, 65536
    buffer_store_dwordx4 v[40:43], v45, s[32:35], s61 offen sc0 sc1
    s_waitcnt vmcnt(0)
    s_barrier
    s_cmp_lg_u32 s56, 7
    s_cbranch_scc1 Lcq_51
    v_mov_b32 v45, 1
    v_mov_b32 v46, 0
    s_mov_b64 s[94:95], exec
    s_mov_b64 exec, 1
    buffer_atomic_add v45, v46, s[52:55], s75 offen offset:0 sc1
    s_mov_b64 exec, s[94:95]
Lcq_51:
    v_lshlrev_b32 v44, 4, v0
    v_cmp_gt_u32 vcc, 7936, v44
    s_and_saveexec_b64 s[94:95], vcc
    s_cbranch_execz Lci_52
    buffer_store_dwordx4 v[40:43], v44, s[32:35], s93 offen sc0 sc1
Lci_52:
    s_mov_b64 exec, s[94:95]
    s_cmp_lg_u32 s56, 5
    s_cbranch_scc1 Lcq_53
    v_mov_b32 v46, 0
    v_mov_b32 v47, 65536
    s_lshl_b32 s61, s75, 8
    s_add_u32 s61, s61, 1507328
    s_mov_b64 s[94:95], exec
    s_mov_b64 exec, 1
    buffer_store_dword v47, v46, s[32:35], s61 offen sc0 sc1
    s_mov_b64 exec, s[94:95]
Lcq_53:
    s_cmp_lg_u32 s56, 6
    s_cbranch_scc1 Lcq_54
    s_lshl_b32 s61, s75, 10
    s_add_u32 s61, s61, 1146880
    buffer_store_dwordx4 v[40:43], v5, s[32:35], s61 offen sc0 sc1
Lcq_54:
    s_cmp_eq_u32 s78, 0
    s_cselect_b32 s36, s8, s22
    s_cselect_b32 s37, s9, s23
    s_cselect_b32 s40, s4, s16
    s_cselect_b32 s41, s5, s17
    s_and_b32 s37, s37, 0xffff
    buffer_load_dwordx4 v[192:195], v232, s[36:39], s77 offen nt
    s_add_u32 s77, s77, 8192
    buffer_load_dwordx4 v[196:199], v232, s[36:39], s77 offen nt
    s_add_u32 s77, s77, 8192
    buffer_load_dwordx4 v[200:203], v232, s[36:39], s77 offen nt
    s_add_u32 s77, s77, 8192
    buffer_load_dwordx4 v[204:207], v232, s[36:39], s77 offen nt
    s_and_b32 s41, s41, 0xffff
    s_mov_b32 s42, 2048
    s_mov_b32 s43, 0x00020000
    v_lshlrev_b32 v231, 3, v229
    buffer_load_dwordx2 v[208:209], v231, s[40:43], s76 offen offset:0
    buffer_load_dwordx2 v[210:211], v231, s[40:43], s76 offen offset:1024
    s_lshl_b32 s3, s78, 5
    s_add_u32 s3, s3, s86
    s_lshl_b32 s3, s3, 2
    s_add_u32 s3, s3, s88
    s_lshl_b32 s3, s3, 1
    s_add_u32 s3, s3, s87
    s_lshl_b32 s3, s3, 8
    s_add_u32 s3, s3, 1310720
    s_and_b32 s91, s86, 0xfc
    s_mov_b32 s68, 0x05040100
    s_mov_b32 s69, 0x07060302
    s_cmp_lt_u32 s75, 32
    s_cbranch_scc1 L_roleT1
    s_sub_u32 s65, s75, 32
    s_waitcnt vmcnt(0)
    s_barrier
    s_cmp_lg_u32 s56, 1
    s_cbranch_scc1 Lsc_55
    v_mov_b32 v40, 1
    v_mov_b32 v41, 0
    s_mov_b64 s[94:95], exec
    s_mov_b64 exec, 1
    buffer_atomic_add v40, v41, s[52:55], 0 offen offset:128 sc1
    s_mov_b64 exec, s[94:95]
Lsc_55:
    s_lshl_b32 s61, s65, 18
    s_add_u32 s44, s6, s61
    s_addc_u32 s45, s7, 0
    s_and_b32 s45, s45, 0xffff
    s_mov_b32 s46, 262144
    s_mov_b32 s47, 0x00020000
    s_waitcnt vmcnt(0)
    v_perm_b32 v232, v196, v192, s68
    v_perm_b32 v233, v196, v192, s69
    v_perm_b32 v234, v197, v193, s68
    v_perm_b32 v235, v197, v193, s69
    v_perm_b32 v236, v198, v194, s68
    v_perm_b32 v237, v198, v194, s69
    v_perm_b32 v238, v199, v195, s68
    v_perm_b32 v239, v199, v195, s69
    v_dot2_f32_bf16 v212, v232, v208, 0
    v_dot2_f32_bf16 v213, v233, v208, 0
    v_dot2_f32_bf16 v214, v234, v208, 0
    v_dot2_f32_bf16 v215, v235, v208, 0
    v_dot2_f32_bf16 v216, v236, v208, 0
    v_dot2_f32_bf16 v217, v237, v208, 0
    v_dot2_f32_bf16 v218, v238, v208, 0
    v_dot2_f32_bf16 v219, v239, v208, 0
    v_dot2_f32_bf16 v220, v232, v210, 0
    v_dot2_f32_bf16 v221, v233, v210, 0
    v_dot2_f32_bf16 v222, v234, v210, 0
    v_dot2_f32_bf16 v223, v235, v210, 0
    v_dot2_f32_bf16 v224, v236, v210, 0
    v_dot2_f32_bf16 v225, v237, v210, 0
    v_dot2_f32_bf16 v226, v238, v210, 0
    v_dot2_f32_bf16 v227, v239, v210, 0
    v_perm_b32 v232, v204, v200, s68
    v_perm_b32 v233, v204, v200, s69
    v_perm_b32 v234, v205, v201, s68
    v_perm_b32 v235, v205, v201, s69
    v_perm_b32 v236, v206, v202, s68
    v_perm_b32 v237, v206, v202, s69
    v_perm_b32 v238, v207, v203, s68
    v_perm_b32 v239, v207, v203, s69
    v_dot2_f32_bf16 v212, v232, v209, v212
    v_dot2_f32_bf16 v213, v233, v209, v213
    v_dot2_f32_bf16 v214, v234, v209, v214
    v_dot2_f32_bf16 v215, v235, v209, v215
    v_dot2_f32_bf16 v216, v236, v209, v216
    v_dot2_f32_bf16 v217, v237, v209, v217
    v_dot2_f32_bf16 v218, v238, v209, v218
    v_dot2_f32_bf16 v219, v239, v209, v219
    v_dot2_f32_bf16 v220, v232, v211, v220
    v_dot2_f32_bf16 v221, v233, v211, v221
    v_dot2_f32_bf16 v222, v234, v211, v222
    v_dot2_f32_bf16 v223, v235, v211, v223
    v_dot2_f32_bf16 v224, v236, v211, v224
    v_dot2_f32_bf16 v225, v237, v211, v225
    v_dot2_f32_bf16 v226, v238, v211, v226
    v_dot2_f32_bf16 v227, v239, v211, v227
    s_nop 2
    v_permlane32_swap_b32 v212, v220
    v_permlane32_swap_b32 v213, v221
    v_permlane32_swap_b32 v214, v222
    v_permlane32_swap_b32 v215, v223
    v_permlane32_swap_b32 v216, v224
    v_permlane32_swap_b32 v217, v225
    v_permlane32_swap_b32 v218, v226
    v_permlane32_swap_b32 v219, v227
    s_nop 1
    v_add_f32 v212, v212, v220
    v_add_f32 v213, v213, v221
    v_add_f32 v214, v214, v222
    v_add_f32 v215, v215, v223
    v_add_f32 v216, v216, v224
    v_add_f32 v217, v217, v225
    v_add_f32 v218, v218, v226
    v_add_f32 v219, v219, v227
    s_nop 1
    v_permlane16_swap_b32 v212, v216
    v_permlane16_swap_b32 v213, v217
    v_permlane16_swap_b32 v214, v218
    v_permlane16_swap_b32 v215, v219
    s_nop 1
    v_add_f32 v212, v212, v216
    v_add_f32 v213, v213, v217
    v_add_f32 v214, v214, v218
    v_add_f32 v215, v215, v219
    s_nop 1
    v_add_f32_dpp v212, v212, v212 row_ror:8 row_mask:0xf bank_mask:0xf
    v_add_f32_dpp v213, v213, v213 row_ror:8 row_mask:0xf bank_mask:0xf
    v_add_f32_dpp v214, v214, v214 row_ror:8 row_mask:0xf bank_mask:0xf
    v_add_f32_dpp v215, v215, v215 row_ror:8 row_mask:0xf bank_mask:0xf
    v_lshrrev_b32 v232, 5, v228
    v_lshlrev_b32 v232, 8, v232
    v_bfe_u32 v233, v228, 4, 1
    v_lshl_add_u32 v232, v233, 4, v232
    v_lshl_add_u32 v232, v230, 5, v232
    s_lshl_b32 s61, s56, 9
    s_add_u32 s61, s61, 147456
    v_add_u32 v232, s61, v232
    ds_write_b128 v232, v[212:215]
    s_waitcnt lgkmcnt(0)
    s_barrier
    s_cmp_lg_u32 s56, 0
    s_cbranch_scc1 Ls1p_56
    v_mov_b32 v234, 0
    buffer_load_dword v235, v234, s[52:55], s91 offen offset:0 sc0 sc1
    v_and_b32 v232, 31, v228
    v_lshlrev_b32 v233, 4, v232
    v_add_u32 v233, 147456, v233
    ds_read_b128 v[192:195], v233 offset:0
    ds_read_b128 v[196:199], v233 offset:512
    ds_read_b128 v[200:203], v233 offset:1024
    ds_read_b128 v[204:207], v233 offset:1536
    ds_read_b128 v[208:211], v233 offset:2048
    ds_read_b128 v[212:215], v233 offset:2560
    ds_read_b128 v[216:219], v233 offset:3072
    ds_read_b128 v[220:223], v233 offset:3584
    s_waitcnt lgkmcnt(6)
    v_add_f32 v192, v192, v196
    v_add_f32 v193, v193, v197
    v_add_f32 v194, v194, v198
    v_add_f32 v195, v195, v199
    s_waitcnt lgkmcnt(5)
    v_add_f32 v192, v192, v200
    v_add_f32 v193, v193, v201
    v_add_f32 v194, v194, v202
    v_add_f32 v195, v195, v203
    s_waitcnt lgkmcnt(4)
    v_add_f32 v192, v192, v204
    v_add_f32 v193, v193, v205
    v_add_f32 v194, v194, v206
    v_add_f32 v195, v195, v207
    s_waitcnt lgkmcnt(3)
    v_add_f32 v192, v192, v208
    v_add_f32 v193, v193, v209
    v_add_f32 v194, v194, v210
    v_add_f32 v195, v195, v211
    s_waitcnt lgkmcnt(2)
    v_add_f32 v192, v192, v212
    v_add_f32 v193, v193, v213
    v_add_f32 v194, v194, v214
    v_add_f32 v195, v195, v215
    s_waitcnt lgkmcnt(1)
    v_add_f32 v192, v192, v216
    v_add_f32 v193, v193, v217
    v_add_f32 v194, v194, v218
    v_add_f32 v195, v195, v219
    s_waitcnt lgkmcnt(0)
    v_add_f32 v192, v192, v220
    v_add_f32 v193, v193, v221
    v_add_f32 v194, v194, v222
    v_add_f32 v195, v195, v223
    v_lshrrev_b32 v233, 4, v232
    v_lshlrev_b32 v233, 10, v233
    v_and_b32 v232, 15, v232
    v_lshl_add_u32 v233, v232, 4, v233
    s_waitcnt vmcnt(0)
    s_mov_b32 s92, 0
Lcf_57:
    v_readfirstlane_b32 s57, v235
    s_nop 3
    s_cmp_lg_u32 s57, 0
    s_cbranch_scc1 Lcfd_58
    s_sleep 2
    buffer_load_dword v235, v234, s[52:55], s91 offen offset:0 sc0 sc1
    s_waitcnt vmcnt(0)
    s_add_u32 s92, s92, 1
    s_cmp_lt_u32 s92, 400000
    s_cbranch_scc1 Lcf_57
Lcfd_58:
    s_mov_b64 exec, 0xffffffff
    buffer_store_dwordx4 v[192:195], v233, s[32:35], s3 offen sc0 sc1
    s_mov_b64 exec, -1
Ls1p_56:
    s_lshl_b32 s61, s56, 14
    s_add_u32 m0, s61, 0
    v_xor_b32 v52, 0, v5
    s_add_u32 s62, s61, 0
    buffer_load_dwordx4 v52, s[44:47], s62 offen nt lds
    s_add_u32 m0, s61, 1024
    v_xor_b32 v53, 64, v5
    s_add_u32 s62, s61, 1024
    buffer_load_dwordx4 v53, s[44:47], s62 offen nt lds
    s_add_u32 m0, s61, 2048
    v_xor_b32 v52, 128, v5
    s_add_u32 s62, s61, 2048
    buffer_load_dwordx4 v52, s[44:47], s62 offen nt lds
    s_add_u32 m0, s61, 3072
    v_xor_b32 v53, 192, v5
    s_add_u32 s62, s61, 3072
    buffer_load_dwordx4 v53, s[44:47], s62 offen nt lds
    s_add_u32 m0, s61, 4096
    v_xor_b32 v52, 0, v5
    s_add_u32 s62, s61, 4096
    buffer_load_dwordx4 v52, s[44:47], s62 offen nt lds
    s_add_u32 m0, s61, 5120
    v_xor_b32 v53, 64, v5
    s_add_u32 s62, s61, 5120
    buffer_load_dwordx4 v53, s[44:47], s62 offen nt lds
    s_add_u32 m0, s61, 6144
    v_xor_b32 v52, 128, v5
    s_add_u32 s62, s61, 6144
    buffer_load_dwordx4 v52, s[44:47], s62 offen nt lds
    s_add_u32 m0, s61, 7168
    v_xor_b32 v53, 192, v5
    s_add_u32 s62, s61, 7168
    buffer_load_dwordx4 v53, s[44:47], s62 offen nt lds
    s_add_u32 m0, s61, 8192
    v_xor_b32 v52, 32, v5
    s_add_u32 s62, s61, 8192
    buffer_load_dwordx4 v52, s[44:47], s62 offen nt lds
    s_add_u32 m0, s61, 9216
    v_xor_b32 v53, 96, v5
    s_add_u32 s62, s61, 9216
    buffer_load_dwordx4 v53, s[44:47], s62 offen nt lds
    s_add_u32 m0, s61, 10240
    v_xor_b32 v52, 160, v5
    s_add_u32 s62, s61, 10240
    buffer_load_dwordx4 v52, s[44:47], s62 offen nt lds
    s_add_u32 m0, s61, 11264
    v_xor_b32 v53, 224, v5
    s_add_u32 s62, s61, 11264
    buffer_load_dwordx4 v53, s[44:47], s62 offen nt lds
    s_add_u32 m0, s61, 12288
    v_xor_b32 v52, 32, v5
    s_add_u32 s62, s61, 12288
    buffer_load_dwordx4 v52, s[44:47], s62 offen nt lds
    s_add_u32 m0, s61, 13312
    v_xor_b32 v53, 96, v5
    s_add_u32 s62, s61, 13312
    buffer_load_dwordx4 v53, s[44:47], s62 offen nt lds
    s_add_u32 m0, s61, 14336
    v_xor_b32 v52, 160, v5
    s_add_u32 s62, s61, 14336
    buffer_load_dwordx4 v52, s[44:47], s62 offen nt lds
    s_add_u32 m0, s61, 15360
    v_xor_b32 v53, 224, v5
    s_add_u32 s62, s61, 15360
    buffer_load_dwordx4 v53, s[44:47], s62 offen nt lds
    s_barrier
    s_lshr_b32 s66, s65, 4
    s_and_b32 s67, s65, 15
    s_and_b32 s63, s56, 3
    s_lshr_b32 s64, s56, 2
    v_and_b32 v40, 3, v3
    v_lshlrev_b32 v40, 2, v40
    v_lshrrev_b32 v41, 3, v3
    v_lshl_or_b32 v40, v41, 1, v40
    s_lshl_b32 s61, s63, 15
    v_lshlrev_b32 v41, 10, v3
    v_add_u32 v41, s61, v41
    v_add_u32 v42, 0, v2
    v_xor_b32 v42, v42, v40
    v_lshl_add_u32 v8, v42, 4, v41
    v_add_u32 v42, 4, v2
    v_xor_b32 v42, v42, v40
    v_lshl_add_u32 v9, v42, 4, v41
    v_add_u32 v42, 8, v2
    v_xor_b32 v42, v42, v40
    v_lshl_add_u32 v10, v42, 4, v41
    v_add_u32 v42, 12, v2
    v_xor_b32 v42, v42, v40
    v_lshl_add_u32 v11, v42, 4, v41
    s_lshl_b32 s61, s64, 14
    s_add_u32 s61, s61, 131072
    s_lshl_b32 s62, s63, 15
    s_sub_u32 s61, s61, s62
    v_lshrrev_b32 v43, 1, v2
    v_and_b32 v44, 1, v2
    v_lshrrev_b32 v45, 2, v3
    v_lshl_add_u32 v46, v43, 3, v45
    v_lshlrev_b32 v47, 2, v45
    v_lshl_or_b32 v47, v43, 1, v47
    v_bfe_u32 v48, v3, 1, 1
    v_lshl_add_u32 v48, v44, 1, v48
    s_lshl_b32 s62, s56, 3
    s_add_u32 s62, s62, 0
    v_add_u32 v48, s62, v48
    v_xor_b32 v48, v48, v47
    v_lshlrev_b32 v48, 4, v48
    v_lshl_add_u32 v48, v46, 10, v48
    v_and_b32 v49, 1, v3
    v_lshl_add_u32 v12, v49, 3, v48
    v_bfe_u32 v48, v3, 1, 1
    v_lshl_add_u32 v48, v44, 1, v48
    s_lshl_b32 s62, s56, 3
    s_add_u32 s62, s62, 4
    v_add_u32 v48, s62, v48
    v_xor_b32 v48, v48, v47
    v_lshlrev_b32 v48, 4, v48
    v_lshl_add_u32 v48, v46, 10, v48
    v_and_b32 v49, 1, v3
    v_lshl_add_u32 v13, v49, 3, v48
    v_lshl_add_u32 v46, v43, 3, v45
    v_add_u32 v46, 4, v46
    v_lshlrev_b32 v47, 2, v45
    v_lshl_or_b32 v47, v43, 1, v47
    v_bfe_u32 v48, v3, 1, 1
    v_lshl_add_u32 v48, v44, 1, v48
    s_lshl_b32 s62, s56, 3
    s_add_u32 s62, s62, 0
    v_add_u32 v48, s62, v48
    v_xor_b32 v48, v48, v47
    v_lshlrev_b32 v48, 4, v48
    v_lshl_add_u32 v48, v46, 10, v48
    v_and_b32 v49, 1, v3
    v_lshl_add_u32 v14, v49, 3, v48
    v_bfe_u32 v48, v3, 1, 1
    v_lshl_add_u32 v48, v44, 1, v48
    s_lshl_b32 s62, s56, 3
    s_add_u32 s62, s62, 4
    v_add_u32 v48, s62, v48
    v_xor_b32 v48, v48, v47
    v_lshlrev_b32 v48, 4, v48
    v_lshl_add_u32 v48, v46, 10, v48
    v_and_b32 v49, 1, v3
    v_lshl_add_u32 v15, v49, 3, v48
    v_and_b32 v43, 31, v1
    v_lshrrev_b32 v44, 5, v1
    v_mul_u32_u24 v16, 272, v43
    v_lshl_add_u32 v16, v44, 4, v16
    v_add_u32 v16, 131072, v16
    v_lshlrev_b32 v23, 4, v43
    v_add_u32 v23, 139776, v23
    s_lshl_b32 s62, s64, 4
    v_add_u32 v43, s62, v3
    v_mul_u32_u24 v17, 272, v43
    v_lshl_add_u32 v17, v2, 3, v17
    s_lshl_b32 s62, s63, 6
    s_add_u32 s62, s62, 131072
    v_add_u32 v17, s62, v17
    v_lshlrev_b32 v22, 4, v43
    v_add_u32 v22, 139776, v22
    s_lshl_b32 s62, s63, 2
    v_add_u32 v21, s62, v22
    v_add_u32 v33, s61, v8
    v_mov_b32 v18, 0xff7fffff
    v_mov_b32 v20, 0xff7fffff
    v_mov_b32 v19, 0
    s_mov_b32 s100, s61
    s_cmp_lt_u32 s56, 4
    s_cbranch_scc1 Lqa0_59
    s_waitcnt vmcnt(0)
    s_lshl_b32 s61, s56, 14
    s_add_u32 s61, s61, 131072
    buffer_load_dwordx4 v[128:131], v5, s[44:47], s61 offen offset:0 nt
    buffer_load_dwordx4 v[132:135], v5, s[44:47], s61 offen offset:1024 nt
    buffer_load_dwordx4 v[136:139], v5, s[44:47], s61 offen offset:2048 nt
    buffer_load_dwordx4 v[140:143], v5, s[44:47], s61 offen offset:3072 nt
    s_add_u32 s61, s61, 4096
    buffer_load_dwordx4 v[144:147], v5, s[44:47], s61 offen offset:0 nt
    buffer_load_dwordx4 v[148:151], v5, s[44:47], s61 offen offset:1024 nt
    buffer_load_dwordx4 v[152:155], v5, s[44:47], s61 offen offset:2048 nt
    buffer_load_dwordx4 v[156:159], v5, s[44:47], s61 offen offset:3072 nt
    s_add_u32 s61, s61, 4096
    buffer_load_dwordx4 v[160:163], v5, s[44:47], s61 offen offset:0 nt
    buffer_load_dwordx4 v[164:167], v5, s[44:47], s61 offen offset:1024 nt
    buffer_load_dwordx4 v[168:171], v5, s[44:47], s61 offen offset:2048 nt
    buffer_load_dwordx4 v[172:175], v5, s[44:47], s61 offen offset:3072 nt
    s_add_u32 s61, s61, 4096
    buffer_load_dwordx4 v[176:179], v5, s[44:47], s61 offen offset:0 nt
    buffer_load_dwordx4 v[180:183], v5, s[44:47], s61 offen offset:1024 nt
    buffer_load_dwordx4 v[184:187], v5, s[44:47], s61 offen offset:2048 nt
    buffer_load_dwordx4 v[188:191], v5, s[44:47], s61 offen offset:3072 nt
    s_branch Lqaj_60
Lqa0_59:
    v_mov_b32 v40, 0
    s_mov_b32 s92, 0
Lcf_61:
    buffer_load_dword v41, v40, s[52:55], 0 offen offset:128 sc0 sc1
    s_waitcnt vmcnt(0)
    v_readfirstlane_b32 s57, v41
    s_nop 3
    s_cmp_ge_u32 s57, 64
    s_cbranch_scc1 Lcfd_62
    s_sleep 16
    s_add_u32 s92, s92, 1
    s_cmp_lt_u32 s92, 400000
    s_cbranch_scc1 Lcf_61
Lcfd_62:
    s_lshl_b32 s61, s66, 15
    s_lshl_b32 s62, s56, 13
    s_add_u32 s61, s61, s62
    s_add_u32 s61, s61, 1146880
    s_add_u32 s62, s61, 4096
    s_mov_b32 s92, 0
Lpoll_63:
    buffer_load_dwordx4 v[64:67], v5, s[32:35], s61 offen offset:0 sc0 sc1
    buffer_load_dwordx4 v[68:71], v5, s[32:35], s61 offen offset:1024 sc0 sc1
    buffer_load_dwordx4 v[72:75], v5, s[32:35], s61 offen offset:2048 sc0 sc1
    buffer_load_dwordx4 v[76:79], v5, s[32:35], s61 offen offset:3072 sc0 sc1
    buffer_load_dwordx4 v[80:83], v5, s[32:35], s62 offen offset:0 sc0 sc1
    buffer_load_dwordx4 v[84:87], v5, s[32:35], s62 offen offset:1024 sc0 sc1
    buffer_load_dwordx4 v[88:91], v5, s[32:35], s62 offen offset:2048 sc0 sc1
    buffer_load_dwordx4 v[92:95], v5, s[32:35], s62 offen offset:3072 sc0 sc1
    s_waitcnt vmcnt(0)
    v_mov_b32 v40, v64
    v_max3_u32 v40, v40, v65, v66
    v_max3_u32 v40, v40, v67, v68
    v_max3_u32 v40, v40, v69, v70
    v_max3_u32 v40, v40, v71, v72
    v_max3_u32 v40, v40, v73, v74
    v_max3_u32 v40, v40, v75, v76
    v_max3_u32 v40, v40, v77, v78
    v_max3_u32 v40, v40, v79, v80
    v_max3_u32 v40, v40, v81, v82
    v_max3_u32 v40, v40, v83, v84
    v_max3_u32 v40, v40, v85, v86
    v_max3_u32 v40, v40, v87, v88
    v_max3_u32 v40, v40, v89, v90
    v_max3_u32 v40, v40, v91, v92
    v_max3_u32 v40, v40, v93, v94
    v_max_u32 v40, v40, v95
    v_cmpx_eq_u32 vcc, -1, v40
    s_cbranch_execz Lpolld_64
    s_sleep 4
    s_add_u32 s92, s92, 1
    s_cmp_lt_u32 s92, 400000
    s_cbranch_scc1 Lpoll_63
Lpolld_64:
    s_mov_b64 exec, -1
    s_and_b32 s62, s56, 1
    s_lshl_b32 s62, s62, 5
    s_lshl_b32 s61, s56, 13
    s_add_u32 s61, s61, 131072
    s_add_u32 s57, s62, 0
    v_xor_b32 v40, s57, v5
    v_add_u32 v40, s61, v40
    ds_write_b128 v40, v[64:67] offset:0
    s_add_u32 s57, s62, 64
    v_xor_b32 v41, s57, v5
    v_add_u32 v41, s61, v41
    ds_write_b128 v41, v[68:71] offset:1024
    s_add_u32 s57, s62, 128
    v_xor_b32 v42, s57, v5
    v_add_u32 v42, s61, v42
    ds_write_b128 v42, v[72:75] offset:2048
    s_add_u32 s57, s62, 192
    v_xor_b32 v43, s57, v5
    v_add_u32 v43, s61, v43
    ds_write_b128 v43, v[76:79] offset:3072
    s_add_u32 s57, s62, 0
    v_xor_b32 v40, s57, v5
    v_add_u32 v40, s61, v40
    ds_write_b128 v40, v[80:83] offset:4096
    s_add_u32 s57, s62, 64
    v_xor_b32 v41, s57, v5
    v_add_u32 v41, s61, v41
    ds_write_b128 v41, v[84:87] offset:5120
    s_add_u32 s57, s62, 128
    v_xor_b32 v42, s57, v5
    v_add_u32 v42, s61, v42
    ds_write_b128 v42, v[88:91] offset:6144
    s_add_u32 s57, s62, 192
    v_xor_b32 v43, s57, v5
    v_add_u32 v43, s61, v43
    ds_write_b128 v43, v[92:95] offset:7168
    s_waitcnt lgkmcnt(0)
    s_lshl_b32 s61, s56, 14
    s_add_u32 s61, s61, 131072
    buffer_load_dwordx4 v[128:131], v5, s[44:47], s61 offen offset:0 nt
    buffer_load_dwordx4 v[132:135], v5, s[44:47], s61 offen offset:1024 nt
    buffer_load_dwordx4 v[136:139], v5, s[44:47], s61 offen offset:2048 nt
    buffer_load_dwordx4 v[140:143], v5, s[44:47], s61 offen offset:3072 nt
    s_add_u32 s61, s61, 4096
    buffer_load_dwordx4 v[144:147], v5, s[44:47], s61 offen offset:0 nt
    buffer_load_dwordx4 v[148:151], v5, s[44:47], s61 offen offset:1024 nt
    buffer_load_dwordx4 v[152:155], v5, s[44:47], s61 offen offset:2048 nt
    buffer_load_dwordx4 v[156:159], v5, s[44:47], s61 offen offset:3072 nt
    s_add_u32 s61, s61, 4096
    buffer_load_dwordx4 v[160:163], v5, s[44:47], s61 offen offset:0 nt
    buffer_load_dwordx4 v[164:167], v5, s[44:47], s61 offen offset:1024 nt
    buffer_load_dwordx4 v[168:171], v5, s[44:47], s61 offen offset:2048 nt
    buffer_load_dwordx4 v[172:175], v5, s[44:47], s61 offen offset:3072 nt
    s_add_u32 s61, s61, 4096
    buffer_load_dwordx4 v[176:179], v5, s[44:47], s61 offen offset:0 nt
    buffer_load_dwordx4 v[180:183], v5, s[44:47], s61 offen offset:1024 nt
    buffer_load_dwordx4 v[184:187], v5, s[44:47], s61 offen offset:2048 nt
    buffer_load_dwordx4 v[188:191], v5, s[44:47], s61 offen offset:3072 nt
Lqaj_60:
    s_barrier
    v_add_u32 v40, s100, v8
    v_add_u32 v41, s100, v9
    v_add_u32 v42, s100, v10
    v_add_u32 v43, s100, v11
    ds_read_b128 v[192:195], v40 offset:0
    ds_read_b128 v[196:199], v41 offset:0
    ds_read_b128 v[200:203], v42 offset:0
    ds_read_b128 v[204:207], v43 offset:0
    ds_read_b128 v[208:211], v40 offset:256
    ds_read_b128 v[212:215], v41 offset:256
    ds_read_b128 v[216:219], v42 offset:256
    ds_read_b128 v[220:223], v43 offset:256
    ds_read_b128 v[224:227], v40 offset:512
    ds_read_b128 v[228:231], v41 offset:512
    ds_read_b128 v[232:235], v42 offset:512
    ds_read_b128 v[236:239], v43 offset:512
    ds_read_b128 v[240:243], v40 offset:768
    ds_read_b128 v[244:247], v41 offset:768
    ds_read_b128 v[248:251], v42 offset:768
    ds_read_b128 v[252:255], v43 offset:768
    s_waitcnt lgkmcnt(0)
    s_barrier
    ds_read_b128 v[96:99], v8 offset:0
    ds_read_b128 v[100:103], v8 offset:16384
    ds_read_b128 v[104:107], v9 offset:0
    ds_read_b128 v[108:111], v9 offset:16384
    ds_read_b128 v[112:115], v10 offset:0
    ds_read_b128 v[116:119], v10 offset:16384
    ds_read_b128 v[120:123], v11 offset:0
    ds_read_b128 v[124:127], v11 offset:16384
    s_waitcnt lgkmcnt(7)
    v_mfma_f32_16x16x32_bf16 v[24:27], v[96:99], v[192:195], 0
    ds_read_b128 v[96:99], v8 offset:256
    s_waitcnt lgkmcnt(7)
    v_mfma_f32_16x16x32_bf16 v[28:31], v[100:103], v[192:195], 0
    ds_read_b128 v[100:103], v8 offset:16640
    s_waitcnt lgkmcnt(7)
    v_mfma_f32_16x16x32_bf16 v[24:27], v[104:107], v[196:199], v[24:27]
    ds_read_b128 v[104:107], v9 offset:256
    s_waitcnt lgkmcnt(7)
    v_mfma_f32_16x16x32_bf16 v[28:31], v[108:111], v[196:199], v[28:31]
    ds_read_b128 v[108:111], v9 offset:16640
    s_waitcnt lgkmcnt(7)
    v_mfma_f32_16x16x32_bf16 v[24:27], v[112:115], v[200:203], v[24:27]
    ds_read_b128 v[112:115], v10 offset:256
    s_waitcnt lgkmcnt(7)
    v_mfma_f32_16x16x32_bf16 v[28:31], v[116:119], v[200:203], v[28:31]
    ds_read_b128 v[116:119], v10 offset:16640
    s_waitcnt lgkmcnt(7)
    v_mfma_f32_16x16x32_bf16 v[24:27], v[120:123], v[204:207], v[24:27]
    ds_read_b128 v[120:123], v11 offset:256
    s_waitcnt lgkmcnt(7)
    v_mfma_f32_16x16x32_bf16 v[28:31], v[124:127], v[204:207], v[28:31]
    ds_read_b128 v[124:127], v11 offset:16640
    s_waitcnt lgkmcnt(7)
    v_mfma_f32_16x16x32_bf16 v[24:27], v[96:99], v[208:211], v[24:27]
    ds_read_b128 v[96:99], v8 offset:512
    s_waitcnt lgkmcnt(7)
    v_mfma_f32_16x16x32_bf16 v[28:31], v[100:103], v[208:211], v[28:31]
    ds_read_b128 v[100:103], v8 offset:16896
    s_waitcnt lgkmcnt(7)
    v_mfma_f32_16x16x32_bf16 v[24:27], v[104:107], v[212:215], v[24:27]
    ds_read_b128 v[104:107], v9 offset:512
    s_waitcnt lgkmcnt(7)
    v_mfma_f32_16x16x32_bf16 v[28:31], v[108:111], v[212:215], v[28:31]
    ds_read_b128 v[108:111], v9 offset:16896
    s_waitcnt lgkmcnt(7)
    v_mfma_f32_16x16x32_bf16 v[24:27], v[112:115], v[216:219], v[24:27]
    ds_read_b128 v[112:115], v10 offset:512
    s_waitcnt lgkmcnt(7)
    v_mfma_f32_16x16x32_bf16 v[28:31], v[116:119], v[216:219], v[28:31]
    ds_read_b128 v[116:119], v10 offset:16896
    s_waitcnt lgkmcnt(7)
    v_mfma_f32_16x16x32_bf16 v[24:27], v[120:123], v[220:223], v[24:27]
    ds_read_b128 v[120:123], v11 offset:512
    s_waitcnt lgkmcnt(7)
    v_mfma_f32_16x16x32_bf16 v[28:31], v[124:127], v[220:223], v[28:31]
    ds_read_b128 v[124:127], v11 offset:16896
    s_waitcnt lgkmcnt(7)
    v_mfma_f32_16x16x32_bf16 v[24:27], v[96:99], v[224:227], v[24:27]
    ds_read_b128 v[96:99], v8 offset:768
    s_waitcnt lgkmcnt(7)
    v_mfma_f32_16x16x32_bf16 v[28:31], v[100:103], v[224:227], v[28:31]
    ds_read_b128 v[100:103], v8 offset:17152
    s_waitcnt lgkmcnt(7)
    v_mfma_f32_16x16x32_bf16 v[24:27], v[104:107], v[228:231], v[24:27]
    ds_read_b128 v[104:107], v9 offset:768
    s_waitcnt lgkmcnt(7)
    v_mfma_f32_16x16x32_bf16 v[28:31], v[108:111], v[228:231], v[28:31]
    ds_read_b128 v[108:111], v9 offset:17152
    s_waitcnt lgkmcnt(7)
    v_mfma_f32_16x16x32_bf16 v[24:27], v[112:115], v[232:235], v[24:27]
    ds_read_b128 v[112:115], v10 offset:768
    s_waitcnt lgkmcnt(7)
    v_mfma_f32_16x16x32_bf16 v[28:31], v[116:119], v[232:235], v[28:31]
    ds_read_b128 v[116:119], v10 offset:17152
    s_waitcnt lgkmcnt(7)
    v_mfma_f32_16x16x32_bf16 v[24:27], v[120:123], v[236:239], v[24:27]
    ds_read_b128 v[120:123], v11 offset:768
    s_waitcnt lgkmcnt(7)
    v_mfma_f32_16x16x32_bf16 v[28:31], v[124:127], v[236:239], v[28:31]
    ds_read_b128 v[124:127], v11 offset:17152
    s_waitcnt lgkmcnt(7)
    v_mfma_f32_16x16x32_bf16 v[24:27], v[96:99], v[240:243], v[24:27]
    s_waitcnt lgkmcnt(6)
    v_mfma_f32_16x16x32_bf16 v[28:31], v[100:103], v[240:243], v[28:31]
    s_waitcnt lgkmcnt(5)
    v_mfma_f32_16x16x32_bf16 v[24:27], v[104:107], v[244:247], v[24:27]
    s_waitcnt lgkmcnt(4)
    v_mfma_f32_16x16x32_bf16 v[28:31], v[108:111], v[244:247], v[28:31]
    s_waitcnt lgkmcnt(3)
    v_mfma_f32_16x16x32_bf16 v[24:27], v[112:115], v[248:251], v[24:27]
    s_waitcnt lgkmcnt(2)
    v_mfma_f32_16x16x32_bf16 v[28:31], v[116:119], v[248:251], v[28:31]
    s_waitcnt lgkmcnt(1)
    v_mfma_f32_16x16x32_bf16 v[24:27], v[120:123], v[252:255], v[24:27]
    s_waitcnt lgkmcnt(0)
    v_mfma_f32_16x16x32_bf16 v[28:31], v[124:127], v[252:255], v[28:31]
    s_nop 7
    s_nop 1
    v_max3_f32 v40, v24, v25, v26
    v_max3_f32 v40, v40, v27, v28
    v_max3_f32 v40, v40, v29, v30
    v_max_f32 v40, v40, v31
    v_mov_b32 v41, v40
    s_nop 1
    v_permlane32_swap_b32 v40, v41
    s_nop 1
    v_max_f32 v40, v40, v41
    v_mov_b32 v41, v40
    s_nop 1
    v_permlane16_swap_b32 v40, v41
    s_nop 1
    v_max_f32 v40, v40, v41
    ds_write_b32 v21, v40
    s_waitcnt lgkmcnt(0)
    s_barrier
    ds_read_b128 v[40:43], v22
    ds_read_b128 v[44:47], v23
    s_waitcnt lgkmcnt(1)
    v_max3_f32 v40, v40, v41, v42
    v_max3_f32 v20, v40, v43, v20
    v_sub_f32 v24, v24, v20
    v_sub_f32 v25, v25, v20
    v_sub_f32 v26, v26, v20
    v_sub_f32 v27, v27, v20
    v_sub_f32 v28, v28, v20
    v_sub_f32 v29, v29, v20
    v_sub_f32 v30, v30, v20
    v_sub_f32 v31, v31, v20
    v_exp_f32 v24, v24
    v_exp_f32 v25, v25
    v_exp_f32 v26, v26
    v_exp_f32 v27, v27
    v_exp_f32 v28, v28
    v_exp_f32 v29, v29
    v_exp_f32 v30, v30
    v_exp_f32 v31, v31
    s_waitcnt lgkmcnt(0)
    v_max3_f32 v44, v44, v45, v46
    v_max3_f32 v44, v44, v47, v18
    v_sub_f32 v32, v18, v44
    v_exp_f32 v32, v32
    v_mov_b32 v18, v44
    v_add_f32 v40, v24, v25
    v_add_f32 v40, v40, v26
    v_add_f32 v40, v40, v27
    v_add_f32 v40, v40, v28
    v_add_f32 v40, v40, v29
    v_add_f32 v40, v40, v30
    v_add_f32 v40, v40, v31
    v_cvt_pk_bf16_f32 v48, v24, v25
    v_cvt_pk_bf16_f32 v49, v26, v27
    v_cvt_pk_bf16_f32 v50, v28, v29
    v_cvt_pk_bf16_f32 v51, v30, v31
    ds_write_b64 v17, v[48:49] offset:0
    ds_write_b64 v17, v[50:51] offset:32
    v_mov_b32 v41, v40
    s_nop 1
    v_permlane32_swap_b32 v40, v41
    s_nop 1
    v_add_f32 v40, v40, v41
    v_mov_b32 v41, v40
    s_nop 1
    v_permlane16_swap_b32 v40, v41
    s_nop 1
    v_add_f32 v40, v40, v41
    ds_write_b32 v21, v40 offset:512
    s_waitcnt lgkmcnt(0)
    s_barrier
    ds_read_b128 v[40:43], v23 offset:512
    ds_read_b128 v[96:99], v16 offset:0
    ds_read_b64_tr_b16 v[100:101], v12 offset:0
    ds_read_b64_tr_b16 v[102:103], v14 offset:0
    ds_read_b64_tr_b16 v[104:105], v13 offset:0
    ds_read_b64_tr_b16 v[106:107], v15 offset:0
    ds_read_b128 v[108:111], v16 offset:32
    ds_read_b64_tr_b16 v[112:113], v12 offset:16384
    ds_read_b64_tr_b16 v[114:115], v14 offset:16384
    ds_read_b64_tr_b16 v[116:117], v13 offset:16384
    ds_read_b64_tr_b16 v[118:119], v15 offset:16384
    s_waitcnt lgkmcnt(5)
    v_mfma_f32_32x32x16_bf16 v[64:79], v[100:103], v[96:99], 0
    v_mfma_f32_32x32x16_bf16 v[80:95], v[104:107], v[96:99], 0
    ds_read_b128 v[96:99], v16 offset:64
    ds_read_b64_tr_b16 v[100:101], v12 offset:32768
    ds_read_b64_tr_b16 v[102:103], v14 offset:32768
    ds_read_b64_tr_b16 v[104:105], v13 offset:32768
    ds_read_b64_tr_b16 v[106:107], v15 offset:32768
    s_waitcnt lgkmcnt(5)
    v_mfma_f32_32x32x16_bf16 v[64:79], v[112:115], v[108:111], v[64:79]
    v_mfma_f32_32x32x16_bf16 v[80:95], v[116:119], v[108:111], v[80:95]
    ds_read_b128 v[108:111], v16 offset:96
    ds_read_b64_tr_b16 v[112:113], v12 offset:49152
    ds_read_b64_tr_b16 v[114:115], v14 offset:49152
    ds_read_b64_tr_b16 v[116:117], v13 offset:49152
    ds_read_b64_tr_b16 v[118:119], v15 offset:49152
    s_waitcnt lgkmcnt(5)
    v_mfma_f32_32x32x16_bf16 v[64:79], v[100:103], v[96:99], v[64:79]
    v_mfma_f32_32x32x16_bf16 v[80:95], v[104:107], v[96:99], v[80:95]
    v_add_u32 v12, 0x10000, v12
    v_add_u32 v13, 0x10000, v13
    v_add_u32 v14, 0x10000, v14
    v_add_u32 v15, 0x10000, v15
    ds_read_b128 v[96:99], v16 offset:128
    ds_read_b64_tr_b16 v[100:101], v12 offset:0
    ds_read_b64_tr_b16 v[102:103], v14 offset:0
    ds_read_b64_tr_b16 v[104:105], v13 offset:0
    ds_read_b64_tr_b16 v[106:107], v15 offset:0
    s_waitcnt lgkmcnt(5)
    v_mfma_f32_32x32x16_bf16 v[64:79], v[112:115], v[108:111], v[64:79]
    v_mfma_f32_32x32x16_bf16 v[80:95], v[116:119], v[108:111], v[80:95]
    ds_read_b128 v[108:111], v16 offset:160
    ds_read_b64_tr_b16 v[112:113], v12 offset:16384
    ds_read_b64_tr_b16 v[114:115], v14 offset:16384
    ds_read_b64_tr_b16 v[116:117], v13 offset:16384
    ds_read_b64_tr_b16 v[118:119], v15 offset:16384
    s_waitcnt lgkmcnt(5)
    v_mfma_f32_32x32x16_bf16 v[64:79], v[100:103], v[96:99], v[64:79]
    v_mfma_f32_32x32x16_bf16 v[80:95], v[104:107], v[96:99], v[80:95]
    ds_read_b128 v[96:99], v16 offset:192
    ds_read_b64_tr_b16 v[100:101], v12 offset:32768
    ds_read_b64_tr_b16 v[102:103], v14 offset:32768
    ds_read_b64_tr_b16 v[104:105], v13 offset:32768
    ds_read_b64_tr_b16 v[106:107], v15 offset:32768
    s_waitcnt lgkmcnt(5)
    v_mfma_f32_32x32x16_bf16 v[64:79], v[112:115], v[108:111], v[64:79]
    v_mfma_f32_32x32x16_bf16 v[80:95], v[116:119], v[108:111], v[80:95]
    ds_read_b128 v[108:111], v16 offset:224
    ds_read_b64_tr_b16 v[112:113], v12 offset:49152
    ds_read_b64_tr_b16 v[114:115], v14 offset:49152
    ds_read_b64_tr_b16 v[116:117], v13 offset:49152
    ds_read_b64_tr_b16 v[118:119], v15 offset:49152
    s_waitcnt lgkmcnt(5)
    v_mfma_f32_32x32x16_bf16 v[64:79], v[100:103], v[96:99], v[64:79]
    v_mfma_f32_32x32x16_bf16 v[80:95], v[104:107], v[96:99], v[80:95]
    s_waitcnt lgkmcnt(0)
    v_mfma_f32_32x32x16_bf16 v[64:79], v[112:115], v[108:111], v[64:79]
    v_mfma_f32_32x32x16_bf16 v[80:95], v[116:119], v[108:111], v[80:95]
    v_subrev_u32 v12, 0x10000, v12
    v_subrev_u32 v13, 0x10000, v13
    v_subrev_u32 v14, 0x10000, v14
    v_subrev_u32 v15, 0x10000, v15
    v_add_f32 v40, v40, v41
    v_add_f32 v42, v42, v43
    v_add_f32 v40, v40, v42
    v_fma_f32 v19, v19, v32, v40
    s_barrier
    s_waitcnt vmcnt(0)
    s_lshl_b32 s61, s56, 14
    v_xor_b32 v40, 0, v5
    v_add_u32 v40, s61, v40
    ds_write_b128 v40, v[128:131] offset:0
    v_xor_b32 v41, 64, v5
    v_add_u32 v41, s61, v41
    ds_write_b128 v41, v[132:135] offset:1024
    v_xor_b32 v42, 128, v5
    v_add_u32 v42, s61, v42
    ds_write_b128 v42, v[136:139] offset:2048
    v_xor_b32 v43, 192, v5
    v_add_u32 v43, s61, v43
    ds_write_b128 v43, v[140:143] offset:3072
    v_xor_b32 v40, 0, v5
    v_add_u32 v40, s61, v40
    ds_write_b128 v40, v[144:147] offset:4096
    v_xor_b32 v41, 64, v5
    v_add_u32 v41, s61, v41
    ds_write_b128 v41, v[148:151] offset:5120
    v_xor_b32 v42, 128, v5
    v_add_u32 v42, s61, v42
    ds_write_b128 v42, v[152:155] offset:6144
    v_xor_b32 v43, 192, v5
    v_add_u32 v43, s61, v43
    ds_write_b128 v43, v[156:159] offset:7168
    v_xor_b32 v40, 32, v5
    v_add_u32 v40, s61, v40
    ds_write_b128 v40, v[160:163] offset:8192
    v_xor_b32 v41, 96, v5
    v_add_u32 v41, s61, v41
    ds_write_b128 v41, v[164:167] offset:9216
    v_xor_b32 v42, 160, v5
    v_add_u32 v42, s61, v42
    ds_write_b128 v42, v[168:171] offset:10240
    v_xor_b32 v43, 224, v5
    v_add_u32 v43, s61, v43
    ds_write_b128 v43, v[172:175] offset:11264
    v_xor_b32 v40, 32, v5
    v_add_u32 v40, s61, v40
    ds_write_b128 v40, v[176:179] offset:12288
    v_xor_b32 v41, 96, v5
    v_add_u32 v41, s61, v41
    ds_write_b128 v41, v[180:183] offset:13312
    v_xor_b32 v42, 160, v5
    v_add_u32 v42, s61, v42
    ds_write_b128 v42, v[184:187] offset:14336
    v_xor_b32 v43, 224, v5
    v_add_u32 v43, s61, v43
    ds_write_b128 v43, v[188:191] offset:15360
    s_waitcnt lgkmcnt(0)
    s_barrier
    ds_read_b128 v[96:99], v8 offset:0
    ds_read_b128 v[100:103], v8 offset:16384
    ds_read_b128 v[104:107], v9 offset:0
    ds_read_b128 v[108:111], v9 offset:16384
    ds_read_b128 v[112:115], v10 offset:0
    ds_read_b128 v[116:119], v10 offset:16384
    ds_read_b128 v[120:123], v11 offset:0
    ds_read_b128 v[124:127], v11 offset:16384
    s_waitcnt lgkmcnt(7)
    v_mfma_f32_16x16x32_bf16 v[24:27], v[96:99], v[192:195], 0
    ds_read_b128 v[96:99], v8 offset:256
    s_waitcnt lgkmcnt(7)
    v_mfma_f32_16x16x32_bf16 v[28:31], v[100:103], v[192:195], 0
    ds_read_b128 v[100:103], v8 offset:16640
    s_waitcnt lgkmcnt(7)
    v_mfma_f32_16x16x32_bf16 v[24:27], v[104:107], v[196:199], v[24:27]
    ds_read_b128 v[104:107], v9 offset:256
    s_waitcnt lgkmcnt(7)
    v_mfma_f32_16x16x32_bf16 v[28:31], v[108:111], v[196:199], v[28:31]
    ds_read_b128 v[108:111], v9 offset:16640
    s_waitcnt lgkmcnt(7)
    v_mfma_f32_16x16x32_bf16 v[24:27], v[112:115], v[200:203], v[24:27]
    ds_read_b128 v[112:115], v10 offset:256
    s_waitcnt lgkmcnt(7)
    v_mfma_f32_16x16x32_bf16 v[28:31], v[116:119], v[200:203], v[28:31]
    ds_read_b128 v[116:119], v10 offset:16640
    s_waitcnt lgkmcnt(7)
    v_mfma_f32_16x16x32_bf16 v[24:27], v[120:123], v[204:207], v[24:27]
    ds_read_b128 v[120:123], v11 offset:256
    s_waitcnt lgkmcnt(7)
    v_mfma_f32_16x16x32_bf16 v[28:31], v[124:127], v[204:207], v[28:31]
    ds_read_b128 v[124:127], v11 offset:16640
    s_waitcnt lgkmcnt(7)
    v_mfma_f32_16x16x32_bf16 v[24:27], v[96:99], v[208:211], v[24:27]
    ds_read_b128 v[96:99], v8 offset:512
    s_waitcnt lgkmcnt(7)
    v_mfma_f32_16x16x32_bf16 v[28:31], v[100:103], v[208:211], v[28:31]
    ds_read_b128 v[100:103], v8 offset:16896
    s_waitcnt lgkmcnt(7)
    v_mfma_f32_16x16x32_bf16 v[24:27], v[104:107], v[212:215], v[24:27]
    ds_read_b128 v[104:107], v9 offset:512
    s_waitcnt lgkmcnt(7)
    v_mfma_f32_16x16x32_bf16 v[28:31], v[108:111], v[212:215], v[28:31]
    ds_read_b128 v[108:111], v9 offset:16896
    s_waitcnt lgkmcnt(7)
    v_mfma_f32_16x16x32_bf16 v[24:27], v[112:115], v[216:219], v[24:27]
    ds_read_b128 v[112:115], v10 offset:512
    s_waitcnt lgkmcnt(7)
    v_mfma_f32_16x16x32_bf16 v[28:31], v[116:119], v[216:219], v[28:31]
    ds_read_b128 v[116:119], v10 offset:16896
    s_waitcnt lgkmcnt(7)
    v_mfma_f32_16x16x32_bf16 v[24:27], v[120:123], v[220:223], v[24:27]
    ds_read_b128 v[120:123], v11 offset:512
    s_waitcnt lgkmcnt(7)
    v_mfma_f32_16x16x32_bf16 v[28:31], v[124:127], v[220:223], v[28:31]
    ds_read_b128 v[124:127], v11 offset:16896
    s_waitcnt lgkmcnt(7)
    v_mfma_f32_16x16x32_bf16 v[24:27], v[96:99], v[224:227], v[24:27]
    ds_read_b128 v[96:99], v8 offset:768
    s_waitcnt lgkmcnt(7)
    v_mfma_f32_16x16x32_bf16 v[28:31], v[100:103], v[224:227], v[28:31]
    ds_read_b128 v[100:103], v8 offset:17152
    s_waitcnt lgkmcnt(7)
    v_mfma_f32_16x16x32_bf16 v[24:27], v[104:107], v[228:231], v[24:27]
    ds_read_b128 v[104:107], v9 offset:768
    s_waitcnt lgkmcnt(7)
    v_mfma_f32_16x16x32_bf16 v[28:31], v[108:111], v[228:231], v[28:31]
    ds_read_b128 v[108:111], v9 offset:17152
    s_waitcnt lgkmcnt(7)
    v_mfma_f32_16x16x32_bf16 v[24:27], v[112:115], v[232:235], v[24:27]
    ds_read_b128 v[112:115], v10 offset:768
    s_waitcnt lgkmcnt(7)
    v_mfma_f32_16x16x32_bf16 v[28:31], v[116:119], v[232:235], v[28:31]
    ds_read_b128 v[116:119], v10 offset:17152
    s_waitcnt lgkmcnt(7)
    v_mfma_f32_16x16x32_bf16 v[24:27], v[120:123], v[236:239], v[24:27]
    ds_read_b128 v[120:123], v11 offset:768
    s_waitcnt lgkmcnt(7)
    v_mfma_f32_16x16x32_bf16 v[28:31], v[124:127], v[236:239], v[28:31]
    ds_read_b128 v[124:127], v11 offset:17152
    s_waitcnt lgkmcnt(7)
    v_mfma_f32_16x16x32_bf16 v[24:27], v[96:99], v[240:243], v[24:27]
    s_waitcnt lgkmcnt(6)
    v_mfma_f32_16x16x32_bf16 v[28:31], v[100:103], v[240:243], v[28:31]
    s_waitcnt lgkmcnt(5)
    v_mfma_f32_16x16x32_bf16 v[24:27], v[104:107], v[244:247], v[24:27]
    s_waitcnt lgkmcnt(4)
    v_mfma_f32_16x16x32_bf16 v[28:31], v[108:111], v[244:247], v[28:31]
    s_waitcnt lgkmcnt(3)
    v_mfma_f32_16x16x32_bf16 v[24:27], v[112:115], v[248:251], v[24:27]
    s_waitcnt lgkmcnt(2)
    v_mfma_f32_16x16x32_bf16 v[28:31], v[116:119], v[248:251], v[28:31]
    s_waitcnt lgkmcnt(1)
    v_mfma_f32_16x16x32_bf16 v[24:27], v[120:123], v[252:255], v[24:27]
    s_waitcnt lgkmcnt(0)
    v_mfma_f32_16x16x32_bf16 v[28:31], v[124:127], v[252:255], v[28:31]
    s_nop 7
    s_nop 1
    v_max3_f32 v40, v24, v25, v26
    v_max3_f32 v40, v40, v27, v28
    v_max3_f32 v40, v40, v29, v30
    v_max_f32 v40, v40, v31
    v_mov_b32 v41, v40
    s_nop 1
    v_permlane32_swap_b32 v40, v41
    s_nop 1
    v_max_f32 v40, v40, v41
    v_mov_b32 v41, v40
    s_nop 1
    v_permlane16_swap_b32 v40, v41
    s_nop 1
    v_max_f32 v40, v40, v41
    ds_write_b32 v21, v40
    s_waitcnt lgkmcnt(0)
    s_barrier
    ds_read_b128 v[40:43], v22
    ds_read_b128 v[44:47], v23
    s_waitcnt lgkmcnt(1)
    v_max3_f32 v40, v40, v41, v42
    v_max3_f32 v20, v40, v43, v20
    v_sub_f32 v24, v24, v20
    v_sub_f32 v25, v25, v20
    v_sub_f32 v26, v26, v20
    v_sub_f32 v27, v27, v20
    v_sub_f32 v28, v28, v20
    v_sub_f32 v29, v29, v20
    v_sub_f32 v30, v30, v20
    v_sub_f32 v31, v31, v20
    v_exp_f32 v24, v24
    v_exp_f32 v25, v25
    v_exp_f32 v26, v26
    v_exp_f32 v27, v27
    v_exp_f32 v28, v28
    v_exp_f32 v29, v29
    v_exp_f32 v30, v30
    v_exp_f32 v31, v31
    s_waitcnt lgkmcnt(0)
    v_max3_f32 v44, v44, v45, v46
    v_max3_f32 v44, v44, v47, v18
    v_sub_f32 v32, v18, v44
    v_exp_f32 v32, v32
    v_mov_b32 v18, v44
    v_add_f32 v40, v24, v25
    v_add_f32 v40, v40, v26
    v_add_f32 v40, v40, v27
    v_add_f32 v40, v40, v28
    v_add_f32 v40, v40, v29
    v_add_f32 v40, v40, v30
    v_add_f32 v40, v40, v31
    v_cvt_pk_bf16_f32 v48, v24, v25
    v_cvt_pk_bf16_f32 v49, v26, v27
    v_cvt_pk_bf16_f32 v50, v28, v29
    v_cvt_pk_bf16_f32 v51, v30, v31
    ds_write_b64 v17, v[48:49] offset:0
    ds_write_b64 v17, v[50:51] offset:32
    v_mov_b32 v41, v40
    s_nop 1
    v_permlane32_swap_b32 v40, v41
    s_nop 1
    v_add_f32 v40, v40, v41
    v_mov_b32 v41, v40
    s_nop 1
    v_permlane16_swap_b32 v40, v41
    s_nop 1
    v_add_f32 v40, v40, v41
    ds_write_b32 v21, v40 offset:512
    s_waitcnt lgkmcnt(0)
    s_barrier
    ds_read_b128 v[40:43], v23 offset:512
    v_mul_f32 v64, v64, v32
    v_mul_f32 v65, v65, v32
    v_mul_f32 v66, v66, v32
    v_mul_f32 v67, v67, v32
    v_mul_f32 v68, v68, v32
    v_mul_f32 v69, v69, v32
    v_mul_f32 v70, v70, v32
    v_mul_f32 v71, v71, v32
    v_mul_f32 v72, v72, v32
    v_mul_f32 v73, v73, v32
    v_mul_f32 v74, v74, v32
    v_mul_f32 v75, v75, v32
    v_mul_f32 v76, v76, v32
    v_mul_f32 v77, v77, v32
    v_mul_f32 v78, v78, v32
    v_mul_f32 v79, v79, v32
    v_mul_f32 v80, v80, v32
    v_mul_f32 v81, v81, v32
    v_mul_f32 v82, v82, v32
    v_mul_f32 v83, v83, v32
    v_mul_f32 v84, v84, v32
    v_mul_f32 v85, v85, v32
    v_mul_f32 v86, v86, v32
    v_mul_f32 v87, v87, v32
    v_mul_f32 v88, v88, v32
    v_mul_f32 v89, v89, v32
    v_mul_f32 v90, v90, v32
    v_mul_f32 v91, v91, v32
    v_mul_f32 v92, v92, v32
    v_mul_f32 v93, v93, v32
    v_mul_f32 v94, v94, v32
    v_mul_f32 v95, v95, v32
    ds_read_b128 v[96:99], v16 offset:0
    ds_read_b64_tr_b16 v[100:101], v12 offset:0
    ds_read_b64_tr_b16 v[102:103], v14 offset:0
    ds_read_b64_tr_b16 v[104:105], v13 offset:0
    ds_read_b64_tr_b16 v[106:107], v15 offset:0
    ds_read_b128 v[108:111], v16 offset:32
    ds_read_b64_tr_b16 v[112:113], v12 offset:16384
    ds_read_b64_tr_b16 v[114:115], v14 offset:16384
    ds_read_b64_tr_b16 v[116:117], v13 offset:16384
    ds_read_b64_tr_b16 v[118:119], v15 offset:16384
    s_waitcnt lgkmcnt(5)
    v_mfma_f32_32x32x16_bf16 v[64:79], v[100:103], v[96:99], v[64:79]
    v_mfma_f32_32x32x16_bf16 v[80:95], v[104:107], v[96:99], v[80:95]
    ds_read_b128 v[96:99], v16 offset:64
    ds_read_b64_tr_b16 v[100:101], v12 offset:32768
    ds_read_b64_tr_b16 v[102:103], v14 offset:32768
    ds_read_b64_tr_b16 v[104:105], v13 offset:32768
    ds_read_b64_tr_b16 v[106:107], v15 offset:32768
    s_waitcnt lgkmcnt(5)
    v_mfma_f32_32x32x16_bf16 v[64:79], v[112:115], v[108:111], v[64:79]
    v_mfma_f32_32x32x16_bf16 v[80:95], v[116:119], v[108:111], v[80:95]
    ds_read_b128 v[108:111], v16 offset:96
    ds_read_b64_tr_b16 v[112:113], v12 offset:49152
    ds_read_b64_tr_b16 v[114:115], v14 offset:49152
    ds_read_b64_tr_b16 v[116:117], v13 offset:49152
    ds_read_b64_tr_b16 v[118:119], v15 offset:49152
    s_waitcnt lgkmcnt(5)
    v_mfma_f32_32x32x16_bf16 v[64:79], v[100:103], v[96:99], v[64:79]
    v_mfma_f32_32x32x16_bf16 v[80:95], v[104:107], v[96:99], v[80:95]
    v_add_u32 v12, 0x10000, v12
    v_add_u32 v13, 0x10000, v13
    v_add_u32 v14, 0x10000, v14
    v_add_u32 v15, 0x10000, v15
    ds_read_b128 v[96:99], v16 offset:128
    ds_read_b64_tr_b16 v[100:101], v12 offset:0
    ds_read_b64_tr_b16 v[102:103], v14 offset:0
    ds_read_b64_tr_b16 v[104:105], v13 offset:0
    ds_read_b64_tr_b16 v[106:107], v15 offset:0
    s_waitcnt lgkmcnt(5)
    v_mfma_f32_32x32x16_bf16 v[64:79], v[112:115], v[108:111], v[64:79]
    v_mfma_f32_32x32x16_bf16 v[80:95], v[116:119], v[108:111], v[80:95]
    ds_read_b128 v[108:111], v16 offset:160
    ds_read_b64_tr_b16 v[112:113], v12 offset:16384
    ds_read_b64_tr_b16 v[114:115], v14 offset:16384
    ds_read_b64_tr_b16 v[116:117], v13 offset:16384
    ds_read_b64_tr_b16 v[118:119], v15 offset:16384
    s_waitcnt lgkmcnt(5)
    v_mfma_f32_32x32x16_bf16 v[64:79], v[100:103], v[96:99], v[64:79]
    v_mfma_f32_32x32x16_bf16 v[80:95], v[104:107], v[96:99], v[80:95]
    ds_read_b128 v[96:99], v16 offset:192
    ds_read_b64_tr_b16 v[100:101], v12 offset:32768
    ds_read_b64_tr_b16 v[102:103], v14 offset:32768
    ds_read_b64_tr_b16 v[104:105], v13 offset:32768
    ds_read_b64_tr_b16 v[106:107], v15 offset:32768
    s_waitcnt lgkmcnt(5)
    v_mfma_f32_32x32x16_bf16 v[64:79], v[112:115], v[108:111], v[64:79]
    v_mfma_f32_32x32x16_bf16 v[80:95], v[116:119], v[108:111], v[80:95]
    ds_read_b128 v[108:111], v16 offset:224
    ds_read_b64_tr_b16 v[112:113], v12 offset:49152
    ds_read_b64_tr_b16 v[114:115], v14 offset:49152
    ds_read_b64_tr_b16 v[116:117], v13 offset:49152
    ds_read_b64_tr_b16 v[118:119], v15 offset:49152
    s_waitcnt lgkmcnt(5)
    v_mfma_f32_32x32x16_bf16 v[64:79], v[100:103], v[96:99], v[64:79]
    v_mfma_f32_32x32x16_bf16 v[80:95], v[104:107], v[96:99], v[80:95]
    s_waitcnt lgkmcnt(0)
    v_mfma_f32_32x32x16_bf16 v[64:79], v[112:115], v[108:111], v[64:79]
    v_mfma_f32_32x32x16_bf16 v[80:95], v[116:119], v[108:111], v[80:95]
    v_subrev_u32 v12, 0x10000, v12
    v_subrev_u32 v13, 0x10000, v13
    v_subrev_u32 v14, 0x10000, v14
    v_subrev_u32 v15, 0x10000, v15
    v_add_f32 v40, v40, v41
    v_add_f32 v42, v42, v43
    v_add_f32 v40, v40, v42
    v_fma_f32 v19, v19, v32, v40
    s_barrier
    s_nop 7
    s_nop 3
    v_and_b32 v43, 31, v1
    v_lshrrev_b32 v44, 5, v1
    v_mul_u32_u24 v40, 1040, v43
    v_lshl_add_u32 v40, v44, 3, v40
    s_lshl_b32 s61, s56, 7
    v_add_u32 v40, s61, v40
    v_cvt_pk_bf16_f32 v64, v64, v65
    v_cvt_pk_bf16_f32 v65, v66, v67
    ds_write_b64 v40, v[64:65] offset:0
    v_cvt_pk_bf16_f32 v68, v68, v69
    v_cvt_pk_bf16_f32 v69, v70, v71
    ds_write_b64 v40, v[68:69] offset:16
    v_cvt_pk_bf16_f32 v72, v72, v73
    v_cvt_pk_bf16_f32 v73, v74, v75
    ds_write_b64 v40, v[72:73] offset:32
    v_cvt_pk_bf16_f32 v76, v76, v77
    v_cvt_pk_bf16_f32 v77, v78, v79
    ds_write_b64 v40, v[76:77] offset:48
    v_cvt_pk_bf16_f32 v80, v80, v81
    v_cvt_pk_bf16_f32 v81, v82, v83
    ds_write_b64 v40, v[80:81] offset:64
    v_cvt_pk_bf16_f32 v84, v84, v85
    v_cvt_pk_bf16_f32 v85, v86, v87
    ds_write_b64 v40, v[84:85] offset:80
    v_cvt_pk_bf16_f32 v88, v88, v89
    v_cvt_pk_bf16_f32 v89, v90, v91
    ds_write_b64 v40, v[88:89] offset:96
    v_cvt_pk_bf16_f32 v92, v92, v93
    v_cvt_pk_bf16_f32 v93, v94, v95
    ds_write_b64 v40, v[92:93] offset:112
    v_mov_b32 v46, v18
    v_mov_b32 v47, v19
    v_lshlrev_b32 v45, 8, v43
    s_lshl_b32 s62, s65, 3
    s_add_u32 s62, s62, 1245184
    s_cmp_lg_u32 s56, 0
    s_cbranch_scc1 Lml_65
    s_mov_b64 exec, 0xffffffff
    buffer_store_dwordx2 v[46:47], v45, s[32:35], s62 offen sc0 sc1
    s_mov_b64 exec, -1
Lml_65:
    v_mov_b32 v40, 0
    v_mov_b32 v43, 98816
    ds_write_b32 v43, v40
    s_waitcnt lgkmcnt(0)
    s_barrier
    s_mul_i32 s61, s56, 4160
    v_add_u32 v40, s61, v5
    ds_read_b128 v[96:99], v40 offset:0
    ds_read_b128 v[100:103], v40 offset:1040
    ds_read_b128 v[104:107], v40 offset:2080
    ds_read_b128 v[108:111], v40 offset:3120
    s_lshl_b32 s61, s65, 15
    s_lshl_b32 s62, s56, 12
    s_add_u32 s61, s61, s62
    s_add_u32 s61, s61, 2097152
    s_waitcnt lgkmcnt(3)
    buffer_store_dwordx4 v[96:99], v5, s[32:35], s61 offen offset:0 sc0 sc1
    s_waitcnt lgkmcnt(2)
    buffer_store_dwordx4 v[100:103], v5, s[32:35], s61 offen offset:1024 sc0 sc1
    s_waitcnt lgkmcnt(1)
    buffer_store_dwordx4 v[104:107], v5, s[32:35], s61 offen offset:2048 sc0 sc1
    s_waitcnt lgkmcnt(0)
    buffer_store_dwordx4 v[108:111], v5, s[32:35], s61 offen offset:3072 sc0 sc1
    s_waitcnt vmcnt(0)
    s_barrier
    s_cmp_lg_u32 s56, 0
    s_cbranch_scc1 Lpf_66
    v_lshlrev_b32 v40, 14, v1
    v_mov_b32 v41, 0
    s_lshl_b32 s61, s65, 2
    s_add_u32 s61, s61, 0
    s_mov_b64 exec, 0xffffffff
    buffer_store_dword v41, v40, s[32:35], s61 offen sc0 sc1
    s_mov_b64 exec, -1
Lpf_66:
    s_mov_b32 s79, 24
    s_mov_b32 s80, 5376
    s_cmp_lt_u32 s56, 4
    s_cbranch_scc1 Ld03_68
    s_cmp_lg_u32 s56, 7
    s_cbranch_scc1 L_distw
    v_lshlrev_b32 v40, 13, v1
    s_lshl_b32 s61, s65, 8
    s_add_u32 s61, s61, 1507328
    s_mov_b32 s92, 0
    s_mov_b64 exec, 3
Lwogl_69:
    buffer_load_dword v41, v40, s[32:35], s61 offen sc0 sc1
    s_waitcnt vmcnt(0)
    v_cmp_gt_u32 vcc, 65756, v41
    s_cbranch_vccz Lwogd_70
    s_sleep 8
    s_add_u32 s92, s92, 1
    s_cmp_lt_u32 s92, 400000
    s_cbranch_scc1 Lwogl_69
Lwogd_70:
    s_mov_b64 exec, -1
    s_mov_b32 s62, 768
    s_mov_b32 s36, s14
    s_mov_b32 s37, s15
    s_and_b32 s37, s37, 0xffff
    s_mov_b32 s38, 4194304
    s_mov_b32 s39, 0x00020000
    v_or_b32 v40, 0, v2
    v_lshlrev_b32 v40, 1, v40
    v_xor_b32 v40, v40, v3
    v_lshlrev_b32 v40, 4, v40
    v_lshl_add_u32 v44, v2, 10, v40
    v_or_b32 v40, 4, v2
    v_lshlrev_b32 v40, 1, v40
    v_xor_b32 v40, v40, v3
    v_lshlrev_b32 v40, 4, v40
    v_lshl_add_u32 v45, v2, 10, v40
    s_lshl_b32 s61, s65, 17
    s_add_u32 s61, s61, s62
    s_mov_b32 m0, 65536
    s_nop 0
    buffer_load_dwordx4 v44, s[36:39], s61 offen nt lds
    s_mov_b32 m0, 66560
    s_add_u32 s61, s61, 4096
    buffer_load_dwordx4 v44, s[36:39], s61 offen nt lds
    s_mov_b32 m0, 67584
    s_add_u32 s61, s61, 4096
    buffer_load_dwordx4 v45, s[36:39], s61 offen nt lds
    s_mov_b32 m0, 68608
    s_add_u32 s61, s61, 4096
    buffer_load_dwordx4 v45, s[36:39], s61 offen nt lds
    s_mov_b32 m0, 69632
    s_add_u32 s61, s61, 4096
    buffer_load_dwordx4 v44, s[36:39], s61 offen nt lds
    s_mov_b32 m0, 70656
    s_add_u32 s61, s61, 4096
    buffer_load_dwordx4 v44, s[36:39], s61 offen nt lds
    s_mov_b32 m0, 71680
    s_add_u32 s61, s61, 4096
    buffer_load_dwordx4 v45, s[36:39], s61 offen nt lds
    s_mov_b32 m0, 72704
    s_add_u32 s61, s61, 4096
    buffer_load_dwordx4 v45, s[36:39], s61 offen nt lds
    s_mov_b32 m0, 73728
    s_add_u32 s61, s61, 4096
    buffer_load_dwordx4 v44, s[36:39], s61 offen nt lds
    s_mov_b32 m0, 74752
    s_add_u32 s61, s61, 4096
    buffer_load_dwordx4 v44, s[36:39], s61 offen nt lds
    s_mov_b32 m0, 75776
    s_add_u32 s61, s61, 4096
    buffer_load_dwordx4 v45, s[36:39], s61 offen nt lds
    s_mov_b32 m0, 76800
    s_add_u32 s61, s61, 4096
    buffer_load_dwordx4 v45, s[36:39], s61 offen nt lds
    s_mov_b32 m0, 77824
    s_add_u32 s61, s61, 4096
    buffer_load_dwordx4 v44, s[36:39], s61 offen nt lds
    s_mov_b32 m0, 78848
    s_add_u32 s61, s61, 4096
    buffer_load_dwordx4 v44, s[36:39], s61 offen nt lds
    s_mov_b32 m0, 79872
    s_add_u32 s61, s61, 4096
    buffer_load_dwordx4 v45, s[36:39], s61 offen nt lds
    s_mov_b32 m0, 80896
    s_add_u32 s61, s61, 4096
    buffer_load_dwordx4 v45, s[36:39], s61 offen nt lds
    s_mov_b32 m0, 81920
    s_add_u32 s61, s61, 4096
    buffer_load_dwordx4 v44, s[36:39], s61 offen nt lds
    s_mov_b32 m0, 82944
    s_add_u32 s61, s61, 4096
    buffer_load_dwordx4 v44, s[36:39], s61 offen nt lds
    s_mov_b32 m0, 83968
    s_add_u32 s61, s61, 4096
    buffer_load_dwordx4 v45, s[36:39], s61 offen nt lds
    s_mov_b32 m0, 84992
    s_add_u32 s61, s61, 4096
    buffer_load_dwordx4 v45, s[36:39], s61 offen nt lds
    s_mov_b32 m0, 86016
    s_add_u32 s61, s61, 4096
    buffer_load_dwordx4 v44, s[36:39], s61 offen nt lds
    s_mov_b32 m0, 87040
    s_add_u32 s61, s61, 4096
    buffer_load_dwordx4 v44, s[36:39], s61 offen nt lds
    s_mov_b32 m0, 88064
    s_add_u32 s61, s61, 4096
    buffer_load_dwordx4 v45, s[36:39], s61 offen nt lds
    s_mov_b32 m0, 89088
    s_add_u32 s61, s61, 4096
    buffer_load_dwordx4 v45, s[36:39], s61 offen nt lds
    s_mov_b32 m0, 90112
    s_add_u32 s61, s61, 4096
    buffer_load_dwordx4 v44, s[36:39], s61 offen nt lds
    s_mov_b32 m0, 91136
    s_add_u32 s61, s61, 4096
    buffer_load_dwordx4 v44, s[36:39], s61 offen nt lds
    s_mov_b32 m0, 92160
    s_add_u32 s61, s61, 4096
    buffer_load_dwordx4 v45, s[36:39], s61 offen nt lds
    s_mov_b32 m0, 93184
    s_add_u32 s61, s61, 4096
    buffer_load_dwordx4 v45, s[36:39], s61 offen nt lds
    s_mov_b32 m0, 94208
    s_add_u32 s61, s61, 4096
    buffer_load_dwordx4 v44, s[36:39], s61 offen nt lds
    s_mov_b32 m0, 95232
    s_add_u32 s61, s61, 4096
    buffer_load_dwordx4 v44, s[36:39], s61 offen nt lds
    s_mov_b32 m0, 96256
    s_add_u32 s61, s61, 4096
    buffer_load_dwordx4 v45, s[36:39], s61 offen nt lds
    s_mov_b32 m0, 97280
    s_add_u32 s61, s61, 4096
    buffer_load_dwordx4 v45, s[36:39], s61 offen nt lds
    s_add_u32 s61, s65, 32
    s_mul_i32 s61, s61, 16384
    s_add_u32 s61, s61, 7424
    v_lshlrev_b32 v46, 3, v1
    s_mov_b32 s92, 0
Lpoll_71:
    buffer_load_dwordx2 v[48:49], v46, s[32:35], s61 offen sc0 sc1
    s_waitcnt vmcnt(0)
    v_mov_b32 v45, v48
    v_max_u32 v45, v45, v49
    v_cmpx_eq_u32 vcc, -1, v45
    s_cbranch_execz Lpolld_72
    s_sleep 2
    s_add_u32 s92, s92, 1
    s_cmp_lt_u32 s92, 400000
    s_cbranch_scc1 Lpoll_71
Lpolld_72:
    s_mov_b64 exec, -1
    v_add_u32 v46, 98304, v46
    ds_write_b64 v46, v[48:49]
    s_waitcnt lgkmcnt(0)
    v_mov_b32 v40, 1
    v_mov_b32 v43, 98816
    ds_write_b32 v43, v40
    s_waitcnt lgkmcnt(0)
    s_branch L_dist
Ld03_68:
    s_barrier
    s_branch L_final
L_roleT1:
    s_mov_b32 s65, s75
    s_waitcnt vmcnt(0)
    s_barrier
    s_cmp_lg_u32 s56, 1
    s_cbranch_scc1 Lsc_73
    v_mov_b32 v40, 1
    v_mov_b32 v41, 0
    s_mov_b64 s[94:95], exec
    s_mov_b64 exec, 1
    buffer_atomic_add v40, v41, s[52:55], 0 offen offset:128 sc1
    s_mov_b64 exec, s[94:95]
Lsc_73:
    s_waitcnt vmcnt(0)
    v_perm_b32 v232, v196, v192, s68
    v_perm_b32 v233, v196, v192, s69
    v_perm_b32 v234, v197, v193, s68
    v_perm_b32 v235, v197, v193, s69
    v_perm_b32 v236, v198, v194, s68
    v_perm_b32 v237, v198, v194, s69
    v_perm_b32 v238, v199, v195, s68
    v_perm_b32 v239, v199, v195, s69
    v_dot2_f32_bf16 v212, v232, v208, 0
    v_dot2_f32_bf16 v213, v233, v208, 0
    v_dot2_f32_bf16 v214, v234, v208, 0
    v_dot2_f32_bf16 v215, v235, v208, 0
    v_dot2_f32_bf16 v216, v236, v208, 0
    v_dot2_f32_bf16 v217, v237, v208, 0
    v_dot2_f32_bf16 v218, v238, v208, 0
    v_dot2_f32_bf16 v219, v239, v208, 0
    v_dot2_f32_bf16 v220, v232, v210, 0
    v_dot2_f32_bf16 v221, v233, v210, 0
    v_dot2_f32_bf16 v222, v234, v210, 0
    v_dot2_f32_bf16 v223, v235, v210, 0
    v_dot2_f32_bf16 v224, v236, v210, 0
    v_dot2_f32_bf16 v225, v237, v210, 0
    v_dot2_f32_bf16 v226, v238, v210, 0
    v_dot2_f32_bf16 v227, v239, v210, 0
    v_perm_b32 v232, v204, v200, s68
    v_perm_b32 v233, v204, v200, s69
    v_perm_b32 v234, v205, v201, s68
    v_perm_b32 v235, v205, v201, s69
    v_perm_b32 v236, v206, v202, s68
    v_perm_b32 v237, v206, v202, s69
    v_perm_b32 v238, v207, v203, s68
    v_perm_b32 v239, v207, v203, s69
    v_dot2_f32_bf16 v212, v232, v209, v212
    v_dot2_f32_bf16 v213, v233, v209, v213
    v_dot2_f32_bf16 v214, v234, v209, v214
    v_dot2_f32_bf16 v215, v235, v209, v215
    v_dot2_f32_bf16 v216, v236, v209, v216
    v_dot2_f32_bf16 v217, v237, v209, v217
    v_dot2_f32_bf16 v218, v238, v209, v218
    v_dot2_f32_bf16 v219, v239, v209, v219
    v_dot2_f32_bf16 v220, v232, v211, v220
    v_dot2_f32_bf16 v221, v233, v211, v221
    v_dot2_f32_bf16 v222, v234, v211, v222
    v_dot2_f32_bf16 v223, v235, v211, v223
    v_dot2_f32_bf16 v224, v236, v211, v224
    v_dot2_f32_bf16 v225, v237, v211, v225
    v_dot2_f32_bf16 v226, v238, v211, v226
    v_dot2_f32_bf16 v227, v239, v211, v227
    s_nop 2
    v_permlane32_swap_b32 v212, v220
    v_permlane32_swap_b32 v213, v221
    v_permlane32_swap_b32 v214, v222
    v_permlane32_swap_b32 v215, v223
    v_permlane32_swap_b32 v216, v224
    v_permlane32_swap_b32 v217, v225
    v_permlane32_swap_b32 v218, v226
    v_permlane32_swap_b32 v219, v227
    s_nop 1
    v_add_f32 v212, v212, v220
    v_add_f32 v213, v213, v221
    v_add_f32 v214, v214, v222
    v_add_f32 v215, v215, v223
    v_add_f32 v216, v216, v224
    v_add_f32 v217, v217, v225
    v_add_f32 v218, v218, v226
    v_add_f32 v219, v219, v227
    s_nop 1
    v_permlane16_swap_b32 v212, v216
    v_permlane16_swap_b32 v213, v217
    v_permlane16_swap_b32 v214, v218
    v_permlane16_swap_b32 v215, v219
    s_nop 1
    v_add_f32 v212, v212, v216
    v_add_f32 v213, v213, v217
    v_add_f32 v214, v214, v218
    v_add_f32 v215, v215, v219
    s_nop 1
    v_add_f32_dpp v212, v212, v212 row_ror:8 row_mask:0xf bank_mask:0xf
    v_add_f32_dpp v213, v213, v213 row_ror:8 row_mask:0xf bank_mask:0xf
    v_add_f32_dpp v214, v214, v214 row_ror:8 row_mask:0xf bank_mask:0xf
    v_add_f32_dpp v215, v215, v215 row_ror:8 row_mask:0xf bank_mask:0xf
    v_lshrrev_b32 v232, 5, v228
    v_lshlrev_b32 v232, 8, v232
    v_bfe_u32 v233, v228, 4, 1
    v_lshl_add_u32 v232, v233, 4, v232
    v_lshl_add_u32 v232, v230, 5, v232
    s_lshl_b32 s61, s56, 9
    s_add_u32 s61, s61, 131072
    v_add_u32 v232, s61, v232
    ds_write_b128 v232, v[212:215]
    s_waitcnt lgkmcnt(0)
    s_barrier
    s_cmp_eq_u32 s56, 0
    s_cbranch_scc1 Ls1p0_75
    s_mov_b32 s44, s10
    s_mov_b32 s45, s11
    s_and_b32 s45, s45, 0xffff
    s_mov_b32 s46, 4194304
    s_mov_b32 s47, 0x00020000
    v_xor_b32 v52, v3, v2
    v_lshlrev_b32 v51, 13, v2
    v_xor_b32 v53, 4, v52
    v_xor_b32 v54, 8, v52
    v_xor_b32 v55, 12, v52
    v_lshl_add_u32 v52, v52, 4, v51
    v_lshl_add_u32 v53, v53, 4, v51
    v_lshl_add_u32 v54, v54, 4, v51
    v_lshl_add_u32 v55, v55, 4, v51
    s_lshl_b32 s61, s56, 19
    s_lshl_b32 s62, s65, 8
    s_add_u32 s62, s62, s61
    s_lshl_b32 s61, s56, 14
    s_add_u32 m0, s61, 0
    s_nop 0
    buffer_load_dwordx4 v52, s[44:47], s62 offen nt lds
    s_add_u32 m0, s61, 1024
    s_add_u32 s62, s62, 32768
    buffer_load_dwordx4 v52, s[44:47], s62 offen nt lds
    s_add_u32 m0, s61, 2048
    s_add_u32 s62, s62, 32768
    buffer_load_dwordx4 v52, s[44:47], s62 offen nt lds
    s_add_u32 m0, s61, 3072
    s_add_u32 s62, s62, 32768
    buffer_load_dwordx4 v52, s[44:47], s62 offen nt lds
    s_add_u32 m0, s61, 4096
    s_add_u32 s62, s62, 32768
    buffer_load_dwordx4 v53, s[44:47], s62 offen nt lds
    s_add_u32 m0, s61, 5120
    s_add_u32 s62, s62, 32768
    buffer_load_dwordx4 v53, s[44:47], s62 offen nt lds
    s_add_u32 m0, s61, 6144
    s_add_u32 s62, s62, 32768
    buffer_load_dwordx4 v53, s[44:47], s62 offen nt lds
    s_add_u32 m0, s61, 7168
    s_add_u32 s62, s62, 32768
    buffer_load_dwordx4 v53, s[44:47], s62 offen nt lds
    s_add_u32 m0, s61, 8192
    s_add_u32 s62, s62, 32768
    buffer_load_dwordx4 v54, s[44:47], s62 offen nt lds
    s_add_u32 m0, s61, 9216
    s_add_u32 s62, s62, 32768
    buffer_load_dwordx4 v54, s[44:47], s62 offen nt lds
    s_add_u32 m0, s61, 10240
    s_add_u32 s62, s62, 32768
    buffer_load_dwordx4 v54, s[44:47], s62 offen nt lds
    s_add_u32 m0, s61, 11264
    s_add_u32 s62, s62, 32768
    buffer_load_dwordx4 v54, s[44:47], s62 offen nt lds
    s_add_u32 m0, s61, 12288
    s_add_u32 s62, s62, 32768
    buffer_load_dwordx4 v55, s[44:47], s62 offen nt lds
    s_add_u32 m0, s61, 13312
    s_add_u32 s62, s62, 32768
    buffer_load_dwordx4 v55, s[44:47], s62 offen nt lds
    s_add_u32 m0, s61, 14336
    s_add_u32 s62, s62, 32768
    buffer_load_dwordx4 v55, s[44:47], s62 offen nt lds
    s_add_u32 m0, s61, 15360
    s_add_u32 s62, s62, 32768
    buffer_load_dwordx4 v55, s[44:47], s62 offen nt lds
    s_branch Ls1p_74
Ls1p0_75:
    v_mov_b32 v234, 0
    buffer_load_dword v235, v234, s[52:55], s91 offen offset:0 sc0 sc1
    v_and_b32 v232, 31, v228
    v_lshlrev_b32 v233, 4, v232
    v_add_u32 v233, 131072, v233
    ds_read_b128 v[192:195], v233 offset:0
    ds_read_b128 v[196:199], v233 offset:512
    ds_read_b128 v[200:203], v233 offset:1024
    ds_read_b128 v[204:207], v233 offset:1536
    ds_read_b128 v[208:211], v233 offset:2048
    ds_read_b128 v[212:215], v233 offset:2560
    ds_read_b128 v[216:219], v233 offset:3072
    ds_read_b128 v[220:223], v233 offset:3584
    s_waitcnt lgkmcnt(6)
    v_add_f32 v192, v192, v196
    v_add_f32 v193, v193, v197
    v_add_f32 v194, v194, v198
    v_add_f32 v195, v195, v199
    s_waitcnt lgkmcnt(5)
    v_add_f32 v192, v192, v200
    v_add_f32 v193, v193, v201
    v_add_f32 v194, v194, v202
    v_add_f32 v195, v195, v203
    s_waitcnt lgkmcnt(4)
    v_add_f32 v192, v192, v204
    v_add_f32 v193, v193, v205
    v_add_f32 v194, v194, v206
    v_add_f32 v195, v195, v207
    s_waitcnt lgkmcnt(3)
    v_add_f32 v192, v192, v208
    v_add_f32 v193, v193, v209
    v_add_f32 v194, v194, v210
    v_add_f32 v195, v195, v211
    s_waitcnt lgkmcnt(2)
    v_add_f32 v192, v192, v212
    v_add_f32 v193, v193, v213
    v_add_f32 v194, v194, v214
    v_add_f32 v195, v195, v215
    s_waitcnt lgkmcnt(1)
    v_add_f32 v192, v192, v216
    v_add_f32 v193, v193, v217
    v_add_f32 v194, v194, v218
    v_add_f32 v195, v195, v219
    s_waitcnt lgkmcnt(0)
    v_add_f32 v192, v192, v220
    v_add_f32 v193, v193, v221
    v_add_f32 v194, v194, v222
    v_add_f32 v195, v195, v223
    v_lshrrev_b32 v233, 4, v232
    v_lshlrev_b32 v233, 10, v233
    v_and_b32 v232, 15, v232
    v_lshl_add_u32 v233, v232, 4, v233
    s_waitcnt vmcnt(0)
    s_mov_b32 s92, 0
Lcf_76:
    v_readfirstlane_b32 s57, v235
    s_nop 3
    s_cmp_lg_u32 s57, 0
    s_cbranch_scc1 Lcfd_77
    s_sleep 2
    buffer_load_dword v235, v234, s[52:55], s91 offen offset:0 sc0 sc1
    s_waitcnt vmcnt(0)
    s_add_u32 s92, s92, 1
    s_cmp_lt_u32 s92, 400000
    s_cbranch_scc1 Lcf_76
Lcfd_77:
    s_mov_b64 exec, 0xffffffff
    buffer_store_dwordx4 v[192:195], v233, s[32:35], s3 offen sc0 sc1
    s_mov_b64 exec, -1
    s_mov_b32 s44, s10
    s_mov_b32 s45, s11
    s_and_b32 s45, s45, 0xffff
    s_mov_b32 s46, 4194304
    s_mov_b32 s47, 0x00020000
    v_xor_b32 v52, v3, v2
    v_lshlrev_b32 v51, 13, v2
    v_xor_b32 v53, 4, v52
    v_xor_b32 v54, 8, v52
    v_xor_b32 v55, 12, v52
    v_lshl_add_u32 v52, v52, 4, v51
    v_lshl_add_u32 v53, v53, 4, v51
    v_lshl_add_u32 v54, v54, 4, v51
    v_lshl_add_u32 v55, v55, 4, v51
    s_lshl_b32 s61, s56, 19
    s_lshl_b32 s62, s65, 8
    s_add_u32 s62, s62, s61
    s_lshl_b32 s61, s56, 14
    s_add_u32 m0, s61, 0
    s_nop 0
    buffer_load_dwordx4 v52, s[44:47], s62 offen nt lds
    s_add_u32 m0, s61, 1024
    s_add_u32 s62, s62, 32768
    buffer_load_dwordx4 v52, s[44:47], s62 offen nt lds
    s_add_u32 m0, s61, 2048
    s_add_u32 s62, s62, 32768
    buffer_load_dwordx4 v52, s[44:47], s62 offen nt lds
    s_add_u32 m0, s61, 3072
    s_add_u32 s62, s62, 32768
    buffer_load_dwordx4 v52, s[44:47], s62 offen nt lds
    s_add_u32 m0, s61, 4096
    s_add_u32 s62, s62, 32768
    buffer_load_dwordx4 v53, s[44:47], s62 offen nt lds
    s_add_u32 m0, s61, 5120
    s_add_u32 s62, s62, 32768
    buffer_load_dwordx4 v53, s[44:47], s62 offen nt lds
    s_add_u32 m0, s61, 6144
    s_add_u32 s62, s62, 32768
    buffer_load_dwordx4 v53, s[44:47], s62 offen nt lds
    s_add_u32 m0, s61, 7168
    s_add_u32 s62, s62, 32768
    buffer_load_dwordx4 v53, s[44:47], s62 offen nt lds
    s_add_u32 m0, s61, 8192
    s_add_u32 s62, s62, 32768
    buffer_load_dwordx4 v54, s[44:47], s62 offen nt lds
    s_add_u32 m0, s61, 9216
    s_add_u32 s62, s62, 32768
    buffer_load_dwordx4 v54, s[44:47], s62 offen nt lds
    s_add_u32 m0, s61, 10240
    s_add_u32 s62, s62, 32768
    buffer_load_dwordx4 v54, s[44:47], s62 offen nt lds
    s_add_u32 m0, s61, 11264
    s_add_u32 s62, s62, 32768
    buffer_load_dwordx4 v54, s[44:47], s62 offen nt lds
    s_add_u32 m0, s61, 12288
    s_add_u32 s62, s62, 32768
    buffer_load_dwordx4 v55, s[44:47], s62 offen nt lds
    s_add_u32 m0, s61, 13312
    s_add_u32 s62, s62, 32768
    buffer_load_dwordx4 v55, s[44:47], s62 offen nt lds
    s_add_u32 m0, s61, 14336
    s_add_u32 s62, s62, 32768
    buffer_load_dwordx4 v55, s[44:47], s62 offen nt lds
    s_add_u32 m0, s61, 15360
    s_add_u32 s62, s62, 32768
    buffer_load_dwordx4 v55, s[44:47], s62 offen nt lds
    v_mov_b32 v46, 0
    buffer_load_dword v47, v46, s[52:55], 0 offen offset:128 sc0 sc1
    v_lshlrev_b32 v40, 4, v1
    s_lshl_b32 s61, s65, 11
    s_add_u32 s61, s61, 1310720
    s_mov_b32 s92, 0
Lpoll_78:
    buffer_load_dwordx4 v[24:27], v40, s[32:35], s61 offen offset:0 sc0 sc1
    buffer_load_dwordx4 v[32:35], v40, s[32:35], s61 offen offset:1024 sc0 sc1
    s_waitcnt vmcnt(0)
    v_mov_b32 v41, v24
    v_max3_u32 v41, v41, v25, v26
    v_max3_u32 v41, v41, v27, v32
    v_max3_u32 v41, v41, v33, v34
    v_max_u32 v41, v41, v35
    v_cmpx_eq_u32 vcc, -1, v41
    s_cbranch_execz Lpolld_79
    s_sleep 4
    s_add_u32 s92, s92, 1
    s_cmp_lt_u32 s92, 400000
    s_cbranch_scc1 Lpoll_78
Lpolld_79:
    s_mov_b64 exec, -1
    v_mov_b32 v28, v24
    v_mov_b32 v29, v25
    v_mov_b32 v30, v26
    v_mov_b32 v31, v27
    v_mov_b32 v36, v32
    v_mov_b32 v37, v33
    v_mov_b32 v38, v34
    v_mov_b32 v39, v35
    s_nop 1
    v_permlane32_swap_b32 v24, v28
    v_permlane32_swap_b32 v25, v29
    v_permlane32_swap_b32 v26, v30
    v_permlane32_swap_b32 v27, v31
    v_permlane32_swap_b32 v32, v36
    v_permlane32_swap_b32 v33, v37
    v_permlane32_swap_b32 v34, v38
    v_permlane32_swap_b32 v35, v39
    s_nop 1
    v_add_f32 v24, v24, v28
    v_add_f32 v25, v25, v29
    v_add_f32 v26, v26, v30
    v_add_f32 v27, v27, v31
    v_cvt_pk_bf16_f32 v24, v24, v25
    v_cvt_pk_bf16_f32 v25, v26, v27
    v_add_f32 v32, v32, v36
    v_add_f32 v33, v33, v37
    v_add_f32 v34, v34, v38
    v_add_f32 v35, v35, v39
    v_cvt_pk_bf16_f32 v32, v32, v33
    v_cvt_pk_bf16_f32 v33, v34, v35
    v_readfirstlane_b32 s57, v47
    s_nop 3
    s_cmp_ge_u32 s57, 64
    s_cbranch_scc1 Lcfm_80
    v_mov_b32 v46, 0
    s_mov_b32 s92, 0
Lcf_81:
    buffer_load_dword v47, v46, s[52:55], 0 offen offset:128 sc0 sc1
    s_waitcnt vmcnt(0)
    v_readfirstlane_b32 s57, v47
    s_nop 3
    s_cmp_ge_u32 s57, 64
    s_cbranch_scc1 Lcfd_82
    s_sleep 16
    s_add_u32 s92, s92, 1
    s_cmp_lt_u32 s92, 400000
    s_cbranch_scc1 Lcf_81
Lcfd_82:
Lcfm_80:
    v_and_b32 v42, 31, v1
    v_lshlrev_b32 v42, 3, v42
    v_add_u32 v42, 135168, v42
    ds_write_b64 v42, v[24:25] offset:0
    ds_write_b64 v42, v[32:33] offset:256
    s_waitcnt lgkmcnt(0)
Ls1p_74:
    v_lshrrev_b32 v40, 2, v3
    v_lshlrev_b32 v40, 12, v40
    v_and_b32 v41, 3, v3
    v_lshl_add_u32 v40, v41, 8, v40
    s_lshl_b32 s61, s56, 14
    v_add_u32 v40, s61, v40
    v_xor_b32 v41, v3, v2
    v_xor_b32 v42, 0, v41
    v_lshl_add_u32 v56, v42, 4, v40
    v_xor_b32 v42, 4, v41
    v_lshl_add_u32 v57, v42, 4, v40
    v_xor_b32 v42, 8, v41
    v_lshl_add_u32 v58, v42, 4, v40
    v_xor_b32 v42, 12, v41
    v_lshl_add_u32 v59, v42, 4, v40
    v_and_b32 v43, 1, v3
    v_lshlrev_b32 v43, 8, v43
    v_lshl_add_u32 v43, v2, 4, v43
    v_add_u32 v43, 135168, v43
    v_lshlrev_b32 v44, 15, v3
    v_lshl_add_u32 v44, v2, 5, v44
    s_lshl_b32 s63, s65, 10
    s_lshl_b32 s64, s56, 7
    s_add_u32 s63, s63, s64
    s_add_u32 s63, s63, 1146880
    s_mov_b32 s70, 1040356334
    s_waitcnt vmcnt(0)
    ds_read_b128 v[128:131], v56 offset:0
    ds_read_b128 v[132:135], v57 offset:0
    ds_read_b128 v[136:139], v58 offset:0
    ds_read_b128 v[140:143], v59 offset:0
    ds_read_b128 v[144:147], v56 offset:1024
    ds_read_b128 v[148:151], v57 offset:1024
    ds_read_b128 v[152:155], v58 offset:1024
    ds_read_b128 v[156:159], v59 offset:1024
    ds_read_b128 v[160:163], v56 offset:2048
    ds_read_b128 v[164:167], v57 offset:2048
    ds_read_b128 v[168:171], v58 offset:2048
    ds_read_b128 v[172:175], v59 offset:2048
    ds_read_b128 v[176:179], v56 offset:3072
    ds_read_b128 v[180:183], v57 offset:3072
    ds_read_b128 v[184:187], v58 offset:3072
    ds_read_b128 v[188:191], v59 offset:3072
    s_barrier
    ds_read_b128 v[8:11], v43 offset:0
    ds_read_b128 v[12:15], v43 offset:64
    ds_read_b128 v[16:19], v43 offset:128
    ds_read_b128 v[20:23], v43 offset:192
    s_waitcnt lgkmcnt(0)
    v_mfma_f32_16x16x32_bf16 v[24:27], v[128:131], v[8:11], 0
    v_mfma_f32_16x16x32_bf16 v[28:31], v[144:147], v[8:11], 0
    v_mfma_f32_16x16x32_bf16 v[32:35], v[160:163], v[8:11], 0
    v_mfma_f32_16x16x32_bf16 v[36:39], v[176:179], v[8:11], 0
    v_mfma_f32_16x16x32_bf16 v[24:27], v[132:135], v[12:15], v[24:27]
    v_mfma_f32_16x16x32_bf16 v[28:31], v[148:151], v[12:15], v[28:31]
    v_mfma_f32_16x16x32_bf16 v[32:35], v[164:167], v[12:15], v[32:35]
    v_mfma_f32_16x16x32_bf16 v[36:39], v[180:183], v[12:15], v[36:39]
    v_mfma_f32_16x16x32_bf16 v[24:27], v[136:139], v[16:19], v[24:27]
    v_mfma_f32_16x16x32_bf16 v[28:31], v[152:155], v[16:19], v[28:31]
    v_mfma_f32_16x16x32_bf16 v[32:35], v[168:171], v[16:19], v[32:35]
    v_mfma_f32_16x16x32_bf16 v[36:39], v[184:187], v[16:19], v[36:39]
    v_mfma_f32_16x16x32_bf16 v[24:27], v[140:143], v[20:23], v[24:27]
    v_mfma_f32_16x16x32_bf16 v[28:31], v[156:159], v[20:23], v[28:31]
    v_mfma_f32_16x16x32_bf16 v[32:35], v[172:175], v[20:23], v[32:35]
    v_mfma_f32_16x16x32_bf16 v[36:39], v[188:191], v[20:23], v[36:39]
    s_nop 7
    v_mul_f32 v24, s70, v24
    v_mul_f32 v25, s70, v25
    v_mul_f32 v26, s70, v26
    v_mul_f32 v27, s70, v27
    v_mul_f32 v28, s70, v28
    v_mul_f32 v29, s70, v29
    v_mul_f32 v30, s70, v30
    v_mul_f32 v31, s70, v31
    v_mul_f32 v32, s70, v32
    v_mul_f32 v33, s70, v33
    v_mul_f32 v34, s70, v34
    v_mul_f32 v35, s70, v35
    v_mul_f32 v36, s70, v36
    v_mul_f32 v37, s70, v37
    v_mul_f32 v38, s70, v38
    v_mul_f32 v39, s70, v39
    v_cvt_pk_bf16_f32 v8, v24, v25
    v_cvt_pk_bf16_f32 v9, v26, v27
    v_cvt_pk_bf16_f32 v10, v28, v29
    v_cvt_pk_bf16_f32 v11, v30, v31
    v_cvt_pk_bf16_f32 v12, v32, v33
    v_cvt_pk_bf16_f32 v13, v34, v35
    v_cvt_pk_bf16_f32 v14, v36, v37
    v_cvt_pk_bf16_f32 v15, v38, v39
    s_mov_b32 exec_lo, 0x00030003
    s_mov_b32 exec_hi, 0x00030003
    buffer_store_dwordx4 v[8:11], v44, s[32:35], s63 offen sc0 sc1
    buffer_store_dwordx4 v[12:15], v44, s[32:35], s63 offen offset:16 sc0 sc1
    s_mov_b64 exec, -1
    s_barrier
    s_mov_b32 s44, s12
    s_mov_b32 s45, s13
    s_and_b32 s45, s45, 0xffff
    s_mov_b32 s46, 4194304
    s_mov_b32 s47, 0x00020000
    s_lshl_b32 s61, s56, 19
    s_lshl_b32 s62, s65, 8
    s_add_u32 s61, s61, s62
    buffer_load_dwordx4 v[64:67], v4, s[44:47], s61 offen nt
    s_add_u32 s61, s61, 8192
    buffer_load_dwordx4 v[68:71], v4, s[44:47], s61 offen nt
    s_add_u32 s61, s61, 8192
    buffer_load_dwordx4 v[72:75], v4, s[44:47], s61 offen nt
    s_add_u32 s61, s61, 8192
    buffer_load_dwordx4 v[76:79], v4, s[44:47], s61 offen nt
    s_add_u32 s61, s61, 8192
    buffer_load_dwordx4 v[80:83], v4, s[44:47], s61 offen nt
    s_add_u32 s61, s61, 8192
    buffer_load_dwordx4 v[84:87], v4, s[44:47], s61 offen nt
    s_add_u32 s61, s61, 8192
    buffer_load_dwordx4 v[88:91], v4, s[44:47], s61 offen nt
    s_add_u32 s61, s61, 8192
    buffer_load_dwordx4 v[92:95], v4, s[44:47], s61 offen nt
    s_add_u32 s61, s61, 8192
    buffer_load_dwordx4 v[96:99], v4, s[44:47], s61 offen nt
    s_add_u32 s61, s61, 8192
    buffer_load_dwordx4 v[100:103], v4, s[44:47], s61 offen nt
    s_add_u32 s61, s61, 8192
    buffer_load_dwordx4 v[104:107], v4, s[44:47], s61 offen nt
    s_add_u32 s61, s61, 8192
    buffer_load_dwordx4 v[108:111], v4, s[44:47], s61 offen nt
    s_add_u32 s61, s61, 8192
    buffer_load_dwordx4 v[112:115], v4, s[44:47], s61 offen nt
    s_add_u32 s61, s61, 8192
    buffer_load_dwordx4 v[116:119], v4, s[44:47], s61 offen nt
    s_add_u32 s61, s61, 8192
    buffer_load_dwordx4 v[120:123], v4, s[44:47], s61 offen nt
    s_add_u32 s61, s61, 8192
    buffer_load_dwordx4 v[124:127], v4, s[44:47], s61 offen nt
    s_waitcnt vmcnt(0)
    v_perm_b32 v192, v68, v64, s68
    v_perm_b32 v193, v76, v72, s68
    v_perm_b32 v194, v84, v80, s68
    v_perm_b32 v195, v92, v88, s68
    v_perm_b32 v196, v68, v64, s69
    v_perm_b32 v197, v76, v72, s69
    v_perm_b32 v198, v84, v80, s69
    v_perm_b32 v199, v92, v88, s69
    v_perm_b32 v200, v69, v65, s68
    v_perm_b32 v201, v77, v73, s68
    v_perm_b32 v202, v85, v81, s68
    v_perm_b32 v203, v93, v89, s68
    v_perm_b32 v204, v69, v65, s69
    v_perm_b32 v205, v77, v73, s69
    v_perm_b32 v206, v85, v81, s69
    v_perm_b32 v207, v93, v89, s69
    v_perm_b32 v208, v70, v66, s68
    v_perm_b32 v209, v78, v74, s68
    v_perm_b32 v210, v86, v82, s68
    v_perm_b32 v211, v94, v90, s68
    v_perm_b32 v212, v70, v66, s69
    v_perm_b32 v213, v78, v74, s69
    v_perm_b32 v214, v86, v82, s69
    v_perm_b32 v215, v94, v90, s69
    v_perm_b32 v216, v71, v67, s68
    v_perm_b32 v217, v79, v75, s68
    v_perm_b32 v218, v87, v83, s68
    v_perm_b32 v219, v95, v91, s68
    v_perm_b32 v220, v71, v67, s69
    v_perm_b32 v221, v79, v75, s69
    v_perm_b32 v222, v87, v83, s69
    v_perm_b32 v223, v95, v91, s69
    v_perm_b32 v224, v100, v96, s68
    v_perm_b32 v225, v108, v104, s68
    v_perm_b32 v226, v116, v112, s68
    v_perm_b32 v227, v124, v120, s68
    v_perm_b32 v228, v100, v96, s69
    v_perm_b32 v229, v108, v104, s69
    v_perm_b32 v230, v116, v112, s69
    v_perm_b32 v231, v124, v120, s69
    v_perm_b32 v232, v101, v97, s68
    v_perm_b32 v233, v109, v105, s68
    v_perm_b32 v234, v117, v113, s68
    v_perm_b32 v235, v125, v121, s68
    v_perm_b32 v236, v101, v97, s69
    v_perm_b32 v237, v109, v105, s69
    v_perm_b32 v238, v117, v113, s69
    v_perm_b32 v239, v125, v121, s69
    v_perm_b32 v240, v102, v98, s68
    v_perm_b32 v241, v110, v106, s68
    v_perm_b32 v242, v118, v114, s68
    v_perm_b32 v243, v126, v122, s68
    v_perm_b32 v244, v102, v98, s69
    v_perm_b32 v245, v110, v106, s69
    v_perm_b32 v246, v118, v114, s69
    v_perm_b32 v247, v126, v122, s69
    v_perm_b32 v248, v103, v99, s68
    v_perm_b32 v249, v111, v107, s68
    v_perm_b32 v250, v119, v115, s68
    v_perm_b32 v251, v127, v123, s68
    v_perm_b32 v252, v103, v99, s69
    v_perm_b32 v253, v111, v107, s69
    v_perm_b32 v254, v119, v115, s69
    v_perm_b32 v255, v127, v123, s69
    s_barrier
    s_cmp_lg_u32 s56, 0
    s_cbranch_scc1 Lwf_83
    v_lshlrev_b32 v40, 2, v1
    s_mov_b64 exec, 0xffffffff
    s_mov_b32 s92, 0
Lpoll_84:
    buffer_load_dword v41, v40, s[32:35], s93 offen offset:0 sc0 sc1
    s_waitcnt vmcnt(0)
    v_mov_b32 v42, v41
    v_cmpx_eq_u32 vcc, -1, v42
    s_cbranch_execz Lpolld_85
    s_sleep 8
    s_add_u32 s92, s92, 1
    s_cmp_lt_u32 s92, 400000
    s_cbranch_scc1 Lpoll_84
Lpolld_85:
    s_mov_b64 exec, -1
Lwf_83:
    s_barrier
    s_lshr_b32 s66, s56, 2
    s_and_b32 s63, s56, 3
    s_lshl_b32 s61, s56, 17
    s_lshl_b32 s62, s65, 10
    s_add_u32 s61, s61, s62
    s_add_u32 s61, s61, 2097152
    v_lshlrev_b32 v40, 3, v3
    s_lshl_b32 s62, s65, 8
    s_lshl_b32 s64, s66, 7
    s_add_u32 s62, s62, s64
    s_add_u32 s62, s62, 1245184
    buffer_load_dwordx2 v[42:43], v40, s[32:35], s62 offen sc0 sc1
    buffer_load_dwordx4 v[64:67], v5, s[32:35], s61 offen sc0 sc1
    s_add_u32 s61, s61, 32768
    buffer_load_dwordx4 v[68:71], v5, s[32:35], s61 offen sc0 sc1
    s_add_u32 s61, s61, 32768
    buffer_load_dwordx4 v[72:75], v5, s[32:35], s61 offen sc0 sc1
    s_add_u32 s61, s61, 32768
    buffer_load_dwordx4 v[76:79], v5, s[32:35], s61 offen sc0 sc1
    s_waitcnt vmcnt(4)
    v_mov_b32 v44, v42
    s_nop 1
    v_max_f32_dpp v44, v44, v44 row_ror:8 row_mask:0xf bank_mask:0xf
    s_nop 1
    v_max_f32_dpp v44, v44, v44 row_ror:4 row_mask:0xf bank_mask:0xf
    s_nop 1
    v_max_f32_dpp v44, v44, v44 row_ror:2 row_mask:0xf bank_mask:0xf
    s_nop 1
    v_max_f32_dpp v44, v44, v44 row_ror:1 row_mask:0xf bank_mask:0xf
    v_sub_f32 v42, v42, v44
    v_exp_f32 v42, v42
    s_nop 0
    v_mul_f32 v43, v43, v42
    s_nop 1
    v_add_f32_dpp v43, v43, v43 row_ror:8 row_mask:0xf bank_mask:0xf
    s_nop 1
    v_add_f32_dpp v43, v43, v43 row_ror:4 row_mask:0xf bank_mask:0xf
    s_nop 1
    v_add_f32_dpp v43, v43, v43 row_ror:2 row_mask:0xf bank_mask:0xf
    s_nop 1
    v_add_f32_dpp v43, v43, v43 row_ror:1 row_mask:0xf bank_mask:0xf
    v_rcp_f32 v43, v43
    s_nop 0
    v_mul_f32 v42, v42, v43
    s_lshl_b32 s63, s63, 2
    s_nop 1
    s_add_u32 s64, s63, 0
    v_readlane_b32 s76, v42, s64
    s_add_u32 s64, s63, 1
    v_readlane_b32 s77, v42, s64
    s_add_u32 s64, s63, 2
    v_readlane_b32 s78, v42, s64
    s_add_u32 s64, s63, 3
    v_readlane_b32 s79, v42, s64
    s_nop 1
    s_waitcnt vmcnt(3)
    v_lshlrev_b32 v48, 16, v64
    v_and_b32 v49, 0xffff0000, v64
    v_lshlrev_b32 v50, 16, v65
    v_and_b32 v51, 0xffff0000, v65
    v_lshlrev_b32 v52, 16, v66
    v_and_b32 v53, 0xffff0000, v66
    v_lshlrev_b32 v54, 16, v67
    v_and_b32 v55, 0xffff0000, v67
    v_mul_f32 v24, s76, v48
    v_mul_f32 v25, s76, v49
    v_mul_f32 v26, s76, v50
    v_mul_f32 v27, s76, v51
    v_mul_f32 v28, s76, v52
    v_mul_f32 v29, s76, v53
    v_mul_f32 v30, s76, v54
    v_mul_f32 v31, s76, v55
    s_waitcnt vmcnt(2)
    v_lshlrev_b32 v48, 16, v68
    v_and_b32 v49, 0xffff0000, v68
    v_lshlrev_b32 v50, 16, v69
    v_and_b32 v51, 0xffff0000, v69
    v_lshlrev_b32 v52, 16, v70
    v_and_b32 v53, 0xffff0000, v70
    v_lshlrev_b32 v54, 16, v71
    v_and_b32 v55, 0xffff0000, v71
    v_fmac_f32 v24, s77, v48
    v_fmac_f32 v25, s77, v49
    v_fmac_f32 v26, s77, v50
    v_fmac_f32 v27, s77, v51
    v_fmac_f32 v28, s77, v52
    v_fmac_f32 v29, s77, v53
    v_fmac_f32 v30, s77, v54
    v_fmac_f32 v31, s77, v55
    s_waitcnt vmcnt(1)
    v_lshlrev_b32 v48, 16, v72
    v_and_b32 v49, 0xffff0000, v72
    v_lshlrev_b32 v50, 16, v73
    v_and_b32 v51, 0xffff0000, v73
    v_lshlrev_b32 v52, 16, v74
    v_and_b32 v53, 0xffff0000, v74
    v_lshlrev_b32 v54, 16, v75
    v_and_b32 v55, 0xffff0000, v75
    v_fmac_f32 v24, s78, v48
    v_fmac_f32 v25, s78, v49
    v_fmac_f32 v26, s78, v50
    v_fmac_f32 v27, s78, v51
    v_fmac_f32 v28, s78, v52
    v_fmac_f32 v29, s78, v53
    v_fmac_f32 v30, s78, v54
    v_fmac_f32 v31, s78, v55
    s_waitcnt vmcnt(0)
    v_lshlrev_b32 v48, 16, v76
    v_and_b32 v49, 0xffff0000, v76
    v_lshlrev_b32 v50, 16, v77
    v_and_b32 v51, 0xffff0000, v77
    v_lshlrev_b32 v52, 16, v78
    v_and_b32 v53, 0xffff0000, v78
    v_lshlrev_b32 v54, 16, v79
    v_and_b32 v55, 0xffff0000, v79
    v_fmac_f32 v24, s79, v48
    v_fmac_f32 v25, s79, v49
    v_fmac_f32 v26, s79, v50
    v_fmac_f32 v27, s79, v51
    v_fmac_f32 v28, s79, v52
    v_fmac_f32 v29, s79, v53
    v_fmac_f32 v30, s79, v54
    v_fmac_f32 v31, s79, v55
    s_mov_b32 s36, s14
    s_mov_b32 s37, s15
    s_and_b32 s37, s37, 0xffff
    s_mov_b32 s38, 4194304
    s_mov_b32 s39, 0x00020000
    v_or_b32 v40, 0, v2
    v_lshlrev_b32 v40, 1, v40
    v_xor_b32 v40, v40, v3
    v_lshlrev_b32 v40, 4, v40
    v_lshl_add_u32 v44, v2, 10, v40
    v_or_b32 v40, 4, v2
    v_lshlrev_b32 v40, 1, v40
    v_xor_b32 v40, v40, v3
    v_lshlrev_b32 v40, 4, v40
    v_lshl_add_u32 v45, v2, 10, v40
    s_lshl_b32 s61, s65, 17
    s_lshl_b32 s62, s56, 14
    s_add_u32 s61, s61, s62
    s_add_u32 s61, s61, 512
    s_lshl_b32 s62, s56, 12
    s_add_u32 s62, s62, 65536
    s_add_u32 m0, s62, 0
    s_nop 0
    buffer_load_dwordx4 v44, s[36:39], s61 offen nt lds
    s_add_u32 m0, s62, 1024
    s_add_u32 s61, s61, 4096
    buffer_load_dwordx4 v44, s[36:39], s61 offen nt lds
    s_add_u32 m0, s62, 2048
    s_add_u32 s61, s61, 4096
    buffer_load_dwordx4 v45, s[36:39], s61 offen nt lds
    s_add_u32 m0, s62, 3072
    s_add_u32 s61, s61, 4096
    buffer_load_dwordx4 v45, s[36:39], s61 offen nt lds
    s_lshl_b32 s61, s56, 11
    v_lshlrev_b32 v40, 5, v1
    v_add_u32 v40, s61, v40
    ds_write_b128 v40, v[24:27] offset:16384
    ds_write_b128 v40, v[28:31] offset:16400
    s_waitcnt lgkmcnt(0)
    s_barrier
    v_and_b32 v40, 255, v0
    v_lshlrev_b32 v40, 3, v40
    s_lshl_b32 s61, s66, 13
    v_add_u32 v40, s61, v40
    ds_read_b64 v[24:25], v40 offset:16384
    ds_read_b64 v[26:27], v40 offset:18432
    ds_read_b64 v[28:29], v40 offset:20480
    ds_read_b64 v[30:31], v40 offset:22528
    s_waitcnt lgkmcnt(0)
    v_add_f32 v24, v24, v26
    v_add_f32 v25, v25, v27
    v_add_f32 v24, v24, v28
    v_add_f32 v25, v25, v29
    v_add_f32 v24, v24, v30
    v_add_f32 v25, v25, v31
    v_cvt_pk_bf16_f32 v24, v24, v25
    v_lshlrev_b32 v40, 2, v0
    ds_write_b32 v40, v24 offset:32768
    s_waitcnt lgkmcnt(0)
    s_barrier
    s_lshl_b32 s61, s56, 7
    v_lshlrev_b32 v40, 5, v2
    v_and_b32 v41, 1, v3
    v_lshl_add_u32 v40, v41, 10, v40
    v_add_u32 v40, s61, v40
    ds_read_b128 v[8:11], v40 offset:32768
    ds_read_b128 v[12:15], v40 offset:32784
    s_waitcnt lgkmcnt(1)
    v_mfma_f32_16x16x32_bf16 v[96:99], v[8:11], v[192:195], 0
    v_mfma_f32_16x16x32_bf16 v[100:103], v[8:11], v[196:199], 0
    v_mfma_f32_16x16x32_bf16 v[104:107], v[8:11], v[200:203], 0
    v_mfma_f32_16x16x32_bf16 v[108:111], v[8:11], v[204:207], 0
    v_mfma_f32_16x16x32_bf16 v[112:115], v[8:11], v[208:211], 0
    v_mfma_f32_16x16x32_bf16 v[116:119], v[8:11], v[212:215], 0
    v_mfma_f32_16x16x32_bf16 v[120:123], v[8:11], v[216:219], 0
    v_mfma_f32_16x16x32_bf16 v[124:127], v[8:11], v[220:223], 0
    s_waitcnt lgkmcnt(0)
    v_mfma_f32_16x16x32_bf16 v[96:99], v[12:15], v[224:227], v[96:99]
    v_mfma_f32_16x16x32_bf16 v[100:103], v[12:15], v[228:231], v[100:103]
    v_mfma_f32_16x16x32_bf16 v[104:107], v[12:15], v[232:235], v[104:107]
    v_mfma_f32_16x16x32_bf16 v[108:111], v[12:15], v[236:239], v[108:111]
    v_mfma_f32_16x16x32_bf16 v[112:115], v[12:15], v[240:243], v[112:115]
    v_mfma_f32_16x16x32_bf16 v[116:119], v[12:15], v[244:247], v[116:119]
    v_mfma_f32_16x16x32_bf16 v[120:123], v[12:15], v[248:251], v[120:123]
    v_mfma_f32_16x16x32_bf16 v[124:127], v[12:15], v[252:255], v[124:127]
    v_lshlrev_b32 v40, 5, v3
    s_lshl_b32 s61, s56, 9
    v_add_u32 v40, s61, v40
    s_nop 7
    v_mov_b32 v24, v96
    v_mov_b32 v25, v100
    v_mov_b32 v26, v104
    v_mov_b32 v27, v108
    v_mov_b32 v28, v112
    v_mov_b32 v29, v116
    v_mov_b32 v30, v120
    v_mov_b32 v31, v124
    v_mov_b32 v32, v97
    v_mov_b32 v33, v101
    v_mov_b32 v34, v105
    v_mov_b32 v35, v109
    v_mov_b32 v36, v113
    v_mov_b32 v37, v117
    v_mov_b32 v38, v121
    v_mov_b32 v39, v125
    s_mov_b64 exec, 0xffff
    ds_write_b128 v40, v[24:27] offset:0
    ds_write_b128 v40, v[28:31] offset:16
    ds_write_b128 v40, v[32:35] offset:4096
    ds_write_b128 v40, v[36:39] offset:4112
    s_mov_b64 exec, -1
    s_waitcnt lgkmcnt(0)
    s_waitcnt vmcnt(0)
    s_barrier
    s_mov_b32 s79, 16
    s_mov_b32 s80, 5376
    s_cmp_ge_u32 s56, 4
    s_cbranch_scc1 L_dist
    s_cmp_lg_u32 s56, 0
    s_cbranch_scc1 Lt103_86
    v_lshrrev_b32 v40, 5, v1
    v_lshlrev_b32 v40, 12, v40
    v_and_b32 v41, 31, v1
    v_lshl_add_u32 v40, v41, 4, v40
    ds_read_b128 v[64:67], v40 offset:0
    ds_read_b128 v[68:71], v40 offset:512
    ds_read_b128 v[72:75], v40 offset:1024
    ds_read_b128 v[76:79], v40 offset:1536
    ds_read_b128 v[80:83], v40 offset:2048
    ds_read_b128 v[84:87], v40 offset:2560
    ds_read_b128 v[88:91], v40 offset:3072
    ds_read_b128 v[92:95], v40 offset:3584
    v_lshlrev_b32 v46, 3, v1
    v_add_u32 v47, 98304, v46
    s_add_u32 s61, s65, 32
    s_mul_i32 s61, s61, 16384
    s_add_u32 s61, s61, 7424
    s_waitcnt lgkmcnt(6)
    v_add_f32 v64, v64, v68
    v_add_f32 v65, v65, v69
    v_add_f32 v66, v66, v70
    v_add_f32 v67, v67, v71
    s_waitcnt lgkmcnt(5)
    v_add_f32 v64, v64, v72
    v_add_f32 v65, v65, v73
    v_add_f32 v66, v66, v74
    v_add_f32 v67, v67, v75
    s_waitcnt lgkmcnt(4)
    v_add_f32 v64, v64, v76
    v_add_f32 v65, v65, v77
    v_add_f32 v66, v66, v78
    v_add_f32 v67, v67, v79
    s_waitcnt lgkmcnt(3)
    v_add_f32 v64, v64, v80
    v_add_f32 v65, v65, v81
    v_add_f32 v66, v66, v82
    v_add_f32 v67, v67, v83
    s_waitcnt lgkmcnt(2)
    v_add_f32 v64, v64, v84
    v_add_f32 v65, v65, v85
    v_add_f32 v66, v66, v86
    v_add_f32 v67, v67, v87
    s_waitcnt lgkmcnt(1)
    v_add_f32 v64, v64, v88
    v_add_f32 v65, v65, v89
    v_add_f32 v66, v66, v90
    v_add_f32 v67, v67, v91
    s_waitcnt lgkmcnt(0)
    v_add_f32 v64, v64, v92
    v_add_f32 v65, v65, v93
    v_add_f32 v66, v66, v94
    v_add_f32 v67, v67, v95
    v_cvt_pk_bf16_f32 v64, v64, v65
    v_cvt_pk_bf16_f32 v65, v66, v67
    buffer_store_dwordx2 v[64:65], v46, s[32:35], s61 offen sc0 sc1
    ds_write_b64 v47, v[64:65]
    s_waitcnt lgkmcnt(0)
Lt103_86:
    s_barrier
    s_branch L_final
L_final:
    s_cmp_ge_u32 s56, 2
    s_cbranch_scc1 L_end
    s_lshr_b32 s66, s75, 5
    s_and_b32 s64, s75, 31
    v_lshlrev_b32 v8, 5, v1
    s_lshl_b32 s61, s56, 11
    s_add_u32 s61, s61, 3328
    s_add_u32 s61, s61, s93
    v_and_b32 v6, 1, v1
    v_lshlrev_b32 v6, 4, v6
    v_lshl_add_u32 v6, v2, 2, v6
    s_lshl_b32 s57, s66, 11
    s_lshl_b32 s58, s64, 5
    s_add_u32 s57, s57, s58
    s_xor_b32 s58, s56, 1
    s_lshl_b32 s58, s58, 10
    s_add_u32 s57, s57, s58
    s_mov_b32 s36, s26
    s_mov_b32 s37, s27
    s_and_b32 s37, s37, 0xffff
    s_mov_b32 s38, 4096
    s_mov_b32 s39, 0x00020000
    s_mov_b32 s92, 0
    buffer_load_dwordx4 v[12:15], v8, s[32:35], s61 offen sc0 sc1
    buffer_load_dwordx4 v[16:19], v8, s[32:35], s61 offen offset:16 sc0 sc1
Lp2_89:
    buffer_load_dwordx4 v[24:27], v8, s[32:35], s61 offen sc0 sc1
    buffer_load_dwordx4 v[28:31], v8, s[32:35], s61 offen offset:16 sc0 sc1
    s_waitcnt vmcnt(2)
    v_mov_b32 v22, v12
    v_max3_u32 v22, v22, v13, v14
    v_max3_u32 v22, v22, v15, v16
    v_max3_u32 v22, v22, v17, v18
    v_max_u32 v22, v22, v19
    v_cmp_eq_u32 vcc, -1, v22
    s_cbranch_vccz Lp2A_90
    buffer_load_dwordx4 v[12:15], v8, s[32:35], s61 offen sc0 sc1
    buffer_load_dwordx4 v[16:19], v8, s[32:35], s61 offen offset:16 sc0 sc1
    s_waitcnt vmcnt(2)
    v_mov_b32 v22, v24
    v_max3_u32 v22, v22, v25, v26
    v_max3_u32 v22, v22, v27, v28
    v_max3_u32 v22, v22, v29, v30
    v_max_u32 v22, v22, v31
    v_cmp_eq_u32 vcc, -1, v22
    s_cbranch_vccz Lp2B_91
    s_add_u32 s92, s92, 1
    s_cmp_lt_u32 s92, 400000
    s_cbranch_scc1 Lp2_89
Lp2B_91:
    s_waitcnt vmcnt(0)
    v_mov_b32 v12, v24
    v_mov_b32 v13, v25
    v_mov_b32 v14, v26
    v_mov_b32 v15, v27
    v_mov_b32 v16, v28
    v_mov_b32 v17, v29
    v_mov_b32 v18, v30
    v_mov_b32 v19, v31
    s_branch Lp2D_92
Lp2A_90:
Lp2D_92:
Lfsk_87:
    s_nop 1
    v_permlane32_swap_b32 v12, v16
    v_permlane32_swap_b32 v13, v17
    v_permlane32_swap_b32 v14, v18
    v_permlane32_swap_b32 v15, v19
    s_nop 1
    v_add_f32 v12, v12, v16
    v_add_f32 v13, v13, v17
    v_add_f32 v14, v14, v18
    v_add_f32 v15, v15, v19
    s_nop 1
    v_permlane16_swap_b32 v12, v14
    v_permlane16_swap_b32 v13, v15
    s_nop 1
    v_add_f32 v12, v12, v14
    v_add_f32 v13, v13, v15
    s_nop 0
    v_add_f32_dpp v12, v12, v12 row_ror:8 row_mask:0xf bank_mask:0xf
    v_add_f32_dpp v13, v13, v13 row_ror:8 row_mask:0xf bank_mask:0xf
    s_nop 0
    v_add_f32_dpp v12, v12, v12 row_ror:4 row_mask:0xf bank_mask:0xf
    v_add_f32_dpp v13, v13, v13 row_ror:4 row_mask:0xf bank_mask:0xf
    s_nop 0
    v_add_f32_dpp v12, v12, v12 quad_perm:[2,3,0,1] row_mask:0xf bank_mask:0xf
    v_add_f32_dpp v13, v13, v13 quad_perm:[2,3,0,1] row_mask:0xf bank_mask:0xf
    v_cvt_pk_bf16_f32 v12, v12, v13
    s_mov_b32 exec_lo, 0x00030003
    s_mov_b32 exec_hi, 0x00030003
    buffer_store_dword v12, v6, s[36:39], s57 offen
    s_mov_b64 exec, -1
    s_branch L_end
L_end:
    s_endpgm
.section .rodata,"a"
.p2align 6
.amdhsa_kernel concat_heads__compressed_kv_cla__gqa_block_cached__decode_kernel
  .amdhsa_next_free_vgpr 256
  .amdhsa_next_free_sgpr 102
  .amdhsa_accum_offset 256
  .amdhsa_group_segment_fixed_size 0
  .amdhsa_kernarg_size 112
  .amdhsa_user_sgpr_count 2
  .amdhsa_user_sgpr_kernarg_segment_ptr 1
  .amdhsa_system_sgpr_workgroup_id_x 1
.end_amdhsa_kernel
```
